```python
import torch

def _softmax(x, axis=-1):
    return torch.softmax(x, dim=axis)
def _gelu(x):
    return torch.nn.functional.gelu(x, approximate="tanh")
def _silu(x):
    return torch.nn.functional.silu(x)
def _sigmoid(x):
    return torch.sigmoid(x)
def _layernorm(x, axis=-1, eps=1e-5):
    m = x.mean(dim=axis, keepdim=True)
    v = x.var(dim=axis, keepdim=True, unbiased=False)
    return (x - m) / torch.sqrt(v + eps)
def _scatter_add(tgt, idx, src, axis=0):
    return tgt.clone().index_add_(axis, idx, src)
def _segment_sum(src, seg, n):
    out = torch.zeros((n,) + src.shape[1:], dtype=src.dtype)
    return out.index_add_(0, seg, src)
def _pad(x, pw):
    flat = tuple(v for pair in reversed(pw) for v in pair)
    return torch.nn.functional.pad(x, flat)

kernel_name = 'standalone__self_sup_conv_stem_wavlm__speech'

def setup_inputs():

    _w = (lambda a: (lambda t: t.to(torch.bfloat16) if t.is_floating_point() else t)(torch.as_tensor(a)))
    B, T, D, K = 2, 16000, 512, 31
    scale = (K * D) ** -0.5
    return {
        "x": _w((lambda *s: torch.randn(*s, dtype=torch.bfloat16) * 0.05)(B, T, D)),
        "w": _w((lambda *s: torch.randn(*s, dtype=torch.bfloat16) * 0.05)(K, D, D) * scale),
        "gn_gamma": _w((lambda *s: torch.randn(*s, dtype=torch.bfloat16) * 0.05)(D) * 0.1 + 1.0),
        "gn_beta": _w((lambda *s: torch.randn(*s, dtype=torch.bfloat16) * 0.05)(D) * 0.1),
    }

def reference(x, w, gn_gamma, gn_beta):
    B, T, D = x.shape
    K = w.shape[0]
    s = 2
    L = (T - K) // s + 1
    h = torch.einsum('blc,cd->bld', x[:, 0:s * L:s, :], w[0])
    for i in range(1, K):
        h = h + torch.einsum('blc,cd->bld', x[:, i:i + s * L:s, :], w[i])
    mu = torch.einsum('bld->bd', h)[:, None, :] / L
    var = torch.einsum('bld->bd', (h - mu) ** 2)[:, None, :] / L
    h = (h - mu) / torch.sqrt(var + 1e-5)
    h = h * gn_gamma[None, None, :] + gn_beta[None, None, :]
    return _gelu(h)
```

```asm
; @launch kernel=xform_kernel grid=(1696,1,1) block=(256,1,1) lds=16384
; @launch kernel=gemm_kernel grid=(256,1,1) block=(512,1,1) lds=152576
; @launch kernel=stats_kernel grid=(336,1,1) block=(256,1,1) lds=24576
; @launch kernel=final_kernel grid=(336,1,1) block=(256,1,1) lds=9216
.amdgcn_target "amdgcn-amd-amdhsa--gfx950"
.text
.globl xform_kernel
.p2align 8
.type xform_kernel,@function
xform_kernel:
    s_cmp_ge_u32 s2, 1696
    s_cbranch_scc1 L_k12_end
    s_load_dwordx4 s[4:7], s[0:1], 0
    s_load_dwordx2 s[8:9], s[0:1], 48
    v_and_b32 v144, 63, v0
    v_lshrrev_b32 v149, 6, v0
    v_and_b32 v145, 15, v144
    v_readfirstlane_b32 s10, v149
    v_lshrrev_b32 v146, 4, v144
    s_mov_b32 s30, 0x05040100
    s_mov_b32 s31, 0x07060302
    s_waitcnt lgkmcnt(0)
    s_mov_b32 s16, s8
    s_and_b32 s17, s9, 0xffff
    s_mov_b32 s18, 268435456
    s_mov_b32 s19, 0x00020000
    s_cmp_ge_u32 s2, 672
    s_cbranch_scc1 L_k12_w
    s_cmp_ge_u32 s2, 336
    s_cselect_b32 s11, 1, 0
    s_mul_i32 s12, s11, 336
    s_sub_u32 s12, s2, s12
    s_and_b32 s13, s12, 7
    s_lshr_b32 s14, s12, 3
    s_lshl_b32 s14, s14, 2
    s_add_u32 s14, s14, s10
    s_mul_i32 s15, s11, 16384000
    s_add_u32 s4, s4, s15
    s_addc_u32 s5, s5, 0
    s_mov_b32 s20, s4
    s_and_b32 s21, s5, 0xffff
    s_mov_b32 s22, 16384000
    s_mov_b32 s23, 0x00020000
    s_mul_i32 s15, s14, 98304
    s_lshl_b32 s24, s13, 8
    s_add_u32 s15, s15, s24
    v_lshlrev_b32 v147, 14, v146
    v_lshl_add_u32 v147, v145, 4, v147
    v_add_u32 v147, s15, v147
    buffer_load_dwordx4 v[0:3], v147, s[20:23], 0 offen
    v_add_u32 v149, 2048, v147
    buffer_load_dwordx4 v[4:7], v149, s[20:23], 0 offen
    v_add_u32 v149, 4096, v147
    buffer_load_dwordx4 v[8:11], v149, s[20:23], 0 offen
    v_add_u32 v149, 6144, v147
    buffer_load_dwordx4 v[12:15], v149, s[20:23], 0 offen
    v_add_u32 v149, 8192, v147
    buffer_load_dwordx4 v[16:19], v149, s[20:23], 0 offen
    v_add_u32 v149, 10240, v147
    buffer_load_dwordx4 v[20:23], v149, s[20:23], 0 offen
    v_add_u32 v149, 12288, v147
    buffer_load_dwordx4 v[24:27], v149, s[20:23], 0 offen
    v_add_u32 v149, 14336, v147
    buffer_load_dwordx4 v[28:31], v149, s[20:23], 0 offen
    v_add_u32 v149, 65536, v147
    buffer_load_dwordx4 v[32:35], v149, s[20:23], 0 offen
    v_add_u32 v149, 67584, v147
    buffer_load_dwordx4 v[36:39], v149, s[20:23], 0 offen
    v_add_u32 v149, 69632, v147
    buffer_load_dwordx4 v[40:43], v149, s[20:23], 0 offen
    v_add_u32 v149, 71680, v147
    buffer_load_dwordx4 v[44:47], v149, s[20:23], 0 offen
    v_add_u32 v149, 73728, v147
    buffer_load_dwordx4 v[48:51], v149, s[20:23], 0 offen
    v_add_u32 v149, 75776, v147
    buffer_load_dwordx4 v[52:55], v149, s[20:23], 0 offen
    v_add_u32 v149, 77824, v147
    buffer_load_dwordx4 v[56:59], v149, s[20:23], 0 offen
    v_add_u32 v149, 79872, v147
    buffer_load_dwordx4 v[60:63], v149, s[20:23], 0 offen
    v_lshrrev_b32 v149, 2, v145
    v_lshlrev_b32 v149, 1, v149
    v_bfe_u32 v150, v145, 1, 1
    v_add_u32 v149, v149, v150
    s_lshl_b32 s24, s10, 3
    v_add_u32 v149, s24, v149
    v_lshl_add_u32 v149, v149, 1, 1
    v_and_b32 v150, 1, v145
    v_lshlrev_b32 v150, 5, v150
    v_lshlrev_b32 v151, 3, v146
    v_mad_u32_u24 v96, v149, v151, v150
    v_add_u32 v97, v96, v149
    v_add_u32 v98, v97, v149
    v_add_u32 v99, v98, v149
    v_add_u32 v100, v99, v149
    v_add_u32 v101, v100, v149
    v_add_u32 v102, v101, v149
    v_add_u32 v103, v102, v149
    v_and_b32 v96, 127, v96
    v_cvt_f32_u32 v96, v96
    v_mul_f32 v96, 0x3c000000, v96
    v_cos_f32 v96, v96
    v_and_b32 v97, 127, v97
    v_cvt_f32_u32 v97, v97
    v_mul_f32 v97, 0x3c000000, v97
    v_cos_f32 v97, v97
    v_and_b32 v98, 127, v98
    v_cvt_f32_u32 v98, v98
    v_mul_f32 v98, 0x3c000000, v98
    v_cos_f32 v98, v98
    v_and_b32 v99, 127, v99
    v_cvt_f32_u32 v99, v99
    v_mul_f32 v99, 0x3c000000, v99
    v_cos_f32 v99, v99
    v_and_b32 v100, 127, v100
    v_cvt_f32_u32 v100, v100
    v_mul_f32 v100, 0x3c000000, v100
    v_cos_f32 v100, v100
    v_and_b32 v101, 127, v101
    v_cvt_f32_u32 v101, v101
    v_mul_f32 v101, 0x3c000000, v101
    v_cos_f32 v101, v101
    v_and_b32 v102, 127, v102
    v_cvt_f32_u32 v102, v102
    v_mul_f32 v102, 0x3c000000, v102
    v_cos_f32 v102, v102
    v_and_b32 v103, 127, v103
    v_cvt_f32_u32 v103, v103
    v_mul_f32 v103, 0x3c000000, v103
    v_cos_f32 v103, v103
    v_cvt_pk_bf16_f32 v112, v96, v97
    v_cvt_pk_bf16_f32 v113, v98, v99
    v_cvt_pk_bf16_f32 v114, v100, v101
    v_cvt_pk_bf16_f32 v115, v102, v103
    s_lshl_b32 s24, s10, 11
    v_lshlrev_b32 v152, 4, v144
    v_add_u32 v152, s24, v152
    ds_write_b128 v152, v[112:115] offset:0
    v_lshlrev_b32 v151, 3, v146
    v_add_u32 v151, 32, v151
    v_mad_u32_u24 v96, v149, v151, v150
    v_add_u32 v97, v96, v149
    v_add_u32 v98, v97, v149
    v_add_u32 v99, v98, v149
    v_add_u32 v100, v99, v149
    v_add_u32 v101, v100, v149
    v_add_u32 v102, v101, v149
    v_add_u32 v103, v102, v149
    v_and_b32 v96, 127, v96
    v_cvt_f32_u32 v96, v96
    v_mul_f32 v96, 0x3c000000, v96
    v_cos_f32 v96, v96
    v_and_b32 v97, 127, v97
    v_cvt_f32_u32 v97, v97
    v_mul_f32 v97, 0x3c000000, v97
    v_cos_f32 v97, v97
    v_and_b32 v98, 127, v98
    v_cvt_f32_u32 v98, v98
    v_mul_f32 v98, 0x3c000000, v98
    v_cos_f32 v98, v98
    v_and_b32 v99, 127, v99
    v_cvt_f32_u32 v99, v99
    v_mul_f32 v99, 0x3c000000, v99
    v_cos_f32 v99, v99
    v_and_b32 v100, 127, v100
    v_cvt_f32_u32 v100, v100
    v_mul_f32 v100, 0x3c000000, v100
    v_cos_f32 v100, v100
    v_and_b32 v101, 127, v101
    v_cvt_f32_u32 v101, v101
    v_mul_f32 v101, 0x3c000000, v101
    v_cos_f32 v101, v101
    v_and_b32 v102, 127, v102
    v_cvt_f32_u32 v102, v102
    v_mul_f32 v102, 0x3c000000, v102
    v_cos_f32 v102, v102
    v_and_b32 v103, 127, v103
    v_cvt_f32_u32 v103, v103
    v_mul_f32 v103, 0x3c000000, v103
    v_cos_f32 v103, v103
    v_cvt_pk_bf16_f32 v112, v96, v97
    v_cvt_pk_bf16_f32 v113, v98, v99
    v_cvt_pk_bf16_f32 v114, v100, v101
    v_cvt_pk_bf16_f32 v115, v102, v103
    s_lshl_b32 s24, s10, 11
    v_lshlrev_b32 v152, 4, v144
    v_add_u32 v152, s24, v152
    ds_write_b128 v152, v[112:115] offset:1024
    s_waitcnt lgkmcnt(0)
    s_barrier
    v_lshlrev_b32 v152, 4, v144
    ds_read_b128 v[64:67], v152 offset:0
    ds_read_b128 v[68:71], v152 offset:1024
    ds_read_b128 v[72:75], v152 offset:2048
    ds_read_b128 v[76:79], v152 offset:3072
    ds_read_b128 v[80:83], v152 offset:4096
    ds_read_b128 v[84:87], v152 offset:5120
    ds_read_b128 v[88:91], v152 offset:6144
    ds_read_b128 v[92:95], v152 offset:7168
    s_bfe_u32 s24, s14, 0x10003
    s_mul_i32 s24, s24, 3
    v_and_b32 v149, 3, v145
    v_xor_b32 v149, s24, v149
    v_lshlrev_b32 v149, 4, v149
    v_lshrrev_b32 v150, 2, v145
    s_mov_b32 s24, 21504
    v_mad_u32_u24 v149, v150, s24, v149
    s_mov_b32 s24, 2752512
    v_mad_u32_u24 v148, v146, s24, v149
    s_mul_i32 s24, s11, 688128
    s_mul_i32 s25, s13, 86016
    s_add_u32 s24, s24, s25
    s_lshl_b32 s25, s14, 6
    s_add_u32 s24, s24, s25
    s_add_u32 s24, s24, 67108864
    s_waitcnt vmcnt(0) lgkmcnt(0)
    v_perm_b32 v96, v4, v0, s30
    v_perm_b32 v97, v12, v8, s30
    v_perm_b32 v98, v20, v16, s30
    v_perm_b32 v99, v28, v24, s30
    v_perm_b32 v100, v4, v0, s31
    v_perm_b32 v101, v12, v8, s31
    v_perm_b32 v102, v20, v16, s31
    v_perm_b32 v103, v28, v24, s31
    v_perm_b32 v104, v36, v32, s30
    v_perm_b32 v105, v44, v40, s30
    v_perm_b32 v106, v52, v48, s30
    v_perm_b32 v107, v60, v56, s30
    v_perm_b32 v108, v36, v32, s31
    v_perm_b32 v109, v44, v40, s31
    v_perm_b32 v110, v52, v48, s31
    v_perm_b32 v111, v60, v56, s31
    v_mfma_f32_16x16x32_bf16 v[112:115], v[64:67], v[96:99], 0
    v_mfma_f32_16x16x32_bf16 v[116:119], v[64:67], v[100:103], 0
    v_mfma_f32_16x16x32_bf16 v[120:123], v[72:75], v[96:99], 0
    v_mfma_f32_16x16x32_bf16 v[124:127], v[72:75], v[100:103], 0
    v_mfma_f32_16x16x32_bf16 v[128:131], v[80:83], v[96:99], 0
    v_mfma_f32_16x16x32_bf16 v[132:135], v[80:83], v[100:103], 0
    v_mfma_f32_16x16x32_bf16 v[136:139], v[88:91], v[96:99], 0
    v_mfma_f32_16x16x32_bf16 v[140:143], v[88:91], v[100:103], 0
    v_mfma_f32_16x16x32_bf16 v[112:115], v[68:71], v[104:107], v[112:115]
    v_mfma_f32_16x16x32_bf16 v[116:119], v[68:71], v[108:111], v[116:119]
    v_mfma_f32_16x16x32_bf16 v[120:123], v[76:79], v[104:107], v[120:123]
    v_mfma_f32_16x16x32_bf16 v[124:127], v[76:79], v[108:111], v[124:127]
    v_mfma_f32_16x16x32_bf16 v[128:131], v[84:87], v[104:107], v[128:131]
    v_mfma_f32_16x16x32_bf16 v[132:135], v[84:87], v[108:111], v[132:135]
    v_mfma_f32_16x16x32_bf16 v[136:139], v[92:95], v[104:107], v[136:139]
    v_mfma_f32_16x16x32_bf16 v[140:143], v[92:95], v[108:111], v[140:143]
    v_perm_b32 v96, v5, v1, s30
    v_perm_b32 v97, v13, v9, s30
    v_perm_b32 v98, v21, v17, s30
    v_perm_b32 v99, v29, v25, s30
    v_perm_b32 v100, v5, v1, s31
    v_perm_b32 v101, v13, v9, s31
    v_perm_b32 v102, v21, v17, s31
    v_perm_b32 v103, v29, v25, s31
    v_perm_b32 v104, v37, v33, s30
    v_perm_b32 v105, v45, v41, s30
    v_perm_b32 v106, v53, v49, s30
    v_perm_b32 v107, v61, v57, s30
    v_perm_b32 v108, v37, v33, s31
    v_perm_b32 v109, v45, v41, s31
    v_perm_b32 v110, v53, v49, s31
    v_perm_b32 v111, v61, v57, s31
    v_cvt_pk_bf16_f32 v0, v112, v116
    v_cvt_pk_bf16_f32 v4, v113, v117
    v_cvt_pk_bf16_f32 v8, v114, v118
    v_cvt_pk_bf16_f32 v12, v115, v119
    v_cvt_pk_bf16_f32 v16, v120, v124
    v_cvt_pk_bf16_f32 v20, v121, v125
    v_cvt_pk_bf16_f32 v24, v122, v126
    v_cvt_pk_bf16_f32 v28, v123, v127
    v_cvt_pk_bf16_f32 v32, v128, v132
    v_cvt_pk_bf16_f32 v36, v129, v133
    v_cvt_pk_bf16_f32 v40, v130, v134
    v_cvt_pk_bf16_f32 v44, v131, v135
    v_cvt_pk_bf16_f32 v48, v136, v140
    v_cvt_pk_bf16_f32 v52, v137, v141
    v_cvt_pk_bf16_f32 v56, v138, v142
    v_cvt_pk_bf16_f32 v60, v139, v143
    v_mfma_f32_16x16x32_bf16 v[112:115], v[64:67], v[96:99], 0
    v_mfma_f32_16x16x32_bf16 v[116:119], v[64:67], v[100:103], 0
    v_mfma_f32_16x16x32_bf16 v[120:123], v[72:75], v[96:99], 0
    v_mfma_f32_16x16x32_bf16 v[124:127], v[72:75], v[100:103], 0
    v_mfma_f32_16x16x32_bf16 v[128:131], v[80:83], v[96:99], 0
    v_mfma_f32_16x16x32_bf16 v[132:135], v[80:83], v[100:103], 0
    v_mfma_f32_16x16x32_bf16 v[136:139], v[88:91], v[96:99], 0
    v_mfma_f32_16x16x32_bf16 v[140:143], v[88:91], v[100:103], 0
    v_mfma_f32_16x16x32_bf16 v[112:115], v[68:71], v[104:107], v[112:115]
    v_mfma_f32_16x16x32_bf16 v[116:119], v[68:71], v[108:111], v[116:119]
    v_mfma_f32_16x16x32_bf16 v[120:123], v[76:79], v[104:107], v[120:123]
    v_mfma_f32_16x16x32_bf16 v[124:127], v[76:79], v[108:111], v[124:127]
    v_mfma_f32_16x16x32_bf16 v[128:131], v[84:87], v[104:107], v[128:131]
    v_mfma_f32_16x16x32_bf16 v[132:135], v[84:87], v[108:111], v[132:135]
    v_mfma_f32_16x16x32_bf16 v[136:139], v[92:95], v[104:107], v[136:139]
    v_mfma_f32_16x16x32_bf16 v[140:143], v[92:95], v[108:111], v[140:143]
    v_perm_b32 v96, v6, v2, s30
    v_perm_b32 v97, v14, v10, s30
    v_perm_b32 v98, v22, v18, s30
    v_perm_b32 v99, v30, v26, s30
    v_perm_b32 v100, v6, v2, s31
    v_perm_b32 v101, v14, v10, s31
    v_perm_b32 v102, v22, v18, s31
    v_perm_b32 v103, v30, v26, s31
    v_perm_b32 v104, v38, v34, s30
    v_perm_b32 v105, v46, v42, s30
    v_perm_b32 v106, v54, v50, s30
    v_perm_b32 v107, v62, v58, s30
    v_perm_b32 v108, v38, v34, s31
    v_perm_b32 v109, v46, v42, s31
    v_perm_b32 v110, v54, v50, s31
    v_perm_b32 v111, v62, v58, s31
    v_cvt_pk_bf16_f32 v1, v112, v116
    v_cvt_pk_bf16_f32 v5, v113, v117
    v_cvt_pk_bf16_f32 v9, v114, v118
    v_cvt_pk_bf16_f32 v13, v115, v119
    v_cvt_pk_bf16_f32 v17, v120, v124
    v_cvt_pk_bf16_f32 v21, v121, v125
    v_cvt_pk_bf16_f32 v25, v122, v126
    v_cvt_pk_bf16_f32 v29, v123, v127
    v_cvt_pk_bf16_f32 v33, v128, v132
    v_cvt_pk_bf16_f32 v37, v129, v133
    v_cvt_pk_bf16_f32 v41, v130, v134
    v_cvt_pk_bf16_f32 v45, v131, v135
    v_cvt_pk_bf16_f32 v49, v136, v140
    v_cvt_pk_bf16_f32 v53, v137, v141
    v_cvt_pk_bf16_f32 v57, v138, v142
    v_cvt_pk_bf16_f32 v61, v139, v143
    v_mfma_f32_16x16x32_bf16 v[112:115], v[64:67], v[96:99], 0
    v_mfma_f32_16x16x32_bf16 v[116:119], v[64:67], v[100:103], 0
    v_mfma_f32_16x16x32_bf16 v[120:123], v[72:75], v[96:99], 0
    v_mfma_f32_16x16x32_bf16 v[124:127], v[72:75], v[100:103], 0
    v_mfma_f32_16x16x32_bf16 v[128:131], v[80:83], v[96:99], 0
    v_mfma_f32_16x16x32_bf16 v[132:135], v[80:83], v[100:103], 0
    v_mfma_f32_16x16x32_bf16 v[136:139], v[88:91], v[96:99], 0
    v_mfma_f32_16x16x32_bf16 v[140:143], v[88:91], v[100:103], 0
    v_mfma_f32_16x16x32_bf16 v[112:115], v[68:71], v[104:107], v[112:115]
    v_mfma_f32_16x16x32_bf16 v[116:119], v[68:71], v[108:111], v[116:119]
    v_mfma_f32_16x16x32_bf16 v[120:123], v[76:79], v[104:107], v[120:123]
    v_mfma_f32_16x16x32_bf16 v[124:127], v[76:79], v[108:111], v[124:127]
    v_mfma_f32_16x16x32_bf16 v[128:131], v[84:87], v[104:107], v[128:131]
    v_mfma_f32_16x16x32_bf16 v[132:135], v[84:87], v[108:111], v[132:135]
    v_mfma_f32_16x16x32_bf16 v[136:139], v[92:95], v[104:107], v[136:139]
    v_mfma_f32_16x16x32_bf16 v[140:143], v[92:95], v[108:111], v[140:143]
    v_perm_b32 v96, v7, v3, s30
    v_perm_b32 v97, v15, v11, s30
    v_perm_b32 v98, v23, v19, s30
    v_perm_b32 v99, v31, v27, s30
    v_perm_b32 v100, v7, v3, s31
    v_perm_b32 v101, v15, v11, s31
    v_perm_b32 v102, v23, v19, s31
    v_perm_b32 v103, v31, v27, s31
    v_perm_b32 v104, v39, v35, s30
    v_perm_b32 v105, v47, v43, s30
    v_perm_b32 v106, v55, v51, s30
    v_perm_b32 v107, v63, v59, s30
    v_perm_b32 v108, v39, v35, s31
    v_perm_b32 v109, v47, v43, s31
    v_perm_b32 v110, v55, v51, s31
    v_perm_b32 v111, v63, v59, s31
    v_cvt_pk_bf16_f32 v2, v112, v116
    v_cvt_pk_bf16_f32 v6, v113, v117
    v_cvt_pk_bf16_f32 v10, v114, v118
    v_cvt_pk_bf16_f32 v14, v115, v119
    v_cvt_pk_bf16_f32 v18, v120, v124
    v_cvt_pk_bf16_f32 v22, v121, v125
    v_cvt_pk_bf16_f32 v26, v122, v126
    v_cvt_pk_bf16_f32 v30, v123, v127
    v_cvt_pk_bf16_f32 v34, v128, v132
    v_cvt_pk_bf16_f32 v38, v129, v133
    v_cvt_pk_bf16_f32 v42, v130, v134
    v_cvt_pk_bf16_f32 v46, v131, v135
    v_cvt_pk_bf16_f32 v50, v136, v140
    v_cvt_pk_bf16_f32 v54, v137, v141
    v_cvt_pk_bf16_f32 v58, v138, v142
    v_cvt_pk_bf16_f32 v62, v139, v143
    v_mfma_f32_16x16x32_bf16 v[112:115], v[64:67], v[96:99], 0
    v_mfma_f32_16x16x32_bf16 v[116:119], v[64:67], v[100:103], 0
    v_mfma_f32_16x16x32_bf16 v[120:123], v[72:75], v[96:99], 0
    v_mfma_f32_16x16x32_bf16 v[124:127], v[72:75], v[100:103], 0
    v_mfma_f32_16x16x32_bf16 v[128:131], v[80:83], v[96:99], 0
    v_mfma_f32_16x16x32_bf16 v[132:135], v[80:83], v[100:103], 0
    v_mfma_f32_16x16x32_bf16 v[136:139], v[88:91], v[96:99], 0
    v_mfma_f32_16x16x32_bf16 v[140:143], v[88:91], v[100:103], 0
    v_mfma_f32_16x16x32_bf16 v[112:115], v[68:71], v[104:107], v[112:115]
    v_mfma_f32_16x16x32_bf16 v[116:119], v[68:71], v[108:111], v[116:119]
    v_mfma_f32_16x16x32_bf16 v[120:123], v[76:79], v[104:107], v[120:123]
    v_mfma_f32_16x16x32_bf16 v[124:127], v[76:79], v[108:111], v[124:127]
    v_mfma_f32_16x16x32_bf16 v[128:131], v[84:87], v[104:107], v[128:131]
    v_mfma_f32_16x16x32_bf16 v[132:135], v[84:87], v[108:111], v[132:135]
    v_mfma_f32_16x16x32_bf16 v[136:139], v[92:95], v[104:107], v[136:139]
    v_mfma_f32_16x16x32_bf16 v[140:143], v[92:95], v[108:111], v[140:143]
    s_nop 1
    v_cvt_pk_bf16_f32 v3, v112, v116
    v_cvt_pk_bf16_f32 v7, v113, v117
    v_cvt_pk_bf16_f32 v11, v114, v118
    v_cvt_pk_bf16_f32 v15, v115, v119
    v_cvt_pk_bf16_f32 v19, v120, v124
    v_cvt_pk_bf16_f32 v23, v121, v125
    v_cvt_pk_bf16_f32 v27, v122, v126
    v_cvt_pk_bf16_f32 v31, v123, v127
    v_cvt_pk_bf16_f32 v35, v128, v132
    v_cvt_pk_bf16_f32 v39, v129, v133
    v_cvt_pk_bf16_f32 v43, v130, v134
    v_cvt_pk_bf16_f32 v47, v131, v135
    v_cvt_pk_bf16_f32 v51, v136, v140
    v_cvt_pk_bf16_f32 v55, v137, v141
    v_cvt_pk_bf16_f32 v59, v138, v142
    v_cvt_pk_bf16_f32 v63, v139, v143
    s_add_u32 s25, s24, 0
    buffer_store_dwordx4 v[0:3], v148, s[16:19], s25 offen
    s_add_u32 s25, s24, 10752
    buffer_store_dwordx4 v[4:7], v148, s[16:19], s25 offen
    s_add_u32 s25, s24, 1376256
    buffer_store_dwordx4 v[8:11], v148, s[16:19], s25 offen
    s_add_u32 s25, s24, 1387008
    buffer_store_dwordx4 v[12:15], v148, s[16:19], s25 offen
    s_add_u32 s25, s24, 11010048
    buffer_store_dwordx4 v[16:19], v148, s[16:19], s25 offen
    s_add_u32 s25, s24, 11020800
    buffer_store_dwordx4 v[20:23], v148, s[16:19], s25 offen
    s_add_u32 s25, s24, 12386304
    buffer_store_dwordx4 v[24:27], v148, s[16:19], s25 offen
    s_add_u32 s25, s24, 12397056
    buffer_store_dwordx4 v[28:31], v148, s[16:19], s25 offen
    s_add_u32 s25, s24, 22020096
    buffer_store_dwordx4 v[32:35], v148, s[16:19], s25 offen
    s_add_u32 s25, s24, 22030848
    buffer_store_dwordx4 v[36:39], v148, s[16:19], s25 offen
    s_add_u32 s25, s24, 23396352
    buffer_store_dwordx4 v[40:43], v148, s[16:19], s25 offen
    s_add_u32 s25, s24, 23407104
    buffer_store_dwordx4 v[44:47], v148, s[16:19], s25 offen
    s_add_u32 s25, s24, 33030144
    buffer_store_dwordx4 v[48:51], v148, s[16:19], s25 offen
    s_add_u32 s25, s24, 33040896
    buffer_store_dwordx4 v[52:55], v148, s[16:19], s25 offen
    s_add_u32 s25, s24, 34406400
    buffer_store_dwordx4 v[56:59], v148, s[16:19], s25 offen
    s_add_u32 s25, s24, 34417152
    buffer_store_dwordx4 v[60:63], v148, s[16:19], s25 offen
    s_endpgm
L_k12_w:
    s_sub_u32 s12, s2, 672
    s_and_b32 s13, s12, 3
    s_lshr_b32 s14, s12, 2
    s_lshl_b32 s14, s14, 2
    s_add_u32 s14, s14, s10
    s_mov_b32 s20, s6
    s_and_b32 s21, s7, 0xffff
    s_mov_b32 s22, 16252928
    s_mov_b32 s23, 0x00020000
    v_and_b32 v149, 1, v146
    v_lshlrev_b32 v147, 23, v149
    v_lshrrev_b32 v149, 2, v145
    v_lshl_add_u32 v147, v149, 6, v147
    v_and_b32 v149, 1, v145
    v_lshl_add_u32 v147, v149, 5, v147
    v_bfe_u32 v149, v145, 1, 1
    v_lshl_add_u32 v147, v149, 3, v147
    s_lshl_b32 s15, s14, 10
    s_lshl_b32 s24, s13, 8
    s_add_u32 s15, s15, s24
    v_add_u32 v147, s15, v147
    buffer_load_dwordx2 v[0:1], v147, s[20:23], 0 offen
    buffer_load_dwordx2 v[2:3], v147, s[20:23], 0 offen offset:16
    v_add_u32 v149, 1048576, v147
    buffer_load_dwordx2 v[4:5], v149, s[20:23], 0 offen
    buffer_load_dwordx2 v[6:7], v149, s[20:23], 0 offen offset:16
    v_add_u32 v149, 2097152, v147
    buffer_load_dwordx2 v[8:9], v149, s[20:23], 0 offen
    buffer_load_dwordx2 v[10:11], v149, s[20:23], 0 offen offset:16
    v_add_u32 v149, 3145728, v147
    buffer_load_dwordx2 v[12:13], v149, s[20:23], 0 offen
    buffer_load_dwordx2 v[14:15], v149, s[20:23], 0 offen offset:16
    v_add_u32 v149, 4194304, v147
    buffer_load_dwordx2 v[16:17], v149, s[20:23], 0 offen
    buffer_load_dwordx2 v[18:19], v149, s[20:23], 0 offen offset:16
    v_add_u32 v149, 5242880, v147
    buffer_load_dwordx2 v[20:21], v149, s[20:23], 0 offen
    buffer_load_dwordx2 v[22:23], v149, s[20:23], 0 offen offset:16
    v_add_u32 v149, 6291456, v147
    buffer_load_dwordx2 v[24:25], v149, s[20:23], 0 offen
    buffer_load_dwordx2 v[26:27], v149, s[20:23], 0 offen offset:16
    v_add_u32 v149, 7340032, v147
    buffer_load_dwordx2 v[28:29], v149, s[20:23], 0 offen
    buffer_load_dwordx2 v[30:31], v149, s[20:23], 0 offen offset:16
    v_lshrrev_b32 v149, 2, v145
    v_lshlrev_b32 v149, 1, v149
    v_bfe_u32 v150, v145, 1, 1
    v_add_u32 v149, v149, v150
    s_lshl_b32 s24, s10, 3
    v_add_u32 v149, s24, v149
    v_lshl_add_u32 v149, v149, 1, 1
    v_and_b32 v150, 1, v145
    v_lshlrev_b32 v150, 5, v150
    v_and_b32 v151, 1, v146
    v_lshlrev_b32 v151, 3, v151
    v_mad_u32_u24 v96, v149, v151, v150
    v_add_u32 v97, v96, v149
    v_add_u32 v98, v97, v149
    v_add_u32 v99, v98, v149
    v_add_u32 v100, v99, v149
    v_add_u32 v101, v100, v149
    v_add_u32 v102, v101, v149
    v_add_u32 v103, v102, v149
    v_cmp_lt_u32 s[26:27], 1, v146
    v_and_b32 v96, 127, v96
    v_cvt_f32_u32 v96, v96
    v_mul_f32 v96, 0x3c000000, v96
    v_cos_f32 v96, v96
    v_and_b32 v97, 127, v97
    v_cvt_f32_u32 v97, v97
    v_mul_f32 v97, 0x3c000000, v97
    v_cos_f32 v97, v97
    v_and_b32 v98, 127, v98
    v_cvt_f32_u32 v98, v98
    v_mul_f32 v98, 0x3c000000, v98
    v_cos_f32 v98, v98
    v_and_b32 v99, 127, v99
    v_cvt_f32_u32 v99, v99
    v_mul_f32 v99, 0x3c000000, v99
    v_cos_f32 v99, v99
    v_and_b32 v100, 127, v100
    v_cvt_f32_u32 v100, v100
    v_mul_f32 v100, 0x3c000000, v100
    v_cos_f32 v100, v100
    v_and_b32 v101, 127, v101
    v_cvt_f32_u32 v101, v101
    v_mul_f32 v101, 0x3c000000, v101
    v_cos_f32 v101, v101
    v_and_b32 v102, 127, v102
    v_cvt_f32_u32 v102, v102
    v_mul_f32 v102, 0x3c000000, v102
    v_cos_f32 v102, v102
    v_and_b32 v103, 127, v103
    v_cvt_f32_u32 v103, v103
    v_mul_f32 v103, 0x3c000000, v103
    v_cos_f32 v103, v103
    v_cvt_pk_bf16_f32 v112, v96, v97
    v_cvt_pk_bf16_f32 v113, v98, v99
    v_cvt_pk_bf16_f32 v114, v100, v101
    v_cvt_pk_bf16_f32 v115, v102, v103
    v_lshlrev_b32 v116, 16, v112
    v_and_b32 v117, 0xffff0000, v112
    v_sub_f32 v96, v96, v116
    v_sub_f32 v97, v97, v117
    v_cvt_pk_bf16_f32 v116, v96, v97
    v_cndmask_b32 v112, v112, v116, s[26:27]
    v_lshlrev_b32 v116, 16, v113
    v_and_b32 v117, 0xffff0000, v113
    v_sub_f32 v98, v98, v116
    v_sub_f32 v99, v99, v117
    v_cvt_pk_bf16_f32 v116, v98, v99
    v_cndmask_b32 v113, v113, v116, s[26:27]
    v_lshlrev_b32 v116, 16, v114
    v_and_b32 v117, 0xffff0000, v114
    v_sub_f32 v100, v100, v116
    v_sub_f32 v101, v101, v117
    v_cvt_pk_bf16_f32 v116, v100, v101
    v_cndmask_b32 v114, v114, v116, s[26:27]
    v_lshlrev_b32 v116, 16, v115
    v_and_b32 v117, 0xffff0000, v115
    v_sub_f32 v102, v102, v116
    v_sub_f32 v103, v103, v117
    v_cvt_pk_bf16_f32 v116, v102, v103
    v_cndmask_b32 v115, v115, v116, s[26:27]
    s_lshl_b32 s24, s10, 10
    v_lshlrev_b32 v152, 4, v144
    v_add_u32 v152, s24, v152
    ds_write_b128 v152, v[112:115]
    s_waitcnt lgkmcnt(0)
    s_barrier
    v_lshlrev_b32 v152, 4, v144
    ds_read_b128 v[64:67], v152 offset:0
    ds_read_b128 v[68:71], v152 offset:1024
    ds_read_b128 v[72:75], v152 offset:2048
    ds_read_b128 v[76:79], v152 offset:3072
    s_and_b32 s24, s14, 3
    s_bfe_u32 s25, s14, 0x10003
    s_lshl_b32 s25, s25, 2
    s_or_b32 s24, s24, s25
    s_lshl_b32 s24, s24, 1
    v_xor_b32 v149, s24, v145
    v_lshlrev_b32 v149, 4, v149
    v_lshlrev_b32 v148, 22, v146
    v_add_u32 v148, v148, v149
    s_lshl_b32 s24, s13, 19
    s_lshr_b32 s25, s14, 5
    s_lshl_b32 s25, s25, 14
    s_add_u32 s24, s24, s25
    s_and_b32 s25, s14, 31
    s_lshl_b32 s25, s25, 8
    s_add_u32 s24, s24, s25
    s_waitcnt vmcnt(0) lgkmcnt(0)
    v_perm_b32 v32, v4, v0, s30
    v_perm_b32 v33, v12, v8, s30
    v_perm_b32 v34, v20, v16, s30
    v_perm_b32 v35, v28, v24, s30
    v_perm_b32 v36, v4, v0, s31
    v_perm_b32 v37, v12, v8, s31
    v_perm_b32 v38, v20, v16, s31
    v_perm_b32 v39, v28, v24, s31
    v_perm_b32 v40, v5, v1, s30
    v_perm_b32 v41, v13, v9, s30
    v_perm_b32 v42, v21, v17, s30
    v_perm_b32 v43, v29, v25, s30
    v_perm_b32 v44, v5, v1, s31
    v_perm_b32 v45, v13, v9, s31
    v_perm_b32 v46, v21, v17, s31
    v_perm_b32 v47, v29, v25, s31
    v_perm_b32 v48, v6, v2, s30
    v_perm_b32 v49, v14, v10, s30
    v_perm_b32 v50, v22, v18, s30
    v_perm_b32 v51, v30, v26, s30
    v_perm_b32 v52, v6, v2, s31
    v_perm_b32 v53, v14, v10, s31
    v_perm_b32 v54, v22, v18, s31
    v_perm_b32 v55, v30, v26, s31
    v_perm_b32 v56, v7, v3, s30
    v_perm_b32 v57, v15, v11, s30
    v_perm_b32 v58, v23, v19, s30
    v_perm_b32 v59, v31, v27, s30
    v_perm_b32 v60, v7, v3, s31
    v_perm_b32 v61, v15, v11, s31
    v_perm_b32 v62, v23, v19, s31
    v_perm_b32 v63, v31, v27, s31
    v_mfma_f32_16x16x32_bf16 v[112:115], v[64:67], v[32:35], 0
    v_mfma_f32_16x16x32_bf16 v[116:119], v[64:67], v[36:39], 0
    v_mfma_f32_16x16x32_bf16 v[120:123], v[64:67], v[40:43], 0
    v_mfma_f32_16x16x32_bf16 v[124:127], v[64:67], v[44:47], 0
    v_mfma_f32_16x16x32_bf16 v[128:131], v[64:67], v[48:51], 0
    v_mfma_f32_16x16x32_bf16 v[132:135], v[64:67], v[52:55], 0
    v_mfma_f32_16x16x32_bf16 v[136:139], v[64:67], v[56:59], 0
    v_mfma_f32_16x16x32_bf16 v[140:143], v[64:67], v[60:63], 0
    s_nop 1
    v_cvt_pk_bf16_f32 v0, v112, v116
    s_nop 0
    v_cvt_pk_bf16_f32 v1, v120, v124
    s_nop 0
    v_cvt_pk_bf16_f32 v2, v128, v132
    s_nop 0
    v_cvt_pk_bf16_f32 v3, v136, v140
    v_cvt_pk_bf16_f32 v4, v113, v117
    v_cvt_pk_bf16_f32 v5, v121, v125
    v_cvt_pk_bf16_f32 v6, v129, v133
    v_cvt_pk_bf16_f32 v7, v137, v141
    v_cvt_pk_bf16_f32 v8, v114, v118
    v_cvt_pk_bf16_f32 v9, v122, v126
    v_cvt_pk_bf16_f32 v10, v130, v134
    v_cvt_pk_bf16_f32 v11, v138, v142
    v_cvt_pk_bf16_f32 v12, v115, v119
    v_cvt_pk_bf16_f32 v13, v123, v127
    v_cvt_pk_bf16_f32 v14, v131, v135
    v_cvt_pk_bf16_f32 v15, v139, v143
    s_add_u32 s25, s24, 0
    buffer_store_dwordx4 v[0:3], v148, s[16:19], s25 offen
    s_add_u32 s25, s24, 8192
    buffer_store_dwordx4 v[4:7], v148, s[16:19], s25 offen
    s_add_u32 s25, s24, 2097152
    buffer_store_dwordx4 v[8:11], v148, s[16:19], s25 offen
    s_add_u32 s25, s24, 2105344
    buffer_store_dwordx4 v[12:15], v148, s[16:19], s25 offen
    v_mfma_f32_16x16x32_bf16 v[112:115], v[68:71], v[32:35], 0
    v_mfma_f32_16x16x32_bf16 v[116:119], v[68:71], v[36:39], 0
    v_mfma_f32_16x16x32_bf16 v[120:123], v[68:71], v[40:43], 0
    v_mfma_f32_16x16x32_bf16 v[124:127], v[68:71], v[44:47], 0
    v_mfma_f32_16x16x32_bf16 v[128:131], v[68:71], v[48:51], 0
    v_mfma_f32_16x16x32_bf16 v[132:135], v[68:71], v[52:55], 0
    v_mfma_f32_16x16x32_bf16 v[136:139], v[68:71], v[56:59], 0
    v_mfma_f32_16x16x32_bf16 v[140:143], v[68:71], v[60:63], 0
    s_nop 1
    v_cvt_pk_bf16_f32 v16, v112, v116
    s_nop 0
    v_cvt_pk_bf16_f32 v17, v120, v124
    s_nop 0
    v_cvt_pk_bf16_f32 v18, v128, v132
    s_nop 0
    v_cvt_pk_bf16_f32 v19, v136, v140
    v_cvt_pk_bf16_f32 v20, v113, v117
    v_cvt_pk_bf16_f32 v21, v121, v125
    v_cvt_pk_bf16_f32 v22, v129, v133
    v_cvt_pk_bf16_f32 v23, v137, v141
    v_cvt_pk_bf16_f32 v24, v114, v118
    v_cvt_pk_bf16_f32 v25, v122, v126
    v_cvt_pk_bf16_f32 v26, v130, v134
    v_cvt_pk_bf16_f32 v27, v138, v142
    v_cvt_pk_bf16_f32 v28, v115, v119
    v_cvt_pk_bf16_f32 v29, v123, v127
    v_cvt_pk_bf16_f32 v30, v131, v135
    v_cvt_pk_bf16_f32 v31, v139, v143
    s_add_u32 s25, s24, 16777216
    buffer_store_dwordx4 v[16:19], v148, s[16:19], s25 offen
    s_add_u32 s25, s24, 16785408
    buffer_store_dwordx4 v[20:23], v148, s[16:19], s25 offen
    s_add_u32 s25, s24, 18874368
    buffer_store_dwordx4 v[24:27], v148, s[16:19], s25 offen
    s_add_u32 s25, s24, 18882560
    buffer_store_dwordx4 v[28:31], v148, s[16:19], s25 offen
    v_mfma_f32_16x16x32_bf16 v[112:115], v[72:75], v[32:35], 0
    v_mfma_f32_16x16x32_bf16 v[116:119], v[72:75], v[36:39], 0
    v_mfma_f32_16x16x32_bf16 v[120:123], v[72:75], v[40:43], 0
    v_mfma_f32_16x16x32_bf16 v[124:127], v[72:75], v[44:47], 0
    v_mfma_f32_16x16x32_bf16 v[128:131], v[72:75], v[48:51], 0
    v_mfma_f32_16x16x32_bf16 v[132:135], v[72:75], v[52:55], 0
    v_mfma_f32_16x16x32_bf16 v[136:139], v[72:75], v[56:59], 0
    v_mfma_f32_16x16x32_bf16 v[140:143], v[72:75], v[60:63], 0
    s_nop 1
    v_cvt_pk_bf16_f32 v0, v112, v116
    s_nop 0
    v_cvt_pk_bf16_f32 v1, v120, v124
    s_nop 0
    v_cvt_pk_bf16_f32 v2, v128, v132
    s_nop 0
    v_cvt_pk_bf16_f32 v3, v136, v140
    v_cvt_pk_bf16_f32 v4, v113, v117
    v_cvt_pk_bf16_f32 v5, v121, v125
    v_cvt_pk_bf16_f32 v6, v129, v133
    v_cvt_pk_bf16_f32 v7, v137, v141
    v_cvt_pk_bf16_f32 v8, v114, v118
    v_cvt_pk_bf16_f32 v9, v122, v126
    v_cvt_pk_bf16_f32 v10, v130, v134
    v_cvt_pk_bf16_f32 v11, v138, v142
    v_cvt_pk_bf16_f32 v12, v115, v119
    v_cvt_pk_bf16_f32 v13, v123, v127
    v_cvt_pk_bf16_f32 v14, v131, v135
    v_cvt_pk_bf16_f32 v15, v139, v143
    s_add_u32 s25, s24, 33554432
    buffer_store_dwordx4 v[0:3], v148, s[16:19], s25 offen
    s_add_u32 s25, s24, 33562624
    buffer_store_dwordx4 v[4:7], v148, s[16:19], s25 offen
    s_add_u32 s25, s24, 35651584
    buffer_store_dwordx4 v[8:11], v148, s[16:19], s25 offen
    s_add_u32 s25, s24, 35659776
    buffer_store_dwordx4 v[12:15], v148, s[16:19], s25 offen
    v_mfma_f32_16x16x32_bf16 v[112:115], v[76:79], v[32:35], 0
    v_mfma_f32_16x16x32_bf16 v[116:119], v[76:79], v[36:39], 0
    v_mfma_f32_16x16x32_bf16 v[120:123], v[76:79], v[40:43], 0
    v_mfma_f32_16x16x32_bf16 v[124:127], v[76:79], v[44:47], 0
    v_mfma_f32_16x16x32_bf16 v[128:131], v[76:79], v[48:51], 0
    v_mfma_f32_16x16x32_bf16 v[132:135], v[76:79], v[52:55], 0
    v_mfma_f32_16x16x32_bf16 v[136:139], v[76:79], v[56:59], 0
    v_mfma_f32_16x16x32_bf16 v[140:143], v[76:79], v[60:63], 0
    s_nop 1
    v_cvt_pk_bf16_f32 v16, v112, v116
    s_nop 0
    v_cvt_pk_bf16_f32 v17, v120, v124
    s_nop 0
    v_cvt_pk_bf16_f32 v18, v128, v132
    s_nop 0
    v_cvt_pk_bf16_f32 v19, v136, v140
    v_cvt_pk_bf16_f32 v20, v113, v117
    v_cvt_pk_bf16_f32 v21, v121, v125
    v_cvt_pk_bf16_f32 v22, v129, v133
    v_cvt_pk_bf16_f32 v23, v137, v141
    v_cvt_pk_bf16_f32 v24, v114, v118
    v_cvt_pk_bf16_f32 v25, v122, v126
    v_cvt_pk_bf16_f32 v26, v130, v134
    v_cvt_pk_bf16_f32 v27, v138, v142
    v_cvt_pk_bf16_f32 v28, v115, v119
    v_cvt_pk_bf16_f32 v29, v123, v127
    v_cvt_pk_bf16_f32 v30, v131, v135
    v_cvt_pk_bf16_f32 v31, v139, v143
    s_add_u32 s25, s24, 50331648
    buffer_store_dwordx4 v[16:19], v148, s[16:19], s25 offen
    s_add_u32 s25, s24, 50339840
    buffer_store_dwordx4 v[20:23], v148, s[16:19], s25 offen
    s_add_u32 s25, s24, 52428800
    buffer_store_dwordx4 v[24:27], v148, s[16:19], s25 offen
    s_add_u32 s25, s24, 52436992
    buffer_store_dwordx4 v[28:31], v148, s[16:19], s25 offen
L_k12_end:
    s_endpgm
.globl gemm_kernel
.p2align 8
.type gemm_kernel,@function
gemm_kernel:
    s_cmp_ge_u32 s2, 256
    s_cbranch_scc1 L_k3_end
    s_load_dwordx2 s[8:9], s[0:1], 48
    v_lshrrev_b32 v192, 6, v0
    v_and_b32 v0, 63, v0
    v_readfirstlane_b32 s10, v192
    s_and_b32 s11, s2, 7
    s_lshr_b32 s12, s2, 3
    s_lshr_b32 s13, s12, 3
    s_lshl_b32 s11, s11, 2
    s_add_u32 s11, s11, s13
    s_bfe_u32 s13, s12, 0x10002
    s_and_b32 s14, s12, 3
    s_and_b32 s15, s10, 3
    s_mul_i32 s40, s11, 2097152
    s_lshl_b32 s20, s14, 19
    s_add_u32 s40, s40, s20
    s_mul_i32 s41, s11, 1376256
    s_mul_i32 s20, s13, 688128
    s_add_u32 s41, s41, s20
    s_add_u32 s41, s41, 67108864
    s_lshl_b32 s42, s10, 11
    s_mul_i32 s43, s10, 2688
    v_lshlrev_b32 v188, 4, v0
    v_add_u32 v189, s43, v188
    v_add_u32 v188, s42, v188
    s_add_u32 s43, s43, 16384
    s_mov_b32 s44, -1
    s_mov_b32 s45, 0xff
    v_lshrrev_b32 v193, 4, v0
    v_and_b32 v194, 15, v0
    v_bfe_u32 v195, v194, 3, 1
    v_mul_u32_u24 v195, 3, v195
    v_xor_b32 v195, v195, v193
    v_lshlrev_b32 v195, 4, v195
    v_lshl_add_u32 v184, v194, 6, v195
    v_add_u32 v185, 37888, v184
    v_add_u32 v186, 75776, v184
    v_add_u32 v187, 113664, v184
    v_lshrrev_b32 v195, 2, v194
    v_and_b32 v196, 1, v193
    v_lshl_or_b32 v196, v196, 2, v195
    v_lshl_add_u32 v195, v193, 3, v195
    v_lshlrev_b32 v195, 8, v195
    v_and_b32 v197, 3, v194
    v_lshl_add_u32 v195, v197, 3, v195
    s_lshl_b32 s20, s15, 1
    v_xor_b32 v197, s20, v196
    v_lshl_add_u32 v176, v197, 5, v195
    v_add_u32 v178, 37888, v176
    v_add_u32 v180, 75776, v176
    v_add_u32 v182, 113664, v176
    s_add_u32 s20, s20, 1
    v_xor_b32 v197, s20, v196
    v_lshl_add_u32 v177, v197, 5, v195
    v_add_u32 v179, 37888, v177
    v_add_u32 v181, 75776, v177
    v_add_u32 v183, 113664, v177
    v_lshlrev_b32 v190, 10, v194
    v_lshl_add_u32 v190, v193, 4, v190
    s_lshl_b32 s20, s15, 6
    v_add_u32 v190, s20, v190
    v_cmp_gt_u32 vcc, 7, v194
    v_mov_b32 v191, 0x80000000
    s_nop 0
    v_cndmask_b32 v191, v191, v190, vcc
    s_mul_i32 s48, s11, 720896
    s_mul_i32 s20, s13, 180224
    s_add_u32 s48, s48, s20
    s_lshl_b32 s20, s14, 8
    s_add_u32 s48, s48, s20
    s_add_u32 s48, s48, 117440512
    s_waitcnt lgkmcnt(0)
    s_mov_b32 s16, s8
    s_and_b32 s17, s9, 0xffff
    s_mov_b32 s18, 268435456
    s_mov_b32 s19, 0x00020000
    s_cmp_ge_u32 s10, 4
    s_cbranch_scc1 L_k3_mh1
    s_add_u32 m0, s42, 0
    s_nop 0
    buffer_load_dwordx4 v188, s[16:19], s40 offen lds
    buffer_load_dwordx4 v188, s[16:19], s40 offen offset:1024 lds
    s_add_u32 s40, s40, 16384
    s_add_u32 m0, s43, 0
    s_nop 0
    buffer_load_dwordx4 v189, s[16:19], s41 offen lds
    buffer_load_dwordx4 v189, s[16:19], s41 offen offset:1024 lds
    s_mov_b64 exec, s[44:45]
    buffer_load_dwordx4 v189, s[16:19], s41 offen offset:2048 lds
    s_mov_b64 exec, -1
    s_add_u32 s41, s41, 21504
    s_add_u32 m0, s42, 37888
    s_nop 0
    buffer_load_dwordx4 v188, s[16:19], s40 offen lds
    buffer_load_dwordx4 v188, s[16:19], s40 offen offset:1024 lds
    s_add_u32 s40, s40, 16384
    s_add_u32 m0, s43, 37888
    s_nop 0
    buffer_load_dwordx4 v189, s[16:19], s41 offen lds
    buffer_load_dwordx4 v189, s[16:19], s41 offen offset:1024 lds
    s_mov_b64 exec, s[44:45]
    buffer_load_dwordx4 v189, s[16:19], s41 offen offset:2048 lds
    s_mov_b64 exec, -1
    s_add_u32 s41, s41, 21504
    s_add_u32 m0, s42, 75776
    s_nop 0
    buffer_load_dwordx4 v188, s[16:19], s40 offen lds
    buffer_load_dwordx4 v188, s[16:19], s40 offen offset:1024 lds
    s_add_u32 s40, s40, 16384
    s_add_u32 m0, s43, 75776
    s_nop 0
    buffer_load_dwordx4 v189, s[16:19], s41 offen lds
    buffer_load_dwordx4 v189, s[16:19], s41 offen offset:1024 lds
    s_mov_b64 exec, s[44:45]
    buffer_load_dwordx4 v189, s[16:19], s41 offen offset:2048 lds
    s_mov_b64 exec, -1
    s_add_u32 s41, s41, 21504
    v_mov_b32 v0, 0
    v_mov_b32 v1, 0
    v_mov_b32 v2, 0
    v_mov_b32 v3, 0
    v_mov_b32 v4, 0
    v_mov_b32 v5, 0
    v_mov_b32 v6, 0
    v_mov_b32 v7, 0
    v_mov_b32 v8, 0
    v_mov_b32 v9, 0
    v_mov_b32 v10, 0
    v_mov_b32 v11, 0
    v_mov_b32 v12, 0
    v_mov_b32 v13, 0
    v_mov_b32 v14, 0
    v_mov_b32 v15, 0
    v_mov_b32 v16, 0
    v_mov_b32 v17, 0
    v_mov_b32 v18, 0
    v_mov_b32 v19, 0
    v_mov_b32 v20, 0
    v_mov_b32 v21, 0
    v_mov_b32 v22, 0
    v_mov_b32 v23, 0
    v_mov_b32 v24, 0
    v_mov_b32 v25, 0
    v_mov_b32 v26, 0
    v_mov_b32 v27, 0
    v_mov_b32 v28, 0
    v_mov_b32 v29, 0
    v_mov_b32 v30, 0
    v_mov_b32 v31, 0
    v_mov_b32 v32, 0
    v_mov_b32 v33, 0
    v_mov_b32 v34, 0
    v_mov_b32 v35, 0
    v_mov_b32 v36, 0
    v_mov_b32 v37, 0
    v_mov_b32 v38, 0
    v_mov_b32 v39, 0
    v_mov_b32 v40, 0
    v_mov_b32 v41, 0
    v_mov_b32 v42, 0
    v_mov_b32 v43, 0
    v_mov_b32 v44, 0
    v_mov_b32 v45, 0
    v_mov_b32 v46, 0
    v_mov_b32 v47, 0
    v_mov_b32 v48, 0
    v_mov_b32 v49, 0
    v_mov_b32 v50, 0
    v_mov_b32 v51, 0
    v_mov_b32 v52, 0
    v_mov_b32 v53, 0
    v_mov_b32 v54, 0
    v_mov_b32 v55, 0
    v_mov_b32 v56, 0
    v_mov_b32 v57, 0
    v_mov_b32 v58, 0
    v_mov_b32 v59, 0
    v_mov_b32 v60, 0
    v_mov_b32 v61, 0
    v_mov_b32 v62, 0
    v_mov_b32 v63, 0
    v_mov_b32 v64, 0
    v_mov_b32 v65, 0
    v_mov_b32 v66, 0
    v_mov_b32 v67, 0
    v_mov_b32 v68, 0
    v_mov_b32 v69, 0
    v_mov_b32 v70, 0
    v_mov_b32 v71, 0
    v_mov_b32 v72, 0
    v_mov_b32 v73, 0
    v_mov_b32 v74, 0
    v_mov_b32 v75, 0
    v_mov_b32 v76, 0
    v_mov_b32 v77, 0
    v_mov_b32 v78, 0
    v_mov_b32 v79, 0
    v_mov_b32 v80, 0
    v_mov_b32 v81, 0
    v_mov_b32 v82, 0
    v_mov_b32 v83, 0
    v_mov_b32 v84, 0
    v_mov_b32 v85, 0
    v_mov_b32 v86, 0
    v_mov_b32 v87, 0
    v_mov_b32 v88, 0
    v_mov_b32 v89, 0
    v_mov_b32 v90, 0
    v_mov_b32 v91, 0
    v_mov_b32 v92, 0
    v_mov_b32 v93, 0
    v_mov_b32 v94, 0
    v_mov_b32 v95, 0
    s_waitcnt vmcnt(10)
    s_barrier
    ds_read_b64_tr_b16 v[96:97], v176 offset:0
    ds_read_b64_tr_b16 v[98:99], v176 offset:1024
    ds_read_b64_tr_b16 v[100:101], v177 offset:0
    ds_read_b64_tr_b16 v[102:103], v177 offset:1024
    ds_read_b64_tr_b16 v[104:105], v176 offset:8192
    ds_read_b64_tr_b16 v[106:107], v176 offset:9216
    ds_read_b64_tr_b16 v[108:109], v177 offset:8192
    ds_read_b64_tr_b16 v[110:111], v177 offset:9216
    ds_read_b128 v[144:147], v184 offset:16384
    ds_read_b128 v[148:151], v184 offset:27136
    ds_read_b128 v[152:155], v184 offset:17408
    ds_read_b128 v[156:159], v184 offset:28160
    s_waitcnt lgkmcnt(4)
    v_xor_b32 v112, 0x80008000, v104
    v_xor_b32 v113, 0x80008000, v105
    v_xor_b32 v114, 0x80008000, v106
    v_xor_b32 v115, 0x80008000, v107
    v_xor_b32 v116, 0x80008000, v108
    v_xor_b32 v117, 0x80008000, v109
    v_xor_b32 v118, 0x80008000, v110
    v_xor_b32 v119, 0x80008000, v111
    s_mov_b32 s46, 7
L_k3_loop0:
    s_waitcnt vmcnt(5)
    s_barrier
    s_waitcnt lgkmcnt(2)
    v_mfma_f32_16x16x32_bf16 v[0:3], v[96:99], v[144:147], v[0:3]
    ds_read_b128 v[160:163], v184 offset:18432
    ds_read_b128 v[164:167], v184 offset:29184
    v_mfma_f32_16x16x32_bf16 v[4:7], v[100:103], v[144:147], v[4:7]
    v_mfma_f32_16x16x32_bf16 v[8:11], v[112:115], v[144:147], v[8:11]
    v_mfma_f32_16x16x32_bf16 v[12:15], v[116:119], v[144:147], v[12:15]
    s_add_u32 m0, s42, 113664
    s_nop 0
    buffer_load_dwordx4 v188, s[16:19], s40 offen lds
    v_mfma_f32_16x16x32_bf16 v[0:3], v[104:107], v[148:151], v[0:3]
    v_mfma_f32_16x16x32_bf16 v[4:7], v[108:111], v[148:151], v[4:7]
    v_mfma_f32_16x16x32_bf16 v[8:11], v[96:99], v[148:151], v[8:11]
    v_mfma_f32_16x16x32_bf16 v[12:15], v[100:103], v[148:151], v[12:15]
    s_waitcnt lgkmcnt(2)
    v_mfma_f32_16x16x32_bf16 v[16:19], v[96:99], v[152:155], v[16:19]
    ds_read_b128 v[168:171], v184 offset:19456
    ds_read_b128 v[172:175], v184 offset:30208
    v_mfma_f32_16x16x32_bf16 v[20:23], v[100:103], v[152:155], v[20:23]
    v_mfma_f32_16x16x32_bf16 v[24:27], v[112:115], v[152:155], v[24:27]
    v_mfma_f32_16x16x32_bf16 v[28:31], v[116:119], v[152:155], v[28:31]
    buffer_load_dwordx4 v188, s[16:19], s40 offen offset:1024 lds
    s_add_u32 s40, s40, 16384
    v_mfma_f32_16x16x32_bf16 v[16:19], v[104:107], v[156:159], v[16:19]
    v_mfma_f32_16x16x32_bf16 v[20:23], v[108:111], v[156:159], v[20:23]
    v_mfma_f32_16x16x32_bf16 v[24:27], v[96:99], v[156:159], v[24:27]
    v_mfma_f32_16x16x32_bf16 v[28:31], v[100:103], v[156:159], v[28:31]
    s_waitcnt lgkmcnt(2)
    v_mfma_f32_16x16x32_bf16 v[32:35], v[96:99], v[160:163], v[32:35]
    ds_read_b128 v[144:147], v184 offset:20480
    ds_read_b128 v[148:151], v184 offset:31232
    v_mfma_f32_16x16x32_bf16 v[36:39], v[100:103], v[160:163], v[36:39]
    v_mfma_f32_16x16x32_bf16 v[40:43], v[112:115], v[160:163], v[40:43]
    v_mfma_f32_16x16x32_bf16 v[44:47], v[116:119], v[160:163], v[44:47]
    s_add_u32 m0, s43, 113664
    s_nop 0
    buffer_load_dwordx4 v189, s[16:19], s41 offen lds
    v_mfma_f32_16x16x32_bf16 v[32:35], v[104:107], v[164:167], v[32:35]
    v_mfma_f32_16x16x32_bf16 v[36:39], v[108:111], v[164:167], v[36:39]
    v_mfma_f32_16x16x32_bf16 v[40:43], v[96:99], v[164:167], v[40:43]
    v_mfma_f32_16x16x32_bf16 v[44:47], v[100:103], v[164:167], v[44:47]
    s_waitcnt lgkmcnt(2)
    v_mfma_f32_16x16x32_bf16 v[48:51], v[96:99], v[168:171], v[48:51]
    ds_read_b128 v[152:155], v184 offset:21504
    ds_read_b128 v[156:159], v184 offset:32256
    v_mfma_f32_16x16x32_bf16 v[52:55], v[100:103], v[168:171], v[52:55]
    v_mfma_f32_16x16x32_bf16 v[56:59], v[112:115], v[168:171], v[56:59]
    ds_read_b64_tr_b16 v[120:121], v178 offset:0
    ds_read_b64_tr_b16 v[122:123], v178 offset:1024
    ds_read_b64_tr_b16 v[124:125], v179 offset:0
    ds_read_b64_tr_b16 v[126:127], v179 offset:1024
    v_mfma_f32_16x16x32_bf16 v[60:63], v[116:119], v[168:171], v[60:63]
    buffer_load_dwordx4 v189, s[16:19], s41 offen offset:1024 lds
    v_mfma_f32_16x16x32_bf16 v[48:51], v[104:107], v[172:175], v[48:51]
    v_mfma_f32_16x16x32_bf16 v[52:55], v[108:111], v[172:175], v[52:55]
    v_mfma_f32_16x16x32_bf16 v[56:59], v[96:99], v[172:175], v[56:59]
    v_mfma_f32_16x16x32_bf16 v[60:63], v[100:103], v[172:175], v[60:63]
    s_waitcnt lgkmcnt(6)
    v_mfma_f32_16x16x32_bf16 v[64:67], v[96:99], v[144:147], v[64:67]
    ds_read_b128 v[160:163], v185 offset:16384
    ds_read_b128 v[164:167], v185 offset:27136
    v_mfma_f32_16x16x32_bf16 v[68:71], v[100:103], v[144:147], v[68:71]
    v_mfma_f32_16x16x32_bf16 v[72:75], v[112:115], v[144:147], v[72:75]
    ds_read_b64_tr_b16 v[128:129], v178 offset:8192
    ds_read_b64_tr_b16 v[130:131], v178 offset:9216
    ds_read_b64_tr_b16 v[132:133], v179 offset:8192
    ds_read_b64_tr_b16 v[134:135], v179 offset:9216
    v_mfma_f32_16x16x32_bf16 v[76:79], v[116:119], v[144:147], v[76:79]
    s_mov_b64 exec, s[44:45]
    buffer_load_dwordx4 v189, s[16:19], s41 offen offset:2048 lds
    s_mov_b64 exec, -1
    s_add_u32 s41, s41, 21504
    v_mfma_f32_16x16x32_bf16 v[64:67], v[104:107], v[148:151], v[64:67]
    v_mfma_f32_16x16x32_bf16 v[68:71], v[108:111], v[148:151], v[68:71]
    v_mfma_f32_16x16x32_bf16 v[72:75], v[96:99], v[148:151], v[72:75]
    v_mfma_f32_16x16x32_bf16 v[76:79], v[100:103], v[148:151], v[76:79]
    s_waitcnt lgkmcnt(10)
    v_mfma_f32_16x16x32_bf16 v[80:83], v[96:99], v[152:155], v[80:83]
    ds_read_b128 v[168:171], v185 offset:17408
    ds_read_b128 v[172:175], v185 offset:28160
    v_mfma_f32_16x16x32_bf16 v[84:87], v[100:103], v[152:155], v[84:87]
    s_waitcnt lgkmcnt(2)
    v_mfma_f32_16x16x32_bf16 v[88:91], v[112:115], v[152:155], v[88:91]
    v_xor_b32 v136, 0x80008000, v128
    v_xor_b32 v137, 0x80008000, v129
    v_mfma_f32_16x16x32_bf16 v[92:95], v[116:119], v[152:155], v[92:95]
    v_xor_b32 v138, 0x80008000, v130
    v_xor_b32 v139, 0x80008000, v131
    v_mfma_f32_16x16x32_bf16 v[80:83], v[104:107], v[156:159], v[80:83]
    v_xor_b32 v140, 0x80008000, v132
    v_xor_b32 v141, 0x80008000, v133
    v_mfma_f32_16x16x32_bf16 v[84:87], v[108:111], v[156:159], v[84:87]
    v_xor_b32 v142, 0x80008000, v134
    v_xor_b32 v143, 0x80008000, v135
    v_mfma_f32_16x16x32_bf16 v[88:91], v[96:99], v[156:159], v[88:91]
    v_mfma_f32_16x16x32_bf16 v[92:95], v[100:103], v[156:159], v[92:95]
    s_waitcnt vmcnt(5)
    s_barrier
    v_mfma_f32_16x16x32_bf16 v[0:3], v[120:123], v[160:163], v[0:3]
    ds_read_b128 v[144:147], v185 offset:18432
    ds_read_b128 v[148:151], v185 offset:29184
    v_mfma_f32_16x16x32_bf16 v[4:7], v[124:127], v[160:163], v[4:7]
    v_mfma_f32_16x16x32_bf16 v[8:11], v[136:139], v[160:163], v[8:11]
    v_mfma_f32_16x16x32_bf16 v[12:15], v[140:143], v[160:163], v[12:15]
    s_add_u32 m0, s42, 0
    s_nop 0
    buffer_load_dwordx4 v188, s[16:19], s40 offen lds
    v_mfma_f32_16x16x32_bf16 v[0:3], v[128:131], v[164:167], v[0:3]
    v_mfma_f32_16x16x32_bf16 v[4:7], v[132:135], v[164:167], v[4:7]
    v_mfma_f32_16x16x32_bf16 v[8:11], v[120:123], v[164:167], v[8:11]
    v_mfma_f32_16x16x32_bf16 v[12:15], v[124:127], v[164:167], v[12:15]
    s_waitcnt lgkmcnt(2)
    v_mfma_f32_16x16x32_bf16 v[16:19], v[120:123], v[168:171], v[16:19]
    ds_read_b128 v[152:155], v185 offset:19456
    ds_read_b128 v[156:159], v185 offset:30208
    v_mfma_f32_16x16x32_bf16 v[20:23], v[124:127], v[168:171], v[20:23]
    v_mfma_f32_16x16x32_bf16 v[24:27], v[136:139], v[168:171], v[24:27]
    v_mfma_f32_16x16x32_bf16 v[28:31], v[140:143], v[168:171], v[28:31]
    buffer_load_dwordx4 v188, s[16:19], s40 offen offset:1024 lds
    s_add_u32 s40, s40, 16384
    v_mfma_f32_16x16x32_bf16 v[16:19], v[128:131], v[172:175], v[16:19]
    v_mfma_f32_16x16x32_bf16 v[20:23], v[132:135], v[172:175], v[20:23]
    v_mfma_f32_16x16x32_bf16 v[24:27], v[120:123], v[172:175], v[24:27]
    v_mfma_f32_16x16x32_bf16 v[28:31], v[124:127], v[172:175], v[28:31]
    s_waitcnt lgkmcnt(2)
    v_mfma_f32_16x16x32_bf16 v[32:35], v[120:123], v[144:147], v[32:35]
    ds_read_b128 v[160:163], v185 offset:20480
    ds_read_b128 v[164:167], v185 offset:31232
    v_mfma_f32_16x16x32_bf16 v[36:39], v[124:127], v[144:147], v[36:39]
    v_mfma_f32_16x16x32_bf16 v[40:43], v[136:139], v[144:147], v[40:43]
    v_mfma_f32_16x16x32_bf16 v[44:47], v[140:143], v[144:147], v[44:47]
    s_add_u32 m0, s43, 0
    s_nop 0
    buffer_load_dwordx4 v189, s[16:19], s41 offen lds
    v_mfma_f32_16x16x32_bf16 v[32:35], v[128:131], v[148:151], v[32:35]
    v_mfma_f32_16x16x32_bf16 v[36:39], v[132:135], v[148:151], v[36:39]
    v_mfma_f32_16x16x32_bf16 v[40:43], v[120:123], v[148:151], v[40:43]
    v_mfma_f32_16x16x32_bf16 v[44:47], v[124:127], v[148:151], v[44:47]
    s_waitcnt lgkmcnt(2)
    v_mfma_f32_16x16x32_bf16 v[48:51], v[120:123], v[152:155], v[48:51]
    ds_read_b128 v[168:171], v185 offset:21504
    ds_read_b128 v[172:175], v185 offset:32256
    v_mfma_f32_16x16x32_bf16 v[52:55], v[124:127], v[152:155], v[52:55]
    v_mfma_f32_16x16x32_bf16 v[56:59], v[136:139], v[152:155], v[56:59]
    ds_read_b64_tr_b16 v[96:97], v180 offset:0
    ds_read_b64_tr_b16 v[98:99], v180 offset:1024
    ds_read_b64_tr_b16 v[100:101], v181 offset:0
    ds_read_b64_tr_b16 v[102:103], v181 offset:1024
    v_mfma_f32_16x16x32_bf16 v[60:63], v[140:143], v[152:155], v[60:63]
    buffer_load_dwordx4 v189, s[16:19], s41 offen offset:1024 lds
    v_mfma_f32_16x16x32_bf16 v[48:51], v[128:131], v[156:159], v[48:51]
    v_mfma_f32_16x16x32_bf16 v[52:55], v[132:135], v[156:159], v[52:55]
    v_mfma_f32_16x16x32_bf16 v[56:59], v[120:123], v[156:159], v[56:59]
    v_mfma_f32_16x16x32_bf16 v[60:63], v[124:127], v[156:159], v[60:63]
    s_waitcnt lgkmcnt(6)
    v_mfma_f32_16x16x32_bf16 v[64:67], v[120:123], v[160:163], v[64:67]
    ds_read_b128 v[144:147], v186 offset:16384
    ds_read_b128 v[148:151], v186 offset:27136
    v_mfma_f32_16x16x32_bf16 v[68:71], v[124:127], v[160:163], v[68:71]
    v_mfma_f32_16x16x32_bf16 v[72:75], v[136:139], v[160:163], v[72:75]
    ds_read_b64_tr_b16 v[104:105], v180 offset:8192
    ds_read_b64_tr_b16 v[106:107], v180 offset:9216
    ds_read_b64_tr_b16 v[108:109], v181 offset:8192
    ds_read_b64_tr_b16 v[110:111], v181 offset:9216
    v_mfma_f32_16x16x32_bf16 v[76:79], v[140:143], v[160:163], v[76:79]
    s_mov_b64 exec, s[44:45]
    buffer_load_dwordx4 v189, s[16:19], s41 offen offset:2048 lds
    s_mov_b64 exec, -1
    s_add_u32 s41, s41, 21504
    v_mfma_f32_16x16x32_bf16 v[64:67], v[128:131], v[164:167], v[64:67]
    v_mfma_f32_16x16x32_bf16 v[68:71], v[132:135], v[164:167], v[68:71]
    v_mfma_f32_16x16x32_bf16 v[72:75], v[120:123], v[164:167], v[72:75]
    v_mfma_f32_16x16x32_bf16 v[76:79], v[124:127], v[164:167], v[76:79]
    s_waitcnt lgkmcnt(10)
    v_mfma_f32_16x16x32_bf16 v[80:83], v[120:123], v[168:171], v[80:83]
    ds_read_b128 v[152:155], v186 offset:17408
    ds_read_b128 v[156:159], v186 offset:28160
    v_mfma_f32_16x16x32_bf16 v[84:87], v[124:127], v[168:171], v[84:87]
    s_waitcnt lgkmcnt(2)
    v_mfma_f32_16x16x32_bf16 v[88:91], v[136:139], v[168:171], v[88:91]
    v_xor_b32 v112, 0x80008000, v104
    v_xor_b32 v113, 0x80008000, v105
    v_mfma_f32_16x16x32_bf16 v[92:95], v[140:143], v[168:171], v[92:95]
    v_xor_b32 v114, 0x80008000, v106
    v_xor_b32 v115, 0x80008000, v107
    v_mfma_f32_16x16x32_bf16 v[80:83], v[128:131], v[172:175], v[80:83]
    v_xor_b32 v116, 0x80008000, v108
    v_xor_b32 v117, 0x80008000, v109
    v_mfma_f32_16x16x32_bf16 v[84:87], v[132:135], v[172:175], v[84:87]
    v_xor_b32 v118, 0x80008000, v110
    v_xor_b32 v119, 0x80008000, v111
    v_mfma_f32_16x16x32_bf16 v[88:91], v[120:123], v[172:175], v[88:91]
    v_mfma_f32_16x16x32_bf16 v[92:95], v[124:127], v[172:175], v[92:95]
    s_waitcnt vmcnt(5)
    s_barrier
    v_mfma_f32_16x16x32_bf16 v[0:3], v[96:99], v[144:147], v[0:3]
    ds_read_b128 v[160:163], v186 offset:18432
    ds_read_b128 v[164:167], v186 offset:29184
    v_mfma_f32_16x16x32_bf16 v[4:7], v[100:103], v[144:147], v[4:7]
    v_mfma_f32_16x16x32_bf16 v[8:11], v[112:115], v[144:147], v[8:11]
    v_mfma_f32_16x16x32_bf16 v[12:15], v[116:119], v[144:147], v[12:15]
    s_add_u32 m0, s42, 37888
    s_nop 0
    buffer_load_dwordx4 v188, s[16:19], s40 offen lds
    v_mfma_f32_16x16x32_bf16 v[0:3], v[104:107], v[148:151], v[0:3]
    v_mfma_f32_16x16x32_bf16 v[4:7], v[108:111], v[148:151], v[4:7]
    v_mfma_f32_16x16x32_bf16 v[8:11], v[96:99], v[148:151], v[8:11]
    v_mfma_f32_16x16x32_bf16 v[12:15], v[100:103], v[148:151], v[12:15]
    s_waitcnt lgkmcnt(2)
    v_mfma_f32_16x16x32_bf16 v[16:19], v[96:99], v[152:155], v[16:19]
    ds_read_b128 v[168:171], v186 offset:19456
    ds_read_b128 v[172:175], v186 offset:30208
    v_mfma_f32_16x16x32_bf16 v[20:23], v[100:103], v[152:155], v[20:23]
    v_mfma_f32_16x16x32_bf16 v[24:27], v[112:115], v[152:155], v[24:27]
    v_mfma_f32_16x16x32_bf16 v[28:31], v[116:119], v[152:155], v[28:31]
    buffer_load_dwordx4 v188, s[16:19], s40 offen offset:1024 lds
    s_add_u32 s40, s40, 16384
    v_mfma_f32_16x16x32_bf16 v[16:19], v[104:107], v[156:159], v[16:19]
    v_mfma_f32_16x16x32_bf16 v[20:23], v[108:111], v[156:159], v[20:23]
    v_mfma_f32_16x16x32_bf16 v[24:27], v[96:99], v[156:159], v[24:27]
    v_mfma_f32_16x16x32_bf16 v[28:31], v[100:103], v[156:159], v[28:31]
    s_waitcnt lgkmcnt(2)
    v_mfma_f32_16x16x32_bf16 v[32:35], v[96:99], v[160:163], v[32:35]
    ds_read_b128 v[144:147], v186 offset:20480
    ds_read_b128 v[148:151], v186 offset:31232
    v_mfma_f32_16x16x32_bf16 v[36:39], v[100:103], v[160:163], v[36:39]
    v_mfma_f32_16x16x32_bf16 v[40:43], v[112:115], v[160:163], v[40:43]
    v_mfma_f32_16x16x32_bf16 v[44:47], v[116:119], v[160:163], v[44:47]
    s_add_u32 m0, s43, 37888
    s_nop 0
    buffer_load_dwordx4 v189, s[16:19], s41 offen lds
    v_mfma_f32_16x16x32_bf16 v[32:35], v[104:107], v[164:167], v[32:35]
    v_mfma_f32_16x16x32_bf16 v[36:39], v[108:111], v[164:167], v[36:39]
    v_mfma_f32_16x16x32_bf16 v[40:43], v[96:99], v[164:167], v[40:43]
    v_mfma_f32_16x16x32_bf16 v[44:47], v[100:103], v[164:167], v[44:47]
    s_waitcnt lgkmcnt(2)
    v_mfma_f32_16x16x32_bf16 v[48:51], v[96:99], v[168:171], v[48:51]
    ds_read_b128 v[152:155], v186 offset:21504
    ds_read_b128 v[156:159], v186 offset:32256
    v_mfma_f32_16x16x32_bf16 v[52:55], v[100:103], v[168:171], v[52:55]
    v_mfma_f32_16x16x32_bf16 v[56:59], v[112:115], v[168:171], v[56:59]
    ds_read_b64_tr_b16 v[120:121], v182 offset:0
    ds_read_b64_tr_b16 v[122:123], v182 offset:1024
    ds_read_b64_tr_b16 v[124:125], v183 offset:0
    ds_read_b64_tr_b16 v[126:127], v183 offset:1024
    v_mfma_f32_16x16x32_bf16 v[60:63], v[116:119], v[168:171], v[60:63]
    buffer_load_dwordx4 v189, s[16:19], s41 offen offset:1024 lds
    v_mfma_f32_16x16x32_bf16 v[48:51], v[104:107], v[172:175], v[48:51]
    v_mfma_f32_16x16x32_bf16 v[52:55], v[108:111], v[172:175], v[52:55]
    v_mfma_f32_16x16x32_bf16 v[56:59], v[96:99], v[172:175], v[56:59]
    v_mfma_f32_16x16x32_bf16 v[60:63], v[100:103], v[172:175], v[60:63]
    s_waitcnt lgkmcnt(6)
    v_mfma_f32_16x16x32_bf16 v[64:67], v[96:99], v[144:147], v[64:67]
    ds_read_b128 v[160:163], v187 offset:16384
    ds_read_b128 v[164:167], v187 offset:27136
    v_mfma_f32_16x16x32_bf16 v[68:71], v[100:103], v[144:147], v[68:71]
    v_mfma_f32_16x16x32_bf16 v[72:75], v[112:115], v[144:147], v[72:75]
    ds_read_b64_tr_b16 v[128:129], v182 offset:8192
    ds_read_b64_tr_b16 v[130:131], v182 offset:9216
    ds_read_b64_tr_b16 v[132:133], v183 offset:8192
    ds_read_b64_tr_b16 v[134:135], v183 offset:9216
    v_mfma_f32_16x16x32_bf16 v[76:79], v[116:119], v[144:147], v[76:79]
    s_mov_b64 exec, s[44:45]
    buffer_load_dwordx4 v189, s[16:19], s41 offen offset:2048 lds
    s_mov_b64 exec, -1
    s_add_u32 s41, s41, 21504
    v_mfma_f32_16x16x32_bf16 v[64:67], v[104:107], v[148:151], v[64:67]
    v_mfma_f32_16x16x32_bf16 v[68:71], v[108:111], v[148:151], v[68:71]
    v_mfma_f32_16x16x32_bf16 v[72:75], v[96:99], v[148:151], v[72:75]
    v_mfma_f32_16x16x32_bf16 v[76:79], v[100:103], v[148:151], v[76:79]
    s_waitcnt lgkmcnt(10)
    v_mfma_f32_16x16x32_bf16 v[80:83], v[96:99], v[152:155], v[80:83]
    ds_read_b128 v[168:171], v187 offset:17408
    ds_read_b128 v[172:175], v187 offset:28160
    v_mfma_f32_16x16x32_bf16 v[84:87], v[100:103], v[152:155], v[84:87]
    s_waitcnt lgkmcnt(2)
    v_mfma_f32_16x16x32_bf16 v[88:91], v[112:115], v[152:155], v[88:91]
    v_xor_b32 v136, 0x80008000, v128
    v_xor_b32 v137, 0x80008000, v129
    v_mfma_f32_16x16x32_bf16 v[92:95], v[116:119], v[152:155], v[92:95]
    v_xor_b32 v138, 0x80008000, v130
    v_xor_b32 v139, 0x80008000, v131
    v_mfma_f32_16x16x32_bf16 v[80:83], v[104:107], v[156:159], v[80:83]
    v_xor_b32 v140, 0x80008000, v132
    v_xor_b32 v141, 0x80008000, v133
    v_mfma_f32_16x16x32_bf16 v[84:87], v[108:111], v[156:159], v[84:87]
    v_xor_b32 v142, 0x80008000, v134
    v_xor_b32 v143, 0x80008000, v135
    v_mfma_f32_16x16x32_bf16 v[88:91], v[96:99], v[156:159], v[88:91]
    v_mfma_f32_16x16x32_bf16 v[92:95], v[100:103], v[156:159], v[92:95]
    s_waitcnt vmcnt(5)
    s_barrier
    v_mfma_f32_16x16x32_bf16 v[0:3], v[120:123], v[160:163], v[0:3]
    ds_read_b128 v[144:147], v187 offset:18432
    ds_read_b128 v[148:151], v187 offset:29184
    v_mfma_f32_16x16x32_bf16 v[4:7], v[124:127], v[160:163], v[4:7]
    v_mfma_f32_16x16x32_bf16 v[8:11], v[136:139], v[160:163], v[8:11]
    v_mfma_f32_16x16x32_bf16 v[12:15], v[140:143], v[160:163], v[12:15]
    s_add_u32 m0, s42, 75776
    s_nop 0
    buffer_load_dwordx4 v188, s[16:19], s40 offen lds
    v_mfma_f32_16x16x32_bf16 v[0:3], v[128:131], v[164:167], v[0:3]
    v_mfma_f32_16x16x32_bf16 v[4:7], v[132:135], v[164:167], v[4:7]
    v_mfma_f32_16x16x32_bf16 v[8:11], v[120:123], v[164:167], v[8:11]
    v_mfma_f32_16x16x32_bf16 v[12:15], v[124:127], v[164:167], v[12:15]
    s_waitcnt lgkmcnt(2)
    v_mfma_f32_16x16x32_bf16 v[16:19], v[120:123], v[168:171], v[16:19]
    ds_read_b128 v[152:155], v187 offset:19456
    ds_read_b128 v[156:159], v187 offset:30208
    v_mfma_f32_16x16x32_bf16 v[20:23], v[124:127], v[168:171], v[20:23]
    v_mfma_f32_16x16x32_bf16 v[24:27], v[136:139], v[168:171], v[24:27]
    v_mfma_f32_16x16x32_bf16 v[28:31], v[140:143], v[168:171], v[28:31]
    buffer_load_dwordx4 v188, s[16:19], s40 offen offset:1024 lds
    s_add_u32 s40, s40, 16384
    v_mfma_f32_16x16x32_bf16 v[16:19], v[128:131], v[172:175], v[16:19]
    v_mfma_f32_16x16x32_bf16 v[20:23], v[132:135], v[172:175], v[20:23]
    v_mfma_f32_16x16x32_bf16 v[24:27], v[120:123], v[172:175], v[24:27]
    v_mfma_f32_16x16x32_bf16 v[28:31], v[124:127], v[172:175], v[28:31]
    s_waitcnt lgkmcnt(2)
    v_mfma_f32_16x16x32_bf16 v[32:35], v[120:123], v[144:147], v[32:35]
    ds_read_b128 v[160:163], v187 offset:20480
    ds_read_b128 v[164:167], v187 offset:31232
    v_mfma_f32_16x16x32_bf16 v[36:39], v[124:127], v[144:147], v[36:39]
    v_mfma_f32_16x16x32_bf16 v[40:43], v[136:139], v[144:147], v[40:43]
    v_mfma_f32_16x16x32_bf16 v[44:47], v[140:143], v[144:147], v[44:47]
    s_add_u32 m0, s43, 75776
    s_nop 0
    buffer_load_dwordx4 v189, s[16:19], s41 offen lds
    v_mfma_f32_16x16x32_bf16 v[32:35], v[128:131], v[148:151], v[32:35]
    v_mfma_f32_16x16x32_bf16 v[36:39], v[132:135], v[148:151], v[36:39]
    v_mfma_f32_16x16x32_bf16 v[40:43], v[120:123], v[148:151], v[40:43]
    v_mfma_f32_16x16x32_bf16 v[44:47], v[124:127], v[148:151], v[44:47]
    s_waitcnt lgkmcnt(2)
    v_mfma_f32_16x16x32_bf16 v[48:51], v[120:123], v[152:155], v[48:51]
    ds_read_b128 v[168:171], v187 offset:21504
    ds_read_b128 v[172:175], v187 offset:32256
    v_mfma_f32_16x16x32_bf16 v[52:55], v[124:127], v[152:155], v[52:55]
    v_mfma_f32_16x16x32_bf16 v[56:59], v[136:139], v[152:155], v[56:59]
    ds_read_b64_tr_b16 v[96:97], v176 offset:0
    ds_read_b64_tr_b16 v[98:99], v176 offset:1024
    ds_read_b64_tr_b16 v[100:101], v177 offset:0
    ds_read_b64_tr_b16 v[102:103], v177 offset:1024
    v_mfma_f32_16x16x32_bf16 v[60:63], v[140:143], v[152:155], v[60:63]
    buffer_load_dwordx4 v189, s[16:19], s41 offen offset:1024 lds
    v_mfma_f32_16x16x32_bf16 v[48:51], v[128:131], v[156:159], v[48:51]
    v_mfma_f32_16x16x32_bf16 v[52:55], v[132:135], v[156:159], v[52:55]
    v_mfma_f32_16x16x32_bf16 v[56:59], v[120:123], v[156:159], v[56:59]
    v_mfma_f32_16x16x32_bf16 v[60:63], v[124:127], v[156:159], v[60:63]
    s_waitcnt lgkmcnt(6)
    v_mfma_f32_16x16x32_bf16 v[64:67], v[120:123], v[160:163], v[64:67]
    ds_read_b128 v[144:147], v184 offset:16384
    ds_read_b128 v[148:151], v184 offset:27136
    v_mfma_f32_16x16x32_bf16 v[68:71], v[124:127], v[160:163], v[68:71]
    v_mfma_f32_16x16x32_bf16 v[72:75], v[136:139], v[160:163], v[72:75]
    ds_read_b64_tr_b16 v[104:105], v176 offset:8192
    ds_read_b64_tr_b16 v[106:107], v176 offset:9216
    ds_read_b64_tr_b16 v[108:109], v177 offset:8192
    ds_read_b64_tr_b16 v[110:111], v177 offset:9216
    v_mfma_f32_16x16x32_bf16 v[76:79], v[140:143], v[160:163], v[76:79]
    s_mov_b64 exec, s[44:45]
    buffer_load_dwordx4 v189, s[16:19], s41 offen offset:2048 lds
    s_mov_b64 exec, -1
    s_add_u32 s41, s41, 21504
    v_mfma_f32_16x16x32_bf16 v[64:67], v[128:131], v[164:167], v[64:67]
    v_mfma_f32_16x16x32_bf16 v[68:71], v[132:135], v[164:167], v[68:71]
    v_mfma_f32_16x16x32_bf16 v[72:75], v[120:123], v[164:167], v[72:75]
    v_mfma_f32_16x16x32_bf16 v[76:79], v[124:127], v[164:167], v[76:79]
    s_waitcnt lgkmcnt(10)
    v_mfma_f32_16x16x32_bf16 v[80:83], v[120:123], v[168:171], v[80:83]
    ds_read_b128 v[152:155], v184 offset:17408
    ds_read_b128 v[156:159], v184 offset:28160
    v_mfma_f32_16x16x32_bf16 v[84:87], v[124:127], v[168:171], v[84:87]
    s_waitcnt lgkmcnt(2)
    v_mfma_f32_16x16x32_bf16 v[88:91], v[136:139], v[168:171], v[88:91]
    v_xor_b32 v112, 0x80008000, v104
    v_xor_b32 v113, 0x80008000, v105
    v_mfma_f32_16x16x32_bf16 v[92:95], v[140:143], v[168:171], v[92:95]
    v_xor_b32 v114, 0x80008000, v106
    v_xor_b32 v115, 0x80008000, v107
    v_mfma_f32_16x16x32_bf16 v[80:83], v[128:131], v[172:175], v[80:83]
    v_xor_b32 v116, 0x80008000, v108
    v_xor_b32 v117, 0x80008000, v109
    v_mfma_f32_16x16x32_bf16 v[84:87], v[132:135], v[172:175], v[84:87]
    v_xor_b32 v118, 0x80008000, v110
    v_xor_b32 v119, 0x80008000, v111
    v_mfma_f32_16x16x32_bf16 v[88:91], v[120:123], v[172:175], v[88:91]
    v_mfma_f32_16x16x32_bf16 v[92:95], v[124:127], v[172:175], v[92:95]
    s_sub_u32 s46, s46, 1
    s_cmp_lg_u32 s46, 0
    s_cbranch_scc1 L_k3_loop0
    s_waitcnt vmcnt(5)
    s_barrier
    v_mfma_f32_16x16x32_bf16 v[0:3], v[96:99], v[144:147], v[0:3]
    ds_read_b128 v[160:163], v184 offset:18432
    ds_read_b128 v[164:167], v184 offset:29184
    v_mfma_f32_16x16x32_bf16 v[4:7], v[100:103], v[144:147], v[4:7]
    v_mfma_f32_16x16x32_bf16 v[8:11], v[112:115], v[144:147], v[8:11]
    v_mfma_f32_16x16x32_bf16 v[12:15], v[116:119], v[144:147], v[12:15]
    s_add_u32 m0, s42, 113664
    s_nop 0
    buffer_load_dwordx4 v188, s[16:19], s40 offen lds
    v_mfma_f32_16x16x32_bf16 v[0:3], v[104:107], v[148:151], v[0:3]
    v_mfma_f32_16x16x32_bf16 v[4:7], v[108:111], v[148:151], v[4:7]
    v_mfma_f32_16x16x32_bf16 v[8:11], v[96:99], v[148:151], v[8:11]
    v_mfma_f32_16x16x32_bf16 v[12:15], v[100:103], v[148:151], v[12:15]
    s_waitcnt lgkmcnt(2)
    v_mfma_f32_16x16x32_bf16 v[16:19], v[96:99], v[152:155], v[16:19]
    ds_read_b128 v[168:171], v184 offset:19456
    ds_read_b128 v[172:175], v184 offset:30208
    v_mfma_f32_16x16x32_bf16 v[20:23], v[100:103], v[152:155], v[20:23]
    v_mfma_f32_16x16x32_bf16 v[24:27], v[112:115], v[152:155], v[24:27]
    v_mfma_f32_16x16x32_bf16 v[28:31], v[116:119], v[152:155], v[28:31]
    buffer_load_dwordx4 v188, s[16:19], s40 offen offset:1024 lds
    s_add_u32 s40, s40, 16384
    v_mfma_f32_16x16x32_bf16 v[16:19], v[104:107], v[156:159], v[16:19]
    v_mfma_f32_16x16x32_bf16 v[20:23], v[108:111], v[156:159], v[20:23]
    v_mfma_f32_16x16x32_bf16 v[24:27], v[96:99], v[156:159], v[24:27]
    v_mfma_f32_16x16x32_bf16 v[28:31], v[100:103], v[156:159], v[28:31]
    s_waitcnt lgkmcnt(2)
    v_mfma_f32_16x16x32_bf16 v[32:35], v[96:99], v[160:163], v[32:35]
    ds_read_b128 v[144:147], v184 offset:20480
    ds_read_b128 v[148:151], v184 offset:31232
    v_mfma_f32_16x16x32_bf16 v[36:39], v[100:103], v[160:163], v[36:39]
    v_mfma_f32_16x16x32_bf16 v[40:43], v[112:115], v[160:163], v[40:43]
    v_mfma_f32_16x16x32_bf16 v[44:47], v[116:119], v[160:163], v[44:47]
    s_add_u32 m0, s43, 113664
    s_nop 0
    buffer_load_dwordx4 v189, s[16:19], s41 offen lds
    v_mfma_f32_16x16x32_bf16 v[32:35], v[104:107], v[164:167], v[32:35]
    v_mfma_f32_16x16x32_bf16 v[36:39], v[108:111], v[164:167], v[36:39]
    v_mfma_f32_16x16x32_bf16 v[40:43], v[96:99], v[164:167], v[40:43]
    v_mfma_f32_16x16x32_bf16 v[44:47], v[100:103], v[164:167], v[44:47]
    s_waitcnt lgkmcnt(2)
    v_mfma_f32_16x16x32_bf16 v[48:51], v[96:99], v[168:171], v[48:51]
    ds_read_b128 v[152:155], v184 offset:21504
    ds_read_b128 v[156:159], v184 offset:32256
    v_mfma_f32_16x16x32_bf16 v[52:55], v[100:103], v[168:171], v[52:55]
    v_mfma_f32_16x16x32_bf16 v[56:59], v[112:115], v[168:171], v[56:59]
    ds_read_b64_tr_b16 v[120:121], v178 offset:0
    ds_read_b64_tr_b16 v[122:123], v178 offset:1024
    ds_read_b64_tr_b16 v[124:125], v179 offset:0
    ds_read_b64_tr_b16 v[126:127], v179 offset:1024
    v_mfma_f32_16x16x32_bf16 v[60:63], v[116:119], v[168:171], v[60:63]
    buffer_load_dwordx4 v189, s[16:19], s41 offen offset:1024 lds
    v_mfma_f32_16x16x32_bf16 v[48:51], v[104:107], v[172:175], v[48:51]
    v_mfma_f32_16x16x32_bf16 v[52:55], v[108:111], v[172:175], v[52:55]
    v_mfma_f32_16x16x32_bf16 v[56:59], v[96:99], v[172:175], v[56:59]
    v_mfma_f32_16x16x32_bf16 v[60:63], v[100:103], v[172:175], v[60:63]
    s_waitcnt lgkmcnt(6)
    v_mfma_f32_16x16x32_bf16 v[64:67], v[96:99], v[144:147], v[64:67]
    ds_read_b128 v[160:163], v185 offset:16384
    ds_read_b128 v[164:167], v185 offset:27136
    v_mfma_f32_16x16x32_bf16 v[68:71], v[100:103], v[144:147], v[68:71]
    v_mfma_f32_16x16x32_bf16 v[72:75], v[112:115], v[144:147], v[72:75]
    ds_read_b64_tr_b16 v[128:129], v178 offset:8192
    ds_read_b64_tr_b16 v[130:131], v178 offset:9216
    ds_read_b64_tr_b16 v[132:133], v179 offset:8192
    ds_read_b64_tr_b16 v[134:135], v179 offset:9216
    v_mfma_f32_16x16x32_bf16 v[76:79], v[116:119], v[144:147], v[76:79]
    s_mov_b64 exec, s[44:45]
    buffer_load_dwordx4 v189, s[16:19], s41 offen offset:2048 lds
    s_mov_b64 exec, -1
    s_add_u32 s41, s41, 21504
    v_mfma_f32_16x16x32_bf16 v[64:67], v[104:107], v[148:151], v[64:67]
    v_mfma_f32_16x16x32_bf16 v[68:71], v[108:111], v[148:151], v[68:71]
    v_mfma_f32_16x16x32_bf16 v[72:75], v[96:99], v[148:151], v[72:75]
    v_mfma_f32_16x16x32_bf16 v[76:79], v[100:103], v[148:151], v[76:79]
    s_waitcnt lgkmcnt(10)
    v_mfma_f32_16x16x32_bf16 v[80:83], v[96:99], v[152:155], v[80:83]
    ds_read_b128 v[168:171], v185 offset:17408
    ds_read_b128 v[172:175], v185 offset:28160
    v_mfma_f32_16x16x32_bf16 v[84:87], v[100:103], v[152:155], v[84:87]
    s_waitcnt lgkmcnt(2)
    v_mfma_f32_16x16x32_bf16 v[88:91], v[112:115], v[152:155], v[88:91]
    v_xor_b32 v136, 0x80008000, v128
    v_xor_b32 v137, 0x80008000, v129
    v_mfma_f32_16x16x32_bf16 v[92:95], v[116:119], v[152:155], v[92:95]
    v_xor_b32 v138, 0x80008000, v130
    v_xor_b32 v139, 0x80008000, v131
    v_mfma_f32_16x16x32_bf16 v[80:83], v[104:107], v[156:159], v[80:83]
    v_xor_b32 v140, 0x80008000, v132
    v_xor_b32 v141, 0x80008000, v133
    v_mfma_f32_16x16x32_bf16 v[84:87], v[108:111], v[156:159], v[84:87]
    v_xor_b32 v142, 0x80008000, v134
    v_xor_b32 v143, 0x80008000, v135
    v_mfma_f32_16x16x32_bf16 v[88:91], v[96:99], v[156:159], v[88:91]
    v_mfma_f32_16x16x32_bf16 v[92:95], v[100:103], v[156:159], v[92:95]
    s_waitcnt vmcnt(5)
    s_barrier
    v_mfma_f32_16x16x32_bf16 v[0:3], v[120:123], v[160:163], v[0:3]
    ds_read_b128 v[144:147], v185 offset:18432
    ds_read_b128 v[148:151], v185 offset:29184
    v_mfma_f32_16x16x32_bf16 v[4:7], v[124:127], v[160:163], v[4:7]
    v_mfma_f32_16x16x32_bf16 v[8:11], v[136:139], v[160:163], v[8:11]
    v_mfma_f32_16x16x32_bf16 v[12:15], v[140:143], v[160:163], v[12:15]
    v_mfma_f32_16x16x32_bf16 v[0:3], v[128:131], v[164:167], v[0:3]
    v_mfma_f32_16x16x32_bf16 v[4:7], v[132:135], v[164:167], v[4:7]
    v_mfma_f32_16x16x32_bf16 v[8:11], v[120:123], v[164:167], v[8:11]
    v_mfma_f32_16x16x32_bf16 v[12:15], v[124:127], v[164:167], v[12:15]
    s_waitcnt lgkmcnt(2)
    v_mfma_f32_16x16x32_bf16 v[16:19], v[120:123], v[168:171], v[16:19]
    ds_read_b128 v[152:155], v185 offset:19456
    ds_read_b128 v[156:159], v185 offset:30208
    v_mfma_f32_16x16x32_bf16 v[20:23], v[124:127], v[168:171], v[20:23]
    v_mfma_f32_16x16x32_bf16 v[24:27], v[136:139], v[168:171], v[24:27]
    v_mfma_f32_16x16x32_bf16 v[28:31], v[140:143], v[168:171], v[28:31]
    v_mfma_f32_16x16x32_bf16 v[16:19], v[128:131], v[172:175], v[16:19]
    v_mfma_f32_16x16x32_bf16 v[20:23], v[132:135], v[172:175], v[20:23]
    v_mfma_f32_16x16x32_bf16 v[24:27], v[120:123], v[172:175], v[24:27]
    v_mfma_f32_16x16x32_bf16 v[28:31], v[124:127], v[172:175], v[28:31]
    s_waitcnt lgkmcnt(2)
    v_mfma_f32_16x16x32_bf16 v[32:35], v[120:123], v[144:147], v[32:35]
    ds_read_b128 v[160:163], v185 offset:20480
    ds_read_b128 v[164:167], v185 offset:31232
    v_mfma_f32_16x16x32_bf16 v[36:39], v[124:127], v[144:147], v[36:39]
    v_mfma_f32_16x16x32_bf16 v[40:43], v[136:139], v[144:147], v[40:43]
    v_mfma_f32_16x16x32_bf16 v[44:47], v[140:143], v[144:147], v[44:47]
    v_mfma_f32_16x16x32_bf16 v[32:35], v[128:131], v[148:151], v[32:35]
    v_mfma_f32_16x16x32_bf16 v[36:39], v[132:135], v[148:151], v[36:39]
    v_mfma_f32_16x16x32_bf16 v[40:43], v[120:123], v[148:151], v[40:43]
    v_mfma_f32_16x16x32_bf16 v[44:47], v[124:127], v[148:151], v[44:47]
    s_waitcnt lgkmcnt(2)
    v_mfma_f32_16x16x32_bf16 v[48:51], v[120:123], v[152:155], v[48:51]
    ds_read_b128 v[168:171], v185 offset:21504
    ds_read_b128 v[172:175], v185 offset:32256
    v_mfma_f32_16x16x32_bf16 v[52:55], v[124:127], v[152:155], v[52:55]
    v_mfma_f32_16x16x32_bf16 v[56:59], v[136:139], v[152:155], v[56:59]
    ds_read_b64_tr_b16 v[96:97], v180 offset:0
    ds_read_b64_tr_b16 v[98:99], v180 offset:1024
    ds_read_b64_tr_b16 v[100:101], v181 offset:0
    ds_read_b64_tr_b16 v[102:103], v181 offset:1024
    v_mfma_f32_16x16x32_bf16 v[60:63], v[140:143], v[152:155], v[60:63]
    v_mfma_f32_16x16x32_bf16 v[48:51], v[128:131], v[156:159], v[48:51]
    v_mfma_f32_16x16x32_bf16 v[52:55], v[132:135], v[156:159], v[52:55]
    v_mfma_f32_16x16x32_bf16 v[56:59], v[120:123], v[156:159], v[56:59]
    v_mfma_f32_16x16x32_bf16 v[60:63], v[124:127], v[156:159], v[60:63]
    s_waitcnt lgkmcnt(6)
    v_mfma_f32_16x16x32_bf16 v[64:67], v[120:123], v[160:163], v[64:67]
    ds_read_b128 v[144:147], v186 offset:16384
    ds_read_b128 v[148:151], v186 offset:27136
    v_mfma_f32_16x16x32_bf16 v[68:71], v[124:127], v[160:163], v[68:71]
    v_mfma_f32_16x16x32_bf16 v[72:75], v[136:139], v[160:163], v[72:75]
    ds_read_b64_tr_b16 v[104:105], v180 offset:8192
    ds_read_b64_tr_b16 v[106:107], v180 offset:9216
    ds_read_b64_tr_b16 v[108:109], v181 offset:8192
    ds_read_b64_tr_b16 v[110:111], v181 offset:9216
    v_mfma_f32_16x16x32_bf16 v[76:79], v[140:143], v[160:163], v[76:79]
    v_mfma_f32_16x16x32_bf16 v[64:67], v[128:131], v[164:167], v[64:67]
    v_mfma_f32_16x16x32_bf16 v[68:71], v[132:135], v[164:167], v[68:71]
    v_mfma_f32_16x16x32_bf16 v[72:75], v[120:123], v[164:167], v[72:75]
    v_mfma_f32_16x16x32_bf16 v[76:79], v[124:127], v[164:167], v[76:79]
    s_waitcnt lgkmcnt(10)
    v_mfma_f32_16x16x32_bf16 v[80:83], v[120:123], v[168:171], v[80:83]
    ds_read_b128 v[152:155], v186 offset:17408
    ds_read_b128 v[156:159], v186 offset:28160
    v_mfma_f32_16x16x32_bf16 v[84:87], v[124:127], v[168:171], v[84:87]
    s_waitcnt lgkmcnt(2)
    v_mfma_f32_16x16x32_bf16 v[88:91], v[136:139], v[168:171], v[88:91]
    v_xor_b32 v112, 0x80008000, v104
    v_xor_b32 v113, 0x80008000, v105
    v_mfma_f32_16x16x32_bf16 v[92:95], v[140:143], v[168:171], v[92:95]
    v_xor_b32 v114, 0x80008000, v106
    v_xor_b32 v115, 0x80008000, v107
    v_mfma_f32_16x16x32_bf16 v[80:83], v[128:131], v[172:175], v[80:83]
    v_xor_b32 v116, 0x80008000, v108
    v_xor_b32 v117, 0x80008000, v109
    v_mfma_f32_16x16x32_bf16 v[84:87], v[132:135], v[172:175], v[84:87]
    v_xor_b32 v118, 0x80008000, v110
    v_xor_b32 v119, 0x80008000, v111
    v_mfma_f32_16x16x32_bf16 v[88:91], v[120:123], v[172:175], v[88:91]
    v_mfma_f32_16x16x32_bf16 v[92:95], v[124:127], v[172:175], v[92:95]
    s_waitcnt vmcnt(0)
    s_barrier
    v_mfma_f32_16x16x32_bf16 v[0:3], v[96:99], v[144:147], v[0:3]
    ds_read_b128 v[160:163], v186 offset:18432
    ds_read_b128 v[164:167], v186 offset:29184
    v_mfma_f32_16x16x32_bf16 v[4:7], v[100:103], v[144:147], v[4:7]
    v_mfma_f32_16x16x32_bf16 v[8:11], v[112:115], v[144:147], v[8:11]
    v_mfma_f32_16x16x32_bf16 v[12:15], v[116:119], v[144:147], v[12:15]
    v_mfma_f32_16x16x32_bf16 v[0:3], v[104:107], v[148:151], v[0:3]
    v_mfma_f32_16x16x32_bf16 v[4:7], v[108:111], v[148:151], v[4:7]
    v_mfma_f32_16x16x32_bf16 v[8:11], v[96:99], v[148:151], v[8:11]
    v_mfma_f32_16x16x32_bf16 v[12:15], v[100:103], v[148:151], v[12:15]
    s_waitcnt lgkmcnt(2)
    v_mfma_f32_16x16x32_bf16 v[16:19], v[96:99], v[152:155], v[16:19]
    ds_read_b128 v[168:171], v186 offset:19456
    ds_read_b128 v[172:175], v186 offset:30208
    v_mfma_f32_16x16x32_bf16 v[20:23], v[100:103], v[152:155], v[20:23]
    v_mfma_f32_16x16x32_bf16 v[24:27], v[112:115], v[152:155], v[24:27]
    v_mfma_f32_16x16x32_bf16 v[28:31], v[116:119], v[152:155], v[28:31]
    v_mfma_f32_16x16x32_bf16 v[16:19], v[104:107], v[156:159], v[16:19]
    v_mfma_f32_16x16x32_bf16 v[20:23], v[108:111], v[156:159], v[20:23]
    v_mfma_f32_16x16x32_bf16 v[24:27], v[96:99], v[156:159], v[24:27]
    v_mfma_f32_16x16x32_bf16 v[28:31], v[100:103], v[156:159], v[28:31]
    s_waitcnt lgkmcnt(2)
    v_mfma_f32_16x16x32_bf16 v[32:35], v[96:99], v[160:163], v[32:35]
    ds_read_b128 v[144:147], v186 offset:20480
    ds_read_b128 v[148:151], v186 offset:31232
    v_mfma_f32_16x16x32_bf16 v[36:39], v[100:103], v[160:163], v[36:39]
    v_mfma_f32_16x16x32_bf16 v[40:43], v[112:115], v[160:163], v[40:43]
    v_mfma_f32_16x16x32_bf16 v[44:47], v[116:119], v[160:163], v[44:47]
    v_mfma_f32_16x16x32_bf16 v[32:35], v[104:107], v[164:167], v[32:35]
    v_mfma_f32_16x16x32_bf16 v[36:39], v[108:111], v[164:167], v[36:39]
    v_mfma_f32_16x16x32_bf16 v[40:43], v[96:99], v[164:167], v[40:43]
    v_mfma_f32_16x16x32_bf16 v[44:47], v[100:103], v[164:167], v[44:47]
    s_waitcnt lgkmcnt(2)
    v_mfma_f32_16x16x32_bf16 v[48:51], v[96:99], v[168:171], v[48:51]
    ds_read_b128 v[152:155], v186 offset:21504
    ds_read_b128 v[156:159], v186 offset:32256
    v_mfma_f32_16x16x32_bf16 v[52:55], v[100:103], v[168:171], v[52:55]
    v_mfma_f32_16x16x32_bf16 v[56:59], v[112:115], v[168:171], v[56:59]
    ds_read_b64_tr_b16 v[120:121], v182 offset:0
    ds_read_b64_tr_b16 v[122:123], v182 offset:1024
    ds_read_b64_tr_b16 v[124:125], v183 offset:0
    ds_read_b64_tr_b16 v[126:127], v183 offset:1024
    v_mfma_f32_16x16x32_bf16 v[60:63], v[116:119], v[168:171], v[60:63]
    v_mfma_f32_16x16x32_bf16 v[48:51], v[104:107], v[172:175], v[48:51]
    v_mfma_f32_16x16x32_bf16 v[52:55], v[108:111], v[172:175], v[52:55]
    v_mfma_f32_16x16x32_bf16 v[56:59], v[96:99], v[172:175], v[56:59]
    v_mfma_f32_16x16x32_bf16 v[60:63], v[100:103], v[172:175], v[60:63]
    s_waitcnt lgkmcnt(6)
    v_mfma_f32_16x16x32_bf16 v[64:67], v[96:99], v[144:147], v[64:67]
    ds_read_b128 v[160:163], v187 offset:16384
    ds_read_b128 v[164:167], v187 offset:27136
    v_mfma_f32_16x16x32_bf16 v[68:71], v[100:103], v[144:147], v[68:71]
    v_mfma_f32_16x16x32_bf16 v[72:75], v[112:115], v[144:147], v[72:75]
    ds_read_b64_tr_b16 v[128:129], v182 offset:8192
    ds_read_b64_tr_b16 v[130:131], v182 offset:9216
    ds_read_b64_tr_b16 v[132:133], v183 offset:8192
    ds_read_b64_tr_b16 v[134:135], v183 offset:9216
    v_mfma_f32_16x16x32_bf16 v[76:79], v[116:119], v[144:147], v[76:79]
    v_mfma_f32_16x16x32_bf16 v[64:67], v[104:107], v[148:151], v[64:67]
    v_mfma_f32_16x16x32_bf16 v[68:71], v[108:111], v[148:151], v[68:71]
    v_mfma_f32_16x16x32_bf16 v[72:75], v[96:99], v[148:151], v[72:75]
    v_mfma_f32_16x16x32_bf16 v[76:79], v[100:103], v[148:151], v[76:79]
    s_waitcnt lgkmcnt(10)
    v_mfma_f32_16x16x32_bf16 v[80:83], v[96:99], v[152:155], v[80:83]
    ds_read_b128 v[168:171], v187 offset:17408
    ds_read_b128 v[172:175], v187 offset:28160
    v_mfma_f32_16x16x32_bf16 v[84:87], v[100:103], v[152:155], v[84:87]
    s_waitcnt lgkmcnt(2)
    v_mfma_f32_16x16x32_bf16 v[88:91], v[112:115], v[152:155], v[88:91]
    v_xor_b32 v136, 0x80008000, v128
    v_xor_b32 v137, 0x80008000, v129
    v_mfma_f32_16x16x32_bf16 v[92:95], v[116:119], v[152:155], v[92:95]
    v_xor_b32 v138, 0x80008000, v130
    v_xor_b32 v139, 0x80008000, v131
    v_mfma_f32_16x16x32_bf16 v[80:83], v[104:107], v[156:159], v[80:83]
    v_xor_b32 v140, 0x80008000, v132
    v_xor_b32 v141, 0x80008000, v133
    v_mfma_f32_16x16x32_bf16 v[84:87], v[108:111], v[156:159], v[84:87]
    v_xor_b32 v142, 0x80008000, v134
    v_xor_b32 v143, 0x80008000, v135
    v_mfma_f32_16x16x32_bf16 v[88:91], v[96:99], v[156:159], v[88:91]
    v_mfma_f32_16x16x32_bf16 v[92:95], v[100:103], v[156:159], v[92:95]
    v_mfma_f32_16x16x32_bf16 v[0:3], v[120:123], v[160:163], v[0:3]
    ds_read_b128 v[144:147], v187 offset:18432
    ds_read_b128 v[148:151], v187 offset:29184
    v_mfma_f32_16x16x32_bf16 v[4:7], v[124:127], v[160:163], v[4:7]
    v_mfma_f32_16x16x32_bf16 v[8:11], v[136:139], v[160:163], v[8:11]
    v_mfma_f32_16x16x32_bf16 v[12:15], v[140:143], v[160:163], v[12:15]
    v_mfma_f32_16x16x32_bf16 v[0:3], v[128:131], v[164:167], v[0:3]
    v_mfma_f32_16x16x32_bf16 v[4:7], v[132:135], v[164:167], v[4:7]
    v_mfma_f32_16x16x32_bf16 v[8:11], v[120:123], v[164:167], v[8:11]
    v_mfma_f32_16x16x32_bf16 v[12:15], v[124:127], v[164:167], v[12:15]
    s_waitcnt lgkmcnt(2)
    v_mfma_f32_16x16x32_bf16 v[16:19], v[120:123], v[168:171], v[16:19]
    ds_read_b128 v[152:155], v187 offset:19456
    ds_read_b128 v[156:159], v187 offset:30208
    v_mfma_f32_16x16x32_bf16 v[20:23], v[124:127], v[168:171], v[20:23]
    v_mfma_f32_16x16x32_bf16 v[24:27], v[136:139], v[168:171], v[24:27]
    v_mfma_f32_16x16x32_bf16 v[28:31], v[140:143], v[168:171], v[28:31]
    v_mfma_f32_16x16x32_bf16 v[16:19], v[128:131], v[172:175], v[16:19]
    v_mfma_f32_16x16x32_bf16 v[20:23], v[132:135], v[172:175], v[20:23]
    v_mfma_f32_16x16x32_bf16 v[24:27], v[120:123], v[172:175], v[24:27]
    v_mfma_f32_16x16x32_bf16 v[28:31], v[124:127], v[172:175], v[28:31]
    s_waitcnt lgkmcnt(2)
    v_mfma_f32_16x16x32_bf16 v[32:35], v[120:123], v[144:147], v[32:35]
    ds_read_b128 v[160:163], v187 offset:20480
    ds_read_b128 v[164:167], v187 offset:31232
    v_mfma_f32_16x16x32_bf16 v[36:39], v[124:127], v[144:147], v[36:39]
    v_mfma_f32_16x16x32_bf16 v[40:43], v[136:139], v[144:147], v[40:43]
    v_mfma_f32_16x16x32_bf16 v[44:47], v[140:143], v[144:147], v[44:47]
    v_mfma_f32_16x16x32_bf16 v[32:35], v[128:131], v[148:151], v[32:35]
    v_mfma_f32_16x16x32_bf16 v[36:39], v[132:135], v[148:151], v[36:39]
    v_mfma_f32_16x16x32_bf16 v[40:43], v[120:123], v[148:151], v[40:43]
    v_mfma_f32_16x16x32_bf16 v[44:47], v[124:127], v[148:151], v[44:47]
    s_waitcnt lgkmcnt(2)
    v_mfma_f32_16x16x32_bf16 v[48:51], v[120:123], v[152:155], v[48:51]
    ds_read_b128 v[168:171], v187 offset:21504
    ds_read_b128 v[172:175], v187 offset:32256
    v_mfma_f32_16x16x32_bf16 v[52:55], v[124:127], v[152:155], v[52:55]
    v_mfma_f32_16x16x32_bf16 v[56:59], v[136:139], v[152:155], v[56:59]
    v_mfma_f32_16x16x32_bf16 v[60:63], v[140:143], v[152:155], v[60:63]
    v_mfma_f32_16x16x32_bf16 v[48:51], v[128:131], v[156:159], v[48:51]
    v_mfma_f32_16x16x32_bf16 v[52:55], v[132:135], v[156:159], v[52:55]
    v_mfma_f32_16x16x32_bf16 v[56:59], v[120:123], v[156:159], v[56:59]
    v_mfma_f32_16x16x32_bf16 v[60:63], v[124:127], v[156:159], v[60:63]
    s_waitcnt lgkmcnt(2)
    v_mfma_f32_16x16x32_bf16 v[64:67], v[120:123], v[160:163], v[64:67]
    v_mfma_f32_16x16x32_bf16 v[68:71], v[124:127], v[160:163], v[68:71]
    v_mfma_f32_16x16x32_bf16 v[72:75], v[136:139], v[160:163], v[72:75]
    v_mfma_f32_16x16x32_bf16 v[76:79], v[140:143], v[160:163], v[76:79]
    v_mfma_f32_16x16x32_bf16 v[64:67], v[128:131], v[164:167], v[64:67]
    v_mfma_f32_16x16x32_bf16 v[68:71], v[132:135], v[164:167], v[68:71]
    v_mfma_f32_16x16x32_bf16 v[72:75], v[120:123], v[164:167], v[72:75]
    v_mfma_f32_16x16x32_bf16 v[76:79], v[124:127], v[164:167], v[76:79]
    s_waitcnt lgkmcnt(0)
    v_mfma_f32_16x16x32_bf16 v[80:83], v[120:123], v[168:171], v[80:83]
    v_mfma_f32_16x16x32_bf16 v[84:87], v[124:127], v[168:171], v[84:87]
    v_mfma_f32_16x16x32_bf16 v[88:91], v[136:139], v[168:171], v[88:91]
    v_mfma_f32_16x16x32_bf16 v[92:95], v[140:143], v[168:171], v[92:95]
    v_mfma_f32_16x16x32_bf16 v[80:83], v[128:131], v[172:175], v[80:83]
    v_mfma_f32_16x16x32_bf16 v[84:87], v[132:135], v[172:175], v[84:87]
    v_mfma_f32_16x16x32_bf16 v[88:91], v[120:123], v[172:175], v[88:91]
    v_mfma_f32_16x16x32_bf16 v[92:95], v[124:127], v[172:175], v[92:95]
    s_nop 7
    v_cvt_pk_bf16_f32 v0, v0, v1
    v_cvt_pk_bf16_f32 v1, v2, v3
    v_cvt_pk_bf16_f32 v2, v4, v5
    v_cvt_pk_bf16_f32 v3, v6, v7
    s_add_u32 s47, s48, 0
    buffer_store_dwordx4 v[0:3], v190, s[16:19], s47 offen
    v_cvt_pk_bf16_f32 v8, v8, v9
    v_cvt_pk_bf16_f32 v9, v10, v11
    v_cvt_pk_bf16_f32 v10, v12, v13
    v_cvt_pk_bf16_f32 v11, v14, v15
    s_add_u32 s47, s48, 360448
    buffer_store_dwordx4 v[8:11], v190, s[16:19], s47 offen
    v_cvt_pk_bf16_f32 v16, v16, v17
    v_cvt_pk_bf16_f32 v17, v18, v19
    v_cvt_pk_bf16_f32 v18, v20, v21
    v_cvt_pk_bf16_f32 v19, v22, v23
    s_add_u32 s47, s48, 16384
    buffer_store_dwordx4 v[16:19], v190, s[16:19], s47 offen
    v_cvt_pk_bf16_f32 v24, v24, v25
    v_cvt_pk_bf16_f32 v25, v26, v27
    v_cvt_pk_bf16_f32 v26, v28, v29
    v_cvt_pk_bf16_f32 v27, v30, v31
    s_add_u32 s47, s48, 376832
    buffer_store_dwordx4 v[24:27], v190, s[16:19], s47 offen
    v_cvt_pk_bf16_f32 v32, v32, v33
    v_cvt_pk_bf16_f32 v33, v34, v35
    v_cvt_pk_bf16_f32 v34, v36, v37
    v_cvt_pk_bf16_f32 v35, v38, v39
    s_add_u32 s47, s48, 32768
    buffer_store_dwordx4 v[32:35], v190, s[16:19], s47 offen
    v_cvt_pk_bf16_f32 v40, v40, v41
    v_cvt_pk_bf16_f32 v41, v42, v43
    v_cvt_pk_bf16_f32 v42, v44, v45
    v_cvt_pk_bf16_f32 v43, v46, v47
    s_add_u32 s47, s48, 393216
    buffer_store_dwordx4 v[40:43], v190, s[16:19], s47 offen
    v_cvt_pk_bf16_f32 v48, v48, v49
    v_cvt_pk_bf16_f32 v49, v50, v51
    v_cvt_pk_bf16_f32 v50, v52, v53
    v_cvt_pk_bf16_f32 v51, v54, v55
    s_add_u32 s47, s48, 49152
    buffer_store_dwordx4 v[48:51], v190, s[16:19], s47 offen
    v_cvt_pk_bf16_f32 v56, v56, v57
    v_cvt_pk_bf16_f32 v57, v58, v59
    v_cvt_pk_bf16_f32 v58, v60, v61
    v_cvt_pk_bf16_f32 v59, v62, v63
    s_add_u32 s47, s48, 409600
    buffer_store_dwordx4 v[56:59], v190, s[16:19], s47 offen
    v_cvt_pk_bf16_f32 v64, v64, v65
    v_cvt_pk_bf16_f32 v65, v66, v67
    v_cvt_pk_bf16_f32 v66, v68, v69
    v_cvt_pk_bf16_f32 v67, v70, v71
    s_add_u32 s47, s48, 65536
    buffer_store_dwordx4 v[64:67], v190, s[16:19], s47 offen
    v_cvt_pk_bf16_f32 v72, v72, v73
    v_cvt_pk_bf16_f32 v73, v74, v75
    v_cvt_pk_bf16_f32 v74, v76, v77
    v_cvt_pk_bf16_f32 v75, v78, v79
    s_add_u32 s47, s48, 425984
    buffer_store_dwordx4 v[72:75], v190, s[16:19], s47 offen
    v_cvt_pk_bf16_f32 v80, v80, v81
    v_cvt_pk_bf16_f32 v81, v82, v83
    v_cvt_pk_bf16_f32 v82, v84, v85
    v_cvt_pk_bf16_f32 v83, v86, v87
    s_add_u32 s47, s48, 81920
    buffer_store_dwordx4 v[80:83], v190, s[16:19], s47 offen
    v_cvt_pk_bf16_f32 v88, v88, v89
    v_cvt_pk_bf16_f32 v89, v90, v91
    v_cvt_pk_bf16_f32 v90, v92, v93
    v_cvt_pk_bf16_f32 v91, v94, v95
    s_add_u32 s47, s48, 442368
    buffer_store_dwordx4 v[88:91], v190, s[16:19], s47 offen
    s_endpgm
L_k3_mh1:
    s_add_u32 m0, s42, 0
    s_nop 0
    buffer_load_dwordx4 v188, s[16:19], s40 offen lds
    buffer_load_dwordx4 v188, s[16:19], s40 offen offset:1024 lds
    s_add_u32 s40, s40, 16384
    s_add_u32 m0, s43, 0
    s_nop 0
    buffer_load_dwordx4 v189, s[16:19], s41 offen lds
    buffer_load_dwordx4 v189, s[16:19], s41 offen offset:1024 lds
    s_mov_b64 exec, s[44:45]
    buffer_load_dwordx4 v189, s[16:19], s41 offen offset:2048 lds
    s_mov_b64 exec, -1
    s_add_u32 s41, s41, 21504
    s_add_u32 m0, s42, 37888
    s_nop 0
    buffer_load_dwordx4 v188, s[16:19], s40 offen lds
    buffer_load_dwordx4 v188, s[16:19], s40 offen offset:1024 lds
    s_add_u32 s40, s40, 16384
    s_add_u32 m0, s43, 37888
    s_nop 0
    buffer_load_dwordx4 v189, s[16:19], s41 offen lds
    buffer_load_dwordx4 v189, s[16:19], s41 offen offset:1024 lds
    s_mov_b64 exec, s[44:45]
    buffer_load_dwordx4 v189, s[16:19], s41 offen offset:2048 lds
    s_mov_b64 exec, -1
    s_add_u32 s41, s41, 21504
    s_add_u32 m0, s42, 75776
    s_nop 0
    buffer_load_dwordx4 v188, s[16:19], s40 offen lds
    buffer_load_dwordx4 v188, s[16:19], s40 offen offset:1024 lds
    s_add_u32 s40, s40, 16384
    s_add_u32 m0, s43, 75776
    s_nop 0
    buffer_load_dwordx4 v189, s[16:19], s41 offen lds
    buffer_load_dwordx4 v189, s[16:19], s41 offen offset:1024 lds
    s_mov_b64 exec, s[44:45]
    buffer_load_dwordx4 v189, s[16:19], s41 offen offset:2048 lds
    s_mov_b64 exec, -1
    s_add_u32 s41, s41, 21504
    v_mov_b32 v0, 0
    v_mov_b32 v1, 0
    v_mov_b32 v2, 0
    v_mov_b32 v3, 0
    v_mov_b32 v4, 0
    v_mov_b32 v5, 0
    v_mov_b32 v6, 0
    v_mov_b32 v7, 0
    v_mov_b32 v8, 0
    v_mov_b32 v9, 0
    v_mov_b32 v10, 0
    v_mov_b32 v11, 0
    v_mov_b32 v12, 0
    v_mov_b32 v13, 0
    v_mov_b32 v14, 0
    v_mov_b32 v15, 0
    v_mov_b32 v16, 0
    v_mov_b32 v17, 0
    v_mov_b32 v18, 0
    v_mov_b32 v19, 0
    v_mov_b32 v20, 0
    v_mov_b32 v21, 0
    v_mov_b32 v22, 0
    v_mov_b32 v23, 0
    v_mov_b32 v24, 0
    v_mov_b32 v25, 0
    v_mov_b32 v26, 0
    v_mov_b32 v27, 0
    v_mov_b32 v28, 0
    v_mov_b32 v29, 0
    v_mov_b32 v30, 0
    v_mov_b32 v31, 0
    v_mov_b32 v32, 0
    v_mov_b32 v33, 0
    v_mov_b32 v34, 0
    v_mov_b32 v35, 0
    v_mov_b32 v36, 0
    v_mov_b32 v37, 0
    v_mov_b32 v38, 0
    v_mov_b32 v39, 0
    v_mov_b32 v40, 0
    v_mov_b32 v41, 0
    v_mov_b32 v42, 0
    v_mov_b32 v43, 0
    v_mov_b32 v44, 0
    v_mov_b32 v45, 0
    v_mov_b32 v46, 0
    v_mov_b32 v47, 0
    v_mov_b32 v48, 0
    v_mov_b32 v49, 0
    v_mov_b32 v50, 0
    v_mov_b32 v51, 0
    v_mov_b32 v52, 0
    v_mov_b32 v53, 0
    v_mov_b32 v54, 0
    v_mov_b32 v55, 0
    v_mov_b32 v56, 0
    v_mov_b32 v57, 0
    v_mov_b32 v58, 0
    v_mov_b32 v59, 0
    v_mov_b32 v60, 0
    v_mov_b32 v61, 0
    v_mov_b32 v62, 0
    v_mov_b32 v63, 0
    v_mov_b32 v64, 0
    v_mov_b32 v65, 0
    v_mov_b32 v66, 0
    v_mov_b32 v67, 0
    v_mov_b32 v68, 0
    v_mov_b32 v69, 0
    v_mov_b32 v70, 0
    v_mov_b32 v71, 0
    v_mov_b32 v72, 0
    v_mov_b32 v73, 0
    v_mov_b32 v74, 0
    v_mov_b32 v75, 0
    v_mov_b32 v76, 0
    v_mov_b32 v77, 0
    v_mov_b32 v78, 0
    v_mov_b32 v79, 0
    s_waitcnt vmcnt(10)
    s_barrier
    ds_read_b64_tr_b16 v[96:97], v176 offset:0
    ds_read_b64_tr_b16 v[98:99], v176 offset:1024
    ds_read_b64_tr_b16 v[100:101], v177 offset:0
    ds_read_b64_tr_b16 v[102:103], v177 offset:1024
    ds_read_b64_tr_b16 v[104:105], v176 offset:8192
    ds_read_b64_tr_b16 v[106:107], v176 offset:9216
    ds_read_b64_tr_b16 v[108:109], v177 offset:8192
    ds_read_b64_tr_b16 v[110:111], v177 offset:9216
    ds_read_b128 v[144:147], v184 offset:22528
    ds_read_b128 v[148:151], v184 offset:33280
    ds_read_b128 v[152:155], v184 offset:23552
    ds_read_b128 v[156:159], v184 offset:34304
    s_waitcnt lgkmcnt(4)
    v_xor_b32 v112, 0x80008000, v104
    v_xor_b32 v113, 0x80008000, v105
    v_xor_b32 v114, 0x80008000, v106
    v_xor_b32 v115, 0x80008000, v107
    v_xor_b32 v116, 0x80008000, v108
    v_xor_b32 v117, 0x80008000, v109
    v_xor_b32 v118, 0x80008000, v110
    v_xor_b32 v119, 0x80008000, v111
    s_mov_b32 s46, 7
L_k3_loop1:
    s_waitcnt vmcnt(5)
    s_barrier
    s_waitcnt lgkmcnt(2)
    v_mfma_f32_16x16x32_bf16 v[0:3], v[96:99], v[144:147], v[0:3]
    ds_read_b128 v[160:163], v184 offset:24576
    ds_read_b128 v[164:167], v184 offset:35328
    v_mfma_f32_16x16x32_bf16 v[4:7], v[100:103], v[144:147], v[4:7]
    v_mfma_f32_16x16x32_bf16 v[8:11], v[112:115], v[144:147], v[8:11]
    v_mfma_f32_16x16x32_bf16 v[12:15], v[116:119], v[144:147], v[12:15]
    s_add_u32 m0, s42, 113664
    s_nop 0
    buffer_load_dwordx4 v188, s[16:19], s40 offen lds
    v_mfma_f32_16x16x32_bf16 v[0:3], v[104:107], v[148:151], v[0:3]
    v_mfma_f32_16x16x32_bf16 v[4:7], v[108:111], v[148:151], v[4:7]
    v_mfma_f32_16x16x32_bf16 v[8:11], v[96:99], v[148:151], v[8:11]
    v_mfma_f32_16x16x32_bf16 v[12:15], v[100:103], v[148:151], v[12:15]
    s_waitcnt lgkmcnt(2)
    v_mfma_f32_16x16x32_bf16 v[16:19], v[96:99], v[152:155], v[16:19]
    ds_read_b128 v[168:171], v184 offset:25600
    ds_read_b128 v[172:175], v184 offset:36352
    v_mfma_f32_16x16x32_bf16 v[20:23], v[100:103], v[152:155], v[20:23]
    v_mfma_f32_16x16x32_bf16 v[24:27], v[112:115], v[152:155], v[24:27]
    v_mfma_f32_16x16x32_bf16 v[28:31], v[116:119], v[152:155], v[28:31]
    buffer_load_dwordx4 v188, s[16:19], s40 offen offset:1024 lds
    s_add_u32 s40, s40, 16384
    v_mfma_f32_16x16x32_bf16 v[16:19], v[104:107], v[156:159], v[16:19]
    v_mfma_f32_16x16x32_bf16 v[20:23], v[108:111], v[156:159], v[20:23]
    v_mfma_f32_16x16x32_bf16 v[24:27], v[96:99], v[156:159], v[24:27]
    v_mfma_f32_16x16x32_bf16 v[28:31], v[100:103], v[156:159], v[28:31]
    s_waitcnt lgkmcnt(2)
    v_mfma_f32_16x16x32_bf16 v[32:35], v[96:99], v[160:163], v[32:35]
    ds_read_b128 v[144:147], v184 offset:26624
    ds_read_b128 v[148:151], v184 offset:37376
    v_mfma_f32_16x16x32_bf16 v[36:39], v[100:103], v[160:163], v[36:39]
    v_mfma_f32_16x16x32_bf16 v[40:43], v[112:115], v[160:163], v[40:43]
    ds_read_b64_tr_b16 v[120:121], v178 offset:0
    ds_read_b64_tr_b16 v[122:123], v178 offset:1024
    ds_read_b64_tr_b16 v[124:125], v179 offset:0
    ds_read_b64_tr_b16 v[126:127], v179 offset:1024
    v_mfma_f32_16x16x32_bf16 v[44:47], v[116:119], v[160:163], v[44:47]
    s_add_u32 m0, s43, 113664
    s_nop 0
    buffer_load_dwordx4 v189, s[16:19], s41 offen lds
    v_mfma_f32_16x16x32_bf16 v[32:35], v[104:107], v[164:167], v[32:35]
    v_mfma_f32_16x16x32_bf16 v[36:39], v[108:111], v[164:167], v[36:39]
    v_mfma_f32_16x16x32_bf16 v[40:43], v[96:99], v[164:167], v[40:43]
    v_mfma_f32_16x16x32_bf16 v[44:47], v[100:103], v[164:167], v[44:47]
    s_waitcnt lgkmcnt(6)
    v_mfma_f32_16x16x32_bf16 v[48:51], v[96:99], v[168:171], v[48:51]
    ds_read_b128 v[152:155], v185 offset:22528
    ds_read_b128 v[156:159], v185 offset:33280
    v_mfma_f32_16x16x32_bf16 v[52:55], v[100:103], v[168:171], v[52:55]
    v_mfma_f32_16x16x32_bf16 v[56:59], v[112:115], v[168:171], v[56:59]
    ds_read_b64_tr_b16 v[128:129], v178 offset:8192
    ds_read_b64_tr_b16 v[130:131], v178 offset:9216
    ds_read_b64_tr_b16 v[132:133], v179 offset:8192
    ds_read_b64_tr_b16 v[134:135], v179 offset:9216
    v_mfma_f32_16x16x32_bf16 v[60:63], v[116:119], v[168:171], v[60:63]
    buffer_load_dwordx4 v189, s[16:19], s41 offen offset:1024 lds
    v_mfma_f32_16x16x32_bf16 v[48:51], v[104:107], v[172:175], v[48:51]
    v_mfma_f32_16x16x32_bf16 v[52:55], v[108:111], v[172:175], v[52:55]
    v_mfma_f32_16x16x32_bf16 v[56:59], v[96:99], v[172:175], v[56:59]
    v_mfma_f32_16x16x32_bf16 v[60:63], v[100:103], v[172:175], v[60:63]
    s_waitcnt lgkmcnt(10)
    v_mfma_f32_16x16x32_bf16 v[64:67], v[96:99], v[144:147], v[64:67]
    ds_read_b128 v[160:163], v185 offset:23552
    ds_read_b128 v[164:167], v185 offset:34304
    v_mfma_f32_16x16x32_bf16 v[68:71], v[100:103], v[144:147], v[68:71]
    s_waitcnt lgkmcnt(2)
    v_mfma_f32_16x16x32_bf16 v[72:75], v[112:115], v[144:147], v[72:75]
    v_xor_b32 v136, 0x80008000, v128
    v_xor_b32 v137, 0x80008000, v129
    v_mfma_f32_16x16x32_bf16 v[76:79], v[116:119], v[144:147], v[76:79]
    s_mov_b64 exec, s[44:45]
    buffer_load_dwordx4 v189, s[16:19], s41 offen offset:2048 lds
    s_mov_b64 exec, -1
    s_add_u32 s41, s41, 21504
    v_xor_b32 v138, 0x80008000, v130
    v_xor_b32 v139, 0x80008000, v131
    v_mfma_f32_16x16x32_bf16 v[64:67], v[104:107], v[148:151], v[64:67]
    v_xor_b32 v140, 0x80008000, v132
    v_xor_b32 v141, 0x80008000, v133
    v_mfma_f32_16x16x32_bf16 v[68:71], v[108:111], v[148:151], v[68:71]
    v_xor_b32 v142, 0x80008000, v134
    v_xor_b32 v143, 0x80008000, v135
    v_mfma_f32_16x16x32_bf16 v[72:75], v[96:99], v[148:151], v[72:75]
    v_mfma_f32_16x16x32_bf16 v[76:79], v[100:103], v[148:151], v[76:79]
    s_waitcnt vmcnt(5)
    s_barrier
    v_mfma_f32_16x16x32_bf16 v[0:3], v[120:123], v[152:155], v[0:3]
    ds_read_b128 v[168:171], v185 offset:24576
    ds_read_b128 v[172:175], v185 offset:35328
    v_mfma_f32_16x16x32_bf16 v[4:7], v[124:127], v[152:155], v[4:7]
    v_mfma_f32_16x16x32_bf16 v[8:11], v[136:139], v[152:155], v[8:11]
    v_mfma_f32_16x16x32_bf16 v[12:15], v[140:143], v[152:155], v[12:15]
    s_add_u32 m0, s42, 0
    s_nop 0
    buffer_load_dwordx4 v188, s[16:19], s40 offen lds
    v_mfma_f32_16x16x32_bf16 v[0:3], v[128:131], v[156:159], v[0:3]
    v_mfma_f32_16x16x32_bf16 v[4:7], v[132:135], v[156:159], v[4:7]
    v_mfma_f32_16x16x32_bf16 v[8:11], v[120:123], v[156:159], v[8:11]
    v_mfma_f32_16x16x32_bf16 v[12:15], v[124:127], v[156:159], v[12:15]
    s_waitcnt lgkmcnt(2)
    v_mfma_f32_16x16x32_bf16 v[16:19], v[120:123], v[160:163], v[16:19]
    ds_read_b128 v[144:147], v185 offset:25600
    ds_read_b128 v[148:151], v185 offset:36352
    v_mfma_f32_16x16x32_bf16 v[20:23], v[124:127], v[160:163], v[20:23]
    v_mfma_f32_16x16x32_bf16 v[24:27], v[136:139], v[160:163], v[24:27]
    v_mfma_f32_16x16x32_bf16 v[28:31], v[140:143], v[160:163], v[28:31]
    buffer_load_dwordx4 v188, s[16:19], s40 offen offset:1024 lds
    s_add_u32 s40, s40, 16384
    v_mfma_f32_16x16x32_bf16 v[16:19], v[128:131], v[164:167], v[16:19]
    v_mfma_f32_16x16x32_bf16 v[20:23], v[132:135], v[164:167], v[20:23]
    v_mfma_f32_16x16x32_bf16 v[24:27], v[120:123], v[164:167], v[24:27]
    v_mfma_f32_16x16x32_bf16 v[28:31], v[124:127], v[164:167], v[28:31]
    s_waitcnt lgkmcnt(2)
    v_mfma_f32_16x16x32_bf16 v[32:35], v[120:123], v[168:171], v[32:35]
    ds_read_b128 v[152:155], v185 offset:26624
    ds_read_b128 v[156:159], v185 offset:37376
    v_mfma_f32_16x16x32_bf16 v[36:39], v[124:127], v[168:171], v[36:39]
    v_mfma_f32_16x16x32_bf16 v[40:43], v[136:139], v[168:171], v[40:43]
    ds_read_b64_tr_b16 v[96:97], v180 offset:0
    ds_read_b64_tr_b16 v[98:99], v180 offset:1024
    ds_read_b64_tr_b16 v[100:101], v181 offset:0
    ds_read_b64_tr_b16 v[102:103], v181 offset:1024
    v_mfma_f32_16x16x32_bf16 v[44:47], v[140:143], v[168:171], v[44:47]
    s_add_u32 m0, s43, 0
    s_nop 0
    buffer_load_dwordx4 v189, s[16:19], s41 offen lds
    v_mfma_f32_16x16x32_bf16 v[32:35], v[128:131], v[172:175], v[32:35]
    v_mfma_f32_16x16x32_bf16 v[36:39], v[132:135], v[172:175], v[36:39]
    v_mfma_f32_16x16x32_bf16 v[40:43], v[120:123], v[172:175], v[40:43]
    v_mfma_f32_16x16x32_bf16 v[44:47], v[124:127], v[172:175], v[44:47]
    s_waitcnt lgkmcnt(6)
    v_mfma_f32_16x16x32_bf16 v[48:51], v[120:123], v[144:147], v[48:51]
    ds_read_b128 v[160:163], v186 offset:22528
    ds_read_b128 v[164:167], v186 offset:33280
    v_mfma_f32_16x16x32_bf16 v[52:55], v[124:127], v[144:147], v[52:55]
    v_mfma_f32_16x16x32_bf16 v[56:59], v[136:139], v[144:147], v[56:59]
    ds_read_b64_tr_b16 v[104:105], v180 offset:8192
    ds_read_b64_tr_b16 v[106:107], v180 offset:9216
    ds_read_b64_tr_b16 v[108:109], v181 offset:8192
    ds_read_b64_tr_b16 v[110:111], v181 offset:9216
    v_mfma_f32_16x16x32_bf16 v[60:63], v[140:143], v[144:147], v[60:63]
    buffer_load_dwordx4 v189, s[16:19], s41 offen offset:1024 lds
    v_mfma_f32_16x16x32_bf16 v[48:51], v[128:131], v[148:151], v[48:51]
    v_mfma_f32_16x16x32_bf16 v[52:55], v[132:135], v[148:151], v[52:55]
    v_mfma_f32_16x16x32_bf16 v[56:59], v[120:123], v[148:151], v[56:59]
    v_mfma_f32_16x16x32_bf16 v[60:63], v[124:127], v[148:151], v[60:63]
    s_waitcnt lgkmcnt(10)
    v_mfma_f32_16x16x32_bf16 v[64:67], v[120:123], v[152:155], v[64:67]
    ds_read_b128 v[168:171], v186 offset:23552
    ds_read_b128 v[172:175], v186 offset:34304
    v_mfma_f32_16x16x32_bf16 v[68:71], v[124:127], v[152:155], v[68:71]
    s_waitcnt lgkmcnt(2)
    v_mfma_f32_16x16x32_bf16 v[72:75], v[136:139], v[152:155], v[72:75]
    v_xor_b32 v112, 0x80008000, v104
    v_xor_b32 v113, 0x80008000, v105
    v_mfma_f32_16x16x32_bf16 v[76:79], v[140:143], v[152:155], v[76:79]
    s_mov_b64 exec, s[44:45]
    buffer_load_dwordx4 v189, s[16:19], s41 offen offset:2048 lds
    s_mov_b64 exec, -1
    s_add_u32 s41, s41, 21504
    v_xor_b32 v114, 0x80008000, v106
    v_xor_b32 v115, 0x80008000, v107
    v_mfma_f32_16x16x32_bf16 v[64:67], v[128:131], v[156:159], v[64:67]
    v_xor_b32 v116, 0x80008000, v108
    v_xor_b32 v117, 0x80008000, v109
    v_mfma_f32_16x16x32_bf16 v[68:71], v[132:135], v[156:159], v[68:71]
    v_xor_b32 v118, 0x80008000, v110
    v_xor_b32 v119, 0x80008000, v111
    v_mfma_f32_16x16x32_bf16 v[72:75], v[120:123], v[156:159], v[72:75]
    v_mfma_f32_16x16x32_bf16 v[76:79], v[124:127], v[156:159], v[76:79]
    s_waitcnt vmcnt(5)
    s_barrier
    v_mfma_f32_16x16x32_bf16 v[0:3], v[96:99], v[160:163], v[0:3]
    ds_read_b128 v[144:147], v186 offset:24576
    ds_read_b128 v[148:151], v186 offset:35328
    v_mfma_f32_16x16x32_bf16 v[4:7], v[100:103], v[160:163], v[4:7]
    v_mfma_f32_16x16x32_bf16 v[8:11], v[112:115], v[160:163], v[8:11]
    v_mfma_f32_16x16x32_bf16 v[12:15], v[116:119], v[160:163], v[12:15]
    s_add_u32 m0, s42, 37888
    s_nop 0
    buffer_load_dwordx4 v188, s[16:19], s40 offen lds
    v_mfma_f32_16x16x32_bf16 v[0:3], v[104:107], v[164:167], v[0:3]
    v_mfma_f32_16x16x32_bf16 v[4:7], v[108:111], v[164:167], v[4:7]
    v_mfma_f32_16x16x32_bf16 v[8:11], v[96:99], v[164:167], v[8:11]
    v_mfma_f32_16x16x32_bf16 v[12:15], v[100:103], v[164:167], v[12:15]
    s_waitcnt lgkmcnt(2)
    v_mfma_f32_16x16x32_bf16 v[16:19], v[96:99], v[168:171], v[16:19]
    ds_read_b128 v[152:155], v186 offset:25600
    ds_read_b128 v[156:159], v186 offset:36352
    v_mfma_f32_16x16x32_bf16 v[20:23], v[100:103], v[168:171], v[20:23]
    v_mfma_f32_16x16x32_bf16 v[24:27], v[112:115], v[168:171], v[24:27]
    v_mfma_f32_16x16x32_bf16 v[28:31], v[116:119], v[168:171], v[28:31]
    buffer_load_dwordx4 v188, s[16:19], s40 offen offset:1024 lds
    s_add_u32 s40, s40, 16384
    v_mfma_f32_16x16x32_bf16 v[16:19], v[104:107], v[172:175], v[16:19]
    v_mfma_f32_16x16x32_bf16 v[20:23], v[108:111], v[172:175], v[20:23]
    v_mfma_f32_16x16x32_bf16 v[24:27], v[96:99], v[172:175], v[24:27]
    v_mfma_f32_16x16x32_bf16 v[28:31], v[100:103], v[172:175], v[28:31]
    s_waitcnt lgkmcnt(2)
    v_mfma_f32_16x16x32_bf16 v[32:35], v[96:99], v[144:147], v[32:35]
    ds_read_b128 v[160:163], v186 offset:26624
    ds_read_b128 v[164:167], v186 offset:37376
    v_mfma_f32_16x16x32_bf16 v[36:39], v[100:103], v[144:147], v[36:39]
    v_mfma_f32_16x16x32_bf16 v[40:43], v[112:115], v[144:147], v[40:43]
    ds_read_b64_tr_b16 v[120:121], v182 offset:0
    ds_read_b64_tr_b16 v[122:123], v182 offset:1024
    ds_read_b64_tr_b16 v[124:125], v183 offset:0
    ds_read_b64_tr_b16 v[126:127], v183 offset:1024
    v_mfma_f32_16x16x32_bf16 v[44:47], v[116:119], v[144:147], v[44:47]
    s_add_u32 m0, s43, 37888
    s_nop 0
    buffer_load_dwordx4 v189, s[16:19], s41 offen lds
    v_mfma_f32_16x16x32_bf16 v[32:35], v[104:107], v[148:151], v[32:35]
    v_mfma_f32_16x16x32_bf16 v[36:39], v[108:111], v[148:151], v[36:39]
    v_mfma_f32_16x16x32_bf16 v[40:43], v[96:99], v[148:151], v[40:43]
    v_mfma_f32_16x16x32_bf16 v[44:47], v[100:103], v[148:151], v[44:47]
    s_waitcnt lgkmcnt(6)
    v_mfma_f32_16x16x32_bf16 v[48:51], v[96:99], v[152:155], v[48:51]
    ds_read_b128 v[168:171], v187 offset:22528
    ds_read_b128 v[172:175], v187 offset:33280
    v_mfma_f32_16x16x32_bf16 v[52:55], v[100:103], v[152:155], v[52:55]
    v_mfma_f32_16x16x32_bf16 v[56:59], v[112:115], v[152:155], v[56:59]
    ds_read_b64_tr_b16 v[128:129], v182 offset:8192
    ds_read_b64_tr_b16 v[130:131], v182 offset:9216
    ds_read_b64_tr_b16 v[132:133], v183 offset:8192
    ds_read_b64_tr_b16 v[134:135], v183 offset:9216
    v_mfma_f32_16x16x32_bf16 v[60:63], v[116:119], v[152:155], v[60:63]
    buffer_load_dwordx4 v189, s[16:19], s41 offen offset:1024 lds
    v_mfma_f32_16x16x32_bf16 v[48:51], v[104:107], v[156:159], v[48:51]
    v_mfma_f32_16x16x32_bf16 v[52:55], v[108:111], v[156:159], v[52:55]
    v_mfma_f32_16x16x32_bf16 v[56:59], v[96:99], v[156:159], v[56:59]
    v_mfma_f32_16x16x32_bf16 v[60:63], v[100:103], v[156:159], v[60:63]
    s_waitcnt lgkmcnt(10)
    v_mfma_f32_16x16x32_bf16 v[64:67], v[96:99], v[160:163], v[64:67]
    ds_read_b128 v[144:147], v187 offset:23552
    ds_read_b128 v[148:151], v187 offset:34304
    v_mfma_f32_16x16x32_bf16 v[68:71], v[100:103], v[160:163], v[68:71]
    s_waitcnt lgkmcnt(2)
    v_mfma_f32_16x16x32_bf16 v[72:75], v[112:115], v[160:163], v[72:75]
    v_xor_b32 v136, 0x80008000, v128
    v_xor_b32 v137, 0x80008000, v129
    v_mfma_f32_16x16x32_bf16 v[76:79], v[116:119], v[160:163], v[76:79]
    s_mov_b64 exec, s[44:45]
    buffer_load_dwordx4 v189, s[16:19], s41 offen offset:2048 lds
    s_mov_b64 exec, -1
    s_add_u32 s41, s41, 21504
    v_xor_b32 v138, 0x80008000, v130
    v_xor_b32 v139, 0x80008000, v131
    v_mfma_f32_16x16x32_bf16 v[64:67], v[104:107], v[164:167], v[64:67]
    v_xor_b32 v140, 0x80008000, v132
    v_xor_b32 v141, 0x80008000, v133
    v_mfma_f32_16x16x32_bf16 v[68:71], v[108:111], v[164:167], v[68:71]
    v_xor_b32 v142, 0x80008000, v134
    v_xor_b32 v143, 0x80008000, v135
    v_mfma_f32_16x16x32_bf16 v[72:75], v[96:99], v[164:167], v[72:75]
    v_mfma_f32_16x16x32_bf16 v[76:79], v[100:103], v[164:167], v[76:79]
    s_waitcnt vmcnt(5)
    s_barrier
    v_mfma_f32_16x16x32_bf16 v[0:3], v[120:123], v[168:171], v[0:3]
    ds_read_b128 v[152:155], v187 offset:24576
    ds_read_b128 v[156:159], v187 offset:35328
    v_mfma_f32_16x16x32_bf16 v[4:7], v[124:127], v[168:171], v[4:7]
    v_mfma_f32_16x16x32_bf16 v[8:11], v[136:139], v[168:171], v[8:11]
    v_mfma_f32_16x16x32_bf16 v[12:15], v[140:143], v[168:171], v[12:15]
    s_add_u32 m0, s42, 75776
    s_nop 0
    buffer_load_dwordx4 v188, s[16:19], s40 offen lds
    v_mfma_f32_16x16x32_bf16 v[0:3], v[128:131], v[172:175], v[0:3]
    v_mfma_f32_16x16x32_bf16 v[4:7], v[132:135], v[172:175], v[4:7]
    v_mfma_f32_16x16x32_bf16 v[8:11], v[120:123], v[172:175], v[8:11]
    v_mfma_f32_16x16x32_bf16 v[12:15], v[124:127], v[172:175], v[12:15]
    s_waitcnt lgkmcnt(2)
    v_mfma_f32_16x16x32_bf16 v[16:19], v[120:123], v[144:147], v[16:19]
    ds_read_b128 v[160:163], v187 offset:25600
    ds_read_b128 v[164:167], v187 offset:36352
    v_mfma_f32_16x16x32_bf16 v[20:23], v[124:127], v[144:147], v[20:23]
    v_mfma_f32_16x16x32_bf16 v[24:27], v[136:139], v[144:147], v[24:27]
    v_mfma_f32_16x16x32_bf16 v[28:31], v[140:143], v[144:147], v[28:31]
    buffer_load_dwordx4 v188, s[16:19], s40 offen offset:1024 lds
    s_add_u32 s40, s40, 16384
    v_mfma_f32_16x16x32_bf16 v[16:19], v[128:131], v[148:151], v[16:19]
    v_mfma_f32_16x16x32_bf16 v[20:23], v[132:135], v[148:151], v[20:23]
    v_mfma_f32_16x16x32_bf16 v[24:27], v[120:123], v[148:151], v[24:27]
    v_mfma_f32_16x16x32_bf16 v[28:31], v[124:127], v[148:151], v[28:31]
    s_waitcnt lgkmcnt(2)
    v_mfma_f32_16x16x32_bf16 v[32:35], v[120:123], v[152:155], v[32:35]
    ds_read_b128 v[168:171], v187 offset:26624
    ds_read_b128 v[172:175], v187 offset:37376
    v_mfma_f32_16x16x32_bf16 v[36:39], v[124:127], v[152:155], v[36:39]
    v_mfma_f32_16x16x32_bf16 v[40:43], v[136:139], v[152:155], v[40:43]
    ds_read_b64_tr_b16 v[96:97], v176 offset:0
    ds_read_b64_tr_b16 v[98:99], v176 offset:1024
    ds_read_b64_tr_b16 v[100:101], v177 offset:0
    ds_read_b64_tr_b16 v[102:103], v177 offset:1024
    v_mfma_f32_16x16x32_bf16 v[44:47], v[140:143], v[152:155], v[44:47]
    s_add_u32 m0, s43, 75776
    s_nop 0
    buffer_load_dwordx4 v189, s[16:19], s41 offen lds
    v_mfma_f32_16x16x32_bf16 v[32:35], v[128:131], v[156:159], v[32:35]
    v_mfma_f32_16x16x32_bf16 v[36:39], v[132:135], v[156:159], v[36:39]
    v_mfma_f32_16x16x32_bf16 v[40:43], v[120:123], v[156:159], v[40:43]
    v_mfma_f32_16x16x32_bf16 v[44:47], v[124:127], v[156:159], v[44:47]
    s_waitcnt lgkmcnt(6)
    v_mfma_f32_16x16x32_bf16 v[48:51], v[120:123], v[160:163], v[48:51]
    ds_read_b128 v[144:147], v184 offset:22528
    ds_read_b128 v[148:151], v184 offset:33280
    v_mfma_f32_16x16x32_bf16 v[52:55], v[124:127], v[160:163], v[52:55]
    v_mfma_f32_16x16x32_bf16 v[56:59], v[136:139], v[160:163], v[56:59]
    ds_read_b64_tr_b16 v[104:105], v176 offset:8192
    ds_read_b64_tr_b16 v[106:107], v176 offset:9216
    ds_read_b64_tr_b16 v[108:109], v177 offset:8192
    ds_read_b64_tr_b16 v[110:111], v177 offset:9216
    v_mfma_f32_16x16x32_bf16 v[60:63], v[140:143], v[160:163], v[60:63]
    buffer_load_dwordx4 v189, s[16:19], s41 offen offset:1024 lds
    v_mfma_f32_16x16x32_bf16 v[48:51], v[128:131], v[164:167], v[48:51]
    v_mfma_f32_16x16x32_bf16 v[52:55], v[132:135], v[164:167], v[52:55]
    v_mfma_f32_16x16x32_bf16 v[56:59], v[120:123], v[164:167], v[56:59]
    v_mfma_f32_16x16x32_bf16 v[60:63], v[124:127], v[164:167], v[60:63]
    s_waitcnt lgkmcnt(10)
    v_mfma_f32_16x16x32_bf16 v[64:67], v[120:123], v[168:171], v[64:67]
    ds_read_b128 v[152:155], v184 offset:23552
    ds_read_b128 v[156:159], v184 offset:34304
    v_mfma_f32_16x16x32_bf16 v[68:71], v[124:127], v[168:171], v[68:71]
    s_waitcnt lgkmcnt(2)
    v_mfma_f32_16x16x32_bf16 v[72:75], v[136:139], v[168:171], v[72:75]
    v_xor_b32 v112, 0x80008000, v104
    v_xor_b32 v113, 0x80008000, v105
    v_mfma_f32_16x16x32_bf16 v[76:79], v[140:143], v[168:171], v[76:79]
    s_mov_b64 exec, s[44:45]
    buffer_load_dwordx4 v189, s[16:19], s41 offen offset:2048 lds
    s_mov_b64 exec, -1
    s_add_u32 s41, s41, 21504
    v_xor_b32 v114, 0x80008000, v106
    v_xor_b32 v115, 0x80008000, v107
    v_mfma_f32_16x16x32_bf16 v[64:67], v[128:131], v[172:175], v[64:67]
    v_xor_b32 v116, 0x80008000, v108
    v_xor_b32 v117, 0x80008000, v109
    v_mfma_f32_16x16x32_bf16 v[68:71], v[132:135], v[172:175], v[68:71]
    v_xor_b32 v118, 0x80008000, v110
    v_xor_b32 v119, 0x80008000, v111
    v_mfma_f32_16x16x32_bf16 v[72:75], v[120:123], v[172:175], v[72:75]
    v_mfma_f32_16x16x32_bf16 v[76:79], v[124:127], v[172:175], v[76:79]
    s_sub_u32 s46, s46, 1
    s_cmp_lg_u32 s46, 0
    s_cbranch_scc1 L_k3_loop1
    s_waitcnt vmcnt(5)
    s_barrier
    v_mfma_f32_16x16x32_bf16 v[0:3], v[96:99], v[144:147], v[0:3]
    ds_read_b128 v[160:163], v184 offset:24576
    ds_read_b128 v[164:167], v184 offset:35328
    v_mfma_f32_16x16x32_bf16 v[4:7], v[100:103], v[144:147], v[4:7]
    v_mfma_f32_16x16x32_bf16 v[8:11], v[112:115], v[144:147], v[8:11]
    v_mfma_f32_16x16x32_bf16 v[12:15], v[116:119], v[144:147], v[12:15]
    s_add_u32 m0, s42, 113664
    s_nop 0
    buffer_load_dwordx4 v188, s[16:19], s40 offen lds
    v_mfma_f32_16x16x32_bf16 v[0:3], v[104:107], v[148:151], v[0:3]
    v_mfma_f32_16x16x32_bf16 v[4:7], v[108:111], v[148:151], v[4:7]
    v_mfma_f32_16x16x32_bf16 v[8:11], v[96:99], v[148:151], v[8:11]
    v_mfma_f32_16x16x32_bf16 v[12:15], v[100:103], v[148:151], v[12:15]
    s_waitcnt lgkmcnt(2)
    v_mfma_f32_16x16x32_bf16 v[16:19], v[96:99], v[152:155], v[16:19]
    ds_read_b128 v[168:171], v184 offset:25600
    ds_read_b128 v[172:175], v184 offset:36352
    v_mfma_f32_16x16x32_bf16 v[20:23], v[100:103], v[152:155], v[20:23]
    v_mfma_f32_16x16x32_bf16 v[24:27], v[112:115], v[152:155], v[24:27]
    v_mfma_f32_16x16x32_bf16 v[28:31], v[116:119], v[152:155], v[28:31]
    buffer_load_dwordx4 v188, s[16:19], s40 offen offset:1024 lds
    s_add_u32 s40, s40, 16384
    v_mfma_f32_16x16x32_bf16 v[16:19], v[104:107], v[156:159], v[16:19]
    v_mfma_f32_16x16x32_bf16 v[20:23], v[108:111], v[156:159], v[20:23]
    v_mfma_f32_16x16x32_bf16 v[24:27], v[96:99], v[156:159], v[24:27]
    v_mfma_f32_16x16x32_bf16 v[28:31], v[100:103], v[156:159], v[28:31]
    s_waitcnt lgkmcnt(2)
    v_mfma_f32_16x16x32_bf16 v[32:35], v[96:99], v[160:163], v[32:35]
    ds_read_b128 v[144:147], v184 offset:26624
    ds_read_b128 v[148:151], v184 offset:37376
    v_mfma_f32_16x16x32_bf16 v[36:39], v[100:103], v[160:163], v[36:39]
    v_mfma_f32_16x16x32_bf16 v[40:43], v[112:115], v[160:163], v[40:43]
    ds_read_b64_tr_b16 v[120:121], v178 offset:0
    ds_read_b64_tr_b16 v[122:123], v178 offset:1024
    ds_read_b64_tr_b16 v[124:125], v179 offset:0
    ds_read_b64_tr_b16 v[126:127], v179 offset:1024
    v_mfma_f32_16x16x32_bf16 v[44:47], v[116:119], v[160:163], v[44:47]
    s_add_u32 m0, s43, 113664
    s_nop 0
    buffer_load_dwordx4 v189, s[16:19], s41 offen lds
    v_mfma_f32_16x16x32_bf16 v[32:35], v[104:107], v[164:167], v[32:35]
    v_mfma_f32_16x16x32_bf16 v[36:39], v[108:111], v[164:167], v[36:39]
    v_mfma_f32_16x16x32_bf16 v[40:43], v[96:99], v[164:167], v[40:43]
    v_mfma_f32_16x16x32_bf16 v[44:47], v[100:103], v[164:167], v[44:47]
    s_waitcnt lgkmcnt(6)
    v_mfma_f32_16x16x32_bf16 v[48:51], v[96:99], v[168:171], v[48:51]
    ds_read_b128 v[152:155], v185 offset:22528
    ds_read_b128 v[156:159], v185 offset:33280
    v_mfma_f32_16x16x32_bf16 v[52:55], v[100:103], v[168:171], v[52:55]
    v_mfma_f32_16x16x32_bf16 v[56:59], v[112:115], v[168:171], v[56:59]
    ds_read_b64_tr_b16 v[128:129], v178 offset:8192
    ds_read_b64_tr_b16 v[130:131], v178 offset:9216
    ds_read_b64_tr_b16 v[132:133], v179 offset:8192
    ds_read_b64_tr_b16 v[134:135], v179 offset:9216
    v_mfma_f32_16x16x32_bf16 v[60:63], v[116:119], v[168:171], v[60:63]
    buffer_load_dwordx4 v189, s[16:19], s41 offen offset:1024 lds
    v_mfma_f32_16x16x32_bf16 v[48:51], v[104:107], v[172:175], v[48:51]
    v_mfma_f32_16x16x32_bf16 v[52:55], v[108:111], v[172:175], v[52:55]
    v_mfma_f32_16x16x32_bf16 v[56:59], v[96:99], v[172:175], v[56:59]
    v_mfma_f32_16x16x32_bf16 v[60:63], v[100:103], v[172:175], v[60:63]
    s_waitcnt lgkmcnt(10)
    v_mfma_f32_16x16x32_bf16 v[64:67], v[96:99], v[144:147], v[64:67]
    ds_read_b128 v[160:163], v185 offset:23552
    ds_read_b128 v[164:167], v185 offset:34304
    v_mfma_f32_16x16x32_bf16 v[68:71], v[100:103], v[144:147], v[68:71]
    s_waitcnt lgkmcnt(2)
    v_mfma_f32_16x16x32_bf16 v[72:75], v[112:115], v[144:147], v[72:75]
    v_xor_b32 v136, 0x80008000, v128
    v_xor_b32 v137, 0x80008000, v129
    v_mfma_f32_16x16x32_bf16 v[76:79], v[116:119], v[144:147], v[76:79]
    s_mov_b64 exec, s[44:45]
    buffer_load_dwordx4 v189, s[16:19], s41 offen offset:2048 lds
    s_mov_b64 exec, -1
    s_add_u32 s41, s41, 21504
    v_xor_b32 v138, 0x80008000, v130
    v_xor_b32 v139, 0x80008000, v131
    v_mfma_f32_16x16x32_bf16 v[64:67], v[104:107], v[148:151], v[64:67]
    v_xor_b32 v140, 0x80008000, v132
    v_xor_b32 v141, 0x80008000, v133
    v_mfma_f32_16x16x32_bf16 v[68:71], v[108:111], v[148:151], v[68:71]
    v_xor_b32 v142, 0x80008000, v134
    v_xor_b32 v143, 0x80008000, v135
    v_mfma_f32_16x16x32_bf16 v[72:75], v[96:99], v[148:151], v[72:75]
    v_mfma_f32_16x16x32_bf16 v[76:79], v[100:103], v[148:151], v[76:79]
    s_waitcnt vmcnt(5)
    s_barrier
    v_mfma_f32_16x16x32_bf16 v[0:3], v[120:123], v[152:155], v[0:3]
    ds_read_b128 v[168:171], v185 offset:24576
    ds_read_b128 v[172:175], v185 offset:35328
    v_mfma_f32_16x16x32_bf16 v[4:7], v[124:127], v[152:155], v[4:7]
    v_mfma_f32_16x16x32_bf16 v[8:11], v[136:139], v[152:155], v[8:11]
    v_mfma_f32_16x16x32_bf16 v[12:15], v[140:143], v[152:155], v[12:15]
    v_mfma_f32_16x16x32_bf16 v[0:3], v[128:131], v[156:159], v[0:3]
    v_mfma_f32_16x16x32_bf16 v[4:7], v[132:135], v[156:159], v[4:7]
    v_mfma_f32_16x16x32_bf16 v[8:11], v[120:123], v[156:159], v[8:11]
    v_mfma_f32_16x16x32_bf16 v[12:15], v[124:127], v[156:159], v[12:15]
    s_waitcnt lgkmcnt(2)
    v_mfma_f32_16x16x32_bf16 v[16:19], v[120:123], v[160:163], v[16:19]
    ds_read_b128 v[144:147], v185 offset:25600
    ds_read_b128 v[148:151], v185 offset:36352
    v_mfma_f32_16x16x32_bf16 v[20:23], v[124:127], v[160:163], v[20:23]
    v_mfma_f32_16x16x32_bf16 v[24:27], v[136:139], v[160:163], v[24:27]
    v_mfma_f32_16x16x32_bf16 v[28:31], v[140:143], v[160:163], v[28:31]
    v_mfma_f32_16x16x32_bf16 v[16:19], v[128:131], v[164:167], v[16:19]
    v_mfma_f32_16x16x32_bf16 v[20:23], v[132:135], v[164:167], v[20:23]
    v_mfma_f32_16x16x32_bf16 v[24:27], v[120:123], v[164:167], v[24:27]
    v_mfma_f32_16x16x32_bf16 v[28:31], v[124:127], v[164:167], v[28:31]
    s_waitcnt lgkmcnt(2)
    v_mfma_f32_16x16x32_bf16 v[32:35], v[120:123], v[168:171], v[32:35]
    ds_read_b128 v[152:155], v185 offset:26624
    ds_read_b128 v[156:159], v185 offset:37376
    v_mfma_f32_16x16x32_bf16 v[36:39], v[124:127], v[168:171], v[36:39]
    v_mfma_f32_16x16x32_bf16 v[40:43], v[136:139], v[168:171], v[40:43]
    ds_read_b64_tr_b16 v[96:97], v180 offset:0
    ds_read_b64_tr_b16 v[98:99], v180 offset:1024
    ds_read_b64_tr_b16 v[100:101], v181 offset:0
    ds_read_b64_tr_b16 v[102:103], v181 offset:1024
    v_mfma_f32_16x16x32_bf16 v[44:47], v[140:143], v[168:171], v[44:47]
    v_mfma_f32_16x16x32_bf16 v[32:35], v[128:131], v[172:175], v[32:35]
    v_mfma_f32_16x16x32_bf16 v[36:39], v[132:135], v[172:175], v[36:39]
    v_mfma_f32_16x16x32_bf16 v[40:43], v[120:123], v[172:175], v[40:43]
    v_mfma_f32_16x16x32_bf16 v[44:47], v[124:127], v[172:175], v[44:47]
    s_waitcnt lgkmcnt(6)
    v_mfma_f32_16x16x32_bf16 v[48:51], v[120:123], v[144:147], v[48:51]
    ds_read_b128 v[160:163], v186 offset:22528
    ds_read_b128 v[164:167], v186 offset:33280
    v_mfma_f32_16x16x32_bf16 v[52:55], v[124:127], v[144:147], v[52:55]
    v_mfma_f32_16x16x32_bf16 v[56:59], v[136:139], v[144:147], v[56:59]
    ds_read_b64_tr_b16 v[104:105], v180 offset:8192
    ds_read_b64_tr_b16 v[106:107], v180 offset:9216
    ds_read_b64_tr_b16 v[108:109], v181 offset:8192
    ds_read_b64_tr_b16 v[110:111], v181 offset:9216
    v_mfma_f32_16x16x32_bf16 v[60:63], v[140:143], v[144:147], v[60:63]
    v_mfma_f32_16x16x32_bf16 v[48:51], v[128:131], v[148:151], v[48:51]
    v_mfma_f32_16x16x32_bf16 v[52:55], v[132:135], v[148:151], v[52:55]
    v_mfma_f32_16x16x32_bf16 v[56:59], v[120:123], v[148:151], v[56:59]
    v_mfma_f32_16x16x32_bf16 v[60:63], v[124:127], v[148:151], v[60:63]
    s_waitcnt lgkmcnt(10)
    v_mfma_f32_16x16x32_bf16 v[64:67], v[120:123], v[152:155], v[64:67]
    ds_read_b128 v[168:171], v186 offset:23552
    ds_read_b128 v[172:175], v186 offset:34304
    v_mfma_f32_16x16x32_bf16 v[68:71], v[124:127], v[152:155], v[68:71]
    s_waitcnt lgkmcnt(2)
    v_mfma_f32_16x16x32_bf16 v[72:75], v[136:139], v[152:155], v[72:75]
    v_xor_b32 v112, 0x80008000, v104
    v_xor_b32 v113, 0x80008000, v105
    v_mfma_f32_16x16x32_bf16 v[76:79], v[140:143], v[152:155], v[76:79]
    v_xor_b32 v114, 0x80008000, v106
    v_xor_b32 v115, 0x80008000, v107
    v_mfma_f32_16x16x32_bf16 v[64:67], v[128:131], v[156:159], v[64:67]
    v_xor_b32 v116, 0x80008000, v108
    v_xor_b32 v117, 0x80008000, v109
    v_mfma_f32_16x16x32_bf16 v[68:71], v[132:135], v[156:159], v[68:71]
    v_xor_b32 v118, 0x80008000, v110
    v_xor_b32 v119, 0x80008000, v111
    v_mfma_f32_16x16x32_bf16 v[72:75], v[120:123], v[156:159], v[72:75]
    v_mfma_f32_16x16x32_bf16 v[76:79], v[124:127], v[156:159], v[76:79]
    s_waitcnt vmcnt(0)
    s_barrier
    v_mfma_f32_16x16x32_bf16 v[0:3], v[96:99], v[160:163], v[0:3]
    ds_read_b128 v[144:147], v186 offset:24576
    ds_read_b128 v[148:151], v186 offset:35328
    v_mfma_f32_16x16x32_bf16 v[4:7], v[100:103], v[160:163], v[4:7]
    v_mfma_f32_16x16x32_bf16 v[8:11], v[112:115], v[160:163], v[8:11]
    v_mfma_f32_16x16x32_bf16 v[12:15], v[116:119], v[160:163], v[12:15]
    v_mfma_f32_16x16x32_bf16 v[0:3], v[104:107], v[164:167], v[0:3]
    v_mfma_f32_16x16x32_bf16 v[4:7], v[108:111], v[164:167], v[4:7]
    v_mfma_f32_16x16x32_bf16 v[8:11], v[96:99], v[164:167], v[8:11]
    v_mfma_f32_16x16x32_bf16 v[12:15], v[100:103], v[164:167], v[12:15]
    s_waitcnt lgkmcnt(2)
    v_mfma_f32_16x16x32_bf16 v[16:19], v[96:99], v[168:171], v[16:19]
    ds_read_b128 v[152:155], v186 offset:25600
    ds_read_b128 v[156:159], v186 offset:36352
    v_mfma_f32_16x16x32_bf16 v[20:23], v[100:103], v[168:171], v[20:23]
    v_mfma_f32_16x16x32_bf16 v[24:27], v[112:115], v[168:171], v[24:27]
    v_mfma_f32_16x16x32_bf16 v[28:31], v[116:119], v[168:171], v[28:31]
    v_mfma_f32_16x16x32_bf16 v[16:19], v[104:107], v[172:175], v[16:19]
    v_mfma_f32_16x16x32_bf16 v[20:23], v[108:111], v[172:175], v[20:23]
    v_mfma_f32_16x16x32_bf16 v[24:27], v[96:99], v[172:175], v[24:27]
    v_mfma_f32_16x16x32_bf16 v[28:31], v[100:103], v[172:175], v[28:31]
    s_waitcnt lgkmcnt(2)
    v_mfma_f32_16x16x32_bf16 v[32:35], v[96:99], v[144:147], v[32:35]
    ds_read_b128 v[160:163], v186 offset:26624
    ds_read_b128 v[164:167], v186 offset:37376
    v_mfma_f32_16x16x32_bf16 v[36:39], v[100:103], v[144:147], v[36:39]
    v_mfma_f32_16x16x32_bf16 v[40:43], v[112:115], v[144:147], v[40:43]
    ds_read_b64_tr_b16 v[120:121], v182 offset:0
    ds_read_b64_tr_b16 v[122:123], v182 offset:1024
    ds_read_b64_tr_b16 v[124:125], v183 offset:0
    ds_read_b64_tr_b16 v[126:127], v183 offset:1024
    v_mfma_f32_16x16x32_bf16 v[44:47], v[116:119], v[144:147], v[44:47]
    v_mfma_f32_16x16x32_bf16 v[32:35], v[104:107], v[148:151], v[32:35]
    v_mfma_f32_16x16x32_bf16 v[36:39], v[108:111], v[148:151], v[36:39]
    v_mfma_f32_16x16x32_bf16 v[40:43], v[96:99], v[148:151], v[40:43]
    v_mfma_f32_16x16x32_bf16 v[44:47], v[100:103], v[148:151], v[44:47]
    s_waitcnt lgkmcnt(6)
    v_mfma_f32_16x16x32_bf16 v[48:51], v[96:99], v[152:155], v[48:51]
    ds_read_b128 v[168:171], v187 offset:22528
    ds_read_b128 v[172:175], v187 offset:33280
    v_mfma_f32_16x16x32_bf16 v[52:55], v[100:103], v[152:155], v[52:55]
    v_mfma_f32_16x16x32_bf16 v[56:59], v[112:115], v[152:155], v[56:59]
    ds_read_b64_tr_b16 v[128:129], v182 offset:8192
    ds_read_b64_tr_b16 v[130:131], v182 offset:9216
    ds_read_b64_tr_b16 v[132:133], v183 offset:8192
    ds_read_b64_tr_b16 v[134:135], v183 offset:9216
    v_mfma_f32_16x16x32_bf16 v[60:63], v[116:119], v[152:155], v[60:63]
    v_mfma_f32_16x16x32_bf16 v[48:51], v[104:107], v[156:159], v[48:51]
    v_mfma_f32_16x16x32_bf16 v[52:55], v[108:111], v[156:159], v[52:55]
    v_mfma_f32_16x16x32_bf16 v[56:59], v[96:99], v[156:159], v[56:59]
    v_mfma_f32_16x16x32_bf16 v[60:63], v[100:103], v[156:159], v[60:63]
    s_waitcnt lgkmcnt(10)
    v_mfma_f32_16x16x32_bf16 v[64:67], v[96:99], v[160:163], v[64:67]
    ds_read_b128 v[144:147], v187 offset:23552
    ds_read_b128 v[148:151], v187 offset:34304
    v_mfma_f32_16x16x32_bf16 v[68:71], v[100:103], v[160:163], v[68:71]
    s_waitcnt lgkmcnt(2)
    v_mfma_f32_16x16x32_bf16 v[72:75], v[112:115], v[160:163], v[72:75]
    v_xor_b32 v136, 0x80008000, v128
    v_xor_b32 v137, 0x80008000, v129
    v_mfma_f32_16x16x32_bf16 v[76:79], v[116:119], v[160:163], v[76:79]
    v_xor_b32 v138, 0x80008000, v130
    v_xor_b32 v139, 0x80008000, v131
    v_mfma_f32_16x16x32_bf16 v[64:67], v[104:107], v[164:167], v[64:67]
    v_xor_b32 v140, 0x80008000, v132
    v_xor_b32 v141, 0x80008000, v133
    v_mfma_f32_16x16x32_bf16 v[68:71], v[108:111], v[164:167], v[68:71]
    v_xor_b32 v142, 0x80008000, v134
    v_xor_b32 v143, 0x80008000, v135
    v_mfma_f32_16x16x32_bf16 v[72:75], v[96:99], v[164:167], v[72:75]
    v_mfma_f32_16x16x32_bf16 v[76:79], v[100:103], v[164:167], v[76:79]
    v_mfma_f32_16x16x32_bf16 v[0:3], v[120:123], v[168:171], v[0:3]
    ds_read_b128 v[152:155], v187 offset:24576
    ds_read_b128 v[156:159], v187 offset:35328
    v_mfma_f32_16x16x32_bf16 v[4:7], v[124:127], v[168:171], v[4:7]
    v_mfma_f32_16x16x32_bf16 v[8:11], v[136:139], v[168:171], v[8:11]
    v_mfma_f32_16x16x32_bf16 v[12:15], v[140:143], v[168:171], v[12:15]
    v_mfma_f32_16x16x32_bf16 v[0:3], v[128:131], v[172:175], v[0:3]
    v_mfma_f32_16x16x32_bf16 v[4:7], v[132:135], v[172:175], v[4:7]
    v_mfma_f32_16x16x32_bf16 v[8:11], v[120:123], v[172:175], v[8:11]
    v_mfma_f32_16x16x32_bf16 v[12:15], v[124:127], v[172:175], v[12:15]
    s_waitcnt lgkmcnt(2)
    v_mfma_f32_16x16x32_bf16 v[16:19], v[120:123], v[144:147], v[16:19]
    ds_read_b128 v[160:163], v187 offset:25600
    ds_read_b128 v[164:167], v187 offset:36352
    v_mfma_f32_16x16x32_bf16 v[20:23], v[124:127], v[144:147], v[20:23]
    v_mfma_f32_16x16x32_bf16 v[24:27], v[136:139], v[144:147], v[24:27]
    v_mfma_f32_16x16x32_bf16 v[28:31], v[140:143], v[144:147], v[28:31]
    v_mfma_f32_16x16x32_bf16 v[16:19], v[128:131], v[148:151], v[16:19]
    v_mfma_f32_16x16x32_bf16 v[20:23], v[132:135], v[148:151], v[20:23]
    v_mfma_f32_16x16x32_bf16 v[24:27], v[120:123], v[148:151], v[24:27]
    v_mfma_f32_16x16x32_bf16 v[28:31], v[124:127], v[148:151], v[28:31]
    s_waitcnt lgkmcnt(2)
    v_mfma_f32_16x16x32_bf16 v[32:35], v[120:123], v[152:155], v[32:35]
    ds_read_b128 v[168:171], v187 offset:26624
    ds_read_b128 v[172:175], v187 offset:37376
    v_mfma_f32_16x16x32_bf16 v[36:39], v[124:127], v[152:155], v[36:39]
    v_mfma_f32_16x16x32_bf16 v[40:43], v[136:139], v[152:155], v[40:43]
    v_mfma_f32_16x16x32_bf16 v[44:47], v[140:143], v[152:155], v[44:47]
    v_mfma_f32_16x16x32_bf16 v[32:35], v[128:131], v[156:159], v[32:35]
    v_mfma_f32_16x16x32_bf16 v[36:39], v[132:135], v[156:159], v[36:39]
    v_mfma_f32_16x16x32_bf16 v[40:43], v[120:123], v[156:159], v[40:43]
    v_mfma_f32_16x16x32_bf16 v[44:47], v[124:127], v[156:159], v[44:47]
    s_waitcnt lgkmcnt(2)
    v_mfma_f32_16x16x32_bf16 v[48:51], v[120:123], v[160:163], v[48:51]
    v_mfma_f32_16x16x32_bf16 v[52:55], v[124:127], v[160:163], v[52:55]
    v_mfma_f32_16x16x32_bf16 v[56:59], v[136:139], v[160:163], v[56:59]
    v_mfma_f32_16x16x32_bf16 v[60:63], v[140:143], v[160:163], v[60:63]
    v_mfma_f32_16x16x32_bf16 v[48:51], v[128:131], v[164:167], v[48:51]
    v_mfma_f32_16x16x32_bf16 v[52:55], v[132:135], v[164:167], v[52:55]
    v_mfma_f32_16x16x32_bf16 v[56:59], v[120:123], v[164:167], v[56:59]
    v_mfma_f32_16x16x32_bf16 v[60:63], v[124:127], v[164:167], v[60:63]
    s_waitcnt lgkmcnt(0)
    v_mfma_f32_16x16x32_bf16 v[64:67], v[120:123], v[168:171], v[64:67]
    v_mfma_f32_16x16x32_bf16 v[68:71], v[124:127], v[168:171], v[68:71]
    v_mfma_f32_16x16x32_bf16 v[72:75], v[136:139], v[168:171], v[72:75]
    v_mfma_f32_16x16x32_bf16 v[76:79], v[140:143], v[168:171], v[76:79]
    v_mfma_f32_16x16x32_bf16 v[64:67], v[128:131], v[172:175], v[64:67]
    v_mfma_f32_16x16x32_bf16 v[68:71], v[132:135], v[172:175], v[68:71]
    v_mfma_f32_16x16x32_bf16 v[72:75], v[120:123], v[172:175], v[72:75]
    v_mfma_f32_16x16x32_bf16 v[76:79], v[124:127], v[172:175], v[76:79]
    s_nop 7
    v_cvt_pk_bf16_f32 v0, v0, v1
    v_cvt_pk_bf16_f32 v1, v2, v3
    v_cvt_pk_bf16_f32 v2, v4, v5
    v_cvt_pk_bf16_f32 v3, v6, v7
    s_add_u32 s47, s48, 98304
    buffer_store_dwordx4 v[0:3], v190, s[16:19], s47 offen
    v_cvt_pk_bf16_f32 v8, v8, v9
    v_cvt_pk_bf16_f32 v9, v10, v11
    v_cvt_pk_bf16_f32 v10, v12, v13
    v_cvt_pk_bf16_f32 v11, v14, v15
    s_add_u32 s47, s48, 458752
    buffer_store_dwordx4 v[8:11], v190, s[16:19], s47 offen
    v_cvt_pk_bf16_f32 v16, v16, v17
    v_cvt_pk_bf16_f32 v17, v18, v19
    v_cvt_pk_bf16_f32 v18, v20, v21
    v_cvt_pk_bf16_f32 v19, v22, v23
    s_add_u32 s47, s48, 114688
    buffer_store_dwordx4 v[16:19], v190, s[16:19], s47 offen
    v_cvt_pk_bf16_f32 v24, v24, v25
    v_cvt_pk_bf16_f32 v25, v26, v27
    v_cvt_pk_bf16_f32 v26, v28, v29
    v_cvt_pk_bf16_f32 v27, v30, v31
    s_add_u32 s47, s48, 475136
    buffer_store_dwordx4 v[24:27], v190, s[16:19], s47 offen
    v_cvt_pk_bf16_f32 v32, v32, v33
    v_cvt_pk_bf16_f32 v33, v34, v35
    v_cvt_pk_bf16_f32 v34, v36, v37
    v_cvt_pk_bf16_f32 v35, v38, v39
    s_add_u32 s47, s48, 131072
    buffer_store_dwordx4 v[32:35], v190, s[16:19], s47 offen
    v_cvt_pk_bf16_f32 v40, v40, v41
    v_cvt_pk_bf16_f32 v41, v42, v43
    v_cvt_pk_bf16_f32 v42, v44, v45
    v_cvt_pk_bf16_f32 v43, v46, v47
    s_add_u32 s47, s48, 491520
    buffer_store_dwordx4 v[40:43], v190, s[16:19], s47 offen
    v_cvt_pk_bf16_f32 v48, v48, v49
    v_cvt_pk_bf16_f32 v49, v50, v51
    v_cvt_pk_bf16_f32 v50, v52, v53
    v_cvt_pk_bf16_f32 v51, v54, v55
    s_add_u32 s47, s48, 147456
    buffer_store_dwordx4 v[48:51], v190, s[16:19], s47 offen
    v_cvt_pk_bf16_f32 v56, v56, v57
    v_cvt_pk_bf16_f32 v57, v58, v59
    v_cvt_pk_bf16_f32 v58, v60, v61
    v_cvt_pk_bf16_f32 v59, v62, v63
    s_add_u32 s47, s48, 507904
    buffer_store_dwordx4 v[56:59], v190, s[16:19], s47 offen
    v_cvt_pk_bf16_f32 v64, v64, v65
    v_cvt_pk_bf16_f32 v65, v66, v67
    v_cvt_pk_bf16_f32 v66, v68, v69
    v_cvt_pk_bf16_f32 v67, v70, v71
    s_add_u32 s47, s48, 163840
    buffer_store_dwordx4 v[64:67], v191, s[16:19], s47 offen
    v_cvt_pk_bf16_f32 v72, v72, v73
    v_cvt_pk_bf16_f32 v73, v74, v75
    v_cvt_pk_bf16_f32 v74, v76, v77
    v_cvt_pk_bf16_f32 v75, v78, v79
    s_add_u32 s47, s48, 524288
    buffer_store_dwordx4 v[72:75], v191, s[16:19], s47 offen
    s_endpgm
L_k3_end:
    s_endpgm
.globl stats_kernel
.p2align 8
.type stats_kernel,@function
stats_kernel:
    s_cmp_ge_u32 s2, 336
    s_cbranch_scc1 L_k4_end
    s_load_dwordx4 s[4:7], s[0:1], 16
    s_load_dwordx2 s[8:9], s[0:1], 48
    s_load_dwordx2 s[28:29], s[0:1], 32
    v_and_b32 v200, 63, v0
    v_lshrrev_b32 v204, 6, v0
    v_and_b32 v201, 15, v200
    v_readfirstlane_b32 s10, v204
    v_lshrrev_b32 v202, 4, v200
    s_mov_b32 s30, 0x05040100
    s_mov_b32 s31, 0x07060302
    s_and_b32 s13, s2, 3
    s_lshr_b32 s12, s2, 2
    s_cmp_ge_u32 s12, 42
    s_cselect_b32 s11, 1, 0
    s_mul_i32 s15, s11, 42
    s_sub_u32 s12, s12, s15
    s_lshl_b32 s14, s12, 2
    s_add_u32 s14, s14, s10
    s_waitcnt lgkmcnt(0)
    s_mov_b32 s16, s8
    s_and_b32 s17, s9, 0xffff
    s_mov_b32 s18, 268435456
    s_mov_b32 s19, 0x00020000
    s_mov_b32 s24, 2883584
    v_mul_u32_u24 v203, s24, v202
    v_lshl_add_u32 v203, v201, 4, v203
    s_mul_i32 s24, s11, 180224
    s_lshl_b32 s25, s14, 10
    s_add_u32 s24, s24, s25
    s_lshl_b32 s25, s13, 8
    s_add_u32 s24, s24, s25
    s_add_u32 s24, s24, 117440512
    s_add_u32 s25, s24, 0
    buffer_load_dwordx4 v[0:3], v203, s[16:19], s25 offen
    s_add_u32 s25, s24, 360448
    buffer_load_dwordx4 v[4:7], v203, s[16:19], s25 offen
    s_add_u32 s25, s24, 720896
    buffer_load_dwordx4 v[8:11], v203, s[16:19], s25 offen
    s_add_u32 s25, s24, 1081344
    buffer_load_dwordx4 v[12:15], v203, s[16:19], s25 offen
    s_add_u32 s25, s24, 1441792
    buffer_load_dwordx4 v[16:19], v203, s[16:19], s25 offen
    s_add_u32 s25, s24, 1802240
    buffer_load_dwordx4 v[20:23], v203, s[16:19], s25 offen
    s_add_u32 s25, s24, 2162688
    buffer_load_dwordx4 v[24:27], v203, s[16:19], s25 offen
    s_add_u32 s25, s24, 2523136
    buffer_load_dwordx4 v[28:31], v203, s[16:19], s25 offen
    s_add_u32 s25, s24, 11534336
    buffer_load_dwordx4 v[32:35], v203, s[16:19], s25 offen
    s_add_u32 s25, s24, 11894784
    buffer_load_dwordx4 v[36:39], v203, s[16:19], s25 offen
    s_add_u32 s25, s24, 12255232
    buffer_load_dwordx4 v[40:43], v203, s[16:19], s25 offen
    s_add_u32 s25, s24, 12615680
    buffer_load_dwordx4 v[44:47], v203, s[16:19], s25 offen
    s_add_u32 s25, s24, 12976128
    buffer_load_dwordx4 v[48:51], v203, s[16:19], s25 offen
    s_add_u32 s25, s24, 13336576
    buffer_load_dwordx4 v[52:55], v203, s[16:19], s25 offen
    s_add_u32 s25, s24, 13697024
    buffer_load_dwordx4 v[56:59], v203, s[16:19], s25 offen
    s_add_u32 s25, s24, 14057472
    buffer_load_dwordx4 v[60:63], v203, s[16:19], s25 offen
    s_cmp_ge_u32 s10, 3
    s_cbranch_scc1 L_k4_notab
    s_lshl_b32 s25, s10, 4
    v_add_u32 v204, s25, v201
    v_lshlrev_b32 v205, 3, v202
    v_add_u32 v205, 1, v205
    v_mul_u32_u24 v88, v205, v204
    v_add_u32 v89, 32, v88
    v_add_u32 v205, 2, v205
    v_mul_u32_u24 v90, v205, v204
    v_add_u32 v91, 32, v90
    v_add_u32 v205, 2, v205
    v_mul_u32_u24 v92, v205, v204
    v_add_u32 v93, 32, v92
    v_add_u32 v205, 2, v205
    v_mul_u32_u24 v94, v205, v204
    v_add_u32 v95, 32, v94
    v_and_b32 v88, 127, v88
    v_cvt_f32_u32 v88, v88
    v_mul_f32 v88, 0x3c000000, v88
    v_cos_f32 v88, v88
    v_and_b32 v89, 127, v89
    v_cvt_f32_u32 v89, v89
    v_mul_f32 v89, 0x3c000000, v89
    v_cos_f32 v89, v89
    v_and_b32 v90, 127, v90
    v_cvt_f32_u32 v90, v90
    v_mul_f32 v90, 0x3c000000, v90
    v_cos_f32 v90, v90
    v_and_b32 v91, 127, v91
    v_cvt_f32_u32 v91, v91
    v_mul_f32 v91, 0x3c000000, v91
    v_cos_f32 v91, v91
    v_and_b32 v92, 127, v92
    v_cvt_f32_u32 v92, v92
    v_mul_f32 v92, 0x3c000000, v92
    v_cos_f32 v92, v92
    v_and_b32 v93, 127, v93
    v_cvt_f32_u32 v93, v93
    v_mul_f32 v93, 0x3c000000, v93
    v_cos_f32 v93, v93
    v_and_b32 v94, 127, v94
    v_cvt_f32_u32 v94, v94
    v_mul_f32 v94, 0x3c000000, v94
    v_cos_f32 v94, v94
    v_and_b32 v95, 127, v95
    v_cvt_f32_u32 v95, v95
    v_mul_f32 v95, 0x3c000000, v95
    v_cos_f32 v95, v95
    v_mul_f32 v88, 0x3d000000, v88
    v_mul_f32 v89, 0x3d000000, v89
    v_mul_f32 v90, 0x3d000000, v90
    v_mul_f32 v91, 0x3d000000, v91
    v_mul_f32 v92, 0x3d000000, v92
    v_mul_f32 v93, 0x3d000000, v93
    v_mul_f32 v94, 0x3d000000, v94
    v_mul_f32 v95, 0x3d000000, v95
    v_cvt_pk_bf16_f32 v104, v88, v89
    v_cvt_pk_bf16_f32 v105, v90, v91
    v_cvt_pk_bf16_f32 v106, v92, v93
    v_cvt_pk_bf16_f32 v107, v94, v95
    s_lshl_b32 s25, s10, 11
    v_lshlrev_b32 v207, 4, v200
    v_add_u32 v207, s25, v207
    ds_write_b128 v207, v[104:107] offset:0
    v_lshlrev_b32 v205, 3, v202
    v_add_u32 v205, 33, v205
    v_mul_u32_u24 v88, v205, v204
    v_add_u32 v89, 32, v88
    v_add_u32 v205, 2, v205
    v_mul_u32_u24 v90, v205, v204
    v_add_u32 v91, 32, v90
    v_add_u32 v205, 2, v205
    v_mul_u32_u24 v92, v205, v204
    v_add_u32 v93, 32, v92
    v_add_u32 v205, 2, v205
    v_mul_u32_u24 v94, v205, v204
    v_add_u32 v95, 32, v94
    v_and_b32 v88, 127, v88
    v_cvt_f32_u32 v88, v88
    v_mul_f32 v88, 0x3c000000, v88
    v_cos_f32 v88, v88
    v_and_b32 v89, 127, v89
    v_cvt_f32_u32 v89, v89
    v_mul_f32 v89, 0x3c000000, v89
    v_cos_f32 v89, v89
    v_and_b32 v90, 127, v90
    v_cvt_f32_u32 v90, v90
    v_mul_f32 v90, 0x3c000000, v90
    v_cos_f32 v90, v90
    v_and_b32 v91, 127, v91
    v_cvt_f32_u32 v91, v91
    v_mul_f32 v91, 0x3c000000, v91
    v_cos_f32 v91, v91
    v_and_b32 v92, 127, v92
    v_cvt_f32_u32 v92, v92
    v_mul_f32 v92, 0x3c000000, v92
    v_cos_f32 v92, v92
    v_and_b32 v93, 127, v93
    v_cvt_f32_u32 v93, v93
    v_mul_f32 v93, 0x3c000000, v93
    v_cos_f32 v93, v93
    v_and_b32 v94, 127, v94
    v_cvt_f32_u32 v94, v94
    v_mul_f32 v94, 0x3c000000, v94
    v_cos_f32 v94, v94
    v_and_b32 v95, 127, v95
    v_cvt_f32_u32 v95, v95
    v_mul_f32 v95, 0x3c000000, v95
    v_cos_f32 v95, v95
    v_mul_f32 v88, 0x3d000000, v88
    v_mul_f32 v89, 0x3d000000, v89
    v_mul_f32 v90, 0x3d000000, v90
    v_mul_f32 v91, 0x3d000000, v91
    v_mul_f32 v92, 0x3d000000, v92
    v_mul_f32 v93, 0x3d000000, v93
    v_mul_f32 v94, 0x3d000000, v94
    v_mul_f32 v95, 0x3d000000, v95
    v_cvt_pk_bf16_f32 v104, v88, v89
    v_cvt_pk_bf16_f32 v105, v90, v91
    v_cvt_pk_bf16_f32 v106, v92, v93
    v_cvt_pk_bf16_f32 v107, v94, v95
    s_lshl_b32 s25, s10, 11
    v_lshlrev_b32 v207, 4, v200
    v_add_u32 v207, s25, v207
    ds_write_b128 v207, v[104:107] offset:1024
L_k4_notab:
    s_waitcnt lgkmcnt(0)
    s_barrier
    v_lshlrev_b32 v207, 4, v200
    ds_read_b128 v[64:67], v207 offset:0
    ds_read_b128 v[68:71], v207 offset:1024
    ds_read_b128 v[72:75], v207 offset:2048
    ds_read_b128 v[76:79], v207 offset:3072
    ds_read_b128 v[80:83], v207 offset:4096
    ds_read_b128 v[84:87], v207 offset:5120
    s_cmp_ge_u32 s14, 167
    s_cbranch_scc1 L_k4_zero
    s_waitcnt lgkmcnt(0)
    s_cmp_lg_u32 s14, 166
    s_cbranch_scc1 L_k4_full
    v_cmp_gt_i32 vcc, 17, v201
    s_nop 1
    v_cndmask_b32 v64, 0, v64, vcc
    v_cndmask_b32 v65, 0, v65, vcc
    v_cndmask_b32 v66, 0, v66, vcc
    v_cndmask_b32 v67, 0, v67, vcc
    v_cndmask_b32 v68, 0, v68, vcc
    v_cndmask_b32 v69, 0, v69, vcc
    v_cndmask_b32 v70, 0, v70, vcc
    v_cndmask_b32 v71, 0, v71, vcc
    v_cmp_gt_i32 vcc, 1, v201
    s_nop 1
    v_cndmask_b32 v72, 0, v72, vcc
    v_cndmask_b32 v73, 0, v73, vcc
    v_cndmask_b32 v74, 0, v74, vcc
    v_cndmask_b32 v75, 0, v75, vcc
    v_cndmask_b32 v76, 0, v76, vcc
    v_cndmask_b32 v77, 0, v77, vcc
    v_cndmask_b32 v78, 0, v78, vcc
    v_cndmask_b32 v79, 0, v79, vcc
    v_cmp_gt_i32 vcc, 0, v201
    s_nop 1
    v_cndmask_b32 v80, 0, v80, vcc
    v_cndmask_b32 v81, 0, v81, vcc
    v_cndmask_b32 v82, 0, v82, vcc
    v_cndmask_b32 v83, 0, v83, vcc
    v_cndmask_b32 v84, 0, v84, vcc
    v_cndmask_b32 v85, 0, v85, vcc
    v_cndmask_b32 v86, 0, v86, vcc
    v_cndmask_b32 v87, 0, v87, vcc
L_k4_full:
    s_waitcnt vmcnt(0)
    v_perm_b32 v88, v4, v0, s30
    v_perm_b32 v89, v12, v8, s30
    v_perm_b32 v90, v20, v16, s30
    v_perm_b32 v91, v28, v24, s30
    v_perm_b32 v92, v4, v0, s31
    v_perm_b32 v93, v12, v8, s31
    v_perm_b32 v94, v20, v16, s31
    v_perm_b32 v95, v28, v24, s31
    v_perm_b32 v96, v36, v32, s30
    v_perm_b32 v97, v44, v40, s30
    v_perm_b32 v98, v52, v48, s30
    v_perm_b32 v99, v60, v56, s30
    v_perm_b32 v100, v36, v32, s31
    v_perm_b32 v101, v44, v40, s31
    v_perm_b32 v102, v52, v48, s31
    v_perm_b32 v103, v60, v56, s31
    v_mfma_f32_16x16x32_bf16 v[104:107], v[64:67], v[88:91], 0
    v_mfma_f32_16x16x32_bf16 v[108:111], v[64:67], v[92:95], 0
    v_mfma_f32_16x16x32_bf16 v[136:139], v[72:75], v[88:91], 0
    v_mfma_f32_16x16x32_bf16 v[140:143], v[72:75], v[92:95], 0
    v_mfma_f32_16x16x32_bf16 v[168:171], v[80:83], v[88:91], 0
    v_mfma_f32_16x16x32_bf16 v[172:175], v[80:83], v[92:95], 0
    v_mfma_f32_16x16x32_bf16 v[104:107], v[68:71], v[96:99], v[104:107]
    v_mfma_f32_16x16x32_bf16 v[108:111], v[68:71], v[100:103], v[108:111]
    v_mfma_f32_16x16x32_bf16 v[136:139], v[76:79], v[96:99], v[136:139]
    v_mfma_f32_16x16x32_bf16 v[140:143], v[76:79], v[100:103], v[140:143]
    v_mfma_f32_16x16x32_bf16 v[168:171], v[84:87], v[96:99], v[168:171]
    v_mfma_f32_16x16x32_bf16 v[172:175], v[84:87], v[100:103], v[172:175]
    v_perm_b32 v88, v5, v1, s30
    v_perm_b32 v89, v13, v9, s30
    v_perm_b32 v90, v21, v17, s30
    v_perm_b32 v91, v29, v25, s30
    v_perm_b32 v92, v5, v1, s31
    v_perm_b32 v93, v13, v9, s31
    v_perm_b32 v94, v21, v17, s31
    v_perm_b32 v95, v29, v25, s31
    v_perm_b32 v96, v37, v33, s30
    v_perm_b32 v97, v45, v41, s30
    v_perm_b32 v98, v53, v49, s30
    v_perm_b32 v99, v61, v57, s30
    v_perm_b32 v100, v37, v33, s31
    v_perm_b32 v101, v45, v41, s31
    v_perm_b32 v102, v53, v49, s31
    v_perm_b32 v103, v61, v57, s31
    v_mfma_f32_16x16x32_bf16 v[112:115], v[64:67], v[88:91], 0
    v_mfma_f32_16x16x32_bf16 v[116:119], v[64:67], v[92:95], 0
    v_mfma_f32_16x16x32_bf16 v[144:147], v[72:75], v[88:91], 0
    v_mfma_f32_16x16x32_bf16 v[148:151], v[72:75], v[92:95], 0
    v_mfma_f32_16x16x32_bf16 v[176:179], v[80:83], v[88:91], 0
    v_mfma_f32_16x16x32_bf16 v[180:183], v[80:83], v[92:95], 0
    v_mfma_f32_16x16x32_bf16 v[112:115], v[68:71], v[96:99], v[112:115]
    v_mfma_f32_16x16x32_bf16 v[116:119], v[68:71], v[100:103], v[116:119]
    v_mfma_f32_16x16x32_bf16 v[144:147], v[76:79], v[96:99], v[144:147]
    v_mfma_f32_16x16x32_bf16 v[148:151], v[76:79], v[100:103], v[148:151]
    v_mfma_f32_16x16x32_bf16 v[176:179], v[84:87], v[96:99], v[176:179]
    v_mfma_f32_16x16x32_bf16 v[180:183], v[84:87], v[100:103], v[180:183]
    v_perm_b32 v88, v6, v2, s30
    v_perm_b32 v89, v14, v10, s30
    v_perm_b32 v90, v22, v18, s30
    v_perm_b32 v91, v30, v26, s30
    v_perm_b32 v92, v6, v2, s31
    v_perm_b32 v93, v14, v10, s31
    v_perm_b32 v94, v22, v18, s31
    v_perm_b32 v95, v30, v26, s31
    v_perm_b32 v96, v38, v34, s30
    v_perm_b32 v97, v46, v42, s30
    v_perm_b32 v98, v54, v50, s30
    v_perm_b32 v99, v62, v58, s30
    v_perm_b32 v100, v38, v34, s31
    v_perm_b32 v101, v46, v42, s31
    v_perm_b32 v102, v54, v50, s31
    v_perm_b32 v103, v62, v58, s31
    v_mfma_f32_16x16x32_bf16 v[120:123], v[64:67], v[88:91], 0
    v_mfma_f32_16x16x32_bf16 v[124:127], v[64:67], v[92:95], 0
    v_mfma_f32_16x16x32_bf16 v[152:155], v[72:75], v[88:91], 0
    v_mfma_f32_16x16x32_bf16 v[156:159], v[72:75], v[92:95], 0
    v_mfma_f32_16x16x32_bf16 v[184:187], v[80:83], v[88:91], 0
    v_mfma_f32_16x16x32_bf16 v[188:191], v[80:83], v[92:95], 0
    v_mfma_f32_16x16x32_bf16 v[120:123], v[68:71], v[96:99], v[120:123]
    v_mfma_f32_16x16x32_bf16 v[124:127], v[68:71], v[100:103], v[124:127]
    v_mfma_f32_16x16x32_bf16 v[152:155], v[76:79], v[96:99], v[152:155]
    v_mfma_f32_16x16x32_bf16 v[156:159], v[76:79], v[100:103], v[156:159]
    v_mfma_f32_16x16x32_bf16 v[184:187], v[84:87], v[96:99], v[184:187]
    v_mfma_f32_16x16x32_bf16 v[188:191], v[84:87], v[100:103], v[188:191]
    v_perm_b32 v88, v7, v3, s30
    v_perm_b32 v89, v15, v11, s30
    v_perm_b32 v90, v23, v19, s30
    v_perm_b32 v91, v31, v27, s30
    v_perm_b32 v92, v7, v3, s31
    v_perm_b32 v93, v15, v11, s31
    v_perm_b32 v94, v23, v19, s31
    v_perm_b32 v95, v31, v27, s31
    v_perm_b32 v96, v39, v35, s30
    v_perm_b32 v97, v47, v43, s30
    v_perm_b32 v98, v55, v51, s30
    v_perm_b32 v99, v63, v59, s30
    v_perm_b32 v100, v39, v35, s31
    v_perm_b32 v101, v47, v43, s31
    v_perm_b32 v102, v55, v51, s31
    v_perm_b32 v103, v63, v59, s31
    v_mfma_f32_16x16x32_bf16 v[128:131], v[64:67], v[88:91], 0
    v_mfma_f32_16x16x32_bf16 v[132:135], v[64:67], v[92:95], 0
    v_mfma_f32_16x16x32_bf16 v[160:163], v[72:75], v[88:91], 0
    v_mfma_f32_16x16x32_bf16 v[164:167], v[72:75], v[92:95], 0
    v_mfma_f32_16x16x32_bf16 v[192:195], v[80:83], v[88:91], 0
    v_mfma_f32_16x16x32_bf16 v[196:199], v[80:83], v[92:95], 0
    v_mfma_f32_16x16x32_bf16 v[128:131], v[68:71], v[96:99], v[128:131]
    v_mfma_f32_16x16x32_bf16 v[132:135], v[68:71], v[100:103], v[132:135]
    v_mfma_f32_16x16x32_bf16 v[160:163], v[76:79], v[96:99], v[160:163]
    v_mfma_f32_16x16x32_bf16 v[164:167], v[76:79], v[100:103], v[164:167]
    v_mfma_f32_16x16x32_bf16 v[192:195], v[84:87], v[96:99], v[192:195]
    v_mfma_f32_16x16x32_bf16 v[196:199], v[84:87], v[100:103], v[196:199]
    s_nop 7
    v_mul_f32 v8, v104, v104
    v_mov_b32 v0, v104
    v_fmac_f32 v8, v105, v105
    v_add_f32 v0, v0, v105
    v_fmac_f32 v8, v106, v106
    v_add_f32 v0, v0, v106
    v_fmac_f32 v8, v107, v107
    v_add_f32 v0, v0, v107
    v_fmac_f32 v8, v136, v136
    v_add_f32 v0, v0, v136
    v_fmac_f32 v8, v137, v137
    v_add_f32 v0, v0, v137
    v_fmac_f32 v8, v138, v138
    v_add_f32 v0, v0, v138
    v_fmac_f32 v8, v139, v139
    v_add_f32 v0, v0, v139
    v_fmac_f32 v8, v168, v168
    v_add_f32 v0, v0, v168
    v_fmac_f32 v8, v169, v169
    v_add_f32 v0, v0, v169
    v_fmac_f32 v8, v170, v170
    v_add_f32 v0, v0, v170
    v_fmac_f32 v8, v171, v171
    v_add_f32 v0, v0, v171
    v_mul_f32 v9, v108, v108
    v_mov_b32 v1, v108
    v_fmac_f32 v9, v109, v109
    v_add_f32 v1, v1, v109
    v_fmac_f32 v9, v110, v110
    v_add_f32 v1, v1, v110
    v_fmac_f32 v9, v111, v111
    v_add_f32 v1, v1, v111
    v_fmac_f32 v9, v140, v140
    v_add_f32 v1, v1, v140
    v_fmac_f32 v9, v141, v141
    v_add_f32 v1, v1, v141
    v_fmac_f32 v9, v142, v142
    v_add_f32 v1, v1, v142
    v_fmac_f32 v9, v143, v143
    v_add_f32 v1, v1, v143
    v_fmac_f32 v9, v172, v172
    v_add_f32 v1, v1, v172
    v_fmac_f32 v9, v173, v173
    v_add_f32 v1, v1, v173
    v_fmac_f32 v9, v174, v174
    v_add_f32 v1, v1, v174
    v_fmac_f32 v9, v175, v175
    v_add_f32 v1, v1, v175
    v_mul_f32 v10, v112, v112
    v_mov_b32 v2, v112
    v_fmac_f32 v10, v113, v113
    v_add_f32 v2, v2, v113
    v_fmac_f32 v10, v114, v114
    v_add_f32 v2, v2, v114
    v_fmac_f32 v10, v115, v115
    v_add_f32 v2, v2, v115
    v_fmac_f32 v10, v144, v144
    v_add_f32 v2, v2, v144
    v_fmac_f32 v10, v145, v145
    v_add_f32 v2, v2, v145
    v_fmac_f32 v10, v146, v146
    v_add_f32 v2, v2, v146
    v_fmac_f32 v10, v147, v147
    v_add_f32 v2, v2, v147
    v_fmac_f32 v10, v176, v176
    v_add_f32 v2, v2, v176
    v_fmac_f32 v10, v177, v177
    v_add_f32 v2, v2, v177
    v_fmac_f32 v10, v178, v178
    v_add_f32 v2, v2, v178
    v_fmac_f32 v10, v179, v179
    v_add_f32 v2, v2, v179
    v_mul_f32 v11, v116, v116
    v_mov_b32 v3, v116
    v_fmac_f32 v11, v117, v117
    v_add_f32 v3, v3, v117
    v_fmac_f32 v11, v118, v118
    v_add_f32 v3, v3, v118
    v_fmac_f32 v11, v119, v119
    v_add_f32 v3, v3, v119
    v_fmac_f32 v11, v148, v148
    v_add_f32 v3, v3, v148
    v_fmac_f32 v11, v149, v149
    v_add_f32 v3, v3, v149
    v_fmac_f32 v11, v150, v150
    v_add_f32 v3, v3, v150
    v_fmac_f32 v11, v151, v151
    v_add_f32 v3, v3, v151
    v_fmac_f32 v11, v180, v180
    v_add_f32 v3, v3, v180
    v_fmac_f32 v11, v181, v181
    v_add_f32 v3, v3, v181
    v_fmac_f32 v11, v182, v182
    v_add_f32 v3, v3, v182
    v_fmac_f32 v11, v183, v183
    v_add_f32 v3, v3, v183
    v_mul_f32 v12, v120, v120
    v_mov_b32 v4, v120
    v_fmac_f32 v12, v121, v121
    v_add_f32 v4, v4, v121
    v_fmac_f32 v12, v122, v122
    v_add_f32 v4, v4, v122
    v_fmac_f32 v12, v123, v123
    v_add_f32 v4, v4, v123
    v_fmac_f32 v12, v152, v152
    v_add_f32 v4, v4, v152
    v_fmac_f32 v12, v153, v153
    v_add_f32 v4, v4, v153
    v_fmac_f32 v12, v154, v154
    v_add_f32 v4, v4, v154
    v_fmac_f32 v12, v155, v155
    v_add_f32 v4, v4, v155
    v_fmac_f32 v12, v184, v184
    v_add_f32 v4, v4, v184
    v_fmac_f32 v12, v185, v185
    v_add_f32 v4, v4, v185
    v_fmac_f32 v12, v186, v186
    v_add_f32 v4, v4, v186
    v_fmac_f32 v12, v187, v187
    v_add_f32 v4, v4, v187
    v_mul_f32 v13, v124, v124
    v_mov_b32 v5, v124
    v_fmac_f32 v13, v125, v125
    v_add_f32 v5, v5, v125
    v_fmac_f32 v13, v126, v126
    v_add_f32 v5, v5, v126
    v_fmac_f32 v13, v127, v127
    v_add_f32 v5, v5, v127
    v_fmac_f32 v13, v156, v156
    v_add_f32 v5, v5, v156
    v_fmac_f32 v13, v157, v157
    v_add_f32 v5, v5, v157
    v_fmac_f32 v13, v158, v158
    v_add_f32 v5, v5, v158
    v_fmac_f32 v13, v159, v159
    v_add_f32 v5, v5, v159
    v_fmac_f32 v13, v188, v188
    v_add_f32 v5, v5, v188
    v_fmac_f32 v13, v189, v189
    v_add_f32 v5, v5, v189
    v_fmac_f32 v13, v190, v190
    v_add_f32 v5, v5, v190
    v_fmac_f32 v13, v191, v191
    v_add_f32 v5, v5, v191
    v_mul_f32 v14, v128, v128
    v_mov_b32 v6, v128
    v_fmac_f32 v14, v129, v129
    v_add_f32 v6, v6, v129
    v_fmac_f32 v14, v130, v130
    v_add_f32 v6, v6, v130
    v_fmac_f32 v14, v131, v131
    v_add_f32 v6, v6, v131
    v_fmac_f32 v14, v160, v160
    v_add_f32 v6, v6, v160
    v_fmac_f32 v14, v161, v161
    v_add_f32 v6, v6, v161
    v_fmac_f32 v14, v162, v162
    v_add_f32 v6, v6, v162
    v_fmac_f32 v14, v163, v163
    v_add_f32 v6, v6, v163
    v_fmac_f32 v14, v192, v192
    v_add_f32 v6, v6, v192
    v_fmac_f32 v14, v193, v193
    v_add_f32 v6, v6, v193
    v_fmac_f32 v14, v194, v194
    v_add_f32 v6, v6, v194
    v_fmac_f32 v14, v195, v195
    v_add_f32 v6, v6, v195
    v_mul_f32 v15, v132, v132
    v_mov_b32 v7, v132
    v_fmac_f32 v15, v133, v133
    v_add_f32 v7, v7, v133
    v_fmac_f32 v15, v134, v134
    v_add_f32 v7, v7, v134
    v_fmac_f32 v15, v135, v135
    v_add_f32 v7, v7, v135
    v_fmac_f32 v15, v164, v164
    v_add_f32 v7, v7, v164
    v_fmac_f32 v15, v165, v165
    v_add_f32 v7, v7, v165
    v_fmac_f32 v15, v166, v166
    v_add_f32 v7, v7, v166
    v_fmac_f32 v15, v167, v167
    v_add_f32 v7, v7, v167
    v_fmac_f32 v15, v196, v196
    v_add_f32 v7, v7, v196
    v_fmac_f32 v15, v197, v197
    v_add_f32 v7, v7, v197
    v_fmac_f32 v15, v198, v198
    v_add_f32 v7, v7, v198
    v_fmac_f32 v15, v199, v199
    v_add_f32 v7, v7, v199
    s_branch L_k4_red
L_k4_zero:
    s_waitcnt vmcnt(0) lgkmcnt(0)
    v_mov_b32 v0, 0
    v_mov_b32 v1, 0
    v_mov_b32 v2, 0
    v_mov_b32 v3, 0
    v_mov_b32 v4, 0
    v_mov_b32 v5, 0
    v_mov_b32 v6, 0
    v_mov_b32 v7, 0
    v_mov_b32 v8, 0
    v_mov_b32 v9, 0
    v_mov_b32 v10, 0
    v_mov_b32 v11, 0
    v_mov_b32 v12, 0
    v_mov_b32 v13, 0
    v_mov_b32 v14, 0
    v_mov_b32 v15, 0
L_k4_red:
    s_lshl_b32 s25, s10, 12
    v_lshlrev_b32 v204, 10, v202
    v_lshl_add_u32 v204, v201, 5, v204
    v_add_u32 v204, s25, v204
    ds_write_b128 v204, v[0:3] offset:8192
    ds_write_b128 v204, v[4:7] offset:8208
    ds_write_b128 v204, v[8:11] offset:8704
    ds_write_b128 v204, v[12:15] offset:8720
    s_waitcnt lgkmcnt(0)
    s_barrier
    v_lshlrev_b32 v204, 2, v0
    ds_read_b32 v16, v204 offset:8192
    ds_read_b32 v17, v204 offset:9216
    ds_read_b32 v18, v204 offset:10240
    ds_read_b32 v19, v204 offset:11264
    ds_read_b32 v20, v204 offset:12288
    ds_read_b32 v21, v204 offset:13312
    ds_read_b32 v22, v204 offset:14336
    ds_read_b32 v23, v204 offset:15360
    ds_read_b32 v24, v204 offset:16384
    ds_read_b32 v25, v204 offset:17408
    ds_read_b32 v26, v204 offset:18432
    ds_read_b32 v27, v204 offset:19456
    ds_read_b32 v28, v204 offset:20480
    ds_read_b32 v29, v204 offset:21504
    ds_read_b32 v30, v204 offset:22528
    ds_read_b32 v31, v204 offset:23552
    s_waitcnt lgkmcnt(0)
    v_add_f32 v16, v16, v17
    v_add_f32 v16, v16, v18
    v_add_f32 v16, v16, v19
    v_add_f32 v16, v16, v20
    v_add_f32 v16, v16, v21
    v_add_f32 v16, v16, v22
    v_add_f32 v16, v16, v23
    v_add_f32 v16, v16, v24
    v_add_f32 v16, v16, v25
    v_add_f32 v16, v16, v26
    v_add_f32 v16, v16, v27
    v_add_f32 v16, v16, v28
    v_add_f32 v16, v16, v29
    v_add_f32 v16, v16, v30
    v_add_f32 v16, v16, v31
    s_mul_i32 s24, s11, 168
    s_mul_i32 s25, s13, 42
    s_add_u32 s24, s24, s25
    s_add_u32 s24, s24, s12
    s_lshl_b32 s24, s24, 10
    s_add_u32 s24, s24, 146800640
    buffer_store_dword v16, v204, s[16:19], s24 offen
L_k4_end:
    s_endpgm
.globl final_kernel
.p2align 8
.type final_kernel,@function
final_kernel:
    s_cmp_ge_u32 s2, 336
    s_cbranch_scc1 L_k5_end
    s_load_dwordx4 s[4:7], s[0:1], 16
    s_load_dwordx2 s[8:9], s[0:1], 48
    s_load_dwordx2 s[28:29], s[0:1], 32
    v_and_b32 v200, 63, v0
    v_lshrrev_b32 v204, 6, v0
    v_and_b32 v201, 15, v200
    v_readfirstlane_b32 s10, v204
    v_lshrrev_b32 v202, 4, v200
    s_mov_b32 s30, 0x05040100
    s_mov_b32 s31, 0x07060302
    s_and_b32 s13, s2, 3
    s_lshr_b32 s12, s2, 2
    s_cmp_ge_u32 s12, 42
    s_cselect_b32 s11, 1, 0
    s_mul_i32 s15, s11, 42
    s_sub_u32 s12, s12, s15
    s_lshl_b32 s14, s12, 2
    s_add_u32 s14, s14, s10
    s_waitcnt lgkmcnt(0)
    s_mov_b32 s16, s8
    s_and_b32 s17, s9, 0xffff
    s_mov_b32 s18, 268435456
    s_mov_b32 s19, 0x00020000
    s_mov_b32 s24, 2883584
    v_mul_u32_u24 v203, s24, v202
    v_lshl_add_u32 v203, v201, 4, v203
    s_mul_i32 s24, s11, 180224
    s_lshl_b32 s25, s14, 10
    s_add_u32 s24, s24, s25
    s_lshl_b32 s25, s13, 8
    s_add_u32 s24, s24, s25
    s_add_u32 s24, s24, 117440512
    s_add_u32 s25, s24, 0
    buffer_load_dwordx4 v[0:3], v203, s[16:19], s25 offen
    s_add_u32 s25, s24, 360448
    buffer_load_dwordx4 v[4:7], v203, s[16:19], s25 offen
    s_add_u32 s25, s24, 720896
    buffer_load_dwordx4 v[8:11], v203, s[16:19], s25 offen
    s_add_u32 s25, s24, 1081344
    buffer_load_dwordx4 v[12:15], v203, s[16:19], s25 offen
    s_add_u32 s25, s24, 1441792
    buffer_load_dwordx4 v[16:19], v203, s[16:19], s25 offen
    s_add_u32 s25, s24, 1802240
    buffer_load_dwordx4 v[20:23], v203, s[16:19], s25 offen
    s_add_u32 s25, s24, 2162688
    buffer_load_dwordx4 v[24:27], v203, s[16:19], s25 offen
    s_add_u32 s25, s24, 2523136
    buffer_load_dwordx4 v[28:31], v203, s[16:19], s25 offen
    s_add_u32 s25, s24, 11534336
    buffer_load_dwordx4 v[32:35], v203, s[16:19], s25 offen
    s_add_u32 s25, s24, 11894784
    buffer_load_dwordx4 v[36:39], v203, s[16:19], s25 offen
    s_add_u32 s25, s24, 12255232
    buffer_load_dwordx4 v[40:43], v203, s[16:19], s25 offen
    s_add_u32 s25, s24, 12615680
    buffer_load_dwordx4 v[44:47], v203, s[16:19], s25 offen
    s_add_u32 s25, s24, 12976128
    buffer_load_dwordx4 v[48:51], v203, s[16:19], s25 offen
    s_add_u32 s25, s24, 13336576
    buffer_load_dwordx4 v[52:55], v203, s[16:19], s25 offen
    s_add_u32 s25, s24, 13697024
    buffer_load_dwordx4 v[56:59], v203, s[16:19], s25 offen
    s_add_u32 s25, s24, 14057472
    buffer_load_dwordx4 v[60:63], v203, s[16:19], s25 offen
    s_cmp_ge_u32 s10, 3
    s_cbranch_scc1 L_k5_notab
    s_lshl_b32 s25, s10, 4
    v_add_u32 v204, s25, v201
    v_lshlrev_b32 v205, 3, v202
    v_add_u32 v205, 1, v205
    v_mul_u32_u24 v88, v205, v204
    v_add_u32 v89, 32, v88
    v_add_u32 v205, 2, v205
    v_mul_u32_u24 v90, v205, v204
    v_add_u32 v91, 32, v90
    v_add_u32 v205, 2, v205
    v_mul_u32_u24 v92, v205, v204
    v_add_u32 v93, 32, v92
    v_add_u32 v205, 2, v205
    v_mul_u32_u24 v94, v205, v204
    v_add_u32 v95, 32, v94
    v_and_b32 v88, 127, v88
    v_cvt_f32_u32 v88, v88
    v_mul_f32 v88, 0x3c000000, v88
    v_cos_f32 v88, v88
    v_and_b32 v89, 127, v89
    v_cvt_f32_u32 v89, v89
    v_mul_f32 v89, 0x3c000000, v89
    v_cos_f32 v89, v89
    v_and_b32 v90, 127, v90
    v_cvt_f32_u32 v90, v90
    v_mul_f32 v90, 0x3c000000, v90
    v_cos_f32 v90, v90
    v_and_b32 v91, 127, v91
    v_cvt_f32_u32 v91, v91
    v_mul_f32 v91, 0x3c000000, v91
    v_cos_f32 v91, v91
    v_and_b32 v92, 127, v92
    v_cvt_f32_u32 v92, v92
    v_mul_f32 v92, 0x3c000000, v92
    v_cos_f32 v92, v92
    v_and_b32 v93, 127, v93
    v_cvt_f32_u32 v93, v93
    v_mul_f32 v93, 0x3c000000, v93
    v_cos_f32 v93, v93
    v_and_b32 v94, 127, v94
    v_cvt_f32_u32 v94, v94
    v_mul_f32 v94, 0x3c000000, v94
    v_cos_f32 v94, v94
    v_and_b32 v95, 127, v95
    v_cvt_f32_u32 v95, v95
    v_mul_f32 v95, 0x3c000000, v95
    v_cos_f32 v95, v95
    v_mul_f32 v88, 0x3d000000, v88
    v_mul_f32 v89, 0x3d000000, v89
    v_mul_f32 v90, 0x3d000000, v90
    v_mul_f32 v91, 0x3d000000, v91
    v_mul_f32 v92, 0x3d000000, v92
    v_mul_f32 v93, 0x3d000000, v93
    v_mul_f32 v94, 0x3d000000, v94
    v_mul_f32 v95, 0x3d000000, v95
    v_cvt_pk_bf16_f32 v104, v88, v89
    v_cvt_pk_bf16_f32 v105, v90, v91
    v_cvt_pk_bf16_f32 v106, v92, v93
    v_cvt_pk_bf16_f32 v107, v94, v95
    s_lshl_b32 s25, s10, 11
    v_lshlrev_b32 v207, 4, v200
    v_add_u32 v207, s25, v207
    ds_write_b128 v207, v[104:107] offset:0
    v_lshlrev_b32 v205, 3, v202
    v_add_u32 v205, 33, v205
    v_mul_u32_u24 v88, v205, v204
    v_add_u32 v89, 32, v88
    v_add_u32 v205, 2, v205
    v_mul_u32_u24 v90, v205, v204
    v_add_u32 v91, 32, v90
    v_add_u32 v205, 2, v205
    v_mul_u32_u24 v92, v205, v204
    v_add_u32 v93, 32, v92
    v_add_u32 v205, 2, v205
    v_mul_u32_u24 v94, v205, v204
    v_add_u32 v95, 32, v94
    v_and_b32 v88, 127, v88
    v_cvt_f32_u32 v88, v88
    v_mul_f32 v88, 0x3c000000, v88
    v_cos_f32 v88, v88
    v_and_b32 v89, 127, v89
    v_cvt_f32_u32 v89, v89
    v_mul_f32 v89, 0x3c000000, v89
    v_cos_f32 v89, v89
    v_and_b32 v90, 127, v90
    v_cvt_f32_u32 v90, v90
    v_mul_f32 v90, 0x3c000000, v90
    v_cos_f32 v90, v90
    v_and_b32 v91, 127, v91
    v_cvt_f32_u32 v91, v91
    v_mul_f32 v91, 0x3c000000, v91
    v_cos_f32 v91, v91
    v_and_b32 v92, 127, v92
    v_cvt_f32_u32 v92, v92
    v_mul_f32 v92, 0x3c000000, v92
    v_cos_f32 v92, v92
    v_and_b32 v93, 127, v93
    v_cvt_f32_u32 v93, v93
    v_mul_f32 v93, 0x3c000000, v93
    v_cos_f32 v93, v93
    v_and_b32 v94, 127, v94
    v_cvt_f32_u32 v94, v94
    v_mul_f32 v94, 0x3c000000, v94
    v_cos_f32 v94, v94
    v_and_b32 v95, 127, v95
    v_cvt_f32_u32 v95, v95
    v_mul_f32 v95, 0x3c000000, v95
    v_cos_f32 v95, v95
    v_mul_f32 v88, 0x3d000000, v88
    v_mul_f32 v89, 0x3d000000, v89
    v_mul_f32 v90, 0x3d000000, v90
    v_mul_f32 v91, 0x3d000000, v91
    v_mul_f32 v92, 0x3d000000, v92
    v_mul_f32 v93, 0x3d000000, v93
    v_mul_f32 v94, 0x3d000000, v94
    v_mul_f32 v95, 0x3d000000, v95
    v_cvt_pk_bf16_f32 v104, v88, v89
    v_cvt_pk_bf16_f32 v105, v90, v91
    v_cvt_pk_bf16_f32 v106, v92, v93
    v_cvt_pk_bf16_f32 v107, v94, v95
    s_lshl_b32 s25, s10, 11
    v_lshlrev_b32 v207, 4, v200
    v_add_u32 v207, s25, v207
    ds_write_b128 v207, v[104:107] offset:1024
L_k5_notab:
    s_mul_i32 s24, s11, 168
    s_mul_i32 s25, s13, 42
    s_add_u32 s24, s24, s25
    s_lshl_b32 s24, s24, 10
    s_add_u32 s24, s24, 146800640
    v_lshlrev_b32 v209, 2, v0
    buffer_load_dword v112, v209, s[16:19], s24 offen offset:0
    buffer_load_dword v113, v209, s[16:19], s24 offen offset:1024
    buffer_load_dword v114, v209, s[16:19], s24 offen offset:2048
    buffer_load_dword v115, v209, s[16:19], s24 offen offset:3072
    s_add_u32 s24, s24, 4096
    buffer_load_dword v116, v209, s[16:19], s24 offen offset:0
    buffer_load_dword v117, v209, s[16:19], s24 offen offset:1024
    buffer_load_dword v118, v209, s[16:19], s24 offen offset:2048
    buffer_load_dword v119, v209, s[16:19], s24 offen offset:3072
    s_add_u32 s24, s24, 4096
    buffer_load_dword v120, v209, s[16:19], s24 offen offset:0
    buffer_load_dword v121, v209, s[16:19], s24 offen offset:1024
    buffer_load_dword v122, v209, s[16:19], s24 offen offset:2048
    buffer_load_dword v123, v209, s[16:19], s24 offen offset:3072
    s_add_u32 s24, s24, 4096
    buffer_load_dword v124, v209, s[16:19], s24 offen offset:0
    buffer_load_dword v125, v209, s[16:19], s24 offen offset:1024
    buffer_load_dword v126, v209, s[16:19], s24 offen offset:2048
    buffer_load_dword v127, v209, s[16:19], s24 offen offset:3072
    s_add_u32 s24, s24, 4096
    buffer_load_dword v128, v209, s[16:19], s24 offen offset:0
    buffer_load_dword v129, v209, s[16:19], s24 offen offset:1024
    buffer_load_dword v130, v209, s[16:19], s24 offen offset:2048
    buffer_load_dword v131, v209, s[16:19], s24 offen offset:3072
    s_add_u32 s24, s24, 4096
    buffer_load_dword v132, v209, s[16:19], s24 offen offset:0
    buffer_load_dword v133, v209, s[16:19], s24 offen offset:1024
    buffer_load_dword v134, v209, s[16:19], s24 offen offset:2048
    buffer_load_dword v135, v209, s[16:19], s24 offen offset:3072
    s_add_u32 s24, s24, 4096
    buffer_load_dword v136, v209, s[16:19], s24 offen offset:0
    buffer_load_dword v137, v209, s[16:19], s24 offen offset:1024
    buffer_load_dword v138, v209, s[16:19], s24 offen offset:2048
    buffer_load_dword v139, v209, s[16:19], s24 offen offset:3072
    s_add_u32 s24, s24, 4096
    buffer_load_dword v140, v209, s[16:19], s24 offen offset:0
    buffer_load_dword v141, v209, s[16:19], s24 offen offset:1024
    buffer_load_dword v142, v209, s[16:19], s24 offen offset:2048
    buffer_load_dword v143, v209, s[16:19], s24 offen offset:3072
    s_add_u32 s24, s24, 4096
    buffer_load_dword v144, v209, s[16:19], s24 offen offset:0
    buffer_load_dword v145, v209, s[16:19], s24 offen offset:1024
    buffer_load_dword v146, v209, s[16:19], s24 offen offset:2048
    buffer_load_dword v147, v209, s[16:19], s24 offen offset:3072
    s_add_u32 s24, s24, 4096
    buffer_load_dword v148, v209, s[16:19], s24 offen offset:0
    buffer_load_dword v149, v209, s[16:19], s24 offen offset:1024
    buffer_load_dword v150, v209, s[16:19], s24 offen offset:2048
    buffer_load_dword v151, v209, s[16:19], s24 offen offset:3072
    s_add_u32 s24, s24, 4096
    buffer_load_dword v152, v209, s[16:19], s24 offen offset:0
    buffer_load_dword v153, v209, s[16:19], s24 offen offset:1024
    s_mov_b32 s20, s4
    s_and_b32 s21, s5, 0xffff
    s_mov_b32 s22, 1024
    s_mov_b32 s23, 0x00020000
    s_mov_b32 s36, s6
    s_and_b32 s37, s7, 0xffff
    s_mov_b32 s38, 1024
    s_mov_b32 s39, 0x00020000
    v_lshlrev_b32 v210, 4, v201
    s_lshl_b32 s25, s13, 8
    buffer_load_dwordx4 v[160:163], v210, s[20:23], s25 offen
    buffer_load_dwordx4 v[164:167], v210, s[36:39], s25 offen
    s_waitcnt vmcnt(2)
    v_add_f32 v112, v112, v113
    v_add_f32 v114, v114, v115
    v_add_f32 v116, v116, v117
    v_add_f32 v118, v118, v119
    v_add_f32 v120, v120, v121
    v_add_f32 v122, v122, v123
    v_add_f32 v124, v124, v125
    v_add_f32 v126, v126, v127
    v_add_f32 v128, v128, v129
    v_add_f32 v130, v130, v131
    v_add_f32 v132, v132, v133
    v_add_f32 v134, v134, v135
    v_add_f32 v136, v136, v137
    v_add_f32 v138, v138, v139
    v_add_f32 v140, v140, v141
    v_add_f32 v142, v142, v143
    v_add_f32 v144, v144, v145
    v_add_f32 v146, v146, v147
    v_add_f32 v148, v148, v149
    v_add_f32 v150, v150, v151
    v_add_f32 v152, v152, v153
    v_add_f32 v112, v112, v114
    v_add_f32 v116, v116, v118
    v_add_f32 v120, v120, v122
    v_add_f32 v124, v124, v126
    v_add_f32 v128, v128, v130
    v_add_f32 v132, v132, v134
    v_add_f32 v136, v136, v138
    v_add_f32 v140, v140, v142
    v_add_f32 v144, v144, v146
    v_add_f32 v148, v148, v150
    v_add_f32 v112, v112, v116
    v_add_f32 v120, v120, v124
    v_add_f32 v128, v128, v132
    v_add_f32 v136, v136, v140
    v_add_f32 v144, v144, v148
    v_add_f32 v112, v112, v120
    v_add_f32 v128, v128, v136
    v_add_f32 v144, v144, v152
    v_add_f32 v112, v112, v128
    v_add_f32 v112, v112, v144
    ds_write_b32 v209, v112 offset:8192
    s_waitcnt lgkmcnt(0)
    s_barrier
    v_lshlrev_b32 v207, 4, v200
    ds_read_b128 v[64:67], v207 offset:0
    ds_read_b128 v[68:71], v207 offset:1024
    ds_read_b128 v[72:75], v207 offset:2048
    ds_read_b128 v[76:79], v207 offset:3072
    ds_read_b128 v[80:83], v207 offset:4096
    ds_read_b128 v[84:87], v207 offset:5120
    v_lshlrev_b32 v210, 5, v201
    ds_read_b128 v[168:171], v210 offset:8192
    ds_read_b128 v[172:175], v210 offset:8208
    ds_read_b128 v[176:179], v210 offset:8704
    ds_read_b128 v[180:183], v210 offset:8720
    s_cmp_ge_u32 s14, 167
    s_cbranch_scc1 L_k5_end
    s_waitcnt vmcnt(0) lgkmcnt(0)
    s_mov_b32 s24, 0x39035177
    s_mov_b32 s25, 0x3727c5ac
    v_mul_f32 v168, s24, v168
    v_mul_f32 v176, s24, v176
    v_fma_f32 v176, -v168, v168, v176
    v_max_f32 v176, 0, v176
    v_add_f32 v176, s25, v176
    v_rsq_f32 v176, v176
    v_lshlrev_b32 v212, 16, v160
    v_lshlrev_b32 v220, 16, v164
    v_mul_f32 v212, v212, v176
    v_fma_f32 v220, -v168, v212, v220
    v_mul_f32 v169, s24, v169
    v_mul_f32 v177, s24, v177
    v_fma_f32 v177, -v169, v169, v177
    v_max_f32 v177, 0, v177
    v_add_f32 v177, s25, v177
    v_rsq_f32 v177, v177
    v_and_b32 v213, 0xffff0000, v160
    v_and_b32 v221, 0xffff0000, v164
    v_mul_f32 v213, v213, v177
    v_fma_f32 v221, -v169, v213, v221
    v_mul_f32 v170, s24, v170
    v_mul_f32 v178, s24, v178
    v_fma_f32 v178, -v170, v170, v178
    v_max_f32 v178, 0, v178
    v_add_f32 v178, s25, v178
    v_rsq_f32 v178, v178
    v_lshlrev_b32 v214, 16, v161
    v_lshlrev_b32 v222, 16, v165
    v_mul_f32 v214, v214, v178
    v_fma_f32 v222, -v170, v214, v222
    v_mul_f32 v171, s24, v171
    v_mul_f32 v179, s24, v179
    v_fma_f32 v179, -v171, v171, v179
    v_max_f32 v179, 0, v179
    v_add_f32 v179, s25, v179
    v_rsq_f32 v179, v179
    v_and_b32 v215, 0xffff0000, v161
    v_and_b32 v223, 0xffff0000, v165
    v_mul_f32 v215, v215, v179
    v_fma_f32 v223, -v171, v215, v223
    v_mul_f32 v172, s24, v172
    v_mul_f32 v180, s24, v180
    v_fma_f32 v180, -v172, v172, v180
    v_max_f32 v180, 0, v180
    v_add_f32 v180, s25, v180
    v_rsq_f32 v180, v180
    v_lshlrev_b32 v216, 16, v162
    v_lshlrev_b32 v224, 16, v166
    v_mul_f32 v216, v216, v180
    v_fma_f32 v224, -v172, v216, v224
    v_mul_f32 v173, s24, v173
    v_mul_f32 v181, s24, v181
    v_fma_f32 v181, -v173, v173, v181
    v_max_f32 v181, 0, v181
    v_add_f32 v181, s25, v181
    v_rsq_f32 v181, v181
    v_and_b32 v217, 0xffff0000, v162
    v_and_b32 v225, 0xffff0000, v166
    v_mul_f32 v217, v217, v181
    v_fma_f32 v225, -v173, v217, v225
    v_mul_f32 v174, s24, v174
    v_mul_f32 v182, s24, v182
    v_fma_f32 v182, -v174, v174, v182
    v_max_f32 v182, 0, v182
    v_add_f32 v182, s25, v182
    v_rsq_f32 v182, v182
    v_lshlrev_b32 v218, 16, v163
    v_lshlrev_b32 v226, 16, v167
    v_mul_f32 v218, v218, v182
    v_fma_f32 v226, -v174, v218, v226
    v_mul_f32 v175, s24, v175
    v_mul_f32 v183, s24, v183
    v_fma_f32 v183, -v175, v175, v183
    v_max_f32 v183, 0, v183
    v_add_f32 v183, s25, v183
    v_rsq_f32 v183, v183
    v_and_b32 v219, 0xffff0000, v163
    v_and_b32 v227, 0xffff0000, v167
    v_mul_f32 v219, v219, v183
    v_fma_f32 v227, -v175, v219, v227
    v_perm_b32 v88, v4, v0, s30
    v_perm_b32 v89, v12, v8, s30
    v_perm_b32 v90, v20, v16, s30
    v_perm_b32 v91, v28, v24, s30
    v_perm_b32 v92, v4, v0, s31
    v_perm_b32 v93, v12, v8, s31
    v_perm_b32 v94, v20, v16, s31
    v_perm_b32 v95, v28, v24, s31
    v_perm_b32 v96, v36, v32, s30
    v_perm_b32 v97, v44, v40, s30
    v_perm_b32 v98, v52, v48, s30
    v_perm_b32 v99, v60, v56, s30
    v_perm_b32 v100, v36, v32, s31
    v_perm_b32 v101, v44, v40, s31
    v_perm_b32 v102, v52, v48, s31
    v_perm_b32 v103, v60, v56, s31
    v_mfma_f32_16x16x32_bf16 v[104:107], v[64:67], v[88:91], 0
    v_mfma_f32_16x16x32_bf16 v[108:111], v[64:67], v[92:95], 0
    v_mfma_f32_16x16x32_bf16 v[136:139], v[72:75], v[88:91], 0
    v_mfma_f32_16x16x32_bf16 v[140:143], v[72:75], v[92:95], 0
    v_mfma_f32_16x16x32_bf16 v[168:171], v[80:83], v[88:91], 0
    v_mfma_f32_16x16x32_bf16 v[172:175], v[80:83], v[92:95], 0
    v_mfma_f32_16x16x32_bf16 v[104:107], v[68:71], v[96:99], v[104:107]
    v_mfma_f32_16x16x32_bf16 v[108:111], v[68:71], v[100:103], v[108:111]
    v_mfma_f32_16x16x32_bf16 v[136:139], v[76:79], v[96:99], v[136:139]
    v_mfma_f32_16x16x32_bf16 v[140:143], v[76:79], v[100:103], v[140:143]
    v_mfma_f32_16x16x32_bf16 v[168:171], v[84:87], v[96:99], v[168:171]
    v_mfma_f32_16x16x32_bf16 v[172:175], v[84:87], v[100:103], v[172:175]
    v_perm_b32 v88, v5, v1, s30
    v_perm_b32 v89, v13, v9, s30
    v_perm_b32 v90, v21, v17, s30
    v_perm_b32 v91, v29, v25, s30
    v_perm_b32 v92, v5, v1, s31
    v_perm_b32 v93, v13, v9, s31
    v_perm_b32 v94, v21, v17, s31
    v_perm_b32 v95, v29, v25, s31
    v_perm_b32 v96, v37, v33, s30
    v_perm_b32 v97, v45, v41, s30
    v_perm_b32 v98, v53, v49, s30
    v_perm_b32 v99, v61, v57, s30
    v_perm_b32 v100, v37, v33, s31
    v_perm_b32 v101, v45, v41, s31
    v_perm_b32 v102, v53, v49, s31
    v_perm_b32 v103, v61, v57, s31
    v_mfma_f32_16x16x32_bf16 v[112:115], v[64:67], v[88:91], 0
    v_mfma_f32_16x16x32_bf16 v[116:119], v[64:67], v[92:95], 0
    v_mfma_f32_16x16x32_bf16 v[144:147], v[72:75], v[88:91], 0
    v_mfma_f32_16x16x32_bf16 v[148:151], v[72:75], v[92:95], 0
    v_mfma_f32_16x16x32_bf16 v[176:179], v[80:83], v[88:91], 0
    v_mfma_f32_16x16x32_bf16 v[180:183], v[80:83], v[92:95], 0
    v_mfma_f32_16x16x32_bf16 v[112:115], v[68:71], v[96:99], v[112:115]
    v_mfma_f32_16x16x32_bf16 v[116:119], v[68:71], v[100:103], v[116:119]
    v_mfma_f32_16x16x32_bf16 v[144:147], v[76:79], v[96:99], v[144:147]
    v_mfma_f32_16x16x32_bf16 v[148:151], v[76:79], v[100:103], v[148:151]
    v_mfma_f32_16x16x32_bf16 v[176:179], v[84:87], v[96:99], v[176:179]
    v_mfma_f32_16x16x32_bf16 v[180:183], v[84:87], v[100:103], v[180:183]
    v_perm_b32 v88, v6, v2, s30
    v_perm_b32 v89, v14, v10, s30
    v_perm_b32 v90, v22, v18, s30
    v_perm_b32 v91, v30, v26, s30
    v_perm_b32 v92, v6, v2, s31
    v_perm_b32 v93, v14, v10, s31
    v_perm_b32 v94, v22, v18, s31
    v_perm_b32 v95, v30, v26, s31
    v_perm_b32 v96, v38, v34, s30
    v_perm_b32 v97, v46, v42, s30
    v_perm_b32 v98, v54, v50, s30
    v_perm_b32 v99, v62, v58, s30
    v_perm_b32 v100, v38, v34, s31
    v_perm_b32 v101, v46, v42, s31
    v_perm_b32 v102, v54, v50, s31
    v_perm_b32 v103, v62, v58, s31
    v_mfma_f32_16x16x32_bf16 v[120:123], v[64:67], v[88:91], 0
    v_mfma_f32_16x16x32_bf16 v[124:127], v[64:67], v[92:95], 0
    v_mfma_f32_16x16x32_bf16 v[152:155], v[72:75], v[88:91], 0
    v_mfma_f32_16x16x32_bf16 v[156:159], v[72:75], v[92:95], 0
    v_mfma_f32_16x16x32_bf16 v[184:187], v[80:83], v[88:91], 0
    v_mfma_f32_16x16x32_bf16 v[188:191], v[80:83], v[92:95], 0
    v_mfma_f32_16x16x32_bf16 v[120:123], v[68:71], v[96:99], v[120:123]
    v_mfma_f32_16x16x32_bf16 v[124:127], v[68:71], v[100:103], v[124:127]
    v_mfma_f32_16x16x32_bf16 v[152:155], v[76:79], v[96:99], v[152:155]
    v_mfma_f32_16x16x32_bf16 v[156:159], v[76:79], v[100:103], v[156:159]
    v_mfma_f32_16x16x32_bf16 v[184:187], v[84:87], v[96:99], v[184:187]
    v_mfma_f32_16x16x32_bf16 v[188:191], v[84:87], v[100:103], v[188:191]
    v_perm_b32 v88, v7, v3, s30
    v_perm_b32 v89, v15, v11, s30
    v_perm_b32 v90, v23, v19, s30
    v_perm_b32 v91, v31, v27, s30
    v_perm_b32 v92, v7, v3, s31
    v_perm_b32 v93, v15, v11, s31
    v_perm_b32 v94, v23, v19, s31
    v_perm_b32 v95, v31, v27, s31
    v_perm_b32 v96, v39, v35, s30
    v_perm_b32 v97, v47, v43, s30
    v_perm_b32 v98, v55, v51, s30
    v_perm_b32 v99, v63, v59, s30
    v_perm_b32 v100, v39, v35, s31
    v_perm_b32 v101, v47, v43, s31
    v_perm_b32 v102, v55, v51, s31
    v_perm_b32 v103, v63, v59, s31
    v_mfma_f32_16x16x32_bf16 v[128:131], v[64:67], v[88:91], 0
    v_mfma_f32_16x16x32_bf16 v[132:135], v[64:67], v[92:95], 0
    v_mfma_f32_16x16x32_bf16 v[160:163], v[72:75], v[88:91], 0
    v_mfma_f32_16x16x32_bf16 v[164:167], v[72:75], v[92:95], 0
    v_mfma_f32_16x16x32_bf16 v[192:195], v[80:83], v[88:91], 0
    v_mfma_f32_16x16x32_bf16 v[196:199], v[80:83], v[92:95], 0
    v_mfma_f32_16x16x32_bf16 v[128:131], v[68:71], v[96:99], v[128:131]
    v_mfma_f32_16x16x32_bf16 v[132:135], v[68:71], v[100:103], v[132:135]
    v_mfma_f32_16x16x32_bf16 v[160:163], v[76:79], v[96:99], v[160:163]
    v_mfma_f32_16x16x32_bf16 v[164:167], v[76:79], v[100:103], v[164:167]
    v_mfma_f32_16x16x32_bf16 v[192:195], v[84:87], v[96:99], v[192:195]
    v_mfma_f32_16x16x32_bf16 v[196:199], v[84:87], v[100:103], v[196:199]
    s_nop 7
    s_mul_i32 s24, s11, 8176640
    s_add_u32 s28, s28, s24
    s_addc_u32 s29, s29, 0
    s_mov_b32 s32, s28
    s_and_b32 s33, s29, 0xffff
    s_mov_b32 s34, 8176640
    s_mov_b32 s35, 0x00020000
    s_mul_i32 s24, s14, 49152
    s_lshl_b32 s25, s13, 8
    s_add_u32 s24, s24, s25
    v_lshlrev_b32 v210, 12, v202
    v_lshl_add_u32 v210, v201, 4, v210
    v_add_u32 v210, s24, v210
    s_mov_b32 s26, 0xbdd2d3e8
    v_mov_b32 v211, 0xc0135761
    v_fma_f32 v104, v104, v212, v220
    v_fma_f32 v108, v108, v213, v221
    v_fma_f32 v112, v112, v214, v222
    v_fma_f32 v116, v116, v215, v223
    v_fma_f32 v120, v120, v216, v224
    v_fma_f32 v124, v124, v217, v225
    v_fma_f32 v128, v128, v218, v226
    v_fma_f32 v132, v132, v219, v227
    v_mul_f32 v0, v104, v104
    v_mul_f32 v1, v108, v108
    v_mul_f32 v2, v112, v112
    v_mul_f32 v3, v116, v116
    v_mul_f32 v4, v120, v120
    v_mul_f32 v5, v124, v124
    v_mul_f32 v6, v128, v128
    v_mul_f32 v7, v132, v132
    v_fma_f32 v0, v0, s26, v211
    v_fma_f32 v1, v1, s26, v211
    v_fma_f32 v2, v2, s26, v211
    v_fma_f32 v3, v3, s26, v211
    v_fma_f32 v4, v4, s26, v211
    v_fma_f32 v5, v5, s26, v211
    v_fma_f32 v6, v6, s26, v211
    v_fma_f32 v7, v7, s26, v211
    v_mul_f32 v0, v0, v104
    v_mul_f32 v1, v1, v108
    v_mul_f32 v2, v2, v112
    v_mul_f32 v3, v3, v116
    v_mul_f32 v4, v4, v120
    v_mul_f32 v5, v5, v124
    v_mul_f32 v6, v6, v128
    v_mul_f32 v7, v7, v132
    v_exp_f32 v0, v0
    v_exp_f32 v1, v1
    v_exp_f32 v2, v2
    v_exp_f32 v3, v3
    v_exp_f32 v4, v4
    v_exp_f32 v5, v5
    v_exp_f32 v6, v6
    v_exp_f32 v7, v7
    v_add_f32 v0, 1.0, v0
    v_add_f32 v1, 1.0, v1
    v_add_f32 v2, 1.0, v2
    v_add_f32 v3, 1.0, v3
    v_add_f32 v4, 1.0, v4
    v_add_f32 v5, 1.0, v5
    v_add_f32 v6, 1.0, v6
    v_add_f32 v7, 1.0, v7
    v_rcp_f32 v0, v0
    v_rcp_f32 v1, v1
    v_rcp_f32 v2, v2
    v_rcp_f32 v3, v3
    v_rcp_f32 v4, v4
    v_rcp_f32 v5, v5
    v_rcp_f32 v6, v6
    v_rcp_f32 v7, v7
    v_mul_f32 v0, v0, v104
    v_mul_f32 v1, v1, v108
    v_mul_f32 v2, v2, v112
    v_mul_f32 v3, v3, v116
    v_mul_f32 v4, v4, v120
    v_mul_f32 v5, v5, v124
    v_mul_f32 v6, v6, v128
    v_mul_f32 v7, v7, v132
    v_cvt_pk_bf16_f32 v16, v0, v1
    v_cvt_pk_bf16_f32 v17, v2, v3
    v_cvt_pk_bf16_f32 v18, v4, v5
    v_cvt_pk_bf16_f32 v19, v6, v7
    v_add_u32 v212, 0, v210
    buffer_store_dwordx4 v[16:19], v212, s[32:35], 0 offen
    v_fma_f32 v105, v105, v212, v220
    v_fma_f32 v109, v109, v213, v221
    v_fma_f32 v113, v113, v214, v222
    v_fma_f32 v117, v117, v215, v223
    v_fma_f32 v121, v121, v216, v224
    v_fma_f32 v125, v125, v217, v225
    v_fma_f32 v129, v129, v218, v226
    v_fma_f32 v133, v133, v219, v227
    v_mul_f32 v0, v105, v105
    v_mul_f32 v1, v109, v109
    v_mul_f32 v2, v113, v113
    v_mul_f32 v3, v117, v117
    v_mul_f32 v4, v121, v121
    v_mul_f32 v5, v125, v125
    v_mul_f32 v6, v129, v129
    v_mul_f32 v7, v133, v133
    v_fma_f32 v0, v0, s26, v211
    v_fma_f32 v1, v1, s26, v211
    v_fma_f32 v2, v2, s26, v211
    v_fma_f32 v3, v3, s26, v211
    v_fma_f32 v4, v4, s26, v211
    v_fma_f32 v5, v5, s26, v211
    v_fma_f32 v6, v6, s26, v211
    v_fma_f32 v7, v7, s26, v211
    v_mul_f32 v0, v0, v105
    v_mul_f32 v1, v1, v109
    v_mul_f32 v2, v2, v113
    v_mul_f32 v3, v3, v117
    v_mul_f32 v4, v4, v121
    v_mul_f32 v5, v5, v125
    v_mul_f32 v6, v6, v129
    v_mul_f32 v7, v7, v133
    v_exp_f32 v0, v0
    v_exp_f32 v1, v1
    v_exp_f32 v2, v2
    v_exp_f32 v3, v3
    v_exp_f32 v4, v4
    v_exp_f32 v5, v5
    v_exp_f32 v6, v6
    v_exp_f32 v7, v7
    v_add_f32 v0, 1.0, v0
    v_add_f32 v1, 1.0, v1
    v_add_f32 v2, 1.0, v2
    v_add_f32 v3, 1.0, v3
    v_add_f32 v4, 1.0, v4
    v_add_f32 v5, 1.0, v5
    v_add_f32 v6, 1.0, v6
    v_add_f32 v7, 1.0, v7
    v_rcp_f32 v0, v0
    v_rcp_f32 v1, v1
    v_rcp_f32 v2, v2
    v_rcp_f32 v3, v3
    v_rcp_f32 v4, v4
    v_rcp_f32 v5, v5
    v_rcp_f32 v6, v6
    v_rcp_f32 v7, v7
    v_mul_f32 v0, v0, v105
    v_mul_f32 v1, v1, v109
    v_mul_f32 v2, v2, v113
    v_mul_f32 v3, v3, v117
    v_mul_f32 v4, v4, v121
    v_mul_f32 v5, v5, v125
    v_mul_f32 v6, v6, v129
    v_mul_f32 v7, v7, v133
    v_cvt_pk_bf16_f32 v20, v0, v1
    v_cvt_pk_bf16_f32 v21, v2, v3
    v_cvt_pk_bf16_f32 v22, v4, v5
    v_cvt_pk_bf16_f32 v23, v6, v7
    v_add_u32 v212, 1024, v210
    buffer_store_dwordx4 v[20:23], v212, s[32:35], 0 offen
    v_fma_f32 v106, v106, v212, v220
    v_fma_f32 v110, v110, v213, v221
    v_fma_f32 v114, v114, v214, v222
    v_fma_f32 v118, v118, v215, v223
    v_fma_f32 v122, v122, v216, v224
    v_fma_f32 v126, v126, v217, v225
    v_fma_f32 v130, v130, v218, v226
    v_fma_f32 v134, v134, v219, v227
    v_mul_f32 v0, v106, v106
    v_mul_f32 v1, v110, v110
    v_mul_f32 v2, v114, v114
    v_mul_f32 v3, v118, v118
    v_mul_f32 v4, v122, v122
    v_mul_f32 v5, v126, v126
    v_mul_f32 v6, v130, v130
    v_mul_f32 v7, v134, v134
    v_fma_f32 v0, v0, s26, v211
    v_fma_f32 v1, v1, s26, v211
    v_fma_f32 v2, v2, s26, v211
    v_fma_f32 v3, v3, s26, v211
    v_fma_f32 v4, v4, s26, v211
    v_fma_f32 v5, v5, s26, v211
    v_fma_f32 v6, v6, s26, v211
    v_fma_f32 v7, v7, s26, v211
    v_mul_f32 v0, v0, v106
    v_mul_f32 v1, v1, v110
    v_mul_f32 v2, v2, v114
    v_mul_f32 v3, v3, v118
    v_mul_f32 v4, v4, v122
    v_mul_f32 v5, v5, v126
    v_mul_f32 v6, v6, v130
    v_mul_f32 v7, v7, v134
    v_exp_f32 v0, v0
    v_exp_f32 v1, v1
    v_exp_f32 v2, v2
    v_exp_f32 v3, v3
    v_exp_f32 v4, v4
    v_exp_f32 v5, v5
    v_exp_f32 v6, v6
    v_exp_f32 v7, v7
    v_add_f32 v0, 1.0, v0
    v_add_f32 v1, 1.0, v1
    v_add_f32 v2, 1.0, v2
    v_add_f32 v3, 1.0, v3
    v_add_f32 v4, 1.0, v4
    v_add_f32 v5, 1.0, v5
    v_add_f32 v6, 1.0, v6
    v_add_f32 v7, 1.0, v7
    v_rcp_f32 v0, v0
    v_rcp_f32 v1, v1
    v_rcp_f32 v2, v2
    v_rcp_f32 v3, v3
    v_rcp_f32 v4, v4
    v_rcp_f32 v5, v5
    v_rcp_f32 v6, v6
    v_rcp_f32 v7, v7
    v_mul_f32 v0, v0, v106
    v_mul_f32 v1, v1, v110
    v_mul_f32 v2, v2, v114
    v_mul_f32 v3, v3, v118
    v_mul_f32 v4, v4, v122
    v_mul_f32 v5, v5, v126
    v_mul_f32 v6, v6, v130
    v_mul_f32 v7, v7, v134
    v_cvt_pk_bf16_f32 v24, v0, v1
    v_cvt_pk_bf16_f32 v25, v2, v3
    v_cvt_pk_bf16_f32 v26, v4, v5
    v_cvt_pk_bf16_f32 v27, v6, v7
    v_add_u32 v212, 2048, v210
    buffer_store_dwordx4 v[24:27], v212, s[32:35], 0 offen
    v_fma_f32 v107, v107, v212, v220
    v_fma_f32 v111, v111, v213, v221
    v_fma_f32 v115, v115, v214, v222
    v_fma_f32 v119, v119, v215, v223
    v_fma_f32 v123, v123, v216, v224
    v_fma_f32 v127, v127, v217, v225
    v_fma_f32 v131, v131, v218, v226
    v_fma_f32 v135, v135, v219, v227
    v_mul_f32 v0, v107, v107
    v_mul_f32 v1, v111, v111
    v_mul_f32 v2, v115, v115
    v_mul_f32 v3, v119, v119
    v_mul_f32 v4, v123, v123
    v_mul_f32 v5, v127, v127
    v_mul_f32 v6, v131, v131
    v_mul_f32 v7, v135, v135
    v_fma_f32 v0, v0, s26, v211
    v_fma_f32 v1, v1, s26, v211
    v_fma_f32 v2, v2, s26, v211
    v_fma_f32 v3, v3, s26, v211
    v_fma_f32 v4, v4, s26, v211
    v_fma_f32 v5, v5, s26, v211
    v_fma_f32 v6, v6, s26, v211
    v_fma_f32 v7, v7, s26, v211
    v_mul_f32 v0, v0, v107
    v_mul_f32 v1, v1, v111
    v_mul_f32 v2, v2, v115
    v_mul_f32 v3, v3, v119
    v_mul_f32 v4, v4, v123
    v_mul_f32 v5, v5, v127
    v_mul_f32 v6, v6, v131
    v_mul_f32 v7, v7, v135
    v_exp_f32 v0, v0
    v_exp_f32 v1, v1
    v_exp_f32 v2, v2
    v_exp_f32 v3, v3
    v_exp_f32 v4, v4
    v_exp_f32 v5, v5
    v_exp_f32 v6, v6
    v_exp_f32 v7, v7
    v_add_f32 v0, 1.0, v0
    v_add_f32 v1, 1.0, v1
    v_add_f32 v2, 1.0, v2
    v_add_f32 v3, 1.0, v3
    v_add_f32 v4, 1.0, v4
    v_add_f32 v5, 1.0, v5
    v_add_f32 v6, 1.0, v6
    v_add_f32 v7, 1.0, v7
    v_rcp_f32 v0, v0
    v_rcp_f32 v1, v1
    v_rcp_f32 v2, v2
    v_rcp_f32 v3, v3
    v_rcp_f32 v4, v4
    v_rcp_f32 v5, v5
    v_rcp_f32 v6, v6
    v_rcp_f32 v7, v7
    v_mul_f32 v0, v0, v107
    v_mul_f32 v1, v1, v111
    v_mul_f32 v2, v2, v115
    v_mul_f32 v3, v3, v119
    v_mul_f32 v4, v4, v123
    v_mul_f32 v5, v5, v127
    v_mul_f32 v6, v6, v131
    v_mul_f32 v7, v7, v135
    v_cvt_pk_bf16_f32 v28, v0, v1
    v_cvt_pk_bf16_f32 v29, v2, v3
    v_cvt_pk_bf16_f32 v30, v4, v5
    v_cvt_pk_bf16_f32 v31, v6, v7
    v_add_u32 v212, 3072, v210
    buffer_store_dwordx4 v[28:31], v212, s[32:35], 0 offen
    v_fma_f32 v136, v136, v212, v220
    v_fma_f32 v140, v140, v213, v221
    v_fma_f32 v144, v144, v214, v222
    v_fma_f32 v148, v148, v215, v223
    v_fma_f32 v152, v152, v216, v224
    v_fma_f32 v156, v156, v217, v225
    v_fma_f32 v160, v160, v218, v226
    v_fma_f32 v164, v164, v219, v227
    v_mul_f32 v0, v136, v136
    v_mul_f32 v1, v140, v140
    v_mul_f32 v2, v144, v144
    v_mul_f32 v3, v148, v148
    v_mul_f32 v4, v152, v152
    v_mul_f32 v5, v156, v156
    v_mul_f32 v6, v160, v160
    v_mul_f32 v7, v164, v164
    v_fma_f32 v0, v0, s26, v211
    v_fma_f32 v1, v1, s26, v211
    v_fma_f32 v2, v2, s26, v211
    v_fma_f32 v3, v3, s26, v211
    v_fma_f32 v4, v4, s26, v211
    v_fma_f32 v5, v5, s26, v211
    v_fma_f32 v6, v6, s26, v211
    v_fma_f32 v7, v7, s26, v211
    v_mul_f32 v0, v0, v136
    v_mul_f32 v1, v1, v140
    v_mul_f32 v2, v2, v144
    v_mul_f32 v3, v3, v148
    v_mul_f32 v4, v4, v152
    v_mul_f32 v5, v5, v156
    v_mul_f32 v6, v6, v160
    v_mul_f32 v7, v7, v164
    v_exp_f32 v0, v0
    v_exp_f32 v1, v1
    v_exp_f32 v2, v2
    v_exp_f32 v3, v3
    v_exp_f32 v4, v4
    v_exp_f32 v5, v5
    v_exp_f32 v6, v6
    v_exp_f32 v7, v7
    v_add_f32 v0, 1.0, v0
    v_add_f32 v1, 1.0, v1
    v_add_f32 v2, 1.0, v2
    v_add_f32 v3, 1.0, v3
    v_add_f32 v4, 1.0, v4
    v_add_f32 v5, 1.0, v5
    v_add_f32 v6, 1.0, v6
    v_add_f32 v7, 1.0, v7
    v_rcp_f32 v0, v0
    v_rcp_f32 v1, v1
    v_rcp_f32 v2, v2
    v_rcp_f32 v3, v3
    v_rcp_f32 v4, v4
    v_rcp_f32 v5, v5
    v_rcp_f32 v6, v6
    v_rcp_f32 v7, v7
    v_mul_f32 v0, v0, v136
    v_mul_f32 v1, v1, v140
    v_mul_f32 v2, v2, v144
    v_mul_f32 v3, v3, v148
    v_mul_f32 v4, v4, v152
    v_mul_f32 v5, v5, v156
    v_mul_f32 v6, v6, v160
    v_mul_f32 v7, v7, v164
    v_cvt_pk_bf16_f32 v32, v0, v1
    v_cvt_pk_bf16_f32 v33, v2, v3
    v_cvt_pk_bf16_f32 v34, v4, v5
    v_cvt_pk_bf16_f32 v35, v6, v7
    v_add_u32 v212, 16384, v210
    buffer_store_dwordx4 v[32:35], v212, s[32:35], 0 offen
    v_fma_f32 v137, v137, v212, v220
    v_fma_f32 v141, v141, v213, v221
    v_fma_f32 v145, v145, v214, v222
    v_fma_f32 v149, v149, v215, v223
    v_fma_f32 v153, v153, v216, v224
    v_fma_f32 v157, v157, v217, v225
    v_fma_f32 v161, v161, v218, v226
    v_fma_f32 v165, v165, v219, v227
    v_mul_f32 v0, v137, v137
    v_mul_f32 v1, v141, v141
    v_mul_f32 v2, v145, v145
    v_mul_f32 v3, v149, v149
    v_mul_f32 v4, v153, v153
    v_mul_f32 v5, v157, v157
    v_mul_f32 v6, v161, v161
    v_mul_f32 v7, v165, v165
    v_fma_f32 v0, v0, s26, v211
    v_fma_f32 v1, v1, s26, v211
    v_fma_f32 v2, v2, s26, v211
    v_fma_f32 v3, v3, s26, v211
    v_fma_f32 v4, v4, s26, v211
    v_fma_f32 v5, v5, s26, v211
    v_fma_f32 v6, v6, s26, v211
    v_fma_f32 v7, v7, s26, v211
    v_mul_f32 v0, v0, v137
    v_mul_f32 v1, v1, v141
    v_mul_f32 v2, v2, v145
    v_mul_f32 v3, v3, v149
    v_mul_f32 v4, v4, v153
    v_mul_f32 v5, v5, v157
    v_mul_f32 v6, v6, v161
    v_mul_f32 v7, v7, v165
    v_exp_f32 v0, v0
    v_exp_f32 v1, v1
    v_exp_f32 v2, v2
    v_exp_f32 v3, v3
    v_exp_f32 v4, v4
    v_exp_f32 v5, v5
    v_exp_f32 v6, v6
    v_exp_f32 v7, v7
    v_add_f32 v0, 1.0, v0
    v_add_f32 v1, 1.0, v1
    v_add_f32 v2, 1.0, v2
    v_add_f32 v3, 1.0, v3
    v_add_f32 v4, 1.0, v4
    v_add_f32 v5, 1.0, v5
    v_add_f32 v6, 1.0, v6
    v_add_f32 v7, 1.0, v7
    v_rcp_f32 v0, v0
    v_rcp_f32 v1, v1
    v_rcp_f32 v2, v2
    v_rcp_f32 v3, v3
    v_rcp_f32 v4, v4
    v_rcp_f32 v5, v5
    v_rcp_f32 v6, v6
    v_rcp_f32 v7, v7
    v_mul_f32 v0, v0, v137
    v_mul_f32 v1, v1, v141
    v_mul_f32 v2, v2, v145
    v_mul_f32 v3, v3, v149
    v_mul_f32 v4, v4, v153
    v_mul_f32 v5, v5, v157
    v_mul_f32 v6, v6, v161
    v_mul_f32 v7, v7, v165
    v_cvt_pk_bf16_f32 v36, v0, v1
    v_cvt_pk_bf16_f32 v37, v2, v3
    v_cvt_pk_bf16_f32 v38, v4, v5
    v_cvt_pk_bf16_f32 v39, v6, v7
    v_add_u32 v212, 17408, v210
    buffer_store_dwordx4 v[36:39], v212, s[32:35], 0 offen
    v_fma_f32 v138, v138, v212, v220
    v_fma_f32 v142, v142, v213, v221
    v_fma_f32 v146, v146, v214, v222
    v_fma_f32 v150, v150, v215, v223
    v_fma_f32 v154, v154, v216, v224
    v_fma_f32 v158, v158, v217, v225
    v_fma_f32 v162, v162, v218, v226
    v_fma_f32 v166, v166, v219, v227
    v_mul_f32 v0, v138, v138
    v_mul_f32 v1, v142, v142
    v_mul_f32 v2, v146, v146
    v_mul_f32 v3, v150, v150
    v_mul_f32 v4, v154, v154
    v_mul_f32 v5, v158, v158
    v_mul_f32 v6, v162, v162
    v_mul_f32 v7, v166, v166
    v_fma_f32 v0, v0, s26, v211
    v_fma_f32 v1, v1, s26, v211
    v_fma_f32 v2, v2, s26, v211
    v_fma_f32 v3, v3, s26, v211
    v_fma_f32 v4, v4, s26, v211
    v_fma_f32 v5, v5, s26, v211
    v_fma_f32 v6, v6, s26, v211
    v_fma_f32 v7, v7, s26, v211
    v_mul_f32 v0, v0, v138
    v_mul_f32 v1, v1, v142
    v_mul_f32 v2, v2, v146
    v_mul_f32 v3, v3, v150
    v_mul_f32 v4, v4, v154
    v_mul_f32 v5, v5, v158
    v_mul_f32 v6, v6, v162
    v_mul_f32 v7, v7, v166
    v_exp_f32 v0, v0
    v_exp_f32 v1, v1
    v_exp_f32 v2, v2
    v_exp_f32 v3, v3
    v_exp_f32 v4, v4
    v_exp_f32 v5, v5
    v_exp_f32 v6, v6
    v_exp_f32 v7, v7
    v_add_f32 v0, 1.0, v0
    v_add_f32 v1, 1.0, v1
    v_add_f32 v2, 1.0, v2
    v_add_f32 v3, 1.0, v3
    v_add_f32 v4, 1.0, v4
    v_add_f32 v5, 1.0, v5
    v_add_f32 v6, 1.0, v6
    v_add_f32 v7, 1.0, v7
    v_rcp_f32 v0, v0
    v_rcp_f32 v1, v1
    v_rcp_f32 v2, v2
    v_rcp_f32 v3, v3
    v_rcp_f32 v4, v4
    v_rcp_f32 v5, v5
    v_rcp_f32 v6, v6
    v_rcp_f32 v7, v7
    v_mul_f32 v0, v0, v138
    v_mul_f32 v1, v1, v142
    v_mul_f32 v2, v2, v146
    v_mul_f32 v3, v3, v150
    v_mul_f32 v4, v4, v154
    v_mul_f32 v5, v5, v158
    v_mul_f32 v6, v6, v162
    v_mul_f32 v7, v7, v166
    v_cvt_pk_bf16_f32 v40, v0, v1
    v_cvt_pk_bf16_f32 v41, v2, v3
    v_cvt_pk_bf16_f32 v42, v4, v5
    v_cvt_pk_bf16_f32 v43, v6, v7
    v_add_u32 v212, 18432, v210
    buffer_store_dwordx4 v[40:43], v212, s[32:35], 0 offen
    v_fma_f32 v139, v139, v212, v220
    v_fma_f32 v143, v143, v213, v221
    v_fma_f32 v147, v147, v214, v222
    v_fma_f32 v151, v151, v215, v223
    v_fma_f32 v155, v155, v216, v224
    v_fma_f32 v159, v159, v217, v225
    v_fma_f32 v163, v163, v218, v226
    v_fma_f32 v167, v167, v219, v227
    v_mul_f32 v0, v139, v139
    v_mul_f32 v1, v143, v143
    v_mul_f32 v2, v147, v147
    v_mul_f32 v3, v151, v151
    v_mul_f32 v4, v155, v155
    v_mul_f32 v5, v159, v159
    v_mul_f32 v6, v163, v163
    v_mul_f32 v7, v167, v167
    v_fma_f32 v0, v0, s26, v211
    v_fma_f32 v1, v1, s26, v211
    v_fma_f32 v2, v2, s26, v211
    v_fma_f32 v3, v3, s26, v211
    v_fma_f32 v4, v4, s26, v211
    v_fma_f32 v5, v5, s26, v211
    v_fma_f32 v6, v6, s26, v211
    v_fma_f32 v7, v7, s26, v211
    v_mul_f32 v0, v0, v139
    v_mul_f32 v1, v1, v143
    v_mul_f32 v2, v2, v147
    v_mul_f32 v3, v3, v151
    v_mul_f32 v4, v4, v155
    v_mul_f32 v5, v5, v159
    v_mul_f32 v6, v6, v163
    v_mul_f32 v7, v7, v167
    v_exp_f32 v0, v0
    v_exp_f32 v1, v1
    v_exp_f32 v2, v2
    v_exp_f32 v3, v3
    v_exp_f32 v4, v4
    v_exp_f32 v5, v5
    v_exp_f32 v6, v6
    v_exp_f32 v7, v7
    v_add_f32 v0, 1.0, v0
    v_add_f32 v1, 1.0, v1
    v_add_f32 v2, 1.0, v2
    v_add_f32 v3, 1.0, v3
    v_add_f32 v4, 1.0, v4
    v_add_f32 v5, 1.0, v5
    v_add_f32 v6, 1.0, v6
    v_add_f32 v7, 1.0, v7
    v_rcp_f32 v0, v0
    v_rcp_f32 v1, v1
    v_rcp_f32 v2, v2
    v_rcp_f32 v3, v3
    v_rcp_f32 v4, v4
    v_rcp_f32 v5, v5
    v_rcp_f32 v6, v6
    v_rcp_f32 v7, v7
    v_mul_f32 v0, v0, v139
    v_mul_f32 v1, v1, v143
    v_mul_f32 v2, v2, v147
    v_mul_f32 v3, v3, v151
    v_mul_f32 v4, v4, v155
    v_mul_f32 v5, v5, v159
    v_mul_f32 v6, v6, v163
    v_mul_f32 v7, v7, v167
    v_cvt_pk_bf16_f32 v44, v0, v1
    v_cvt_pk_bf16_f32 v45, v2, v3
    v_cvt_pk_bf16_f32 v46, v4, v5
    v_cvt_pk_bf16_f32 v47, v6, v7
    v_add_u32 v212, 19456, v210
    buffer_store_dwordx4 v[44:47], v212, s[32:35], 0 offen
    v_fma_f32 v168, v168, v212, v220
    v_fma_f32 v172, v172, v213, v221
    v_fma_f32 v176, v176, v214, v222
    v_fma_f32 v180, v180, v215, v223
    v_fma_f32 v184, v184, v216, v224
    v_fma_f32 v188, v188, v217, v225
    v_fma_f32 v192, v192, v218, v226
    v_fma_f32 v196, v196, v219, v227
    v_mul_f32 v0, v168, v168
    v_mul_f32 v1, v172, v172
    v_mul_f32 v2, v176, v176
    v_mul_f32 v3, v180, v180
    v_mul_f32 v4, v184, v184
    v_mul_f32 v5, v188, v188
    v_mul_f32 v6, v192, v192
    v_mul_f32 v7, v196, v196
    v_fma_f32 v0, v0, s26, v211
    v_fma_f32 v1, v1, s26, v211
    v_fma_f32 v2, v2, s26, v211
    v_fma_f32 v3, v3, s26, v211
    v_fma_f32 v4, v4, s26, v211
    v_fma_f32 v5, v5, s26, v211
    v_fma_f32 v6, v6, s26, v211
    v_fma_f32 v7, v7, s26, v211
    v_mul_f32 v0, v0, v168
    v_mul_f32 v1, v1, v172
    v_mul_f32 v2, v2, v176
    v_mul_f32 v3, v3, v180
    v_mul_f32 v4, v4, v184
    v_mul_f32 v5, v5, v188
    v_mul_f32 v6, v6, v192
    v_mul_f32 v7, v7, v196
    v_exp_f32 v0, v0
    v_exp_f32 v1, v1
    v_exp_f32 v2, v2
    v_exp_f32 v3, v3
    v_exp_f32 v4, v4
    v_exp_f32 v5, v5
    v_exp_f32 v6, v6
    v_exp_f32 v7, v7
    v_add_f32 v0, 1.0, v0
    v_add_f32 v1, 1.0, v1
    v_add_f32 v2, 1.0, v2
    v_add_f32 v3, 1.0, v3
    v_add_f32 v4, 1.0, v4
    v_add_f32 v5, 1.0, v5
    v_add_f32 v6, 1.0, v6
    v_add_f32 v7, 1.0, v7
    v_rcp_f32 v0, v0
    v_rcp_f32 v1, v1
    v_rcp_f32 v2, v2
    v_rcp_f32 v3, v3
    v_rcp_f32 v4, v4
    v_rcp_f32 v5, v5
    v_rcp_f32 v6, v6
    v_rcp_f32 v7, v7
    v_mul_f32 v0, v0, v168
    v_mul_f32 v1, v1, v172
    v_mul_f32 v2, v2, v176
    v_mul_f32 v3, v3, v180
    v_mul_f32 v4, v4, v184
    v_mul_f32 v5, v5, v188
    v_mul_f32 v6, v6, v192
    v_mul_f32 v7, v7, v196
    v_cvt_pk_bf16_f32 v16, v0, v1
    v_cvt_pk_bf16_f32 v17, v2, v3
    v_cvt_pk_bf16_f32 v18, v4, v5
    v_cvt_pk_bf16_f32 v19, v6, v7
    v_add_u32 v212, 32768, v210
    buffer_store_dwordx4 v[16:19], v212, s[32:35], 0 offen
    v_fma_f32 v169, v169, v212, v220
    v_fma_f32 v173, v173, v213, v221
    v_fma_f32 v177, v177, v214, v222
    v_fma_f32 v181, v181, v215, v223
    v_fma_f32 v185, v185, v216, v224
    v_fma_f32 v189, v189, v217, v225
    v_fma_f32 v193, v193, v218, v226
    v_fma_f32 v197, v197, v219, v227
    v_mul_f32 v0, v169, v169
    v_mul_f32 v1, v173, v173
    v_mul_f32 v2, v177, v177
    v_mul_f32 v3, v181, v181
    v_mul_f32 v4, v185, v185
    v_mul_f32 v5, v189, v189
    v_mul_f32 v6, v193, v193
    v_mul_f32 v7, v197, v197
    v_fma_f32 v0, v0, s26, v211
    v_fma_f32 v1, v1, s26, v211
    v_fma_f32 v2, v2, s26, v211
    v_fma_f32 v3, v3, s26, v211
    v_fma_f32 v4, v4, s26, v211
    v_fma_f32 v5, v5, s26, v211
    v_fma_f32 v6, v6, s26, v211
    v_fma_f32 v7, v7, s26, v211
    v_mul_f32 v0, v0, v169
    v_mul_f32 v1, v1, v173
    v_mul_f32 v2, v2, v177
    v_mul_f32 v3, v3, v181
    v_mul_f32 v4, v4, v185
    v_mul_f32 v5, v5, v189
    v_mul_f32 v6, v6, v193
    v_mul_f32 v7, v7, v197
    v_exp_f32 v0, v0
    v_exp_f32 v1, v1
    v_exp_f32 v2, v2
    v_exp_f32 v3, v3
    v_exp_f32 v4, v4
    v_exp_f32 v5, v5
    v_exp_f32 v6, v6
    v_exp_f32 v7, v7
    v_add_f32 v0, 1.0, v0
    v_add_f32 v1, 1.0, v1
    v_add_f32 v2, 1.0, v2
    v_add_f32 v3, 1.0, v3
    v_add_f32 v4, 1.0, v4
    v_add_f32 v5, 1.0, v5
    v_add_f32 v6, 1.0, v6
    v_add_f32 v7, 1.0, v7
    v_rcp_f32 v0, v0
    v_rcp_f32 v1, v1
    v_rcp_f32 v2, v2
    v_rcp_f32 v3, v3
    v_rcp_f32 v4, v4
    v_rcp_f32 v5, v5
    v_rcp_f32 v6, v6
    v_rcp_f32 v7, v7
    v_mul_f32 v0, v0, v169
    v_mul_f32 v1, v1, v173
    v_mul_f32 v2, v2, v177
    v_mul_f32 v3, v3, v181
    v_mul_f32 v4, v4, v185
    v_mul_f32 v5, v5, v189
    v_mul_f32 v6, v6, v193
    v_mul_f32 v7, v7, v197
    v_cvt_pk_bf16_f32 v20, v0, v1
    v_cvt_pk_bf16_f32 v21, v2, v3
    v_cvt_pk_bf16_f32 v22, v4, v5
    v_cvt_pk_bf16_f32 v23, v6, v7
    v_add_u32 v212, 33792, v210
    buffer_store_dwordx4 v[20:23], v212, s[32:35], 0 offen
    v_fma_f32 v170, v170, v212, v220
    v_fma_f32 v174, v174, v213, v221
    v_fma_f32 v178, v178, v214, v222
    v_fma_f32 v182, v182, v215, v223
    v_fma_f32 v186, v186, v216, v224
    v_fma_f32 v190, v190, v217, v225
    v_fma_f32 v194, v194, v218, v226
    v_fma_f32 v198, v198, v219, v227
    v_mul_f32 v0, v170, v170
    v_mul_f32 v1, v174, v174
    v_mul_f32 v2, v178, v178
    v_mul_f32 v3, v182, v182
    v_mul_f32 v4, v186, v186
    v_mul_f32 v5, v190, v190
    v_mul_f32 v6, v194, v194
    v_mul_f32 v7, v198, v198
    v_fma_f32 v0, v0, s26, v211
    v_fma_f32 v1, v1, s26, v211
    v_fma_f32 v2, v2, s26, v211
    v_fma_f32 v3, v3, s26, v211
    v_fma_f32 v4, v4, s26, v211
    v_fma_f32 v5, v5, s26, v211
    v_fma_f32 v6, v6, s26, v211
    v_fma_f32 v7, v7, s26, v211
    v_mul_f32 v0, v0, v170
    v_mul_f32 v1, v1, v174
    v_mul_f32 v2, v2, v178
    v_mul_f32 v3, v3, v182
    v_mul_f32 v4, v4, v186
    v_mul_f32 v5, v5, v190
    v_mul_f32 v6, v6, v194
    v_mul_f32 v7, v7, v198
    v_exp_f32 v0, v0
    v_exp_f32 v1, v1
    v_exp_f32 v2, v2
    v_exp_f32 v3, v3
    v_exp_f32 v4, v4
    v_exp_f32 v5, v5
    v_exp_f32 v6, v6
    v_exp_f32 v7, v7
    v_add_f32 v0, 1.0, v0
    v_add_f32 v1, 1.0, v1
    v_add_f32 v2, 1.0, v2
    v_add_f32 v3, 1.0, v3
    v_add_f32 v4, 1.0, v4
    v_add_f32 v5, 1.0, v5
    v_add_f32 v6, 1.0, v6
    v_add_f32 v7, 1.0, v7
    v_rcp_f32 v0, v0
    v_rcp_f32 v1, v1
    v_rcp_f32 v2, v2
    v_rcp_f32 v3, v3
    v_rcp_f32 v4, v4
    v_rcp_f32 v5, v5
    v_rcp_f32 v6, v6
    v_rcp_f32 v7, v7
    v_mul_f32 v0, v0, v170
    v_mul_f32 v1, v1, v174
    v_mul_f32 v2, v2, v178
    v_mul_f32 v3, v3, v182
    v_mul_f32 v4, v4, v186
    v_mul_f32 v5, v5, v190
    v_mul_f32 v6, v6, v194
    v_mul_f32 v7, v7, v198
    v_cvt_pk_bf16_f32 v24, v0, v1
    v_cvt_pk_bf16_f32 v25, v2, v3
    v_cvt_pk_bf16_f32 v26, v4, v5
    v_cvt_pk_bf16_f32 v27, v6, v7
    v_add_u32 v212, 34816, v210
    buffer_store_dwordx4 v[24:27], v212, s[32:35], 0 offen
    v_fma_f32 v171, v171, v212, v220
    v_fma_f32 v175, v175, v213, v221
    v_fma_f32 v179, v179, v214, v222
    v_fma_f32 v183, v183, v215, v223
    v_fma_f32 v187, v187, v216, v224
    v_fma_f32 v191, v191, v217, v225
    v_fma_f32 v195, v195, v218, v226
    v_fma_f32 v199, v199, v219, v227
    v_mul_f32 v0, v171, v171
    v_mul_f32 v1, v175, v175
    v_mul_f32 v2, v179, v179
    v_mul_f32 v3, v183, v183
    v_mul_f32 v4, v187, v187
    v_mul_f32 v5, v191, v191
    v_mul_f32 v6, v195, v195
    v_mul_f32 v7, v199, v199
    v_fma_f32 v0, v0, s26, v211
    v_fma_f32 v1, v1, s26, v211
    v_fma_f32 v2, v2, s26, v211
    v_fma_f32 v3, v3, s26, v211
    v_fma_f32 v4, v4, s26, v211
    v_fma_f32 v5, v5, s26, v211
    v_fma_f32 v6, v6, s26, v211
    v_fma_f32 v7, v7, s26, v211
    v_mul_f32 v0, v0, v171
    v_mul_f32 v1, v1, v175
    v_mul_f32 v2, v2, v179
    v_mul_f32 v3, v3, v183
    v_mul_f32 v4, v4, v187
    v_mul_f32 v5, v5, v191
    v_mul_f32 v6, v6, v195
    v_mul_f32 v7, v7, v199
    v_exp_f32 v0, v0
    v_exp_f32 v1, v1
    v_exp_f32 v2, v2
    v_exp_f32 v3, v3
    v_exp_f32 v4, v4
    v_exp_f32 v5, v5
    v_exp_f32 v6, v6
    v_exp_f32 v7, v7
    v_add_f32 v0, 1.0, v0
    v_add_f32 v1, 1.0, v1
    v_add_f32 v2, 1.0, v2
    v_add_f32 v3, 1.0, v3
    v_add_f32 v4, 1.0, v4
    v_add_f32 v5, 1.0, v5
    v_add_f32 v6, 1.0, v6
    v_add_f32 v7, 1.0, v7
    v_rcp_f32 v0, v0
    v_rcp_f32 v1, v1
    v_rcp_f32 v2, v2
    v_rcp_f32 v3, v3
    v_rcp_f32 v4, v4
    v_rcp_f32 v5, v5
    v_rcp_f32 v6, v6
    v_rcp_f32 v7, v7
    v_mul_f32 v0, v0, v171
    v_mul_f32 v1, v1, v175
    v_mul_f32 v2, v2, v179
    v_mul_f32 v3, v3, v183
    v_mul_f32 v4, v4, v187
    v_mul_f32 v5, v5, v191
    v_mul_f32 v6, v6, v195
    v_mul_f32 v7, v7, v199
    v_cvt_pk_bf16_f32 v28, v0, v1
    v_cvt_pk_bf16_f32 v29, v2, v3
    v_cvt_pk_bf16_f32 v30, v4, v5
    v_cvt_pk_bf16_f32 v31, v6, v7
    v_add_u32 v212, 35840, v210
    buffer_store_dwordx4 v[28:31], v212, s[32:35], 0 offen
L_k5_end:
    s_endpgm
.section .rodata,"a"
.p2align 6
.amdhsa_kernel xform_kernel
  .amdhsa_next_free_vgpr 160
  .amdhsa_next_free_sgpr 96
  .amdhsa_accum_offset 160
  .amdhsa_group_segment_fixed_size 0
  .amdhsa_kernarg_size 56
  .amdhsa_user_sgpr_count 2
  .amdhsa_user_sgpr_kernarg_segment_ptr 1
  .amdhsa_system_sgpr_workgroup_id_x 1
  .amdhsa_float_denorm_mode_32 3
.end_amdhsa_kernel

.p2align 6
.amdhsa_kernel gemm_kernel
  .amdhsa_next_free_vgpr 200
  .amdhsa_next_free_sgpr 96
  .amdhsa_accum_offset 200
  .amdhsa_group_segment_fixed_size 0
  .amdhsa_kernarg_size 56
  .amdhsa_user_sgpr_count 2
  .amdhsa_user_sgpr_kernarg_segment_ptr 1
  .amdhsa_system_sgpr_workgroup_id_x 1
  .amdhsa_float_denorm_mode_32 3
.end_amdhsa_kernel

.p2align 6
.amdhsa_kernel stats_kernel
  .amdhsa_next_free_vgpr 216
  .amdhsa_next_free_sgpr 96
  .amdhsa_accum_offset 216
  .amdhsa_group_segment_fixed_size 0
  .amdhsa_kernarg_size 56
  .amdhsa_user_sgpr_count 2
  .amdhsa_user_sgpr_kernarg_segment_ptr 1
  .amdhsa_system_sgpr_workgroup_id_x 1
  .amdhsa_float_denorm_mode_32 3
.end_amdhsa_kernel

.p2align 6
.amdhsa_kernel final_kernel
  .amdhsa_next_free_vgpr 232
  .amdhsa_next_free_sgpr 96
  .amdhsa_accum_offset 232
  .amdhsa_group_segment_fixed_size 0
  .amdhsa_kernarg_size 56
  .amdhsa_user_sgpr_count 2
  .amdhsa_user_sgpr_kernarg_segment_ptr 1
  .amdhsa_system_sgpr_workgroup_id_x 1
  .amdhsa_float_denorm_mode_32 3
.end_amdhsa_kernel
```

```asm
; @launch kernel=xform_kernel grid=(1696,1,1) block=(256,1,1) lds=16384
; @launch kernel=gemm_kernel grid=(256,1,1) block=(512,1,1) lds=152576
; @launch kernel=stats_kernel grid=(336,1,1) block=(256,1,1) lds=24576
; @launch kernel=final_kernel grid=(336,1,1) block=(256,1,1) lds=9216
.amdgcn_target "amdgcn-amd-amdhsa--gfx950"
.text
.globl xform_kernel
.p2align 8
.type xform_kernel,@function
xform_kernel:
    s_cmp_ge_u32 s2, 1696
    s_cbranch_scc1 L_k12_end
    s_load_dwordx4 s[4:7], s[0:1], 0
    s_load_dwordx2 s[8:9], s[0:1], 48
    v_and_b32 v144, 63, v0
    v_lshrrev_b32 v149, 6, v0
    v_and_b32 v145, 15, v144
    v_readfirstlane_b32 s10, v149
    v_lshrrev_b32 v146, 4, v144
    s_mov_b32 s30, 0x05040100
    s_mov_b32 s31, 0x07060302
    s_waitcnt lgkmcnt(0)
    s_mov_b32 s16, s8
    s_and_b32 s17, s9, 0xffff
    s_mov_b32 s18, 268435456
    s_mov_b32 s19, 0x00020000
    s_cmp_ge_u32 s2, 672
    s_cbranch_scc1 L_k12_w
    s_cmp_ge_u32 s2, 336
    s_cselect_b32 s11, 1, 0
    s_mul_i32 s12, s11, 336
    s_sub_u32 s12, s2, s12
    s_and_b32 s13, s12, 7
    s_lshr_b32 s14, s12, 3
    s_lshl_b32 s14, s14, 2
    s_add_u32 s14, s14, s10
    s_mul_i32 s15, s11, 16384000
    s_add_u32 s4, s4, s15
    s_addc_u32 s5, s5, 0
    s_mov_b32 s20, s4
    s_and_b32 s21, s5, 0xffff
    s_mov_b32 s22, 16384000
    s_mov_b32 s23, 0x00020000
    s_mul_i32 s15, s14, 98304
    s_lshl_b32 s24, s13, 8
    s_add_u32 s15, s15, s24
    v_lshlrev_b32 v147, 14, v146
    v_lshl_add_u32 v147, v145, 4, v147
    v_add_u32 v147, s15, v147
    buffer_load_dwordx4 v[0:3], v147, s[20:23], 0 offen
    v_add_u32 v149, 2048, v147
    buffer_load_dwordx4 v[4:7], v149, s[20:23], 0 offen
    v_add_u32 v149, 4096, v147
    buffer_load_dwordx4 v[8:11], v149, s[20:23], 0 offen
    v_add_u32 v149, 6144, v147
    buffer_load_dwordx4 v[12:15], v149, s[20:23], 0 offen
    v_add_u32 v149, 8192, v147
    buffer_load_dwordx4 v[16:19], v149, s[20:23], 0 offen
    v_add_u32 v149, 10240, v147
    buffer_load_dwordx4 v[20:23], v149, s[20:23], 0 offen
    v_add_u32 v149, 12288, v147
    buffer_load_dwordx4 v[24:27], v149, s[20:23], 0 offen
    v_add_u32 v149, 14336, v147
    buffer_load_dwordx4 v[28:31], v149, s[20:23], 0 offen
    v_add_u32 v149, 65536, v147
    buffer_load_dwordx4 v[32:35], v149, s[20:23], 0 offen
    v_add_u32 v149, 67584, v147
    buffer_load_dwordx4 v[36:39], v149, s[20:23], 0 offen
    v_add_u32 v149, 69632, v147
    buffer_load_dwordx4 v[40:43], v149, s[20:23], 0 offen
    v_add_u32 v149, 71680, v147
    buffer_load_dwordx4 v[44:47], v149, s[20:23], 0 offen
    v_add_u32 v149, 73728, v147
    buffer_load_dwordx4 v[48:51], v149, s[20:23], 0 offen
    v_add_u32 v149, 75776, v147
    buffer_load_dwordx4 v[52:55], v149, s[20:23], 0 offen
    v_add_u32 v149, 77824, v147
    buffer_load_dwordx4 v[56:59], v149, s[20:23], 0 offen
    v_add_u32 v149, 79872, v147
    buffer_load_dwordx4 v[60:63], v149, s[20:23], 0 offen
    v_lshrrev_b32 v149, 2, v145
    v_lshlrev_b32 v149, 1, v149
    v_bfe_u32 v150, v145, 1, 1
    v_add_u32 v149, v149, v150
    s_lshl_b32 s24, s10, 3
    v_add_u32 v149, s24, v149
    v_lshl_add_u32 v149, v149, 1, 1
    v_and_b32 v150, 1, v145
    v_lshlrev_b32 v150, 5, v150
    v_lshlrev_b32 v151, 3, v146
    v_mad_u32_u24 v96, v149, v151, v150
    v_add_u32 v97, v96, v149
    v_add_u32 v98, v97, v149
    v_add_u32 v99, v98, v149
    v_add_u32 v100, v99, v149
    v_add_u32 v101, v100, v149
    v_add_u32 v102, v101, v149
    v_add_u32 v103, v102, v149
    v_and_b32 v96, 127, v96
    v_cvt_f32_u32 v96, v96
    v_mul_f32 v96, 0x3c000000, v96
    v_cos_f32 v96, v96
    v_and_b32 v97, 127, v97
    v_cvt_f32_u32 v97, v97
    v_mul_f32 v97, 0x3c000000, v97
    v_cos_f32 v97, v97
    v_and_b32 v98, 127, v98
    v_cvt_f32_u32 v98, v98
    v_mul_f32 v98, 0x3c000000, v98
    v_cos_f32 v98, v98
    v_and_b32 v99, 127, v99
    v_cvt_f32_u32 v99, v99
    v_mul_f32 v99, 0x3c000000, v99
    v_cos_f32 v99, v99
    v_and_b32 v100, 127, v100
    v_cvt_f32_u32 v100, v100
    v_mul_f32 v100, 0x3c000000, v100
    v_cos_f32 v100, v100
    v_and_b32 v101, 127, v101
    v_cvt_f32_u32 v101, v101
    v_mul_f32 v101, 0x3c000000, v101
    v_cos_f32 v101, v101
    v_and_b32 v102, 127, v102
    v_cvt_f32_u32 v102, v102
    v_mul_f32 v102, 0x3c000000, v102
    v_cos_f32 v102, v102
    v_and_b32 v103, 127, v103
    v_cvt_f32_u32 v103, v103
    v_mul_f32 v103, 0x3c000000, v103
    v_cos_f32 v103, v103
    v_cvt_pk_bf16_f32 v112, v96, v97
    v_cvt_pk_bf16_f32 v113, v98, v99
    v_cvt_pk_bf16_f32 v114, v100, v101
    v_cvt_pk_bf16_f32 v115, v102, v103
    s_lshl_b32 s24, s10, 11
    v_lshlrev_b32 v152, 4, v144
    v_add_u32 v152, s24, v152
    ds_write_b128 v152, v[112:115] offset:0
    v_lshlrev_b32 v151, 3, v146
    v_add_u32 v151, 32, v151
    v_mad_u32_u24 v96, v149, v151, v150
    v_add_u32 v97, v96, v149
    v_add_u32 v98, v97, v149
    v_add_u32 v99, v98, v149
    v_add_u32 v100, v99, v149
    v_add_u32 v101, v100, v149
    v_add_u32 v102, v101, v149
    v_add_u32 v103, v102, v149
    v_and_b32 v96, 127, v96
    v_cvt_f32_u32 v96, v96
    v_mul_f32 v96, 0x3c000000, v96
    v_cos_f32 v96, v96
    v_and_b32 v97, 127, v97
    v_cvt_f32_u32 v97, v97
    v_mul_f32 v97, 0x3c000000, v97
    v_cos_f32 v97, v97
    v_and_b32 v98, 127, v98
    v_cvt_f32_u32 v98, v98
    v_mul_f32 v98, 0x3c000000, v98
    v_cos_f32 v98, v98
    v_and_b32 v99, 127, v99
    v_cvt_f32_u32 v99, v99
    v_mul_f32 v99, 0x3c000000, v99
    v_cos_f32 v99, v99
    v_and_b32 v100, 127, v100
    v_cvt_f32_u32 v100, v100
    v_mul_f32 v100, 0x3c000000, v100
    v_cos_f32 v100, v100
    v_and_b32 v101, 127, v101
    v_cvt_f32_u32 v101, v101
    v_mul_f32 v101, 0x3c000000, v101
    v_cos_f32 v101, v101
    v_and_b32 v102, 127, v102
    v_cvt_f32_u32 v102, v102
    v_mul_f32 v102, 0x3c000000, v102
    v_cos_f32 v102, v102
    v_and_b32 v103, 127, v103
    v_cvt_f32_u32 v103, v103
    v_mul_f32 v103, 0x3c000000, v103
    v_cos_f32 v103, v103
    v_cvt_pk_bf16_f32 v112, v96, v97
    v_cvt_pk_bf16_f32 v113, v98, v99
    v_cvt_pk_bf16_f32 v114, v100, v101
    v_cvt_pk_bf16_f32 v115, v102, v103
    s_lshl_b32 s24, s10, 11
    v_lshlrev_b32 v152, 4, v144
    v_add_u32 v152, s24, v152
    ds_write_b128 v152, v[112:115] offset:1024
    s_waitcnt lgkmcnt(0)
    s_barrier
    v_lshlrev_b32 v152, 4, v144
    ds_read_b128 v[64:67], v152 offset:0
    ds_read_b128 v[68:71], v152 offset:1024
    ds_read_b128 v[72:75], v152 offset:2048
    ds_read_b128 v[76:79], v152 offset:3072
    ds_read_b128 v[80:83], v152 offset:4096
    ds_read_b128 v[84:87], v152 offset:5120
    ds_read_b128 v[88:91], v152 offset:6144
    ds_read_b128 v[92:95], v152 offset:7168
    s_bfe_u32 s24, s14, 0x10003
    s_mul_i32 s24, s24, 3
    v_and_b32 v149, 3, v145
    v_xor_b32 v149, s24, v149
    v_lshlrev_b32 v149, 4, v149
    v_lshrrev_b32 v150, 2, v145
    s_mov_b32 s24, 21504
    v_mad_u32_u24 v149, v150, s24, v149
    s_mov_b32 s24, 2752512
    v_mad_u32_u24 v148, v146, s24, v149
    s_mul_i32 s24, s11, 688128
    s_mul_i32 s25, s13, 86016
    s_add_u32 s24, s24, s25
    s_lshl_b32 s25, s14, 6
    s_add_u32 s24, s24, s25
    s_add_u32 s24, s24, 67108864
    s_waitcnt vmcnt(0) lgkmcnt(0)
    v_perm_b32 v96, v4, v0, s30
    v_perm_b32 v97, v12, v8, s30
    v_perm_b32 v98, v20, v16, s30
    v_perm_b32 v99, v28, v24, s30
    v_perm_b32 v100, v4, v0, s31
    v_perm_b32 v101, v12, v8, s31
    v_perm_b32 v102, v20, v16, s31
    v_perm_b32 v103, v28, v24, s31
    v_perm_b32 v104, v36, v32, s30
    v_perm_b32 v105, v44, v40, s30
    v_perm_b32 v106, v52, v48, s30
    v_perm_b32 v107, v60, v56, s30
    v_perm_b32 v108, v36, v32, s31
    v_perm_b32 v109, v44, v40, s31
    v_perm_b32 v110, v52, v48, s31
    v_perm_b32 v111, v60, v56, s31
    v_mfma_f32_16x16x32_bf16 v[112:115], v[64:67], v[96:99], 0
    v_mfma_f32_16x16x32_bf16 v[116:119], v[64:67], v[100:103], 0
    v_mfma_f32_16x16x32_bf16 v[120:123], v[72:75], v[96:99], 0
    v_mfma_f32_16x16x32_bf16 v[124:127], v[72:75], v[100:103], 0
    v_mfma_f32_16x16x32_bf16 v[128:131], v[80:83], v[96:99], 0
    v_mfma_f32_16x16x32_bf16 v[132:135], v[80:83], v[100:103], 0
    v_mfma_f32_16x16x32_bf16 v[136:139], v[88:91], v[96:99], 0
    v_mfma_f32_16x16x32_bf16 v[140:143], v[88:91], v[100:103], 0
    v_mfma_f32_16x16x32_bf16 v[112:115], v[68:71], v[104:107], v[112:115]
    v_mfma_f32_16x16x32_bf16 v[116:119], v[68:71], v[108:111], v[116:119]
    v_mfma_f32_16x16x32_bf16 v[120:123], v[76:79], v[104:107], v[120:123]
    v_mfma_f32_16x16x32_bf16 v[124:127], v[76:79], v[108:111], v[124:127]
    v_mfma_f32_16x16x32_bf16 v[128:131], v[84:87], v[104:107], v[128:131]
    v_mfma_f32_16x16x32_bf16 v[132:135], v[84:87], v[108:111], v[132:135]
    v_mfma_f32_16x16x32_bf16 v[136:139], v[92:95], v[104:107], v[136:139]
    v_mfma_f32_16x16x32_bf16 v[140:143], v[92:95], v[108:111], v[140:143]
    v_perm_b32 v96, v5, v1, s30
    v_perm_b32 v97, v13, v9, s30
    v_perm_b32 v98, v21, v17, s30
    v_perm_b32 v99, v29, v25, s30
    v_perm_b32 v100, v5, v1, s31
    v_perm_b32 v101, v13, v9, s31
    v_perm_b32 v102, v21, v17, s31
    v_perm_b32 v103, v29, v25, s31
    v_perm_b32 v104, v37, v33, s30
    v_perm_b32 v105, v45, v41, s30
    v_perm_b32 v106, v53, v49, s30
    v_perm_b32 v107, v61, v57, s30
    v_perm_b32 v108, v37, v33, s31
    v_perm_b32 v109, v45, v41, s31
    v_perm_b32 v110, v53, v49, s31
    v_perm_b32 v111, v61, v57, s31
    v_cvt_pk_bf16_f32 v0, v112, v116
    v_cvt_pk_bf16_f32 v4, v113, v117
    v_cvt_pk_bf16_f32 v8, v114, v118
    v_cvt_pk_bf16_f32 v12, v115, v119
    v_cvt_pk_bf16_f32 v16, v120, v124
    v_cvt_pk_bf16_f32 v20, v121, v125
    v_cvt_pk_bf16_f32 v24, v122, v126
    v_cvt_pk_bf16_f32 v28, v123, v127
    v_cvt_pk_bf16_f32 v32, v128, v132
    v_cvt_pk_bf16_f32 v36, v129, v133
    v_cvt_pk_bf16_f32 v40, v130, v134
    v_cvt_pk_bf16_f32 v44, v131, v135
    v_cvt_pk_bf16_f32 v48, v136, v140
    v_cvt_pk_bf16_f32 v52, v137, v141
    v_cvt_pk_bf16_f32 v56, v138, v142
    v_cvt_pk_bf16_f32 v60, v139, v143
    v_mfma_f32_16x16x32_bf16 v[112:115], v[64:67], v[96:99], 0
    v_mfma_f32_16x16x32_bf16 v[116:119], v[64:67], v[100:103], 0
    v_mfma_f32_16x16x32_bf16 v[120:123], v[72:75], v[96:99], 0
    v_mfma_f32_16x16x32_bf16 v[124:127], v[72:75], v[100:103], 0
    v_mfma_f32_16x16x32_bf16 v[128:131], v[80:83], v[96:99], 0
    v_mfma_f32_16x16x32_bf16 v[132:135], v[80:83], v[100:103], 0
    v_mfma_f32_16x16x32_bf16 v[136:139], v[88:91], v[96:99], 0
    v_mfma_f32_16x16x32_bf16 v[140:143], v[88:91], v[100:103], 0
    v_mfma_f32_16x16x32_bf16 v[112:115], v[68:71], v[104:107], v[112:115]
    v_mfma_f32_16x16x32_bf16 v[116:119], v[68:71], v[108:111], v[116:119]
    v_mfma_f32_16x16x32_bf16 v[120:123], v[76:79], v[104:107], v[120:123]
    v_mfma_f32_16x16x32_bf16 v[124:127], v[76:79], v[108:111], v[124:127]
    v_mfma_f32_16x16x32_bf16 v[128:131], v[84:87], v[104:107], v[128:131]
    v_mfma_f32_16x16x32_bf16 v[132:135], v[84:87], v[108:111], v[132:135]
    v_mfma_f32_16x16x32_bf16 v[136:139], v[92:95], v[104:107], v[136:139]
    v_mfma_f32_16x16x32_bf16 v[140:143], v[92:95], v[108:111], v[140:143]
    v_perm_b32 v96, v6, v2, s30
    v_perm_b32 v97, v14, v10, s30
    v_perm_b32 v98, v22, v18, s30
    v_perm_b32 v99, v30, v26, s30
    v_perm_b32 v100, v6, v2, s31
    v_perm_b32 v101, v14, v10, s31
    v_perm_b32 v102, v22, v18, s31
    v_perm_b32 v103, v30, v26, s31
    v_perm_b32 v104, v38, v34, s30
    v_perm_b32 v105, v46, v42, s30
    v_perm_b32 v106, v54, v50, s30
    v_perm_b32 v107, v62, v58, s30
    v_perm_b32 v108, v38, v34, s31
    v_perm_b32 v109, v46, v42, s31
    v_perm_b32 v110, v54, v50, s31
    v_perm_b32 v111, v62, v58, s31
    v_cvt_pk_bf16_f32 v1, v112, v116
    v_cvt_pk_bf16_f32 v5, v113, v117
    v_cvt_pk_bf16_f32 v9, v114, v118
    v_cvt_pk_bf16_f32 v13, v115, v119
    v_cvt_pk_bf16_f32 v17, v120, v124
    v_cvt_pk_bf16_f32 v21, v121, v125
    v_cvt_pk_bf16_f32 v25, v122, v126
    v_cvt_pk_bf16_f32 v29, v123, v127
    v_cvt_pk_bf16_f32 v33, v128, v132
    v_cvt_pk_bf16_f32 v37, v129, v133
    v_cvt_pk_bf16_f32 v41, v130, v134
    v_cvt_pk_bf16_f32 v45, v131, v135
    v_cvt_pk_bf16_f32 v49, v136, v140
    v_cvt_pk_bf16_f32 v53, v137, v141
    v_cvt_pk_bf16_f32 v57, v138, v142
    v_cvt_pk_bf16_f32 v61, v139, v143
    v_mfma_f32_16x16x32_bf16 v[112:115], v[64:67], v[96:99], 0
    v_mfma_f32_16x16x32_bf16 v[116:119], v[64:67], v[100:103], 0
    v_mfma_f32_16x16x32_bf16 v[120:123], v[72:75], v[96:99], 0
    v_mfma_f32_16x16x32_bf16 v[124:127], v[72:75], v[100:103], 0
    v_mfma_f32_16x16x32_bf16 v[128:131], v[80:83], v[96:99], 0
    v_mfma_f32_16x16x32_bf16 v[132:135], v[80:83], v[100:103], 0
    v_mfma_f32_16x16x32_bf16 v[136:139], v[88:91], v[96:99], 0
    v_mfma_f32_16x16x32_bf16 v[140:143], v[88:91], v[100:103], 0
    v_mfma_f32_16x16x32_bf16 v[112:115], v[68:71], v[104:107], v[112:115]
    v_mfma_f32_16x16x32_bf16 v[116:119], v[68:71], v[108:111], v[116:119]
    v_mfma_f32_16x16x32_bf16 v[120:123], v[76:79], v[104:107], v[120:123]
    v_mfma_f32_16x16x32_bf16 v[124:127], v[76:79], v[108:111], v[124:127]
    v_mfma_f32_16x16x32_bf16 v[128:131], v[84:87], v[104:107], v[128:131]
    v_mfma_f32_16x16x32_bf16 v[132:135], v[84:87], v[108:111], v[132:135]
    v_mfma_f32_16x16x32_bf16 v[136:139], v[92:95], v[104:107], v[136:139]
    v_mfma_f32_16x16x32_bf16 v[140:143], v[92:95], v[108:111], v[140:143]
    v_perm_b32 v96, v7, v3, s30
    v_perm_b32 v97, v15, v11, s30
    v_perm_b32 v98, v23, v19, s30
    v_perm_b32 v99, v31, v27, s30
    v_perm_b32 v100, v7, v3, s31
    v_perm_b32 v101, v15, v11, s31
    v_perm_b32 v102, v23, v19, s31
    v_perm_b32 v103, v31, v27, s31
    v_perm_b32 v104, v39, v35, s30
    v_perm_b32 v105, v47, v43, s30
    v_perm_b32 v106, v55, v51, s30
    v_perm_b32 v107, v63, v59, s30
    v_perm_b32 v108, v39, v35, s31
    v_perm_b32 v109, v47, v43, s31
    v_perm_b32 v110, v55, v51, s31
    v_perm_b32 v111, v63, v59, s31
    v_cvt_pk_bf16_f32 v2, v112, v116
    v_cvt_pk_bf16_f32 v6, v113, v117
    v_cvt_pk_bf16_f32 v10, v114, v118
    v_cvt_pk_bf16_f32 v14, v115, v119
    v_cvt_pk_bf16_f32 v18, v120, v124
    v_cvt_pk_bf16_f32 v22, v121, v125
    v_cvt_pk_bf16_f32 v26, v122, v126
    v_cvt_pk_bf16_f32 v30, v123, v127
    v_cvt_pk_bf16_f32 v34, v128, v132
    v_cvt_pk_bf16_f32 v38, v129, v133
    v_cvt_pk_bf16_f32 v42, v130, v134
    v_cvt_pk_bf16_f32 v46, v131, v135
    v_cvt_pk_bf16_f32 v50, v136, v140
    v_cvt_pk_bf16_f32 v54, v137, v141
    v_cvt_pk_bf16_f32 v58, v138, v142
    v_cvt_pk_bf16_f32 v62, v139, v143
    v_mfma_f32_16x16x32_bf16 v[112:115], v[64:67], v[96:99], 0
    v_mfma_f32_16x16x32_bf16 v[116:119], v[64:67], v[100:103], 0
    v_mfma_f32_16x16x32_bf16 v[120:123], v[72:75], v[96:99], 0
    v_mfma_f32_16x16x32_bf16 v[124:127], v[72:75], v[100:103], 0
    v_mfma_f32_16x16x32_bf16 v[128:131], v[80:83], v[96:99], 0
    v_mfma_f32_16x16x32_bf16 v[132:135], v[80:83], v[100:103], 0
    v_mfma_f32_16x16x32_bf16 v[136:139], v[88:91], v[96:99], 0
    v_mfma_f32_16x16x32_bf16 v[140:143], v[88:91], v[100:103], 0
    v_mfma_f32_16x16x32_bf16 v[112:115], v[68:71], v[104:107], v[112:115]
    v_mfma_f32_16x16x32_bf16 v[116:119], v[68:71], v[108:111], v[116:119]
    v_mfma_f32_16x16x32_bf16 v[120:123], v[76:79], v[104:107], v[120:123]
    v_mfma_f32_16x16x32_bf16 v[124:127], v[76:79], v[108:111], v[124:127]
    v_mfma_f32_16x16x32_bf16 v[128:131], v[84:87], v[104:107], v[128:131]
    v_mfma_f32_16x16x32_bf16 v[132:135], v[84:87], v[108:111], v[132:135]
    v_mfma_f32_16x16x32_bf16 v[136:139], v[92:95], v[104:107], v[136:139]
    v_mfma_f32_16x16x32_bf16 v[140:143], v[92:95], v[108:111], v[140:143]
    s_nop 1
    v_cvt_pk_bf16_f32 v3, v112, v116
    v_cvt_pk_bf16_f32 v7, v113, v117
    v_cvt_pk_bf16_f32 v11, v114, v118
    v_cvt_pk_bf16_f32 v15, v115, v119
    v_cvt_pk_bf16_f32 v19, v120, v124
    v_cvt_pk_bf16_f32 v23, v121, v125
    v_cvt_pk_bf16_f32 v27, v122, v126
    v_cvt_pk_bf16_f32 v31, v123, v127
    v_cvt_pk_bf16_f32 v35, v128, v132
    v_cvt_pk_bf16_f32 v39, v129, v133
    v_cvt_pk_bf16_f32 v43, v130, v134
    v_cvt_pk_bf16_f32 v47, v131, v135
    v_cvt_pk_bf16_f32 v51, v136, v140
    v_cvt_pk_bf16_f32 v55, v137, v141
    v_cvt_pk_bf16_f32 v59, v138, v142
    v_cvt_pk_bf16_f32 v63, v139, v143
    s_add_u32 s25, s24, 0
    buffer_store_dwordx4 v[0:3], v148, s[16:19], s25 offen
    s_add_u32 s25, s24, 10752
    buffer_store_dwordx4 v[4:7], v148, s[16:19], s25 offen
    s_add_u32 s25, s24, 1376256
    buffer_store_dwordx4 v[8:11], v148, s[16:19], s25 offen
    s_add_u32 s25, s24, 1387008
    buffer_store_dwordx4 v[12:15], v148, s[16:19], s25 offen
    s_add_u32 s25, s24, 11010048
    buffer_store_dwordx4 v[16:19], v148, s[16:19], s25 offen
    s_add_u32 s25, s24, 11020800
    buffer_store_dwordx4 v[20:23], v148, s[16:19], s25 offen
    s_add_u32 s25, s24, 12386304
    buffer_store_dwordx4 v[24:27], v148, s[16:19], s25 offen
    s_add_u32 s25, s24, 12397056
    buffer_store_dwordx4 v[28:31], v148, s[16:19], s25 offen
    s_add_u32 s25, s24, 22020096
    buffer_store_dwordx4 v[32:35], v148, s[16:19], s25 offen
    s_add_u32 s25, s24, 22030848
    buffer_store_dwordx4 v[36:39], v148, s[16:19], s25 offen
    s_add_u32 s25, s24, 23396352
    buffer_store_dwordx4 v[40:43], v148, s[16:19], s25 offen
    s_add_u32 s25, s24, 23407104
    buffer_store_dwordx4 v[44:47], v148, s[16:19], s25 offen
    s_add_u32 s25, s24, 33030144
    buffer_store_dwordx4 v[48:51], v148, s[16:19], s25 offen
    s_add_u32 s25, s24, 33040896
    buffer_store_dwordx4 v[52:55], v148, s[16:19], s25 offen
    s_add_u32 s25, s24, 34406400
    buffer_store_dwordx4 v[56:59], v148, s[16:19], s25 offen
    s_add_u32 s25, s24, 34417152
    buffer_store_dwordx4 v[60:63], v148, s[16:19], s25 offen
    s_endpgm
L_k12_w:
    s_sub_u32 s12, s2, 672
    s_and_b32 s13, s12, 3
    s_lshr_b32 s14, s12, 2
    s_lshl_b32 s14, s14, 2
    s_add_u32 s14, s14, s10
    s_mov_b32 s20, s6
    s_and_b32 s21, s7, 0xffff
    s_mov_b32 s22, 16252928
    s_mov_b32 s23, 0x00020000
    v_and_b32 v149, 1, v146
    v_lshlrev_b32 v147, 23, v149
    v_lshrrev_b32 v149, 2, v145
    v_lshl_add_u32 v147, v149, 6, v147
    v_and_b32 v149, 1, v145
    v_lshl_add_u32 v147, v149, 5, v147
    v_bfe_u32 v149, v145, 1, 1
    v_lshl_add_u32 v147, v149, 3, v147
    s_lshl_b32 s15, s14, 10
    s_lshl_b32 s24, s13, 8
    s_add_u32 s15, s15, s24
    v_add_u32 v147, s15, v147
    buffer_load_dwordx2 v[0:1], v147, s[20:23], 0 offen
    buffer_load_dwordx2 v[2:3], v147, s[20:23], 0 offen offset:16
    v_add_u32 v149, 1048576, v147
    buffer_load_dwordx2 v[4:5], v149, s[20:23], 0 offen
    buffer_load_dwordx2 v[6:7], v149, s[20:23], 0 offen offset:16
    v_add_u32 v149, 2097152, v147
    buffer_load_dwordx2 v[8:9], v149, s[20:23], 0 offen
    buffer_load_dwordx2 v[10:11], v149, s[20:23], 0 offen offset:16
    v_add_u32 v149, 3145728, v147
    buffer_load_dwordx2 v[12:13], v149, s[20:23], 0 offen
    buffer_load_dwordx2 v[14:15], v149, s[20:23], 0 offen offset:16
    v_add_u32 v149, 4194304, v147
    buffer_load_dwordx2 v[16:17], v149, s[20:23], 0 offen
    buffer_load_dwordx2 v[18:19], v149, s[20:23], 0 offen offset:16
    v_add_u32 v149, 5242880, v147
    buffer_load_dwordx2 v[20:21], v149, s[20:23], 0 offen
    buffer_load_dwordx2 v[22:23], v149, s[20:23], 0 offen offset:16
    v_add_u32 v149, 6291456, v147
    buffer_load_dwordx2 v[24:25], v149, s[20:23], 0 offen
    buffer_load_dwordx2 v[26:27], v149, s[20:23], 0 offen offset:16
    v_add_u32 v149, 7340032, v147
    buffer_load_dwordx2 v[28:29], v149, s[20:23], 0 offen
    buffer_load_dwordx2 v[30:31], v149, s[20:23], 0 offen offset:16
    v_lshrrev_b32 v149, 2, v145
    v_lshlrev_b32 v149, 1, v149
    v_bfe_u32 v150, v145, 1, 1
    v_add_u32 v149, v149, v150
    s_lshl_b32 s24, s10, 3
    v_add_u32 v149, s24, v149
    v_lshl_add_u32 v149, v149, 1, 1
    v_and_b32 v150, 1, v145
    v_lshlrev_b32 v150, 5, v150
    v_and_b32 v151, 1, v146
    v_lshlrev_b32 v151, 3, v151
    v_mad_u32_u24 v96, v149, v151, v150
    v_add_u32 v97, v96, v149
    v_add_u32 v98, v97, v149
    v_add_u32 v99, v98, v149
    v_add_u32 v100, v99, v149
    v_add_u32 v101, v100, v149
    v_add_u32 v102, v101, v149
    v_add_u32 v103, v102, v149
    v_cmp_lt_u32 s[26:27], 1, v146
    v_and_b32 v96, 127, v96
    v_cvt_f32_u32 v96, v96
    v_mul_f32 v96, 0x3c000000, v96
    v_cos_f32 v96, v96
    v_and_b32 v97, 127, v97
    v_cvt_f32_u32 v97, v97
    v_mul_f32 v97, 0x3c000000, v97
    v_cos_f32 v97, v97
    v_and_b32 v98, 127, v98
    v_cvt_f32_u32 v98, v98
    v_mul_f32 v98, 0x3c000000, v98
    v_cos_f32 v98, v98
    v_and_b32 v99, 127, v99
    v_cvt_f32_u32 v99, v99
    v_mul_f32 v99, 0x3c000000, v99
    v_cos_f32 v99, v99
    v_and_b32 v100, 127, v100
    v_cvt_f32_u32 v100, v100
    v_mul_f32 v100, 0x3c000000, v100
    v_cos_f32 v100, v100
    v_and_b32 v101, 127, v101
    v_cvt_f32_u32 v101, v101
    v_mul_f32 v101, 0x3c000000, v101
    v_cos_f32 v101, v101
    v_and_b32 v102, 127, v102
    v_cvt_f32_u32 v102, v102
    v_mul_f32 v102, 0x3c000000, v102
    v_cos_f32 v102, v102
    v_and_b32 v103, 127, v103
    v_cvt_f32_u32 v103, v103
    v_mul_f32 v103, 0x3c000000, v103
    v_cos_f32 v103, v103
    v_cvt_pk_bf16_f32 v112, v96, v97
    v_cvt_pk_bf16_f32 v113, v98, v99
    v_cvt_pk_bf16_f32 v114, v100, v101
    v_cvt_pk_bf16_f32 v115, v102, v103
    v_lshlrev_b32 v116, 16, v112
    v_and_b32 v117, 0xffff0000, v112
    v_sub_f32 v96, v96, v116
    v_sub_f32 v97, v97, v117
    v_cvt_pk_bf16_f32 v116, v96, v97
    v_cndmask_b32 v112, v112, v116, s[26:27]
    v_lshlrev_b32 v116, 16, v113
    v_and_b32 v117, 0xffff0000, v113
    v_sub_f32 v98, v98, v116
    v_sub_f32 v99, v99, v117
    v_cvt_pk_bf16_f32 v116, v98, v99
    v_cndmask_b32 v113, v113, v116, s[26:27]
    v_lshlrev_b32 v116, 16, v114
    v_and_b32 v117, 0xffff0000, v114
    v_sub_f32 v100, v100, v116
    v_sub_f32 v101, v101, v117
    v_cvt_pk_bf16_f32 v116, v100, v101
    v_cndmask_b32 v114, v114, v116, s[26:27]
    v_lshlrev_b32 v116, 16, v115
    v_and_b32 v117, 0xffff0000, v115
    v_sub_f32 v102, v102, v116
    v_sub_f32 v103, v103, v117
    v_cvt_pk_bf16_f32 v116, v102, v103
    v_cndmask_b32 v115, v115, v116, s[26:27]
    s_lshl_b32 s24, s10, 10
    v_lshlrev_b32 v152, 4, v144
    v_add_u32 v152, s24, v152
    ds_write_b128 v152, v[112:115]
    s_waitcnt lgkmcnt(0)
    s_barrier
    v_lshlrev_b32 v152, 4, v144
    ds_read_b128 v[64:67], v152 offset:0
    ds_read_b128 v[68:71], v152 offset:1024
    ds_read_b128 v[72:75], v152 offset:2048
    ds_read_b128 v[76:79], v152 offset:3072
    s_and_b32 s24, s14, 3
    s_bfe_u32 s25, s14, 0x10003
    s_lshl_b32 s25, s25, 2
    s_or_b32 s24, s24, s25
    s_lshl_b32 s24, s24, 1
    v_xor_b32 v149, s24, v145
    v_lshlrev_b32 v149, 4, v149
    v_lshlrev_b32 v148, 22, v146
    v_add_u32 v148, v148, v149
    s_lshl_b32 s24, s13, 19
    s_lshr_b32 s25, s14, 5
    s_lshl_b32 s25, s25, 14
    s_add_u32 s24, s24, s25
    s_and_b32 s25, s14, 31
    s_lshl_b32 s25, s25, 8
    s_add_u32 s24, s24, s25
    s_waitcnt vmcnt(0) lgkmcnt(0)
    v_perm_b32 v32, v4, v0, s30
    v_perm_b32 v33, v12, v8, s30
    v_perm_b32 v34, v20, v16, s30
    v_perm_b32 v35, v28, v24, s30
    v_perm_b32 v36, v4, v0, s31
    v_perm_b32 v37, v12, v8, s31
    v_perm_b32 v38, v20, v16, s31
    v_perm_b32 v39, v28, v24, s31
    v_perm_b32 v40, v5, v1, s30
    v_perm_b32 v41, v13, v9, s30
    v_perm_b32 v42, v21, v17, s30
    v_perm_b32 v43, v29, v25, s30
    v_perm_b32 v44, v5, v1, s31
    v_perm_b32 v45, v13, v9, s31
    v_perm_b32 v46, v21, v17, s31
    v_perm_b32 v47, v29, v25, s31
    v_perm_b32 v48, v6, v2, s30
    v_perm_b32 v49, v14, v10, s30
    v_perm_b32 v50, v22, v18, s30
    v_perm_b32 v51, v30, v26, s30
    v_perm_b32 v52, v6, v2, s31
    v_perm_b32 v53, v14, v10, s31
    v_perm_b32 v54, v22, v18, s31
    v_perm_b32 v55, v30, v26, s31
    v_perm_b32 v56, v7, v3, s30
    v_perm_b32 v57, v15, v11, s30
    v_perm_b32 v58, v23, v19, s30
    v_perm_b32 v59, v31, v27, s30
    v_perm_b32 v60, v7, v3, s31
    v_perm_b32 v61, v15, v11, s31
    v_perm_b32 v62, v23, v19, s31
    v_perm_b32 v63, v31, v27, s31
    v_mfma_f32_16x16x32_bf16 v[112:115], v[64:67], v[32:35], 0
    v_mfma_f32_16x16x32_bf16 v[116:119], v[64:67], v[36:39], 0
    v_mfma_f32_16x16x32_bf16 v[120:123], v[64:67], v[40:43], 0
    v_mfma_f32_16x16x32_bf16 v[124:127], v[64:67], v[44:47], 0
    v_mfma_f32_16x16x32_bf16 v[128:131], v[64:67], v[48:51], 0
    v_mfma_f32_16x16x32_bf16 v[132:135], v[64:67], v[52:55], 0
    v_mfma_f32_16x16x32_bf16 v[136:139], v[64:67], v[56:59], 0
    v_mfma_f32_16x16x32_bf16 v[140:143], v[64:67], v[60:63], 0
    s_nop 1
    v_cvt_pk_bf16_f32 v0, v112, v116
    s_nop 0
    v_cvt_pk_bf16_f32 v1, v120, v124
    s_nop 0
    v_cvt_pk_bf16_f32 v2, v128, v132
    s_nop 0
    v_cvt_pk_bf16_f32 v3, v136, v140
    v_cvt_pk_bf16_f32 v4, v113, v117
    v_cvt_pk_bf16_f32 v5, v121, v125
    v_cvt_pk_bf16_f32 v6, v129, v133
    v_cvt_pk_bf16_f32 v7, v137, v141
    v_cvt_pk_bf16_f32 v8, v114, v118
    v_cvt_pk_bf16_f32 v9, v122, v126
    v_cvt_pk_bf16_f32 v10, v130, v134
    v_cvt_pk_bf16_f32 v11, v138, v142
    v_cvt_pk_bf16_f32 v12, v115, v119
    v_cvt_pk_bf16_f32 v13, v123, v127
    v_cvt_pk_bf16_f32 v14, v131, v135
    v_cvt_pk_bf16_f32 v15, v139, v143
    s_add_u32 s25, s24, 0
    buffer_store_dwordx4 v[0:3], v148, s[16:19], s25 offen
    s_add_u32 s25, s24, 8192
    buffer_store_dwordx4 v[4:7], v148, s[16:19], s25 offen
    s_add_u32 s25, s24, 2097152
    buffer_store_dwordx4 v[8:11], v148, s[16:19], s25 offen
    s_add_u32 s25, s24, 2105344
    buffer_store_dwordx4 v[12:15], v148, s[16:19], s25 offen
    v_mfma_f32_16x16x32_bf16 v[112:115], v[68:71], v[32:35], 0
    v_mfma_f32_16x16x32_bf16 v[116:119], v[68:71], v[36:39], 0
    v_mfma_f32_16x16x32_bf16 v[120:123], v[68:71], v[40:43], 0
    v_mfma_f32_16x16x32_bf16 v[124:127], v[68:71], v[44:47], 0
    v_mfma_f32_16x16x32_bf16 v[128:131], v[68:71], v[48:51], 0
    v_mfma_f32_16x16x32_bf16 v[132:135], v[68:71], v[52:55], 0
    v_mfma_f32_16x16x32_bf16 v[136:139], v[68:71], v[56:59], 0
    v_mfma_f32_16x16x32_bf16 v[140:143], v[68:71], v[60:63], 0
    s_nop 1
    v_cvt_pk_bf16_f32 v16, v112, v116
    s_nop 0
    v_cvt_pk_bf16_f32 v17, v120, v124
    s_nop 0
    v_cvt_pk_bf16_f32 v18, v128, v132
    s_nop 0
    v_cvt_pk_bf16_f32 v19, v136, v140
    v_cvt_pk_bf16_f32 v20, v113, v117
    v_cvt_pk_bf16_f32 v21, v121, v125
    v_cvt_pk_bf16_f32 v22, v129, v133
    v_cvt_pk_bf16_f32 v23, v137, v141
    v_cvt_pk_bf16_f32 v24, v114, v118
    v_cvt_pk_bf16_f32 v25, v122, v126
    v_cvt_pk_bf16_f32 v26, v130, v134
    v_cvt_pk_bf16_f32 v27, v138, v142
    v_cvt_pk_bf16_f32 v28, v115, v119
    v_cvt_pk_bf16_f32 v29, v123, v127
    v_cvt_pk_bf16_f32 v30, v131, v135
    v_cvt_pk_bf16_f32 v31, v139, v143
    s_add_u32 s25, s24, 16777216
    buffer_store_dwordx4 v[16:19], v148, s[16:19], s25 offen
    s_add_u32 s25, s24, 16785408
    buffer_store_dwordx4 v[20:23], v148, s[16:19], s25 offen
    s_add_u32 s25, s24, 18874368
    buffer_store_dwordx4 v[24:27], v148, s[16:19], s25 offen
    s_add_u32 s25, s24, 18882560
    buffer_store_dwordx4 v[28:31], v148, s[16:19], s25 offen
    v_mfma_f32_16x16x32_bf16 v[112:115], v[72:75], v[32:35], 0
    v_mfma_f32_16x16x32_bf16 v[116:119], v[72:75], v[36:39], 0
    v_mfma_f32_16x16x32_bf16 v[120:123], v[72:75], v[40:43], 0
    v_mfma_f32_16x16x32_bf16 v[124:127], v[72:75], v[44:47], 0
    v_mfma_f32_16x16x32_bf16 v[128:131], v[72:75], v[48:51], 0
    v_mfma_f32_16x16x32_bf16 v[132:135], v[72:75], v[52:55], 0
    v_mfma_f32_16x16x32_bf16 v[136:139], v[72:75], v[56:59], 0
    v_mfma_f32_16x16x32_bf16 v[140:143], v[72:75], v[60:63], 0
    s_nop 1
    v_cvt_pk_bf16_f32 v0, v112, v116
    s_nop 0
    v_cvt_pk_bf16_f32 v1, v120, v124
    s_nop 0
    v_cvt_pk_bf16_f32 v2, v128, v132
    s_nop 0
    v_cvt_pk_bf16_f32 v3, v136, v140
    v_cvt_pk_bf16_f32 v4, v113, v117
    v_cvt_pk_bf16_f32 v5, v121, v125
    v_cvt_pk_bf16_f32 v6, v129, v133
    v_cvt_pk_bf16_f32 v7, v137, v141
    v_cvt_pk_bf16_f32 v8, v114, v118
    v_cvt_pk_bf16_f32 v9, v122, v126
    v_cvt_pk_bf16_f32 v10, v130, v134
    v_cvt_pk_bf16_f32 v11, v138, v142
    v_cvt_pk_bf16_f32 v12, v115, v119
    v_cvt_pk_bf16_f32 v13, v123, v127
    v_cvt_pk_bf16_f32 v14, v131, v135
    v_cvt_pk_bf16_f32 v15, v139, v143
    s_add_u32 s25, s24, 33554432
    buffer_store_dwordx4 v[0:3], v148, s[16:19], s25 offen
    s_add_u32 s25, s24, 33562624
    buffer_store_dwordx4 v[4:7], v148, s[16:19], s25 offen
    s_add_u32 s25, s24, 35651584
    buffer_store_dwordx4 v[8:11], v148, s[16:19], s25 offen
    s_add_u32 s25, s24, 35659776
    buffer_store_dwordx4 v[12:15], v148, s[16:19], s25 offen
    v_mfma_f32_16x16x32_bf16 v[112:115], v[76:79], v[32:35], 0
    v_mfma_f32_16x16x32_bf16 v[116:119], v[76:79], v[36:39], 0
    v_mfma_f32_16x16x32_bf16 v[120:123], v[76:79], v[40:43], 0
    v_mfma_f32_16x16x32_bf16 v[124:127], v[76:79], v[44:47], 0
    v_mfma_f32_16x16x32_bf16 v[128:131], v[76:79], v[48:51], 0
    v_mfma_f32_16x16x32_bf16 v[132:135], v[76:79], v[52:55], 0
    v_mfma_f32_16x16x32_bf16 v[136:139], v[76:79], v[56:59], 0
    v_mfma_f32_16x16x32_bf16 v[140:143], v[76:79], v[60:63], 0
    s_nop 1
    v_cvt_pk_bf16_f32 v16, v112, v116
    s_nop 0
    v_cvt_pk_bf16_f32 v17, v120, v124
    s_nop 0
    v_cvt_pk_bf16_f32 v18, v128, v132
    s_nop 0
    v_cvt_pk_bf16_f32 v19, v136, v140
    v_cvt_pk_bf16_f32 v20, v113, v117
    v_cvt_pk_bf16_f32 v21, v121, v125
    v_cvt_pk_bf16_f32 v22, v129, v133
    v_cvt_pk_bf16_f32 v23, v137, v141
    v_cvt_pk_bf16_f32 v24, v114, v118
    v_cvt_pk_bf16_f32 v25, v122, v126
    v_cvt_pk_bf16_f32 v26, v130, v134
    v_cvt_pk_bf16_f32 v27, v138, v142
    v_cvt_pk_bf16_f32 v28, v115, v119
    v_cvt_pk_bf16_f32 v29, v123, v127
    v_cvt_pk_bf16_f32 v30, v131, v135
    v_cvt_pk_bf16_f32 v31, v139, v143
    s_add_u32 s25, s24, 50331648
    buffer_store_dwordx4 v[16:19], v148, s[16:19], s25 offen
    s_add_u32 s25, s24, 50339840
    buffer_store_dwordx4 v[20:23], v148, s[16:19], s25 offen
    s_add_u32 s25, s24, 52428800
    buffer_store_dwordx4 v[24:27], v148, s[16:19], s25 offen
    s_add_u32 s25, s24, 52436992
    buffer_store_dwordx4 v[28:31], v148, s[16:19], s25 offen
L_k12_end:
    s_endpgm
.globl gemm_kernel
.p2align 8
.type gemm_kernel,@function
gemm_kernel:
    s_cmp_ge_u32 s2, 256
    s_cbranch_scc1 L_k3_end
    s_load_dwordx2 s[8:9], s[0:1], 48
    v_lshrrev_b32 v192, 6, v0
    v_and_b32 v0, 63, v0
    v_readfirstlane_b32 s10, v192
    s_and_b32 s11, s2, 7
    s_lshr_b32 s12, s2, 3
    s_lshr_b32 s13, s12, 3
    s_lshl_b32 s11, s11, 2
    s_add_u32 s11, s11, s13
    s_bfe_u32 s13, s12, 0x10002
    s_and_b32 s14, s12, 3
    s_and_b32 s15, s10, 3
    s_mul_i32 s40, s11, 2097152
    s_lshl_b32 s20, s14, 19
    s_add_u32 s40, s40, s20
    s_mul_i32 s41, s11, 1376256
    s_mul_i32 s20, s13, 688128
    s_add_u32 s41, s41, s20
    s_add_u32 s41, s41, 67108864
    s_lshl_b32 s42, s10, 11
    s_mul_i32 s43, s10, 2688
    v_lshlrev_b32 v188, 4, v0
    v_add_u32 v189, s43, v188
    v_add_u32 v188, s42, v188
    s_add_u32 s43, s43, 16384
    s_mov_b32 s44, -1
    s_mov_b32 s45, 0xff
    v_lshrrev_b32 v193, 4, v0
    v_and_b32 v194, 15, v0
    v_bfe_u32 v195, v194, 3, 1
    v_mul_u32_u24 v195, 3, v195
    v_xor_b32 v195, v195, v193
    v_lshlrev_b32 v195, 4, v195
    v_lshl_add_u32 v184, v194, 6, v195
    v_add_u32 v185, 37888, v184
    v_add_u32 v186, 75776, v184
    v_add_u32 v187, 113664, v184
    v_lshrrev_b32 v195, 2, v194
    v_and_b32 v196, 1, v193
    v_lshl_or_b32 v196, v196, 2, v195
    v_lshl_add_u32 v195, v193, 3, v195
    v_lshlrev_b32 v195, 8, v195
    v_and_b32 v197, 3, v194
    v_lshl_add_u32 v195, v197, 3, v195
    s_lshl_b32 s20, s15, 1
    v_xor_b32 v197, s20, v196
    v_lshl_add_u32 v176, v197, 5, v195
    v_add_u32 v178, 37888, v176
    v_add_u32 v180, 75776, v176
    v_add_u32 v182, 113664, v176
    s_add_u32 s20, s20, 1
    v_xor_b32 v197, s20, v196
    v_lshl_add_u32 v177, v197, 5, v195
    v_add_u32 v179, 37888, v177
    v_add_u32 v181, 75776, v177
    v_add_u32 v183, 113664, v177
    v_lshlrev_b32 v190, 10, v194
    v_lshl_add_u32 v190, v193, 4, v190
    s_lshl_b32 s20, s15, 6
    v_add_u32 v190, s20, v190
    v_cmp_gt_u32 vcc, 7, v194
    v_mov_b32 v191, 0x80000000
    s_nop 0
    v_cndmask_b32 v191, v191, v190, vcc
    s_mul_i32 s48, s11, 720896
    s_mul_i32 s20, s13, 180224
    s_add_u32 s48, s48, s20
    s_lshl_b32 s20, s14, 8
    s_add_u32 s48, s48, s20
    s_add_u32 s48, s48, 117440512
    s_waitcnt lgkmcnt(0)
    s_mov_b32 s16, s8
    s_and_b32 s17, s9, 0xffff
    s_mov_b32 s18, 268435456
    s_mov_b32 s19, 0x00020000
    s_cmp_ge_u32 s10, 4
    s_cbranch_scc1 L_k3_mh1
    s_add_u32 m0, s42, 0
    s_nop 0
    buffer_load_dwordx4 v188, s[16:19], s40 offen lds
    buffer_load_dwordx4 v188, s[16:19], s40 offen offset:1024 lds
    s_add_u32 s40, s40, 16384
    s_add_u32 m0, s43, 0
    s_nop 0
    buffer_load_dwordx4 v189, s[16:19], s41 offen lds
    buffer_load_dwordx4 v189, s[16:19], s41 offen offset:1024 lds
    s_mov_b64 exec, s[44:45]
    buffer_load_dwordx4 v189, s[16:19], s41 offen offset:2048 lds
    s_mov_b64 exec, -1
    s_add_u32 s41, s41, 21504
    s_add_u32 m0, s42, 37888
    s_nop 0
    buffer_load_dwordx4 v188, s[16:19], s40 offen lds
    buffer_load_dwordx4 v188, s[16:19], s40 offen offset:1024 lds
    s_add_u32 s40, s40, 16384
    s_add_u32 m0, s43, 37888
    s_nop 0
    buffer_load_dwordx4 v189, s[16:19], s41 offen lds
    buffer_load_dwordx4 v189, s[16:19], s41 offen offset:1024 lds
    s_mov_b64 exec, s[44:45]
    buffer_load_dwordx4 v189, s[16:19], s41 offen offset:2048 lds
    s_mov_b64 exec, -1
    s_add_u32 s41, s41, 21504
    s_add_u32 m0, s42, 75776
    s_nop 0
    buffer_load_dwordx4 v188, s[16:19], s40 offen lds
    buffer_load_dwordx4 v188, s[16:19], s40 offen offset:1024 lds
    s_add_u32 s40, s40, 16384
    s_add_u32 m0, s43, 75776
    s_nop 0
    buffer_load_dwordx4 v189, s[16:19], s41 offen lds
    buffer_load_dwordx4 v189, s[16:19], s41 offen offset:1024 lds
    s_mov_b64 exec, s[44:45]
    buffer_load_dwordx4 v189, s[16:19], s41 offen offset:2048 lds
    s_mov_b64 exec, -1
    s_add_u32 s41, s41, 21504
    v_mov_b32 v0, 0
    v_mov_b32 v1, 0
    v_mov_b32 v2, 0
    v_mov_b32 v3, 0
    v_mov_b32 v4, 0
    v_mov_b32 v5, 0
    v_mov_b32 v6, 0
    v_mov_b32 v7, 0
    v_mov_b32 v8, 0
    v_mov_b32 v9, 0
    v_mov_b32 v10, 0
    v_mov_b32 v11, 0
    v_mov_b32 v12, 0
    v_mov_b32 v13, 0
    v_mov_b32 v14, 0
    v_mov_b32 v15, 0
    v_mov_b32 v16, 0
    v_mov_b32 v17, 0
    v_mov_b32 v18, 0
    v_mov_b32 v19, 0
    v_mov_b32 v20, 0
    v_mov_b32 v21, 0
    v_mov_b32 v22, 0
    v_mov_b32 v23, 0
    v_mov_b32 v24, 0
    v_mov_b32 v25, 0
    v_mov_b32 v26, 0
    v_mov_b32 v27, 0
    v_mov_b32 v28, 0
    v_mov_b32 v29, 0
    v_mov_b32 v30, 0
    v_mov_b32 v31, 0
    v_mov_b32 v32, 0
    v_mov_b32 v33, 0
    v_mov_b32 v34, 0
    v_mov_b32 v35, 0
    v_mov_b32 v36, 0
    v_mov_b32 v37, 0
    v_mov_b32 v38, 0
    v_mov_b32 v39, 0
    v_mov_b32 v40, 0
    v_mov_b32 v41, 0
    v_mov_b32 v42, 0
    v_mov_b32 v43, 0
    v_mov_b32 v44, 0
    v_mov_b32 v45, 0
    v_mov_b32 v46, 0
    v_mov_b32 v47, 0
    v_mov_b32 v48, 0
    v_mov_b32 v49, 0
    v_mov_b32 v50, 0
    v_mov_b32 v51, 0
    v_mov_b32 v52, 0
    v_mov_b32 v53, 0
    v_mov_b32 v54, 0
    v_mov_b32 v55, 0
    v_mov_b32 v56, 0
    v_mov_b32 v57, 0
    v_mov_b32 v58, 0
    v_mov_b32 v59, 0
    v_mov_b32 v60, 0
    v_mov_b32 v61, 0
    v_mov_b32 v62, 0
    v_mov_b32 v63, 0
    v_mov_b32 v64, 0
    v_mov_b32 v65, 0
    v_mov_b32 v66, 0
    v_mov_b32 v67, 0
    v_mov_b32 v68, 0
    v_mov_b32 v69, 0
    v_mov_b32 v70, 0
    v_mov_b32 v71, 0
    v_mov_b32 v72, 0
    v_mov_b32 v73, 0
    v_mov_b32 v74, 0
    v_mov_b32 v75, 0
    v_mov_b32 v76, 0
    v_mov_b32 v77, 0
    v_mov_b32 v78, 0
    v_mov_b32 v79, 0
    v_mov_b32 v80, 0
    v_mov_b32 v81, 0
    v_mov_b32 v82, 0
    v_mov_b32 v83, 0
    v_mov_b32 v84, 0
    v_mov_b32 v85, 0
    v_mov_b32 v86, 0
    v_mov_b32 v87, 0
    v_mov_b32 v88, 0
    v_mov_b32 v89, 0
    v_mov_b32 v90, 0
    v_mov_b32 v91, 0
    v_mov_b32 v92, 0
    v_mov_b32 v93, 0
    v_mov_b32 v94, 0
    v_mov_b32 v95, 0
    s_waitcnt vmcnt(10)
    s_barrier
    ds_read_b64_tr_b16 v[96:97], v176 offset:0
    ds_read_b64_tr_b16 v[98:99], v176 offset:1024
    ds_read_b64_tr_b16 v[100:101], v177 offset:0
    ds_read_b64_tr_b16 v[102:103], v177 offset:1024
    ds_read_b64_tr_b16 v[104:105], v176 offset:8192
    ds_read_b64_tr_b16 v[106:107], v176 offset:9216
    ds_read_b64_tr_b16 v[108:109], v177 offset:8192
    ds_read_b64_tr_b16 v[110:111], v177 offset:9216
    ds_read_b128 v[144:147], v184 offset:16384
    ds_read_b128 v[148:151], v184 offset:27136
    ds_read_b128 v[152:155], v184 offset:17408
    ds_read_b128 v[156:159], v184 offset:28160
    s_waitcnt lgkmcnt(4)
    v_xor_b32 v112, 0x80008000, v104
    v_xor_b32 v113, 0x80008000, v105
    v_xor_b32 v114, 0x80008000, v106
    v_xor_b32 v115, 0x80008000, v107
    v_xor_b32 v116, 0x80008000, v108
    v_xor_b32 v117, 0x80008000, v109
    v_xor_b32 v118, 0x80008000, v110
    v_xor_b32 v119, 0x80008000, v111
    s_mov_b32 s46, 7
L_k3_loop0:
    s_waitcnt vmcnt(5)
    s_barrier
    s_waitcnt lgkmcnt(2)
    v_mfma_f32_16x16x32_bf16 v[0:3], v[96:99], v[144:147], v[0:3]
    ds_read_b128 v[160:163], v184 offset:18432
    ds_read_b128 v[164:167], v184 offset:29184
    v_mfma_f32_16x16x32_bf16 v[4:7], v[100:103], v[144:147], v[4:7]
    v_mfma_f32_16x16x32_bf16 v[8:11], v[112:115], v[144:147], v[8:11]
    v_mfma_f32_16x16x32_bf16 v[12:15], v[116:119], v[144:147], v[12:15]
    s_add_u32 m0, s42, 113664
    s_nop 0
    buffer_load_dwordx4 v188, s[16:19], s40 offen lds
    v_mfma_f32_16x16x32_bf16 v[0:3], v[104:107], v[148:151], v[0:3]
    v_mfma_f32_16x16x32_bf16 v[4:7], v[108:111], v[148:151], v[4:7]
    v_mfma_f32_16x16x32_bf16 v[8:11], v[96:99], v[148:151], v[8:11]
    v_mfma_f32_16x16x32_bf16 v[12:15], v[100:103], v[148:151], v[12:15]
    s_waitcnt lgkmcnt(2)
    v_mfma_f32_16x16x32_bf16 v[16:19], v[96:99], v[152:155], v[16:19]
    ds_read_b128 v[168:171], v184 offset:19456
    ds_read_b128 v[172:175], v184 offset:30208
    v_mfma_f32_16x16x32_bf16 v[20:23], v[100:103], v[152:155], v[20:23]
    v_mfma_f32_16x16x32_bf16 v[24:27], v[112:115], v[152:155], v[24:27]
    v_mfma_f32_16x16x32_bf16 v[28:31], v[116:119], v[152:155], v[28:31]
    buffer_load_dwordx4 v188, s[16:19], s40 offen offset:1024 lds
    s_add_u32 s40, s40, 16384
    v_mfma_f32_16x16x32_bf16 v[16:19], v[104:107], v[156:159], v[16:19]
    v_mfma_f32_16x16x32_bf16 v[20:23], v[108:111], v[156:159], v[20:23]
    v_mfma_f32_16x16x32_bf16 v[24:27], v[96:99], v[156:159], v[24:27]
    v_mfma_f32_16x16x32_bf16 v[28:31], v[100:103], v[156:159], v[28:31]
    s_waitcnt lgkmcnt(2)
    v_mfma_f32_16x16x32_bf16 v[32:35], v[96:99], v[160:163], v[32:35]
    ds_read_b128 v[144:147], v184 offset:20480
    ds_read_b128 v[148:151], v184 offset:31232
    v_mfma_f32_16x16x32_bf16 v[36:39], v[100:103], v[160:163], v[36:39]
    v_mfma_f32_16x16x32_bf16 v[40:43], v[112:115], v[160:163], v[40:43]
    v_mfma_f32_16x16x32_bf16 v[44:47], v[116:119], v[160:163], v[44:47]
    s_add_u32 m0, s43, 113664
    s_nop 0
    buffer_load_dwordx4 v189, s[16:19], s41 offen lds
    v_mfma_f32_16x16x32_bf16 v[32:35], v[104:107], v[164:167], v[32:35]
    v_mfma_f32_16x16x32_bf16 v[36:39], v[108:111], v[164:167], v[36:39]
    v_mfma_f32_16x16x32_bf16 v[40:43], v[96:99], v[164:167], v[40:43]
    v_mfma_f32_16x16x32_bf16 v[44:47], v[100:103], v[164:167], v[44:47]
    s_waitcnt lgkmcnt(2)
    v_mfma_f32_16x16x32_bf16 v[48:51], v[96:99], v[168:171], v[48:51]
    ds_read_b128 v[152:155], v184 offset:21504
    ds_read_b128 v[156:159], v184 offset:32256
    v_mfma_f32_16x16x32_bf16 v[52:55], v[100:103], v[168:171], v[52:55]
    v_mfma_f32_16x16x32_bf16 v[56:59], v[112:115], v[168:171], v[56:59]
    ds_read_b64_tr_b16 v[120:121], v178 offset:0
    ds_read_b64_tr_b16 v[122:123], v178 offset:1024
    ds_read_b64_tr_b16 v[124:125], v179 offset:0
    ds_read_b64_tr_b16 v[126:127], v179 offset:1024
    v_mfma_f32_16x16x32_bf16 v[60:63], v[116:119], v[168:171], v[60:63]
    buffer_load_dwordx4 v189, s[16:19], s41 offen offset:1024 lds
    v_mfma_f32_16x16x32_bf16 v[48:51], v[104:107], v[172:175], v[48:51]
    v_mfma_f32_16x16x32_bf16 v[52:55], v[108:111], v[172:175], v[52:55]
    v_mfma_f32_16x16x32_bf16 v[56:59], v[96:99], v[172:175], v[56:59]
    v_mfma_f32_16x16x32_bf16 v[60:63], v[100:103], v[172:175], v[60:63]
    s_waitcnt lgkmcnt(6)
    v_mfma_f32_16x16x32_bf16 v[64:67], v[96:99], v[144:147], v[64:67]
    ds_read_b128 v[160:163], v185 offset:16384
    ds_read_b128 v[164:167], v185 offset:27136
    v_mfma_f32_16x16x32_bf16 v[68:71], v[100:103], v[144:147], v[68:71]
    v_mfma_f32_16x16x32_bf16 v[72:75], v[112:115], v[144:147], v[72:75]
    ds_read_b64_tr_b16 v[128:129], v178 offset:8192
    ds_read_b64_tr_b16 v[130:131], v178 offset:9216
    ds_read_b64_tr_b16 v[132:133], v179 offset:8192
    ds_read_b64_tr_b16 v[134:135], v179 offset:9216
    v_mfma_f32_16x16x32_bf16 v[76:79], v[116:119], v[144:147], v[76:79]
    s_mov_b64 exec, s[44:45]
    buffer_load_dwordx4 v189, s[16:19], s41 offen offset:2048 lds
    s_mov_b64 exec, -1
    s_add_u32 s41, s41, 21504
    v_mfma_f32_16x16x32_bf16 v[64:67], v[104:107], v[148:151], v[64:67]
    v_mfma_f32_16x16x32_bf16 v[68:71], v[108:111], v[148:151], v[68:71]
    v_mfma_f32_16x16x32_bf16 v[72:75], v[96:99], v[148:151], v[72:75]
    v_mfma_f32_16x16x32_bf16 v[76:79], v[100:103], v[148:151], v[76:79]
    s_waitcnt lgkmcnt(10)
    v_mfma_f32_16x16x32_bf16 v[80:83], v[96:99], v[152:155], v[80:83]
    ds_read_b128 v[168:171], v185 offset:17408
    ds_read_b128 v[172:175], v185 offset:28160
    v_mfma_f32_16x16x32_bf16 v[84:87], v[100:103], v[152:155], v[84:87]
    s_waitcnt lgkmcnt(2)
    v_mfma_f32_16x16x32_bf16 v[88:91], v[112:115], v[152:155], v[88:91]
    v_xor_b32 v136, 0x80008000, v128
    v_xor_b32 v137, 0x80008000, v129
    v_mfma_f32_16x16x32_bf16 v[92:95], v[116:119], v[152:155], v[92:95]
    v_xor_b32 v138, 0x80008000, v130
    v_xor_b32 v139, 0x80008000, v131
    v_mfma_f32_16x16x32_bf16 v[80:83], v[104:107], v[156:159], v[80:83]
    v_xor_b32 v140, 0x80008000, v132
    v_xor_b32 v141, 0x80008000, v133
    v_mfma_f32_16x16x32_bf16 v[84:87], v[108:111], v[156:159], v[84:87]
    v_xor_b32 v142, 0x80008000, v134
    v_xor_b32 v143, 0x80008000, v135
    v_mfma_f32_16x16x32_bf16 v[88:91], v[96:99], v[156:159], v[88:91]
    v_mfma_f32_16x16x32_bf16 v[92:95], v[100:103], v[156:159], v[92:95]
    s_waitcnt vmcnt(5)
    s_barrier
    v_mfma_f32_16x16x32_bf16 v[0:3], v[120:123], v[160:163], v[0:3]
    ds_read_b128 v[144:147], v185 offset:18432
    ds_read_b128 v[148:151], v185 offset:29184
    v_mfma_f32_16x16x32_bf16 v[4:7], v[124:127], v[160:163], v[4:7]
    v_mfma_f32_16x16x32_bf16 v[8:11], v[136:139], v[160:163], v[8:11]
    v_mfma_f32_16x16x32_bf16 v[12:15], v[140:143], v[160:163], v[12:15]
    s_add_u32 m0, s42, 0
    s_nop 0
    buffer_load_dwordx4 v188, s[16:19], s40 offen lds
    v_mfma_f32_16x16x32_bf16 v[0:3], v[128:131], v[164:167], v[0:3]
    v_mfma_f32_16x16x32_bf16 v[4:7], v[132:135], v[164:167], v[4:7]
    v_mfma_f32_16x16x32_bf16 v[8:11], v[120:123], v[164:167], v[8:11]
    v_mfma_f32_16x16x32_bf16 v[12:15], v[124:127], v[164:167], v[12:15]
    s_waitcnt lgkmcnt(2)
    v_mfma_f32_16x16x32_bf16 v[16:19], v[120:123], v[168:171], v[16:19]
    ds_read_b128 v[152:155], v185 offset:19456
    ds_read_b128 v[156:159], v185 offset:30208
    v_mfma_f32_16x16x32_bf16 v[20:23], v[124:127], v[168:171], v[20:23]
    v_mfma_f32_16x16x32_bf16 v[24:27], v[136:139], v[168:171], v[24:27]
    v_mfma_f32_16x16x32_bf16 v[28:31], v[140:143], v[168:171], v[28:31]
    buffer_load_dwordx4 v188, s[16:19], s40 offen offset:1024 lds
    s_add_u32 s40, s40, 16384
    v_mfma_f32_16x16x32_bf16 v[16:19], v[128:131], v[172:175], v[16:19]
    v_mfma_f32_16x16x32_bf16 v[20:23], v[132:135], v[172:175], v[20:23]
    v_mfma_f32_16x16x32_bf16 v[24:27], v[120:123], v[172:175], v[24:27]
    v_mfma_f32_16x16x32_bf16 v[28:31], v[124:127], v[172:175], v[28:31]
    s_waitcnt lgkmcnt(2)
    v_mfma_f32_16x16x32_bf16 v[32:35], v[120:123], v[144:147], v[32:35]
    ds_read_b128 v[160:163], v185 offset:20480
    ds_read_b128 v[164:167], v185 offset:31232
    v_mfma_f32_16x16x32_bf16 v[36:39], v[124:127], v[144:147], v[36:39]
    v_mfma_f32_16x16x32_bf16 v[40:43], v[136:139], v[144:147], v[40:43]
    v_mfma_f32_16x16x32_bf16 v[44:47], v[140:143], v[144:147], v[44:47]
    s_add_u32 m0, s43, 0
    s_nop 0
    buffer_load_dwordx4 v189, s[16:19], s41 offen lds
    v_mfma_f32_16x16x32_bf16 v[32:35], v[128:131], v[148:151], v[32:35]
    v_mfma_f32_16x16x32_bf16 v[36:39], v[132:135], v[148:151], v[36:39]
    v_mfma_f32_16x16x32_bf16 v[40:43], v[120:123], v[148:151], v[40:43]
    v_mfma_f32_16x16x32_bf16 v[44:47], v[124:127], v[148:151], v[44:47]
    s_waitcnt lgkmcnt(2)
    v_mfma_f32_16x16x32_bf16 v[48:51], v[120:123], v[152:155], v[48:51]
    ds_read_b128 v[168:171], v185 offset:21504
    ds_read_b128 v[172:175], v185 offset:32256
    v_mfma_f32_16x16x32_bf16 v[52:55], v[124:127], v[152:155], v[52:55]
    v_mfma_f32_16x16x32_bf16 v[56:59], v[136:139], v[152:155], v[56:59]
    ds_read_b64_tr_b16 v[96:97], v180 offset:0
    ds_read_b64_tr_b16 v[98:99], v180 offset:1024
    ds_read_b64_tr_b16 v[100:101], v181 offset:0
    ds_read_b64_tr_b16 v[102:103], v181 offset:1024
    v_mfma_f32_16x16x32_bf16 v[60:63], v[140:143], v[152:155], v[60:63]
    buffer_load_dwordx4 v189, s[16:19], s41 offen offset:1024 lds
    v_mfma_f32_16x16x32_bf16 v[48:51], v[128:131], v[156:159], v[48:51]
    v_mfma_f32_16x16x32_bf16 v[52:55], v[132:135], v[156:159], v[52:55]
    v_mfma_f32_16x16x32_bf16 v[56:59], v[120:123], v[156:159], v[56:59]
    v_mfma_f32_16x16x32_bf16 v[60:63], v[124:127], v[156:159], v[60:63]
    s_waitcnt lgkmcnt(6)
    v_mfma_f32_16x16x32_bf16 v[64:67], v[120:123], v[160:163], v[64:67]
    ds_read_b128 v[144:147], v186 offset:16384
    ds_read_b128 v[148:151], v186 offset:27136
    v_mfma_f32_16x16x32_bf16 v[68:71], v[124:127], v[160:163], v[68:71]
    v_mfma_f32_16x16x32_bf16 v[72:75], v[136:139], v[160:163], v[72:75]
    ds_read_b64_tr_b16 v[104:105], v180 offset:8192
    ds_read_b64_tr_b16 v[106:107], v180 offset:9216
    ds_read_b64_tr_b16 v[108:109], v181 offset:8192
    ds_read_b64_tr_b16 v[110:111], v181 offset:9216
    v_mfma_f32_16x16x32_bf16 v[76:79], v[140:143], v[160:163], v[76:79]
    s_mov_b64 exec, s[44:45]
    buffer_load_dwordx4 v189, s[16:19], s41 offen offset:2048 lds
    s_mov_b64 exec, -1
    s_add_u32 s41, s41, 21504
    v_mfma_f32_16x16x32_bf16 v[64:67], v[128:131], v[164:167], v[64:67]
    v_mfma_f32_16x16x32_bf16 v[68:71], v[132:135], v[164:167], v[68:71]
    v_mfma_f32_16x16x32_bf16 v[72:75], v[120:123], v[164:167], v[72:75]
    v_mfma_f32_16x16x32_bf16 v[76:79], v[124:127], v[164:167], v[76:79]
    s_waitcnt lgkmcnt(10)
    v_mfma_f32_16x16x32_bf16 v[80:83], v[120:123], v[168:171], v[80:83]
    ds_read_b128 v[152:155], v186 offset:17408
    ds_read_b128 v[156:159], v186 offset:28160
    v_mfma_f32_16x16x32_bf16 v[84:87], v[124:127], v[168:171], v[84:87]
    s_waitcnt lgkmcnt(2)
    v_mfma_f32_16x16x32_bf16 v[88:91], v[136:139], v[168:171], v[88:91]
    v_xor_b32 v112, 0x80008000, v104
    v_xor_b32 v113, 0x80008000, v105
    v_mfma_f32_16x16x32_bf16 v[92:95], v[140:143], v[168:171], v[92:95]
    v_xor_b32 v114, 0x80008000, v106
    v_xor_b32 v115, 0x80008000, v107
    v_mfma_f32_16x16x32_bf16 v[80:83], v[128:131], v[172:175], v[80:83]
    v_xor_b32 v116, 0x80008000, v108
    v_xor_b32 v117, 0x80008000, v109
    v_mfma_f32_16x16x32_bf16 v[84:87], v[132:135], v[172:175], v[84:87]
    v_xor_b32 v118, 0x80008000, v110
    v_xor_b32 v119, 0x80008000, v111
    v_mfma_f32_16x16x32_bf16 v[88:91], v[120:123], v[172:175], v[88:91]
    v_mfma_f32_16x16x32_bf16 v[92:95], v[124:127], v[172:175], v[92:95]
    s_waitcnt vmcnt(5)
    s_barrier
    v_mfma_f32_16x16x32_bf16 v[0:3], v[96:99], v[144:147], v[0:3]
    ds_read_b128 v[160:163], v186 offset:18432
    ds_read_b128 v[164:167], v186 offset:29184
    v_mfma_f32_16x16x32_bf16 v[4:7], v[100:103], v[144:147], v[4:7]
    v_mfma_f32_16x16x32_bf16 v[8:11], v[112:115], v[144:147], v[8:11]
    v_mfma_f32_16x16x32_bf16 v[12:15], v[116:119], v[144:147], v[12:15]
    s_add_u32 m0, s42, 37888
    s_nop 0
    buffer_load_dwordx4 v188, s[16:19], s40 offen lds
    v_mfma_f32_16x16x32_bf16 v[0:3], v[104:107], v[148:151], v[0:3]
    v_mfma_f32_16x16x32_bf16 v[4:7], v[108:111], v[148:151], v[4:7]
    v_mfma_f32_16x16x32_bf16 v[8:11], v[96:99], v[148:151], v[8:11]
    v_mfma_f32_16x16x32_bf16 v[12:15], v[100:103], v[148:151], v[12:15]
    s_waitcnt lgkmcnt(2)
    v_mfma_f32_16x16x32_bf16 v[16:19], v[96:99], v[152:155], v[16:19]
    ds_read_b128 v[168:171], v186 offset:19456
    ds_read_b128 v[172:175], v186 offset:30208
    v_mfma_f32_16x16x32_bf16 v[20:23], v[100:103], v[152:155], v[20:23]
    v_mfma_f32_16x16x32_bf16 v[24:27], v[112:115], v[152:155], v[24:27]
    v_mfma_f32_16x16x32_bf16 v[28:31], v[116:119], v[152:155], v[28:31]
    buffer_load_dwordx4 v188, s[16:19], s40 offen offset:1024 lds
    s_add_u32 s40, s40, 16384
    v_mfma_f32_16x16x32_bf16 v[16:19], v[104:107], v[156:159], v[16:19]
    v_mfma_f32_16x16x32_bf16 v[20:23], v[108:111], v[156:159], v[20:23]
    v_mfma_f32_16x16x32_bf16 v[24:27], v[96:99], v[156:159], v[24:27]
    v_mfma_f32_16x16x32_bf16 v[28:31], v[100:103], v[156:159], v[28:31]
    s_waitcnt lgkmcnt(2)
    v_mfma_f32_16x16x32_bf16 v[32:35], v[96:99], v[160:163], v[32:35]
    ds_read_b128 v[144:147], v186 offset:20480
    ds_read_b128 v[148:151], v186 offset:31232
    v_mfma_f32_16x16x32_bf16 v[36:39], v[100:103], v[160:163], v[36:39]
    v_mfma_f32_16x16x32_bf16 v[40:43], v[112:115], v[160:163], v[40:43]
    v_mfma_f32_16x16x32_bf16 v[44:47], v[116:119], v[160:163], v[44:47]
    s_add_u32 m0, s43, 37888
    s_nop 0
    buffer_load_dwordx4 v189, s[16:19], s41 offen lds
    v_mfma_f32_16x16x32_bf16 v[32:35], v[104:107], v[164:167], v[32:35]
    v_mfma_f32_16x16x32_bf16 v[36:39], v[108:111], v[164:167], v[36:39]
    v_mfma_f32_16x16x32_bf16 v[40:43], v[96:99], v[164:167], v[40:43]
    v_mfma_f32_16x16x32_bf16 v[44:47], v[100:103], v[164:167], v[44:47]
    s_waitcnt lgkmcnt(2)
    v_mfma_f32_16x16x32_bf16 v[48:51], v[96:99], v[168:171], v[48:51]
    ds_read_b128 v[152:155], v186 offset:21504
    ds_read_b128 v[156:159], v186 offset:32256
    v_mfma_f32_16x16x32_bf16 v[52:55], v[100:103], v[168:171], v[52:55]
    v_mfma_f32_16x16x32_bf16 v[56:59], v[112:115], v[168:171], v[56:59]
    ds_read_b64_tr_b16 v[120:121], v182 offset:0
    ds_read_b64_tr_b16 v[122:123], v182 offset:1024
    ds_read_b64_tr_b16 v[124:125], v183 offset:0
    ds_read_b64_tr_b16 v[126:127], v183 offset:1024
    v_mfma_f32_16x16x32_bf16 v[60:63], v[116:119], v[168:171], v[60:63]
    buffer_load_dwordx4 v189, s[16:19], s41 offen offset:1024 lds
    v_mfma_f32_16x16x32_bf16 v[48:51], v[104:107], v[172:175], v[48:51]
    v_mfma_f32_16x16x32_bf16 v[52:55], v[108:111], v[172:175], v[52:55]
    v_mfma_f32_16x16x32_bf16 v[56:59], v[96:99], v[172:175], v[56:59]
    v_mfma_f32_16x16x32_bf16 v[60:63], v[100:103], v[172:175], v[60:63]
    s_waitcnt lgkmcnt(6)
    v_mfma_f32_16x16x32_bf16 v[64:67], v[96:99], v[144:147], v[64:67]
    ds_read_b128 v[160:163], v187 offset:16384
    ds_read_b128 v[164:167], v187 offset:27136
    v_mfma_f32_16x16x32_bf16 v[68:71], v[100:103], v[144:147], v[68:71]
    v_mfma_f32_16x16x32_bf16 v[72:75], v[112:115], v[144:147], v[72:75]
    ds_read_b64_tr_b16 v[128:129], v182 offset:8192
    ds_read_b64_tr_b16 v[130:131], v182 offset:9216
    ds_read_b64_tr_b16 v[132:133], v183 offset:8192
    ds_read_b64_tr_b16 v[134:135], v183 offset:9216
    v_mfma_f32_16x16x32_bf16 v[76:79], v[116:119], v[144:147], v[76:79]
    s_mov_b64 exec, s[44:45]
    buffer_load_dwordx4 v189, s[16:19], s41 offen offset:2048 lds
    s_mov_b64 exec, -1
    s_add_u32 s41, s41, 21504
    v_mfma_f32_16x16x32_bf16 v[64:67], v[104:107], v[148:151], v[64:67]
    v_mfma_f32_16x16x32_bf16 v[68:71], v[108:111], v[148:151], v[68:71]
    v_mfma_f32_16x16x32_bf16 v[72:75], v[96:99], v[148:151], v[72:75]
    v_mfma_f32_16x16x32_bf16 v[76:79], v[100:103], v[148:151], v[76:79]
    s_waitcnt lgkmcnt(10)
    v_mfma_f32_16x16x32_bf16 v[80:83], v[96:99], v[152:155], v[80:83]
    ds_read_b128 v[168:171], v187 offset:17408
    ds_read_b128 v[172:175], v187 offset:28160
    v_mfma_f32_16x16x32_bf16 v[84:87], v[100:103], v[152:155], v[84:87]
    s_waitcnt lgkmcnt(2)
    v_mfma_f32_16x16x32_bf16 v[88:91], v[112:115], v[152:155], v[88:91]
    v_xor_b32 v136, 0x80008000, v128
    v_xor_b32 v137, 0x80008000, v129
    v_mfma_f32_16x16x32_bf16 v[92:95], v[116:119], v[152:155], v[92:95]
    v_xor_b32 v138, 0x80008000, v130
    v_xor_b32 v139, 0x80008000, v131
    v_mfma_f32_16x16x32_bf16 v[80:83], v[104:107], v[156:159], v[80:83]
    v_xor_b32 v140, 0x80008000, v132
    v_xor_b32 v141, 0x80008000, v133
    v_mfma_f32_16x16x32_bf16 v[84:87], v[108:111], v[156:159], v[84:87]
    v_xor_b32 v142, 0x80008000, v134
    v_xor_b32 v143, 0x80008000, v135
    v_mfma_f32_16x16x32_bf16 v[88:91], v[96:99], v[156:159], v[88:91]
    v_mfma_f32_16x16x32_bf16 v[92:95], v[100:103], v[156:159], v[92:95]
    s_waitcnt vmcnt(5)
    s_barrier
    v_mfma_f32_16x16x32_bf16 v[0:3], v[120:123], v[160:163], v[0:3]
    ds_read_b128 v[144:147], v187 offset:18432
    ds_read_b128 v[148:151], v187 offset:29184
    v_mfma_f32_16x16x32_bf16 v[4:7], v[124:127], v[160:163], v[4:7]
    v_mfma_f32_16x16x32_bf16 v[8:11], v[136:139], v[160:163], v[8:11]
    v_mfma_f32_16x16x32_bf16 v[12:15], v[140:143], v[160:163], v[12:15]
    s_add_u32 m0, s42, 75776
    s_nop 0
    buffer_load_dwordx4 v188, s[16:19], s40 offen lds
    v_mfma_f32_16x16x32_bf16 v[0:3], v[128:131], v[164:167], v[0:3]
    v_mfma_f32_16x16x32_bf16 v[4:7], v[132:135], v[164:167], v[4:7]
    v_mfma_f32_16x16x32_bf16 v[8:11], v[120:123], v[164:167], v[8:11]
    v_mfma_f32_16x16x32_bf16 v[12:15], v[124:127], v[164:167], v[12:15]
    s_waitcnt lgkmcnt(2)
    v_mfma_f32_16x16x32_bf16 v[16:19], v[120:123], v[168:171], v[16:19]
    ds_read_b128 v[152:155], v187 offset:19456
    ds_read_b128 v[156:159], v187 offset:30208
    v_mfma_f32_16x16x32_bf16 v[20:23], v[124:127], v[168:171], v[20:23]
    v_mfma_f32_16x16x32_bf16 v[24:27], v[136:139], v[168:171], v[24:27]
    v_mfma_f32_16x16x32_bf16 v[28:31], v[140:143], v[168:171], v[28:31]
    buffer_load_dwordx4 v188, s[16:19], s40 offen offset:1024 lds
    s_add_u32 s40, s40, 16384
    v_mfma_f32_16x16x32_bf16 v[16:19], v[128:131], v[172:175], v[16:19]
    v_mfma_f32_16x16x32_bf16 v[20:23], v[132:135], v[172:175], v[20:23]
    v_mfma_f32_16x16x32_bf16 v[24:27], v[120:123], v[172:175], v[24:27]
    v_mfma_f32_16x16x32_bf16 v[28:31], v[124:127], v[172:175], v[28:31]
    s_waitcnt lgkmcnt(2)
    v_mfma_f32_16x16x32_bf16 v[32:35], v[120:123], v[144:147], v[32:35]
    ds_read_b128 v[160:163], v187 offset:20480
    ds_read_b128 v[164:167], v187 offset:31232
    v_mfma_f32_16x16x32_bf16 v[36:39], v[124:127], v[144:147], v[36:39]
    v_mfma_f32_16x16x32_bf16 v[40:43], v[136:139], v[144:147], v[40:43]
    v_mfma_f32_16x16x32_bf16 v[44:47], v[140:143], v[144:147], v[44:47]
    s_add_u32 m0, s43, 75776
    s_nop 0
    buffer_load_dwordx4 v189, s[16:19], s41 offen lds
    v_mfma_f32_16x16x32_bf16 v[32:35], v[128:131], v[148:151], v[32:35]
    v_mfma_f32_16x16x32_bf16 v[36:39], v[132:135], v[148:151], v[36:39]
    v_mfma_f32_16x16x32_bf16 v[40:43], v[120:123], v[148:151], v[40:43]
    v_mfma_f32_16x16x32_bf16 v[44:47], v[124:127], v[148:151], v[44:47]
    s_waitcnt lgkmcnt(2)
    v_mfma_f32_16x16x32_bf16 v[48:51], v[120:123], v[152:155], v[48:51]
    ds_read_b128 v[168:171], v187 offset:21504
    ds_read_b128 v[172:175], v187 offset:32256
    v_mfma_f32_16x16x32_bf16 v[52:55], v[124:127], v[152:155], v[52:55]
    v_mfma_f32_16x16x32_bf16 v[56:59], v[136:139], v[152:155], v[56:59]
    ds_read_b64_tr_b16 v[96:97], v176 offset:0
    ds_read_b64_tr_b16 v[98:99], v176 offset:1024
    ds_read_b64_tr_b16 v[100:101], v177 offset:0
    ds_read_b64_tr_b16 v[102:103], v177 offset:1024
    v_mfma_f32_16x16x32_bf16 v[60:63], v[140:143], v[152:155], v[60:63]
    buffer_load_dwordx4 v189, s[16:19], s41 offen offset:1024 lds
    v_mfma_f32_16x16x32_bf16 v[48:51], v[128:131], v[156:159], v[48:51]
    v_mfma_f32_16x16x32_bf16 v[52:55], v[132:135], v[156:159], v[52:55]
    v_mfma_f32_16x16x32_bf16 v[56:59], v[120:123], v[156:159], v[56:59]
    v_mfma_f32_16x16x32_bf16 v[60:63], v[124:127], v[156:159], v[60:63]
    s_waitcnt lgkmcnt(6)
    v_mfma_f32_16x16x32_bf16 v[64:67], v[120:123], v[160:163], v[64:67]
    ds_read_b128 v[144:147], v184 offset:16384
    ds_read_b128 v[148:151], v184 offset:27136
    v_mfma_f32_16x16x32_bf16 v[68:71], v[124:127], v[160:163], v[68:71]
    v_mfma_f32_16x16x32_bf16 v[72:75], v[136:139], v[160:163], v[72:75]
    ds_read_b64_tr_b16 v[104:105], v176 offset:8192
    ds_read_b64_tr_b16 v[106:107], v176 offset:9216
    ds_read_b64_tr_b16 v[108:109], v177 offset:8192
    ds_read_b64_tr_b16 v[110:111], v177 offset:9216
    v_mfma_f32_16x16x32_bf16 v[76:79], v[140:143], v[160:163], v[76:79]
    s_mov_b64 exec, s[44:45]
    buffer_load_dwordx4 v189, s[16:19], s41 offen offset:2048 lds
    s_mov_b64 exec, -1
    s_add_u32 s41, s41, 21504
    v_mfma_f32_16x16x32_bf16 v[64:67], v[128:131], v[164:167], v[64:67]
    v_mfma_f32_16x16x32_bf16 v[68:71], v[132:135], v[164:167], v[68:71]
    v_mfma_f32_16x16x32_bf16 v[72:75], v[120:123], v[164:167], v[72:75]
    v_mfma_f32_16x16x32_bf16 v[76:79], v[124:127], v[164:167], v[76:79]
    s_waitcnt lgkmcnt(10)
    v_mfma_f32_16x16x32_bf16 v[80:83], v[120:123], v[168:171], v[80:83]
    ds_read_b128 v[152:155], v184 offset:17408
    ds_read_b128 v[156:159], v184 offset:28160
    v_mfma_f32_16x16x32_bf16 v[84:87], v[124:127], v[168:171], v[84:87]
    s_waitcnt lgkmcnt(2)
    v_mfma_f32_16x16x32_bf16 v[88:91], v[136:139], v[168:171], v[88:91]
    v_xor_b32 v112, 0x80008000, v104
    v_xor_b32 v113, 0x80008000, v105
    v_mfma_f32_16x16x32_bf16 v[92:95], v[140:143], v[168:171], v[92:95]
    v_xor_b32 v114, 0x80008000, v106
    v_xor_b32 v115, 0x80008000, v107
    v_mfma_f32_16x16x32_bf16 v[80:83], v[128:131], v[172:175], v[80:83]
    v_xor_b32 v116, 0x80008000, v108
    v_xor_b32 v117, 0x80008000, v109
    v_mfma_f32_16x16x32_bf16 v[84:87], v[132:135], v[172:175], v[84:87]
    v_xor_b32 v118, 0x80008000, v110
    v_xor_b32 v119, 0x80008000, v111
    v_mfma_f32_16x16x32_bf16 v[88:91], v[120:123], v[172:175], v[88:91]
    v_mfma_f32_16x16x32_bf16 v[92:95], v[124:127], v[172:175], v[92:95]
    s_sub_u32 s46, s46, 1
    s_cmp_lg_u32 s46, 0
    s_cbranch_scc1 L_k3_loop0
    s_waitcnt vmcnt(5)
    s_barrier
    v_mfma_f32_16x16x32_bf16 v[0:3], v[96:99], v[144:147], v[0:3]
    ds_read_b128 v[160:163], v184 offset:18432
    ds_read_b128 v[164:167], v184 offset:29184
    v_mfma_f32_16x16x32_bf16 v[4:7], v[100:103], v[144:147], v[4:7]
    v_mfma_f32_16x16x32_bf16 v[8:11], v[112:115], v[144:147], v[8:11]
    v_mfma_f32_16x16x32_bf16 v[12:15], v[116:119], v[144:147], v[12:15]
    s_add_u32 m0, s42, 113664
    s_nop 0
    buffer_load_dwordx4 v188, s[16:19], s40 offen lds
    v_mfma_f32_16x16x32_bf16 v[0:3], v[104:107], v[148:151], v[0:3]
    v_mfma_f32_16x16x32_bf16 v[4:7], v[108:111], v[148:151], v[4:7]
    v_mfma_f32_16x16x32_bf16 v[8:11], v[96:99], v[148:151], v[8:11]
    v_mfma_f32_16x16x32_bf16 v[12:15], v[100:103], v[148:151], v[12:15]
    s_waitcnt lgkmcnt(2)
    v_mfma_f32_16x16x32_bf16 v[16:19], v[96:99], v[152:155], v[16:19]
    ds_read_b128 v[168:171], v184 offset:19456
    ds_read_b128 v[172:175], v184 offset:30208
    v_mfma_f32_16x16x32_bf16 v[20:23], v[100:103], v[152:155], v[20:23]
    v_mfma_f32_16x16x32_bf16 v[24:27], v[112:115], v[152:155], v[24:27]
    v_mfma_f32_16x16x32_bf16 v[28:31], v[116:119], v[152:155], v[28:31]
    buffer_load_dwordx4 v188, s[16:19], s40 offen offset:1024 lds
    s_add_u32 s40, s40, 16384
    v_mfma_f32_16x16x32_bf16 v[16:19], v[104:107], v[156:159], v[16:19]
    v_mfma_f32_16x16x32_bf16 v[20:23], v[108:111], v[156:159], v[20:23]
    v_mfma_f32_16x16x32_bf16 v[24:27], v[96:99], v[156:159], v[24:27]
    v_mfma_f32_16x16x32_bf16 v[28:31], v[100:103], v[156:159], v[28:31]
    s_waitcnt lgkmcnt(2)
    v_mfma_f32_16x16x32_bf16 v[32:35], v[96:99], v[160:163], v[32:35]
    ds_read_b128 v[144:147], v184 offset:20480
    ds_read_b128 v[148:151], v184 offset:31232
    v_mfma_f32_16x16x32_bf16 v[36:39], v[100:103], v[160:163], v[36:39]
    v_mfma_f32_16x16x32_bf16 v[40:43], v[112:115], v[160:163], v[40:43]
    v_mfma_f32_16x16x32_bf16 v[44:47], v[116:119], v[160:163], v[44:47]
    s_add_u32 m0, s43, 113664
    s_nop 0
    buffer_load_dwordx4 v189, s[16:19], s41 offen lds
    v_mfma_f32_16x16x32_bf16 v[32:35], v[104:107], v[164:167], v[32:35]
    v_mfma_f32_16x16x32_bf16 v[36:39], v[108:111], v[164:167], v[36:39]
    v_mfma_f32_16x16x32_bf16 v[40:43], v[96:99], v[164:167], v[40:43]
    v_mfma_f32_16x16x32_bf16 v[44:47], v[100:103], v[164:167], v[44:47]
    s_waitcnt lgkmcnt(2)
    v_mfma_f32_16x16x32_bf16 v[48:51], v[96:99], v[168:171], v[48:51]
    ds_read_b128 v[152:155], v184 offset:21504
    ds_read_b128 v[156:159], v184 offset:32256
    v_mfma_f32_16x16x32_bf16 v[52:55], v[100:103], v[168:171], v[52:55]
    v_mfma_f32_16x16x32_bf16 v[56:59], v[112:115], v[168:171], v[56:59]
    ds_read_b64_tr_b16 v[120:121], v178 offset:0
    ds_read_b64_tr_b16 v[122:123], v178 offset:1024
    ds_read_b64_tr_b16 v[124:125], v179 offset:0
    ds_read_b64_tr_b16 v[126:127], v179 offset:1024
    v_mfma_f32_16x16x32_bf16 v[60:63], v[116:119], v[168:171], v[60:63]
    buffer_load_dwordx4 v189, s[16:19], s41 offen offset:1024 lds
    v_mfma_f32_16x16x32_bf16 v[48:51], v[104:107], v[172:175], v[48:51]
    v_mfma_f32_16x16x32_bf16 v[52:55], v[108:111], v[172:175], v[52:55]
    v_mfma_f32_16x16x32_bf16 v[56:59], v[96:99], v[172:175], v[56:59]
    v_mfma_f32_16x16x32_bf16 v[60:63], v[100:103], v[172:175], v[60:63]
    s_waitcnt lgkmcnt(6)
    v_mfma_f32_16x16x32_bf16 v[64:67], v[96:99], v[144:147], v[64:67]
    ds_read_b128 v[160:163], v185 offset:16384
    ds_read_b128 v[164:167], v185 offset:27136
    v_mfma_f32_16x16x32_bf16 v[68:71], v[100:103], v[144:147], v[68:71]
    v_mfma_f32_16x16x32_bf16 v[72:75], v[112:115], v[144:147], v[72:75]
    ds_read_b64_tr_b16 v[128:129], v178 offset:8192
    ds_read_b64_tr_b16 v[130:131], v178 offset:9216
    ds_read_b64_tr_b16 v[132:133], v179 offset:8192
    ds_read_b64_tr_b16 v[134:135], v179 offset:9216
    v_mfma_f32_16x16x32_bf16 v[76:79], v[116:119], v[144:147], v[76:79]
    s_mov_b64 exec, s[44:45]
    buffer_load_dwordx4 v189, s[16:19], s41 offen offset:2048 lds
    s_mov_b64 exec, -1
    s_add_u32 s41, s41, 21504
    v_mfma_f32_16x16x32_bf16 v[64:67], v[104:107], v[148:151], v[64:67]
    v_mfma_f32_16x16x32_bf16 v[68:71], v[108:111], v[148:151], v[68:71]
    v_mfma_f32_16x16x32_bf16 v[72:75], v[96:99], v[148:151], v[72:75]
    v_mfma_f32_16x16x32_bf16 v[76:79], v[100:103], v[148:151], v[76:79]
    s_waitcnt lgkmcnt(10)
    v_mfma_f32_16x16x32_bf16 v[80:83], v[96:99], v[152:155], v[80:83]
    ds_read_b128 v[168:171], v185 offset:17408
    ds_read_b128 v[172:175], v185 offset:28160
    v_mfma_f32_16x16x32_bf16 v[84:87], v[100:103], v[152:155], v[84:87]
    s_waitcnt lgkmcnt(2)
    v_mfma_f32_16x16x32_bf16 v[88:91], v[112:115], v[152:155], v[88:91]
    v_xor_b32 v136, 0x80008000, v128
    v_xor_b32 v137, 0x80008000, v129
    v_mfma_f32_16x16x32_bf16 v[92:95], v[116:119], v[152:155], v[92:95]
    v_xor_b32 v138, 0x80008000, v130
    v_xor_b32 v139, 0x80008000, v131
    v_mfma_f32_16x16x32_bf16 v[80:83], v[104:107], v[156:159], v[80:83]
    v_xor_b32 v140, 0x80008000, v132
    v_xor_b32 v141, 0x80008000, v133
    v_mfma_f32_16x16x32_bf16 v[84:87], v[108:111], v[156:159], v[84:87]
    v_xor_b32 v142, 0x80008000, v134
    v_xor_b32 v143, 0x80008000, v135
    v_mfma_f32_16x16x32_bf16 v[88:91], v[96:99], v[156:159], v[88:91]
    v_mfma_f32_16x16x32_bf16 v[92:95], v[100:103], v[156:159], v[92:95]
    s_waitcnt vmcnt(5)
    s_barrier
    v_mfma_f32_16x16x32_bf16 v[0:3], v[120:123], v[160:163], v[0:3]
    ds_read_b128 v[144:147], v185 offset:18432
    ds_read_b128 v[148:151], v185 offset:29184
    v_mfma_f32_16x16x32_bf16 v[4:7], v[124:127], v[160:163], v[4:7]
    v_mfma_f32_16x16x32_bf16 v[8:11], v[136:139], v[160:163], v[8:11]
    v_mfma_f32_16x16x32_bf16 v[12:15], v[140:143], v[160:163], v[12:15]
    v_mfma_f32_16x16x32_bf16 v[0:3], v[128:131], v[164:167], v[0:3]
    v_mfma_f32_16x16x32_bf16 v[4:7], v[132:135], v[164:167], v[4:7]
    v_mfma_f32_16x16x32_bf16 v[8:11], v[120:123], v[164:167], v[8:11]
    v_mfma_f32_16x16x32_bf16 v[12:15], v[124:127], v[164:167], v[12:15]
    s_waitcnt lgkmcnt(2)
    v_mfma_f32_16x16x32_bf16 v[16:19], v[120:123], v[168:171], v[16:19]
    ds_read_b128 v[152:155], v185 offset:19456
    ds_read_b128 v[156:159], v185 offset:30208
    v_mfma_f32_16x16x32_bf16 v[20:23], v[124:127], v[168:171], v[20:23]
    v_mfma_f32_16x16x32_bf16 v[24:27], v[136:139], v[168:171], v[24:27]
    v_mfma_f32_16x16x32_bf16 v[28:31], v[140:143], v[168:171], v[28:31]
    v_mfma_f32_16x16x32_bf16 v[16:19], v[128:131], v[172:175], v[16:19]
    v_mfma_f32_16x16x32_bf16 v[20:23], v[132:135], v[172:175], v[20:23]
    v_mfma_f32_16x16x32_bf16 v[24:27], v[120:123], v[172:175], v[24:27]
    v_mfma_f32_16x16x32_bf16 v[28:31], v[124:127], v[172:175], v[28:31]
    s_waitcnt lgkmcnt(2)
    v_mfma_f32_16x16x32_bf16 v[32:35], v[120:123], v[144:147], v[32:35]
    ds_read_b128 v[160:163], v185 offset:20480
    ds_read_b128 v[164:167], v185 offset:31232
    v_mfma_f32_16x16x32_bf16 v[36:39], v[124:127], v[144:147], v[36:39]
    v_mfma_f32_16x16x32_bf16 v[40:43], v[136:139], v[144:147], v[40:43]
    v_mfma_f32_16x16x32_bf16 v[44:47], v[140:143], v[144:147], v[44:47]
    v_mfma_f32_16x16x32_bf16 v[32:35], v[128:131], v[148:151], v[32:35]
    v_mfma_f32_16x16x32_bf16 v[36:39], v[132:135], v[148:151], v[36:39]
    v_mfma_f32_16x16x32_bf16 v[40:43], v[120:123], v[148:151], v[40:43]
    v_mfma_f32_16x16x32_bf16 v[44:47], v[124:127], v[148:151], v[44:47]
    s_waitcnt lgkmcnt(2)
    v_mfma_f32_16x16x32_bf16 v[48:51], v[120:123], v[152:155], v[48:51]
    ds_read_b128 v[168:171], v185 offset:21504
    ds_read_b128 v[172:175], v185 offset:32256
    v_mfma_f32_16x16x32_bf16 v[52:55], v[124:127], v[152:155], v[52:55]
    v_mfma_f32_16x16x32_bf16 v[56:59], v[136:139], v[152:155], v[56:59]
    ds_read_b64_tr_b16 v[96:97], v180 offset:0
    ds_read_b64_tr_b16 v[98:99], v180 offset:1024
    ds_read_b64_tr_b16 v[100:101], v181 offset:0
    ds_read_b64_tr_b16 v[102:103], v181 offset:1024
    v_mfma_f32_16x16x32_bf16 v[60:63], v[140:143], v[152:155], v[60:63]
    v_mfma_f32_16x16x32_bf16 v[48:51], v[128:131], v[156:159], v[48:51]
    v_mfma_f32_16x16x32_bf16 v[52:55], v[132:135], v[156:159], v[52:55]
    v_mfma_f32_16x16x32_bf16 v[56:59], v[120:123], v[156:159], v[56:59]
    v_mfma_f32_16x16x32_bf16 v[60:63], v[124:127], v[156:159], v[60:63]
    s_waitcnt lgkmcnt(6)
    v_mfma_f32_16x16x32_bf16 v[64:67], v[120:123], v[160:163], v[64:67]
    ds_read_b128 v[144:147], v186 offset:16384
    ds_read_b128 v[148:151], v186 offset:27136
    v_mfma_f32_16x16x32_bf16 v[68:71], v[124:127], v[160:163], v[68:71]
    v_mfma_f32_16x16x32_bf16 v[72:75], v[136:139], v[160:163], v[72:75]
    ds_read_b64_tr_b16 v[104:105], v180 offset:8192
    ds_read_b64_tr_b16 v[106:107], v180 offset:9216
    ds_read_b64_tr_b16 v[108:109], v181 offset:8192
    ds_read_b64_tr_b16 v[110:111], v181 offset:9216
    v_mfma_f32_16x16x32_bf16 v[76:79], v[140:143], v[160:163], v[76:79]
    v_mfma_f32_16x16x32_bf16 v[64:67], v[128:131], v[164:167], v[64:67]
    v_mfma_f32_16x16x32_bf16 v[68:71], v[132:135], v[164:167], v[68:71]
    v_mfma_f32_16x16x32_bf16 v[72:75], v[120:123], v[164:167], v[72:75]
    v_mfma_f32_16x16x32_bf16 v[76:79], v[124:127], v[164:167], v[76:79]
    s_waitcnt lgkmcnt(10)
    v_mfma_f32_16x16x32_bf16 v[80:83], v[120:123], v[168:171], v[80:83]
    ds_read_b128 v[152:155], v186 offset:17408
    ds_read_b128 v[156:159], v186 offset:28160
    v_mfma_f32_16x16x32_bf16 v[84:87], v[124:127], v[168:171], v[84:87]
    s_waitcnt lgkmcnt(2)
    v_mfma_f32_16x16x32_bf16 v[88:91], v[136:139], v[168:171], v[88:91]
    v_xor_b32 v112, 0x80008000, v104
    v_xor_b32 v113, 0x80008000, v105
    v_mfma_f32_16x16x32_bf16 v[92:95], v[140:143], v[168:171], v[92:95]
    v_xor_b32 v114, 0x80008000, v106
    v_xor_b32 v115, 0x80008000, v107
    v_mfma_f32_16x16x32_bf16 v[80:83], v[128:131], v[172:175], v[80:83]
    v_xor_b32 v116, 0x80008000, v108
    v_xor_b32 v117, 0x80008000, v109
    v_mfma_f32_16x16x32_bf16 v[84:87], v[132:135], v[172:175], v[84:87]
    v_xor_b32 v118, 0x80008000, v110
    v_xor_b32 v119, 0x80008000, v111
    v_mfma_f32_16x16x32_bf16 v[88:91], v[120:123], v[172:175], v[88:91]
    v_mfma_f32_16x16x32_bf16 v[92:95], v[124:127], v[172:175], v[92:95]
    s_waitcnt vmcnt(0)
    s_barrier
    v_mfma_f32_16x16x32_bf16 v[0:3], v[96:99], v[144:147], v[0:3]
    ds_read_b128 v[160:163], v186 offset:18432
    ds_read_b128 v[164:167], v186 offset:29184
    v_mfma_f32_16x16x32_bf16 v[4:7], v[100:103], v[144:147], v[4:7]
    v_mfma_f32_16x16x32_bf16 v[8:11], v[112:115], v[144:147], v[8:11]
    v_mfma_f32_16x16x32_bf16 v[12:15], v[116:119], v[144:147], v[12:15]
    v_mfma_f32_16x16x32_bf16 v[0:3], v[104:107], v[148:151], v[0:3]
    v_mfma_f32_16x16x32_bf16 v[4:7], v[108:111], v[148:151], v[4:7]
    v_mfma_f32_16x16x32_bf16 v[8:11], v[96:99], v[148:151], v[8:11]
    v_mfma_f32_16x16x32_bf16 v[12:15], v[100:103], v[148:151], v[12:15]
    s_waitcnt lgkmcnt(2)
    v_mfma_f32_16x16x32_bf16 v[16:19], v[96:99], v[152:155], v[16:19]
    ds_read_b128 v[168:171], v186 offset:19456
    ds_read_b128 v[172:175], v186 offset:30208
    v_mfma_f32_16x16x32_bf16 v[20:23], v[100:103], v[152:155], v[20:23]
    v_mfma_f32_16x16x32_bf16 v[24:27], v[112:115], v[152:155], v[24:27]
    v_mfma_f32_16x16x32_bf16 v[28:31], v[116:119], v[152:155], v[28:31]
    v_mfma_f32_16x16x32_bf16 v[16:19], v[104:107], v[156:159], v[16:19]
    v_mfma_f32_16x16x32_bf16 v[20:23], v[108:111], v[156:159], v[20:23]
    v_mfma_f32_16x16x32_bf16 v[24:27], v[96:99], v[156:159], v[24:27]
    v_mfma_f32_16x16x32_bf16 v[28:31], v[100:103], v[156:159], v[28:31]
    s_waitcnt lgkmcnt(2)
    v_mfma_f32_16x16x32_bf16 v[32:35], v[96:99], v[160:163], v[32:35]
    ds_read_b128 v[144:147], v186 offset:20480
    ds_read_b128 v[148:151], v186 offset:31232
    v_mfma_f32_16x16x32_bf16 v[36:39], v[100:103], v[160:163], v[36:39]
    v_mfma_f32_16x16x32_bf16 v[40:43], v[112:115], v[160:163], v[40:43]
    v_mfma_f32_16x16x32_bf16 v[44:47], v[116:119], v[160:163], v[44:47]
    v_mfma_f32_16x16x32_bf16 v[32:35], v[104:107], v[164:167], v[32:35]
    v_mfma_f32_16x16x32_bf16 v[36:39], v[108:111], v[164:167], v[36:39]
    v_mfma_f32_16x16x32_bf16 v[40:43], v[96:99], v[164:167], v[40:43]
    v_mfma_f32_16x16x32_bf16 v[44:47], v[100:103], v[164:167], v[44:47]
    s_waitcnt lgkmcnt(2)
    v_mfma_f32_16x16x32_bf16 v[48:51], v[96:99], v[168:171], v[48:51]
    ds_read_b128 v[152:155], v186 offset:21504
    ds_read_b128 v[156:159], v186 offset:32256
    v_mfma_f32_16x16x32_bf16 v[52:55], v[100:103], v[168:171], v[52:55]
    v_mfma_f32_16x16x32_bf16 v[56:59], v[112:115], v[168:171], v[56:59]
    ds_read_b64_tr_b16 v[120:121], v182 offset:0
    ds_read_b64_tr_b16 v[122:123], v182 offset:1024
    ds_read_b64_tr_b16 v[124:125], v183 offset:0
    ds_read_b64_tr_b16 v[126:127], v183 offset:1024
    v_mfma_f32_16x16x32_bf16 v[60:63], v[116:119], v[168:171], v[60:63]
    v_mfma_f32_16x16x32_bf16 v[48:51], v[104:107], v[172:175], v[48:51]
    v_mfma_f32_16x16x32_bf16 v[52:55], v[108:111], v[172:175], v[52:55]
    v_mfma_f32_16x16x32_bf16 v[56:59], v[96:99], v[172:175], v[56:59]
    v_mfma_f32_16x16x32_bf16 v[60:63], v[100:103], v[172:175], v[60:63]
    s_waitcnt lgkmcnt(6)
    v_mfma_f32_16x16x32_bf16 v[64:67], v[96:99], v[144:147], v[64:67]
    ds_read_b128 v[160:163], v187 offset:16384
    ds_read_b128 v[164:167], v187 offset:27136
    v_mfma_f32_16x16x32_bf16 v[68:71], v[100:103], v[144:147], v[68:71]
    v_mfma_f32_16x16x32_bf16 v[72:75], v[112:115], v[144:147], v[72:75]
    ds_read_b64_tr_b16 v[128:129], v182 offset:8192
    ds_read_b64_tr_b16 v[130:131], v182 offset:9216
    ds_read_b64_tr_b16 v[132:133], v183 offset:8192
    ds_read_b64_tr_b16 v[134:135], v183 offset:9216
    v_mfma_f32_16x16x32_bf16 v[76:79], v[116:119], v[144:147], v[76:79]
    v_mfma_f32_16x16x32_bf16 v[64:67], v[104:107], v[148:151], v[64:67]
    v_mfma_f32_16x16x32_bf16 v[68:71], v[108:111], v[148:151], v[68:71]
    v_mfma_f32_16x16x32_bf16 v[72:75], v[96:99], v[148:151], v[72:75]
    v_mfma_f32_16x16x32_bf16 v[76:79], v[100:103], v[148:151], v[76:79]
    s_waitcnt lgkmcnt(10)
    v_mfma_f32_16x16x32_bf16 v[80:83], v[96:99], v[152:155], v[80:83]
    ds_read_b128 v[168:171], v187 offset:17408
    ds_read_b128 v[172:175], v187 offset:28160
    v_mfma_f32_16x16x32_bf16 v[84:87], v[100:103], v[152:155], v[84:87]
    s_waitcnt lgkmcnt(2)
    v_mfma_f32_16x16x32_bf16 v[88:91], v[112:115], v[152:155], v[88:91]
    v_xor_b32 v136, 0x80008000, v128
    v_xor_b32 v137, 0x80008000, v129
    v_mfma_f32_16x16x32_bf16 v[92:95], v[116:119], v[152:155], v[92:95]
    v_xor_b32 v138, 0x80008000, v130
    v_xor_b32 v139, 0x80008000, v131
    v_mfma_f32_16x16x32_bf16 v[80:83], v[104:107], v[156:159], v[80:83]
    v_xor_b32 v140, 0x80008000, v132
    v_xor_b32 v141, 0x80008000, v133
    v_mfma_f32_16x16x32_bf16 v[84:87], v[108:111], v[156:159], v[84:87]
    v_xor_b32 v142, 0x80008000, v134
    v_xor_b32 v143, 0x80008000, v135
    v_mfma_f32_16x16x32_bf16 v[88:91], v[96:99], v[156:159], v[88:91]
    v_mfma_f32_16x16x32_bf16 v[92:95], v[100:103], v[156:159], v[92:95]
    v_mfma_f32_16x16x32_bf16 v[0:3], v[120:123], v[160:163], v[0:3]
    ds_read_b128 v[144:147], v187 offset:18432
    ds_read_b128 v[148:151], v187 offset:29184
    v_mfma_f32_16x16x32_bf16 v[4:7], v[124:127], v[160:163], v[4:7]
    v_mfma_f32_16x16x32_bf16 v[8:11], v[136:139], v[160:163], v[8:11]
    v_mfma_f32_16x16x32_bf16 v[12:15], v[140:143], v[160:163], v[12:15]
    v_mfma_f32_16x16x32_bf16 v[0:3], v[128:131], v[164:167], v[0:3]
    v_mfma_f32_16x16x32_bf16 v[4:7], v[132:135], v[164:167], v[4:7]
    v_mfma_f32_16x16x32_bf16 v[8:11], v[120:123], v[164:167], v[8:11]
    v_mfma_f32_16x16x32_bf16 v[12:15], v[124:127], v[164:167], v[12:15]
    s_waitcnt lgkmcnt(2)
    v_mfma_f32_16x16x32_bf16 v[16:19], v[120:123], v[168:171], v[16:19]
    ds_read_b128 v[152:155], v187 offset:19456
    ds_read_b128 v[156:159], v187 offset:30208
    v_mfma_f32_16x16x32_bf16 v[20:23], v[124:127], v[168:171], v[20:23]
    v_mfma_f32_16x16x32_bf16 v[24:27], v[136:139], v[168:171], v[24:27]
    v_mfma_f32_16x16x32_bf16 v[28:31], v[140:143], v[168:171], v[28:31]
    v_mfma_f32_16x16x32_bf16 v[16:19], v[128:131], v[172:175], v[16:19]
    v_mfma_f32_16x16x32_bf16 v[20:23], v[132:135], v[172:175], v[20:23]
    v_mfma_f32_16x16x32_bf16 v[24:27], v[120:123], v[172:175], v[24:27]
    v_mfma_f32_16x16x32_bf16 v[28:31], v[124:127], v[172:175], v[28:31]
    s_waitcnt lgkmcnt(2)
    v_mfma_f32_16x16x32_bf16 v[32:35], v[120:123], v[144:147], v[32:35]
    ds_read_b128 v[160:163], v187 offset:20480
    ds_read_b128 v[164:167], v187 offset:31232
    v_mfma_f32_16x16x32_bf16 v[36:39], v[124:127], v[144:147], v[36:39]
    v_mfma_f32_16x16x32_bf16 v[40:43], v[136:139], v[144:147], v[40:43]
    v_mfma_f32_16x16x32_bf16 v[44:47], v[140:143], v[144:147], v[44:47]
    v_mfma_f32_16x16x32_bf16 v[32:35], v[128:131], v[148:151], v[32:35]
    v_mfma_f32_16x16x32_bf16 v[36:39], v[132:135], v[148:151], v[36:39]
    v_mfma_f32_16x16x32_bf16 v[40:43], v[120:123], v[148:151], v[40:43]
    v_mfma_f32_16x16x32_bf16 v[44:47], v[124:127], v[148:151], v[44:47]
    s_waitcnt lgkmcnt(2)
    v_mfma_f32_16x16x32_bf16 v[48:51], v[120:123], v[152:155], v[48:51]
    ds_read_b128 v[168:171], v187 offset:21504
    ds_read_b128 v[172:175], v187 offset:32256
    v_mfma_f32_16x16x32_bf16 v[52:55], v[124:127], v[152:155], v[52:55]
    v_mfma_f32_16x16x32_bf16 v[56:59], v[136:139], v[152:155], v[56:59]
    v_mfma_f32_16x16x32_bf16 v[60:63], v[140:143], v[152:155], v[60:63]
    v_mfma_f32_16x16x32_bf16 v[48:51], v[128:131], v[156:159], v[48:51]
    v_mfma_f32_16x16x32_bf16 v[52:55], v[132:135], v[156:159], v[52:55]
    v_mfma_f32_16x16x32_bf16 v[56:59], v[120:123], v[156:159], v[56:59]
    v_mfma_f32_16x16x32_bf16 v[60:63], v[124:127], v[156:159], v[60:63]
    s_waitcnt lgkmcnt(2)
    v_mfma_f32_16x16x32_bf16 v[64:67], v[120:123], v[160:163], v[64:67]
    v_mfma_f32_16x16x32_bf16 v[68:71], v[124:127], v[160:163], v[68:71]
    v_mfma_f32_16x16x32_bf16 v[72:75], v[136:139], v[160:163], v[72:75]
    v_mfma_f32_16x16x32_bf16 v[76:79], v[140:143], v[160:163], v[76:79]
    v_mfma_f32_16x16x32_bf16 v[64:67], v[128:131], v[164:167], v[64:67]
    v_mfma_f32_16x16x32_bf16 v[68:71], v[132:135], v[164:167], v[68:71]
    v_mfma_f32_16x16x32_bf16 v[72:75], v[120:123], v[164:167], v[72:75]
    v_mfma_f32_16x16x32_bf16 v[76:79], v[124:127], v[164:167], v[76:79]
    s_waitcnt lgkmcnt(0)
    v_mfma_f32_16x16x32_bf16 v[80:83], v[120:123], v[168:171], v[80:83]
    v_mfma_f32_16x16x32_bf16 v[84:87], v[124:127], v[168:171], v[84:87]
    v_mfma_f32_16x16x32_bf16 v[88:91], v[136:139], v[168:171], v[88:91]
    v_mfma_f32_16x16x32_bf16 v[92:95], v[140:143], v[168:171], v[92:95]
    v_mfma_f32_16x16x32_bf16 v[80:83], v[128:131], v[172:175], v[80:83]
    v_mfma_f32_16x16x32_bf16 v[84:87], v[132:135], v[172:175], v[84:87]
    v_mfma_f32_16x16x32_bf16 v[88:91], v[120:123], v[172:175], v[88:91]
    v_mfma_f32_16x16x32_bf16 v[92:95], v[124:127], v[172:175], v[92:95]
    s_nop 7
    v_cvt_pk_bf16_f32 v0, v0, v1
    v_cvt_pk_bf16_f32 v1, v2, v3
    v_cvt_pk_bf16_f32 v2, v4, v5
    v_cvt_pk_bf16_f32 v3, v6, v7
    s_add_u32 s47, s48, 0
    buffer_store_dwordx4 v[0:3], v190, s[16:19], s47 offen
    v_cvt_pk_bf16_f32 v8, v8, v9
    v_cvt_pk_bf16_f32 v9, v10, v11
    v_cvt_pk_bf16_f32 v10, v12, v13
    v_cvt_pk_bf16_f32 v11, v14, v15
    s_add_u32 s47, s48, 360448
    buffer_store_dwordx4 v[8:11], v190, s[16:19], s47 offen
    v_cvt_pk_bf16_f32 v16, v16, v17
    v_cvt_pk_bf16_f32 v17, v18, v19
    v_cvt_pk_bf16_f32 v18, v20, v21
    v_cvt_pk_bf16_f32 v19, v22, v23
    s_add_u32 s47, s48, 16384
    buffer_store_dwordx4 v[16:19], v190, s[16:19], s47 offen
    v_cvt_pk_bf16_f32 v24, v24, v25
    v_cvt_pk_bf16_f32 v25, v26, v27
    v_cvt_pk_bf16_f32 v26, v28, v29
    v_cvt_pk_bf16_f32 v27, v30, v31
    s_add_u32 s47, s48, 376832
    buffer_store_dwordx4 v[24:27], v190, s[16:19], s47 offen
    v_cvt_pk_bf16_f32 v32, v32, v33
    v_cvt_pk_bf16_f32 v33, v34, v35
    v_cvt_pk_bf16_f32 v34, v36, v37
    v_cvt_pk_bf16_f32 v35, v38, v39
    s_add_u32 s47, s48, 32768
    buffer_store_dwordx4 v[32:35], v190, s[16:19], s47 offen
    v_cvt_pk_bf16_f32 v40, v40, v41
    v_cvt_pk_bf16_f32 v41, v42, v43
    v_cvt_pk_bf16_f32 v42, v44, v45
    v_cvt_pk_bf16_f32 v43, v46, v47
    s_add_u32 s47, s48, 393216
    buffer_store_dwordx4 v[40:43], v190, s[16:19], s47 offen
    v_cvt_pk_bf16_f32 v48, v48, v49
    v_cvt_pk_bf16_f32 v49, v50, v51
    v_cvt_pk_bf16_f32 v50, v52, v53
    v_cvt_pk_bf16_f32 v51, v54, v55
    s_add_u32 s47, s48, 49152
    buffer_store_dwordx4 v[48:51], v190, s[16:19], s47 offen
    v_cvt_pk_bf16_f32 v56, v56, v57
    v_cvt_pk_bf16_f32 v57, v58, v59
    v_cvt_pk_bf16_f32 v58, v60, v61
    v_cvt_pk_bf16_f32 v59, v62, v63
    s_add_u32 s47, s48, 409600
    buffer_store_dwordx4 v[56:59], v190, s[16:19], s47 offen
    v_cvt_pk_bf16_f32 v64, v64, v65
    v_cvt_pk_bf16_f32 v65, v66, v67
    v_cvt_pk_bf16_f32 v66, v68, v69
    v_cvt_pk_bf16_f32 v67, v70, v71
    s_add_u32 s47, s48, 65536
    buffer_store_dwordx4 v[64:67], v190, s[16:19], s47 offen
    v_cvt_pk_bf16_f32 v72, v72, v73
    v_cvt_pk_bf16_f32 v73, v74, v75
    v_cvt_pk_bf16_f32 v74, v76, v77
    v_cvt_pk_bf16_f32 v75, v78, v79
    s_add_u32 s47, s48, 425984
    buffer_store_dwordx4 v[72:75], v190, s[16:19], s47 offen
    v_cvt_pk_bf16_f32 v80, v80, v81
    v_cvt_pk_bf16_f32 v81, v82, v83
    v_cvt_pk_bf16_f32 v82, v84, v85
    v_cvt_pk_bf16_f32 v83, v86, v87
    s_add_u32 s47, s48, 81920
    buffer_store_dwordx4 v[80:83], v190, s[16:19], s47 offen
    v_cvt_pk_bf16_f32 v88, v88, v89
    v_cvt_pk_bf16_f32 v89, v90, v91
    v_cvt_pk_bf16_f32 v90, v92, v93
    v_cvt_pk_bf16_f32 v91, v94, v95
    s_add_u32 s47, s48, 442368
    buffer_store_dwordx4 v[88:91], v190, s[16:19], s47 offen
    s_endpgm
L_k3_mh1:
    s_add_u32 m0, s42, 0
    s_nop 0
    buffer_load_dwordx4 v188, s[16:19], s40 offen lds
    buffer_load_dwordx4 v188, s[16:19], s40 offen offset:1024 lds
    s_add_u32 s40, s40, 16384
    s_add_u32 m0, s43, 0
    s_nop 0
    buffer_load_dwordx4 v189, s[16:19], s41 offen lds
    buffer_load_dwordx4 v189, s[16:19], s41 offen offset:1024 lds
    s_mov_b64 exec, s[44:45]
    buffer_load_dwordx4 v189, s[16:19], s41 offen offset:2048 lds
    s_mov_b64 exec, -1
    s_add_u32 s41, s41, 21504
    s_add_u32 m0, s42, 37888
    s_nop 0
    buffer_load_dwordx4 v188, s[16:19], s40 offen lds
    buffer_load_dwordx4 v188, s[16:19], s40 offen offset:1024 lds
    s_add_u32 s40, s40, 16384
    s_add_u32 m0, s43, 37888
    s_nop 0
    buffer_load_dwordx4 v189, s[16:19], s41 offen lds
    buffer_load_dwordx4 v189, s[16:19], s41 offen offset:1024 lds
    s_mov_b64 exec, s[44:45]
    buffer_load_dwordx4 v189, s[16:19], s41 offen offset:2048 lds
    s_mov_b64 exec, -1
    s_add_u32 s41, s41, 21504
    s_add_u32 m0, s42, 75776
    s_nop 0
    buffer_load_dwordx4 v188, s[16:19], s40 offen lds
    buffer_load_dwordx4 v188, s[16:19], s40 offen offset:1024 lds
    s_add_u32 s40, s40, 16384
    s_add_u32 m0, s43, 75776
    s_nop 0
    buffer_load_dwordx4 v189, s[16:19], s41 offen lds
    buffer_load_dwordx4 v189, s[16:19], s41 offen offset:1024 lds
    s_mov_b64 exec, s[44:45]
    buffer_load_dwordx4 v189, s[16:19], s41 offen offset:2048 lds
    s_mov_b64 exec, -1
    s_add_u32 s41, s41, 21504
    v_mov_b32 v0, 0
    v_mov_b32 v1, 0
    v_mov_b32 v2, 0
    v_mov_b32 v3, 0
    v_mov_b32 v4, 0
    v_mov_b32 v5, 0
    v_mov_b32 v6, 0
    v_mov_b32 v7, 0
    v_mov_b32 v8, 0
    v_mov_b32 v9, 0
    v_mov_b32 v10, 0
    v_mov_b32 v11, 0
    v_mov_b32 v12, 0
    v_mov_b32 v13, 0
    v_mov_b32 v14, 0
    v_mov_b32 v15, 0
    v_mov_b32 v16, 0
    v_mov_b32 v17, 0
    v_mov_b32 v18, 0
    v_mov_b32 v19, 0
    v_mov_b32 v20, 0
    v_mov_b32 v21, 0
    v_mov_b32 v22, 0
    v_mov_b32 v23, 0
    v_mov_b32 v24, 0
    v_mov_b32 v25, 0
    v_mov_b32 v26, 0
    v_mov_b32 v27, 0
    v_mov_b32 v28, 0
    v_mov_b32 v29, 0
    v_mov_b32 v30, 0
    v_mov_b32 v31, 0
    v_mov_b32 v32, 0
    v_mov_b32 v33, 0
    v_mov_b32 v34, 0
    v_mov_b32 v35, 0
    v_mov_b32 v36, 0
    v_mov_b32 v37, 0
    v_mov_b32 v38, 0
    v_mov_b32 v39, 0
    v_mov_b32 v40, 0
    v_mov_b32 v41, 0
    v_mov_b32 v42, 0
    v_mov_b32 v43, 0
    v_mov_b32 v44, 0
    v_mov_b32 v45, 0
    v_mov_b32 v46, 0
    v_mov_b32 v47, 0
    v_mov_b32 v48, 0
    v_mov_b32 v49, 0
    v_mov_b32 v50, 0
    v_mov_b32 v51, 0
    v_mov_b32 v52, 0
    v_mov_b32 v53, 0
    v_mov_b32 v54, 0
    v_mov_b32 v55, 0
    v_mov_b32 v56, 0
    v_mov_b32 v57, 0
    v_mov_b32 v58, 0
    v_mov_b32 v59, 0
    v_mov_b32 v60, 0
    v_mov_b32 v61, 0
    v_mov_b32 v62, 0
    v_mov_b32 v63, 0
    v_mov_b32 v64, 0
    v_mov_b32 v65, 0
    v_mov_b32 v66, 0
    v_mov_b32 v67, 0
    v_mov_b32 v68, 0
    v_mov_b32 v69, 0
    v_mov_b32 v70, 0
    v_mov_b32 v71, 0
    v_mov_b32 v72, 0
    v_mov_b32 v73, 0
    v_mov_b32 v74, 0
    v_mov_b32 v75, 0
    v_mov_b32 v76, 0
    v_mov_b32 v77, 0
    v_mov_b32 v78, 0
    v_mov_b32 v79, 0
    s_waitcnt vmcnt(10)
    s_barrier
    ds_read_b64_tr_b16 v[96:97], v176 offset:0
    ds_read_b64_tr_b16 v[98:99], v176 offset:1024
    ds_read_b64_tr_b16 v[100:101], v177 offset:0
    ds_read_b64_tr_b16 v[102:103], v177 offset:1024
    ds_read_b64_tr_b16 v[104:105], v176 offset:8192
    ds_read_b64_tr_b16 v[106:107], v176 offset:9216
    ds_read_b64_tr_b16 v[108:109], v177 offset:8192
    ds_read_b64_tr_b16 v[110:111], v177 offset:9216
    ds_read_b128 v[144:147], v184 offset:22528
    ds_read_b128 v[148:151], v184 offset:33280
    ds_read_b128 v[152:155], v184 offset:23552
    ds_read_b128 v[156:159], v184 offset:34304
    s_waitcnt lgkmcnt(4)
    v_xor_b32 v112, 0x80008000, v104
    v_xor_b32 v113, 0x80008000, v105
    v_xor_b32 v114, 0x80008000, v106
    v_xor_b32 v115, 0x80008000, v107
    v_xor_b32 v116, 0x80008000, v108
    v_xor_b32 v117, 0x80008000, v109
    v_xor_b32 v118, 0x80008000, v110
    v_xor_b32 v119, 0x80008000, v111
    s_mov_b32 s46, 7
L_k3_loop1:
    s_waitcnt vmcnt(5)
    s_barrier
    s_waitcnt lgkmcnt(2)
    v_mfma_f32_16x16x32_bf16 v[0:3], v[96:99], v[144:147], v[0:3]
    ds_read_b128 v[160:163], v184 offset:24576
    ds_read_b128 v[164:167], v184 offset:35328
    v_mfma_f32_16x16x32_bf16 v[4:7], v[100:103], v[144:147], v[4:7]
    v_mfma_f32_16x16x32_bf16 v[8:11], v[112:115], v[144:147], v[8:11]
    v_mfma_f32_16x16x32_bf16 v[12:15], v[116:119], v[144:147], v[12:15]
    s_add_u32 m0, s42, 113664
    s_nop 0
    buffer_load_dwordx4 v188, s[16:19], s40 offen lds
    v_mfma_f32_16x16x32_bf16 v[0:3], v[104:107], v[148:151], v[0:3]
    v_mfma_f32_16x16x32_bf16 v[4:7], v[108:111], v[148:151], v[4:7]
    v_mfma_f32_16x16x32_bf16 v[8:11], v[96:99], v[148:151], v[8:11]
    v_mfma_f32_16x16x32_bf16 v[12:15], v[100:103], v[148:151], v[12:15]
    s_waitcnt lgkmcnt(2)
    v_mfma_f32_16x16x32_bf16 v[16:19], v[96:99], v[152:155], v[16:19]
    ds_read_b128 v[168:171], v184 offset:25600
    ds_read_b128 v[172:175], v184 offset:36352
    v_mfma_f32_16x16x32_bf16 v[20:23], v[100:103], v[152:155], v[20:23]
    v_mfma_f32_16x16x32_bf16 v[24:27], v[112:115], v[152:155], v[24:27]
    v_mfma_f32_16x16x32_bf16 v[28:31], v[116:119], v[152:155], v[28:31]
    buffer_load_dwordx4 v188, s[16:19], s40 offen offset:1024 lds
    s_add_u32 s40, s40, 16384
    v_mfma_f32_16x16x32_bf16 v[16:19], v[104:107], v[156:159], v[16:19]
    v_mfma_f32_16x16x32_bf16 v[20:23], v[108:111], v[156:159], v[20:23]
    v_mfma_f32_16x16x32_bf16 v[24:27], v[96:99], v[156:159], v[24:27]
    v_mfma_f32_16x16x32_bf16 v[28:31], v[100:103], v[156:159], v[28:31]
    s_waitcnt lgkmcnt(2)
    v_mfma_f32_16x16x32_bf16 v[32:35], v[96:99], v[160:163], v[32:35]
    ds_read_b128 v[144:147], v184 offset:26624
    ds_read_b128 v[148:151], v184 offset:37376
    v_mfma_f32_16x16x32_bf16 v[36:39], v[100:103], v[160:163], v[36:39]
    v_mfma_f32_16x16x32_bf16 v[40:43], v[112:115], v[160:163], v[40:43]
    ds_read_b64_tr_b16 v[120:121], v178 offset:0
    ds_read_b64_tr_b16 v[122:123], v178 offset:1024
    ds_read_b64_tr_b16 v[124:125], v179 offset:0
    ds_read_b64_tr_b16 v[126:127], v179 offset:1024
    v_mfma_f32_16x16x32_bf16 v[44:47], v[116:119], v[160:163], v[44:47]
    s_add_u32 m0, s43, 113664
    s_nop 0
    buffer_load_dwordx4 v189, s[16:19], s41 offen lds
    v_mfma_f32_16x16x32_bf16 v[32:35], v[104:107], v[164:167], v[32:35]
    v_mfma_f32_16x16x32_bf16 v[36:39], v[108:111], v[164:167], v[36:39]
    v_mfma_f32_16x16x32_bf16 v[40:43], v[96:99], v[164:167], v[40:43]
    v_mfma_f32_16x16x32_bf16 v[44:47], v[100:103], v[164:167], v[44:47]
    s_waitcnt lgkmcnt(6)
    v_mfma_f32_16x16x32_bf16 v[48:51], v[96:99], v[168:171], v[48:51]
    ds_read_b128 v[152:155], v185 offset:22528
    ds_read_b128 v[156:159], v185 offset:33280
    v_mfma_f32_16x16x32_bf16 v[52:55], v[100:103], v[168:171], v[52:55]
    v_mfma_f32_16x16x32_bf16 v[56:59], v[112:115], v[168:171], v[56:59]
    ds_read_b64_tr_b16 v[128:129], v178 offset:8192
    ds_read_b64_tr_b16 v[130:131], v178 offset:9216
    ds_read_b64_tr_b16 v[132:133], v179 offset:8192
    ds_read_b64_tr_b16 v[134:135], v179 offset:9216
    v_mfma_f32_16x16x32_bf16 v[60:63], v[116:119], v[168:171], v[60:63]
    buffer_load_dwordx4 v189, s[16:19], s41 offen offset:1024 lds
    v_mfma_f32_16x16x32_bf16 v[48:51], v[104:107], v[172:175], v[48:51]
    v_mfma_f32_16x16x32_bf16 v[52:55], v[108:111], v[172:175], v[52:55]
    v_mfma_f32_16x16x32_bf16 v[56:59], v[96:99], v[172:175], v[56:59]
    v_mfma_f32_16x16x32_bf16 v[60:63], v[100:103], v[172:175], v[60:63]
    s_waitcnt lgkmcnt(10)
    v_mfma_f32_16x16x32_bf16 v[64:67], v[96:99], v[144:147], v[64:67]
    ds_read_b128 v[160:163], v185 offset:23552
    ds_read_b128 v[164:167], v185 offset:34304
    v_mfma_f32_16x16x32_bf16 v[68:71], v[100:103], v[144:147], v[68:71]
    s_waitcnt lgkmcnt(2)
    v_mfma_f32_16x16x32_bf16 v[72:75], v[112:115], v[144:147], v[72:75]
    v_xor_b32 v136, 0x80008000, v128
    v_xor_b32 v137, 0x80008000, v129
    v_mfma_f32_16x16x32_bf16 v[76:79], v[116:119], v[144:147], v[76:79]
    s_mov_b64 exec, s[44:45]
    buffer_load_dwordx4 v189, s[16:19], s41 offen offset:2048 lds
    s_mov_b64 exec, -1
    s_add_u32 s41, s41, 21504
    v_xor_b32 v138, 0x80008000, v130
    v_xor_b32 v139, 0x80008000, v131
    v_mfma_f32_16x16x32_bf16 v[64:67], v[104:107], v[148:151], v[64:67]
    v_xor_b32 v140, 0x80008000, v132
    v_xor_b32 v141, 0x80008000, v133
    v_mfma_f32_16x16x32_bf16 v[68:71], v[108:111], v[148:151], v[68:71]
    v_xor_b32 v142, 0x80008000, v134
    v_xor_b32 v143, 0x80008000, v135
    v_mfma_f32_16x16x32_bf16 v[72:75], v[96:99], v[148:151], v[72:75]
    v_mfma_f32_16x16x32_bf16 v[76:79], v[100:103], v[148:151], v[76:79]
    s_waitcnt vmcnt(5)
    s_barrier
    v_mfma_f32_16x16x32_bf16 v[0:3], v[120:123], v[152:155], v[0:3]
    ds_read_b128 v[168:171], v185 offset:24576
    ds_read_b128 v[172:175], v185 offset:35328
    v_mfma_f32_16x16x32_bf16 v[4:7], v[124:127], v[152:155], v[4:7]
    v_mfma_f32_16x16x32_bf16 v[8:11], v[136:139], v[152:155], v[8:11]
    v_mfma_f32_16x16x32_bf16 v[12:15], v[140:143], v[152:155], v[12:15]
    s_add_u32 m0, s42, 0
    s_nop 0
    buffer_load_dwordx4 v188, s[16:19], s40 offen lds
    v_mfma_f32_16x16x32_bf16 v[0:3], v[128:131], v[156:159], v[0:3]
    v_mfma_f32_16x16x32_bf16 v[4:7], v[132:135], v[156:159], v[4:7]
    v_mfma_f32_16x16x32_bf16 v[8:11], v[120:123], v[156:159], v[8:11]
    v_mfma_f32_16x16x32_bf16 v[12:15], v[124:127], v[156:159], v[12:15]
    s_waitcnt lgkmcnt(2)
    v_mfma_f32_16x16x32_bf16 v[16:19], v[120:123], v[160:163], v[16:19]
    ds_read_b128 v[144:147], v185 offset:25600
    ds_read_b128 v[148:151], v185 offset:36352
    v_mfma_f32_16x16x32_bf16 v[20:23], v[124:127], v[160:163], v[20:23]
    v_mfma_f32_16x16x32_bf16 v[24:27], v[136:139], v[160:163], v[24:27]
    v_mfma_f32_16x16x32_bf16 v[28:31], v[140:143], v[160:163], v[28:31]
    buffer_load_dwordx4 v188, s[16:19], s40 offen offset:1024 lds
    s_add_u32 s40, s40, 16384
    v_mfma_f32_16x16x32_bf16 v[16:19], v[128:131], v[164:167], v[16:19]
    v_mfma_f32_16x16x32_bf16 v[20:23], v[132:135], v[164:167], v[20:23]
    v_mfma_f32_16x16x32_bf16 v[24:27], v[120:123], v[164:167], v[24:27]
    v_mfma_f32_16x16x32_bf16 v[28:31], v[124:127], v[164:167], v[28:31]
    s_waitcnt lgkmcnt(2)
    v_mfma_f32_16x16x32_bf16 v[32:35], v[120:123], v[168:171], v[32:35]
    ds_read_b128 v[152:155], v185 offset:26624
    ds_read_b128 v[156:159], v185 offset:37376
    v_mfma_f32_16x16x32_bf16 v[36:39], v[124:127], v[168:171], v[36:39]
    v_mfma_f32_16x16x32_bf16 v[40:43], v[136:139], v[168:171], v[40:43]
    ds_read_b64_tr_b16 v[96:97], v180 offset:0
    ds_read_b64_tr_b16 v[98:99], v180 offset:1024
    ds_read_b64_tr_b16 v[100:101], v181 offset:0
    ds_read_b64_tr_b16 v[102:103], v181 offset:1024
    v_mfma_f32_16x16x32_bf16 v[44:47], v[140:143], v[168:171], v[44:47]
    s_add_u32 m0, s43, 0
    s_nop 0
    buffer_load_dwordx4 v189, s[16:19], s41 offen lds
    v_mfma_f32_16x16x32_bf16 v[32:35], v[128:131], v[172:175], v[32:35]
    v_mfma_f32_16x16x32_bf16 v[36:39], v[132:135], v[172:175], v[36:39]
    v_mfma_f32_16x16x32_bf16 v[40:43], v[120:123], v[172:175], v[40:43]
    v_mfma_f32_16x16x32_bf16 v[44:47], v[124:127], v[172:175], v[44:47]
    s_waitcnt lgkmcnt(6)
    v_mfma_f32_16x16x32_bf16 v[48:51], v[120:123], v[144:147], v[48:51]
    ds_read_b128 v[160:163], v186 offset:22528
    ds_read_b128 v[164:167], v186 offset:33280
    v_mfma_f32_16x16x32_bf16 v[52:55], v[124:127], v[144:147], v[52:55]
    v_mfma_f32_16x16x32_bf16 v[56:59], v[136:139], v[144:147], v[56:59]
    ds_read_b64_tr_b16 v[104:105], v180 offset:8192
    ds_read_b64_tr_b16 v[106:107], v180 offset:9216
    ds_read_b64_tr_b16 v[108:109], v181 offset:8192
    ds_read_b64_tr_b16 v[110:111], v181 offset:9216
    v_mfma_f32_16x16x32_bf16 v[60:63], v[140:143], v[144:147], v[60:63]
    buffer_load_dwordx4 v189, s[16:19], s41 offen offset:1024 lds
    v_mfma_f32_16x16x32_bf16 v[48:51], v[128:131], v[148:151], v[48:51]
    v_mfma_f32_16x16x32_bf16 v[52:55], v[132:135], v[148:151], v[52:55]
    v_mfma_f32_16x16x32_bf16 v[56:59], v[120:123], v[148:151], v[56:59]
    v_mfma_f32_16x16x32_bf16 v[60:63], v[124:127], v[148:151], v[60:63]
    s_waitcnt lgkmcnt(10)
    v_mfma_f32_16x16x32_bf16 v[64:67], v[120:123], v[152:155], v[64:67]
    ds_read_b128 v[168:171], v186 offset:23552
    ds_read_b128 v[172:175], v186 offset:34304
    v_mfma_f32_16x16x32_bf16 v[68:71], v[124:127], v[152:155], v[68:71]
    s_waitcnt lgkmcnt(2)
    v_mfma_f32_16x16x32_bf16 v[72:75], v[136:139], v[152:155], v[72:75]
    v_xor_b32 v112, 0x80008000, v104
    v_xor_b32 v113, 0x80008000, v105
    v_mfma_f32_16x16x32_bf16 v[76:79], v[140:143], v[152:155], v[76:79]
    s_mov_b64 exec, s[44:45]
    buffer_load_dwordx4 v189, s[16:19], s41 offen offset:2048 lds
    s_mov_b64 exec, -1
    s_add_u32 s41, s41, 21504
    v_xor_b32 v114, 0x80008000, v106
    v_xor_b32 v115, 0x80008000, v107
    v_mfma_f32_16x16x32_bf16 v[64:67], v[128:131], v[156:159], v[64:67]
    v_xor_b32 v116, 0x80008000, v108
    v_xor_b32 v117, 0x80008000, v109
    v_mfma_f32_16x16x32_bf16 v[68:71], v[132:135], v[156:159], v[68:71]
    v_xor_b32 v118, 0x80008000, v110
    v_xor_b32 v119, 0x80008000, v111
    v_mfma_f32_16x16x32_bf16 v[72:75], v[120:123], v[156:159], v[72:75]
    v_mfma_f32_16x16x32_bf16 v[76:79], v[124:127], v[156:159], v[76:79]
    s_waitcnt vmcnt(5)
    s_barrier
    v_mfma_f32_16x16x32_bf16 v[0:3], v[96:99], v[160:163], v[0:3]
    ds_read_b128 v[144:147], v186 offset:24576
    ds_read_b128 v[148:151], v186 offset:35328
    v_mfma_f32_16x16x32_bf16 v[4:7], v[100:103], v[160:163], v[4:7]
    v_mfma_f32_16x16x32_bf16 v[8:11], v[112:115], v[160:163], v[8:11]
    v_mfma_f32_16x16x32_bf16 v[12:15], v[116:119], v[160:163], v[12:15]
    s_add_u32 m0, s42, 37888
    s_nop 0
    buffer_load_dwordx4 v188, s[16:19], s40 offen lds
    v_mfma_f32_16x16x32_bf16 v[0:3], v[104:107], v[164:167], v[0:3]
    v_mfma_f32_16x16x32_bf16 v[4:7], v[108:111], v[164:167], v[4:7]
    v_mfma_f32_16x16x32_bf16 v[8:11], v[96:99], v[164:167], v[8:11]
    v_mfma_f32_16x16x32_bf16 v[12:15], v[100:103], v[164:167], v[12:15]
    s_waitcnt lgkmcnt(2)
    v_mfma_f32_16x16x32_bf16 v[16:19], v[96:99], v[168:171], v[16:19]
    ds_read_b128 v[152:155], v186 offset:25600
    ds_read_b128 v[156:159], v186 offset:36352
    v_mfma_f32_16x16x32_bf16 v[20:23], v[100:103], v[168:171], v[20:23]
    v_mfma_f32_16x16x32_bf16 v[24:27], v[112:115], v[168:171], v[24:27]
    v_mfma_f32_16x16x32_bf16 v[28:31], v[116:119], v[168:171], v[28:31]
    buffer_load_dwordx4 v188, s[16:19], s40 offen offset:1024 lds
    s_add_u32 s40, s40, 16384
    v_mfma_f32_16x16x32_bf16 v[16:19], v[104:107], v[172:175], v[16:19]
    v_mfma_f32_16x16x32_bf16 v[20:23], v[108:111], v[172:175], v[20:23]
    v_mfma_f32_16x16x32_bf16 v[24:27], v[96:99], v[172:175], v[24:27]
    v_mfma_f32_16x16x32_bf16 v[28:31], v[100:103], v[172:175], v[28:31]
    s_waitcnt lgkmcnt(2)
    v_mfma_f32_16x16x32_bf16 v[32:35], v[96:99], v[144:147], v[32:35]
    ds_read_b128 v[160:163], v186 offset:26624
    ds_read_b128 v[164:167], v186 offset:37376
    v_mfma_f32_16x16x32_bf16 v[36:39], v[100:103], v[144:147], v[36:39]
    v_mfma_f32_16x16x32_bf16 v[40:43], v[112:115], v[144:147], v[40:43]
    ds_read_b64_tr_b16 v[120:121], v182 offset:0
    ds_read_b64_tr_b16 v[122:123], v182 offset:1024
    ds_read_b64_tr_b16 v[124:125], v183 offset:0
    ds_read_b64_tr_b16 v[126:127], v183 offset:1024
    v_mfma_f32_16x16x32_bf16 v[44:47], v[116:119], v[144:147], v[44:47]
    s_add_u32 m0, s43, 37888
    s_nop 0
    buffer_load_dwordx4 v189, s[16:19], s41 offen lds
    v_mfma_f32_16x16x32_bf16 v[32:35], v[104:107], v[148:151], v[32:35]
    v_mfma_f32_16x16x32_bf16 v[36:39], v[108:111], v[148:151], v[36:39]
    v_mfma_f32_16x16x32_bf16 v[40:43], v[96:99], v[148:151], v[40:43]
    v_mfma_f32_16x16x32_bf16 v[44:47], v[100:103], v[148:151], v[44:47]
    s_waitcnt lgkmcnt(6)
    v_mfma_f32_16x16x32_bf16 v[48:51], v[96:99], v[152:155], v[48:51]
    ds_read_b128 v[168:171], v187 offset:22528
    ds_read_b128 v[172:175], v187 offset:33280
    v_mfma_f32_16x16x32_bf16 v[52:55], v[100:103], v[152:155], v[52:55]
    v_mfma_f32_16x16x32_bf16 v[56:59], v[112:115], v[152:155], v[56:59]
    ds_read_b64_tr_b16 v[128:129], v182 offset:8192
    ds_read_b64_tr_b16 v[130:131], v182 offset:9216
    ds_read_b64_tr_b16 v[132:133], v183 offset:8192
    ds_read_b64_tr_b16 v[134:135], v183 offset:9216
    v_mfma_f32_16x16x32_bf16 v[60:63], v[116:119], v[152:155], v[60:63]
    buffer_load_dwordx4 v189, s[16:19], s41 offen offset:1024 lds
    v_mfma_f32_16x16x32_bf16 v[48:51], v[104:107], v[156:159], v[48:51]
    v_mfma_f32_16x16x32_bf16 v[52:55], v[108:111], v[156:159], v[52:55]
    v_mfma_f32_16x16x32_bf16 v[56:59], v[96:99], v[156:159], v[56:59]
    v_mfma_f32_16x16x32_bf16 v[60:63], v[100:103], v[156:159], v[60:63]
    s_waitcnt lgkmcnt(10)
    v_mfma_f32_16x16x32_bf16 v[64:67], v[96:99], v[160:163], v[64:67]
    ds_read_b128 v[144:147], v187 offset:23552
    ds_read_b128 v[148:151], v187 offset:34304
    v_mfma_f32_16x16x32_bf16 v[68:71], v[100:103], v[160:163], v[68:71]
    s_waitcnt lgkmcnt(2)
    v_mfma_f32_16x16x32_bf16 v[72:75], v[112:115], v[160:163], v[72:75]
    v_xor_b32 v136, 0x80008000, v128
    v_xor_b32 v137, 0x80008000, v129
    v_mfma_f32_16x16x32_bf16 v[76:79], v[116:119], v[160:163], v[76:79]
    s_mov_b64 exec, s[44:45]
    buffer_load_dwordx4 v189, s[16:19], s41 offen offset:2048 lds
    s_mov_b64 exec, -1
    s_add_u32 s41, s41, 21504
    v_xor_b32 v138, 0x80008000, v130
    v_xor_b32 v139, 0x80008000, v131
    v_mfma_f32_16x16x32_bf16 v[64:67], v[104:107], v[164:167], v[64:67]
    v_xor_b32 v140, 0x80008000, v132
    v_xor_b32 v141, 0x80008000, v133
    v_mfma_f32_16x16x32_bf16 v[68:71], v[108:111], v[164:167], v[68:71]
    v_xor_b32 v142, 0x80008000, v134
    v_xor_b32 v143, 0x80008000, v135
    v_mfma_f32_16x16x32_bf16 v[72:75], v[96:99], v[164:167], v[72:75]
    v_mfma_f32_16x16x32_bf16 v[76:79], v[100:103], v[164:167], v[76:79]
    s_waitcnt vmcnt(5)
    s_barrier
    v_mfma_f32_16x16x32_bf16 v[0:3], v[120:123], v[168:171], v[0:3]
    ds_read_b128 v[152:155], v187 offset:24576
    ds_read_b128 v[156:159], v187 offset:35328
    v_mfma_f32_16x16x32_bf16 v[4:7], v[124:127], v[168:171], v[4:7]
    v_mfma_f32_16x16x32_bf16 v[8:11], v[136:139], v[168:171], v[8:11]
    v_mfma_f32_16x16x32_bf16 v[12:15], v[140:143], v[168:171], v[12:15]
    s_add_u32 m0, s42, 75776
    s_nop 0
    buffer_load_dwordx4 v188, s[16:19], s40 offen lds
    v_mfma_f32_16x16x32_bf16 v[0:3], v[128:131], v[172:175], v[0:3]
    v_mfma_f32_16x16x32_bf16 v[4:7], v[132:135], v[172:175], v[4:7]
    v_mfma_f32_16x16x32_bf16 v[8:11], v[120:123], v[172:175], v[8:11]
    v_mfma_f32_16x16x32_bf16 v[12:15], v[124:127], v[172:175], v[12:15]
    s_waitcnt lgkmcnt(2)
    v_mfma_f32_16x16x32_bf16 v[16:19], v[120:123], v[144:147], v[16:19]
    ds_read_b128 v[160:163], v187 offset:25600
    ds_read_b128 v[164:167], v187 offset:36352
    v_mfma_f32_16x16x32_bf16 v[20:23], v[124:127], v[144:147], v[20:23]
    v_mfma_f32_16x16x32_bf16 v[24:27], v[136:139], v[144:147], v[24:27]
    v_mfma_f32_16x16x32_bf16 v[28:31], v[140:143], v[144:147], v[28:31]
    buffer_load_dwordx4 v188, s[16:19], s40 offen offset:1024 lds
    s_add_u32 s40, s40, 16384
    v_mfma_f32_16x16x32_bf16 v[16:19], v[128:131], v[148:151], v[16:19]
    v_mfma_f32_16x16x32_bf16 v[20:23], v[132:135], v[148:151], v[20:23]
    v_mfma_f32_16x16x32_bf16 v[24:27], v[120:123], v[148:151], v[24:27]
    v_mfma_f32_16x16x32_bf16 v[28:31], v[124:127], v[148:151], v[28:31]
    s_waitcnt lgkmcnt(2)
    v_mfma_f32_16x16x32_bf16 v[32:35], v[120:123], v[152:155], v[32:35]
    ds_read_b128 v[168:171], v187 offset:26624
    ds_read_b128 v[172:175], v187 offset:37376
    v_mfma_f32_16x16x32_bf16 v[36:39], v[124:127], v[152:155], v[36:39]
    v_mfma_f32_16x16x32_bf16 v[40:43], v[136:139], v[152:155], v[40:43]
    ds_read_b64_tr_b16 v[96:97], v176 offset:0
    ds_read_b64_tr_b16 v[98:99], v176 offset:1024
    ds_read_b64_tr_b16 v[100:101], v177 offset:0
    ds_read_b64_tr_b16 v[102:103], v177 offset:1024
    v_mfma_f32_16x16x32_bf16 v[44:47], v[140:143], v[152:155], v[44:47]
    s_add_u32 m0, s43, 75776
    s_nop 0
    buffer_load_dwordx4 v189, s[16:19], s41 offen lds
    v_mfma_f32_16x16x32_bf16 v[32:35], v[128:131], v[156:159], v[32:35]
    v_mfma_f32_16x16x32_bf16 v[36:39], v[132:135], v[156:159], v[36:39]
    v_mfma_f32_16x16x32_bf16 v[40:43], v[120:123], v[156:159], v[40:43]
    v_mfma_f32_16x16x32_bf16 v[44:47], v[124:127], v[156:159], v[44:47]
    s_waitcnt lgkmcnt(6)
    v_mfma_f32_16x16x32_bf16 v[48:51], v[120:123], v[160:163], v[48:51]
    ds_read_b128 v[144:147], v184 offset:22528
    ds_read_b128 v[148:151], v184 offset:33280
    v_mfma_f32_16x16x32_bf16 v[52:55], v[124:127], v[160:163], v[52:55]
    v_mfma_f32_16x16x32_bf16 v[56:59], v[136:139], v[160:163], v[56:59]
    ds_read_b64_tr_b16 v[104:105], v176 offset:8192
    ds_read_b64_tr_b16 v[106:107], v176 offset:9216
    ds_read_b64_tr_b16 v[108:109], v177 offset:8192
    ds_read_b64_tr_b16 v[110:111], v177 offset:9216
    v_mfma_f32_16x16x32_bf16 v[60:63], v[140:143], v[160:163], v[60:63]
    buffer_load_dwordx4 v189, s[16:19], s41 offen offset:1024 lds
    v_mfma_f32_16x16x32_bf16 v[48:51], v[128:131], v[164:167], v[48:51]
    v_mfma_f32_16x16x32_bf16 v[52:55], v[132:135], v[164:167], v[52:55]
    v_mfma_f32_16x16x32_bf16 v[56:59], v[120:123], v[164:167], v[56:59]
    v_mfma_f32_16x16x32_bf16 v[60:63], v[124:127], v[164:167], v[60:63]
    s_waitcnt lgkmcnt(10)
    v_mfma_f32_16x16x32_bf16 v[64:67], v[120:123], v[168:171], v[64:67]
    ds_read_b128 v[152:155], v184 offset:23552
    ds_read_b128 v[156:159], v184 offset:34304
    v_mfma_f32_16x16x32_bf16 v[68:71], v[124:127], v[168:171], v[68:71]
    s_waitcnt lgkmcnt(2)
    v_mfma_f32_16x16x32_bf16 v[72:75], v[136:139], v[168:171], v[72:75]
    v_xor_b32 v112, 0x80008000, v104
    v_xor_b32 v113, 0x80008000, v105
    v_mfma_f32_16x16x32_bf16 v[76:79], v[140:143], v[168:171], v[76:79]
    s_mov_b64 exec, s[44:45]
    buffer_load_dwordx4 v189, s[16:19], s41 offen offset:2048 lds
    s_mov_b64 exec, -1
    s_add_u32 s41, s41, 21504
    v_xor_b32 v114, 0x80008000, v106
    v_xor_b32 v115, 0x80008000, v107
    v_mfma_f32_16x16x32_bf16 v[64:67], v[128:131], v[172:175], v[64:67]
    v_xor_b32 v116, 0x80008000, v108
    v_xor_b32 v117, 0x80008000, v109
    v_mfma_f32_16x16x32_bf16 v[68:71], v[132:135], v[172:175], v[68:71]
    v_xor_b32 v118, 0x80008000, v110
    v_xor_b32 v119, 0x80008000, v111
    v_mfma_f32_16x16x32_bf16 v[72:75], v[120:123], v[172:175], v[72:75]
    v_mfma_f32_16x16x32_bf16 v[76:79], v[124:127], v[172:175], v[76:79]
    s_sub_u32 s46, s46, 1
    s_cmp_lg_u32 s46, 0
    s_cbranch_scc1 L_k3_loop1
    s_waitcnt vmcnt(5)
    s_barrier
    v_mfma_f32_16x16x32_bf16 v[0:3], v[96:99], v[144:147], v[0:3]
    ds_read_b128 v[160:163], v184 offset:24576
    ds_read_b128 v[164:167], v184 offset:35328
    v_mfma_f32_16x16x32_bf16 v[4:7], v[100:103], v[144:147], v[4:7]
    v_mfma_f32_16x16x32_bf16 v[8:11], v[112:115], v[144:147], v[8:11]
    v_mfma_f32_16x16x32_bf16 v[12:15], v[116:119], v[144:147], v[12:15]
    s_add_u32 m0, s42, 113664
    s_nop 0
    buffer_load_dwordx4 v188, s[16:19], s40 offen lds
    v_mfma_f32_16x16x32_bf16 v[0:3], v[104:107], v[148:151], v[0:3]
    v_mfma_f32_16x16x32_bf16 v[4:7], v[108:111], v[148:151], v[4:7]
    v_mfma_f32_16x16x32_bf16 v[8:11], v[96:99], v[148:151], v[8:11]
    v_mfma_f32_16x16x32_bf16 v[12:15], v[100:103], v[148:151], v[12:15]
    s_waitcnt lgkmcnt(2)
    v_mfma_f32_16x16x32_bf16 v[16:19], v[96:99], v[152:155], v[16:19]
    ds_read_b128 v[168:171], v184 offset:25600
    ds_read_b128 v[172:175], v184 offset:36352
    v_mfma_f32_16x16x32_bf16 v[20:23], v[100:103], v[152:155], v[20:23]
    v_mfma_f32_16x16x32_bf16 v[24:27], v[112:115], v[152:155], v[24:27]
    v_mfma_f32_16x16x32_bf16 v[28:31], v[116:119], v[152:155], v[28:31]
    buffer_load_dwordx4 v188, s[16:19], s40 offen offset:1024 lds
    s_add_u32 s40, s40, 16384
    v_mfma_f32_16x16x32_bf16 v[16:19], v[104:107], v[156:159], v[16:19]
    v_mfma_f32_16x16x32_bf16 v[20:23], v[108:111], v[156:159], v[20:23]
    v_mfma_f32_16x16x32_bf16 v[24:27], v[96:99], v[156:159], v[24:27]
    v_mfma_f32_16x16x32_bf16 v[28:31], v[100:103], v[156:159], v[28:31]
    s_waitcnt lgkmcnt(2)
    v_mfma_f32_16x16x32_bf16 v[32:35], v[96:99], v[160:163], v[32:35]
    ds_read_b128 v[144:147], v184 offset:26624
    ds_read_b128 v[148:151], v184 offset:37376
    v_mfma_f32_16x16x32_bf16 v[36:39], v[100:103], v[160:163], v[36:39]
    v_mfma_f32_16x16x32_bf16 v[40:43], v[112:115], v[160:163], v[40:43]
    ds_read_b64_tr_b16 v[120:121], v178 offset:0
    ds_read_b64_tr_b16 v[122:123], v178 offset:1024
    ds_read_b64_tr_b16 v[124:125], v179 offset:0
    ds_read_b64_tr_b16 v[126:127], v179 offset:1024
    v_mfma_f32_16x16x32_bf16 v[44:47], v[116:119], v[160:163], v[44:47]
    s_add_u32 m0, s43, 113664
    s_nop 0
    buffer_load_dwordx4 v189, s[16:19], s41 offen lds
    v_mfma_f32_16x16x32_bf16 v[32:35], v[104:107], v[164:167], v[32:35]
    v_mfma_f32_16x16x32_bf16 v[36:39], v[108:111], v[164:167], v[36:39]
    v_mfma_f32_16x16x32_bf16 v[40:43], v[96:99], v[164:167], v[40:43]
    v_mfma_f32_16x16x32_bf16 v[44:47], v[100:103], v[164:167], v[44:47]
    s_waitcnt lgkmcnt(6)
    v_mfma_f32_16x16x32_bf16 v[48:51], v[96:99], v[168:171], v[48:51]
    ds_read_b128 v[152:155], v185 offset:22528
    ds_read_b128 v[156:159], v185 offset:33280
    v_mfma_f32_16x16x32_bf16 v[52:55], v[100:103], v[168:171], v[52:55]
    v_mfma_f32_16x16x32_bf16 v[56:59], v[112:115], v[168:171], v[56:59]
    ds_read_b64_tr_b16 v[128:129], v178 offset:8192
    ds_read_b64_tr_b16 v[130:131], v178 offset:9216
    ds_read_b64_tr_b16 v[132:133], v179 offset:8192
    ds_read_b64_tr_b16 v[134:135], v179 offset:9216
    v_mfma_f32_16x16x32_bf16 v[60:63], v[116:119], v[168:171], v[60:63]
    buffer_load_dwordx4 v189, s[16:19], s41 offen offset:1024 lds
    v_mfma_f32_16x16x32_bf16 v[48:51], v[104:107], v[172:175], v[48:51]
    v_mfma_f32_16x16x32_bf16 v[52:55], v[108:111], v[172:175], v[52:55]
    v_mfma_f32_16x16x32_bf16 v[56:59], v[96:99], v[172:175], v[56:59]
    v_mfma_f32_16x16x32_bf16 v[60:63], v[100:103], v[172:175], v[60:63]
    s_waitcnt lgkmcnt(10)
    v_mfma_f32_16x16x32_bf16 v[64:67], v[96:99], v[144:147], v[64:67]
    ds_read_b128 v[160:163], v185 offset:23552
    ds_read_b128 v[164:167], v185 offset:34304
    v_mfma_f32_16x16x32_bf16 v[68:71], v[100:103], v[144:147], v[68:71]
    s_waitcnt lgkmcnt(2)
    v_mfma_f32_16x16x32_bf16 v[72:75], v[112:115], v[144:147], v[72:75]
    v_xor_b32 v136, 0x80008000, v128
    v_xor_b32 v137, 0x80008000, v129
    v_mfma_f32_16x16x32_bf16 v[76:79], v[116:119], v[144:147], v[76:79]
    s_mov_b64 exec, s[44:45]
    buffer_load_dwordx4 v189, s[16:19], s41 offen offset:2048 lds
    s_mov_b64 exec, -1
    s_add_u32 s41, s41, 21504
    v_xor_b32 v138, 0x80008000, v130
    v_xor_b32 v139, 0x80008000, v131
    v_mfma_f32_16x16x32_bf16 v[64:67], v[104:107], v[148:151], v[64:67]
    v_xor_b32 v140, 0x80008000, v132
    v_xor_b32 v141, 0x80008000, v133
    v_mfma_f32_16x16x32_bf16 v[68:71], v[108:111], v[148:151], v[68:71]
    v_xor_b32 v142, 0x80008000, v134
    v_xor_b32 v143, 0x80008000, v135
    v_mfma_f32_16x16x32_bf16 v[72:75], v[96:99], v[148:151], v[72:75]
    v_mfma_f32_16x16x32_bf16 v[76:79], v[100:103], v[148:151], v[76:79]
    s_waitcnt vmcnt(5)
    s_barrier
    v_mfma_f32_16x16x32_bf16 v[0:3], v[120:123], v[152:155], v[0:3]
    ds_read_b128 v[168:171], v185 offset:24576
    ds_read_b128 v[172:175], v185 offset:35328
    v_mfma_f32_16x16x32_bf16 v[4:7], v[124:127], v[152:155], v[4:7]
    v_mfma_f32_16x16x32_bf16 v[8:11], v[136:139], v[152:155], v[8:11]
    v_mfma_f32_16x16x32_bf16 v[12:15], v[140:143], v[152:155], v[12:15]
    v_mfma_f32_16x16x32_bf16 v[0:3], v[128:131], v[156:159], v[0:3]
    v_mfma_f32_16x16x32_bf16 v[4:7], v[132:135], v[156:159], v[4:7]
    v_mfma_f32_16x16x32_bf16 v[8:11], v[120:123], v[156:159], v[8:11]
    v_mfma_f32_16x16x32_bf16 v[12:15], v[124:127], v[156:159], v[12:15]
    s_waitcnt lgkmcnt(2)
    v_mfma_f32_16x16x32_bf16 v[16:19], v[120:123], v[160:163], v[16:19]
    ds_read_b128 v[144:147], v185 offset:25600
    ds_read_b128 v[148:151], v185 offset:36352
    v_mfma_f32_16x16x32_bf16 v[20:23], v[124:127], v[160:163], v[20:23]
    v_mfma_f32_16x16x32_bf16 v[24:27], v[136:139], v[160:163], v[24:27]
    v_mfma_f32_16x16x32_bf16 v[28:31], v[140:143], v[160:163], v[28:31]
    v_mfma_f32_16x16x32_bf16 v[16:19], v[128:131], v[164:167], v[16:19]
    v_mfma_f32_16x16x32_bf16 v[20:23], v[132:135], v[164:167], v[20:23]
    v_mfma_f32_16x16x32_bf16 v[24:27], v[120:123], v[164:167], v[24:27]
    v_mfma_f32_16x16x32_bf16 v[28:31], v[124:127], v[164:167], v[28:31]
    s_waitcnt lgkmcnt(2)
    v_mfma_f32_16x16x32_bf16 v[32:35], v[120:123], v[168:171], v[32:35]
    ds_read_b128 v[152:155], v185 offset:26624
    ds_read_b128 v[156:159], v185 offset:37376
    v_mfma_f32_16x16x32_bf16 v[36:39], v[124:127], v[168:171], v[36:39]
    v_mfma_f32_16x16x32_bf16 v[40:43], v[136:139], v[168:171], v[40:43]
    ds_read_b64_tr_b16 v[96:97], v180 offset:0
    ds_read_b64_tr_b16 v[98:99], v180 offset:1024
    ds_read_b64_tr_b16 v[100:101], v181 offset:0
    ds_read_b64_tr_b16 v[102:103], v181 offset:1024
    v_mfma_f32_16x16x32_bf16 v[44:47], v[140:143], v[168:171], v[44:47]
    v_mfma_f32_16x16x32_bf16 v[32:35], v[128:131], v[172:175], v[32:35]
    v_mfma_f32_16x16x32_bf16 v[36:39], v[132:135], v[172:175], v[36:39]
    v_mfma_f32_16x16x32_bf16 v[40:43], v[120:123], v[172:175], v[40:43]
    v_mfma_f32_16x16x32_bf16 v[44:47], v[124:127], v[172:175], v[44:47]
    s_waitcnt lgkmcnt(6)
    v_mfma_f32_16x16x32_bf16 v[48:51], v[120:123], v[144:147], v[48:51]
    ds_read_b128 v[160:163], v186 offset:22528
    ds_read_b128 v[164:167], v186 offset:33280
    v_mfma_f32_16x16x32_bf16 v[52:55], v[124:127], v[144:147], v[52:55]
    v_mfma_f32_16x16x32_bf16 v[56:59], v[136:139], v[144:147], v[56:59]
    ds_read_b64_tr_b16 v[104:105], v180 offset:8192
    ds_read_b64_tr_b16 v[106:107], v180 offset:9216
    ds_read_b64_tr_b16 v[108:109], v181 offset:8192
    ds_read_b64_tr_b16 v[110:111], v181 offset:9216
    v_mfma_f32_16x16x32_bf16 v[60:63], v[140:143], v[144:147], v[60:63]
    v_mfma_f32_16x16x32_bf16 v[48:51], v[128:131], v[148:151], v[48:51]
    v_mfma_f32_16x16x32_bf16 v[52:55], v[132:135], v[148:151], v[52:55]
    v_mfma_f32_16x16x32_bf16 v[56:59], v[120:123], v[148:151], v[56:59]
    v_mfma_f32_16x16x32_bf16 v[60:63], v[124:127], v[148:151], v[60:63]
    s_waitcnt lgkmcnt(10)
    v_mfma_f32_16x16x32_bf16 v[64:67], v[120:123], v[152:155], v[64:67]
    ds_read_b128 v[168:171], v186 offset:23552
    ds_read_b128 v[172:175], v186 offset:34304
    v_mfma_f32_16x16x32_bf16 v[68:71], v[124:127], v[152:155], v[68:71]
    s_waitcnt lgkmcnt(2)
    v_mfma_f32_16x16x32_bf16 v[72:75], v[136:139], v[152:155], v[72:75]
    v_xor_b32 v112, 0x80008000, v104
    v_xor_b32 v113, 0x80008000, v105
    v_mfma_f32_16x16x32_bf16 v[76:79], v[140:143], v[152:155], v[76:79]
    v_xor_b32 v114, 0x80008000, v106
    v_xor_b32 v115, 0x80008000, v107
    v_mfma_f32_16x16x32_bf16 v[64:67], v[128:131], v[156:159], v[64:67]
    v_xor_b32 v116, 0x80008000, v108
    v_xor_b32 v117, 0x80008000, v109
    v_mfma_f32_16x16x32_bf16 v[68:71], v[132:135], v[156:159], v[68:71]
    v_xor_b32 v118, 0x80008000, v110
    v_xor_b32 v119, 0x80008000, v111
    v_mfma_f32_16x16x32_bf16 v[72:75], v[120:123], v[156:159], v[72:75]
    v_mfma_f32_16x16x32_bf16 v[76:79], v[124:127], v[156:159], v[76:79]
    s_waitcnt vmcnt(0)
    s_barrier
    v_mfma_f32_16x16x32_bf16 v[0:3], v[96:99], v[160:163], v[0:3]
    ds_read_b128 v[144:147], v186 offset:24576
    ds_read_b128 v[148:151], v186 offset:35328
    v_mfma_f32_16x16x32_bf16 v[4:7], v[100:103], v[160:163], v[4:7]
    v_mfma_f32_16x16x32_bf16 v[8:11], v[112:115], v[160:163], v[8:11]
    v_mfma_f32_16x16x32_bf16 v[12:15], v[116:119], v[160:163], v[12:15]
    v_mfma_f32_16x16x32_bf16 v[0:3], v[104:107], v[164:167], v[0:3]
    v_mfma_f32_16x16x32_bf16 v[4:7], v[108:111], v[164:167], v[4:7]
    v_mfma_f32_16x16x32_bf16 v[8:11], v[96:99], v[164:167], v[8:11]
    v_mfma_f32_16x16x32_bf16 v[12:15], v[100:103], v[164:167], v[12:15]
    s_waitcnt lgkmcnt(2)
    v_mfma_f32_16x16x32_bf16 v[16:19], v[96:99], v[168:171], v[16:19]
    ds_read_b128 v[152:155], v186 offset:25600
    ds_read_b128 v[156:159], v186 offset:36352
    v_mfma_f32_16x16x32_bf16 v[20:23], v[100:103], v[168:171], v[20:23]
    v_mfma_f32_16x16x32_bf16 v[24:27], v[112:115], v[168:171], v[24:27]
    v_mfma_f32_16x16x32_bf16 v[28:31], v[116:119], v[168:171], v[28:31]
    v_mfma_f32_16x16x32_bf16 v[16:19], v[104:107], v[172:175], v[16:19]
    v_mfma_f32_16x16x32_bf16 v[20:23], v[108:111], v[172:175], v[20:23]
    v_mfma_f32_16x16x32_bf16 v[24:27], v[96:99], v[172:175], v[24:27]
    v_mfma_f32_16x16x32_bf16 v[28:31], v[100:103], v[172:175], v[28:31]
    s_waitcnt lgkmcnt(2)
    v_mfma_f32_16x16x32_bf16 v[32:35], v[96:99], v[144:147], v[32:35]
    ds_read_b128 v[160:163], v186 offset:26624
    ds_read_b128 v[164:167], v186 offset:37376
    v_mfma_f32_16x16x32_bf16 v[36:39], v[100:103], v[144:147], v[36:39]
    v_mfma_f32_16x16x32_bf16 v[40:43], v[112:115], v[144:147], v[40:43]
    ds_read_b64_tr_b16 v[120:121], v182 offset:0
    ds_read_b64_tr_b16 v[122:123], v182 offset:1024
    ds_read_b64_tr_b16 v[124:125], v183 offset:0
    ds_read_b64_tr_b16 v[126:127], v183 offset:1024
    v_mfma_f32_16x16x32_bf16 v[44:47], v[116:119], v[144:147], v[44:47]
    v_mfma_f32_16x16x32_bf16 v[32:35], v[104:107], v[148:151], v[32:35]
    v_mfma_f32_16x16x32_bf16 v[36:39], v[108:111], v[148:151], v[36:39]
    v_mfma_f32_16x16x32_bf16 v[40:43], v[96:99], v[148:151], v[40:43]
    v_mfma_f32_16x16x32_bf16 v[44:47], v[100:103], v[148:151], v[44:47]
    s_waitcnt lgkmcnt(6)
    v_mfma_f32_16x16x32_bf16 v[48:51], v[96:99], v[152:155], v[48:51]
    ds_read_b128 v[168:171], v187 offset:22528
    ds_read_b128 v[172:175], v187 offset:33280
    v_mfma_f32_16x16x32_bf16 v[52:55], v[100:103], v[152:155], v[52:55]
    v_mfma_f32_16x16x32_bf16 v[56:59], v[112:115], v[152:155], v[56:59]
    ds_read_b64_tr_b16 v[128:129], v182 offset:8192
    ds_read_b64_tr_b16 v[130:131], v182 offset:9216
    ds_read_b64_tr_b16 v[132:133], v183 offset:8192
    ds_read_b64_tr_b16 v[134:135], v183 offset:9216
    v_mfma_f32_16x16x32_bf16 v[60:63], v[116:119], v[152:155], v[60:63]
    v_mfma_f32_16x16x32_bf16 v[48:51], v[104:107], v[156:159], v[48:51]
    v_mfma_f32_16x16x32_bf16 v[52:55], v[108:111], v[156:159], v[52:55]
    v_mfma_f32_16x16x32_bf16 v[56:59], v[96:99], v[156:159], v[56:59]
    v_mfma_f32_16x16x32_bf16 v[60:63], v[100:103], v[156:159], v[60:63]
    s_waitcnt lgkmcnt(10)
    v_mfma_f32_16x16x32_bf16 v[64:67], v[96:99], v[160:163], v[64:67]
    ds_read_b128 v[144:147], v187 offset:23552
    ds_read_b128 v[148:151], v187 offset:34304
    v_mfma_f32_16x16x32_bf16 v[68:71], v[100:103], v[160:163], v[68:71]
    s_waitcnt lgkmcnt(2)
    v_mfma_f32_16x16x32_bf16 v[72:75], v[112:115], v[160:163], v[72:75]
    v_xor_b32 v136, 0x80008000, v128
    v_xor_b32 v137, 0x80008000, v129
    v_mfma_f32_16x16x32_bf16 v[76:79], v[116:119], v[160:163], v[76:79]
    v_xor_b32 v138, 0x80008000, v130
    v_xor_b32 v139, 0x80008000, v131
    v_mfma_f32_16x16x32_bf16 v[64:67], v[104:107], v[164:167], v[64:67]
    v_xor_b32 v140, 0x80008000, v132
    v_xor_b32 v141, 0x80008000, v133
    v_mfma_f32_16x16x32_bf16 v[68:71], v[108:111], v[164:167], v[68:71]
    v_xor_b32 v142, 0x80008000, v134
    v_xor_b32 v143, 0x80008000, v135
    v_mfma_f32_16x16x32_bf16 v[72:75], v[96:99], v[164:167], v[72:75]
    v_mfma_f32_16x16x32_bf16 v[76:79], v[100:103], v[164:167], v[76:79]
    v_mfma_f32_16x16x32_bf16 v[0:3], v[120:123], v[168:171], v[0:3]
    ds_read_b128 v[152:155], v187 offset:24576
    ds_read_b128 v[156:159], v187 offset:35328
    v_mfma_f32_16x16x32_bf16 v[4:7], v[124:127], v[168:171], v[4:7]
    v_mfma_f32_16x16x32_bf16 v[8:11], v[136:139], v[168:171], v[8:11]
    v_mfma_f32_16x16x32_bf16 v[12:15], v[140:143], v[168:171], v[12:15]
    v_mfma_f32_16x16x32_bf16 v[0:3], v[128:131], v[172:175], v[0:3]
    v_mfma_f32_16x16x32_bf16 v[4:7], v[132:135], v[172:175], v[4:7]
    v_mfma_f32_16x16x32_bf16 v[8:11], v[120:123], v[172:175], v[8:11]
    v_mfma_f32_16x16x32_bf16 v[12:15], v[124:127], v[172:175], v[12:15]
    s_waitcnt lgkmcnt(2)
    v_mfma_f32_16x16x32_bf16 v[16:19], v[120:123], v[144:147], v[16:19]
    ds_read_b128 v[160:163], v187 offset:25600
    ds_read_b128 v[164:167], v187 offset:36352
    v_mfma_f32_16x16x32_bf16 v[20:23], v[124:127], v[144:147], v[20:23]
    v_mfma_f32_16x16x32_bf16 v[24:27], v[136:139], v[144:147], v[24:27]
    v_mfma_f32_16x16x32_bf16 v[28:31], v[140:143], v[144:147], v[28:31]
    v_mfma_f32_16x16x32_bf16 v[16:19], v[128:131], v[148:151], v[16:19]
    v_mfma_f32_16x16x32_bf16 v[20:23], v[132:135], v[148:151], v[20:23]
    v_mfma_f32_16x16x32_bf16 v[24:27], v[120:123], v[148:151], v[24:27]
    v_mfma_f32_16x16x32_bf16 v[28:31], v[124:127], v[148:151], v[28:31]
    s_waitcnt lgkmcnt(2)
    v_mfma_f32_16x16x32_bf16 v[32:35], v[120:123], v[152:155], v[32:35]
    ds_read_b128 v[168:171], v187 offset:26624
    ds_read_b128 v[172:175], v187 offset:37376
    v_mfma_f32_16x16x32_bf16 v[36:39], v[124:127], v[152:155], v[36:39]
    v_mfma_f32_16x16x32_bf16 v[40:43], v[136:139], v[152:155], v[40:43]
    v_mfma_f32_16x16x32_bf16 v[44:47], v[140:143], v[152:155], v[44:47]
    v_mfma_f32_16x16x32_bf16 v[32:35], v[128:131], v[156:159], v[32:35]
    v_mfma_f32_16x16x32_bf16 v[36:39], v[132:135], v[156:159], v[36:39]
    v_mfma_f32_16x16x32_bf16 v[40:43], v[120:123], v[156:159], v[40:43]
    v_mfma_f32_16x16x32_bf16 v[44:47], v[124:127], v[156:159], v[44:47]
    s_waitcnt lgkmcnt(2)
    v_mfma_f32_16x16x32_bf16 v[48:51], v[120:123], v[160:163], v[48:51]
    v_mfma_f32_16x16x32_bf16 v[52:55], v[124:127], v[160:163], v[52:55]
    v_mfma_f32_16x16x32_bf16 v[56:59], v[136:139], v[160:163], v[56:59]
    v_mfma_f32_16x16x32_bf16 v[60:63], v[140:143], v[160:163], v[60:63]
    v_mfma_f32_16x16x32_bf16 v[48:51], v[128:131], v[164:167], v[48:51]
    v_mfma_f32_16x16x32_bf16 v[52:55], v[132:135], v[164:167], v[52:55]
    v_mfma_f32_16x16x32_bf16 v[56:59], v[120:123], v[164:167], v[56:59]
    v_mfma_f32_16x16x32_bf16 v[60:63], v[124:127], v[164:167], v[60:63]
    s_waitcnt lgkmcnt(0)
    v_mfma_f32_16x16x32_bf16 v[64:67], v[120:123], v[168:171], v[64:67]
    v_mfma_f32_16x16x32_bf16 v[68:71], v[124:127], v[168:171], v[68:71]
    v_mfma_f32_16x16x32_bf16 v[72:75], v[136:139], v[168:171], v[72:75]
    v_mfma_f32_16x16x32_bf16 v[76:79], v[140:143], v[168:171], v[76:79]
    v_mfma_f32_16x16x32_bf16 v[64:67], v[128:131], v[172:175], v[64:67]
    v_mfma_f32_16x16x32_bf16 v[68:71], v[132:135], v[172:175], v[68:71]
    v_mfma_f32_16x16x32_bf16 v[72:75], v[120:123], v[172:175], v[72:75]
    v_mfma_f32_16x16x32_bf16 v[76:79], v[124:127], v[172:175], v[76:79]
    s_nop 7
    v_cvt_pk_bf16_f32 v0, v0, v1
    v_cvt_pk_bf16_f32 v1, v2, v3
    v_cvt_pk_bf16_f32 v2, v4, v5
    v_cvt_pk_bf16_f32 v3, v6, v7
    s_add_u32 s47, s48, 98304
    buffer_store_dwordx4 v[0:3], v190, s[16:19], s47 offen
    v_cvt_pk_bf16_f32 v8, v8, v9
    v_cvt_pk_bf16_f32 v9, v10, v11
    v_cvt_pk_bf16_f32 v10, v12, v13
    v_cvt_pk_bf16_f32 v11, v14, v15
    s_add_u32 s47, s48, 458752
    buffer_store_dwordx4 v[8:11], v190, s[16:19], s47 offen
    v_cvt_pk_bf16_f32 v16, v16, v17
    v_cvt_pk_bf16_f32 v17, v18, v19
    v_cvt_pk_bf16_f32 v18, v20, v21
    v_cvt_pk_bf16_f32 v19, v22, v23
    s_add_u32 s47, s48, 114688
    buffer_store_dwordx4 v[16:19], v190, s[16:19], s47 offen
    v_cvt_pk_bf16_f32 v24, v24, v25
    v_cvt_pk_bf16_f32 v25, v26, v27
    v_cvt_pk_bf16_f32 v26, v28, v29
    v_cvt_pk_bf16_f32 v27, v30, v31
    s_add_u32 s47, s48, 475136
    buffer_store_dwordx4 v[24:27], v190, s[16:19], s47 offen
    v_cvt_pk_bf16_f32 v32, v32, v33
    v_cvt_pk_bf16_f32 v33, v34, v35
    v_cvt_pk_bf16_f32 v34, v36, v37
    v_cvt_pk_bf16_f32 v35, v38, v39
    s_add_u32 s47, s48, 131072
    buffer_store_dwordx4 v[32:35], v190, s[16:19], s47 offen
    v_cvt_pk_bf16_f32 v40, v40, v41
    v_cvt_pk_bf16_f32 v41, v42, v43
    v_cvt_pk_bf16_f32 v42, v44, v45
    v_cvt_pk_bf16_f32 v43, v46, v47
    s_add_u32 s47, s48, 491520
    buffer_store_dwordx4 v[40:43], v190, s[16:19], s47 offen
    v_cvt_pk_bf16_f32 v48, v48, v49
    v_cvt_pk_bf16_f32 v49, v50, v51
    v_cvt_pk_bf16_f32 v50, v52, v53
    v_cvt_pk_bf16_f32 v51, v54, v55
    s_add_u32 s47, s48, 147456
    buffer_store_dwordx4 v[48:51], v190, s[16:19], s47 offen
    v_cvt_pk_bf16_f32 v56, v56, v57
    v_cvt_pk_bf16_f32 v57, v58, v59
    v_cvt_pk_bf16_f32 v58, v60, v61
    v_cvt_pk_bf16_f32 v59, v62, v63
    s_add_u32 s47, s48, 507904
    buffer_store_dwordx4 v[56:59], v190, s[16:19], s47 offen
    v_cvt_pk_bf16_f32 v64, v64, v65
    v_cvt_pk_bf16_f32 v65, v66, v67
    v_cvt_pk_bf16_f32 v66, v68, v69
    v_cvt_pk_bf16_f32 v67, v70, v71
    s_add_u32 s47, s48, 163840
    buffer_store_dwordx4 v[64:67], v191, s[16:19], s47 offen
    v_cvt_pk_bf16_f32 v72, v72, v73
    v_cvt_pk_bf16_f32 v73, v74, v75
    v_cvt_pk_bf16_f32 v74, v76, v77
    v_cvt_pk_bf16_f32 v75, v78, v79
    s_add_u32 s47, s48, 524288
    buffer_store_dwordx4 v[72:75], v191, s[16:19], s47 offen
    s_endpgm
L_k3_end:
    s_endpgm
.globl stats_kernel
.p2align 8
.type stats_kernel,@function
stats_kernel:
    s_cmp_ge_u32 s2, 336
    s_cbranch_scc1 L_k4_end
    s_load_dwordx4 s[4:7], s[0:1], 16
    s_load_dwordx2 s[8:9], s[0:1], 48
    s_load_dwordx2 s[28:29], s[0:1], 32
    v_lshlrev_b32 v214, 2, v0
    v_and_b32 v200, 63, v0
    v_lshrrev_b32 v204, 6, v0
    v_and_b32 v201, 15, v200
    v_readfirstlane_b32 s10, v204
    v_lshrrev_b32 v202, 4, v200
    s_mov_b32 s30, 0x05040100
    s_mov_b32 s31, 0x07060302
    s_and_b32 s13, s2, 3
    s_lshr_b32 s12, s2, 2
    s_cmp_ge_u32 s12, 42
    s_cselect_b32 s11, 1, 0
    s_mul_i32 s15, s11, 42
    s_sub_u32 s12, s12, s15
    s_lshl_b32 s14, s12, 2
    s_add_u32 s14, s14, s10
    s_waitcnt lgkmcnt(0)
    s_mov_b32 s16, s8
    s_and_b32 s17, s9, 0xffff
    s_mov_b32 s18, 268435456
    s_mov_b32 s19, 0x00020000
    s_mov_b32 s24, 2883584
    v_mul_u32_u24 v203, s24, v202
    v_lshl_add_u32 v203, v201, 4, v203
    s_mul_i32 s24, s11, 180224
    s_lshl_b32 s25, s14, 10
    s_add_u32 s24, s24, s25
    s_lshl_b32 s25, s13, 8
    s_add_u32 s24, s24, s25
    s_add_u32 s24, s24, 117440512
    s_add_u32 s25, s24, 0
    buffer_load_dwordx4 v[0:3], v203, s[16:19], s25 offen
    s_add_u32 s25, s24, 360448
    buffer_load_dwordx4 v[4:7], v203, s[16:19], s25 offen
    s_add_u32 s25, s24, 720896
    buffer_load_dwordx4 v[8:11], v203, s[16:19], s25 offen
    s_add_u32 s25, s24, 1081344
    buffer_load_dwordx4 v[12:15], v203, s[16:19], s25 offen
    s_add_u32 s25, s24, 1441792
    buffer_load_dwordx4 v[16:19], v203, s[16:19], s25 offen
    s_add_u32 s25, s24, 1802240
    buffer_load_dwordx4 v[20:23], v203, s[16:19], s25 offen
    s_add_u32 s25, s24, 2162688
    buffer_load_dwordx4 v[24:27], v203, s[16:19], s25 offen
    s_add_u32 s25, s24, 2523136
    buffer_load_dwordx4 v[28:31], v203, s[16:19], s25 offen
    s_add_u32 s25, s24, 11534336
    buffer_load_dwordx4 v[32:35], v203, s[16:19], s25 offen
    s_add_u32 s25, s24, 11894784
    buffer_load_dwordx4 v[36:39], v203, s[16:19], s25 offen
    s_add_u32 s25, s24, 12255232
    buffer_load_dwordx4 v[40:43], v203, s[16:19], s25 offen
    s_add_u32 s25, s24, 12615680
    buffer_load_dwordx4 v[44:47], v203, s[16:19], s25 offen
    s_add_u32 s25, s24, 12976128
    buffer_load_dwordx4 v[48:51], v203, s[16:19], s25 offen
    s_add_u32 s25, s24, 13336576
    buffer_load_dwordx4 v[52:55], v203, s[16:19], s25 offen
    s_add_u32 s25, s24, 13697024
    buffer_load_dwordx4 v[56:59], v203, s[16:19], s25 offen
    s_add_u32 s25, s24, 14057472
    buffer_load_dwordx4 v[60:63], v203, s[16:19], s25 offen
    s_cmp_ge_u32 s10, 3
    s_cbranch_scc1 L_k4_notab
    s_lshl_b32 s25, s10, 4
    v_add_u32 v204, s25, v201
    v_lshlrev_b32 v205, 3, v202
    v_add_u32 v205, 1, v205
    v_mul_u32_u24 v88, v205, v204
    v_add_u32 v89, 32, v88
    v_add_u32 v205, 2, v205
    v_mul_u32_u24 v90, v205, v204
    v_add_u32 v91, 32, v90
    v_add_u32 v205, 2, v205
    v_mul_u32_u24 v92, v205, v204
    v_add_u32 v93, 32, v92
    v_add_u32 v205, 2, v205
    v_mul_u32_u24 v94, v205, v204
    v_add_u32 v95, 32, v94
    v_and_b32 v88, 127, v88
    v_cvt_f32_u32 v88, v88
    v_mul_f32 v88, 0x3c000000, v88
    v_cos_f32 v88, v88
    v_and_b32 v89, 127, v89
    v_cvt_f32_u32 v89, v89
    v_mul_f32 v89, 0x3c000000, v89
    v_cos_f32 v89, v89
    v_and_b32 v90, 127, v90
    v_cvt_f32_u32 v90, v90
    v_mul_f32 v90, 0x3c000000, v90
    v_cos_f32 v90, v90
    v_and_b32 v91, 127, v91
    v_cvt_f32_u32 v91, v91
    v_mul_f32 v91, 0x3c000000, v91
    v_cos_f32 v91, v91
    v_and_b32 v92, 127, v92
    v_cvt_f32_u32 v92, v92
    v_mul_f32 v92, 0x3c000000, v92
    v_cos_f32 v92, v92
    v_and_b32 v93, 127, v93
    v_cvt_f32_u32 v93, v93
    v_mul_f32 v93, 0x3c000000, v93
    v_cos_f32 v93, v93
    v_and_b32 v94, 127, v94
    v_cvt_f32_u32 v94, v94
    v_mul_f32 v94, 0x3c000000, v94
    v_cos_f32 v94, v94
    v_and_b32 v95, 127, v95
    v_cvt_f32_u32 v95, v95
    v_mul_f32 v95, 0x3c000000, v95
    v_cos_f32 v95, v95
    v_mul_f32 v88, 0x3d000000, v88
    v_mul_f32 v89, 0x3d000000, v89
    v_mul_f32 v90, 0x3d000000, v90
    v_mul_f32 v91, 0x3d000000, v91
    v_mul_f32 v92, 0x3d000000, v92
    v_mul_f32 v93, 0x3d000000, v93
    v_mul_f32 v94, 0x3d000000, v94
    v_mul_f32 v95, 0x3d000000, v95
    v_cvt_pk_bf16_f32 v104, v88, v89
    v_cvt_pk_bf16_f32 v105, v90, v91
    v_cvt_pk_bf16_f32 v106, v92, v93
    v_cvt_pk_bf16_f32 v107, v94, v95
    s_lshl_b32 s25, s10, 11
    v_lshlrev_b32 v207, 4, v200
    v_add_u32 v207, s25, v207
    ds_write_b128 v207, v[104:107] offset:0
    v_lshlrev_b32 v205, 3, v202
    v_add_u32 v205, 33, v205
    v_mul_u32_u24 v88, v205, v204
    v_add_u32 v89, 32, v88
    v_add_u32 v205, 2, v205
    v_mul_u32_u24 v90, v205, v204
    v_add_u32 v91, 32, v90
    v_add_u32 v205, 2, v205
    v_mul_u32_u24 v92, v205, v204
    v_add_u32 v93, 32, v92
    v_add_u32 v205, 2, v205
    v_mul_u32_u24 v94, v205, v204
    v_add_u32 v95, 32, v94
    v_and_b32 v88, 127, v88
    v_cvt_f32_u32 v88, v88
    v_mul_f32 v88, 0x3c000000, v88
    v_cos_f32 v88, v88
    v_and_b32 v89, 127, v89
    v_cvt_f32_u32 v89, v89
    v_mul_f32 v89, 0x3c000000, v89
    v_cos_f32 v89, v89
    v_and_b32 v90, 127, v90
    v_cvt_f32_u32 v90, v90
    v_mul_f32 v90, 0x3c000000, v90
    v_cos_f32 v90, v90
    v_and_b32 v91, 127, v91
    v_cvt_f32_u32 v91, v91
    v_mul_f32 v91, 0x3c000000, v91
    v_cos_f32 v91, v91
    v_and_b32 v92, 127, v92
    v_cvt_f32_u32 v92, v92
    v_mul_f32 v92, 0x3c000000, v92
    v_cos_f32 v92, v92
    v_and_b32 v93, 127, v93
    v_cvt_f32_u32 v93, v93
    v_mul_f32 v93, 0x3c000000, v93
    v_cos_f32 v93, v93
    v_and_b32 v94, 127, v94
    v_cvt_f32_u32 v94, v94
    v_mul_f32 v94, 0x3c000000, v94
    v_cos_f32 v94, v94
    v_and_b32 v95, 127, v95
    v_cvt_f32_u32 v95, v95
    v_mul_f32 v95, 0x3c000000, v95
    v_cos_f32 v95, v95
    v_mul_f32 v88, 0x3d000000, v88
    v_mul_f32 v89, 0x3d000000, v89
    v_mul_f32 v90, 0x3d000000, v90
    v_mul_f32 v91, 0x3d000000, v91
    v_mul_f32 v92, 0x3d000000, v92
    v_mul_f32 v93, 0x3d000000, v93
    v_mul_f32 v94, 0x3d000000, v94
    v_mul_f32 v95, 0x3d000000, v95
    v_cvt_pk_bf16_f32 v104, v88, v89
    v_cvt_pk_bf16_f32 v105, v90, v91
    v_cvt_pk_bf16_f32 v106, v92, v93
    v_cvt_pk_bf16_f32 v107, v94, v95
    s_lshl_b32 s25, s10, 11
    v_lshlrev_b32 v207, 4, v200
    v_add_u32 v207, s25, v207
    ds_write_b128 v207, v[104:107] offset:1024
L_k4_notab:
    s_waitcnt lgkmcnt(0)
    s_barrier
    v_lshlrev_b32 v207, 4, v200
    ds_read_b128 v[64:67], v207 offset:0
    ds_read_b128 v[68:71], v207 offset:1024
    ds_read_b128 v[72:75], v207 offset:2048
    ds_read_b128 v[76:79], v207 offset:3072
    ds_read_b128 v[80:83], v207 offset:4096
    ds_read_b128 v[84:87], v207 offset:5120
    s_cmp_ge_u32 s14, 167
    s_cbranch_scc1 L_k4_zero
    s_waitcnt lgkmcnt(0)
    s_cmp_lg_u32 s14, 166
    s_cbranch_scc1 L_k4_full
    v_cmp_gt_i32 vcc, 17, v201
    s_nop 1
    v_cndmask_b32 v64, 0, v64, vcc
    v_cndmask_b32 v65, 0, v65, vcc
    v_cndmask_b32 v66, 0, v66, vcc
    v_cndmask_b32 v67, 0, v67, vcc
    v_cndmask_b32 v68, 0, v68, vcc
    v_cndmask_b32 v69, 0, v69, vcc
    v_cndmask_b32 v70, 0, v70, vcc
    v_cndmask_b32 v71, 0, v71, vcc
    v_cmp_gt_i32 vcc, 1, v201
    s_nop 1
    v_cndmask_b32 v72, 0, v72, vcc
    v_cndmask_b32 v73, 0, v73, vcc
    v_cndmask_b32 v74, 0, v74, vcc
    v_cndmask_b32 v75, 0, v75, vcc
    v_cndmask_b32 v76, 0, v76, vcc
    v_cndmask_b32 v77, 0, v77, vcc
    v_cndmask_b32 v78, 0, v78, vcc
    v_cndmask_b32 v79, 0, v79, vcc
    v_cmp_gt_i32 vcc, 0, v201
    s_nop 1
    v_cndmask_b32 v80, 0, v80, vcc
    v_cndmask_b32 v81, 0, v81, vcc
    v_cndmask_b32 v82, 0, v82, vcc
    v_cndmask_b32 v83, 0, v83, vcc
    v_cndmask_b32 v84, 0, v84, vcc
    v_cndmask_b32 v85, 0, v85, vcc
    v_cndmask_b32 v86, 0, v86, vcc
    v_cndmask_b32 v87, 0, v87, vcc
L_k4_full:
    s_waitcnt vmcnt(0)
    v_perm_b32 v88, v4, v0, s30
    v_perm_b32 v89, v12, v8, s30
    v_perm_b32 v90, v20, v16, s30
    v_perm_b32 v91, v28, v24, s30
    v_perm_b32 v92, v4, v0, s31
    v_perm_b32 v93, v12, v8, s31
    v_perm_b32 v94, v20, v16, s31
    v_perm_b32 v95, v28, v24, s31
    v_perm_b32 v96, v36, v32, s30
    v_perm_b32 v97, v44, v40, s30
    v_perm_b32 v98, v52, v48, s30
    v_perm_b32 v99, v60, v56, s30
    v_perm_b32 v100, v36, v32, s31
    v_perm_b32 v101, v44, v40, s31
    v_perm_b32 v102, v52, v48, s31
    v_perm_b32 v103, v60, v56, s31
    v_mfma_f32_16x16x32_bf16 v[104:107], v[64:67], v[88:91], 0
    v_mfma_f32_16x16x32_bf16 v[108:111], v[64:67], v[92:95], 0
    v_mfma_f32_16x16x32_bf16 v[136:139], v[72:75], v[88:91], 0
    v_mfma_f32_16x16x32_bf16 v[140:143], v[72:75], v[92:95], 0
    v_mfma_f32_16x16x32_bf16 v[168:171], v[80:83], v[88:91], 0
    v_mfma_f32_16x16x32_bf16 v[172:175], v[80:83], v[92:95], 0
    v_mfma_f32_16x16x32_bf16 v[104:107], v[68:71], v[96:99], v[104:107]
    v_mfma_f32_16x16x32_bf16 v[108:111], v[68:71], v[100:103], v[108:111]
    v_mfma_f32_16x16x32_bf16 v[136:139], v[76:79], v[96:99], v[136:139]
    v_mfma_f32_16x16x32_bf16 v[140:143], v[76:79], v[100:103], v[140:143]
    v_mfma_f32_16x16x32_bf16 v[168:171], v[84:87], v[96:99], v[168:171]
    v_mfma_f32_16x16x32_bf16 v[172:175], v[84:87], v[100:103], v[172:175]
    v_perm_b32 v88, v5, v1, s30
    v_perm_b32 v89, v13, v9, s30
    v_perm_b32 v90, v21, v17, s30
    v_perm_b32 v91, v29, v25, s30
    v_perm_b32 v92, v5, v1, s31
    v_perm_b32 v93, v13, v9, s31
    v_perm_b32 v94, v21, v17, s31
    v_perm_b32 v95, v29, v25, s31
    v_perm_b32 v96, v37, v33, s30
    v_perm_b32 v97, v45, v41, s30
    v_perm_b32 v98, v53, v49, s30
    v_perm_b32 v99, v61, v57, s30
    v_perm_b32 v100, v37, v33, s31
    v_perm_b32 v101, v45, v41, s31
    v_perm_b32 v102, v53, v49, s31
    v_perm_b32 v103, v61, v57, s31
    v_mfma_f32_16x16x32_bf16 v[112:115], v[64:67], v[88:91], 0
    v_mfma_f32_16x16x32_bf16 v[116:119], v[64:67], v[92:95], 0
    v_mfma_f32_16x16x32_bf16 v[144:147], v[72:75], v[88:91], 0
    v_mfma_f32_16x16x32_bf16 v[148:151], v[72:75], v[92:95], 0
    v_mfma_f32_16x16x32_bf16 v[176:179], v[80:83], v[88:91], 0
    v_mfma_f32_16x16x32_bf16 v[180:183], v[80:83], v[92:95], 0
    v_mfma_f32_16x16x32_bf16 v[112:115], v[68:71], v[96:99], v[112:115]
    v_mfma_f32_16x16x32_bf16 v[116:119], v[68:71], v[100:103], v[116:119]
    v_mfma_f32_16x16x32_bf16 v[144:147], v[76:79], v[96:99], v[144:147]
    v_mfma_f32_16x16x32_bf16 v[148:151], v[76:79], v[100:103], v[148:151]
    v_mfma_f32_16x16x32_bf16 v[176:179], v[84:87], v[96:99], v[176:179]
    v_mfma_f32_16x16x32_bf16 v[180:183], v[84:87], v[100:103], v[180:183]
    v_perm_b32 v88, v6, v2, s30
    v_perm_b32 v89, v14, v10, s30
    v_perm_b32 v90, v22, v18, s30
    v_perm_b32 v91, v30, v26, s30
    v_perm_b32 v92, v6, v2, s31
    v_perm_b32 v93, v14, v10, s31
    v_perm_b32 v94, v22, v18, s31
    v_perm_b32 v95, v30, v26, s31
    v_perm_b32 v96, v38, v34, s30
    v_perm_b32 v97, v46, v42, s30
    v_perm_b32 v98, v54, v50, s30
    v_perm_b32 v99, v62, v58, s30
    v_perm_b32 v100, v38, v34, s31
    v_perm_b32 v101, v46, v42, s31
    v_perm_b32 v102, v54, v50, s31
    v_perm_b32 v103, v62, v58, s31
    v_mfma_f32_16x16x32_bf16 v[120:123], v[64:67], v[88:91], 0
    v_mfma_f32_16x16x32_bf16 v[124:127], v[64:67], v[92:95], 0
    v_mfma_f32_16x16x32_bf16 v[152:155], v[72:75], v[88:91], 0
    v_mfma_f32_16x16x32_bf16 v[156:159], v[72:75], v[92:95], 0
    v_mfma_f32_16x16x32_bf16 v[184:187], v[80:83], v[88:91], 0
    v_mfma_f32_16x16x32_bf16 v[188:191], v[80:83], v[92:95], 0
    v_mfma_f32_16x16x32_bf16 v[120:123], v[68:71], v[96:99], v[120:123]
    v_mfma_f32_16x16x32_bf16 v[124:127], v[68:71], v[100:103], v[124:127]
    v_mfma_f32_16x16x32_bf16 v[152:155], v[76:79], v[96:99], v[152:155]
    v_mfma_f32_16x16x32_bf16 v[156:159], v[76:79], v[100:103], v[156:159]
    v_mfma_f32_16x16x32_bf16 v[184:187], v[84:87], v[96:99], v[184:187]
    v_mfma_f32_16x16x32_bf16 v[188:191], v[84:87], v[100:103], v[188:191]
    v_perm_b32 v88, v7, v3, s30
    v_perm_b32 v89, v15, v11, s30
    v_perm_b32 v90, v23, v19, s30
    v_perm_b32 v91, v31, v27, s30
    v_perm_b32 v92, v7, v3, s31
    v_perm_b32 v93, v15, v11, s31
    v_perm_b32 v94, v23, v19, s31
    v_perm_b32 v95, v31, v27, s31
    v_perm_b32 v96, v39, v35, s30
    v_perm_b32 v97, v47, v43, s30
    v_perm_b32 v98, v55, v51, s30
    v_perm_b32 v99, v63, v59, s30
    v_perm_b32 v100, v39, v35, s31
    v_perm_b32 v101, v47, v43, s31
    v_perm_b32 v102, v55, v51, s31
    v_perm_b32 v103, v63, v59, s31
    v_mfma_f32_16x16x32_bf16 v[128:131], v[64:67], v[88:91], 0
    v_mfma_f32_16x16x32_bf16 v[132:135], v[64:67], v[92:95], 0
    v_mfma_f32_16x16x32_bf16 v[160:163], v[72:75], v[88:91], 0
    v_mfma_f32_16x16x32_bf16 v[164:167], v[72:75], v[92:95], 0
    v_mfma_f32_16x16x32_bf16 v[192:195], v[80:83], v[88:91], 0
    v_mfma_f32_16x16x32_bf16 v[196:199], v[80:83], v[92:95], 0
    v_mfma_f32_16x16x32_bf16 v[128:131], v[68:71], v[96:99], v[128:131]
    v_mfma_f32_16x16x32_bf16 v[132:135], v[68:71], v[100:103], v[132:135]
    v_mfma_f32_16x16x32_bf16 v[160:163], v[76:79], v[96:99], v[160:163]
    v_mfma_f32_16x16x32_bf16 v[164:167], v[76:79], v[100:103], v[164:167]
    v_mfma_f32_16x16x32_bf16 v[192:195], v[84:87], v[96:99], v[192:195]
    v_mfma_f32_16x16x32_bf16 v[196:199], v[84:87], v[100:103], v[196:199]
    s_nop 7
    v_mul_f32 v8, v104, v104
    v_mov_b32 v0, v104
    v_fmac_f32 v8, v105, v105
    v_add_f32 v0, v0, v105
    v_fmac_f32 v8, v106, v106
    v_add_f32 v0, v0, v106
    v_fmac_f32 v8, v107, v107
    v_add_f32 v0, v0, v107
    v_fmac_f32 v8, v136, v136
    v_add_f32 v0, v0, v136
    v_fmac_f32 v8, v137, v137
    v_add_f32 v0, v0, v137
    v_fmac_f32 v8, v138, v138
    v_add_f32 v0, v0, v138
    v_fmac_f32 v8, v139, v139
    v_add_f32 v0, v0, v139
    v_fmac_f32 v8, v168, v168
    v_add_f32 v0, v0, v168
    v_fmac_f32 v8, v169, v169
    v_add_f32 v0, v0, v169
    v_fmac_f32 v8, v170, v170
    v_add_f32 v0, v0, v170
    v_fmac_f32 v8, v171, v171
    v_add_f32 v0, v0, v171
    v_mul_f32 v9, v108, v108
    v_mov_b32 v1, v108
    v_fmac_f32 v9, v109, v109
    v_add_f32 v1, v1, v109
    v_fmac_f32 v9, v110, v110
    v_add_f32 v1, v1, v110
    v_fmac_f32 v9, v111, v111
    v_add_f32 v1, v1, v111
    v_fmac_f32 v9, v140, v140
    v_add_f32 v1, v1, v140
    v_fmac_f32 v9, v141, v141
    v_add_f32 v1, v1, v141
    v_fmac_f32 v9, v142, v142
    v_add_f32 v1, v1, v142
    v_fmac_f32 v9, v143, v143
    v_add_f32 v1, v1, v143
    v_fmac_f32 v9, v172, v172
    v_add_f32 v1, v1, v172
    v_fmac_f32 v9, v173, v173
    v_add_f32 v1, v1, v173
    v_fmac_f32 v9, v174, v174
    v_add_f32 v1, v1, v174
    v_fmac_f32 v9, v175, v175
    v_add_f32 v1, v1, v175
    v_mul_f32 v10, v112, v112
    v_mov_b32 v2, v112
    v_fmac_f32 v10, v113, v113
    v_add_f32 v2, v2, v113
    v_fmac_f32 v10, v114, v114
    v_add_f32 v2, v2, v114
    v_fmac_f32 v10, v115, v115
    v_add_f32 v2, v2, v115
    v_fmac_f32 v10, v144, v144
    v_add_f32 v2, v2, v144
    v_fmac_f32 v10, v145, v145
    v_add_f32 v2, v2, v145
    v_fmac_f32 v10, v146, v146
    v_add_f32 v2, v2, v146
    v_fmac_f32 v10, v147, v147
    v_add_f32 v2, v2, v147
    v_fmac_f32 v10, v176, v176
    v_add_f32 v2, v2, v176
    v_fmac_f32 v10, v177, v177
    v_add_f32 v2, v2, v177
    v_fmac_f32 v10, v178, v178
    v_add_f32 v2, v2, v178
    v_fmac_f32 v10, v179, v179
    v_add_f32 v2, v2, v179
    v_mul_f32 v11, v116, v116
    v_mov_b32 v3, v116
    v_fmac_f32 v11, v117, v117
    v_add_f32 v3, v3, v117
    v_fmac_f32 v11, v118, v118
    v_add_f32 v3, v3, v118
    v_fmac_f32 v11, v119, v119
    v_add_f32 v3, v3, v119
    v_fmac_f32 v11, v148, v148
    v_add_f32 v3, v3, v148
    v_fmac_f32 v11, v149, v149
    v_add_f32 v3, v3, v149
    v_fmac_f32 v11, v150, v150
    v_add_f32 v3, v3, v150
    v_fmac_f32 v11, v151, v151
    v_add_f32 v3, v3, v151
    v_fmac_f32 v11, v180, v180
    v_add_f32 v3, v3, v180
    v_fmac_f32 v11, v181, v181
    v_add_f32 v3, v3, v181
    v_fmac_f32 v11, v182, v182
    v_add_f32 v3, v3, v182
    v_fmac_f32 v11, v183, v183
    v_add_f32 v3, v3, v183
    v_mul_f32 v12, v120, v120
    v_mov_b32 v4, v120
    v_fmac_f32 v12, v121, v121
    v_add_f32 v4, v4, v121
    v_fmac_f32 v12, v122, v122
    v_add_f32 v4, v4, v122
    v_fmac_f32 v12, v123, v123
    v_add_f32 v4, v4, v123
    v_fmac_f32 v12, v152, v152
    v_add_f32 v4, v4, v152
    v_fmac_f32 v12, v153, v153
    v_add_f32 v4, v4, v153
    v_fmac_f32 v12, v154, v154
    v_add_f32 v4, v4, v154
    v_fmac_f32 v12, v155, v155
    v_add_f32 v4, v4, v155
    v_fmac_f32 v12, v184, v184
    v_add_f32 v4, v4, v184
    v_fmac_f32 v12, v185, v185
    v_add_f32 v4, v4, v185
    v_fmac_f32 v12, v186, v186
    v_add_f32 v4, v4, v186
    v_fmac_f32 v12, v187, v187
    v_add_f32 v4, v4, v187
    v_mul_f32 v13, v124, v124
    v_mov_b32 v5, v124
    v_fmac_f32 v13, v125, v125
    v_add_f32 v5, v5, v125
    v_fmac_f32 v13, v126, v126
    v_add_f32 v5, v5, v126
    v_fmac_f32 v13, v127, v127
    v_add_f32 v5, v5, v127
    v_fmac_f32 v13, v156, v156
    v_add_f32 v5, v5, v156
    v_fmac_f32 v13, v157, v157
    v_add_f32 v5, v5, v157
    v_fmac_f32 v13, v158, v158
    v_add_f32 v5, v5, v158
    v_fmac_f32 v13, v159, v159
    v_add_f32 v5, v5, v159
    v_fmac_f32 v13, v188, v188
    v_add_f32 v5, v5, v188
    v_fmac_f32 v13, v189, v189
    v_add_f32 v5, v5, v189
    v_fmac_f32 v13, v190, v190
    v_add_f32 v5, v5, v190
    v_fmac_f32 v13, v191, v191
    v_add_f32 v5, v5, v191
    v_mul_f32 v14, v128, v128
    v_mov_b32 v6, v128
    v_fmac_f32 v14, v129, v129
    v_add_f32 v6, v6, v129
    v_fmac_f32 v14, v130, v130
    v_add_f32 v6, v6, v130
    v_fmac_f32 v14, v131, v131
    v_add_f32 v6, v6, v131
    v_fmac_f32 v14, v160, v160
    v_add_f32 v6, v6, v160
    v_fmac_f32 v14, v161, v161
    v_add_f32 v6, v6, v161
    v_fmac_f32 v14, v162, v162
    v_add_f32 v6, v6, v162
    v_fmac_f32 v14, v163, v163
    v_add_f32 v6, v6, v163
    v_fmac_f32 v14, v192, v192
    v_add_f32 v6, v6, v192
    v_fmac_f32 v14, v193, v193
    v_add_f32 v6, v6, v193
    v_fmac_f32 v14, v194, v194
    v_add_f32 v6, v6, v194
    v_fmac_f32 v14, v195, v195
    v_add_f32 v6, v6, v195
    v_mul_f32 v15, v132, v132
    v_mov_b32 v7, v132
    v_fmac_f32 v15, v133, v133
    v_add_f32 v7, v7, v133
    v_fmac_f32 v15, v134, v134
    v_add_f32 v7, v7, v134
    v_fmac_f32 v15, v135, v135
    v_add_f32 v7, v7, v135
    v_fmac_f32 v15, v164, v164
    v_add_f32 v7, v7, v164
    v_fmac_f32 v15, v165, v165
    v_add_f32 v7, v7, v165
    v_fmac_f32 v15, v166, v166
    v_add_f32 v7, v7, v166
    v_fmac_f32 v15, v167, v167
    v_add_f32 v7, v7, v167
    v_fmac_f32 v15, v196, v196
    v_add_f32 v7, v7, v196
    v_fmac_f32 v15, v197, v197
    v_add_f32 v7, v7, v197
    v_fmac_f32 v15, v198, v198
    v_add_f32 v7, v7, v198
    v_fmac_f32 v15, v199, v199
    v_add_f32 v7, v7, v199
    s_branch L_k4_red
L_k4_zero:
    s_waitcnt vmcnt(0) lgkmcnt(0)
    v_mov_b32 v0, 0
    v_mov_b32 v1, 0
    v_mov_b32 v2, 0
    v_mov_b32 v3, 0
    v_mov_b32 v4, 0
    v_mov_b32 v5, 0
    v_mov_b32 v6, 0
    v_mov_b32 v7, 0
    v_mov_b32 v8, 0
    v_mov_b32 v9, 0
    v_mov_b32 v10, 0
    v_mov_b32 v11, 0
    v_mov_b32 v12, 0
    v_mov_b32 v13, 0
    v_mov_b32 v14, 0
    v_mov_b32 v15, 0
L_k4_red:
    s_lshl_b32 s25, s10, 12
    v_lshlrev_b32 v204, 10, v202
    v_lshl_add_u32 v204, v201, 5, v204
    v_add_u32 v204, s25, v204
    ds_write_b128 v204, v[0:3] offset:8192
    ds_write_b128 v204, v[4:7] offset:8208
    ds_write_b128 v204, v[8:11] offset:8704
    ds_write_b128 v204, v[12:15] offset:8720
    s_waitcnt lgkmcnt(0)
    s_barrier
    ds_read_b32 v16, v214 offset:8192
    ds_read_b32 v17, v214 offset:9216
    ds_read_b32 v18, v214 offset:10240
    ds_read_b32 v19, v214 offset:11264
    ds_read_b32 v20, v214 offset:12288
    ds_read_b32 v21, v214 offset:13312
    ds_read_b32 v22, v214 offset:14336
    ds_read_b32 v23, v214 offset:15360
    ds_read_b32 v24, v214 offset:16384
    ds_read_b32 v25, v214 offset:17408
    ds_read_b32 v26, v214 offset:18432
    ds_read_b32 v27, v214 offset:19456
    ds_read_b32 v28, v214 offset:20480
    ds_read_b32 v29, v214 offset:21504
    ds_read_b32 v30, v214 offset:22528
    ds_read_b32 v31, v214 offset:23552
    s_waitcnt lgkmcnt(0)
    v_add_f32 v16, v16, v17
    v_add_f32 v16, v16, v18
    v_add_f32 v16, v16, v19
    v_add_f32 v16, v16, v20
    v_add_f32 v16, v16, v21
    v_add_f32 v16, v16, v22
    v_add_f32 v16, v16, v23
    v_add_f32 v16, v16, v24
    v_add_f32 v16, v16, v25
    v_add_f32 v16, v16, v26
    v_add_f32 v16, v16, v27
    v_add_f32 v16, v16, v28
    v_add_f32 v16, v16, v29
    v_add_f32 v16, v16, v30
    v_add_f32 v16, v16, v31
    s_mul_i32 s24, s11, 168
    s_mul_i32 s25, s13, 42
    s_add_u32 s24, s24, s25
    s_add_u32 s24, s24, s12
    s_lshl_b32 s24, s24, 10
    s_add_u32 s24, s24, 146800640
    buffer_store_dword v16, v214, s[16:19], s24 offen
L_k4_end:
    s_endpgm
.globl final_kernel
.p2align 8
.type final_kernel,@function
final_kernel:
    s_cmp_ge_u32 s2, 336
    s_cbranch_scc1 L_k5_end
    s_load_dwordx4 s[4:7], s[0:1], 16
    s_load_dwordx2 s[8:9], s[0:1], 48
    s_load_dwordx2 s[28:29], s[0:1], 32
    v_lshlrev_b32 v214, 2, v0
    v_and_b32 v200, 63, v0
    v_lshrrev_b32 v204, 6, v0
    v_and_b32 v201, 15, v200
    v_readfirstlane_b32 s10, v204
    v_lshrrev_b32 v202, 4, v200
    s_mov_b32 s30, 0x05040100
    s_mov_b32 s31, 0x07060302
    s_and_b32 s13, s2, 3
    s_lshr_b32 s12, s2, 2
    s_cmp_ge_u32 s12, 42
    s_cselect_b32 s11, 1, 0
    s_mul_i32 s15, s11, 42
    s_sub_u32 s12, s12, s15
    s_lshl_b32 s14, s12, 2
    s_add_u32 s14, s14, s10
    s_waitcnt lgkmcnt(0)
    s_mov_b32 s16, s8
    s_and_b32 s17, s9, 0xffff
    s_mov_b32 s18, 268435456
    s_mov_b32 s19, 0x00020000
    s_mov_b32 s24, 2883584
    v_mul_u32_u24 v203, s24, v202
    v_lshl_add_u32 v203, v201, 4, v203
    s_mul_i32 s24, s11, 180224
    s_lshl_b32 s25, s14, 10
    s_add_u32 s24, s24, s25
    s_lshl_b32 s25, s13, 8
    s_add_u32 s24, s24, s25
    s_add_u32 s24, s24, 117440512
    s_add_u32 s25, s24, 0
    buffer_load_dwordx4 v[0:3], v203, s[16:19], s25 offen
    s_add_u32 s25, s24, 360448
    buffer_load_dwordx4 v[4:7], v203, s[16:19], s25 offen
    s_add_u32 s25, s24, 720896
    buffer_load_dwordx4 v[8:11], v203, s[16:19], s25 offen
    s_add_u32 s25, s24, 1081344
    buffer_load_dwordx4 v[12:15], v203, s[16:19], s25 offen
    s_add_u32 s25, s24, 1441792
    buffer_load_dwordx4 v[16:19], v203, s[16:19], s25 offen
    s_add_u32 s25, s24, 1802240
    buffer_load_dwordx4 v[20:23], v203, s[16:19], s25 offen
    s_add_u32 s25, s24, 2162688
    buffer_load_dwordx4 v[24:27], v203, s[16:19], s25 offen
    s_add_u32 s25, s24, 2523136
    buffer_load_dwordx4 v[28:31], v203, s[16:19], s25 offen
    s_add_u32 s25, s24, 11534336
    buffer_load_dwordx4 v[32:35], v203, s[16:19], s25 offen
    s_add_u32 s25, s24, 11894784
    buffer_load_dwordx4 v[36:39], v203, s[16:19], s25 offen
    s_add_u32 s25, s24, 12255232
    buffer_load_dwordx4 v[40:43], v203, s[16:19], s25 offen
    s_add_u32 s25, s24, 12615680
    buffer_load_dwordx4 v[44:47], v203, s[16:19], s25 offen
    s_add_u32 s25, s24, 12976128
    buffer_load_dwordx4 v[48:51], v203, s[16:19], s25 offen
    s_add_u32 s25, s24, 13336576
    buffer_load_dwordx4 v[52:55], v203, s[16:19], s25 offen
    s_add_u32 s25, s24, 13697024
    buffer_load_dwordx4 v[56:59], v203, s[16:19], s25 offen
    s_add_u32 s25, s24, 14057472
    buffer_load_dwordx4 v[60:63], v203, s[16:19], s25 offen
    s_cmp_ge_u32 s10, 3
    s_cbranch_scc1 L_k5_notab
    s_lshl_b32 s25, s10, 4
    v_add_u32 v204, s25, v201
    v_lshlrev_b32 v205, 3, v202
    v_add_u32 v205, 1, v205
    v_mul_u32_u24 v88, v205, v204
    v_add_u32 v89, 32, v88
    v_add_u32 v205, 2, v205
    v_mul_u32_u24 v90, v205, v204
    v_add_u32 v91, 32, v90
    v_add_u32 v205, 2, v205
    v_mul_u32_u24 v92, v205, v204
    v_add_u32 v93, 32, v92
    v_add_u32 v205, 2, v205
    v_mul_u32_u24 v94, v205, v204
    v_add_u32 v95, 32, v94
    v_and_b32 v88, 127, v88
    v_cvt_f32_u32 v88, v88
    v_mul_f32 v88, 0x3c000000, v88
    v_cos_f32 v88, v88
    v_and_b32 v89, 127, v89
    v_cvt_f32_u32 v89, v89
    v_mul_f32 v89, 0x3c000000, v89
    v_cos_f32 v89, v89
    v_and_b32 v90, 127, v90
    v_cvt_f32_u32 v90, v90
    v_mul_f32 v90, 0x3c000000, v90
    v_cos_f32 v90, v90
    v_and_b32 v91, 127, v91
    v_cvt_f32_u32 v91, v91
    v_mul_f32 v91, 0x3c000000, v91
    v_cos_f32 v91, v91
    v_and_b32 v92, 127, v92
    v_cvt_f32_u32 v92, v92
    v_mul_f32 v92, 0x3c000000, v92
    v_cos_f32 v92, v92
    v_and_b32 v93, 127, v93
    v_cvt_f32_u32 v93, v93
    v_mul_f32 v93, 0x3c000000, v93
    v_cos_f32 v93, v93
    v_and_b32 v94, 127, v94
    v_cvt_f32_u32 v94, v94
    v_mul_f32 v94, 0x3c000000, v94
    v_cos_f32 v94, v94
    v_and_b32 v95, 127, v95
    v_cvt_f32_u32 v95, v95
    v_mul_f32 v95, 0x3c000000, v95
    v_cos_f32 v95, v95
    v_mul_f32 v88, 0x3d000000, v88
    v_mul_f32 v89, 0x3d000000, v89
    v_mul_f32 v90, 0x3d000000, v90
    v_mul_f32 v91, 0x3d000000, v91
    v_mul_f32 v92, 0x3d000000, v92
    v_mul_f32 v93, 0x3d000000, v93
    v_mul_f32 v94, 0x3d000000, v94
    v_mul_f32 v95, 0x3d000000, v95
    v_cvt_pk_bf16_f32 v104, v88, v89
    v_cvt_pk_bf16_f32 v105, v90, v91
    v_cvt_pk_bf16_f32 v106, v92, v93
    v_cvt_pk_bf16_f32 v107, v94, v95
    s_lshl_b32 s25, s10, 11
    v_lshlrev_b32 v207, 4, v200
    v_add_u32 v207, s25, v207
    ds_write_b128 v207, v[104:107] offset:0
    v_lshlrev_b32 v205, 3, v202
    v_add_u32 v205, 33, v205
    v_mul_u32_u24 v88, v205, v204
    v_add_u32 v89, 32, v88
    v_add_u32 v205, 2, v205
    v_mul_u32_u24 v90, v205, v204
    v_add_u32 v91, 32, v90
    v_add_u32 v205, 2, v205
    v_mul_u32_u24 v92, v205, v204
    v_add_u32 v93, 32, v92
    v_add_u32 v205, 2, v205
    v_mul_u32_u24 v94, v205, v204
    v_add_u32 v95, 32, v94
    v_and_b32 v88, 127, v88
    v_cvt_f32_u32 v88, v88
    v_mul_f32 v88, 0x3c000000, v88
    v_cos_f32 v88, v88
    v_and_b32 v89, 127, v89
    v_cvt_f32_u32 v89, v89
    v_mul_f32 v89, 0x3c000000, v89
    v_cos_f32 v89, v89
    v_and_b32 v90, 127, v90
    v_cvt_f32_u32 v90, v90
    v_mul_f32 v90, 0x3c000000, v90
    v_cos_f32 v90, v90
    v_and_b32 v91, 127, v91
    v_cvt_f32_u32 v91, v91
    v_mul_f32 v91, 0x3c000000, v91
    v_cos_f32 v91, v91
    v_and_b32 v92, 127, v92
    v_cvt_f32_u32 v92, v92
    v_mul_f32 v92, 0x3c000000, v92
    v_cos_f32 v92, v92
    v_and_b32 v93, 127, v93
    v_cvt_f32_u32 v93, v93
    v_mul_f32 v93, 0x3c000000, v93
    v_cos_f32 v93, v93
    v_and_b32 v94, 127, v94
    v_cvt_f32_u32 v94, v94
    v_mul_f32 v94, 0x3c000000, v94
    v_cos_f32 v94, v94
    v_and_b32 v95, 127, v95
    v_cvt_f32_u32 v95, v95
    v_mul_f32 v95, 0x3c000000, v95
    v_cos_f32 v95, v95
    v_mul_f32 v88, 0x3d000000, v88
    v_mul_f32 v89, 0x3d000000, v89
    v_mul_f32 v90, 0x3d000000, v90
    v_mul_f32 v91, 0x3d000000, v91
    v_mul_f32 v92, 0x3d000000, v92
    v_mul_f32 v93, 0x3d000000, v93
    v_mul_f32 v94, 0x3d000000, v94
    v_mul_f32 v95, 0x3d000000, v95
    v_cvt_pk_bf16_f32 v104, v88, v89
    v_cvt_pk_bf16_f32 v105, v90, v91
    v_cvt_pk_bf16_f32 v106, v92, v93
    v_cvt_pk_bf16_f32 v107, v94, v95
    s_lshl_b32 s25, s10, 11
    v_lshlrev_b32 v207, 4, v200
    v_add_u32 v207, s25, v207
    ds_write_b128 v207, v[104:107] offset:1024
L_k5_notab:
    s_mul_i32 s24, s11, 168
    s_mul_i32 s25, s13, 42
    s_add_u32 s24, s24, s25
    s_lshl_b32 s24, s24, 10
    s_add_u32 s24, s24, 146800640
    buffer_load_dword v112, v214, s[16:19], s24 offen offset:0
    buffer_load_dword v113, v214, s[16:19], s24 offen offset:1024
    buffer_load_dword v114, v214, s[16:19], s24 offen offset:2048
    buffer_load_dword v115, v214, s[16:19], s24 offen offset:3072
    s_add_u32 s24, s24, 4096
    buffer_load_dword v116, v214, s[16:19], s24 offen offset:0
    buffer_load_dword v117, v214, s[16:19], s24 offen offset:1024
    buffer_load_dword v118, v214, s[16:19], s24 offen offset:2048
    buffer_load_dword v119, v214, s[16:19], s24 offen offset:3072
    s_add_u32 s24, s24, 4096
    buffer_load_dword v120, v214, s[16:19], s24 offen offset:0
    buffer_load_dword v121, v214, s[16:19], s24 offen offset:1024
    buffer_load_dword v122, v214, s[16:19], s24 offen offset:2048
    buffer_load_dword v123, v214, s[16:19], s24 offen offset:3072
    s_add_u32 s24, s24, 4096
    buffer_load_dword v124, v214, s[16:19], s24 offen offset:0
    buffer_load_dword v125, v214, s[16:19], s24 offen offset:1024
    buffer_load_dword v126, v214, s[16:19], s24 offen offset:2048
    buffer_load_dword v127, v214, s[16:19], s24 offen offset:3072
    s_add_u32 s24, s24, 4096
    buffer_load_dword v128, v214, s[16:19], s24 offen offset:0
    buffer_load_dword v129, v214, s[16:19], s24 offen offset:1024
    buffer_load_dword v130, v214, s[16:19], s24 offen offset:2048
    buffer_load_dword v131, v214, s[16:19], s24 offen offset:3072
    s_add_u32 s24, s24, 4096
    buffer_load_dword v132, v214, s[16:19], s24 offen offset:0
    buffer_load_dword v133, v214, s[16:19], s24 offen offset:1024
    buffer_load_dword v134, v214, s[16:19], s24 offen offset:2048
    buffer_load_dword v135, v214, s[16:19], s24 offen offset:3072
    s_add_u32 s24, s24, 4096
    buffer_load_dword v136, v214, s[16:19], s24 offen offset:0
    buffer_load_dword v137, v214, s[16:19], s24 offen offset:1024
    buffer_load_dword v138, v214, s[16:19], s24 offen offset:2048
    buffer_load_dword v139, v214, s[16:19], s24 offen offset:3072
    s_add_u32 s24, s24, 4096
    buffer_load_dword v140, v214, s[16:19], s24 offen offset:0
    buffer_load_dword v141, v214, s[16:19], s24 offen offset:1024
    buffer_load_dword v142, v214, s[16:19], s24 offen offset:2048
    buffer_load_dword v143, v214, s[16:19], s24 offen offset:3072
    s_add_u32 s24, s24, 4096
    buffer_load_dword v144, v214, s[16:19], s24 offen offset:0
    buffer_load_dword v145, v214, s[16:19], s24 offen offset:1024
    buffer_load_dword v146, v214, s[16:19], s24 offen offset:2048
    buffer_load_dword v147, v214, s[16:19], s24 offen offset:3072
    s_add_u32 s24, s24, 4096
    buffer_load_dword v148, v214, s[16:19], s24 offen offset:0
    buffer_load_dword v149, v214, s[16:19], s24 offen offset:1024
    buffer_load_dword v150, v214, s[16:19], s24 offen offset:2048
    buffer_load_dword v151, v214, s[16:19], s24 offen offset:3072
    s_add_u32 s24, s24, 4096
    buffer_load_dword v152, v214, s[16:19], s24 offen offset:0
    buffer_load_dword v153, v214, s[16:19], s24 offen offset:1024
    s_mov_b32 s20, s4
    s_and_b32 s21, s5, 0xffff
    s_mov_b32 s22, 1024
    s_mov_b32 s23, 0x00020000
    s_mov_b32 s36, s6
    s_and_b32 s37, s7, 0xffff
    s_mov_b32 s38, 1024
    s_mov_b32 s39, 0x00020000
    v_lshlrev_b32 v210, 4, v201
    s_lshl_b32 s25, s13, 8
    buffer_load_dwordx4 v[160:163], v210, s[20:23], s25 offen
    buffer_load_dwordx4 v[164:167], v210, s[36:39], s25 offen
    s_waitcnt vmcnt(2)
    v_add_f32 v112, v112, v113
    v_add_f32 v114, v114, v115
    v_add_f32 v116, v116, v117
    v_add_f32 v118, v118, v119
    v_add_f32 v120, v120, v121
    v_add_f32 v122, v122, v123
    v_add_f32 v124, v124, v125
    v_add_f32 v126, v126, v127
    v_add_f32 v128, v128, v129
    v_add_f32 v130, v130, v131
    v_add_f32 v132, v132, v133
    v_add_f32 v134, v134, v135
    v_add_f32 v136, v136, v137
    v_add_f32 v138, v138, v139
    v_add_f32 v140, v140, v141
    v_add_f32 v142, v142, v143
    v_add_f32 v144, v144, v145
    v_add_f32 v146, v146, v147
    v_add_f32 v148, v148, v149
    v_add_f32 v150, v150, v151
    v_add_f32 v152, v152, v153
    v_add_f32 v112, v112, v114
    v_add_f32 v116, v116, v118
    v_add_f32 v120, v120, v122
    v_add_f32 v124, v124, v126
    v_add_f32 v128, v128, v130
    v_add_f32 v132, v132, v134
    v_add_f32 v136, v136, v138
    v_add_f32 v140, v140, v142
    v_add_f32 v144, v144, v146
    v_add_f32 v148, v148, v150
    v_add_f32 v112, v112, v116
    v_add_f32 v120, v120, v124
    v_add_f32 v128, v128, v132
    v_add_f32 v136, v136, v140
    v_add_f32 v144, v144, v148
    v_add_f32 v112, v112, v120
    v_add_f32 v128, v128, v136
    v_add_f32 v144, v144, v152
    v_add_f32 v112, v112, v128
    v_add_f32 v112, v112, v144
    ds_write_b32 v214, v112 offset:8192
    s_waitcnt lgkmcnt(0)
    s_barrier
    v_lshlrev_b32 v207, 4, v200
    ds_read_b128 v[64:67], v207 offset:0
    ds_read_b128 v[68:71], v207 offset:1024
    ds_read_b128 v[72:75], v207 offset:2048
    ds_read_b128 v[76:79], v207 offset:3072
    ds_read_b128 v[80:83], v207 offset:4096
    ds_read_b128 v[84:87], v207 offset:5120
    v_lshlrev_b32 v210, 5, v201
    ds_read_b128 v[168:171], v210 offset:8192
    ds_read_b128 v[172:175], v210 offset:8208
    ds_read_b128 v[176:179], v210 offset:8704
    ds_read_b128 v[180:183], v210 offset:8720
    s_cmp_ge_u32 s14, 167
    s_cbranch_scc1 L_k5_end
    s_waitcnt vmcnt(0) lgkmcnt(0)
    s_mov_b32 s24, 0x39035177
    s_mov_b32 s25, 0x3727c5ac
    v_mul_f32 v168, s24, v168
    v_mul_f32 v176, s24, v176
    v_fma_f32 v176, -v168, v168, v176
    v_max_f32 v176, 0, v176
    v_add_f32 v176, s25, v176
    v_rsq_f32 v176, v176
    v_lshlrev_b32 v216, 16, v160
    v_lshlrev_b32 v224, 16, v164
    v_mul_f32 v216, v216, v176
    v_fma_f32 v224, -v168, v216, v224
    v_mul_f32 v169, s24, v169
    v_mul_f32 v177, s24, v177
    v_fma_f32 v177, -v169, v169, v177
    v_max_f32 v177, 0, v177
    v_add_f32 v177, s25, v177
    v_rsq_f32 v177, v177
    v_and_b32 v217, 0xffff0000, v160
    v_and_b32 v225, 0xffff0000, v164
    v_mul_f32 v217, v217, v177
    v_fma_f32 v225, -v169, v217, v225
    v_mul_f32 v170, s24, v170
    v_mul_f32 v178, s24, v178
    v_fma_f32 v178, -v170, v170, v178
    v_max_f32 v178, 0, v178
    v_add_f32 v178, s25, v178
    v_rsq_f32 v178, v178
    v_lshlrev_b32 v218, 16, v161
    v_lshlrev_b32 v226, 16, v165
    v_mul_f32 v218, v218, v178
    v_fma_f32 v226, -v170, v218, v226
    v_mul_f32 v171, s24, v171
    v_mul_f32 v179, s24, v179
    v_fma_f32 v179, -v171, v171, v179
    v_max_f32 v179, 0, v179
    v_add_f32 v179, s25, v179
    v_rsq_f32 v179, v179
    v_and_b32 v219, 0xffff0000, v161
    v_and_b32 v227, 0xffff0000, v165
    v_mul_f32 v219, v219, v179
    v_fma_f32 v227, -v171, v219, v227
    v_mul_f32 v172, s24, v172
    v_mul_f32 v180, s24, v180
    v_fma_f32 v180, -v172, v172, v180
    v_max_f32 v180, 0, v180
    v_add_f32 v180, s25, v180
    v_rsq_f32 v180, v180
    v_lshlrev_b32 v220, 16, v162
    v_lshlrev_b32 v228, 16, v166
    v_mul_f32 v220, v220, v180
    v_fma_f32 v228, -v172, v220, v228
    v_mul_f32 v173, s24, v173
    v_mul_f32 v181, s24, v181
    v_fma_f32 v181, -v173, v173, v181
    v_max_f32 v181, 0, v181
    v_add_f32 v181, s25, v181
    v_rsq_f32 v181, v181
    v_and_b32 v221, 0xffff0000, v162
    v_and_b32 v229, 0xffff0000, v166
    v_mul_f32 v221, v221, v181
    v_fma_f32 v229, -v173, v221, v229
    v_mul_f32 v174, s24, v174
    v_mul_f32 v182, s24, v182
    v_fma_f32 v182, -v174, v174, v182
    v_max_f32 v182, 0, v182
    v_add_f32 v182, s25, v182
    v_rsq_f32 v182, v182
    v_lshlrev_b32 v222, 16, v163
    v_lshlrev_b32 v230, 16, v167
    v_mul_f32 v222, v222, v182
    v_fma_f32 v230, -v174, v222, v230
    v_mul_f32 v175, s24, v175
    v_mul_f32 v183, s24, v183
    v_fma_f32 v183, -v175, v175, v183
    v_max_f32 v183, 0, v183
    v_add_f32 v183, s25, v183
    v_rsq_f32 v183, v183
    v_and_b32 v223, 0xffff0000, v163
    v_and_b32 v231, 0xffff0000, v167
    v_mul_f32 v223, v223, v183
    v_fma_f32 v231, -v175, v223, v231
    v_perm_b32 v88, v4, v0, s30
    v_perm_b32 v89, v12, v8, s30
    v_perm_b32 v90, v20, v16, s30
    v_perm_b32 v91, v28, v24, s30
    v_perm_b32 v92, v4, v0, s31
    v_perm_b32 v93, v12, v8, s31
    v_perm_b32 v94, v20, v16, s31
    v_perm_b32 v95, v28, v24, s31
    v_perm_b32 v96, v36, v32, s30
    v_perm_b32 v97, v44, v40, s30
    v_perm_b32 v98, v52, v48, s30
    v_perm_b32 v99, v60, v56, s30
    v_perm_b32 v100, v36, v32, s31
    v_perm_b32 v101, v44, v40, s31
    v_perm_b32 v102, v52, v48, s31
    v_perm_b32 v103, v60, v56, s31
    v_mfma_f32_16x16x32_bf16 v[104:107], v[64:67], v[88:91], 0
    v_mfma_f32_16x16x32_bf16 v[108:111], v[64:67], v[92:95], 0
    v_mfma_f32_16x16x32_bf16 v[136:139], v[72:75], v[88:91], 0
    v_mfma_f32_16x16x32_bf16 v[140:143], v[72:75], v[92:95], 0
    v_mfma_f32_16x16x32_bf16 v[168:171], v[80:83], v[88:91], 0
    v_mfma_f32_16x16x32_bf16 v[172:175], v[80:83], v[92:95], 0
    v_mfma_f32_16x16x32_bf16 v[104:107], v[68:71], v[96:99], v[104:107]
    v_mfma_f32_16x16x32_bf16 v[108:111], v[68:71], v[100:103], v[108:111]
    v_mfma_f32_16x16x32_bf16 v[136:139], v[76:79], v[96:99], v[136:139]
    v_mfma_f32_16x16x32_bf16 v[140:143], v[76:79], v[100:103], v[140:143]
    v_mfma_f32_16x16x32_bf16 v[168:171], v[84:87], v[96:99], v[168:171]
    v_mfma_f32_16x16x32_bf16 v[172:175], v[84:87], v[100:103], v[172:175]
    v_perm_b32 v88, v5, v1, s30
    v_perm_b32 v89, v13, v9, s30
    v_perm_b32 v90, v21, v17, s30
    v_perm_b32 v91, v29, v25, s30
    v_perm_b32 v92, v5, v1, s31
    v_perm_b32 v93, v13, v9, s31
    v_perm_b32 v94, v21, v17, s31
    v_perm_b32 v95, v29, v25, s31
    v_perm_b32 v96, v37, v33, s30
    v_perm_b32 v97, v45, v41, s30
    v_perm_b32 v98, v53, v49, s30
    v_perm_b32 v99, v61, v57, s30
    v_perm_b32 v100, v37, v33, s31
    v_perm_b32 v101, v45, v41, s31
    v_perm_b32 v102, v53, v49, s31
    v_perm_b32 v103, v61, v57, s31
    v_mfma_f32_16x16x32_bf16 v[112:115], v[64:67], v[88:91], 0
    v_mfma_f32_16x16x32_bf16 v[116:119], v[64:67], v[92:95], 0
    v_mfma_f32_16x16x32_bf16 v[144:147], v[72:75], v[88:91], 0
    v_mfma_f32_16x16x32_bf16 v[148:151], v[72:75], v[92:95], 0
    v_mfma_f32_16x16x32_bf16 v[176:179], v[80:83], v[88:91], 0
    v_mfma_f32_16x16x32_bf16 v[180:183], v[80:83], v[92:95], 0
    v_mfma_f32_16x16x32_bf16 v[112:115], v[68:71], v[96:99], v[112:115]
    v_mfma_f32_16x16x32_bf16 v[116:119], v[68:71], v[100:103], v[116:119]
    v_mfma_f32_16x16x32_bf16 v[144:147], v[76:79], v[96:99], v[144:147]
    v_mfma_f32_16x16x32_bf16 v[148:151], v[76:79], v[100:103], v[148:151]
    v_mfma_f32_16x16x32_bf16 v[176:179], v[84:87], v[96:99], v[176:179]
    v_mfma_f32_16x16x32_bf16 v[180:183], v[84:87], v[100:103], v[180:183]
    v_perm_b32 v88, v6, v2, s30
    v_perm_b32 v89, v14, v10, s30
    v_perm_b32 v90, v22, v18, s30
    v_perm_b32 v91, v30, v26, s30
    v_perm_b32 v92, v6, v2, s31
    v_perm_b32 v93, v14, v10, s31
    v_perm_b32 v94, v22, v18, s31
    v_perm_b32 v95, v30, v26, s31
    v_perm_b32 v96, v38, v34, s30
    v_perm_b32 v97, v46, v42, s30
    v_perm_b32 v98, v54, v50, s30
    v_perm_b32 v99, v62, v58, s30
    v_perm_b32 v100, v38, v34, s31
    v_perm_b32 v101, v46, v42, s31
    v_perm_b32 v102, v54, v50, s31
    v_perm_b32 v103, v62, v58, s31
    v_mfma_f32_16x16x32_bf16 v[120:123], v[64:67], v[88:91], 0
    v_mfma_f32_16x16x32_bf16 v[124:127], v[64:67], v[92:95], 0
    v_mfma_f32_16x16x32_bf16 v[152:155], v[72:75], v[88:91], 0
    v_mfma_f32_16x16x32_bf16 v[156:159], v[72:75], v[92:95], 0
    v_mfma_f32_16x16x32_bf16 v[184:187], v[80:83], v[88:91], 0
    v_mfma_f32_16x16x32_bf16 v[188:191], v[80:83], v[92:95], 0
    v_mfma_f32_16x16x32_bf16 v[120:123], v[68:71], v[96:99], v[120:123]
    v_mfma_f32_16x16x32_bf16 v[124:127], v[68:71], v[100:103], v[124:127]
    v_mfma_f32_16x16x32_bf16 v[152:155], v[76:79], v[96:99], v[152:155]
    v_mfma_f32_16x16x32_bf16 v[156:159], v[76:79], v[100:103], v[156:159]
    v_mfma_f32_16x16x32_bf16 v[184:187], v[84:87], v[96:99], v[184:187]
    v_mfma_f32_16x16x32_bf16 v[188:191], v[84:87], v[100:103], v[188:191]
    v_perm_b32 v88, v7, v3, s30
    v_perm_b32 v89, v15, v11, s30
    v_perm_b32 v90, v23, v19, s30
    v_perm_b32 v91, v31, v27, s30
    v_perm_b32 v92, v7, v3, s31
    v_perm_b32 v93, v15, v11, s31
    v_perm_b32 v94, v23, v19, s31
    v_perm_b32 v95, v31, v27, s31
    v_perm_b32 v96, v39, v35, s30
    v_perm_b32 v97, v47, v43, s30
    v_perm_b32 v98, v55, v51, s30
    v_perm_b32 v99, v63, v59, s30
    v_perm_b32 v100, v39, v35, s31
    v_perm_b32 v101, v47, v43, s31
    v_perm_b32 v102, v55, v51, s31
    v_perm_b32 v103, v63, v59, s31
    v_mfma_f32_16x16x32_bf16 v[128:131], v[64:67], v[88:91], 0
    v_mfma_f32_16x16x32_bf16 v[132:135], v[64:67], v[92:95], 0
    v_mfma_f32_16x16x32_bf16 v[160:163], v[72:75], v[88:91], 0
    v_mfma_f32_16x16x32_bf16 v[164:167], v[72:75], v[92:95], 0
    v_mfma_f32_16x16x32_bf16 v[192:195], v[80:83], v[88:91], 0
    v_mfma_f32_16x16x32_bf16 v[196:199], v[80:83], v[92:95], 0
    v_mfma_f32_16x16x32_bf16 v[128:131], v[68:71], v[96:99], v[128:131]
    v_mfma_f32_16x16x32_bf16 v[132:135], v[68:71], v[100:103], v[132:135]
    v_mfma_f32_16x16x32_bf16 v[160:163], v[76:79], v[96:99], v[160:163]
    v_mfma_f32_16x16x32_bf16 v[164:167], v[76:79], v[100:103], v[164:167]
    v_mfma_f32_16x16x32_bf16 v[192:195], v[84:87], v[96:99], v[192:195]
    v_mfma_f32_16x16x32_bf16 v[196:199], v[84:87], v[100:103], v[196:199]
    s_nop 7
    s_mul_i32 s24, s11, 8176640
    s_add_u32 s28, s28, s24
    s_addc_u32 s29, s29, 0
    s_mov_b32 s32, s28
    s_and_b32 s33, s29, 0xffff
    s_mov_b32 s34, 8176640
    s_mov_b32 s35, 0x00020000
    s_mul_i32 s24, s14, 49152
    s_lshl_b32 s25, s13, 8
    s_add_u32 s24, s24, s25
    v_lshlrev_b32 v210, 12, v202
    v_lshl_add_u32 v210, v201, 4, v210
    v_add_u32 v210, s24, v210
    s_mov_b32 s26, 0xbdd2d3e8
    v_mov_b32 v211, 0xc0135761
    v_fma_f32 v104, v104, v216, v224
    v_fma_f32 v108, v108, v217, v225
    v_fma_f32 v112, v112, v218, v226
    v_fma_f32 v116, v116, v219, v227
    v_fma_f32 v120, v120, v220, v228
    v_fma_f32 v124, v124, v221, v229
    v_fma_f32 v128, v128, v222, v230
    v_fma_f32 v132, v132, v223, v231
    v_mul_f32 v0, v104, v104
    v_mul_f32 v1, v108, v108
    v_mul_f32 v2, v112, v112
    v_mul_f32 v3, v116, v116
    v_mul_f32 v4, v120, v120
    v_mul_f32 v5, v124, v124
    v_mul_f32 v6, v128, v128
    v_mul_f32 v7, v132, v132
    v_fma_f32 v0, v0, s26, v211
    v_fma_f32 v1, v1, s26, v211
    v_fma_f32 v2, v2, s26, v211
    v_fma_f32 v3, v3, s26, v211
    v_fma_f32 v4, v4, s26, v211
    v_fma_f32 v5, v5, s26, v211
    v_fma_f32 v6, v6, s26, v211
    v_fma_f32 v7, v7, s26, v211
    v_mul_f32 v0, v0, v104
    v_mul_f32 v1, v1, v108
    v_mul_f32 v2, v2, v112
    v_mul_f32 v3, v3, v116
    v_mul_f32 v4, v4, v120
    v_mul_f32 v5, v5, v124
    v_mul_f32 v6, v6, v128
    v_mul_f32 v7, v7, v132
    v_exp_f32 v0, v0
    v_exp_f32 v1, v1
    v_exp_f32 v2, v2
    v_exp_f32 v3, v3
    v_exp_f32 v4, v4
    v_exp_f32 v5, v5
    v_exp_f32 v6, v6
    v_exp_f32 v7, v7
    v_add_f32 v0, 1.0, v0
    v_add_f32 v1, 1.0, v1
    v_add_f32 v2, 1.0, v2
    v_add_f32 v3, 1.0, v3
    v_add_f32 v4, 1.0, v4
    v_add_f32 v5, 1.0, v5
    v_add_f32 v6, 1.0, v6
    v_add_f32 v7, 1.0, v7
    v_rcp_f32 v0, v0
    v_rcp_f32 v1, v1
    v_rcp_f32 v2, v2
    v_rcp_f32 v3, v3
    v_rcp_f32 v4, v4
    v_rcp_f32 v5, v5
    v_rcp_f32 v6, v6
    v_rcp_f32 v7, v7
    v_mul_f32 v0, v0, v104
    v_mul_f32 v1, v1, v108
    v_mul_f32 v2, v2, v112
    v_mul_f32 v3, v3, v116
    v_mul_f32 v4, v4, v120
    v_mul_f32 v5, v5, v124
    v_mul_f32 v6, v6, v128
    v_mul_f32 v7, v7, v132
    v_cvt_pk_bf16_f32 v16, v0, v1
    v_cvt_pk_bf16_f32 v17, v2, v3
    v_cvt_pk_bf16_f32 v18, v4, v5
    v_cvt_pk_bf16_f32 v19, v6, v7
    v_add_u32 v212, 0, v210
    buffer_store_dwordx4 v[16:19], v212, s[32:35], 0 offen
    v_fma_f32 v105, v105, v216, v224
    v_fma_f32 v109, v109, v217, v225
    v_fma_f32 v113, v113, v218, v226
    v_fma_f32 v117, v117, v219, v227
    v_fma_f32 v121, v121, v220, v228
    v_fma_f32 v125, v125, v221, v229
    v_fma_f32 v129, v129, v222, v230
    v_fma_f32 v133, v133, v223, v231
    v_mul_f32 v0, v105, v105
    v_mul_f32 v1, v109, v109
    v_mul_f32 v2, v113, v113
    v_mul_f32 v3, v117, v117
    v_mul_f32 v4, v121, v121
    v_mul_f32 v5, v125, v125
    v_mul_f32 v6, v129, v129
    v_mul_f32 v7, v133, v133
    v_fma_f32 v0, v0, s26, v211
    v_fma_f32 v1, v1, s26, v211
    v_fma_f32 v2, v2, s26, v211
    v_fma_f32 v3, v3, s26, v211
    v_fma_f32 v4, v4, s26, v211
    v_fma_f32 v5, v5, s26, v211
    v_fma_f32 v6, v6, s26, v211
    v_fma_f32 v7, v7, s26, v211
    v_mul_f32 v0, v0, v105
    v_mul_f32 v1, v1, v109
    v_mul_f32 v2, v2, v113
    v_mul_f32 v3, v3, v117
    v_mul_f32 v4, v4, v121
    v_mul_f32 v5, v5, v125
    v_mul_f32 v6, v6, v129
    v_mul_f32 v7, v7, v133
    v_exp_f32 v0, v0
    v_exp_f32 v1, v1
    v_exp_f32 v2, v2
    v_exp_f32 v3, v3
    v_exp_f32 v4, v4
    v_exp_f32 v5, v5
    v_exp_f32 v6, v6
    v_exp_f32 v7, v7
    v_add_f32 v0, 1.0, v0
    v_add_f32 v1, 1.0, v1
    v_add_f32 v2, 1.0, v2
    v_add_f32 v3, 1.0, v3
    v_add_f32 v4, 1.0, v4
    v_add_f32 v5, 1.0, v5
    v_add_f32 v6, 1.0, v6
    v_add_f32 v7, 1.0, v7
    v_rcp_f32 v0, v0
    v_rcp_f32 v1, v1
    v_rcp_f32 v2, v2
    v_rcp_f32 v3, v3
    v_rcp_f32 v4, v4
    v_rcp_f32 v5, v5
    v_rcp_f32 v6, v6
    v_rcp_f32 v7, v7
    v_mul_f32 v0, v0, v105
    v_mul_f32 v1, v1, v109
    v_mul_f32 v2, v2, v113
    v_mul_f32 v3, v3, v117
    v_mul_f32 v4, v4, v121
    v_mul_f32 v5, v5, v125
    v_mul_f32 v6, v6, v129
    v_mul_f32 v7, v7, v133
    v_cvt_pk_bf16_f32 v20, v0, v1
    v_cvt_pk_bf16_f32 v21, v2, v3
    v_cvt_pk_bf16_f32 v22, v4, v5
    v_cvt_pk_bf16_f32 v23, v6, v7
    v_add_u32 v212, 1024, v210
    buffer_store_dwordx4 v[20:23], v212, s[32:35], 0 offen
    v_fma_f32 v106, v106, v216, v224
    v_fma_f32 v110, v110, v217, v225
    v_fma_f32 v114, v114, v218, v226
    v_fma_f32 v118, v118, v219, v227
    v_fma_f32 v122, v122, v220, v228
    v_fma_f32 v126, v126, v221, v229
    v_fma_f32 v130, v130, v222, v230
    v_fma_f32 v134, v134, v223, v231
    v_mul_f32 v0, v106, v106
    v_mul_f32 v1, v110, v110
    v_mul_f32 v2, v114, v114
    v_mul_f32 v3, v118, v118
    v_mul_f32 v4, v122, v122
    v_mul_f32 v5, v126, v126
    v_mul_f32 v6, v130, v130
    v_mul_f32 v7, v134, v134
    v_fma_f32 v0, v0, s26, v211
    v_fma_f32 v1, v1, s26, v211
    v_fma_f32 v2, v2, s26, v211
    v_fma_f32 v3, v3, s26, v211
    v_fma_f32 v4, v4, s26, v211
    v_fma_f32 v5, v5, s26, v211
    v_fma_f32 v6, v6, s26, v211
    v_fma_f32 v7, v7, s26, v211
    v_mul_f32 v0, v0, v106
    v_mul_f32 v1, v1, v110
    v_mul_f32 v2, v2, v114
    v_mul_f32 v3, v3, v118
    v_mul_f32 v4, v4, v122
    v_mul_f32 v5, v5, v126
    v_mul_f32 v6, v6, v130
    v_mul_f32 v7, v7, v134
    v_exp_f32 v0, v0
    v_exp_f32 v1, v1
    v_exp_f32 v2, v2
    v_exp_f32 v3, v3
    v_exp_f32 v4, v4
    v_exp_f32 v5, v5
    v_exp_f32 v6, v6
    v_exp_f32 v7, v7
    v_add_f32 v0, 1.0, v0
    v_add_f32 v1, 1.0, v1
    v_add_f32 v2, 1.0, v2
    v_add_f32 v3, 1.0, v3
    v_add_f32 v4, 1.0, v4
    v_add_f32 v5, 1.0, v5
    v_add_f32 v6, 1.0, v6
    v_add_f32 v7, 1.0, v7
    v_rcp_f32 v0, v0
    v_rcp_f32 v1, v1
    v_rcp_f32 v2, v2
    v_rcp_f32 v3, v3
    v_rcp_f32 v4, v4
    v_rcp_f32 v5, v5
    v_rcp_f32 v6, v6
    v_rcp_f32 v7, v7
    v_mul_f32 v0, v0, v106
    v_mul_f32 v1, v1, v110
    v_mul_f32 v2, v2, v114
    v_mul_f32 v3, v3, v118
    v_mul_f32 v4, v4, v122
    v_mul_f32 v5, v5, v126
    v_mul_f32 v6, v6, v130
    v_mul_f32 v7, v7, v134
    v_cvt_pk_bf16_f32 v24, v0, v1
    v_cvt_pk_bf16_f32 v25, v2, v3
    v_cvt_pk_bf16_f32 v26, v4, v5
    v_cvt_pk_bf16_f32 v27, v6, v7
    v_add_u32 v212, 2048, v210
    buffer_store_dwordx4 v[24:27], v212, s[32:35], 0 offen
    v_fma_f32 v107, v107, v216, v224
    v_fma_f32 v111, v111, v217, v225
    v_fma_f32 v115, v115, v218, v226
    v_fma_f32 v119, v119, v219, v227
    v_fma_f32 v123, v123, v220, v228
    v_fma_f32 v127, v127, v221, v229
    v_fma_f32 v131, v131, v222, v230
    v_fma_f32 v135, v135, v223, v231
    v_mul_f32 v0, v107, v107
    v_mul_f32 v1, v111, v111
    v_mul_f32 v2, v115, v115
    v_mul_f32 v3, v119, v119
    v_mul_f32 v4, v123, v123
    v_mul_f32 v5, v127, v127
    v_mul_f32 v6, v131, v131
    v_mul_f32 v7, v135, v135
    v_fma_f32 v0, v0, s26, v211
    v_fma_f32 v1, v1, s26, v211
    v_fma_f32 v2, v2, s26, v211
    v_fma_f32 v3, v3, s26, v211
    v_fma_f32 v4, v4, s26, v211
    v_fma_f32 v5, v5, s26, v211
    v_fma_f32 v6, v6, s26, v211
    v_fma_f32 v7, v7, s26, v211
    v_mul_f32 v0, v0, v107
    v_mul_f32 v1, v1, v111
    v_mul_f32 v2, v2, v115
    v_mul_f32 v3, v3, v119
    v_mul_f32 v4, v4, v123
    v_mul_f32 v5, v5, v127
    v_mul_f32 v6, v6, v131
    v_mul_f32 v7, v7, v135
    v_exp_f32 v0, v0
    v_exp_f32 v1, v1
    v_exp_f32 v2, v2
    v_exp_f32 v3, v3
    v_exp_f32 v4, v4
    v_exp_f32 v5, v5
    v_exp_f32 v6, v6
    v_exp_f32 v7, v7
    v_add_f32 v0, 1.0, v0
    v_add_f32 v1, 1.0, v1
    v_add_f32 v2, 1.0, v2
    v_add_f32 v3, 1.0, v3
    v_add_f32 v4, 1.0, v4
    v_add_f32 v5, 1.0, v5
    v_add_f32 v6, 1.0, v6
    v_add_f32 v7, 1.0, v7
    v_rcp_f32 v0, v0
    v_rcp_f32 v1, v1
    v_rcp_f32 v2, v2
    v_rcp_f32 v3, v3
    v_rcp_f32 v4, v4
    v_rcp_f32 v5, v5
    v_rcp_f32 v6, v6
    v_rcp_f32 v7, v7
    v_mul_f32 v0, v0, v107
    v_mul_f32 v1, v1, v111
    v_mul_f32 v2, v2, v115
    v_mul_f32 v3, v3, v119
    v_mul_f32 v4, v4, v123
    v_mul_f32 v5, v5, v127
    v_mul_f32 v6, v6, v131
    v_mul_f32 v7, v7, v135
    v_cvt_pk_bf16_f32 v28, v0, v1
    v_cvt_pk_bf16_f32 v29, v2, v3
    v_cvt_pk_bf16_f32 v30, v4, v5
    v_cvt_pk_bf16_f32 v31, v6, v7
    v_add_u32 v212, 3072, v210
    buffer_store_dwordx4 v[28:31], v212, s[32:35], 0 offen
    v_fma_f32 v136, v136, v216, v224
    v_fma_f32 v140, v140, v217, v225
    v_fma_f32 v144, v144, v218, v226
    v_fma_f32 v148, v148, v219, v227
    v_fma_f32 v152, v152, v220, v228
    v_fma_f32 v156, v156, v221, v229
    v_fma_f32 v160, v160, v222, v230
    v_fma_f32 v164, v164, v223, v231
    v_mul_f32 v0, v136, v136
    v_mul_f32 v1, v140, v140
    v_mul_f32 v2, v144, v144
    v_mul_f32 v3, v148, v148
    v_mul_f32 v4, v152, v152
    v_mul_f32 v5, v156, v156
    v_mul_f32 v6, v160, v160
    v_mul_f32 v7, v164, v164
    v_fma_f32 v0, v0, s26, v211
    v_fma_f32 v1, v1, s26, v211
    v_fma_f32 v2, v2, s26, v211
    v_fma_f32 v3, v3, s26, v211
    v_fma_f32 v4, v4, s26, v211
    v_fma_f32 v5, v5, s26, v211
    v_fma_f32 v6, v6, s26, v211
    v_fma_f32 v7, v7, s26, v211
    v_mul_f32 v0, v0, v136
    v_mul_f32 v1, v1, v140
    v_mul_f32 v2, v2, v144
    v_mul_f32 v3, v3, v148
    v_mul_f32 v4, v4, v152
    v_mul_f32 v5, v5, v156
    v_mul_f32 v6, v6, v160
    v_mul_f32 v7, v7, v164
    v_exp_f32 v0, v0
    v_exp_f32 v1, v1
    v_exp_f32 v2, v2
    v_exp_f32 v3, v3
    v_exp_f32 v4, v4
    v_exp_f32 v5, v5
    v_exp_f32 v6, v6
    v_exp_f32 v7, v7
    v_add_f32 v0, 1.0, v0
    v_add_f32 v1, 1.0, v1
    v_add_f32 v2, 1.0, v2
    v_add_f32 v3, 1.0, v3
    v_add_f32 v4, 1.0, v4
    v_add_f32 v5, 1.0, v5
    v_add_f32 v6, 1.0, v6
    v_add_f32 v7, 1.0, v7
    v_rcp_f32 v0, v0
    v_rcp_f32 v1, v1
    v_rcp_f32 v2, v2
    v_rcp_f32 v3, v3
    v_rcp_f32 v4, v4
    v_rcp_f32 v5, v5
    v_rcp_f32 v6, v6
    v_rcp_f32 v7, v7
    v_mul_f32 v0, v0, v136
    v_mul_f32 v1, v1, v140
    v_mul_f32 v2, v2, v144
    v_mul_f32 v3, v3, v148
    v_mul_f32 v4, v4, v152
    v_mul_f32 v5, v5, v156
    v_mul_f32 v6, v6, v160
    v_mul_f32 v7, v7, v164
    v_cvt_pk_bf16_f32 v32, v0, v1
    v_cvt_pk_bf16_f32 v33, v2, v3
    v_cvt_pk_bf16_f32 v34, v4, v5
    v_cvt_pk_bf16_f32 v35, v6, v7
    v_add_u32 v212, 16384, v210
    buffer_store_dwordx4 v[32:35], v212, s[32:35], 0 offen
    v_fma_f32 v137, v137, v216, v224
    v_fma_f32 v141, v141, v217, v225
    v_fma_f32 v145, v145, v218, v226
    v_fma_f32 v149, v149, v219, v227
    v_fma_f32 v153, v153, v220, v228
    v_fma_f32 v157, v157, v221, v229
    v_fma_f32 v161, v161, v222, v230
    v_fma_f32 v165, v165, v223, v231
    v_mul_f32 v0, v137, v137
    v_mul_f32 v1, v141, v141
    v_mul_f32 v2, v145, v145
    v_mul_f32 v3, v149, v149
    v_mul_f32 v4, v153, v153
    v_mul_f32 v5, v157, v157
    v_mul_f32 v6, v161, v161
    v_mul_f32 v7, v165, v165
    v_fma_f32 v0, v0, s26, v211
    v_fma_f32 v1, v1, s26, v211
    v_fma_f32 v2, v2, s26, v211
    v_fma_f32 v3, v3, s26, v211
    v_fma_f32 v4, v4, s26, v211
    v_fma_f32 v5, v5, s26, v211
    v_fma_f32 v6, v6, s26, v211
    v_fma_f32 v7, v7, s26, v211
    v_mul_f32 v0, v0, v137
    v_mul_f32 v1, v1, v141
    v_mul_f32 v2, v2, v145
    v_mul_f32 v3, v3, v149
    v_mul_f32 v4, v4, v153
    v_mul_f32 v5, v5, v157
    v_mul_f32 v6, v6, v161
    v_mul_f32 v7, v7, v165
    v_exp_f32 v0, v0
    v_exp_f32 v1, v1
    v_exp_f32 v2, v2
    v_exp_f32 v3, v3
    v_exp_f32 v4, v4
    v_exp_f32 v5, v5
    v_exp_f32 v6, v6
    v_exp_f32 v7, v7
    v_add_f32 v0, 1.0, v0
    v_add_f32 v1, 1.0, v1
    v_add_f32 v2, 1.0, v2
    v_add_f32 v3, 1.0, v3
    v_add_f32 v4, 1.0, v4
    v_add_f32 v5, 1.0, v5
    v_add_f32 v6, 1.0, v6
    v_add_f32 v7, 1.0, v7
    v_rcp_f32 v0, v0
    v_rcp_f32 v1, v1
    v_rcp_f32 v2, v2
    v_rcp_f32 v3, v3
    v_rcp_f32 v4, v4
    v_rcp_f32 v5, v5
    v_rcp_f32 v6, v6
    v_rcp_f32 v7, v7
    v_mul_f32 v0, v0, v137
    v_mul_f32 v1, v1, v141
    v_mul_f32 v2, v2, v145
    v_mul_f32 v3, v3, v149
    v_mul_f32 v4, v4, v153
    v_mul_f32 v5, v5, v157
    v_mul_f32 v6, v6, v161
    v_mul_f32 v7, v7, v165
    v_cvt_pk_bf16_f32 v36, v0, v1
    v_cvt_pk_bf16_f32 v37, v2, v3
    v_cvt_pk_bf16_f32 v38, v4, v5
    v_cvt_pk_bf16_f32 v39, v6, v7
    v_add_u32 v212, 17408, v210
    buffer_store_dwordx4 v[36:39], v212, s[32:35], 0 offen
    v_fma_f32 v138, v138, v216, v224
    v_fma_f32 v142, v142, v217, v225
    v_fma_f32 v146, v146, v218, v226
    v_fma_f32 v150, v150, v219, v227
    v_fma_f32 v154, v154, v220, v228
    v_fma_f32 v158, v158, v221, v229
    v_fma_f32 v162, v162, v222, v230
    v_fma_f32 v166, v166, v223, v231
    v_mul_f32 v0, v138, v138
    v_mul_f32 v1, v142, v142
    v_mul_f32 v2, v146, v146
    v_mul_f32 v3, v150, v150
    v_mul_f32 v4, v154, v154
    v_mul_f32 v5, v158, v158
    v_mul_f32 v6, v162, v162
    v_mul_f32 v7, v166, v166
    v_fma_f32 v0, v0, s26, v211
    v_fma_f32 v1, v1, s26, v211
    v_fma_f32 v2, v2, s26, v211
    v_fma_f32 v3, v3, s26, v211
    v_fma_f32 v4, v4, s26, v211
    v_fma_f32 v5, v5, s26, v211
    v_fma_f32 v6, v6, s26, v211
    v_fma_f32 v7, v7, s26, v211
    v_mul_f32 v0, v0, v138
    v_mul_f32 v1, v1, v142
    v_mul_f32 v2, v2, v146
    v_mul_f32 v3, v3, v150
    v_mul_f32 v4, v4, v154
    v_mul_f32 v5, v5, v158
    v_mul_f32 v6, v6, v162
    v_mul_f32 v7, v7, v166
    v_exp_f32 v0, v0
    v_exp_f32 v1, v1
    v_exp_f32 v2, v2
    v_exp_f32 v3, v3
    v_exp_f32 v4, v4
    v_exp_f32 v5, v5
    v_exp_f32 v6, v6
    v_exp_f32 v7, v7
    v_add_f32 v0, 1.0, v0
    v_add_f32 v1, 1.0, v1
    v_add_f32 v2, 1.0, v2
    v_add_f32 v3, 1.0, v3
    v_add_f32 v4, 1.0, v4
    v_add_f32 v5, 1.0, v5
    v_add_f32 v6, 1.0, v6
    v_add_f32 v7, 1.0, v7
    v_rcp_f32 v0, v0
    v_rcp_f32 v1, v1
    v_rcp_f32 v2, v2
    v_rcp_f32 v3, v3
    v_rcp_f32 v4, v4
    v_rcp_f32 v5, v5
    v_rcp_f32 v6, v6
    v_rcp_f32 v7, v7
    v_mul_f32 v0, v0, v138
    v_mul_f32 v1, v1, v142
    v_mul_f32 v2, v2, v146
    v_mul_f32 v3, v3, v150
    v_mul_f32 v4, v4, v154
    v_mul_f32 v5, v5, v158
    v_mul_f32 v6, v6, v162
    v_mul_f32 v7, v7, v166
    v_cvt_pk_bf16_f32 v40, v0, v1
    v_cvt_pk_bf16_f32 v41, v2, v3
    v_cvt_pk_bf16_f32 v42, v4, v5
    v_cvt_pk_bf16_f32 v43, v6, v7
    v_add_u32 v212, 18432, v210
    buffer_store_dwordx4 v[40:43], v212, s[32:35], 0 offen
    v_fma_f32 v139, v139, v216, v224
    v_fma_f32 v143, v143, v217, v225
    v_fma_f32 v147, v147, v218, v226
    v_fma_f32 v151, v151, v219, v227
    v_fma_f32 v155, v155, v220, v228
    v_fma_f32 v159, v159, v221, v229
    v_fma_f32 v163, v163, v222, v230
    v_fma_f32 v167, v167, v223, v231
    v_mul_f32 v0, v139, v139
    v_mul_f32 v1, v143, v143
    v_mul_f32 v2, v147, v147
    v_mul_f32 v3, v151, v151
    v_mul_f32 v4, v155, v155
    v_mul_f32 v5, v159, v159
    v_mul_f32 v6, v163, v163
    v_mul_f32 v7, v167, v167
    v_fma_f32 v0, v0, s26, v211
    v_fma_f32 v1, v1, s26, v211
    v_fma_f32 v2, v2, s26, v211
    v_fma_f32 v3, v3, s26, v211
    v_fma_f32 v4, v4, s26, v211
    v_fma_f32 v5, v5, s26, v211
    v_fma_f32 v6, v6, s26, v211
    v_fma_f32 v7, v7, s26, v211
    v_mul_f32 v0, v0, v139
    v_mul_f32 v1, v1, v143
    v_mul_f32 v2, v2, v147
    v_mul_f32 v3, v3, v151
    v_mul_f32 v4, v4, v155
    v_mul_f32 v5, v5, v159
    v_mul_f32 v6, v6, v163
    v_mul_f32 v7, v7, v167
    v_exp_f32 v0, v0
    v_exp_f32 v1, v1
    v_exp_f32 v2, v2
    v_exp_f32 v3, v3
    v_exp_f32 v4, v4
    v_exp_f32 v5, v5
    v_exp_f32 v6, v6
    v_exp_f32 v7, v7
    v_add_f32 v0, 1.0, v0
    v_add_f32 v1, 1.0, v1
    v_add_f32 v2, 1.0, v2
    v_add_f32 v3, 1.0, v3
    v_add_f32 v4, 1.0, v4
    v_add_f32 v5, 1.0, v5
    v_add_f32 v6, 1.0, v6
    v_add_f32 v7, 1.0, v7
    v_rcp_f32 v0, v0
    v_rcp_f32 v1, v1
    v_rcp_f32 v2, v2
    v_rcp_f32 v3, v3
    v_rcp_f32 v4, v4
    v_rcp_f32 v5, v5
    v_rcp_f32 v6, v6
    v_rcp_f32 v7, v7
    v_mul_f32 v0, v0, v139
    v_mul_f32 v1, v1, v143
    v_mul_f32 v2, v2, v147
    v_mul_f32 v3, v3, v151
    v_mul_f32 v4, v4, v155
    v_mul_f32 v5, v5, v159
    v_mul_f32 v6, v6, v163
    v_mul_f32 v7, v7, v167
    v_cvt_pk_bf16_f32 v44, v0, v1
    v_cvt_pk_bf16_f32 v45, v2, v3
    v_cvt_pk_bf16_f32 v46, v4, v5
    v_cvt_pk_bf16_f32 v47, v6, v7
    v_add_u32 v212, 19456, v210
    buffer_store_dwordx4 v[44:47], v212, s[32:35], 0 offen
    v_fma_f32 v168, v168, v216, v224
    v_fma_f32 v172, v172, v217, v225
    v_fma_f32 v176, v176, v218, v226
    v_fma_f32 v180, v180, v219, v227
    v_fma_f32 v184, v184, v220, v228
    v_fma_f32 v188, v188, v221, v229
    v_fma_f32 v192, v192, v222, v230
    v_fma_f32 v196, v196, v223, v231
    v_mul_f32 v0, v168, v168
    v_mul_f32 v1, v172, v172
    v_mul_f32 v2, v176, v176
    v_mul_f32 v3, v180, v180
    v_mul_f32 v4, v184, v184
    v_mul_f32 v5, v188, v188
    v_mul_f32 v6, v192, v192
    v_mul_f32 v7, v196, v196
    v_fma_f32 v0, v0, s26, v211
    v_fma_f32 v1, v1, s26, v211
    v_fma_f32 v2, v2, s26, v211
    v_fma_f32 v3, v3, s26, v211
    v_fma_f32 v4, v4, s26, v211
    v_fma_f32 v5, v5, s26, v211
    v_fma_f32 v6, v6, s26, v211
    v_fma_f32 v7, v7, s26, v211
    v_mul_f32 v0, v0, v168
    v_mul_f32 v1, v1, v172
    v_mul_f32 v2, v2, v176
    v_mul_f32 v3, v3, v180
    v_mul_f32 v4, v4, v184
    v_mul_f32 v5, v5, v188
    v_mul_f32 v6, v6, v192
    v_mul_f32 v7, v7, v196
    v_exp_f32 v0, v0
    v_exp_f32 v1, v1
    v_exp_f32 v2, v2
    v_exp_f32 v3, v3
    v_exp_f32 v4, v4
    v_exp_f32 v5, v5
    v_exp_f32 v6, v6
    v_exp_f32 v7, v7
    v_add_f32 v0, 1.0, v0
    v_add_f32 v1, 1.0, v1
    v_add_f32 v2, 1.0, v2
    v_add_f32 v3, 1.0, v3
    v_add_f32 v4, 1.0, v4
    v_add_f32 v5, 1.0, v5
    v_add_f32 v6, 1.0, v6
    v_add_f32 v7, 1.0, v7
    v_rcp_f32 v0, v0
    v_rcp_f32 v1, v1
    v_rcp_f32 v2, v2
    v_rcp_f32 v3, v3
    v_rcp_f32 v4, v4
    v_rcp_f32 v5, v5
    v_rcp_f32 v6, v6
    v_rcp_f32 v7, v7
    v_mul_f32 v0, v0, v168
    v_mul_f32 v1, v1, v172
    v_mul_f32 v2, v2, v176
    v_mul_f32 v3, v3, v180
    v_mul_f32 v4, v4, v184
    v_mul_f32 v5, v5, v188
    v_mul_f32 v6, v6, v192
    v_mul_f32 v7, v7, v196
    v_cvt_pk_bf16_f32 v16, v0, v1
    v_cvt_pk_bf16_f32 v17, v2, v3
    v_cvt_pk_bf16_f32 v18, v4, v5
    v_cvt_pk_bf16_f32 v19, v6, v7
    v_add_u32 v212, 32768, v210
    buffer_store_dwordx4 v[16:19], v212, s[32:35], 0 offen
    v_fma_f32 v169, v169, v216, v224
    v_fma_f32 v173, v173, v217, v225
    v_fma_f32 v177, v177, v218, v226
    v_fma_f32 v181, v181, v219, v227
    v_fma_f32 v185, v185, v220, v228
    v_fma_f32 v189, v189, v221, v229
    v_fma_f32 v193, v193, v222, v230
    v_fma_f32 v197, v197, v223, v231
    v_mul_f32 v0, v169, v169
    v_mul_f32 v1, v173, v173
    v_mul_f32 v2, v177, v177
    v_mul_f32 v3, v181, v181
    v_mul_f32 v4, v185, v185
    v_mul_f32 v5, v189, v189
    v_mul_f32 v6, v193, v193
    v_mul_f32 v7, v197, v197
    v_fma_f32 v0, v0, s26, v211
    v_fma_f32 v1, v1, s26, v211
    v_fma_f32 v2, v2, s26, v211
    v_fma_f32 v3, v3, s26, v211
    v_fma_f32 v4, v4, s26, v211
    v_fma_f32 v5, v5, s26, v211
    v_fma_f32 v6, v6, s26, v211
    v_fma_f32 v7, v7, s26, v211
    v_mul_f32 v0, v0, v169
    v_mul_f32 v1, v1, v173
    v_mul_f32 v2, v2, v177
    v_mul_f32 v3, v3, v181
    v_mul_f32 v4, v4, v185
    v_mul_f32 v5, v5, v189
    v_mul_f32 v6, v6, v193
    v_mul_f32 v7, v7, v197
    v_exp_f32 v0, v0
    v_exp_f32 v1, v1
    v_exp_f32 v2, v2
    v_exp_f32 v3, v3
    v_exp_f32 v4, v4
    v_exp_f32 v5, v5
    v_exp_f32 v6, v6
    v_exp_f32 v7, v7
    v_add_f32 v0, 1.0, v0
    v_add_f32 v1, 1.0, v1
    v_add_f32 v2, 1.0, v2
    v_add_f32 v3, 1.0, v3
    v_add_f32 v4, 1.0, v4
    v_add_f32 v5, 1.0, v5
    v_add_f32 v6, 1.0, v6
    v_add_f32 v7, 1.0, v7
    v_rcp_f32 v0, v0
    v_rcp_f32 v1, v1
    v_rcp_f32 v2, v2
    v_rcp_f32 v3, v3
    v_rcp_f32 v4, v4
    v_rcp_f32 v5, v5
    v_rcp_f32 v6, v6
    v_rcp_f32 v7, v7
    v_mul_f32 v0, v0, v169
    v_mul_f32 v1, v1, v173
    v_mul_f32 v2, v2, v177
    v_mul_f32 v3, v3, v181
    v_mul_f32 v4, v4, v185
    v_mul_f32 v5, v5, v189
    v_mul_f32 v6, v6, v193
    v_mul_f32 v7, v7, v197
    v_cvt_pk_bf16_f32 v20, v0, v1
    v_cvt_pk_bf16_f32 v21, v2, v3
    v_cvt_pk_bf16_f32 v22, v4, v5
    v_cvt_pk_bf16_f32 v23, v6, v7
    v_add_u32 v212, 33792, v210
    buffer_store_dwordx4 v[20:23], v212, s[32:35], 0 offen
    v_fma_f32 v170, v170, v216, v224
    v_fma_f32 v174, v174, v217, v225
    v_fma_f32 v178, v178, v218, v226
    v_fma_f32 v182, v182, v219, v227
    v_fma_f32 v186, v186, v220, v228
    v_fma_f32 v190, v190, v221, v229
    v_fma_f32 v194, v194, v222, v230
    v_fma_f32 v198, v198, v223, v231
    v_mul_f32 v0, v170, v170
    v_mul_f32 v1, v174, v174
    v_mul_f32 v2, v178, v178
    v_mul_f32 v3, v182, v182
    v_mul_f32 v4, v186, v186
    v_mul_f32 v5, v190, v190
    v_mul_f32 v6, v194, v194
    v_mul_f32 v7, v198, v198
    v_fma_f32 v0, v0, s26, v211
    v_fma_f32 v1, v1, s26, v211
    v_fma_f32 v2, v2, s26, v211
    v_fma_f32 v3, v3, s26, v211
    v_fma_f32 v4, v4, s26, v211
    v_fma_f32 v5, v5, s26, v211
    v_fma_f32 v6, v6, s26, v211
    v_fma_f32 v7, v7, s26, v211
    v_mul_f32 v0, v0, v170
    v_mul_f32 v1, v1, v174
    v_mul_f32 v2, v2, v178
    v_mul_f32 v3, v3, v182
    v_mul_f32 v4, v4, v186
    v_mul_f32 v5, v5, v190
    v_mul_f32 v6, v6, v194
    v_mul_f32 v7, v7, v198
    v_exp_f32 v0, v0
    v_exp_f32 v1, v1
    v_exp_f32 v2, v2
    v_exp_f32 v3, v3
    v_exp_f32 v4, v4
    v_exp_f32 v5, v5
    v_exp_f32 v6, v6
    v_exp_f32 v7, v7
    v_add_f32 v0, 1.0, v0
    v_add_f32 v1, 1.0, v1
    v_add_f32 v2, 1.0, v2
    v_add_f32 v3, 1.0, v3
    v_add_f32 v4, 1.0, v4
    v_add_f32 v5, 1.0, v5
    v_add_f32 v6, 1.0, v6
    v_add_f32 v7, 1.0, v7
    v_rcp_f32 v0, v0
    v_rcp_f32 v1, v1
    v_rcp_f32 v2, v2
    v_rcp_f32 v3, v3
    v_rcp_f32 v4, v4
    v_rcp_f32 v5, v5
    v_rcp_f32 v6, v6
    v_rcp_f32 v7, v7
    v_mul_f32 v0, v0, v170
    v_mul_f32 v1, v1, v174
    v_mul_f32 v2, v2, v178
    v_mul_f32 v3, v3, v182
    v_mul_f32 v4, v4, v186
    v_mul_f32 v5, v5, v190
    v_mul_f32 v6, v6, v194
    v_mul_f32 v7, v7, v198
    v_cvt_pk_bf16_f32 v24, v0, v1
    v_cvt_pk_bf16_f32 v25, v2, v3
    v_cvt_pk_bf16_f32 v26, v4, v5
    v_cvt_pk_bf16_f32 v27, v6, v7
    v_add_u32 v212, 34816, v210
    buffer_store_dwordx4 v[24:27], v212, s[32:35], 0 offen
    v_fma_f32 v171, v171, v216, v224
    v_fma_f32 v175, v175, v217, v225
    v_fma_f32 v179, v179, v218, v226
    v_fma_f32 v183, v183, v219, v227
    v_fma_f32 v187, v187, v220, v228
    v_fma_f32 v191, v191, v221, v229
    v_fma_f32 v195, v195, v222, v230
    v_fma_f32 v199, v199, v223, v231
    v_mul_f32 v0, v171, v171
    v_mul_f32 v1, v175, v175
    v_mul_f32 v2, v179, v179
    v_mul_f32 v3, v183, v183
    v_mul_f32 v4, v187, v187
    v_mul_f32 v5, v191, v191
    v_mul_f32 v6, v195, v195
    v_mul_f32 v7, v199, v199
    v_fma_f32 v0, v0, s26, v211
    v_fma_f32 v1, v1, s26, v211
    v_fma_f32 v2, v2, s26, v211
    v_fma_f32 v3, v3, s26, v211
    v_fma_f32 v4, v4, s26, v211
    v_fma_f32 v5, v5, s26, v211
    v_fma_f32 v6, v6, s26, v211
    v_fma_f32 v7, v7, s26, v211
    v_mul_f32 v0, v0, v171
    v_mul_f32 v1, v1, v175
    v_mul_f32 v2, v2, v179
    v_mul_f32 v3, v3, v183
    v_mul_f32 v4, v4, v187
    v_mul_f32 v5, v5, v191
    v_mul_f32 v6, v6, v195
    v_mul_f32 v7, v7, v199
    v_exp_f32 v0, v0
    v_exp_f32 v1, v1
    v_exp_f32 v2, v2
    v_exp_f32 v3, v3
    v_exp_f32 v4, v4
    v_exp_f32 v5, v5
    v_exp_f32 v6, v6
    v_exp_f32 v7, v7
    v_add_f32 v0, 1.0, v0
    v_add_f32 v1, 1.0, v1
    v_add_f32 v2, 1.0, v2
    v_add_f32 v3, 1.0, v3
    v_add_f32 v4, 1.0, v4
    v_add_f32 v5, 1.0, v5
    v_add_f32 v6, 1.0, v6
    v_add_f32 v7, 1.0, v7
    v_rcp_f32 v0, v0
    v_rcp_f32 v1, v1
    v_rcp_f32 v2, v2
    v_rcp_f32 v3, v3
    v_rcp_f32 v4, v4
    v_rcp_f32 v5, v5
    v_rcp_f32 v6, v6
    v_rcp_f32 v7, v7
    v_mul_f32 v0, v0, v171
    v_mul_f32 v1, v1, v175
    v_mul_f32 v2, v2, v179
    v_mul_f32 v3, v3, v183
    v_mul_f32 v4, v4, v187
    v_mul_f32 v5, v5, v191
    v_mul_f32 v6, v6, v195
    v_mul_f32 v7, v7, v199
    v_cvt_pk_bf16_f32 v28, v0, v1
    v_cvt_pk_bf16_f32 v29, v2, v3
    v_cvt_pk_bf16_f32 v30, v4, v5
    v_cvt_pk_bf16_f32 v31, v6, v7
    v_add_u32 v212, 35840, v210
    buffer_store_dwordx4 v[28:31], v212, s[32:35], 0 offen
L_k5_end:
    s_endpgm
.section .rodata,"a"
.p2align 6
.amdhsa_kernel xform_kernel
  .amdhsa_next_free_vgpr 160
  .amdhsa_next_free_sgpr 96
  .amdhsa_accum_offset 160
  .amdhsa_group_segment_fixed_size 0
  .amdhsa_kernarg_size 56
  .amdhsa_user_sgpr_count 2
  .amdhsa_user_sgpr_kernarg_segment_ptr 1
  .amdhsa_system_sgpr_workgroup_id_x 1
  .amdhsa_float_denorm_mode_32 3
.end_amdhsa_kernel

.p2align 6
.amdhsa_kernel gemm_kernel
  .amdhsa_next_free_vgpr 200
  .amdhsa_next_free_sgpr 96
  .amdhsa_accum_offset 200
  .amdhsa_group_segment_fixed_size 0
  .amdhsa_kernarg_size 56
  .amdhsa_user_sgpr_count 2
  .amdhsa_user_sgpr_kernarg_segment_ptr 1
  .amdhsa_system_sgpr_workgroup_id_x 1
  .amdhsa_float_denorm_mode_32 3
.end_amdhsa_kernel

.p2align 6
.amdhsa_kernel stats_kernel
  .amdhsa_next_free_vgpr 216
  .amdhsa_next_free_sgpr 96
  .amdhsa_accum_offset 216
  .amdhsa_group_segment_fixed_size 0
  .amdhsa_kernarg_size 56
  .amdhsa_user_sgpr_count 2
  .amdhsa_user_sgpr_kernarg_segment_ptr 1
  .amdhsa_system_sgpr_workgroup_id_x 1
  .amdhsa_float_denorm_mode_32 3
.end_amdhsa_kernel

.p2align 6
.amdhsa_kernel final_kernel
  .amdhsa_next_free_vgpr 232
  .amdhsa_next_free_sgpr 96
  .amdhsa_accum_offset 232
  .amdhsa_group_segment_fixed_size 0
  .amdhsa_kernarg_size 56
  .amdhsa_user_sgpr_count 2
  .amdhsa_user_sgpr_kernarg_segment_ptr 1
  .amdhsa_system_sgpr_workgroup_id_x 1
  .amdhsa_float_denorm_mode_32 3
.end_amdhsa_kernel
```

```asm
; @launch kernel=xform_kernel grid=(1696,1,1) block=(256,1,1) lds=16384
; @launch kernel=gemm_kernel grid=(256,1,1) block=(512,1,1) lds=152576
; @launch kernel=final_kernel grid=(336,1,1) block=(256,1,1) lds=25600
.amdgcn_target "amdgcn-amd-amdhsa--gfx950"
.text
.globl xform_kernel
.p2align 8
.type xform_kernel,@function
xform_kernel:
    s_cmp_ge_u32 s2, 1696
    s_cbranch_scc1 L_k12_end
    s_load_dwordx4 s[4:7], s[0:1], 0
    s_load_dwordx2 s[8:9], s[0:1], 48
    v_and_b32 v144, 63, v0
    v_lshrrev_b32 v149, 6, v0
    v_and_b32 v145, 15, v144
    v_readfirstlane_b32 s10, v149
    v_lshrrev_b32 v146, 4, v144
    s_mov_b32 s30, 0x05040100
    s_mov_b32 s31, 0x07060302
    s_waitcnt lgkmcnt(0)
    s_mov_b32 s16, s8
    s_and_b32 s17, s9, 0xffff
    s_mov_b32 s18, 268435456
    s_mov_b32 s19, 0x00020000
    s_cmp_ge_u32 s2, 672
    s_cbranch_scc1 L_k12_w
    s_cmp_ge_u32 s2, 336
    s_cselect_b32 s11, 1, 0
    s_mul_i32 s12, s11, 336
    s_sub_u32 s12, s2, s12
    s_mul_hi_u32 s14, s12, 536870912
    s_mul_i32 s13, s14, 8
    s_sub_u32 s13, s12, s13
    s_lshl_b32 s14, s14, 2
    s_add_u32 s14, s14, s10
    s_mul_i32 s15, s11, 16384000
    s_add_u32 s4, s4, s15
    s_addc_u32 s5, s5, 0
    s_mov_b32 s20, s4
    s_and_b32 s21, s5, 0xffff
    s_mov_b32 s22, 16384000
    s_mov_b32 s23, 0x00020000
    s_mul_i32 s15, s14, 98304
    s_lshl_b32 s24, s13, 8
    s_add_u32 s15, s15, s24
    v_lshlrev_b32 v147, 14, v146
    v_lshl_add_u32 v147, v145, 4, v147
    v_add_u32 v147, s15, v147
    buffer_load_dwordx4 v[0:3], v147, s[20:23], 0 offen
    v_add_u32 v149, 2048, v147
    buffer_load_dwordx4 v[4:7], v149, s[20:23], 0 offen
    v_add_u32 v149, 4096, v147
    buffer_load_dwordx4 v[8:11], v149, s[20:23], 0 offen
    v_add_u32 v149, 6144, v147
    buffer_load_dwordx4 v[12:15], v149, s[20:23], 0 offen
    v_add_u32 v149, 8192, v147
    buffer_load_dwordx4 v[16:19], v149, s[20:23], 0 offen
    v_add_u32 v149, 10240, v147
    buffer_load_dwordx4 v[20:23], v149, s[20:23], 0 offen
    v_add_u32 v149, 12288, v147
    buffer_load_dwordx4 v[24:27], v149, s[20:23], 0 offen
    v_add_u32 v149, 14336, v147
    buffer_load_dwordx4 v[28:31], v149, s[20:23], 0 offen
    v_add_u32 v149, 65536, v147
    buffer_load_dwordx4 v[32:35], v149, s[20:23], 0 offen
    v_add_u32 v149, 67584, v147
    buffer_load_dwordx4 v[36:39], v149, s[20:23], 0 offen
    v_add_u32 v149, 69632, v147
    buffer_load_dwordx4 v[40:43], v149, s[20:23], 0 offen
    v_add_u32 v149, 71680, v147
    buffer_load_dwordx4 v[44:47], v149, s[20:23], 0 offen
    v_add_u32 v149, 73728, v147
    buffer_load_dwordx4 v[48:51], v149, s[20:23], 0 offen
    v_add_u32 v149, 75776, v147
    buffer_load_dwordx4 v[52:55], v149, s[20:23], 0 offen
    v_add_u32 v149, 77824, v147
    buffer_load_dwordx4 v[56:59], v149, s[20:23], 0 offen
    v_add_u32 v149, 79872, v147
    buffer_load_dwordx4 v[60:63], v149, s[20:23], 0 offen
    v_lshrrev_b32 v149, 2, v145
    v_lshlrev_b32 v149, 1, v149
    v_bfe_u32 v150, v145, 1, 1
    v_add_u32 v149, v149, v150
    s_lshl_b32 s24, s10, 3
    v_add_u32 v149, s24, v149
    v_lshl_add_u32 v149, v149, 1, 1
    v_and_b32 v150, 1, v145
    v_lshlrev_b32 v150, 5, v150
    v_lshlrev_b32 v151, 3, v146
    v_mad_u32_u24 v96, v149, v151, v150
    v_add_u32 v97, v96, v149
    v_add_u32 v98, v97, v149
    v_add_u32 v99, v98, v149
    v_add_u32 v100, v99, v149
    v_add_u32 v101, v100, v149
    v_add_u32 v102, v101, v149
    v_add_u32 v103, v102, v149
    v_and_b32 v96, 127, v96
    v_cvt_f32_u32 v96, v96
    v_mul_f32 v96, 0x3c000000, v96
    v_cos_f32 v96, v96
    v_and_b32 v97, 127, v97
    v_cvt_f32_u32 v97, v97
    v_mul_f32 v97, 0x3c000000, v97
    v_cos_f32 v97, v97
    v_and_b32 v98, 127, v98
    v_cvt_f32_u32 v98, v98
    v_mul_f32 v98, 0x3c000000, v98
    v_cos_f32 v98, v98
    v_and_b32 v99, 127, v99
    v_cvt_f32_u32 v99, v99
    v_mul_f32 v99, 0x3c000000, v99
    v_cos_f32 v99, v99
    v_and_b32 v100, 127, v100
    v_cvt_f32_u32 v100, v100
    v_mul_f32 v100, 0x3c000000, v100
    v_cos_f32 v100, v100
    v_and_b32 v101, 127, v101
    v_cvt_f32_u32 v101, v101
    v_mul_f32 v101, 0x3c000000, v101
    v_cos_f32 v101, v101
    v_and_b32 v102, 127, v102
    v_cvt_f32_u32 v102, v102
    v_mul_f32 v102, 0x3c000000, v102
    v_cos_f32 v102, v102
    v_and_b32 v103, 127, v103
    v_cvt_f32_u32 v103, v103
    v_mul_f32 v103, 0x3c000000, v103
    v_cos_f32 v103, v103
    v_cvt_pk_bf16_f32 v112, v96, v97
    v_cvt_pk_bf16_f32 v113, v98, v99
    v_cvt_pk_bf16_f32 v114, v100, v101
    v_cvt_pk_bf16_f32 v115, v102, v103
    s_lshl_b32 s24, s10, 11
    v_lshlrev_b32 v152, 4, v144
    v_add_u32 v152, s24, v152
    ds_write_b128 v152, v[112:115] offset:0
    v_lshlrev_b32 v151, 3, v146
    v_add_u32 v151, 32, v151
    v_mad_u32_u24 v96, v149, v151, v150
    v_add_u32 v97, v96, v149
    v_add_u32 v98, v97, v149
    v_add_u32 v99, v98, v149
    v_add_u32 v100, v99, v149
    v_add_u32 v101, v100, v149
    v_add_u32 v102, v101, v149
    v_add_u32 v103, v102, v149
    v_and_b32 v96, 127, v96
    v_cvt_f32_u32 v96, v96
    v_mul_f32 v96, 0x3c000000, v96
    v_cos_f32 v96, v96
    v_and_b32 v97, 127, v97
    v_cvt_f32_u32 v97, v97
    v_mul_f32 v97, 0x3c000000, v97
    v_cos_f32 v97, v97
    v_and_b32 v98, 127, v98
    v_cvt_f32_u32 v98, v98
    v_mul_f32 v98, 0x3c000000, v98
    v_cos_f32 v98, v98
    v_and_b32 v99, 127, v99
    v_cvt_f32_u32 v99, v99
    v_mul_f32 v99, 0x3c000000, v99
    v_cos_f32 v99, v99
    v_and_b32 v100, 127, v100
    v_cvt_f32_u32 v100, v100
    v_mul_f32 v100, 0x3c000000, v100
    v_cos_f32 v100, v100
    v_and_b32 v101, 127, v101
    v_cvt_f32_u32 v101, v101
    v_mul_f32 v101, 0x3c000000, v101
    v_cos_f32 v101, v101
    v_and_b32 v102, 127, v102
    v_cvt_f32_u32 v102, v102
    v_mul_f32 v102, 0x3c000000, v102
    v_cos_f32 v102, v102
    v_and_b32 v103, 127, v103
    v_cvt_f32_u32 v103, v103
    v_mul_f32 v103, 0x3c000000, v103
    v_cos_f32 v103, v103
    v_cvt_pk_bf16_f32 v112, v96, v97
    v_cvt_pk_bf16_f32 v113, v98, v99
    v_cvt_pk_bf16_f32 v114, v100, v101
    v_cvt_pk_bf16_f32 v115, v102, v103
    s_lshl_b32 s24, s10, 11
    v_lshlrev_b32 v152, 4, v144
    v_add_u32 v152, s24, v152
    ds_write_b128 v152, v[112:115] offset:1024
    s_waitcnt lgkmcnt(0)
    s_barrier
    v_lshlrev_b32 v152, 4, v144
    ds_read_b128 v[64:67], v152 offset:0
    ds_read_b128 v[68:71], v152 offset:1024
    ds_read_b128 v[72:75], v152 offset:2048
    ds_read_b128 v[76:79], v152 offset:3072
    ds_read_b128 v[80:83], v152 offset:4096
    ds_read_b128 v[84:87], v152 offset:5120
    ds_read_b128 v[88:91], v152 offset:6144
    ds_read_b128 v[92:95], v152 offset:7168
    s_bfe_u32 s24, s14, 0x10003
    s_mul_i32 s24, s24, 3
    v_and_b32 v149, 3, v145
    v_xor_b32 v149, s24, v149
    v_lshlrev_b32 v149, 4, v149
    v_lshrrev_b32 v150, 2, v145
    s_mov_b32 s24, 688128
    v_mad_u32_u24 v149, v150, s24, v149
    s_mov_b32 s24, 43008
    v_mad_u32_u24 v148, v146, s24, v149
    s_mul_i32 s24, s11, 22020096
    s_mul_i32 s25, s13, 2752512
    s_add_u32 s24, s24, s25
    s_lshl_b32 s25, s14, 6
    s_add_u32 s24, s24, s25
    s_add_u32 s24, s24, 67108864
    s_waitcnt vmcnt(0) lgkmcnt(0)
    v_perm_b32 v96, v4, v0, s30
    v_perm_b32 v97, v12, v8, s30
    v_perm_b32 v98, v20, v16, s30
    v_perm_b32 v99, v28, v24, s30
    v_perm_b32 v100, v4, v0, s31
    v_perm_b32 v101, v12, v8, s31
    v_perm_b32 v102, v20, v16, s31
    v_perm_b32 v103, v28, v24, s31
    v_perm_b32 v104, v36, v32, s30
    v_perm_b32 v105, v44, v40, s30
    v_perm_b32 v106, v52, v48, s30
    v_perm_b32 v107, v60, v56, s30
    v_perm_b32 v108, v36, v32, s31
    v_perm_b32 v109, v44, v40, s31
    v_perm_b32 v110, v52, v48, s31
    v_perm_b32 v111, v60, v56, s31
    v_mfma_f32_16x16x32_bf16 v[112:115], v[64:67], v[96:99], 0
    v_mfma_f32_16x16x32_bf16 v[116:119], v[64:67], v[100:103], 0
    v_mfma_f32_16x16x32_bf16 v[120:123], v[72:75], v[96:99], 0
    v_mfma_f32_16x16x32_bf16 v[124:127], v[72:75], v[100:103], 0
    v_mfma_f32_16x16x32_bf16 v[128:131], v[80:83], v[96:99], 0
    v_mfma_f32_16x16x32_bf16 v[132:135], v[80:83], v[100:103], 0
    v_mfma_f32_16x16x32_bf16 v[136:139], v[88:91], v[96:99], 0
    v_mfma_f32_16x16x32_bf16 v[140:143], v[88:91], v[100:103], 0
    v_mfma_f32_16x16x32_bf16 v[112:115], v[68:71], v[104:107], v[112:115]
    v_mfma_f32_16x16x32_bf16 v[116:119], v[68:71], v[108:111], v[116:119]
    v_mfma_f32_16x16x32_bf16 v[120:123], v[76:79], v[104:107], v[120:123]
    v_mfma_f32_16x16x32_bf16 v[124:127], v[76:79], v[108:111], v[124:127]
    v_mfma_f32_16x16x32_bf16 v[128:131], v[84:87], v[104:107], v[128:131]
    v_mfma_f32_16x16x32_bf16 v[132:135], v[84:87], v[108:111], v[132:135]
    v_mfma_f32_16x16x32_bf16 v[136:139], v[92:95], v[104:107], v[136:139]
    v_mfma_f32_16x16x32_bf16 v[140:143], v[92:95], v[108:111], v[140:143]
    v_perm_b32 v96, v5, v1, s30
    v_perm_b32 v97, v13, v9, s30
    v_perm_b32 v98, v21, v17, s30
    v_perm_b32 v99, v29, v25, s30
    v_perm_b32 v100, v5, v1, s31
    v_perm_b32 v101, v13, v9, s31
    v_perm_b32 v102, v21, v17, s31
    v_perm_b32 v103, v29, v25, s31
    v_perm_b32 v104, v37, v33, s30
    v_perm_b32 v105, v45, v41, s30
    v_perm_b32 v106, v53, v49, s30
    v_perm_b32 v107, v61, v57, s30
    v_perm_b32 v108, v37, v33, s31
    v_perm_b32 v109, v45, v41, s31
    v_perm_b32 v110, v53, v49, s31
    v_perm_b32 v111, v61, v57, s31
    v_cvt_pk_bf16_f32 v0, v112, v116
    v_cvt_pk_bf16_f32 v4, v113, v117
    v_cvt_pk_bf16_f32 v8, v114, v118
    v_cvt_pk_bf16_f32 v12, v115, v119
    v_cvt_pk_bf16_f32 v16, v120, v124
    v_cvt_pk_bf16_f32 v20, v121, v125
    v_cvt_pk_bf16_f32 v24, v122, v126
    v_cvt_pk_bf16_f32 v28, v123, v127
    v_cvt_pk_bf16_f32 v32, v128, v132
    v_cvt_pk_bf16_f32 v36, v129, v133
    v_cvt_pk_bf16_f32 v40, v130, v134
    v_cvt_pk_bf16_f32 v44, v131, v135
    v_cvt_pk_bf16_f32 v48, v136, v140
    v_cvt_pk_bf16_f32 v52, v137, v141
    v_cvt_pk_bf16_f32 v56, v138, v142
    v_cvt_pk_bf16_f32 v60, v139, v143
    v_mfma_f32_16x16x32_bf16 v[112:115], v[64:67], v[96:99], 0
    v_mfma_f32_16x16x32_bf16 v[116:119], v[64:67], v[100:103], 0
    v_mfma_f32_16x16x32_bf16 v[120:123], v[72:75], v[96:99], 0
    v_mfma_f32_16x16x32_bf16 v[124:127], v[72:75], v[100:103], 0
    v_mfma_f32_16x16x32_bf16 v[128:131], v[80:83], v[96:99], 0
    v_mfma_f32_16x16x32_bf16 v[132:135], v[80:83], v[100:103], 0
    v_mfma_f32_16x16x32_bf16 v[136:139], v[88:91], v[96:99], 0
    v_mfma_f32_16x16x32_bf16 v[140:143], v[88:91], v[100:103], 0
    v_mfma_f32_16x16x32_bf16 v[112:115], v[68:71], v[104:107], v[112:115]
    v_mfma_f32_16x16x32_bf16 v[116:119], v[68:71], v[108:111], v[116:119]
    v_mfma_f32_16x16x32_bf16 v[120:123], v[76:79], v[104:107], v[120:123]
    v_mfma_f32_16x16x32_bf16 v[124:127], v[76:79], v[108:111], v[124:127]
    v_mfma_f32_16x16x32_bf16 v[128:131], v[84:87], v[104:107], v[128:131]
    v_mfma_f32_16x16x32_bf16 v[132:135], v[84:87], v[108:111], v[132:135]
    v_mfma_f32_16x16x32_bf16 v[136:139], v[92:95], v[104:107], v[136:139]
    v_mfma_f32_16x16x32_bf16 v[140:143], v[92:95], v[108:111], v[140:143]
    v_perm_b32 v96, v6, v2, s30
    v_perm_b32 v97, v14, v10, s30
    v_perm_b32 v98, v22, v18, s30
    v_perm_b32 v99, v30, v26, s30
    v_perm_b32 v100, v6, v2, s31
    v_perm_b32 v101, v14, v10, s31
    v_perm_b32 v102, v22, v18, s31
    v_perm_b32 v103, v30, v26, s31
    v_perm_b32 v104, v38, v34, s30
    v_perm_b32 v105, v46, v42, s30
    v_perm_b32 v106, v54, v50, s30
    v_perm_b32 v107, v62, v58, s30
    v_perm_b32 v108, v38, v34, s31
    v_perm_b32 v109, v46, v42, s31
    v_perm_b32 v110, v54, v50, s31
    v_perm_b32 v111, v62, v58, s31
    v_cvt_pk_bf16_f32 v1, v112, v116
    v_cvt_pk_bf16_f32 v5, v113, v117
    v_cvt_pk_bf16_f32 v9, v114, v118
    v_cvt_pk_bf16_f32 v13, v115, v119
    v_cvt_pk_bf16_f32 v17, v120, v124
    v_cvt_pk_bf16_f32 v21, v121, v125
    v_cvt_pk_bf16_f32 v25, v122, v126
    v_cvt_pk_bf16_f32 v29, v123, v127
    v_cvt_pk_bf16_f32 v33, v128, v132
    v_cvt_pk_bf16_f32 v37, v129, v133
    v_cvt_pk_bf16_f32 v41, v130, v134
    v_cvt_pk_bf16_f32 v45, v131, v135
    v_cvt_pk_bf16_f32 v49, v136, v140
    v_cvt_pk_bf16_f32 v53, v137, v141
    v_cvt_pk_bf16_f32 v57, v138, v142
    v_cvt_pk_bf16_f32 v61, v139, v143
    v_mfma_f32_16x16x32_bf16 v[112:115], v[64:67], v[96:99], 0
    v_mfma_f32_16x16x32_bf16 v[116:119], v[64:67], v[100:103], 0
    v_mfma_f32_16x16x32_bf16 v[120:123], v[72:75], v[96:99], 0
    v_mfma_f32_16x16x32_bf16 v[124:127], v[72:75], v[100:103], 0
    v_mfma_f32_16x16x32_bf16 v[128:131], v[80:83], v[96:99], 0
    v_mfma_f32_16x16x32_bf16 v[132:135], v[80:83], v[100:103], 0
    v_mfma_f32_16x16x32_bf16 v[136:139], v[88:91], v[96:99], 0
    v_mfma_f32_16x16x32_bf16 v[140:143], v[88:91], v[100:103], 0
    v_mfma_f32_16x16x32_bf16 v[112:115], v[68:71], v[104:107], v[112:115]
    v_mfma_f32_16x16x32_bf16 v[116:119], v[68:71], v[108:111], v[116:119]
    v_mfma_f32_16x16x32_bf16 v[120:123], v[76:79], v[104:107], v[120:123]
    v_mfma_f32_16x16x32_bf16 v[124:127], v[76:79], v[108:111], v[124:127]
    v_mfma_f32_16x16x32_bf16 v[128:131], v[84:87], v[104:107], v[128:131]
    v_mfma_f32_16x16x32_bf16 v[132:135], v[84:87], v[108:111], v[132:135]
    v_mfma_f32_16x16x32_bf16 v[136:139], v[92:95], v[104:107], v[136:139]
    v_mfma_f32_16x16x32_bf16 v[140:143], v[92:95], v[108:111], v[140:143]
    v_perm_b32 v96, v7, v3, s30
    v_perm_b32 v97, v15, v11, s30
    v_perm_b32 v98, v23, v19, s30
    v_perm_b32 v99, v31, v27, s30
    v_perm_b32 v100, v7, v3, s31
    v_perm_b32 v101, v15, v11, s31
    v_perm_b32 v102, v23, v19, s31
    v_perm_b32 v103, v31, v27, s31
    v_perm_b32 v104, v39, v35, s30
    v_perm_b32 v105, v47, v43, s30
    v_perm_b32 v106, v55, v51, s30
    v_perm_b32 v107, v63, v59, s30
    v_perm_b32 v108, v39, v35, s31
    v_perm_b32 v109, v47, v43, s31
    v_perm_b32 v110, v55, v51, s31
    v_perm_b32 v111, v63, v59, s31
    v_cvt_pk_bf16_f32 v2, v112, v116
    v_cvt_pk_bf16_f32 v6, v113, v117
    v_cvt_pk_bf16_f32 v10, v114, v118
    v_cvt_pk_bf16_f32 v14, v115, v119
    v_cvt_pk_bf16_f32 v18, v120, v124
    v_cvt_pk_bf16_f32 v22, v121, v125
    v_cvt_pk_bf16_f32 v26, v122, v126
    v_cvt_pk_bf16_f32 v30, v123, v127
    v_cvt_pk_bf16_f32 v34, v128, v132
    v_cvt_pk_bf16_f32 v38, v129, v133
    v_cvt_pk_bf16_f32 v42, v130, v134
    v_cvt_pk_bf16_f32 v46, v131, v135
    v_cvt_pk_bf16_f32 v50, v136, v140
    v_cvt_pk_bf16_f32 v54, v137, v141
    v_cvt_pk_bf16_f32 v58, v138, v142
    v_cvt_pk_bf16_f32 v62, v139, v143
    v_mfma_f32_16x16x32_bf16 v[112:115], v[64:67], v[96:99], 0
    v_mfma_f32_16x16x32_bf16 v[116:119], v[64:67], v[100:103], 0
    v_mfma_f32_16x16x32_bf16 v[120:123], v[72:75], v[96:99], 0
    v_mfma_f32_16x16x32_bf16 v[124:127], v[72:75], v[100:103], 0
    v_mfma_f32_16x16x32_bf16 v[128:131], v[80:83], v[96:99], 0
    v_mfma_f32_16x16x32_bf16 v[132:135], v[80:83], v[100:103], 0
    v_mfma_f32_16x16x32_bf16 v[136:139], v[88:91], v[96:99], 0
    v_mfma_f32_16x16x32_bf16 v[140:143], v[88:91], v[100:103], 0
    v_mfma_f32_16x16x32_bf16 v[112:115], v[68:71], v[104:107], v[112:115]
    v_mfma_f32_16x16x32_bf16 v[116:119], v[68:71], v[108:111], v[116:119]
    v_mfma_f32_16x16x32_bf16 v[120:123], v[76:79], v[104:107], v[120:123]
    v_mfma_f32_16x16x32_bf16 v[124:127], v[76:79], v[108:111], v[124:127]
    v_mfma_f32_16x16x32_bf16 v[128:131], v[84:87], v[104:107], v[128:131]
    v_mfma_f32_16x16x32_bf16 v[132:135], v[84:87], v[108:111], v[132:135]
    v_mfma_f32_16x16x32_bf16 v[136:139], v[92:95], v[104:107], v[136:139]
    v_mfma_f32_16x16x32_bf16 v[140:143], v[92:95], v[108:111], v[140:143]
    s_nop 1
    v_cvt_pk_bf16_f32 v3, v112, v116
    v_cvt_pk_bf16_f32 v7, v113, v117
    v_cvt_pk_bf16_f32 v11, v114, v118
    v_cvt_pk_bf16_f32 v15, v115, v119
    v_cvt_pk_bf16_f32 v19, v120, v124
    v_cvt_pk_bf16_f32 v23, v121, v125
    v_cvt_pk_bf16_f32 v27, v122, v126
    v_cvt_pk_bf16_f32 v31, v123, v127
    v_cvt_pk_bf16_f32 v35, v128, v132
    v_cvt_pk_bf16_f32 v39, v129, v133
    v_cvt_pk_bf16_f32 v43, v130, v134
    v_cvt_pk_bf16_f32 v47, v131, v135
    v_cvt_pk_bf16_f32 v51, v136, v140
    v_cvt_pk_bf16_f32 v55, v137, v141
    v_cvt_pk_bf16_f32 v59, v138, v142
    v_cvt_pk_bf16_f32 v63, v139, v143
    s_add_u32 s25, s24, 0
    buffer_store_dwordx4 v[0:3], v148, s[16:19], s25 offen sc1
    s_add_u32 s25, s24, 10752
    buffer_store_dwordx4 v[4:7], v148, s[16:19], s25 offen sc1
    s_add_u32 s25, s24, 21504
    buffer_store_dwordx4 v[8:11], v148, s[16:19], s25 offen sc1
    s_add_u32 s25, s24, 32256
    buffer_store_dwordx4 v[12:15], v148, s[16:19], s25 offen sc1
    s_add_u32 s25, s24, 172032
    buffer_store_dwordx4 v[16:19], v148, s[16:19], s25 offen sc1
    s_add_u32 s25, s24, 182784
    buffer_store_dwordx4 v[20:23], v148, s[16:19], s25 offen sc1
    s_add_u32 s25, s24, 193536
    buffer_store_dwordx4 v[24:27], v148, s[16:19], s25 offen sc1
    s_add_u32 s25, s24, 204288
    buffer_store_dwordx4 v[28:31], v148, s[16:19], s25 offen sc1
    s_add_u32 s25, s24, 344064
    buffer_store_dwordx4 v[32:35], v148, s[16:19], s25 offen sc1
    s_add_u32 s25, s24, 354816
    buffer_store_dwordx4 v[36:39], v148, s[16:19], s25 offen sc1
    s_add_u32 s25, s24, 365568
    buffer_store_dwordx4 v[40:43], v148, s[16:19], s25 offen sc1
    s_add_u32 s25, s24, 376320
    buffer_store_dwordx4 v[44:47], v148, s[16:19], s25 offen sc1
    s_add_u32 s25, s24, 516096
    buffer_store_dwordx4 v[48:51], v148, s[16:19], s25 offen sc1
    s_add_u32 s25, s24, 526848
    buffer_store_dwordx4 v[52:55], v148, s[16:19], s25 offen sc1
    s_add_u32 s25, s24, 537600
    buffer_store_dwordx4 v[56:59], v148, s[16:19], s25 offen sc1
    s_add_u32 s25, s24, 548352
    buffer_store_dwordx4 v[60:63], v148, s[16:19], s25 offen sc1
    s_endpgm
L_k12_w:
    s_sub_u32 s12, s2, 672
    s_and_b32 s13, s12, 3
    s_lshr_b32 s14, s12, 2
    s_lshl_b32 s14, s14, 2
    s_add_u32 s14, s14, s10
    s_mov_b32 s20, s6
    s_and_b32 s21, s7, 0xffff
    s_mov_b32 s22, 16252928
    s_mov_b32 s23, 0x00020000
    v_and_b32 v149, 1, v146
    v_lshlrev_b32 v147, 23, v149
    v_lshrrev_b32 v149, 2, v145
    v_lshl_add_u32 v147, v149, 6, v147
    v_and_b32 v149, 1, v145
    v_lshl_add_u32 v147, v149, 5, v147
    v_bfe_u32 v149, v145, 1, 1
    v_lshl_add_u32 v147, v149, 3, v147
    s_lshl_b32 s15, s14, 10
    s_lshl_b32 s24, s13, 8
    s_add_u32 s15, s15, s24
    v_add_u32 v147, s15, v147
    buffer_load_dwordx2 v[0:1], v147, s[20:23], 0 offen
    buffer_load_dwordx2 v[2:3], v147, s[20:23], 0 offen offset:16
    v_add_u32 v149, 1048576, v147
    buffer_load_dwordx2 v[4:5], v149, s[20:23], 0 offen
    buffer_load_dwordx2 v[6:7], v149, s[20:23], 0 offen offset:16
    v_add_u32 v149, 2097152, v147
    buffer_load_dwordx2 v[8:9], v149, s[20:23], 0 offen
    buffer_load_dwordx2 v[10:11], v149, s[20:23], 0 offen offset:16
    v_add_u32 v149, 3145728, v147
    buffer_load_dwordx2 v[12:13], v149, s[20:23], 0 offen
    buffer_load_dwordx2 v[14:15], v149, s[20:23], 0 offen offset:16
    v_add_u32 v149, 4194304, v147
    buffer_load_dwordx2 v[16:17], v149, s[20:23], 0 offen
    buffer_load_dwordx2 v[18:19], v149, s[20:23], 0 offen offset:16
    v_add_u32 v149, 5242880, v147
    buffer_load_dwordx2 v[20:21], v149, s[20:23], 0 offen
    buffer_load_dwordx2 v[22:23], v149, s[20:23], 0 offen offset:16
    v_add_u32 v149, 6291456, v147
    buffer_load_dwordx2 v[24:25], v149, s[20:23], 0 offen
    buffer_load_dwordx2 v[26:27], v149, s[20:23], 0 offen offset:16
    v_add_u32 v149, 7340032, v147
    buffer_load_dwordx2 v[28:29], v149, s[20:23], 0 offen
    buffer_load_dwordx2 v[30:31], v149, s[20:23], 0 offen offset:16
    v_lshrrev_b32 v149, 2, v145
    v_lshlrev_b32 v149, 1, v149
    v_bfe_u32 v150, v145, 1, 1
    v_add_u32 v149, v149, v150
    s_lshl_b32 s24, s10, 3
    v_add_u32 v149, s24, v149
    v_lshl_add_u32 v149, v149, 1, 1
    v_and_b32 v150, 1, v145
    v_lshlrev_b32 v150, 5, v150
    v_and_b32 v151, 1, v146
    v_lshlrev_b32 v151, 3, v151
    v_mad_u32_u24 v96, v149, v151, v150
    v_add_u32 v97, v96, v149
    v_add_u32 v98, v97, v149
    v_add_u32 v99, v98, v149
    v_add_u32 v100, v99, v149
    v_add_u32 v101, v100, v149
    v_add_u32 v102, v101, v149
    v_add_u32 v103, v102, v149
    v_cmp_lt_u32 s[26:27], 1, v146
    v_and_b32 v96, 127, v96
    v_cvt_f32_u32 v96, v96
    v_mul_f32 v96, 0x3c000000, v96
    v_cos_f32 v96, v96
    v_and_b32 v97, 127, v97
    v_cvt_f32_u32 v97, v97
    v_mul_f32 v97, 0x3c000000, v97
    v_cos_f32 v97, v97
    v_and_b32 v98, 127, v98
    v_cvt_f32_u32 v98, v98
    v_mul_f32 v98, 0x3c000000, v98
    v_cos_f32 v98, v98
    v_and_b32 v99, 127, v99
    v_cvt_f32_u32 v99, v99
    v_mul_f32 v99, 0x3c000000, v99
    v_cos_f32 v99, v99
    v_and_b32 v100, 127, v100
    v_cvt_f32_u32 v100, v100
    v_mul_f32 v100, 0x3c000000, v100
    v_cos_f32 v100, v100
    v_and_b32 v101, 127, v101
    v_cvt_f32_u32 v101, v101
    v_mul_f32 v101, 0x3c000000, v101
    v_cos_f32 v101, v101
    v_and_b32 v102, 127, v102
    v_cvt_f32_u32 v102, v102
    v_mul_f32 v102, 0x3c000000, v102
    v_cos_f32 v102, v102
    v_and_b32 v103, 127, v103
    v_cvt_f32_u32 v103, v103
    v_mul_f32 v103, 0x3c000000, v103
    v_cos_f32 v103, v103
    v_cvt_pk_bf16_f32 v112, v96, v97
    v_cvt_pk_bf16_f32 v113, v98, v99
    v_cvt_pk_bf16_f32 v114, v100, v101
    v_cvt_pk_bf16_f32 v115, v102, v103
    v_lshlrev_b32 v116, 16, v112
    v_and_b32 v117, 0xffff0000, v112
    v_sub_f32 v96, v96, v116
    v_sub_f32 v97, v97, v117
    v_cvt_pk_bf16_f32 v116, v96, v97
    v_cndmask_b32 v112, v112, v116, s[26:27]
    v_lshlrev_b32 v116, 16, v113
    v_and_b32 v117, 0xffff0000, v113
    v_sub_f32 v98, v98, v116
    v_sub_f32 v99, v99, v117
    v_cvt_pk_bf16_f32 v116, v98, v99
    v_cndmask_b32 v113, v113, v116, s[26:27]
    v_lshlrev_b32 v116, 16, v114
    v_and_b32 v117, 0xffff0000, v114
    v_sub_f32 v100, v100, v116
    v_sub_f32 v101, v101, v117
    v_cvt_pk_bf16_f32 v116, v100, v101
    v_cndmask_b32 v114, v114, v116, s[26:27]
    v_lshlrev_b32 v116, 16, v115
    v_and_b32 v117, 0xffff0000, v115
    v_sub_f32 v102, v102, v116
    v_sub_f32 v103, v103, v117
    v_cvt_pk_bf16_f32 v116, v102, v103
    v_cndmask_b32 v115, v115, v116, s[26:27]
    s_lshl_b32 s24, s10, 10
    v_lshlrev_b32 v152, 4, v144
    v_add_u32 v152, s24, v152
    ds_write_b128 v152, v[112:115]
    s_waitcnt lgkmcnt(0)
    s_barrier
    v_lshlrev_b32 v152, 4, v144
    ds_read_b128 v[64:67], v152 offset:0
    ds_read_b128 v[68:71], v152 offset:1024
    ds_read_b128 v[72:75], v152 offset:2048
    ds_read_b128 v[76:79], v152 offset:3072
    s_and_b32 s24, s14, 3
    s_bfe_u32 s25, s14, 0x10003
    s_lshl_b32 s25, s25, 2
    s_or_b32 s24, s24, s25
    s_lshl_b32 s24, s24, 1
    v_xor_b32 v149, s24, v145
    v_lshlrev_b32 v149, 4, v149
    s_mov_b32 s25, 32768
    v_mul_u32_u24 v148, s25, v146
    v_add_u32 v148, v148, v149
    s_mul_i32 s24, s13, 16777216
    s_lshr_b32 s25, s14, 5
    s_mul_i32 s25, s25, 524288
    s_add_u32 s24, s24, s25
    s_and_b32 s25, s14, 31
    s_lshl_b32 s25, s25, 8
    s_add_u32 s24, s24, s25
    s_waitcnt vmcnt(0) lgkmcnt(0)
    v_perm_b32 v32, v4, v0, s30
    v_perm_b32 v33, v12, v8, s30
    v_perm_b32 v34, v20, v16, s30
    v_perm_b32 v35, v28, v24, s30
    v_perm_b32 v36, v4, v0, s31
    v_perm_b32 v37, v12, v8, s31
    v_perm_b32 v38, v20, v16, s31
    v_perm_b32 v39, v28, v24, s31
    v_perm_b32 v40, v5, v1, s30
    v_perm_b32 v41, v13, v9, s30
    v_perm_b32 v42, v21, v17, s30
    v_perm_b32 v43, v29, v25, s30
    v_perm_b32 v44, v5, v1, s31
    v_perm_b32 v45, v13, v9, s31
    v_perm_b32 v46, v21, v17, s31
    v_perm_b32 v47, v29, v25, s31
    v_perm_b32 v48, v6, v2, s30
    v_perm_b32 v49, v14, v10, s30
    v_perm_b32 v50, v22, v18, s30
    v_perm_b32 v51, v30, v26, s30
    v_perm_b32 v52, v6, v2, s31
    v_perm_b32 v53, v14, v10, s31
    v_perm_b32 v54, v22, v18, s31
    v_perm_b32 v55, v30, v26, s31
    v_perm_b32 v56, v7, v3, s30
    v_perm_b32 v57, v15, v11, s30
    v_perm_b32 v58, v23, v19, s30
    v_perm_b32 v59, v31, v27, s30
    v_perm_b32 v60, v7, v3, s31
    v_perm_b32 v61, v15, v11, s31
    v_perm_b32 v62, v23, v19, s31
    v_perm_b32 v63, v31, v27, s31
    v_mfma_f32_16x16x32_bf16 v[112:115], v[64:67], v[32:35], 0
    v_mfma_f32_16x16x32_bf16 v[116:119], v[64:67], v[36:39], 0
    v_mfma_f32_16x16x32_bf16 v[120:123], v[64:67], v[40:43], 0
    v_mfma_f32_16x16x32_bf16 v[124:127], v[64:67], v[44:47], 0
    v_mfma_f32_16x16x32_bf16 v[128:131], v[64:67], v[48:51], 0
    v_mfma_f32_16x16x32_bf16 v[132:135], v[64:67], v[52:55], 0
    v_mfma_f32_16x16x32_bf16 v[136:139], v[64:67], v[56:59], 0
    v_mfma_f32_16x16x32_bf16 v[140:143], v[64:67], v[60:63], 0
    s_nop 1
    v_cvt_pk_bf16_f32 v0, v112, v116
    s_nop 0
    v_cvt_pk_bf16_f32 v1, v120, v124
    s_nop 0
    v_cvt_pk_bf16_f32 v2, v128, v132
    s_nop 0
    v_cvt_pk_bf16_f32 v3, v136, v140
    v_cvt_pk_bf16_f32 v4, v113, v117
    v_cvt_pk_bf16_f32 v5, v121, v125
    v_cvt_pk_bf16_f32 v6, v129, v133
    v_cvt_pk_bf16_f32 v7, v137, v141
    v_cvt_pk_bf16_f32 v8, v114, v118
    v_cvt_pk_bf16_f32 v9, v122, v126
    v_cvt_pk_bf16_f32 v10, v130, v134
    v_cvt_pk_bf16_f32 v11, v138, v142
    v_cvt_pk_bf16_f32 v12, v115, v119
    v_cvt_pk_bf16_f32 v13, v123, v127
    v_cvt_pk_bf16_f32 v14, v131, v135
    v_cvt_pk_bf16_f32 v15, v139, v143
    s_add_u32 s25, s24, 0
    buffer_store_dwordx4 v[0:3], v148, s[16:19], s25 offen sc1
    s_add_u32 s25, s24, 8192
    buffer_store_dwordx4 v[4:7], v148, s[16:19], s25 offen sc1
    s_add_u32 s25, s24, 16384
    buffer_store_dwordx4 v[8:11], v148, s[16:19], s25 offen sc1
    s_add_u32 s25, s24, 24576
    buffer_store_dwordx4 v[12:15], v148, s[16:19], s25 offen sc1
    v_mfma_f32_16x16x32_bf16 v[112:115], v[68:71], v[32:35], 0
    v_mfma_f32_16x16x32_bf16 v[116:119], v[68:71], v[36:39], 0
    v_mfma_f32_16x16x32_bf16 v[120:123], v[68:71], v[40:43], 0
    v_mfma_f32_16x16x32_bf16 v[124:127], v[68:71], v[44:47], 0
    v_mfma_f32_16x16x32_bf16 v[128:131], v[68:71], v[48:51], 0
    v_mfma_f32_16x16x32_bf16 v[132:135], v[68:71], v[52:55], 0
    v_mfma_f32_16x16x32_bf16 v[136:139], v[68:71], v[56:59], 0
    v_mfma_f32_16x16x32_bf16 v[140:143], v[68:71], v[60:63], 0
    s_nop 1
    v_cvt_pk_bf16_f32 v16, v112, v116
    s_nop 0
    v_cvt_pk_bf16_f32 v17, v120, v124
    s_nop 0
    v_cvt_pk_bf16_f32 v18, v128, v132
    s_nop 0
    v_cvt_pk_bf16_f32 v19, v136, v140
    v_cvt_pk_bf16_f32 v20, v113, v117
    v_cvt_pk_bf16_f32 v21, v121, v125
    v_cvt_pk_bf16_f32 v22, v129, v133
    v_cvt_pk_bf16_f32 v23, v137, v141
    v_cvt_pk_bf16_f32 v24, v114, v118
    v_cvt_pk_bf16_f32 v25, v122, v126
    v_cvt_pk_bf16_f32 v26, v130, v134
    v_cvt_pk_bf16_f32 v27, v138, v142
    v_cvt_pk_bf16_f32 v28, v115, v119
    v_cvt_pk_bf16_f32 v29, v123, v127
    v_cvt_pk_bf16_f32 v30, v131, v135
    v_cvt_pk_bf16_f32 v31, v139, v143
    s_add_u32 s25, s24, 131072
    buffer_store_dwordx4 v[16:19], v148, s[16:19], s25 offen sc1
    s_add_u32 s25, s24, 139264
    buffer_store_dwordx4 v[20:23], v148, s[16:19], s25 offen sc1
    s_add_u32 s25, s24, 147456
    buffer_store_dwordx4 v[24:27], v148, s[16:19], s25 offen sc1
    s_add_u32 s25, s24, 155648
    buffer_store_dwordx4 v[28:31], v148, s[16:19], s25 offen sc1
    v_mfma_f32_16x16x32_bf16 v[112:115], v[72:75], v[32:35], 0
    v_mfma_f32_16x16x32_bf16 v[116:119], v[72:75], v[36:39], 0
    v_mfma_f32_16x16x32_bf16 v[120:123], v[72:75], v[40:43], 0
    v_mfma_f32_16x16x32_bf16 v[124:127], v[72:75], v[44:47], 0
    v_mfma_f32_16x16x32_bf16 v[128:131], v[72:75], v[48:51], 0
    v_mfma_f32_16x16x32_bf16 v[132:135], v[72:75], v[52:55], 0
    v_mfma_f32_16x16x32_bf16 v[136:139], v[72:75], v[56:59], 0
    v_mfma_f32_16x16x32_bf16 v[140:143], v[72:75], v[60:63], 0
    s_nop 1
    v_cvt_pk_bf16_f32 v0, v112, v116
    s_nop 0
    v_cvt_pk_bf16_f32 v1, v120, v124
    s_nop 0
    v_cvt_pk_bf16_f32 v2, v128, v132
    s_nop 0
    v_cvt_pk_bf16_f32 v3, v136, v140
    v_cvt_pk_bf16_f32 v4, v113, v117
    v_cvt_pk_bf16_f32 v5, v121, v125
    v_cvt_pk_bf16_f32 v6, v129, v133
    v_cvt_pk_bf16_f32 v7, v137, v141
    v_cvt_pk_bf16_f32 v8, v114, v118
    v_cvt_pk_bf16_f32 v9, v122, v126
    v_cvt_pk_bf16_f32 v10, v130, v134
    v_cvt_pk_bf16_f32 v11, v138, v142
    v_cvt_pk_bf16_f32 v12, v115, v119
    v_cvt_pk_bf16_f32 v13, v123, v127
    v_cvt_pk_bf16_f32 v14, v131, v135
    v_cvt_pk_bf16_f32 v15, v139, v143
    s_add_u32 s25, s24, 262144
    buffer_store_dwordx4 v[0:3], v148, s[16:19], s25 offen sc1
    s_add_u32 s25, s24, 270336
    buffer_store_dwordx4 v[4:7], v148, s[16:19], s25 offen sc1
    s_add_u32 s25, s24, 278528
    buffer_store_dwordx4 v[8:11], v148, s[16:19], s25 offen sc1
    s_add_u32 s25, s24, 286720
    buffer_store_dwordx4 v[12:15], v148, s[16:19], s25 offen sc1
    v_mfma_f32_16x16x32_bf16 v[112:115], v[76:79], v[32:35], 0
    v_mfma_f32_16x16x32_bf16 v[116:119], v[76:79], v[36:39], 0
    v_mfma_f32_16x16x32_bf16 v[120:123], v[76:79], v[40:43], 0
    v_mfma_f32_16x16x32_bf16 v[124:127], v[76:79], v[44:47], 0
    v_mfma_f32_16x16x32_bf16 v[128:131], v[76:79], v[48:51], 0
    v_mfma_f32_16x16x32_bf16 v[132:135], v[76:79], v[52:55], 0
    v_mfma_f32_16x16x32_bf16 v[136:139], v[76:79], v[56:59], 0
    v_mfma_f32_16x16x32_bf16 v[140:143], v[76:79], v[60:63], 0
    s_nop 1
    v_cvt_pk_bf16_f32 v16, v112, v116
    s_nop 0
    v_cvt_pk_bf16_f32 v17, v120, v124
    s_nop 0
    v_cvt_pk_bf16_f32 v18, v128, v132
    s_nop 0
    v_cvt_pk_bf16_f32 v19, v136, v140
    v_cvt_pk_bf16_f32 v20, v113, v117
    v_cvt_pk_bf16_f32 v21, v121, v125
    v_cvt_pk_bf16_f32 v22, v129, v133
    v_cvt_pk_bf16_f32 v23, v137, v141
    v_cvt_pk_bf16_f32 v24, v114, v118
    v_cvt_pk_bf16_f32 v25, v122, v126
    v_cvt_pk_bf16_f32 v26, v130, v134
    v_cvt_pk_bf16_f32 v27, v138, v142
    v_cvt_pk_bf16_f32 v28, v115, v119
    v_cvt_pk_bf16_f32 v29, v123, v127
    v_cvt_pk_bf16_f32 v30, v131, v135
    v_cvt_pk_bf16_f32 v31, v139, v143
    s_add_u32 s25, s24, 393216
    buffer_store_dwordx4 v[16:19], v148, s[16:19], s25 offen sc1
    s_add_u32 s25, s24, 401408
    buffer_store_dwordx4 v[20:23], v148, s[16:19], s25 offen sc1
    s_add_u32 s25, s24, 409600
    buffer_store_dwordx4 v[24:27], v148, s[16:19], s25 offen sc1
    s_add_u32 s25, s24, 417792
    buffer_store_dwordx4 v[28:31], v148, s[16:19], s25 offen sc1
L_k12_end:
    s_endpgm
.globl gemm_kernel
.p2align 8
.type gemm_kernel,@function
gemm_kernel:
    s_cmp_ge_u32 s2, 256
    s_cbranch_scc1 L_k3_end
    s_load_dwordx2 s[8:9], s[0:1], 48
    v_lshrrev_b32 v253, 6, v0
    v_and_b32 v0, 63, v0
    v_readfirstlane_b32 s10, v253
    s_and_b32 s11, s2, 7
    s_lshr_b32 s12, s2, 3
    s_lshr_b32 s13, s12, 3
    s_lshl_b32 s11, s11, 2
    s_add_u32 s11, s11, s13
    s_bfe_u32 s13, s12, 0x10002
    s_and_b32 s14, s12, 3
    s_and_b32 s15, s10, 3
    s_waitcnt lgkmcnt(0)
    s_mov_b32 s16, s8
    s_and_b32 s17, s9, 0xffff
    s_mov_b32 s18, 268435456
    s_mov_b32 s19, 0x00020000
    s_cmp_ge_u32 s10, 4
    s_cbranch_scc1 L_k3_helper
    v_lshrrev_b32 v253, 4, v0
    v_and_b32 v254, 15, v0
    v_bfe_u32 v255, v254, 3, 1
    v_mul_u32_u24 v255, 3, v255
    v_xor_b32 v255, v255, v253
    v_lshlrev_b32 v255, 4, v255
    v_lshl_add_u32 v250, v254, 6, v255
    v_lshrrev_b32 v255, 2, v254
    v_and_b32 v216, 1, v253
    v_lshl_or_b32 v216, v216, 2, v255
    v_lshl_add_u32 v255, v253, 3, v255
    v_lshlrev_b32 v255, 8, v255
    v_and_b32 v217, 3, v254
    v_lshl_add_u32 v255, v217, 3, v255
    s_lshl_b32 s20, s15, 1
    v_xor_b32 v217, s20, v216
    v_lshl_add_u32 v248, v217, 5, v255
    s_add_u32 s20, s20, 1
    v_xor_b32 v217, s20, v216
    v_lshl_add_u32 v249, v217, 5, v255
    s_mov_b32 s21, 65792
    v_mul_u32_u24 v251, s21, v254
    v_lshl_add_u32 v251, v253, 4, v251
    s_lshl_b32 s20, s15, 6
    v_add_u32 v251, s20, v251
    v_cmp_gt_u32 vcc, 7, v254
    v_mov_b32 v252, 0x80000000
    s_nop 0
    v_cndmask_b32 v252, v252, v251, vcc
    s_mul_i32 s48, s11, 2048
    s_mul_i32 s20, s13, 11579392
    s_add_u32 s48, s48, s20
    s_lshl_b32 s20, s14, 8
    s_add_u32 s48, s48, s20
    s_add_u32 s48, s48, 117440512
    v_mov_b32 v0, 0
    v_mov_b32 v1, 0
    v_mov_b32 v2, 0
    v_mov_b32 v3, 0
    v_mov_b32 v4, 0
    v_mov_b32 v5, 0
    v_mov_b32 v6, 0
    v_mov_b32 v7, 0
    v_mov_b32 v8, 0
    v_mov_b32 v9, 0
    v_mov_b32 v10, 0
    v_mov_b32 v11, 0
    v_mov_b32 v12, 0
    v_mov_b32 v13, 0
    v_mov_b32 v14, 0
    v_mov_b32 v15, 0
    v_mov_b32 v16, 0
    v_mov_b32 v17, 0
    v_mov_b32 v18, 0
    v_mov_b32 v19, 0
    v_mov_b32 v20, 0
    v_mov_b32 v21, 0
    v_mov_b32 v22, 0
    v_mov_b32 v23, 0
    v_mov_b32 v24, 0
    v_mov_b32 v25, 0
    v_mov_b32 v26, 0
    v_mov_b32 v27, 0
    v_mov_b32 v28, 0
    v_mov_b32 v29, 0
    v_mov_b32 v30, 0
    v_mov_b32 v31, 0
    v_mov_b32 v32, 0
    v_mov_b32 v33, 0
    v_mov_b32 v34, 0
    v_mov_b32 v35, 0
    v_mov_b32 v36, 0
    v_mov_b32 v37, 0
    v_mov_b32 v38, 0
    v_mov_b32 v39, 0
    v_mov_b32 v40, 0
    v_mov_b32 v41, 0
    v_mov_b32 v42, 0
    v_mov_b32 v43, 0
    v_mov_b32 v44, 0
    v_mov_b32 v45, 0
    v_mov_b32 v46, 0
    v_mov_b32 v47, 0
    v_mov_b32 v48, 0
    v_mov_b32 v49, 0
    v_mov_b32 v50, 0
    v_mov_b32 v51, 0
    v_mov_b32 v52, 0
    v_mov_b32 v53, 0
    v_mov_b32 v54, 0
    v_mov_b32 v55, 0
    v_mov_b32 v56, 0
    v_mov_b32 v57, 0
    v_mov_b32 v58, 0
    v_mov_b32 v59, 0
    v_mov_b32 v60, 0
    v_mov_b32 v61, 0
    v_mov_b32 v62, 0
    v_mov_b32 v63, 0
    v_mov_b32 v64, 0
    v_mov_b32 v65, 0
    v_mov_b32 v66, 0
    v_mov_b32 v67, 0
    v_mov_b32 v68, 0
    v_mov_b32 v69, 0
    v_mov_b32 v70, 0
    v_mov_b32 v71, 0
    v_mov_b32 v72, 0
    v_mov_b32 v73, 0
    v_mov_b32 v74, 0
    v_mov_b32 v75, 0
    v_mov_b32 v76, 0
    v_mov_b32 v77, 0
    v_mov_b32 v78, 0
    v_mov_b32 v79, 0
    v_mov_b32 v80, 0
    v_mov_b32 v81, 0
    v_mov_b32 v82, 0
    v_mov_b32 v83, 0
    v_mov_b32 v84, 0
    v_mov_b32 v85, 0
    v_mov_b32 v86, 0
    v_mov_b32 v87, 0
    v_mov_b32 v88, 0
    v_mov_b32 v89, 0
    v_mov_b32 v90, 0
    v_mov_b32 v91, 0
    v_mov_b32 v92, 0
    v_mov_b32 v93, 0
    v_mov_b32 v94, 0
    v_mov_b32 v95, 0
    v_mov_b32 v96, 0
    v_mov_b32 v97, 0
    v_mov_b32 v98, 0
    v_mov_b32 v99, 0
    v_mov_b32 v100, 0
    v_mov_b32 v101, 0
    v_mov_b32 v102, 0
    v_mov_b32 v103, 0
    v_mov_b32 v104, 0
    v_mov_b32 v105, 0
    v_mov_b32 v106, 0
    v_mov_b32 v107, 0
    v_mov_b32 v108, 0
    v_mov_b32 v109, 0
    v_mov_b32 v110, 0
    v_mov_b32 v111, 0
    v_mov_b32 v112, 0
    v_mov_b32 v113, 0
    v_mov_b32 v114, 0
    v_mov_b32 v115, 0
    v_mov_b32 v116, 0
    v_mov_b32 v117, 0
    v_mov_b32 v118, 0
    v_mov_b32 v119, 0
    v_mov_b32 v120, 0
    v_mov_b32 v121, 0
    v_mov_b32 v122, 0
    v_mov_b32 v123, 0
    v_mov_b32 v124, 0
    v_mov_b32 v125, 0
    v_mov_b32 v126, 0
    v_mov_b32 v127, 0
    v_mov_b32 v128, 0
    v_mov_b32 v129, 0
    v_mov_b32 v130, 0
    v_mov_b32 v131, 0
    v_mov_b32 v132, 0
    v_mov_b32 v133, 0
    v_mov_b32 v134, 0
    v_mov_b32 v135, 0
    v_mov_b32 v136, 0
    v_mov_b32 v137, 0
    v_mov_b32 v138, 0
    v_mov_b32 v139, 0
    v_mov_b32 v140, 0
    v_mov_b32 v141, 0
    v_mov_b32 v142, 0
    v_mov_b32 v143, 0
    v_mov_b32 v144, 0
    v_mov_b32 v145, 0
    v_mov_b32 v146, 0
    v_mov_b32 v147, 0
    v_mov_b32 v148, 0
    v_mov_b32 v149, 0
    v_mov_b32 v150, 0
    v_mov_b32 v151, 0
    v_mov_b32 v152, 0
    v_mov_b32 v153, 0
    v_mov_b32 v154, 0
    v_mov_b32 v155, 0
    v_mov_b32 v156, 0
    v_mov_b32 v157, 0
    v_mov_b32 v158, 0
    v_mov_b32 v159, 0
    v_mov_b32 v160, 0
    v_mov_b32 v161, 0
    v_mov_b32 v162, 0
    v_mov_b32 v163, 0
    v_mov_b32 v164, 0
    v_mov_b32 v165, 0
    v_mov_b32 v166, 0
    v_mov_b32 v167, 0
    v_mov_b32 v168, 0
    v_mov_b32 v169, 0
    v_mov_b32 v170, 0
    v_mov_b32 v171, 0
    v_mov_b32 v172, 0
    v_mov_b32 v173, 0
    v_mov_b32 v174, 0
    v_mov_b32 v175, 0
    s_barrier
    ds_read_b64_tr_b16 v[176:177], v248 offset:0
    ds_read_b64_tr_b16 v[178:179], v248 offset:1024
    ds_read_b64_tr_b16 v[180:181], v249 offset:0
    ds_read_b64_tr_b16 v[182:183], v249 offset:1024
    ds_read_b64_tr_b16 v[184:185], v248 offset:8192
    ds_read_b64_tr_b16 v[186:187], v248 offset:9216
    ds_read_b64_tr_b16 v[188:189], v249 offset:8192
    ds_read_b64_tr_b16 v[190:191], v249 offset:9216
    ds_read_b128 v[216:219], v250 offset:16384
    ds_read_b128 v[220:223], v250 offset:27136
    ds_read_b128 v[224:227], v250 offset:17408
    ds_read_b128 v[228:231], v250 offset:28160
    s_waitcnt lgkmcnt(4)
    v_xor_b32 v208, 0x80008000, v184
    v_xor_b32 v209, 0x80008000, v185
    v_xor_b32 v210, 0x80008000, v186
    v_xor_b32 v211, 0x80008000, v187
    v_xor_b32 v212, 0x80008000, v188
    v_xor_b32 v213, 0x80008000, v189
    v_xor_b32 v214, 0x80008000, v190
    v_xor_b32 v215, 0x80008000, v191
    s_mov_b32 s46, 7
L_g_loop:
    s_barrier
    s_waitcnt lgkmcnt(2)
    v_mfma_f32_16x16x32_bf16 v[0:3], v[176:179], v[216:219], v[0:3]
    ds_read_b128 v[232:235], v250 offset:18432
    ds_read_b128 v[236:239], v250 offset:29184
    v_mfma_f32_16x16x32_bf16 v[4:7], v[180:183], v[216:219], v[4:7]
    v_mfma_f32_16x16x32_bf16 v[8:11], v[208:211], v[216:219], v[8:11]
    v_mfma_f32_16x16x32_bf16 v[12:15], v[212:215], v[216:219], v[12:15]
    v_mfma_f32_16x16x32_bf16 v[0:3], v[184:187], v[220:223], v[0:3]
    v_mfma_f32_16x16x32_bf16 v[4:7], v[188:191], v[220:223], v[4:7]
    v_mfma_f32_16x16x32_bf16 v[8:11], v[176:179], v[220:223], v[8:11]
    v_mfma_f32_16x16x32_bf16 v[12:15], v[180:183], v[220:223], v[12:15]
    s_waitcnt lgkmcnt(2)
    v_mfma_f32_16x16x32_bf16 v[16:19], v[176:179], v[224:227], v[16:19]
    ds_read_b128 v[240:243], v250 offset:19456
    ds_read_b128 v[244:247], v250 offset:30208
    v_mfma_f32_16x16x32_bf16 v[20:23], v[180:183], v[224:227], v[20:23]
    v_mfma_f32_16x16x32_bf16 v[24:27], v[208:211], v[224:227], v[24:27]
    v_mfma_f32_16x16x32_bf16 v[28:31], v[212:215], v[224:227], v[28:31]
    v_mfma_f32_16x16x32_bf16 v[16:19], v[184:187], v[228:231], v[16:19]
    v_mfma_f32_16x16x32_bf16 v[20:23], v[188:191], v[228:231], v[20:23]
    v_mfma_f32_16x16x32_bf16 v[24:27], v[176:179], v[228:231], v[24:27]
    v_mfma_f32_16x16x32_bf16 v[28:31], v[180:183], v[228:231], v[28:31]
    s_waitcnt lgkmcnt(2)
    v_mfma_f32_16x16x32_bf16 v[32:35], v[176:179], v[232:235], v[32:35]
    ds_read_b128 v[216:219], v250 offset:20480
    ds_read_b128 v[220:223], v250 offset:31232
    v_mfma_f32_16x16x32_bf16 v[36:39], v[180:183], v[232:235], v[36:39]
    v_mfma_f32_16x16x32_bf16 v[40:43], v[208:211], v[232:235], v[40:43]
    v_mfma_f32_16x16x32_bf16 v[44:47], v[212:215], v[232:235], v[44:47]
    v_mfma_f32_16x16x32_bf16 v[32:35], v[184:187], v[236:239], v[32:35]
    v_mfma_f32_16x16x32_bf16 v[36:39], v[188:191], v[236:239], v[36:39]
    v_mfma_f32_16x16x32_bf16 v[40:43], v[176:179], v[236:239], v[40:43]
    v_mfma_f32_16x16x32_bf16 v[44:47], v[180:183], v[236:239], v[44:47]
    s_waitcnt lgkmcnt(2)
    v_mfma_f32_16x16x32_bf16 v[48:51], v[176:179], v[240:243], v[48:51]
    ds_read_b128 v[224:227], v250 offset:21504
    ds_read_b128 v[228:231], v250 offset:32256
    v_mfma_f32_16x16x32_bf16 v[52:55], v[180:183], v[240:243], v[52:55]
    v_mfma_f32_16x16x32_bf16 v[56:59], v[208:211], v[240:243], v[56:59]
    v_mfma_f32_16x16x32_bf16 v[60:63], v[212:215], v[240:243], v[60:63]
    v_mfma_f32_16x16x32_bf16 v[48:51], v[184:187], v[244:247], v[48:51]
    v_mfma_f32_16x16x32_bf16 v[52:55], v[188:191], v[244:247], v[52:55]
    v_mfma_f32_16x16x32_bf16 v[56:59], v[176:179], v[244:247], v[56:59]
    v_mfma_f32_16x16x32_bf16 v[60:63], v[180:183], v[244:247], v[60:63]
    s_waitcnt lgkmcnt(2)
    v_mfma_f32_16x16x32_bf16 v[64:67], v[176:179], v[216:219], v[64:67]
    ds_read_b128 v[232:235], v250 offset:22528
    ds_read_b128 v[236:239], v250 offset:33280
    v_mfma_f32_16x16x32_bf16 v[68:71], v[180:183], v[216:219], v[68:71]
    v_mfma_f32_16x16x32_bf16 v[72:75], v[208:211], v[216:219], v[72:75]
    v_mfma_f32_16x16x32_bf16 v[76:79], v[212:215], v[216:219], v[76:79]
    v_mfma_f32_16x16x32_bf16 v[64:67], v[184:187], v[220:223], v[64:67]
    v_mfma_f32_16x16x32_bf16 v[68:71], v[188:191], v[220:223], v[68:71]
    v_mfma_f32_16x16x32_bf16 v[72:75], v[176:179], v[220:223], v[72:75]
    v_mfma_f32_16x16x32_bf16 v[76:79], v[180:183], v[220:223], v[76:79]
    s_waitcnt lgkmcnt(2)
    v_mfma_f32_16x16x32_bf16 v[80:83], v[176:179], v[224:227], v[80:83]
    ds_read_b128 v[240:243], v250 offset:23552
    ds_read_b128 v[244:247], v250 offset:34304
    v_mfma_f32_16x16x32_bf16 v[84:87], v[180:183], v[224:227], v[84:87]
    v_mfma_f32_16x16x32_bf16 v[88:91], v[208:211], v[224:227], v[88:91]
    v_mfma_f32_16x16x32_bf16 v[92:95], v[212:215], v[224:227], v[92:95]
    v_mfma_f32_16x16x32_bf16 v[80:83], v[184:187], v[228:231], v[80:83]
    v_mfma_f32_16x16x32_bf16 v[84:87], v[188:191], v[228:231], v[84:87]
    v_mfma_f32_16x16x32_bf16 v[88:91], v[176:179], v[228:231], v[88:91]
    v_mfma_f32_16x16x32_bf16 v[92:95], v[180:183], v[228:231], v[92:95]
    s_waitcnt lgkmcnt(2)
    v_mfma_f32_16x16x32_bf16 v[96:99], v[176:179], v[232:235], v[96:99]
    ds_read_b128 v[216:219], v250 offset:24576
    ds_read_b128 v[220:223], v250 offset:35328
    v_mfma_f32_16x16x32_bf16 v[100:103], v[180:183], v[232:235], v[100:103]
    v_mfma_f32_16x16x32_bf16 v[104:107], v[208:211], v[232:235], v[104:107]
    v_mfma_f32_16x16x32_bf16 v[108:111], v[212:215], v[232:235], v[108:111]
    v_mfma_f32_16x16x32_bf16 v[96:99], v[184:187], v[236:239], v[96:99]
    v_add_u32 v248, 0x9400, v248
    v_add_u32 v249, 0x9400, v249
    v_mfma_f32_16x16x32_bf16 v[100:103], v[188:191], v[236:239], v[100:103]
    v_mfma_f32_16x16x32_bf16 v[104:107], v[176:179], v[236:239], v[104:107]
    v_mfma_f32_16x16x32_bf16 v[108:111], v[180:183], v[236:239], v[108:111]
    s_waitcnt lgkmcnt(2)
    v_mfma_f32_16x16x32_bf16 v[112:115], v[176:179], v[240:243], v[112:115]
    ds_read_b128 v[224:227], v250 offset:25600
    ds_read_b128 v[228:231], v250 offset:36352
    v_mfma_f32_16x16x32_bf16 v[116:119], v[180:183], v[240:243], v[116:119]
    v_mfma_f32_16x16x32_bf16 v[120:123], v[208:211], v[240:243], v[120:123]
    v_mfma_f32_16x16x32_bf16 v[124:127], v[212:215], v[240:243], v[124:127]
    ds_read_b64_tr_b16 v[192:193], v248 offset:0
    ds_read_b64_tr_b16 v[194:195], v248 offset:1024
    ds_read_b64_tr_b16 v[196:197], v249 offset:0
    ds_read_b64_tr_b16 v[198:199], v249 offset:1024
    v_mfma_f32_16x16x32_bf16 v[112:115], v[184:187], v[244:247], v[112:115]
    v_mfma_f32_16x16x32_bf16 v[116:119], v[188:191], v[244:247], v[116:119]
    v_mfma_f32_16x16x32_bf16 v[120:123], v[176:179], v[244:247], v[120:123]
    v_mfma_f32_16x16x32_bf16 v[124:127], v[180:183], v[244:247], v[124:127]
    s_waitcnt lgkmcnt(6)
    v_mfma_f32_16x16x32_bf16 v[128:131], v[176:179], v[216:219], v[128:131]
    ds_read_b128 v[232:235], v250 offset:26624
    ds_read_b128 v[236:239], v250 offset:37376
    v_mfma_f32_16x16x32_bf16 v[132:135], v[180:183], v[216:219], v[132:135]
    v_mfma_f32_16x16x32_bf16 v[136:139], v[208:211], v[216:219], v[136:139]
    v_mfma_f32_16x16x32_bf16 v[140:143], v[212:215], v[216:219], v[140:143]
    ds_read_b64_tr_b16 v[200:201], v248 offset:8192
    ds_read_b64_tr_b16 v[202:203], v248 offset:9216
    ds_read_b64_tr_b16 v[204:205], v249 offset:8192
    ds_read_b64_tr_b16 v[206:207], v249 offset:9216
    v_mfma_f32_16x16x32_bf16 v[128:131], v[184:187], v[220:223], v[128:131]
    v_mfma_f32_16x16x32_bf16 v[132:135], v[188:191], v[220:223], v[132:135]
    v_mfma_f32_16x16x32_bf16 v[136:139], v[176:179], v[220:223], v[136:139]
    v_mfma_f32_16x16x32_bf16 v[140:143], v[180:183], v[220:223], v[140:143]
    s_waitcnt lgkmcnt(10)
    v_mfma_f32_16x16x32_bf16 v[144:147], v[176:179], v[224:227], v[144:147]
    v_add_u32 v250, 0x9400, v250
    ds_read_b128 v[240:243], v250 offset:16384
    ds_read_b128 v[244:247], v250 offset:27136
    v_mfma_f32_16x16x32_bf16 v[148:151], v[180:183], v[224:227], v[148:151]
    v_mfma_f32_16x16x32_bf16 v[152:155], v[208:211], v[224:227], v[152:155]
    v_mfma_f32_16x16x32_bf16 v[156:159], v[212:215], v[224:227], v[156:159]
    v_mfma_f32_16x16x32_bf16 v[144:147], v[184:187], v[228:231], v[144:147]
    v_mfma_f32_16x16x32_bf16 v[148:151], v[188:191], v[228:231], v[148:151]
    v_mfma_f32_16x16x32_bf16 v[152:155], v[176:179], v[228:231], v[152:155]
    v_mfma_f32_16x16x32_bf16 v[156:159], v[180:183], v[228:231], v[156:159]
    s_waitcnt lgkmcnt(6)
    v_mfma_f32_16x16x32_bf16 v[160:163], v[176:179], v[232:235], v[160:163]
    ds_read_b128 v[216:219], v250 offset:17408
    ds_read_b128 v[220:223], v250 offset:28160
    v_mfma_f32_16x16x32_bf16 v[164:167], v[180:183], v[232:235], v[164:167]
    v_mfma_f32_16x16x32_bf16 v[168:171], v[208:211], v[232:235], v[168:171]
    v_mfma_f32_16x16x32_bf16 v[172:175], v[212:215], v[232:235], v[172:175]
    s_waitcnt lgkmcnt(4)
    v_xor_b32 v208, 0x80008000, v200
    v_xor_b32 v209, 0x80008000, v201
    v_mfma_f32_16x16x32_bf16 v[160:163], v[184:187], v[236:239], v[160:163]
    v_xor_b32 v210, 0x80008000, v202
    v_xor_b32 v211, 0x80008000, v203
    v_mfma_f32_16x16x32_bf16 v[164:167], v[188:191], v[236:239], v[164:167]
    v_xor_b32 v212, 0x80008000, v204
    v_xor_b32 v213, 0x80008000, v205
    v_mfma_f32_16x16x32_bf16 v[168:171], v[176:179], v[236:239], v[168:171]
    v_xor_b32 v214, 0x80008000, v206
    v_xor_b32 v215, 0x80008000, v207
    v_mfma_f32_16x16x32_bf16 v[172:175], v[180:183], v[236:239], v[172:175]
    s_barrier
    s_waitcnt lgkmcnt(2)
    v_mfma_f32_16x16x32_bf16 v[0:3], v[192:195], v[240:243], v[0:3]
    ds_read_b128 v[224:227], v250 offset:18432
    ds_read_b128 v[228:231], v250 offset:29184
    v_mfma_f32_16x16x32_bf16 v[4:7], v[196:199], v[240:243], v[4:7]
    v_mfma_f32_16x16x32_bf16 v[8:11], v[208:211], v[240:243], v[8:11]
    v_mfma_f32_16x16x32_bf16 v[12:15], v[212:215], v[240:243], v[12:15]
    v_mfma_f32_16x16x32_bf16 v[0:3], v[200:203], v[244:247], v[0:3]
    v_mfma_f32_16x16x32_bf16 v[4:7], v[204:207], v[244:247], v[4:7]
    v_mfma_f32_16x16x32_bf16 v[8:11], v[192:195], v[244:247], v[8:11]
    v_mfma_f32_16x16x32_bf16 v[12:15], v[196:199], v[244:247], v[12:15]
    s_waitcnt lgkmcnt(2)
    v_mfma_f32_16x16x32_bf16 v[16:19], v[192:195], v[216:219], v[16:19]
    ds_read_b128 v[232:235], v250 offset:19456
    ds_read_b128 v[236:239], v250 offset:30208
    v_mfma_f32_16x16x32_bf16 v[20:23], v[196:199], v[216:219], v[20:23]
    v_mfma_f32_16x16x32_bf16 v[24:27], v[208:211], v[216:219], v[24:27]
    v_mfma_f32_16x16x32_bf16 v[28:31], v[212:215], v[216:219], v[28:31]
    v_mfma_f32_16x16x32_bf16 v[16:19], v[200:203], v[220:223], v[16:19]
    v_mfma_f32_16x16x32_bf16 v[20:23], v[204:207], v[220:223], v[20:23]
    v_mfma_f32_16x16x32_bf16 v[24:27], v[192:195], v[220:223], v[24:27]
    v_mfma_f32_16x16x32_bf16 v[28:31], v[196:199], v[220:223], v[28:31]
    s_waitcnt lgkmcnt(2)
    v_mfma_f32_16x16x32_bf16 v[32:35], v[192:195], v[224:227], v[32:35]
    ds_read_b128 v[240:243], v250 offset:20480
    ds_read_b128 v[244:247], v250 offset:31232
    v_mfma_f32_16x16x32_bf16 v[36:39], v[196:199], v[224:227], v[36:39]
    v_mfma_f32_16x16x32_bf16 v[40:43], v[208:211], v[224:227], v[40:43]
    v_mfma_f32_16x16x32_bf16 v[44:47], v[212:215], v[224:227], v[44:47]
    v_mfma_f32_16x16x32_bf16 v[32:35], v[200:203], v[228:231], v[32:35]
    v_mfma_f32_16x16x32_bf16 v[36:39], v[204:207], v[228:231], v[36:39]
    v_mfma_f32_16x16x32_bf16 v[40:43], v[192:195], v[228:231], v[40:43]
    v_mfma_f32_16x16x32_bf16 v[44:47], v[196:199], v[228:231], v[44:47]
    s_waitcnt lgkmcnt(2)
    v_mfma_f32_16x16x32_bf16 v[48:51], v[192:195], v[232:235], v[48:51]
    ds_read_b128 v[216:219], v250 offset:21504
    ds_read_b128 v[220:223], v250 offset:32256
    v_mfma_f32_16x16x32_bf16 v[52:55], v[196:199], v[232:235], v[52:55]
    v_mfma_f32_16x16x32_bf16 v[56:59], v[208:211], v[232:235], v[56:59]
    v_mfma_f32_16x16x32_bf16 v[60:63], v[212:215], v[232:235], v[60:63]
    v_mfma_f32_16x16x32_bf16 v[48:51], v[200:203], v[236:239], v[48:51]
    v_mfma_f32_16x16x32_bf16 v[52:55], v[204:207], v[236:239], v[52:55]
    v_mfma_f32_16x16x32_bf16 v[56:59], v[192:195], v[236:239], v[56:59]
    v_mfma_f32_16x16x32_bf16 v[60:63], v[196:199], v[236:239], v[60:63]
    s_waitcnt lgkmcnt(2)
    v_mfma_f32_16x16x32_bf16 v[64:67], v[192:195], v[240:243], v[64:67]
    ds_read_b128 v[224:227], v250 offset:22528
    ds_read_b128 v[228:231], v250 offset:33280
    v_mfma_f32_16x16x32_bf16 v[68:71], v[196:199], v[240:243], v[68:71]
    v_mfma_f32_16x16x32_bf16 v[72:75], v[208:211], v[240:243], v[72:75]
    v_mfma_f32_16x16x32_bf16 v[76:79], v[212:215], v[240:243], v[76:79]
    v_mfma_f32_16x16x32_bf16 v[64:67], v[200:203], v[244:247], v[64:67]
    v_mfma_f32_16x16x32_bf16 v[68:71], v[204:207], v[244:247], v[68:71]
    v_mfma_f32_16x16x32_bf16 v[72:75], v[192:195], v[244:247], v[72:75]
    v_mfma_f32_16x16x32_bf16 v[76:79], v[196:199], v[244:247], v[76:79]
    s_waitcnt lgkmcnt(2)
    v_mfma_f32_16x16x32_bf16 v[80:83], v[192:195], v[216:219], v[80:83]
    ds_read_b128 v[232:235], v250 offset:23552
    ds_read_b128 v[236:239], v250 offset:34304
    v_mfma_f32_16x16x32_bf16 v[84:87], v[196:199], v[216:219], v[84:87]
    v_mfma_f32_16x16x32_bf16 v[88:91], v[208:211], v[216:219], v[88:91]
    v_mfma_f32_16x16x32_bf16 v[92:95], v[212:215], v[216:219], v[92:95]
    v_mfma_f32_16x16x32_bf16 v[80:83], v[200:203], v[220:223], v[80:83]
    v_mfma_f32_16x16x32_bf16 v[84:87], v[204:207], v[220:223], v[84:87]
    v_mfma_f32_16x16x32_bf16 v[88:91], v[192:195], v[220:223], v[88:91]
    v_mfma_f32_16x16x32_bf16 v[92:95], v[196:199], v[220:223], v[92:95]
    s_waitcnt lgkmcnt(2)
    v_mfma_f32_16x16x32_bf16 v[96:99], v[192:195], v[224:227], v[96:99]
    ds_read_b128 v[240:243], v250 offset:24576
    ds_read_b128 v[244:247], v250 offset:35328
    v_mfma_f32_16x16x32_bf16 v[100:103], v[196:199], v[224:227], v[100:103]
    v_mfma_f32_16x16x32_bf16 v[104:107], v[208:211], v[224:227], v[104:107]
    v_mfma_f32_16x16x32_bf16 v[108:111], v[212:215], v[224:227], v[108:111]
    v_mfma_f32_16x16x32_bf16 v[96:99], v[200:203], v[228:231], v[96:99]
    v_add_u32 v248, 0x9400, v248
    v_add_u32 v249, 0x9400, v249
    v_mfma_f32_16x16x32_bf16 v[100:103], v[204:207], v[228:231], v[100:103]
    v_mfma_f32_16x16x32_bf16 v[104:107], v[192:195], v[228:231], v[104:107]
    v_mfma_f32_16x16x32_bf16 v[108:111], v[196:199], v[228:231], v[108:111]
    s_waitcnt lgkmcnt(2)
    v_mfma_f32_16x16x32_bf16 v[112:115], v[192:195], v[232:235], v[112:115]
    ds_read_b128 v[216:219], v250 offset:25600
    ds_read_b128 v[220:223], v250 offset:36352
    v_mfma_f32_16x16x32_bf16 v[116:119], v[196:199], v[232:235], v[116:119]
    v_mfma_f32_16x16x32_bf16 v[120:123], v[208:211], v[232:235], v[120:123]
    v_mfma_f32_16x16x32_bf16 v[124:127], v[212:215], v[232:235], v[124:127]
    ds_read_b64_tr_b16 v[176:177], v248 offset:0
    ds_read_b64_tr_b16 v[178:179], v248 offset:1024
    ds_read_b64_tr_b16 v[180:181], v249 offset:0
    ds_read_b64_tr_b16 v[182:183], v249 offset:1024
    v_mfma_f32_16x16x32_bf16 v[112:115], v[200:203], v[236:239], v[112:115]
    v_mfma_f32_16x16x32_bf16 v[116:119], v[204:207], v[236:239], v[116:119]
    v_mfma_f32_16x16x32_bf16 v[120:123], v[192:195], v[236:239], v[120:123]
    v_mfma_f32_16x16x32_bf16 v[124:127], v[196:199], v[236:239], v[124:127]
    s_waitcnt lgkmcnt(6)
    v_mfma_f32_16x16x32_bf16 v[128:131], v[192:195], v[240:243], v[128:131]
    ds_read_b128 v[224:227], v250 offset:26624
    ds_read_b128 v[228:231], v250 offset:37376
    v_mfma_f32_16x16x32_bf16 v[132:135], v[196:199], v[240:243], v[132:135]
    v_mfma_f32_16x16x32_bf16 v[136:139], v[208:211], v[240:243], v[136:139]
    v_mfma_f32_16x16x32_bf16 v[140:143], v[212:215], v[240:243], v[140:143]
    ds_read_b64_tr_b16 v[184:185], v248 offset:8192
    ds_read_b64_tr_b16 v[186:187], v248 offset:9216
    ds_read_b64_tr_b16 v[188:189], v249 offset:8192
    ds_read_b64_tr_b16 v[190:191], v249 offset:9216
    v_mfma_f32_16x16x32_bf16 v[128:131], v[200:203], v[244:247], v[128:131]
    v_mfma_f32_16x16x32_bf16 v[132:135], v[204:207], v[244:247], v[132:135]
    v_mfma_f32_16x16x32_bf16 v[136:139], v[192:195], v[244:247], v[136:139]
    v_mfma_f32_16x16x32_bf16 v[140:143], v[196:199], v[244:247], v[140:143]
    s_waitcnt lgkmcnt(10)
    v_mfma_f32_16x16x32_bf16 v[144:147], v[192:195], v[216:219], v[144:147]
    v_add_u32 v250, 0x9400, v250
    ds_read_b128 v[232:235], v250 offset:16384
    ds_read_b128 v[236:239], v250 offset:27136
    v_mfma_f32_16x16x32_bf16 v[148:151], v[196:199], v[216:219], v[148:151]
    v_mfma_f32_16x16x32_bf16 v[152:155], v[208:211], v[216:219], v[152:155]
    v_mfma_f32_16x16x32_bf16 v[156:159], v[212:215], v[216:219], v[156:159]
    v_mfma_f32_16x16x32_bf16 v[144:147], v[200:203], v[220:223], v[144:147]
    v_mfma_f32_16x16x32_bf16 v[148:151], v[204:207], v[220:223], v[148:151]
    v_mfma_f32_16x16x32_bf16 v[152:155], v[192:195], v[220:223], v[152:155]
    v_mfma_f32_16x16x32_bf16 v[156:159], v[196:199], v[220:223], v[156:159]
    s_waitcnt lgkmcnt(6)
    v_mfma_f32_16x16x32_bf16 v[160:163], v[192:195], v[224:227], v[160:163]
    ds_read_b128 v[240:243], v250 offset:17408
    ds_read_b128 v[244:247], v250 offset:28160
    v_mfma_f32_16x16x32_bf16 v[164:167], v[196:199], v[224:227], v[164:167]
    v_mfma_f32_16x16x32_bf16 v[168:171], v[208:211], v[224:227], v[168:171]
    v_mfma_f32_16x16x32_bf16 v[172:175], v[212:215], v[224:227], v[172:175]
    s_waitcnt lgkmcnt(4)
    v_xor_b32 v208, 0x80008000, v184
    v_xor_b32 v209, 0x80008000, v185
    v_mfma_f32_16x16x32_bf16 v[160:163], v[200:203], v[228:231], v[160:163]
    v_xor_b32 v210, 0x80008000, v186
    v_xor_b32 v211, 0x80008000, v187
    v_mfma_f32_16x16x32_bf16 v[164:167], v[204:207], v[228:231], v[164:167]
    v_xor_b32 v212, 0x80008000, v188
    v_xor_b32 v213, 0x80008000, v189
    v_mfma_f32_16x16x32_bf16 v[168:171], v[192:195], v[228:231], v[168:171]
    v_xor_b32 v214, 0x80008000, v190
    v_xor_b32 v215, 0x80008000, v191
    v_mfma_f32_16x16x32_bf16 v[172:175], v[196:199], v[228:231], v[172:175]
    s_barrier
    s_waitcnt lgkmcnt(2)
    v_mfma_f32_16x16x32_bf16 v[0:3], v[176:179], v[232:235], v[0:3]
    ds_read_b128 v[216:219], v250 offset:18432
    ds_read_b128 v[220:223], v250 offset:29184
    v_mfma_f32_16x16x32_bf16 v[4:7], v[180:183], v[232:235], v[4:7]
    v_mfma_f32_16x16x32_bf16 v[8:11], v[208:211], v[232:235], v[8:11]
    v_mfma_f32_16x16x32_bf16 v[12:15], v[212:215], v[232:235], v[12:15]
    v_mfma_f32_16x16x32_bf16 v[0:3], v[184:187], v[236:239], v[0:3]
    v_mfma_f32_16x16x32_bf16 v[4:7], v[188:191], v[236:239], v[4:7]
    v_mfma_f32_16x16x32_bf16 v[8:11], v[176:179], v[236:239], v[8:11]
    v_mfma_f32_16x16x32_bf16 v[12:15], v[180:183], v[236:239], v[12:15]
    s_waitcnt lgkmcnt(2)
    v_mfma_f32_16x16x32_bf16 v[16:19], v[176:179], v[240:243], v[16:19]
    ds_read_b128 v[224:227], v250 offset:19456
    ds_read_b128 v[228:231], v250 offset:30208
    v_mfma_f32_16x16x32_bf16 v[20:23], v[180:183], v[240:243], v[20:23]
    v_mfma_f32_16x16x32_bf16 v[24:27], v[208:211], v[240:243], v[24:27]
    v_mfma_f32_16x16x32_bf16 v[28:31], v[212:215], v[240:243], v[28:31]
    v_mfma_f32_16x16x32_bf16 v[16:19], v[184:187], v[244:247], v[16:19]
    v_mfma_f32_16x16x32_bf16 v[20:23], v[188:191], v[244:247], v[20:23]
    v_mfma_f32_16x16x32_bf16 v[24:27], v[176:179], v[244:247], v[24:27]
    v_mfma_f32_16x16x32_bf16 v[28:31], v[180:183], v[244:247], v[28:31]
    s_waitcnt lgkmcnt(2)
    v_mfma_f32_16x16x32_bf16 v[32:35], v[176:179], v[216:219], v[32:35]
    ds_read_b128 v[232:235], v250 offset:20480
    ds_read_b128 v[236:239], v250 offset:31232
    v_mfma_f32_16x16x32_bf16 v[36:39], v[180:183], v[216:219], v[36:39]
    v_mfma_f32_16x16x32_bf16 v[40:43], v[208:211], v[216:219], v[40:43]
    v_mfma_f32_16x16x32_bf16 v[44:47], v[212:215], v[216:219], v[44:47]
    v_mfma_f32_16x16x32_bf16 v[32:35], v[184:187], v[220:223], v[32:35]
    v_mfma_f32_16x16x32_bf16 v[36:39], v[188:191], v[220:223], v[36:39]
    v_mfma_f32_16x16x32_bf16 v[40:43], v[176:179], v[220:223], v[40:43]
    v_mfma_f32_16x16x32_bf16 v[44:47], v[180:183], v[220:223], v[44:47]
    s_waitcnt lgkmcnt(2)
    v_mfma_f32_16x16x32_bf16 v[48:51], v[176:179], v[224:227], v[48:51]
    ds_read_b128 v[240:243], v250 offset:21504
    ds_read_b128 v[244:247], v250 offset:32256
    v_mfma_f32_16x16x32_bf16 v[52:55], v[180:183], v[224:227], v[52:55]
    v_mfma_f32_16x16x32_bf16 v[56:59], v[208:211], v[224:227], v[56:59]
    v_mfma_f32_16x16x32_bf16 v[60:63], v[212:215], v[224:227], v[60:63]
    v_mfma_f32_16x16x32_bf16 v[48:51], v[184:187], v[228:231], v[48:51]
    v_mfma_f32_16x16x32_bf16 v[52:55], v[188:191], v[228:231], v[52:55]
    v_mfma_f32_16x16x32_bf16 v[56:59], v[176:179], v[228:231], v[56:59]
    v_mfma_f32_16x16x32_bf16 v[60:63], v[180:183], v[228:231], v[60:63]
    s_waitcnt lgkmcnt(2)
    v_mfma_f32_16x16x32_bf16 v[64:67], v[176:179], v[232:235], v[64:67]
    ds_read_b128 v[216:219], v250 offset:22528
    ds_read_b128 v[220:223], v250 offset:33280
    v_mfma_f32_16x16x32_bf16 v[68:71], v[180:183], v[232:235], v[68:71]
    v_mfma_f32_16x16x32_bf16 v[72:75], v[208:211], v[232:235], v[72:75]
    v_mfma_f32_16x16x32_bf16 v[76:79], v[212:215], v[232:235], v[76:79]
    v_mfma_f32_16x16x32_bf16 v[64:67], v[184:187], v[236:239], v[64:67]
    v_mfma_f32_16x16x32_bf16 v[68:71], v[188:191], v[236:239], v[68:71]
    v_mfma_f32_16x16x32_bf16 v[72:75], v[176:179], v[236:239], v[72:75]
    v_mfma_f32_16x16x32_bf16 v[76:79], v[180:183], v[236:239], v[76:79]
    s_waitcnt lgkmcnt(2)
    v_mfma_f32_16x16x32_bf16 v[80:83], v[176:179], v[240:243], v[80:83]
    ds_read_b128 v[224:227], v250 offset:23552
    ds_read_b128 v[228:231], v250 offset:34304
    v_mfma_f32_16x16x32_bf16 v[84:87], v[180:183], v[240:243], v[84:87]
    v_mfma_f32_16x16x32_bf16 v[88:91], v[208:211], v[240:243], v[88:91]
    v_mfma_f32_16x16x32_bf16 v[92:95], v[212:215], v[240:243], v[92:95]
    v_mfma_f32_16x16x32_bf16 v[80:83], v[184:187], v[244:247], v[80:83]
    v_mfma_f32_16x16x32_bf16 v[84:87], v[188:191], v[244:247], v[84:87]
    v_mfma_f32_16x16x32_bf16 v[88:91], v[176:179], v[244:247], v[88:91]
    v_mfma_f32_16x16x32_bf16 v[92:95], v[180:183], v[244:247], v[92:95]
    s_waitcnt lgkmcnt(2)
    v_mfma_f32_16x16x32_bf16 v[96:99], v[176:179], v[216:219], v[96:99]
    ds_read_b128 v[232:235], v250 offset:24576
    ds_read_b128 v[236:239], v250 offset:35328
    v_mfma_f32_16x16x32_bf16 v[100:103], v[180:183], v[216:219], v[100:103]
    v_mfma_f32_16x16x32_bf16 v[104:107], v[208:211], v[216:219], v[104:107]
    v_mfma_f32_16x16x32_bf16 v[108:111], v[212:215], v[216:219], v[108:111]
    v_mfma_f32_16x16x32_bf16 v[96:99], v[184:187], v[220:223], v[96:99]
    v_add_u32 v248, 0x9400, v248
    v_add_u32 v249, 0x9400, v249
    v_mfma_f32_16x16x32_bf16 v[100:103], v[188:191], v[220:223], v[100:103]
    v_mfma_f32_16x16x32_bf16 v[104:107], v[176:179], v[220:223], v[104:107]
    v_mfma_f32_16x16x32_bf16 v[108:111], v[180:183], v[220:223], v[108:111]
    s_waitcnt lgkmcnt(2)
    v_mfma_f32_16x16x32_bf16 v[112:115], v[176:179], v[224:227], v[112:115]
    ds_read_b128 v[240:243], v250 offset:25600
    ds_read_b128 v[244:247], v250 offset:36352
    v_mfma_f32_16x16x32_bf16 v[116:119], v[180:183], v[224:227], v[116:119]
    v_mfma_f32_16x16x32_bf16 v[120:123], v[208:211], v[224:227], v[120:123]
    v_mfma_f32_16x16x32_bf16 v[124:127], v[212:215], v[224:227], v[124:127]
    ds_read_b64_tr_b16 v[192:193], v248 offset:0
    ds_read_b64_tr_b16 v[194:195], v248 offset:1024
    ds_read_b64_tr_b16 v[196:197], v249 offset:0
    ds_read_b64_tr_b16 v[198:199], v249 offset:1024
    v_mfma_f32_16x16x32_bf16 v[112:115], v[184:187], v[228:231], v[112:115]
    v_mfma_f32_16x16x32_bf16 v[116:119], v[188:191], v[228:231], v[116:119]
    v_mfma_f32_16x16x32_bf16 v[120:123], v[176:179], v[228:231], v[120:123]
    v_mfma_f32_16x16x32_bf16 v[124:127], v[180:183], v[228:231], v[124:127]
    s_waitcnt lgkmcnt(6)
    v_mfma_f32_16x16x32_bf16 v[128:131], v[176:179], v[232:235], v[128:131]
    ds_read_b128 v[216:219], v250 offset:26624
    ds_read_b128 v[220:223], v250 offset:37376
    v_mfma_f32_16x16x32_bf16 v[132:135], v[180:183], v[232:235], v[132:135]
    v_mfma_f32_16x16x32_bf16 v[136:139], v[208:211], v[232:235], v[136:139]
    v_mfma_f32_16x16x32_bf16 v[140:143], v[212:215], v[232:235], v[140:143]
    ds_read_b64_tr_b16 v[200:201], v248 offset:8192
    ds_read_b64_tr_b16 v[202:203], v248 offset:9216
    ds_read_b64_tr_b16 v[204:205], v249 offset:8192
    ds_read_b64_tr_b16 v[206:207], v249 offset:9216
    v_mfma_f32_16x16x32_bf16 v[128:131], v[184:187], v[236:239], v[128:131]
    v_mfma_f32_16x16x32_bf16 v[132:135], v[188:191], v[236:239], v[132:135]
    v_mfma_f32_16x16x32_bf16 v[136:139], v[176:179], v[236:239], v[136:139]
    v_mfma_f32_16x16x32_bf16 v[140:143], v[180:183], v[236:239], v[140:143]
    s_waitcnt lgkmcnt(10)
    v_mfma_f32_16x16x32_bf16 v[144:147], v[176:179], v[240:243], v[144:147]
    v_add_u32 v250, 0x9400, v250
    ds_read_b128 v[224:227], v250 offset:16384
    ds_read_b128 v[228:231], v250 offset:27136
    v_mfma_f32_16x16x32_bf16 v[148:151], v[180:183], v[240:243], v[148:151]
    v_mfma_f32_16x16x32_bf16 v[152:155], v[208:211], v[240:243], v[152:155]
    v_mfma_f32_16x16x32_bf16 v[156:159], v[212:215], v[240:243], v[156:159]
    v_mfma_f32_16x16x32_bf16 v[144:147], v[184:187], v[244:247], v[144:147]
    v_mfma_f32_16x16x32_bf16 v[148:151], v[188:191], v[244:247], v[148:151]
    v_mfma_f32_16x16x32_bf16 v[152:155], v[176:179], v[244:247], v[152:155]
    v_mfma_f32_16x16x32_bf16 v[156:159], v[180:183], v[244:247], v[156:159]
    s_waitcnt lgkmcnt(6)
    v_mfma_f32_16x16x32_bf16 v[160:163], v[176:179], v[216:219], v[160:163]
    ds_read_b128 v[232:235], v250 offset:17408
    ds_read_b128 v[236:239], v250 offset:28160
    v_mfma_f32_16x16x32_bf16 v[164:167], v[180:183], v[216:219], v[164:167]
    v_mfma_f32_16x16x32_bf16 v[168:171], v[208:211], v[216:219], v[168:171]
    v_mfma_f32_16x16x32_bf16 v[172:175], v[212:215], v[216:219], v[172:175]
    s_waitcnt lgkmcnt(4)
    v_xor_b32 v208, 0x80008000, v200
    v_xor_b32 v209, 0x80008000, v201
    v_mfma_f32_16x16x32_bf16 v[160:163], v[184:187], v[220:223], v[160:163]
    v_xor_b32 v210, 0x80008000, v202
    v_xor_b32 v211, 0x80008000, v203
    v_mfma_f32_16x16x32_bf16 v[164:167], v[188:191], v[220:223], v[164:167]
    v_xor_b32 v212, 0x80008000, v204
    v_xor_b32 v213, 0x80008000, v205
    v_mfma_f32_16x16x32_bf16 v[168:171], v[176:179], v[220:223], v[168:171]
    v_xor_b32 v214, 0x80008000, v206
    v_xor_b32 v215, 0x80008000, v207
    v_mfma_f32_16x16x32_bf16 v[172:175], v[180:183], v[220:223], v[172:175]
    s_barrier
    s_waitcnt lgkmcnt(2)
    v_mfma_f32_16x16x32_bf16 v[0:3], v[192:195], v[224:227], v[0:3]
    ds_read_b128 v[240:243], v250 offset:18432
    ds_read_b128 v[244:247], v250 offset:29184
    v_mfma_f32_16x16x32_bf16 v[4:7], v[196:199], v[224:227], v[4:7]
    v_mfma_f32_16x16x32_bf16 v[8:11], v[208:211], v[224:227], v[8:11]
    v_mfma_f32_16x16x32_bf16 v[12:15], v[212:215], v[224:227], v[12:15]
    v_mfma_f32_16x16x32_bf16 v[0:3], v[200:203], v[228:231], v[0:3]
    v_mfma_f32_16x16x32_bf16 v[4:7], v[204:207], v[228:231], v[4:7]
    v_mfma_f32_16x16x32_bf16 v[8:11], v[192:195], v[228:231], v[8:11]
    v_mfma_f32_16x16x32_bf16 v[12:15], v[196:199], v[228:231], v[12:15]
    s_waitcnt lgkmcnt(2)
    v_mfma_f32_16x16x32_bf16 v[16:19], v[192:195], v[232:235], v[16:19]
    ds_read_b128 v[216:219], v250 offset:19456
    ds_read_b128 v[220:223], v250 offset:30208
    v_mfma_f32_16x16x32_bf16 v[20:23], v[196:199], v[232:235], v[20:23]
    v_mfma_f32_16x16x32_bf16 v[24:27], v[208:211], v[232:235], v[24:27]
    v_mfma_f32_16x16x32_bf16 v[28:31], v[212:215], v[232:235], v[28:31]
    v_mfma_f32_16x16x32_bf16 v[16:19], v[200:203], v[236:239], v[16:19]
    v_mfma_f32_16x16x32_bf16 v[20:23], v[204:207], v[236:239], v[20:23]
    v_mfma_f32_16x16x32_bf16 v[24:27], v[192:195], v[236:239], v[24:27]
    v_mfma_f32_16x16x32_bf16 v[28:31], v[196:199], v[236:239], v[28:31]
    s_waitcnt lgkmcnt(2)
    v_mfma_f32_16x16x32_bf16 v[32:35], v[192:195], v[240:243], v[32:35]
    ds_read_b128 v[224:227], v250 offset:20480
    ds_read_b128 v[228:231], v250 offset:31232
    v_mfma_f32_16x16x32_bf16 v[36:39], v[196:199], v[240:243], v[36:39]
    v_mfma_f32_16x16x32_bf16 v[40:43], v[208:211], v[240:243], v[40:43]
    v_mfma_f32_16x16x32_bf16 v[44:47], v[212:215], v[240:243], v[44:47]
    v_mfma_f32_16x16x32_bf16 v[32:35], v[200:203], v[244:247], v[32:35]
    v_mfma_f32_16x16x32_bf16 v[36:39], v[204:207], v[244:247], v[36:39]
    v_mfma_f32_16x16x32_bf16 v[40:43], v[192:195], v[244:247], v[40:43]
    v_mfma_f32_16x16x32_bf16 v[44:47], v[196:199], v[244:247], v[44:47]
    s_waitcnt lgkmcnt(2)
    v_mfma_f32_16x16x32_bf16 v[48:51], v[192:195], v[216:219], v[48:51]
    ds_read_b128 v[232:235], v250 offset:21504
    ds_read_b128 v[236:239], v250 offset:32256
    v_mfma_f32_16x16x32_bf16 v[52:55], v[196:199], v[216:219], v[52:55]
    v_mfma_f32_16x16x32_bf16 v[56:59], v[208:211], v[216:219], v[56:59]
    v_mfma_f32_16x16x32_bf16 v[60:63], v[212:215], v[216:219], v[60:63]
    v_mfma_f32_16x16x32_bf16 v[48:51], v[200:203], v[220:223], v[48:51]
    v_mfma_f32_16x16x32_bf16 v[52:55], v[204:207], v[220:223], v[52:55]
    v_mfma_f32_16x16x32_bf16 v[56:59], v[192:195], v[220:223], v[56:59]
    v_mfma_f32_16x16x32_bf16 v[60:63], v[196:199], v[220:223], v[60:63]
    s_waitcnt lgkmcnt(2)
    v_mfma_f32_16x16x32_bf16 v[64:67], v[192:195], v[224:227], v[64:67]
    ds_read_b128 v[240:243], v250 offset:22528
    ds_read_b128 v[244:247], v250 offset:33280
    v_mfma_f32_16x16x32_bf16 v[68:71], v[196:199], v[224:227], v[68:71]
    v_mfma_f32_16x16x32_bf16 v[72:75], v[208:211], v[224:227], v[72:75]
    v_mfma_f32_16x16x32_bf16 v[76:79], v[212:215], v[224:227], v[76:79]
    v_mfma_f32_16x16x32_bf16 v[64:67], v[200:203], v[228:231], v[64:67]
    v_mfma_f32_16x16x32_bf16 v[68:71], v[204:207], v[228:231], v[68:71]
    v_mfma_f32_16x16x32_bf16 v[72:75], v[192:195], v[228:231], v[72:75]
    v_mfma_f32_16x16x32_bf16 v[76:79], v[196:199], v[228:231], v[76:79]
    s_waitcnt lgkmcnt(2)
    v_mfma_f32_16x16x32_bf16 v[80:83], v[192:195], v[232:235], v[80:83]
    ds_read_b128 v[216:219], v250 offset:23552
    ds_read_b128 v[220:223], v250 offset:34304
    v_mfma_f32_16x16x32_bf16 v[84:87], v[196:199], v[232:235], v[84:87]
    v_mfma_f32_16x16x32_bf16 v[88:91], v[208:211], v[232:235], v[88:91]
    v_mfma_f32_16x16x32_bf16 v[92:95], v[212:215], v[232:235], v[92:95]
    v_mfma_f32_16x16x32_bf16 v[80:83], v[200:203], v[236:239], v[80:83]
    v_mfma_f32_16x16x32_bf16 v[84:87], v[204:207], v[236:239], v[84:87]
    v_mfma_f32_16x16x32_bf16 v[88:91], v[192:195], v[236:239], v[88:91]
    v_mfma_f32_16x16x32_bf16 v[92:95], v[196:199], v[236:239], v[92:95]
    s_waitcnt lgkmcnt(2)
    v_mfma_f32_16x16x32_bf16 v[96:99], v[192:195], v[240:243], v[96:99]
    ds_read_b128 v[224:227], v250 offset:24576
    ds_read_b128 v[228:231], v250 offset:35328
    v_mfma_f32_16x16x32_bf16 v[100:103], v[196:199], v[240:243], v[100:103]
    v_mfma_f32_16x16x32_bf16 v[104:107], v[208:211], v[240:243], v[104:107]
    v_mfma_f32_16x16x32_bf16 v[108:111], v[212:215], v[240:243], v[108:111]
    v_mfma_f32_16x16x32_bf16 v[96:99], v[200:203], v[244:247], v[96:99]
    v_add_u32 v248, 0xfffe4400, v248
    v_add_u32 v249, 0xfffe4400, v249
    v_mfma_f32_16x16x32_bf16 v[100:103], v[204:207], v[244:247], v[100:103]
    v_mfma_f32_16x16x32_bf16 v[104:107], v[192:195], v[244:247], v[104:107]
    v_mfma_f32_16x16x32_bf16 v[108:111], v[196:199], v[244:247], v[108:111]
    s_waitcnt lgkmcnt(2)
    v_mfma_f32_16x16x32_bf16 v[112:115], v[192:195], v[216:219], v[112:115]
    ds_read_b128 v[232:235], v250 offset:25600
    ds_read_b128 v[236:239], v250 offset:36352
    v_mfma_f32_16x16x32_bf16 v[116:119], v[196:199], v[216:219], v[116:119]
    v_mfma_f32_16x16x32_bf16 v[120:123], v[208:211], v[216:219], v[120:123]
    v_mfma_f32_16x16x32_bf16 v[124:127], v[212:215], v[216:219], v[124:127]
    ds_read_b64_tr_b16 v[176:177], v248 offset:0
    ds_read_b64_tr_b16 v[178:179], v248 offset:1024
    ds_read_b64_tr_b16 v[180:181], v249 offset:0
    ds_read_b64_tr_b16 v[182:183], v249 offset:1024
    v_mfma_f32_16x16x32_bf16 v[112:115], v[200:203], v[220:223], v[112:115]
    v_mfma_f32_16x16x32_bf16 v[116:119], v[204:207], v[220:223], v[116:119]
    v_mfma_f32_16x16x32_bf16 v[120:123], v[192:195], v[220:223], v[120:123]
    v_mfma_f32_16x16x32_bf16 v[124:127], v[196:199], v[220:223], v[124:127]
    s_waitcnt lgkmcnt(6)
    v_mfma_f32_16x16x32_bf16 v[128:131], v[192:195], v[224:227], v[128:131]
    ds_read_b128 v[240:243], v250 offset:26624
    ds_read_b128 v[244:247], v250 offset:37376
    v_mfma_f32_16x16x32_bf16 v[132:135], v[196:199], v[224:227], v[132:135]
    v_mfma_f32_16x16x32_bf16 v[136:139], v[208:211], v[224:227], v[136:139]
    v_mfma_f32_16x16x32_bf16 v[140:143], v[212:215], v[224:227], v[140:143]
    ds_read_b64_tr_b16 v[184:185], v248 offset:8192
    ds_read_b64_tr_b16 v[186:187], v248 offset:9216
    ds_read_b64_tr_b16 v[188:189], v249 offset:8192
    ds_read_b64_tr_b16 v[190:191], v249 offset:9216
    v_mfma_f32_16x16x32_bf16 v[128:131], v[200:203], v[228:231], v[128:131]
    v_mfma_f32_16x16x32_bf16 v[132:135], v[204:207], v[228:231], v[132:135]
    v_mfma_f32_16x16x32_bf16 v[136:139], v[192:195], v[228:231], v[136:139]
    v_mfma_f32_16x16x32_bf16 v[140:143], v[196:199], v[228:231], v[140:143]
    s_waitcnt lgkmcnt(10)
    v_mfma_f32_16x16x32_bf16 v[144:147], v[192:195], v[232:235], v[144:147]
    v_add_u32 v250, 0xfffe4400, v250
    ds_read_b128 v[216:219], v250 offset:16384
    ds_read_b128 v[220:223], v250 offset:27136
    v_mfma_f32_16x16x32_bf16 v[148:151], v[196:199], v[232:235], v[148:151]
    v_mfma_f32_16x16x32_bf16 v[152:155], v[208:211], v[232:235], v[152:155]
    v_mfma_f32_16x16x32_bf16 v[156:159], v[212:215], v[232:235], v[156:159]
    v_mfma_f32_16x16x32_bf16 v[144:147], v[200:203], v[236:239], v[144:147]
    v_mfma_f32_16x16x32_bf16 v[148:151], v[204:207], v[236:239], v[148:151]
    v_mfma_f32_16x16x32_bf16 v[152:155], v[192:195], v[236:239], v[152:155]
    v_mfma_f32_16x16x32_bf16 v[156:159], v[196:199], v[236:239], v[156:159]
    s_waitcnt lgkmcnt(6)
    v_mfma_f32_16x16x32_bf16 v[160:163], v[192:195], v[240:243], v[160:163]
    ds_read_b128 v[224:227], v250 offset:17408
    ds_read_b128 v[228:231], v250 offset:28160
    v_mfma_f32_16x16x32_bf16 v[164:167], v[196:199], v[240:243], v[164:167]
    v_mfma_f32_16x16x32_bf16 v[168:171], v[208:211], v[240:243], v[168:171]
    v_mfma_f32_16x16x32_bf16 v[172:175], v[212:215], v[240:243], v[172:175]
    s_waitcnt lgkmcnt(4)
    v_xor_b32 v208, 0x80008000, v184
    v_xor_b32 v209, 0x80008000, v185
    v_mfma_f32_16x16x32_bf16 v[160:163], v[200:203], v[244:247], v[160:163]
    v_xor_b32 v210, 0x80008000, v186
    v_xor_b32 v211, 0x80008000, v187
    v_mfma_f32_16x16x32_bf16 v[164:167], v[204:207], v[244:247], v[164:167]
    v_xor_b32 v212, 0x80008000, v188
    v_xor_b32 v213, 0x80008000, v189
    v_mfma_f32_16x16x32_bf16 v[168:171], v[192:195], v[244:247], v[168:171]
    v_xor_b32 v214, 0x80008000, v190
    v_xor_b32 v215, 0x80008000, v191
    v_mfma_f32_16x16x32_bf16 v[172:175], v[196:199], v[244:247], v[172:175]
    s_sub_u32 s46, s46, 1
    s_cmp_lg_u32 s46, 0
    s_cbranch_scc1 L_g_loop
    s_barrier
    s_waitcnt lgkmcnt(2)
    v_mfma_f32_16x16x32_bf16 v[0:3], v[176:179], v[216:219], v[0:3]
    ds_read_b128 v[232:235], v250 offset:18432
    ds_read_b128 v[236:239], v250 offset:29184
    v_mfma_f32_16x16x32_bf16 v[4:7], v[180:183], v[216:219], v[4:7]
    v_mfma_f32_16x16x32_bf16 v[8:11], v[208:211], v[216:219], v[8:11]
    v_mfma_f32_16x16x32_bf16 v[12:15], v[212:215], v[216:219], v[12:15]
    v_mfma_f32_16x16x32_bf16 v[0:3], v[184:187], v[220:223], v[0:3]
    v_mfma_f32_16x16x32_bf16 v[4:7], v[188:191], v[220:223], v[4:7]
    v_mfma_f32_16x16x32_bf16 v[8:11], v[176:179], v[220:223], v[8:11]
    v_mfma_f32_16x16x32_bf16 v[12:15], v[180:183], v[220:223], v[12:15]
    s_waitcnt lgkmcnt(2)
    v_mfma_f32_16x16x32_bf16 v[16:19], v[176:179], v[224:227], v[16:19]
    ds_read_b128 v[240:243], v250 offset:19456
    ds_read_b128 v[244:247], v250 offset:30208
    v_mfma_f32_16x16x32_bf16 v[20:23], v[180:183], v[224:227], v[20:23]
    v_mfma_f32_16x16x32_bf16 v[24:27], v[208:211], v[224:227], v[24:27]
    v_mfma_f32_16x16x32_bf16 v[28:31], v[212:215], v[224:227], v[28:31]
    v_mfma_f32_16x16x32_bf16 v[16:19], v[184:187], v[228:231], v[16:19]
    v_mfma_f32_16x16x32_bf16 v[20:23], v[188:191], v[228:231], v[20:23]
    v_mfma_f32_16x16x32_bf16 v[24:27], v[176:179], v[228:231], v[24:27]
    v_mfma_f32_16x16x32_bf16 v[28:31], v[180:183], v[228:231], v[28:31]
    s_waitcnt lgkmcnt(2)
    v_mfma_f32_16x16x32_bf16 v[32:35], v[176:179], v[232:235], v[32:35]
    ds_read_b128 v[216:219], v250 offset:20480
    ds_read_b128 v[220:223], v250 offset:31232
    v_mfma_f32_16x16x32_bf16 v[36:39], v[180:183], v[232:235], v[36:39]
    v_mfma_f32_16x16x32_bf16 v[40:43], v[208:211], v[232:235], v[40:43]
    v_mfma_f32_16x16x32_bf16 v[44:47], v[212:215], v[232:235], v[44:47]
    v_mfma_f32_16x16x32_bf16 v[32:35], v[184:187], v[236:239], v[32:35]
    v_mfma_f32_16x16x32_bf16 v[36:39], v[188:191], v[236:239], v[36:39]
    v_mfma_f32_16x16x32_bf16 v[40:43], v[176:179], v[236:239], v[40:43]
    v_mfma_f32_16x16x32_bf16 v[44:47], v[180:183], v[236:239], v[44:47]
    s_waitcnt lgkmcnt(2)
    v_mfma_f32_16x16x32_bf16 v[48:51], v[176:179], v[240:243], v[48:51]
    ds_read_b128 v[224:227], v250 offset:21504
    ds_read_b128 v[228:231], v250 offset:32256
    v_mfma_f32_16x16x32_bf16 v[52:55], v[180:183], v[240:243], v[52:55]
    v_mfma_f32_16x16x32_bf16 v[56:59], v[208:211], v[240:243], v[56:59]
    v_mfma_f32_16x16x32_bf16 v[60:63], v[212:215], v[240:243], v[60:63]
    v_mfma_f32_16x16x32_bf16 v[48:51], v[184:187], v[244:247], v[48:51]
    v_mfma_f32_16x16x32_bf16 v[52:55], v[188:191], v[244:247], v[52:55]
    v_mfma_f32_16x16x32_bf16 v[56:59], v[176:179], v[244:247], v[56:59]
    v_mfma_f32_16x16x32_bf16 v[60:63], v[180:183], v[244:247], v[60:63]
    s_waitcnt lgkmcnt(2)
    v_mfma_f32_16x16x32_bf16 v[64:67], v[176:179], v[216:219], v[64:67]
    ds_read_b128 v[232:235], v250 offset:22528
    ds_read_b128 v[236:239], v250 offset:33280
    v_mfma_f32_16x16x32_bf16 v[68:71], v[180:183], v[216:219], v[68:71]
    v_mfma_f32_16x16x32_bf16 v[72:75], v[208:211], v[216:219], v[72:75]
    v_mfma_f32_16x16x32_bf16 v[76:79], v[212:215], v[216:219], v[76:79]
    v_mfma_f32_16x16x32_bf16 v[64:67], v[184:187], v[220:223], v[64:67]
    v_mfma_f32_16x16x32_bf16 v[68:71], v[188:191], v[220:223], v[68:71]
    v_mfma_f32_16x16x32_bf16 v[72:75], v[176:179], v[220:223], v[72:75]
    v_mfma_f32_16x16x32_bf16 v[76:79], v[180:183], v[220:223], v[76:79]
    s_waitcnt lgkmcnt(2)
    v_mfma_f32_16x16x32_bf16 v[80:83], v[176:179], v[224:227], v[80:83]
    ds_read_b128 v[240:243], v250 offset:23552
    ds_read_b128 v[244:247], v250 offset:34304
    v_mfma_f32_16x16x32_bf16 v[84:87], v[180:183], v[224:227], v[84:87]
    v_mfma_f32_16x16x32_bf16 v[88:91], v[208:211], v[224:227], v[88:91]
    v_mfma_f32_16x16x32_bf16 v[92:95], v[212:215], v[224:227], v[92:95]
    v_mfma_f32_16x16x32_bf16 v[80:83], v[184:187], v[228:231], v[80:83]
    v_mfma_f32_16x16x32_bf16 v[84:87], v[188:191], v[228:231], v[84:87]
    v_mfma_f32_16x16x32_bf16 v[88:91], v[176:179], v[228:231], v[88:91]
    v_mfma_f32_16x16x32_bf16 v[92:95], v[180:183], v[228:231], v[92:95]
    s_waitcnt lgkmcnt(2)
    v_mfma_f32_16x16x32_bf16 v[96:99], v[176:179], v[232:235], v[96:99]
    ds_read_b128 v[216:219], v250 offset:24576
    ds_read_b128 v[220:223], v250 offset:35328
    v_mfma_f32_16x16x32_bf16 v[100:103], v[180:183], v[232:235], v[100:103]
    v_mfma_f32_16x16x32_bf16 v[104:107], v[208:211], v[232:235], v[104:107]
    v_mfma_f32_16x16x32_bf16 v[108:111], v[212:215], v[232:235], v[108:111]
    v_mfma_f32_16x16x32_bf16 v[96:99], v[184:187], v[236:239], v[96:99]
    v_add_u32 v248, 0x9400, v248
    v_add_u32 v249, 0x9400, v249
    v_mfma_f32_16x16x32_bf16 v[100:103], v[188:191], v[236:239], v[100:103]
    v_mfma_f32_16x16x32_bf16 v[104:107], v[176:179], v[236:239], v[104:107]
    v_mfma_f32_16x16x32_bf16 v[108:111], v[180:183], v[236:239], v[108:111]
    s_waitcnt lgkmcnt(2)
    v_mfma_f32_16x16x32_bf16 v[112:115], v[176:179], v[240:243], v[112:115]
    ds_read_b128 v[224:227], v250 offset:25600
    ds_read_b128 v[228:231], v250 offset:36352
    v_mfma_f32_16x16x32_bf16 v[116:119], v[180:183], v[240:243], v[116:119]
    v_mfma_f32_16x16x32_bf16 v[120:123], v[208:211], v[240:243], v[120:123]
    v_mfma_f32_16x16x32_bf16 v[124:127], v[212:215], v[240:243], v[124:127]
    ds_read_b64_tr_b16 v[192:193], v248 offset:0
    ds_read_b64_tr_b16 v[194:195], v248 offset:1024
    ds_read_b64_tr_b16 v[196:197], v249 offset:0
    ds_read_b64_tr_b16 v[198:199], v249 offset:1024
    v_mfma_f32_16x16x32_bf16 v[112:115], v[184:187], v[244:247], v[112:115]
    v_mfma_f32_16x16x32_bf16 v[116:119], v[188:191], v[244:247], v[116:119]
    v_mfma_f32_16x16x32_bf16 v[120:123], v[176:179], v[244:247], v[120:123]
    v_mfma_f32_16x16x32_bf16 v[124:127], v[180:183], v[244:247], v[124:127]
    s_waitcnt lgkmcnt(6)
    v_mfma_f32_16x16x32_bf16 v[128:131], v[176:179], v[216:219], v[128:131]
    ds_read_b128 v[232:235], v250 offset:26624
    ds_read_b128 v[236:239], v250 offset:37376
    v_mfma_f32_16x16x32_bf16 v[132:135], v[180:183], v[216:219], v[132:135]
    v_mfma_f32_16x16x32_bf16 v[136:139], v[208:211], v[216:219], v[136:139]
    v_mfma_f32_16x16x32_bf16 v[140:143], v[212:215], v[216:219], v[140:143]
    ds_read_b64_tr_b16 v[200:201], v248 offset:8192
    ds_read_b64_tr_b16 v[202:203], v248 offset:9216
    ds_read_b64_tr_b16 v[204:205], v249 offset:8192
    ds_read_b64_tr_b16 v[206:207], v249 offset:9216
    v_mfma_f32_16x16x32_bf16 v[128:131], v[184:187], v[220:223], v[128:131]
    v_mfma_f32_16x16x32_bf16 v[132:135], v[188:191], v[220:223], v[132:135]
    v_mfma_f32_16x16x32_bf16 v[136:139], v[176:179], v[220:223], v[136:139]
    v_mfma_f32_16x16x32_bf16 v[140:143], v[180:183], v[220:223], v[140:143]
    s_waitcnt lgkmcnt(10)
    v_mfma_f32_16x16x32_bf16 v[144:147], v[176:179], v[224:227], v[144:147]
    v_add_u32 v250, 0x9400, v250
    ds_read_b128 v[240:243], v250 offset:16384
    ds_read_b128 v[244:247], v250 offset:27136
    v_mfma_f32_16x16x32_bf16 v[148:151], v[180:183], v[224:227], v[148:151]
    v_mfma_f32_16x16x32_bf16 v[152:155], v[208:211], v[224:227], v[152:155]
    v_mfma_f32_16x16x32_bf16 v[156:159], v[212:215], v[224:227], v[156:159]
    v_mfma_f32_16x16x32_bf16 v[144:147], v[184:187], v[228:231], v[144:147]
    v_mfma_f32_16x16x32_bf16 v[148:151], v[188:191], v[228:231], v[148:151]
    v_mfma_f32_16x16x32_bf16 v[152:155], v[176:179], v[228:231], v[152:155]
    v_mfma_f32_16x16x32_bf16 v[156:159], v[180:183], v[228:231], v[156:159]
    s_waitcnt lgkmcnt(6)
    v_mfma_f32_16x16x32_bf16 v[160:163], v[176:179], v[232:235], v[160:163]
    ds_read_b128 v[216:219], v250 offset:17408
    ds_read_b128 v[220:223], v250 offset:28160
    v_mfma_f32_16x16x32_bf16 v[164:167], v[180:183], v[232:235], v[164:167]
    v_mfma_f32_16x16x32_bf16 v[168:171], v[208:211], v[232:235], v[168:171]
    v_mfma_f32_16x16x32_bf16 v[172:175], v[212:215], v[232:235], v[172:175]
    s_waitcnt lgkmcnt(4)
    v_xor_b32 v208, 0x80008000, v200
    v_xor_b32 v209, 0x80008000, v201
    v_mfma_f32_16x16x32_bf16 v[160:163], v[184:187], v[236:239], v[160:163]
    v_xor_b32 v210, 0x80008000, v202
    v_xor_b32 v211, 0x80008000, v203
    v_mfma_f32_16x16x32_bf16 v[164:167], v[188:191], v[236:239], v[164:167]
    v_xor_b32 v212, 0x80008000, v204
    v_xor_b32 v213, 0x80008000, v205
    v_mfma_f32_16x16x32_bf16 v[168:171], v[176:179], v[236:239], v[168:171]
    v_xor_b32 v214, 0x80008000, v206
    v_xor_b32 v215, 0x80008000, v207
    v_mfma_f32_16x16x32_bf16 v[172:175], v[180:183], v[236:239], v[172:175]
    s_barrier
    s_waitcnt lgkmcnt(2)
    v_mfma_f32_16x16x32_bf16 v[0:3], v[192:195], v[240:243], v[0:3]
    ds_read_b128 v[224:227], v250 offset:18432
    ds_read_b128 v[228:231], v250 offset:29184
    v_mfma_f32_16x16x32_bf16 v[4:7], v[196:199], v[240:243], v[4:7]
    v_mfma_f32_16x16x32_bf16 v[8:11], v[208:211], v[240:243], v[8:11]
    v_mfma_f32_16x16x32_bf16 v[12:15], v[212:215], v[240:243], v[12:15]
    v_mfma_f32_16x16x32_bf16 v[0:3], v[200:203], v[244:247], v[0:3]
    v_mfma_f32_16x16x32_bf16 v[4:7], v[204:207], v[244:247], v[4:7]
    v_mfma_f32_16x16x32_bf16 v[8:11], v[192:195], v[244:247], v[8:11]
    v_mfma_f32_16x16x32_bf16 v[12:15], v[196:199], v[244:247], v[12:15]
    s_waitcnt lgkmcnt(2)
    v_mfma_f32_16x16x32_bf16 v[16:19], v[192:195], v[216:219], v[16:19]
    ds_read_b128 v[232:235], v250 offset:19456
    ds_read_b128 v[236:239], v250 offset:30208
    v_mfma_f32_16x16x32_bf16 v[20:23], v[196:199], v[216:219], v[20:23]
    v_mfma_f32_16x16x32_bf16 v[24:27], v[208:211], v[216:219], v[24:27]
    v_mfma_f32_16x16x32_bf16 v[28:31], v[212:215], v[216:219], v[28:31]
    v_mfma_f32_16x16x32_bf16 v[16:19], v[200:203], v[220:223], v[16:19]
    v_mfma_f32_16x16x32_bf16 v[20:23], v[204:207], v[220:223], v[20:23]
    v_mfma_f32_16x16x32_bf16 v[24:27], v[192:195], v[220:223], v[24:27]
    v_mfma_f32_16x16x32_bf16 v[28:31], v[196:199], v[220:223], v[28:31]
    s_waitcnt lgkmcnt(2)
    v_mfma_f32_16x16x32_bf16 v[32:35], v[192:195], v[224:227], v[32:35]
    ds_read_b128 v[240:243], v250 offset:20480
    ds_read_b128 v[244:247], v250 offset:31232
    v_mfma_f32_16x16x32_bf16 v[36:39], v[196:199], v[224:227], v[36:39]
    v_mfma_f32_16x16x32_bf16 v[40:43], v[208:211], v[224:227], v[40:43]
    v_mfma_f32_16x16x32_bf16 v[44:47], v[212:215], v[224:227], v[44:47]
    v_mfma_f32_16x16x32_bf16 v[32:35], v[200:203], v[228:231], v[32:35]
    v_mfma_f32_16x16x32_bf16 v[36:39], v[204:207], v[228:231], v[36:39]
    v_mfma_f32_16x16x32_bf16 v[40:43], v[192:195], v[228:231], v[40:43]
    v_mfma_f32_16x16x32_bf16 v[44:47], v[196:199], v[228:231], v[44:47]
    s_waitcnt lgkmcnt(2)
    v_mfma_f32_16x16x32_bf16 v[48:51], v[192:195], v[232:235], v[48:51]
    ds_read_b128 v[216:219], v250 offset:21504
    ds_read_b128 v[220:223], v250 offset:32256
    v_mfma_f32_16x16x32_bf16 v[52:55], v[196:199], v[232:235], v[52:55]
    v_mfma_f32_16x16x32_bf16 v[56:59], v[208:211], v[232:235], v[56:59]
    v_mfma_f32_16x16x32_bf16 v[60:63], v[212:215], v[232:235], v[60:63]
    v_mfma_f32_16x16x32_bf16 v[48:51], v[200:203], v[236:239], v[48:51]
    v_mfma_f32_16x16x32_bf16 v[52:55], v[204:207], v[236:239], v[52:55]
    v_mfma_f32_16x16x32_bf16 v[56:59], v[192:195], v[236:239], v[56:59]
    v_mfma_f32_16x16x32_bf16 v[60:63], v[196:199], v[236:239], v[60:63]
    s_waitcnt lgkmcnt(2)
    v_mfma_f32_16x16x32_bf16 v[64:67], v[192:195], v[240:243], v[64:67]
    ds_read_b128 v[224:227], v250 offset:22528
    ds_read_b128 v[228:231], v250 offset:33280
    v_mfma_f32_16x16x32_bf16 v[68:71], v[196:199], v[240:243], v[68:71]
    v_mfma_f32_16x16x32_bf16 v[72:75], v[208:211], v[240:243], v[72:75]
    v_mfma_f32_16x16x32_bf16 v[76:79], v[212:215], v[240:243], v[76:79]
    v_mfma_f32_16x16x32_bf16 v[64:67], v[200:203], v[244:247], v[64:67]
    v_mfma_f32_16x16x32_bf16 v[68:71], v[204:207], v[244:247], v[68:71]
    v_mfma_f32_16x16x32_bf16 v[72:75], v[192:195], v[244:247], v[72:75]
    v_mfma_f32_16x16x32_bf16 v[76:79], v[196:199], v[244:247], v[76:79]
    s_waitcnt lgkmcnt(2)
    v_mfma_f32_16x16x32_bf16 v[80:83], v[192:195], v[216:219], v[80:83]
    ds_read_b128 v[232:235], v250 offset:23552
    ds_read_b128 v[236:239], v250 offset:34304
    v_mfma_f32_16x16x32_bf16 v[84:87], v[196:199], v[216:219], v[84:87]
    v_mfma_f32_16x16x32_bf16 v[88:91], v[208:211], v[216:219], v[88:91]
    v_mfma_f32_16x16x32_bf16 v[92:95], v[212:215], v[216:219], v[92:95]
    v_mfma_f32_16x16x32_bf16 v[80:83], v[200:203], v[220:223], v[80:83]
    v_mfma_f32_16x16x32_bf16 v[84:87], v[204:207], v[220:223], v[84:87]
    v_mfma_f32_16x16x32_bf16 v[88:91], v[192:195], v[220:223], v[88:91]
    v_mfma_f32_16x16x32_bf16 v[92:95], v[196:199], v[220:223], v[92:95]
    s_waitcnt lgkmcnt(2)
    v_mfma_f32_16x16x32_bf16 v[96:99], v[192:195], v[224:227], v[96:99]
    ds_read_b128 v[240:243], v250 offset:24576
    ds_read_b128 v[244:247], v250 offset:35328
    v_mfma_f32_16x16x32_bf16 v[100:103], v[196:199], v[224:227], v[100:103]
    v_mfma_f32_16x16x32_bf16 v[104:107], v[208:211], v[224:227], v[104:107]
    v_mfma_f32_16x16x32_bf16 v[108:111], v[212:215], v[224:227], v[108:111]
    v_mfma_f32_16x16x32_bf16 v[96:99], v[200:203], v[228:231], v[96:99]
    v_add_u32 v248, 0x9400, v248
    v_add_u32 v249, 0x9400, v249
    v_mfma_f32_16x16x32_bf16 v[100:103], v[204:207], v[228:231], v[100:103]
    v_mfma_f32_16x16x32_bf16 v[104:107], v[192:195], v[228:231], v[104:107]
    v_mfma_f32_16x16x32_bf16 v[108:111], v[196:199], v[228:231], v[108:111]
    s_waitcnt lgkmcnt(2)
    v_mfma_f32_16x16x32_bf16 v[112:115], v[192:195], v[232:235], v[112:115]
    ds_read_b128 v[216:219], v250 offset:25600
    ds_read_b128 v[220:223], v250 offset:36352
    v_mfma_f32_16x16x32_bf16 v[116:119], v[196:199], v[232:235], v[116:119]
    v_mfma_f32_16x16x32_bf16 v[120:123], v[208:211], v[232:235], v[120:123]
    v_mfma_f32_16x16x32_bf16 v[124:127], v[212:215], v[232:235], v[124:127]
    ds_read_b64_tr_b16 v[176:177], v248 offset:0
    ds_read_b64_tr_b16 v[178:179], v248 offset:1024
    ds_read_b64_tr_b16 v[180:181], v249 offset:0
    ds_read_b64_tr_b16 v[182:183], v249 offset:1024
    v_mfma_f32_16x16x32_bf16 v[112:115], v[200:203], v[236:239], v[112:115]
    v_mfma_f32_16x16x32_bf16 v[116:119], v[204:207], v[236:239], v[116:119]
    v_mfma_f32_16x16x32_bf16 v[120:123], v[192:195], v[236:239], v[120:123]
    v_mfma_f32_16x16x32_bf16 v[124:127], v[196:199], v[236:239], v[124:127]
    s_waitcnt lgkmcnt(6)
    v_mfma_f32_16x16x32_bf16 v[128:131], v[192:195], v[240:243], v[128:131]
    ds_read_b128 v[224:227], v250 offset:26624
    ds_read_b128 v[228:231], v250 offset:37376
    v_mfma_f32_16x16x32_bf16 v[132:135], v[196:199], v[240:243], v[132:135]
    v_mfma_f32_16x16x32_bf16 v[136:139], v[208:211], v[240:243], v[136:139]
    v_mfma_f32_16x16x32_bf16 v[140:143], v[212:215], v[240:243], v[140:143]
    ds_read_b64_tr_b16 v[184:185], v248 offset:8192
    ds_read_b64_tr_b16 v[186:187], v248 offset:9216
    ds_read_b64_tr_b16 v[188:189], v249 offset:8192
    ds_read_b64_tr_b16 v[190:191], v249 offset:9216
    v_mfma_f32_16x16x32_bf16 v[128:131], v[200:203], v[244:247], v[128:131]
    v_mfma_f32_16x16x32_bf16 v[132:135], v[204:207], v[244:247], v[132:135]
    v_mfma_f32_16x16x32_bf16 v[136:139], v[192:195], v[244:247], v[136:139]
    v_mfma_f32_16x16x32_bf16 v[140:143], v[196:199], v[244:247], v[140:143]
    s_waitcnt lgkmcnt(10)
    v_mfma_f32_16x16x32_bf16 v[144:147], v[192:195], v[216:219], v[144:147]
    v_add_u32 v250, 0x9400, v250
    ds_read_b128 v[232:235], v250 offset:16384
    ds_read_b128 v[236:239], v250 offset:27136
    v_mfma_f32_16x16x32_bf16 v[148:151], v[196:199], v[216:219], v[148:151]
    v_mfma_f32_16x16x32_bf16 v[152:155], v[208:211], v[216:219], v[152:155]
    v_mfma_f32_16x16x32_bf16 v[156:159], v[212:215], v[216:219], v[156:159]
    v_mfma_f32_16x16x32_bf16 v[144:147], v[200:203], v[220:223], v[144:147]
    v_mfma_f32_16x16x32_bf16 v[148:151], v[204:207], v[220:223], v[148:151]
    v_mfma_f32_16x16x32_bf16 v[152:155], v[192:195], v[220:223], v[152:155]
    v_mfma_f32_16x16x32_bf16 v[156:159], v[196:199], v[220:223], v[156:159]
    s_waitcnt lgkmcnt(6)
    v_mfma_f32_16x16x32_bf16 v[160:163], v[192:195], v[224:227], v[160:163]
    ds_read_b128 v[240:243], v250 offset:17408
    ds_read_b128 v[244:247], v250 offset:28160
    v_mfma_f32_16x16x32_bf16 v[164:167], v[196:199], v[224:227], v[164:167]
    v_mfma_f32_16x16x32_bf16 v[168:171], v[208:211], v[224:227], v[168:171]
    v_mfma_f32_16x16x32_bf16 v[172:175], v[212:215], v[224:227], v[172:175]
    s_waitcnt lgkmcnt(4)
    v_xor_b32 v208, 0x80008000, v184
    v_xor_b32 v209, 0x80008000, v185
    v_mfma_f32_16x16x32_bf16 v[160:163], v[200:203], v[228:231], v[160:163]
    v_xor_b32 v210, 0x80008000, v186
    v_xor_b32 v211, 0x80008000, v187
    v_mfma_f32_16x16x32_bf16 v[164:167], v[204:207], v[228:231], v[164:167]
    v_xor_b32 v212, 0x80008000, v188
    v_xor_b32 v213, 0x80008000, v189
    v_mfma_f32_16x16x32_bf16 v[168:171], v[192:195], v[228:231], v[168:171]
    v_xor_b32 v214, 0x80008000, v190
    v_xor_b32 v215, 0x80008000, v191
    v_mfma_f32_16x16x32_bf16 v[172:175], v[196:199], v[228:231], v[172:175]
    s_barrier
    s_waitcnt lgkmcnt(2)
    v_mfma_f32_16x16x32_bf16 v[0:3], v[176:179], v[232:235], v[0:3]
    ds_read_b128 v[216:219], v250 offset:18432
    ds_read_b128 v[220:223], v250 offset:29184
    v_mfma_f32_16x16x32_bf16 v[4:7], v[180:183], v[232:235], v[4:7]
    v_mfma_f32_16x16x32_bf16 v[8:11], v[208:211], v[232:235], v[8:11]
    v_mfma_f32_16x16x32_bf16 v[12:15], v[212:215], v[232:235], v[12:15]
    v_mfma_f32_16x16x32_bf16 v[0:3], v[184:187], v[236:239], v[0:3]
    v_mfma_f32_16x16x32_bf16 v[4:7], v[188:191], v[236:239], v[4:7]
    v_mfma_f32_16x16x32_bf16 v[8:11], v[176:179], v[236:239], v[8:11]
    v_mfma_f32_16x16x32_bf16 v[12:15], v[180:183], v[236:239], v[12:15]
    s_waitcnt lgkmcnt(2)
    v_mfma_f32_16x16x32_bf16 v[16:19], v[176:179], v[240:243], v[16:19]
    ds_read_b128 v[224:227], v250 offset:19456
    ds_read_b128 v[228:231], v250 offset:30208
    v_mfma_f32_16x16x32_bf16 v[20:23], v[180:183], v[240:243], v[20:23]
    v_mfma_f32_16x16x32_bf16 v[24:27], v[208:211], v[240:243], v[24:27]
    v_mfma_f32_16x16x32_bf16 v[28:31], v[212:215], v[240:243], v[28:31]
    v_mfma_f32_16x16x32_bf16 v[16:19], v[184:187], v[244:247], v[16:19]
    v_mfma_f32_16x16x32_bf16 v[20:23], v[188:191], v[244:247], v[20:23]
    v_mfma_f32_16x16x32_bf16 v[24:27], v[176:179], v[244:247], v[24:27]
    v_mfma_f32_16x16x32_bf16 v[28:31], v[180:183], v[244:247], v[28:31]
    s_waitcnt lgkmcnt(2)
    v_mfma_f32_16x16x32_bf16 v[32:35], v[176:179], v[216:219], v[32:35]
    ds_read_b128 v[232:235], v250 offset:20480
    ds_read_b128 v[236:239], v250 offset:31232
    v_mfma_f32_16x16x32_bf16 v[36:39], v[180:183], v[216:219], v[36:39]
    v_mfma_f32_16x16x32_bf16 v[40:43], v[208:211], v[216:219], v[40:43]
    v_mfma_f32_16x16x32_bf16 v[44:47], v[212:215], v[216:219], v[44:47]
    v_mfma_f32_16x16x32_bf16 v[32:35], v[184:187], v[220:223], v[32:35]
    v_mfma_f32_16x16x32_bf16 v[36:39], v[188:191], v[220:223], v[36:39]
    v_mfma_f32_16x16x32_bf16 v[40:43], v[176:179], v[220:223], v[40:43]
    v_mfma_f32_16x16x32_bf16 v[44:47], v[180:183], v[220:223], v[44:47]
    s_waitcnt lgkmcnt(2)
    v_mfma_f32_16x16x32_bf16 v[48:51], v[176:179], v[224:227], v[48:51]
    ds_read_b128 v[240:243], v250 offset:21504
    ds_read_b128 v[244:247], v250 offset:32256
    v_mfma_f32_16x16x32_bf16 v[52:55], v[180:183], v[224:227], v[52:55]
    v_mfma_f32_16x16x32_bf16 v[56:59], v[208:211], v[224:227], v[56:59]
    v_mfma_f32_16x16x32_bf16 v[60:63], v[212:215], v[224:227], v[60:63]
    v_mfma_f32_16x16x32_bf16 v[48:51], v[184:187], v[228:231], v[48:51]
    v_mfma_f32_16x16x32_bf16 v[52:55], v[188:191], v[228:231], v[52:55]
    v_mfma_f32_16x16x32_bf16 v[56:59], v[176:179], v[228:231], v[56:59]
    v_mfma_f32_16x16x32_bf16 v[60:63], v[180:183], v[228:231], v[60:63]
    s_waitcnt lgkmcnt(2)
    v_mfma_f32_16x16x32_bf16 v[64:67], v[176:179], v[232:235], v[64:67]
    ds_read_b128 v[216:219], v250 offset:22528
    ds_read_b128 v[220:223], v250 offset:33280
    v_mfma_f32_16x16x32_bf16 v[68:71], v[180:183], v[232:235], v[68:71]
    v_mfma_f32_16x16x32_bf16 v[72:75], v[208:211], v[232:235], v[72:75]
    v_mfma_f32_16x16x32_bf16 v[76:79], v[212:215], v[232:235], v[76:79]
    v_mfma_f32_16x16x32_bf16 v[64:67], v[184:187], v[236:239], v[64:67]
    v_mfma_f32_16x16x32_bf16 v[68:71], v[188:191], v[236:239], v[68:71]
    v_mfma_f32_16x16x32_bf16 v[72:75], v[176:179], v[236:239], v[72:75]
    v_mfma_f32_16x16x32_bf16 v[76:79], v[180:183], v[236:239], v[76:79]
    s_waitcnt lgkmcnt(2)
    v_mfma_f32_16x16x32_bf16 v[80:83], v[176:179], v[240:243], v[80:83]
    ds_read_b128 v[224:227], v250 offset:23552
    ds_read_b128 v[228:231], v250 offset:34304
    v_mfma_f32_16x16x32_bf16 v[84:87], v[180:183], v[240:243], v[84:87]
    v_mfma_f32_16x16x32_bf16 v[88:91], v[208:211], v[240:243], v[88:91]
    v_mfma_f32_16x16x32_bf16 v[92:95], v[212:215], v[240:243], v[92:95]
    v_mfma_f32_16x16x32_bf16 v[80:83], v[184:187], v[244:247], v[80:83]
    v_mfma_f32_16x16x32_bf16 v[84:87], v[188:191], v[244:247], v[84:87]
    v_mfma_f32_16x16x32_bf16 v[88:91], v[176:179], v[244:247], v[88:91]
    v_mfma_f32_16x16x32_bf16 v[92:95], v[180:183], v[244:247], v[92:95]
    s_waitcnt lgkmcnt(2)
    v_mfma_f32_16x16x32_bf16 v[96:99], v[176:179], v[216:219], v[96:99]
    ds_read_b128 v[232:235], v250 offset:24576
    ds_read_b128 v[236:239], v250 offset:35328
    v_mfma_f32_16x16x32_bf16 v[100:103], v[180:183], v[216:219], v[100:103]
    v_mfma_f32_16x16x32_bf16 v[104:107], v[208:211], v[216:219], v[104:107]
    v_mfma_f32_16x16x32_bf16 v[108:111], v[212:215], v[216:219], v[108:111]
    v_mfma_f32_16x16x32_bf16 v[96:99], v[184:187], v[220:223], v[96:99]
    v_add_u32 v248, 0x9400, v248
    v_add_u32 v249, 0x9400, v249
    v_mfma_f32_16x16x32_bf16 v[100:103], v[188:191], v[220:223], v[100:103]
    v_mfma_f32_16x16x32_bf16 v[104:107], v[176:179], v[220:223], v[104:107]
    v_mfma_f32_16x16x32_bf16 v[108:111], v[180:183], v[220:223], v[108:111]
    s_waitcnt lgkmcnt(2)
    v_mfma_f32_16x16x32_bf16 v[112:115], v[176:179], v[224:227], v[112:115]
    ds_read_b128 v[240:243], v250 offset:25600
    ds_read_b128 v[244:247], v250 offset:36352
    v_mfma_f32_16x16x32_bf16 v[116:119], v[180:183], v[224:227], v[116:119]
    v_mfma_f32_16x16x32_bf16 v[120:123], v[208:211], v[224:227], v[120:123]
    v_mfma_f32_16x16x32_bf16 v[124:127], v[212:215], v[224:227], v[124:127]
    ds_read_b64_tr_b16 v[192:193], v248 offset:0
    ds_read_b64_tr_b16 v[194:195], v248 offset:1024
    ds_read_b64_tr_b16 v[196:197], v249 offset:0
    ds_read_b64_tr_b16 v[198:199], v249 offset:1024
    v_mfma_f32_16x16x32_bf16 v[112:115], v[184:187], v[228:231], v[112:115]
    v_mfma_f32_16x16x32_bf16 v[116:119], v[188:191], v[228:231], v[116:119]
    v_mfma_f32_16x16x32_bf16 v[120:123], v[176:179], v[228:231], v[120:123]
    v_mfma_f32_16x16x32_bf16 v[124:127], v[180:183], v[228:231], v[124:127]
    s_waitcnt lgkmcnt(6)
    v_mfma_f32_16x16x32_bf16 v[128:131], v[176:179], v[232:235], v[128:131]
    ds_read_b128 v[216:219], v250 offset:26624
    ds_read_b128 v[220:223], v250 offset:37376
    v_mfma_f32_16x16x32_bf16 v[132:135], v[180:183], v[232:235], v[132:135]
    v_mfma_f32_16x16x32_bf16 v[136:139], v[208:211], v[232:235], v[136:139]
    v_mfma_f32_16x16x32_bf16 v[140:143], v[212:215], v[232:235], v[140:143]
    ds_read_b64_tr_b16 v[200:201], v248 offset:8192
    ds_read_b64_tr_b16 v[202:203], v248 offset:9216
    ds_read_b64_tr_b16 v[204:205], v249 offset:8192
    ds_read_b64_tr_b16 v[206:207], v249 offset:9216
    v_mfma_f32_16x16x32_bf16 v[128:131], v[184:187], v[236:239], v[128:131]
    v_mfma_f32_16x16x32_bf16 v[132:135], v[188:191], v[236:239], v[132:135]
    v_mfma_f32_16x16x32_bf16 v[136:139], v[176:179], v[236:239], v[136:139]
    v_mfma_f32_16x16x32_bf16 v[140:143], v[180:183], v[236:239], v[140:143]
    s_waitcnt lgkmcnt(10)
    v_mfma_f32_16x16x32_bf16 v[144:147], v[176:179], v[240:243], v[144:147]
    v_add_u32 v250, 0x9400, v250
    ds_read_b128 v[224:227], v250 offset:16384
    ds_read_b128 v[228:231], v250 offset:27136
    v_mfma_f32_16x16x32_bf16 v[148:151], v[180:183], v[240:243], v[148:151]
    v_mfma_f32_16x16x32_bf16 v[152:155], v[208:211], v[240:243], v[152:155]
    v_mfma_f32_16x16x32_bf16 v[156:159], v[212:215], v[240:243], v[156:159]
    v_mfma_f32_16x16x32_bf16 v[144:147], v[184:187], v[244:247], v[144:147]
    v_mfma_f32_16x16x32_bf16 v[148:151], v[188:191], v[244:247], v[148:151]
    v_mfma_f32_16x16x32_bf16 v[152:155], v[176:179], v[244:247], v[152:155]
    v_mfma_f32_16x16x32_bf16 v[156:159], v[180:183], v[244:247], v[156:159]
    s_waitcnt lgkmcnt(6)
    v_mfma_f32_16x16x32_bf16 v[160:163], v[176:179], v[216:219], v[160:163]
    ds_read_b128 v[232:235], v250 offset:17408
    ds_read_b128 v[236:239], v250 offset:28160
    v_mfma_f32_16x16x32_bf16 v[164:167], v[180:183], v[216:219], v[164:167]
    v_mfma_f32_16x16x32_bf16 v[168:171], v[208:211], v[216:219], v[168:171]
    v_mfma_f32_16x16x32_bf16 v[172:175], v[212:215], v[216:219], v[172:175]
    s_waitcnt lgkmcnt(4)
    v_xor_b32 v208, 0x80008000, v200
    v_xor_b32 v209, 0x80008000, v201
    v_mfma_f32_16x16x32_bf16 v[160:163], v[184:187], v[220:223], v[160:163]
    v_xor_b32 v210, 0x80008000, v202
    v_xor_b32 v211, 0x80008000, v203
    v_mfma_f32_16x16x32_bf16 v[164:167], v[188:191], v[220:223], v[164:167]
    v_xor_b32 v212, 0x80008000, v204
    v_xor_b32 v213, 0x80008000, v205
    v_mfma_f32_16x16x32_bf16 v[168:171], v[176:179], v[220:223], v[168:171]
    v_xor_b32 v214, 0x80008000, v206
    v_xor_b32 v215, 0x80008000, v207
    v_mfma_f32_16x16x32_bf16 v[172:175], v[180:183], v[220:223], v[172:175]
    s_waitcnt lgkmcnt(2)
    v_mfma_f32_16x16x32_bf16 v[0:3], v[192:195], v[224:227], v[0:3]
    ds_read_b128 v[240:243], v250 offset:18432
    ds_read_b128 v[244:247], v250 offset:29184
    v_mfma_f32_16x16x32_bf16 v[4:7], v[196:199], v[224:227], v[4:7]
    v_mfma_f32_16x16x32_bf16 v[8:11], v[208:211], v[224:227], v[8:11]
    v_mfma_f32_16x16x32_bf16 v[12:15], v[212:215], v[224:227], v[12:15]
    v_mfma_f32_16x16x32_bf16 v[0:3], v[200:203], v[228:231], v[0:3]
    v_mfma_f32_16x16x32_bf16 v[4:7], v[204:207], v[228:231], v[4:7]
    v_mfma_f32_16x16x32_bf16 v[8:11], v[192:195], v[228:231], v[8:11]
    v_mfma_f32_16x16x32_bf16 v[12:15], v[196:199], v[228:231], v[12:15]
    s_waitcnt lgkmcnt(2)
    v_mfma_f32_16x16x32_bf16 v[16:19], v[192:195], v[232:235], v[16:19]
    ds_read_b128 v[216:219], v250 offset:19456
    ds_read_b128 v[220:223], v250 offset:30208
    v_mfma_f32_16x16x32_bf16 v[20:23], v[196:199], v[232:235], v[20:23]
    v_mfma_f32_16x16x32_bf16 v[24:27], v[208:211], v[232:235], v[24:27]
    v_mfma_f32_16x16x32_bf16 v[28:31], v[212:215], v[232:235], v[28:31]
    v_mfma_f32_16x16x32_bf16 v[16:19], v[200:203], v[236:239], v[16:19]
    v_mfma_f32_16x16x32_bf16 v[20:23], v[204:207], v[236:239], v[20:23]
    v_mfma_f32_16x16x32_bf16 v[24:27], v[192:195], v[236:239], v[24:27]
    v_mfma_f32_16x16x32_bf16 v[28:31], v[196:199], v[236:239], v[28:31]
    s_waitcnt lgkmcnt(2)
    v_mfma_f32_16x16x32_bf16 v[32:35], v[192:195], v[240:243], v[32:35]
    ds_read_b128 v[224:227], v250 offset:20480
    ds_read_b128 v[228:231], v250 offset:31232
    v_mfma_f32_16x16x32_bf16 v[36:39], v[196:199], v[240:243], v[36:39]
    v_mfma_f32_16x16x32_bf16 v[40:43], v[208:211], v[240:243], v[40:43]
    v_mfma_f32_16x16x32_bf16 v[44:47], v[212:215], v[240:243], v[44:47]
    v_mfma_f32_16x16x32_bf16 v[32:35], v[200:203], v[244:247], v[32:35]
    v_mfma_f32_16x16x32_bf16 v[36:39], v[204:207], v[244:247], v[36:39]
    v_mfma_f32_16x16x32_bf16 v[40:43], v[192:195], v[244:247], v[40:43]
    v_mfma_f32_16x16x32_bf16 v[44:47], v[196:199], v[244:247], v[44:47]
    s_waitcnt lgkmcnt(2)
    v_mfma_f32_16x16x32_bf16 v[48:51], v[192:195], v[216:219], v[48:51]
    ds_read_b128 v[232:235], v250 offset:21504
    ds_read_b128 v[236:239], v250 offset:32256
    v_mfma_f32_16x16x32_bf16 v[52:55], v[196:199], v[216:219], v[52:55]
    v_mfma_f32_16x16x32_bf16 v[56:59], v[208:211], v[216:219], v[56:59]
    v_mfma_f32_16x16x32_bf16 v[60:63], v[212:215], v[216:219], v[60:63]
    v_mfma_f32_16x16x32_bf16 v[48:51], v[200:203], v[220:223], v[48:51]
    v_mfma_f32_16x16x32_bf16 v[52:55], v[204:207], v[220:223], v[52:55]
    v_mfma_f32_16x16x32_bf16 v[56:59], v[192:195], v[220:223], v[56:59]
    v_mfma_f32_16x16x32_bf16 v[60:63], v[196:199], v[220:223], v[60:63]
    s_waitcnt lgkmcnt(2)
    v_mfma_f32_16x16x32_bf16 v[64:67], v[192:195], v[224:227], v[64:67]
    ds_read_b128 v[240:243], v250 offset:22528
    ds_read_b128 v[244:247], v250 offset:33280
    v_mfma_f32_16x16x32_bf16 v[68:71], v[196:199], v[224:227], v[68:71]
    v_mfma_f32_16x16x32_bf16 v[72:75], v[208:211], v[224:227], v[72:75]
    v_mfma_f32_16x16x32_bf16 v[76:79], v[212:215], v[224:227], v[76:79]
    v_mfma_f32_16x16x32_bf16 v[64:67], v[200:203], v[228:231], v[64:67]
    v_mfma_f32_16x16x32_bf16 v[68:71], v[204:207], v[228:231], v[68:71]
    v_mfma_f32_16x16x32_bf16 v[72:75], v[192:195], v[228:231], v[72:75]
    v_mfma_f32_16x16x32_bf16 v[76:79], v[196:199], v[228:231], v[76:79]
    s_waitcnt lgkmcnt(2)
    v_mfma_f32_16x16x32_bf16 v[80:83], v[192:195], v[232:235], v[80:83]
    ds_read_b128 v[216:219], v250 offset:23552
    ds_read_b128 v[220:223], v250 offset:34304
    v_mfma_f32_16x16x32_bf16 v[84:87], v[196:199], v[232:235], v[84:87]
    v_mfma_f32_16x16x32_bf16 v[88:91], v[208:211], v[232:235], v[88:91]
    v_mfma_f32_16x16x32_bf16 v[92:95], v[212:215], v[232:235], v[92:95]
    v_mfma_f32_16x16x32_bf16 v[80:83], v[200:203], v[236:239], v[80:83]
    v_mfma_f32_16x16x32_bf16 v[84:87], v[204:207], v[236:239], v[84:87]
    v_mfma_f32_16x16x32_bf16 v[88:91], v[192:195], v[236:239], v[88:91]
    v_mfma_f32_16x16x32_bf16 v[92:95], v[196:199], v[236:239], v[92:95]
    s_waitcnt lgkmcnt(2)
    v_mfma_f32_16x16x32_bf16 v[96:99], v[192:195], v[240:243], v[96:99]
    ds_read_b128 v[224:227], v250 offset:24576
    ds_read_b128 v[228:231], v250 offset:35328
    v_mfma_f32_16x16x32_bf16 v[100:103], v[196:199], v[240:243], v[100:103]
    v_mfma_f32_16x16x32_bf16 v[104:107], v[208:211], v[240:243], v[104:107]
    v_mfma_f32_16x16x32_bf16 v[108:111], v[212:215], v[240:243], v[108:111]
    v_mfma_f32_16x16x32_bf16 v[96:99], v[200:203], v[244:247], v[96:99]
    v_mfma_f32_16x16x32_bf16 v[100:103], v[204:207], v[244:247], v[100:103]
    v_mfma_f32_16x16x32_bf16 v[104:107], v[192:195], v[244:247], v[104:107]
    v_mfma_f32_16x16x32_bf16 v[108:111], v[196:199], v[244:247], v[108:111]
    s_waitcnt lgkmcnt(2)
    v_mfma_f32_16x16x32_bf16 v[112:115], v[192:195], v[216:219], v[112:115]
    ds_read_b128 v[232:235], v250 offset:25600
    ds_read_b128 v[236:239], v250 offset:36352
    v_mfma_f32_16x16x32_bf16 v[116:119], v[196:199], v[216:219], v[116:119]
    v_mfma_f32_16x16x32_bf16 v[120:123], v[208:211], v[216:219], v[120:123]
    v_mfma_f32_16x16x32_bf16 v[124:127], v[212:215], v[216:219], v[124:127]
    v_mfma_f32_16x16x32_bf16 v[112:115], v[200:203], v[220:223], v[112:115]
    v_mfma_f32_16x16x32_bf16 v[116:119], v[204:207], v[220:223], v[116:119]
    v_mfma_f32_16x16x32_bf16 v[120:123], v[192:195], v[220:223], v[120:123]
    v_mfma_f32_16x16x32_bf16 v[124:127], v[196:199], v[220:223], v[124:127]
    s_waitcnt lgkmcnt(2)
    v_mfma_f32_16x16x32_bf16 v[128:131], v[192:195], v[224:227], v[128:131]
    ds_read_b128 v[240:243], v250 offset:26624
    ds_read_b128 v[244:247], v250 offset:37376
    v_mfma_f32_16x16x32_bf16 v[132:135], v[196:199], v[224:227], v[132:135]
    v_mfma_f32_16x16x32_bf16 v[136:139], v[208:211], v[224:227], v[136:139]
    v_mfma_f32_16x16x32_bf16 v[140:143], v[212:215], v[224:227], v[140:143]
    v_mfma_f32_16x16x32_bf16 v[128:131], v[200:203], v[228:231], v[128:131]
    v_mfma_f32_16x16x32_bf16 v[132:135], v[204:207], v[228:231], v[132:135]
    v_mfma_f32_16x16x32_bf16 v[136:139], v[192:195], v[228:231], v[136:139]
    v_mfma_f32_16x16x32_bf16 v[140:143], v[196:199], v[228:231], v[140:143]
    s_waitcnt lgkmcnt(2)
    v_mfma_f32_16x16x32_bf16 v[144:147], v[192:195], v[232:235], v[144:147]
    v_mfma_f32_16x16x32_bf16 v[148:151], v[196:199], v[232:235], v[148:151]
    v_mfma_f32_16x16x32_bf16 v[152:155], v[208:211], v[232:235], v[152:155]
    v_mfma_f32_16x16x32_bf16 v[156:159], v[212:215], v[232:235], v[156:159]
    v_mfma_f32_16x16x32_bf16 v[144:147], v[200:203], v[236:239], v[144:147]
    v_mfma_f32_16x16x32_bf16 v[148:151], v[204:207], v[236:239], v[148:151]
    v_mfma_f32_16x16x32_bf16 v[152:155], v[192:195], v[236:239], v[152:155]
    v_mfma_f32_16x16x32_bf16 v[156:159], v[196:199], v[236:239], v[156:159]
    s_waitcnt lgkmcnt(0)
    v_mfma_f32_16x16x32_bf16 v[160:163], v[192:195], v[240:243], v[160:163]
    v_mfma_f32_16x16x32_bf16 v[164:167], v[196:199], v[240:243], v[164:167]
    v_mfma_f32_16x16x32_bf16 v[168:171], v[208:211], v[240:243], v[168:171]
    v_mfma_f32_16x16x32_bf16 v[172:175], v[212:215], v[240:243], v[172:175]
    v_mfma_f32_16x16x32_bf16 v[160:163], v[200:203], v[244:247], v[160:163]
    v_mfma_f32_16x16x32_bf16 v[164:167], v[204:207], v[244:247], v[164:167]
    v_mfma_f32_16x16x32_bf16 v[168:171], v[192:195], v[244:247], v[168:171]
    v_mfma_f32_16x16x32_bf16 v[172:175], v[196:199], v[244:247], v[172:175]
    s_nop 7
    v_cvt_pk_bf16_f32 v0, v0, v1
    v_cvt_pk_bf16_f32 v1, v2, v3
    v_cvt_pk_bf16_f32 v2, v4, v5
    v_cvt_pk_bf16_f32 v3, v6, v7
    s_add_u32 s47, s48, 0
    buffer_store_dwordx4 v[0:3], v251, s[16:19], s47 offen sc1
    v_cvt_pk_bf16_f32 v8, v8, v9
    v_cvt_pk_bf16_f32 v9, v10, v11
    v_cvt_pk_bf16_f32 v10, v12, v13
    v_cvt_pk_bf16_f32 v11, v14, v15
    s_add_u32 s47, s48, 1024
    buffer_store_dwordx4 v[8:11], v251, s[16:19], s47 offen sc1
    v_cvt_pk_bf16_f32 v16, v16, v17
    v_cvt_pk_bf16_f32 v17, v18, v19
    v_cvt_pk_bf16_f32 v18, v20, v21
    v_cvt_pk_bf16_f32 v19, v22, v23
    s_add_u32 s47, s48, 1052672
    buffer_store_dwordx4 v[16:19], v251, s[16:19], s47 offen sc1
    v_cvt_pk_bf16_f32 v24, v24, v25
    v_cvt_pk_bf16_f32 v25, v26, v27
    v_cvt_pk_bf16_f32 v26, v28, v29
    v_cvt_pk_bf16_f32 v27, v30, v31
    s_add_u32 s47, s48, 1053696
    buffer_store_dwordx4 v[24:27], v251, s[16:19], s47 offen sc1
    v_cvt_pk_bf16_f32 v32, v32, v33
    v_cvt_pk_bf16_f32 v33, v34, v35
    v_cvt_pk_bf16_f32 v34, v36, v37
    v_cvt_pk_bf16_f32 v35, v38, v39
    s_add_u32 s47, s48, 2105344
    buffer_store_dwordx4 v[32:35], v251, s[16:19], s47 offen sc1
    v_cvt_pk_bf16_f32 v40, v40, v41
    v_cvt_pk_bf16_f32 v41, v42, v43
    v_cvt_pk_bf16_f32 v42, v44, v45
    v_cvt_pk_bf16_f32 v43, v46, v47
    s_add_u32 s47, s48, 2106368
    buffer_store_dwordx4 v[40:43], v251, s[16:19], s47 offen sc1
    v_cvt_pk_bf16_f32 v48, v48, v49
    v_cvt_pk_bf16_f32 v49, v50, v51
    v_cvt_pk_bf16_f32 v50, v52, v53
    v_cvt_pk_bf16_f32 v51, v54, v55
    s_add_u32 s47, s48, 3158016
    buffer_store_dwordx4 v[48:51], v251, s[16:19], s47 offen sc1
    v_cvt_pk_bf16_f32 v56, v56, v57
    v_cvt_pk_bf16_f32 v57, v58, v59
    v_cvt_pk_bf16_f32 v58, v60, v61
    v_cvt_pk_bf16_f32 v59, v62, v63
    s_add_u32 s47, s48, 3159040
    buffer_store_dwordx4 v[56:59], v251, s[16:19], s47 offen sc1
    v_cvt_pk_bf16_f32 v64, v64, v65
    v_cvt_pk_bf16_f32 v65, v66, v67
    v_cvt_pk_bf16_f32 v66, v68, v69
    v_cvt_pk_bf16_f32 v67, v70, v71
    s_add_u32 s47, s48, 4210688
    buffer_store_dwordx4 v[64:67], v251, s[16:19], s47 offen sc1
    v_cvt_pk_bf16_f32 v72, v72, v73
    v_cvt_pk_bf16_f32 v73, v74, v75
    v_cvt_pk_bf16_f32 v74, v76, v77
    v_cvt_pk_bf16_f32 v75, v78, v79
    s_add_u32 s47, s48, 4211712
    buffer_store_dwordx4 v[72:75], v251, s[16:19], s47 offen sc1
    v_cvt_pk_bf16_f32 v80, v80, v81
    v_cvt_pk_bf16_f32 v81, v82, v83
    v_cvt_pk_bf16_f32 v82, v84, v85
    v_cvt_pk_bf16_f32 v83, v86, v87
    s_add_u32 s47, s48, 5263360
    buffer_store_dwordx4 v[80:83], v251, s[16:19], s47 offen sc1
    v_cvt_pk_bf16_f32 v88, v88, v89
    v_cvt_pk_bf16_f32 v89, v90, v91
    v_cvt_pk_bf16_f32 v90, v92, v93
    v_cvt_pk_bf16_f32 v91, v94, v95
    s_add_u32 s47, s48, 5264384
    buffer_store_dwordx4 v[88:91], v251, s[16:19], s47 offen sc1
    v_cvt_pk_bf16_f32 v96, v96, v97
    v_cvt_pk_bf16_f32 v97, v98, v99
    v_cvt_pk_bf16_f32 v98, v100, v101
    v_cvt_pk_bf16_f32 v99, v102, v103
    s_add_u32 s47, s48, 6316032
    buffer_store_dwordx4 v[96:99], v251, s[16:19], s47 offen sc1
    v_cvt_pk_bf16_f32 v104, v104, v105
    v_cvt_pk_bf16_f32 v105, v106, v107
    v_cvt_pk_bf16_f32 v106, v108, v109
    v_cvt_pk_bf16_f32 v107, v110, v111
    s_add_u32 s47, s48, 6317056
    buffer_store_dwordx4 v[104:107], v251, s[16:19], s47 offen sc1
    v_cvt_pk_bf16_f32 v112, v112, v113
    v_cvt_pk_bf16_f32 v113, v114, v115
    v_cvt_pk_bf16_f32 v114, v116, v117
    v_cvt_pk_bf16_f32 v115, v118, v119
    s_add_u32 s47, s48, 7368704
    buffer_store_dwordx4 v[112:115], v251, s[16:19], s47 offen sc1
    v_cvt_pk_bf16_f32 v120, v120, v121
    v_cvt_pk_bf16_f32 v121, v122, v123
    v_cvt_pk_bf16_f32 v122, v124, v125
    v_cvt_pk_bf16_f32 v123, v126, v127
    s_add_u32 s47, s48, 7369728
    buffer_store_dwordx4 v[120:123], v251, s[16:19], s47 offen sc1
    v_cvt_pk_bf16_f32 v128, v128, v129
    v_cvt_pk_bf16_f32 v129, v130, v131
    v_cvt_pk_bf16_f32 v130, v132, v133
    v_cvt_pk_bf16_f32 v131, v134, v135
    s_add_u32 s47, s48, 8421376
    buffer_store_dwordx4 v[128:131], v251, s[16:19], s47 offen sc1
    v_cvt_pk_bf16_f32 v136, v136, v137
    v_cvt_pk_bf16_f32 v137, v138, v139
    v_cvt_pk_bf16_f32 v138, v140, v141
    v_cvt_pk_bf16_f32 v139, v142, v143
    s_add_u32 s47, s48, 8422400
    buffer_store_dwordx4 v[136:139], v251, s[16:19], s47 offen sc1
    v_cvt_pk_bf16_f32 v144, v144, v145
    v_cvt_pk_bf16_f32 v145, v146, v147
    v_cvt_pk_bf16_f32 v146, v148, v149
    v_cvt_pk_bf16_f32 v147, v150, v151
    s_add_u32 s47, s48, 9474048
    buffer_store_dwordx4 v[144:147], v251, s[16:19], s47 offen sc1
    v_cvt_pk_bf16_f32 v152, v152, v153
    v_cvt_pk_bf16_f32 v153, v154, v155
    v_cvt_pk_bf16_f32 v154, v156, v157
    v_cvt_pk_bf16_f32 v155, v158, v159
    s_add_u32 s47, s48, 9475072
    buffer_store_dwordx4 v[152:155], v251, s[16:19], s47 offen sc1
    v_cvt_pk_bf16_f32 v160, v160, v161
    v_cvt_pk_bf16_f32 v161, v162, v163
    v_cvt_pk_bf16_f32 v162, v164, v165
    v_cvt_pk_bf16_f32 v163, v166, v167
    s_add_u32 s47, s48, 10526720
    buffer_store_dwordx4 v[160:163], v252, s[16:19], s47 offen sc1
    v_cvt_pk_bf16_f32 v168, v168, v169
    v_cvt_pk_bf16_f32 v169, v170, v171
    v_cvt_pk_bf16_f32 v170, v172, v173
    v_cvt_pk_bf16_f32 v171, v174, v175
    s_add_u32 s47, s48, 10527744
    buffer_store_dwordx4 v[168:171], v252, s[16:19], s47 offen sc1
    s_endpgm
L_k3_helper:
    s_mul_i32 s40, s11, 16384
    s_mul_i32 s20, s14, 16777216
    s_add_u32 s40, s40, s20
    s_mul_i32 s41, s11, 21504
    s_mul_i32 s20, s13, 22020096
    s_add_u32 s41, s41, s20
    s_add_u32 s41, s41, 67108864
    s_lshl_b32 s42, s15, 12
    s_mul_i32 s43, s15, 5376
    v_lshlrev_b32 v1, 4, v0
    v_add_u32 v2, s43, v1
    v_add_u32 v1, s42, v1
    s_add_u32 s43, s43, 16384
    s_cmp_ge_u32 s2, 8
    s_cbranch_scc1 L_nozero
    s_cmp_lg_u32 s15, 0
    s_cbranch_scc1 L_nozero
    s_mul_i32 s20, s2, 8448
    s_add_u32 s20, s20, 147849216
    v_mov_b32 v3, 0
    v_lshlrev_b32 v4, 2, v0
    buffer_store_dword v3, v4, s[16:19], s20 offen
L_nozero:
    s_add_u32 m0, s42, 0
    s_nop 0
    buffer_load_dwordx4 v1, s[16:19], s40 offen offset:0 lds
    buffer_load_dwordx4 v1, s[16:19], s40 offen offset:1024 lds
    buffer_load_dwordx4 v1, s[16:19], s40 offen offset:2048 lds
    buffer_load_dwordx4 v1, s[16:19], s40 offen offset:3072 lds
    s_add_u32 s40, s40, 524288
    s_add_u32 m0, s43, 0
    s_nop 0
    buffer_load_dwordx4 v2, s[16:19], s41 offen offset:0 lds
    buffer_load_dwordx4 v2, s[16:19], s41 offen offset:1024 lds
    buffer_load_dwordx4 v2, s[16:19], s41 offen offset:2048 lds
    buffer_load_dwordx4 v2, s[16:19], s41 offen offset:3072 lds
    s_add_u32 m0, s43, 4096
    s_add_u32 s49, s41, 4096
    buffer_load_dwordx4 v2, s[16:19], s49 offen lds
    s_mov_b64 exec, 0xffff
    buffer_load_dwordx4 v2, s[16:19], s49 offen offset:1024 lds
    s_mov_b64 exec, -1
    s_add_u32 s41, s41, 688128
    s_add_u32 m0, s42, 37888
    s_nop 0
    buffer_load_dwordx4 v1, s[16:19], s40 offen offset:0 lds
    buffer_load_dwordx4 v1, s[16:19], s40 offen offset:1024 lds
    buffer_load_dwordx4 v1, s[16:19], s40 offen offset:2048 lds
    buffer_load_dwordx4 v1, s[16:19], s40 offen offset:3072 lds
    s_add_u32 s40, s40, 524288
    s_add_u32 m0, s43, 37888
    s_nop 0
    buffer_load_dwordx4 v2, s[16:19], s41 offen offset:0 lds
    buffer_load_dwordx4 v2, s[16:19], s41 offen offset:1024 lds
    buffer_load_dwordx4 v2, s[16:19], s41 offen offset:2048 lds
    buffer_load_dwordx4 v2, s[16:19], s41 offen offset:3072 lds
    s_add_u32 m0, s43, 41984
    s_add_u32 s49, s41, 4096
    buffer_load_dwordx4 v2, s[16:19], s49 offen lds
    s_mov_b64 exec, 0xffff
    buffer_load_dwordx4 v2, s[16:19], s49 offen offset:1024 lds
    s_mov_b64 exec, -1
    s_add_u32 s41, s41, 688128
    s_add_u32 m0, s42, 75776
    s_nop 0
    buffer_load_dwordx4 v1, s[16:19], s40 offen offset:0 lds
    buffer_load_dwordx4 v1, s[16:19], s40 offen offset:1024 lds
    buffer_load_dwordx4 v1, s[16:19], s40 offen offset:2048 lds
    buffer_load_dwordx4 v1, s[16:19], s40 offen offset:3072 lds
    s_add_u32 s40, s40, 524288
    s_add_u32 m0, s43, 75776
    s_nop 0
    buffer_load_dwordx4 v2, s[16:19], s41 offen offset:0 lds
    buffer_load_dwordx4 v2, s[16:19], s41 offen offset:1024 lds
    buffer_load_dwordx4 v2, s[16:19], s41 offen offset:2048 lds
    buffer_load_dwordx4 v2, s[16:19], s41 offen offset:3072 lds
    s_add_u32 m0, s43, 79872
    s_add_u32 s49, s41, 4096
    buffer_load_dwordx4 v2, s[16:19], s49 offen lds
    s_mov_b64 exec, 0xffff
    buffer_load_dwordx4 v2, s[16:19], s49 offen offset:1024 lds
    s_mov_b64 exec, -1
    s_add_u32 s41, s41, 688128
    s_waitcnt vmcnt(20)
    s_barrier
    s_mov_b32 s46, 7
L_h_loop:
    s_waitcnt vmcnt(10)
    s_barrier
    s_add_u32 m0, s42, 113664
    s_nop 0
    buffer_load_dwordx4 v1, s[16:19], s40 offen offset:0 lds
    buffer_load_dwordx4 v1, s[16:19], s40 offen offset:1024 lds
    buffer_load_dwordx4 v1, s[16:19], s40 offen offset:2048 lds
    buffer_load_dwordx4 v1, s[16:19], s40 offen offset:3072 lds
    s_add_u32 s40, s40, 524288
    s_add_u32 m0, s43, 113664
    s_nop 0
    buffer_load_dwordx4 v2, s[16:19], s41 offen offset:0 lds
    buffer_load_dwordx4 v2, s[16:19], s41 offen offset:1024 lds
    buffer_load_dwordx4 v2, s[16:19], s41 offen offset:2048 lds
    buffer_load_dwordx4 v2, s[16:19], s41 offen offset:3072 lds
    s_add_u32 m0, s43, 117760
    s_add_u32 s49, s41, 4096
    buffer_load_dwordx4 v2, s[16:19], s49 offen lds
    s_mov_b64 exec, 0xffff
    buffer_load_dwordx4 v2, s[16:19], s49 offen offset:1024 lds
    s_mov_b64 exec, -1
    s_add_u32 s41, s41, 688128
    s_waitcnt vmcnt(10)
    s_barrier
    s_add_u32 m0, s42, 0
    s_nop 0
    buffer_load_dwordx4 v1, s[16:19], s40 offen offset:0 lds
    buffer_load_dwordx4 v1, s[16:19], s40 offen offset:1024 lds
    buffer_load_dwordx4 v1, s[16:19], s40 offen offset:2048 lds
    buffer_load_dwordx4 v1, s[16:19], s40 offen offset:3072 lds
    s_add_u32 s40, s40, 524288
    s_add_u32 m0, s43, 0
    s_nop 0
    buffer_load_dwordx4 v2, s[16:19], s41 offen offset:0 lds
    buffer_load_dwordx4 v2, s[16:19], s41 offen offset:1024 lds
    buffer_load_dwordx4 v2, s[16:19], s41 offen offset:2048 lds
    buffer_load_dwordx4 v2, s[16:19], s41 offen offset:3072 lds
    s_add_u32 m0, s43, 4096
    s_add_u32 s49, s41, 4096
    buffer_load_dwordx4 v2, s[16:19], s49 offen lds
    s_mov_b64 exec, 0xffff
    buffer_load_dwordx4 v2, s[16:19], s49 offen offset:1024 lds
    s_mov_b64 exec, -1
    s_add_u32 s41, s41, 688128
    s_waitcnt vmcnt(10)
    s_barrier
    s_add_u32 m0, s42, 37888
    s_nop 0
    buffer_load_dwordx4 v1, s[16:19], s40 offen offset:0 lds
    buffer_load_dwordx4 v1, s[16:19], s40 offen offset:1024 lds
    buffer_load_dwordx4 v1, s[16:19], s40 offen offset:2048 lds
    buffer_load_dwordx4 v1, s[16:19], s40 offen offset:3072 lds
    s_add_u32 s40, s40, 524288
    s_add_u32 m0, s43, 37888
    s_nop 0
    buffer_load_dwordx4 v2, s[16:19], s41 offen offset:0 lds
    buffer_load_dwordx4 v2, s[16:19], s41 offen offset:1024 lds
    buffer_load_dwordx4 v2, s[16:19], s41 offen offset:2048 lds
    buffer_load_dwordx4 v2, s[16:19], s41 offen offset:3072 lds
    s_add_u32 m0, s43, 41984
    s_add_u32 s49, s41, 4096
    buffer_load_dwordx4 v2, s[16:19], s49 offen lds
    s_mov_b64 exec, 0xffff
    buffer_load_dwordx4 v2, s[16:19], s49 offen offset:1024 lds
    s_mov_b64 exec, -1
    s_add_u32 s41, s41, 688128
    s_waitcnt vmcnt(10)
    s_barrier
    s_add_u32 m0, s42, 75776
    s_nop 0
    buffer_load_dwordx4 v1, s[16:19], s40 offen offset:0 lds
    buffer_load_dwordx4 v1, s[16:19], s40 offen offset:1024 lds
    buffer_load_dwordx4 v1, s[16:19], s40 offen offset:2048 lds
    buffer_load_dwordx4 v1, s[16:19], s40 offen offset:3072 lds
    s_add_u32 s40, s40, 524288
    s_add_u32 m0, s43, 75776
    s_nop 0
    buffer_load_dwordx4 v2, s[16:19], s41 offen offset:0 lds
    buffer_load_dwordx4 v2, s[16:19], s41 offen offset:1024 lds
    buffer_load_dwordx4 v2, s[16:19], s41 offen offset:2048 lds
    buffer_load_dwordx4 v2, s[16:19], s41 offen offset:3072 lds
    s_add_u32 m0, s43, 79872
    s_add_u32 s49, s41, 4096
    buffer_load_dwordx4 v2, s[16:19], s49 offen lds
    s_mov_b64 exec, 0xffff
    buffer_load_dwordx4 v2, s[16:19], s49 offen offset:1024 lds
    s_mov_b64 exec, -1
    s_add_u32 s41, s41, 688128
    s_sub_u32 s46, s46, 1
    s_cmp_lg_u32 s46, 0
    s_cbranch_scc1 L_h_loop
    s_waitcnt vmcnt(10)
    s_barrier
    s_add_u32 m0, s42, 113664
    s_nop 0
    buffer_load_dwordx4 v1, s[16:19], s40 offen offset:0 lds
    buffer_load_dwordx4 v1, s[16:19], s40 offen offset:1024 lds
    buffer_load_dwordx4 v1, s[16:19], s40 offen offset:2048 lds
    buffer_load_dwordx4 v1, s[16:19], s40 offen offset:3072 lds
    s_add_u32 s40, s40, 524288
    s_add_u32 m0, s43, 113664
    s_nop 0
    buffer_load_dwordx4 v2, s[16:19], s41 offen offset:0 lds
    buffer_load_dwordx4 v2, s[16:19], s41 offen offset:1024 lds
    buffer_load_dwordx4 v2, s[16:19], s41 offen offset:2048 lds
    buffer_load_dwordx4 v2, s[16:19], s41 offen offset:3072 lds
    s_add_u32 m0, s43, 117760
    s_add_u32 s49, s41, 4096
    buffer_load_dwordx4 v2, s[16:19], s49 offen lds
    s_mov_b64 exec, 0xffff
    buffer_load_dwordx4 v2, s[16:19], s49 offen offset:1024 lds
    s_mov_b64 exec, -1
    s_add_u32 s41, s41, 688128
    s_waitcnt vmcnt(10)
    s_barrier
    s_waitcnt vmcnt(0)
    s_barrier
    s_endpgm
L_k3_end:
    s_endpgm
.globl final_kernel
.p2align 8
.type final_kernel,@function
final_kernel:
    s_cmp_ge_u32 s2, 336
    s_cbranch_scc1 L_k45_end
    s_load_dwordx4 s[4:7], s[0:1], 16
    s_load_dwordx2 s[8:9], s[0:1], 48
    s_load_dwordx2 s[28:29], s[0:1], 32
    v_lshlrev_b32 v214, 2, v0
    v_and_b32 v200, 63, v0
    v_lshrrev_b32 v204, 6, v0
    v_and_b32 v201, 15, v200
    v_readfirstlane_b32 s10, v204
    v_lshrrev_b32 v202, 4, v200
    s_mov_b32 s30, 0x05040100
    s_mov_b32 s31, 0x07060302
    s_and_b32 s13, s2, 3
    s_lshr_b32 s12, s2, 2
    s_cmp_ge_u32 s12, 42
    s_cselect_b32 s11, 1, 0
    s_mul_i32 s15, s11, 42
    s_sub_u32 s12, s12, s15
    s_lshl_b32 s14, s12, 2
    s_add_u32 s14, s14, s10
    s_waitcnt lgkmcnt(0)
    s_mov_b32 s16, s8
    s_and_b32 s17, s9, 0xffff
    s_mov_b32 s18, 268435456
    s_mov_b32 s19, 0x00020000
    s_mov_b32 s24, 8192
    v_mul_u32_u24 v203, s24, v202
    v_lshl_add_u32 v203, v201, 4, v203
    s_mul_i32 s24, s11, 11579392
    s_mul_i32 s25, s14, 65792
    s_add_u32 s24, s24, s25
    s_lshl_b32 s25, s13, 8
    s_add_u32 s24, s24, s25
    s_add_u32 s24, s24, 117440512
    s_add_u32 s25, s24, 0
    buffer_load_dwordx4 v[0:3], v203, s[16:19], s25 offen
    s_add_u32 s25, s24, 1024
    buffer_load_dwordx4 v[4:7], v203, s[16:19], s25 offen
    s_add_u32 s25, s24, 2048
    buffer_load_dwordx4 v[8:11], v203, s[16:19], s25 offen
    s_add_u32 s25, s24, 3072
    buffer_load_dwordx4 v[12:15], v203, s[16:19], s25 offen
    s_add_u32 s25, s24, 4096
    buffer_load_dwordx4 v[16:19], v203, s[16:19], s25 offen
    s_add_u32 s25, s24, 5120
    buffer_load_dwordx4 v[20:23], v203, s[16:19], s25 offen
    s_add_u32 s25, s24, 6144
    buffer_load_dwordx4 v[24:27], v203, s[16:19], s25 offen
    s_add_u32 s25, s24, 7168
    buffer_load_dwordx4 v[28:31], v203, s[16:19], s25 offen
    s_add_u32 s25, s24, 32768
    buffer_load_dwordx4 v[32:35], v203, s[16:19], s25 offen
    s_add_u32 s25, s24, 33792
    buffer_load_dwordx4 v[36:39], v203, s[16:19], s25 offen
    s_add_u32 s25, s24, 34816
    buffer_load_dwordx4 v[40:43], v203, s[16:19], s25 offen
    s_add_u32 s25, s24, 35840
    buffer_load_dwordx4 v[44:47], v203, s[16:19], s25 offen
    s_add_u32 s25, s24, 36864
    buffer_load_dwordx4 v[48:51], v203, s[16:19], s25 offen
    s_add_u32 s25, s24, 37888
    buffer_load_dwordx4 v[52:55], v203, s[16:19], s25 offen
    s_add_u32 s25, s24, 38912
    buffer_load_dwordx4 v[56:59], v203, s[16:19], s25 offen
    s_add_u32 s25, s24, 39936
    buffer_load_dwordx4 v[60:63], v203, s[16:19], s25 offen
    s_cmp_ge_u32 s10, 3
    s_cbranch_scc1 L_k45_notab
    s_lshl_b32 s25, s10, 4
    v_add_u32 v204, s25, v201
    v_lshlrev_b32 v205, 3, v202
    v_add_u32 v205, 1, v205
    v_mul_u32_u24 v88, v205, v204
    v_add_u32 v89, 32, v88
    v_add_u32 v205, 2, v205
    v_mul_u32_u24 v90, v205, v204
    v_add_u32 v91, 32, v90
    v_add_u32 v205, 2, v205
    v_mul_u32_u24 v92, v205, v204
    v_add_u32 v93, 32, v92
    v_add_u32 v205, 2, v205
    v_mul_u32_u24 v94, v205, v204
    v_add_u32 v95, 32, v94
    v_and_b32 v88, 127, v88
    v_cvt_f32_u32 v88, v88
    v_mul_f32 v88, 0x3c000000, v88
    v_cos_f32 v88, v88
    v_and_b32 v89, 127, v89
    v_cvt_f32_u32 v89, v89
    v_mul_f32 v89, 0x3c000000, v89
    v_cos_f32 v89, v89
    v_and_b32 v90, 127, v90
    v_cvt_f32_u32 v90, v90
    v_mul_f32 v90, 0x3c000000, v90
    v_cos_f32 v90, v90
    v_and_b32 v91, 127, v91
    v_cvt_f32_u32 v91, v91
    v_mul_f32 v91, 0x3c000000, v91
    v_cos_f32 v91, v91
    v_and_b32 v92, 127, v92
    v_cvt_f32_u32 v92, v92
    v_mul_f32 v92, 0x3c000000, v92
    v_cos_f32 v92, v92
    v_and_b32 v93, 127, v93
    v_cvt_f32_u32 v93, v93
    v_mul_f32 v93, 0x3c000000, v93
    v_cos_f32 v93, v93
    v_and_b32 v94, 127, v94
    v_cvt_f32_u32 v94, v94
    v_mul_f32 v94, 0x3c000000, v94
    v_cos_f32 v94, v94
    v_and_b32 v95, 127, v95
    v_cvt_f32_u32 v95, v95
    v_mul_f32 v95, 0x3c000000, v95
    v_cos_f32 v95, v95
    v_mul_f32 v88, 0x3d000000, v88
    v_mul_f32 v89, 0x3d000000, v89
    v_mul_f32 v90, 0x3d000000, v90
    v_mul_f32 v91, 0x3d000000, v91
    v_mul_f32 v92, 0x3d000000, v92
    v_mul_f32 v93, 0x3d000000, v93
    v_mul_f32 v94, 0x3d000000, v94
    v_mul_f32 v95, 0x3d000000, v95
    v_cvt_pk_bf16_f32 v104, v88, v89
    v_cvt_pk_bf16_f32 v105, v90, v91
    v_cvt_pk_bf16_f32 v106, v92, v93
    v_cvt_pk_bf16_f32 v107, v94, v95
    s_lshl_b32 s25, s10, 11
    v_lshlrev_b32 v207, 4, v200
    v_add_u32 v207, s25, v207
    ds_write_b128 v207, v[104:107] offset:0
    v_lshlrev_b32 v205, 3, v202
    v_add_u32 v205, 33, v205
    v_mul_u32_u24 v88, v205, v204
    v_add_u32 v89, 32, v88
    v_add_u32 v205, 2, v205
    v_mul_u32_u24 v90, v205, v204
    v_add_u32 v91, 32, v90
    v_add_u32 v205, 2, v205
    v_mul_u32_u24 v92, v205, v204
    v_add_u32 v93, 32, v92
    v_add_u32 v205, 2, v205
    v_mul_u32_u24 v94, v205, v204
    v_add_u32 v95, 32, v94
    v_and_b32 v88, 127, v88
    v_cvt_f32_u32 v88, v88
    v_mul_f32 v88, 0x3c000000, v88
    v_cos_f32 v88, v88
    v_and_b32 v89, 127, v89
    v_cvt_f32_u32 v89, v89
    v_mul_f32 v89, 0x3c000000, v89
    v_cos_f32 v89, v89
    v_and_b32 v90, 127, v90
    v_cvt_f32_u32 v90, v90
    v_mul_f32 v90, 0x3c000000, v90
    v_cos_f32 v90, v90
    v_and_b32 v91, 127, v91
    v_cvt_f32_u32 v91, v91
    v_mul_f32 v91, 0x3c000000, v91
    v_cos_f32 v91, v91
    v_and_b32 v92, 127, v92
    v_cvt_f32_u32 v92, v92
    v_mul_f32 v92, 0x3c000000, v92
    v_cos_f32 v92, v92
    v_and_b32 v93, 127, v93
    v_cvt_f32_u32 v93, v93
    v_mul_f32 v93, 0x3c000000, v93
    v_cos_f32 v93, v93
    v_and_b32 v94, 127, v94
    v_cvt_f32_u32 v94, v94
    v_mul_f32 v94, 0x3c000000, v94
    v_cos_f32 v94, v94
    v_and_b32 v95, 127, v95
    v_cvt_f32_u32 v95, v95
    v_mul_f32 v95, 0x3c000000, v95
    v_cos_f32 v95, v95
    v_mul_f32 v88, 0x3d000000, v88
    v_mul_f32 v89, 0x3d000000, v89
    v_mul_f32 v90, 0x3d000000, v90
    v_mul_f32 v91, 0x3d000000, v91
    v_mul_f32 v92, 0x3d000000, v92
    v_mul_f32 v93, 0x3d000000, v93
    v_mul_f32 v94, 0x3d000000, v94
    v_mul_f32 v95, 0x3d000000, v95
    v_cvt_pk_bf16_f32 v104, v88, v89
    v_cvt_pk_bf16_f32 v105, v90, v91
    v_cvt_pk_bf16_f32 v106, v92, v93
    v_cvt_pk_bf16_f32 v107, v94, v95
    s_lshl_b32 s25, s10, 11
    v_lshlrev_b32 v207, 4, v200
    v_add_u32 v207, s25, v207
    ds_write_b128 v207, v[104:107] offset:1024
L_k45_notab:
    s_mov_b32 s20, s4
    s_and_b32 s21, s5, 0xffff
    s_mov_b32 s22, 1024
    s_mov_b32 s23, 0x00020000
    s_mov_b32 s36, s6
    s_and_b32 s37, s7, 0xffff
    s_mov_b32 s38, 1024
    s_mov_b32 s39, 0x00020000
    v_lshlrev_b32 v210, 4, v201
    s_lshl_b32 s25, s13, 8
    buffer_load_dwordx4 v[232:235], v210, s[20:23], s25 offen
    buffer_load_dwordx4 v[236:239], v210, s[36:39], s25 offen
    s_waitcnt lgkmcnt(0)
    s_barrier
    v_lshlrev_b32 v207, 4, v200
    ds_read_b128 v[64:67], v207 offset:0
    ds_read_b128 v[68:71], v207 offset:1024
    ds_read_b128 v[72:75], v207 offset:2048
    ds_read_b128 v[76:79], v207 offset:3072
    ds_read_b128 v[80:83], v207 offset:4096
    ds_read_b128 v[84:87], v207 offset:5120
    s_cmp_ge_u32 s14, 167
    s_cbranch_scc1 L_k45_zero
    s_waitcnt lgkmcnt(0)
    s_cmp_lg_u32 s14, 166
    s_cbranch_scc1 L_k45_full
    v_cmp_gt_i32 vcc, 17, v201
    s_nop 1
    v_cndmask_b32 v64, 0, v64, vcc
    v_cndmask_b32 v65, 0, v65, vcc
    v_cndmask_b32 v66, 0, v66, vcc
    v_cndmask_b32 v67, 0, v67, vcc
    v_cndmask_b32 v68, 0, v68, vcc
    v_cndmask_b32 v69, 0, v69, vcc
    v_cndmask_b32 v70, 0, v70, vcc
    v_cndmask_b32 v71, 0, v71, vcc
    v_cmp_gt_i32 vcc, 1, v201
    s_nop 1
    v_cndmask_b32 v72, 0, v72, vcc
    v_cndmask_b32 v73, 0, v73, vcc
    v_cndmask_b32 v74, 0, v74, vcc
    v_cndmask_b32 v75, 0, v75, vcc
    v_cndmask_b32 v76, 0, v76, vcc
    v_cndmask_b32 v77, 0, v77, vcc
    v_cndmask_b32 v78, 0, v78, vcc
    v_cndmask_b32 v79, 0, v79, vcc
    v_cmp_gt_i32 vcc, 0, v201
    s_nop 1
    v_cndmask_b32 v80, 0, v80, vcc
    v_cndmask_b32 v81, 0, v81, vcc
    v_cndmask_b32 v82, 0, v82, vcc
    v_cndmask_b32 v83, 0, v83, vcc
    v_cndmask_b32 v84, 0, v84, vcc
    v_cndmask_b32 v85, 0, v85, vcc
    v_cndmask_b32 v86, 0, v86, vcc
    v_cndmask_b32 v87, 0, v87, vcc
L_k45_full:
    s_waitcnt vmcnt(2)
    v_perm_b32 v88, v4, v0, s30
    v_perm_b32 v89, v12, v8, s30
    v_perm_b32 v90, v20, v16, s30
    v_perm_b32 v91, v28, v24, s30
    v_perm_b32 v92, v4, v0, s31
    v_perm_b32 v93, v12, v8, s31
    v_perm_b32 v94, v20, v16, s31
    v_perm_b32 v95, v28, v24, s31
    v_perm_b32 v96, v36, v32, s30
    v_perm_b32 v97, v44, v40, s30
    v_perm_b32 v98, v52, v48, s30
    v_perm_b32 v99, v60, v56, s30
    v_perm_b32 v100, v36, v32, s31
    v_perm_b32 v101, v44, v40, s31
    v_perm_b32 v102, v52, v48, s31
    v_perm_b32 v103, v60, v56, s31
    v_mfma_f32_16x16x32_bf16 v[104:107], v[64:67], v[88:91], 0
    v_mfma_f32_16x16x32_bf16 v[108:111], v[64:67], v[92:95], 0
    v_mfma_f32_16x16x32_bf16 v[136:139], v[72:75], v[88:91], 0
    v_mfma_f32_16x16x32_bf16 v[140:143], v[72:75], v[92:95], 0
    v_mfma_f32_16x16x32_bf16 v[168:171], v[80:83], v[88:91], 0
    v_mfma_f32_16x16x32_bf16 v[172:175], v[80:83], v[92:95], 0
    v_mfma_f32_16x16x32_bf16 v[104:107], v[68:71], v[96:99], v[104:107]
    v_mfma_f32_16x16x32_bf16 v[108:111], v[68:71], v[100:103], v[108:111]
    v_mfma_f32_16x16x32_bf16 v[136:139], v[76:79], v[96:99], v[136:139]
    v_mfma_f32_16x16x32_bf16 v[140:143], v[76:79], v[100:103], v[140:143]
    v_mfma_f32_16x16x32_bf16 v[168:171], v[84:87], v[96:99], v[168:171]
    v_mfma_f32_16x16x32_bf16 v[172:175], v[84:87], v[100:103], v[172:175]
    v_perm_b32 v88, v5, v1, s30
    v_perm_b32 v89, v13, v9, s30
    v_perm_b32 v90, v21, v17, s30
    v_perm_b32 v91, v29, v25, s30
    v_perm_b32 v92, v5, v1, s31
    v_perm_b32 v93, v13, v9, s31
    v_perm_b32 v94, v21, v17, s31
    v_perm_b32 v95, v29, v25, s31
    v_perm_b32 v96, v37, v33, s30
    v_perm_b32 v97, v45, v41, s30
    v_perm_b32 v98, v53, v49, s30
    v_perm_b32 v99, v61, v57, s30
    v_perm_b32 v100, v37, v33, s31
    v_perm_b32 v101, v45, v41, s31
    v_perm_b32 v102, v53, v49, s31
    v_perm_b32 v103, v61, v57, s31
    v_mfma_f32_16x16x32_bf16 v[112:115], v[64:67], v[88:91], 0
    v_mfma_f32_16x16x32_bf16 v[116:119], v[64:67], v[92:95], 0
    v_mfma_f32_16x16x32_bf16 v[144:147], v[72:75], v[88:91], 0
    v_mfma_f32_16x16x32_bf16 v[148:151], v[72:75], v[92:95], 0
    v_mfma_f32_16x16x32_bf16 v[176:179], v[80:83], v[88:91], 0
    v_mfma_f32_16x16x32_bf16 v[180:183], v[80:83], v[92:95], 0
    v_mfma_f32_16x16x32_bf16 v[112:115], v[68:71], v[96:99], v[112:115]
    v_mfma_f32_16x16x32_bf16 v[116:119], v[68:71], v[100:103], v[116:119]
    v_mfma_f32_16x16x32_bf16 v[144:147], v[76:79], v[96:99], v[144:147]
    v_mfma_f32_16x16x32_bf16 v[148:151], v[76:79], v[100:103], v[148:151]
    v_mfma_f32_16x16x32_bf16 v[176:179], v[84:87], v[96:99], v[176:179]
    v_mfma_f32_16x16x32_bf16 v[180:183], v[84:87], v[100:103], v[180:183]
    v_perm_b32 v88, v6, v2, s30
    v_perm_b32 v89, v14, v10, s30
    v_perm_b32 v90, v22, v18, s30
    v_perm_b32 v91, v30, v26, s30
    v_perm_b32 v92, v6, v2, s31
    v_perm_b32 v93, v14, v10, s31
    v_perm_b32 v94, v22, v18, s31
    v_perm_b32 v95, v30, v26, s31
    v_perm_b32 v96, v38, v34, s30
    v_perm_b32 v97, v46, v42, s30
    v_perm_b32 v98, v54, v50, s30
    v_perm_b32 v99, v62, v58, s30
    v_perm_b32 v100, v38, v34, s31
    v_perm_b32 v101, v46, v42, s31
    v_perm_b32 v102, v54, v50, s31
    v_perm_b32 v103, v62, v58, s31
    v_mfma_f32_16x16x32_bf16 v[120:123], v[64:67], v[88:91], 0
    v_mfma_f32_16x16x32_bf16 v[124:127], v[64:67], v[92:95], 0
    v_mfma_f32_16x16x32_bf16 v[152:155], v[72:75], v[88:91], 0
    v_mfma_f32_16x16x32_bf16 v[156:159], v[72:75], v[92:95], 0
    v_mfma_f32_16x16x32_bf16 v[184:187], v[80:83], v[88:91], 0
    v_mfma_f32_16x16x32_bf16 v[188:191], v[80:83], v[92:95], 0
    v_mfma_f32_16x16x32_bf16 v[120:123], v[68:71], v[96:99], v[120:123]
    v_mfma_f32_16x16x32_bf16 v[124:127], v[68:71], v[100:103], v[124:127]
    v_mfma_f32_16x16x32_bf16 v[152:155], v[76:79], v[96:99], v[152:155]
    v_mfma_f32_16x16x32_bf16 v[156:159], v[76:79], v[100:103], v[156:159]
    v_mfma_f32_16x16x32_bf16 v[184:187], v[84:87], v[96:99], v[184:187]
    v_mfma_f32_16x16x32_bf16 v[188:191], v[84:87], v[100:103], v[188:191]
    v_perm_b32 v88, v7, v3, s30
    v_perm_b32 v89, v15, v11, s30
    v_perm_b32 v90, v23, v19, s30
    v_perm_b32 v91, v31, v27, s30
    v_perm_b32 v92, v7, v3, s31
    v_perm_b32 v93, v15, v11, s31
    v_perm_b32 v94, v23, v19, s31
    v_perm_b32 v95, v31, v27, s31
    v_perm_b32 v96, v39, v35, s30
    v_perm_b32 v97, v47, v43, s30
    v_perm_b32 v98, v55, v51, s30
    v_perm_b32 v99, v63, v59, s30
    v_perm_b32 v100, v39, v35, s31
    v_perm_b32 v101, v47, v43, s31
    v_perm_b32 v102, v55, v51, s31
    v_perm_b32 v103, v63, v59, s31
    v_mfma_f32_16x16x32_bf16 v[128:131], v[64:67], v[88:91], 0
    v_mfma_f32_16x16x32_bf16 v[132:135], v[64:67], v[92:95], 0
    v_mfma_f32_16x16x32_bf16 v[160:163], v[72:75], v[88:91], 0
    v_mfma_f32_16x16x32_bf16 v[164:167], v[72:75], v[92:95], 0
    v_mfma_f32_16x16x32_bf16 v[192:195], v[80:83], v[88:91], 0
    v_mfma_f32_16x16x32_bf16 v[196:199], v[80:83], v[92:95], 0
    v_mfma_f32_16x16x32_bf16 v[128:131], v[68:71], v[96:99], v[128:131]
    v_mfma_f32_16x16x32_bf16 v[132:135], v[68:71], v[100:103], v[132:135]
    v_mfma_f32_16x16x32_bf16 v[160:163], v[76:79], v[96:99], v[160:163]
    v_mfma_f32_16x16x32_bf16 v[164:167], v[76:79], v[100:103], v[164:167]
    v_mfma_f32_16x16x32_bf16 v[192:195], v[84:87], v[96:99], v[192:195]
    v_mfma_f32_16x16x32_bf16 v[196:199], v[84:87], v[100:103], v[196:199]
    s_nop 7
    v_mul_f32 v224, v104, v104
    v_mov_b32 v216, v104
    v_fmac_f32 v224, v105, v105
    v_add_f32 v216, v216, v105
    v_fmac_f32 v224, v106, v106
    v_add_f32 v216, v216, v106
    v_fmac_f32 v224, v107, v107
    v_add_f32 v216, v216, v107
    v_fmac_f32 v224, v136, v136
    v_add_f32 v216, v216, v136
    v_fmac_f32 v224, v137, v137
    v_add_f32 v216, v216, v137
    v_fmac_f32 v224, v138, v138
    v_add_f32 v216, v216, v138
    v_fmac_f32 v224, v139, v139
    v_add_f32 v216, v216, v139
    v_fmac_f32 v224, v168, v168
    v_add_f32 v216, v216, v168
    v_fmac_f32 v224, v169, v169
    v_add_f32 v216, v216, v169
    v_fmac_f32 v224, v170, v170
    v_add_f32 v216, v216, v170
    v_fmac_f32 v224, v171, v171
    v_add_f32 v216, v216, v171
    v_mul_f32 v225, v108, v108
    v_mov_b32 v217, v108
    v_fmac_f32 v225, v109, v109
    v_add_f32 v217, v217, v109
    v_fmac_f32 v225, v110, v110
    v_add_f32 v217, v217, v110
    v_fmac_f32 v225, v111, v111
    v_add_f32 v217, v217, v111
    v_fmac_f32 v225, v140, v140
    v_add_f32 v217, v217, v140
    v_fmac_f32 v225, v141, v141
    v_add_f32 v217, v217, v141
    v_fmac_f32 v225, v142, v142
    v_add_f32 v217, v217, v142
    v_fmac_f32 v225, v143, v143
    v_add_f32 v217, v217, v143
    v_fmac_f32 v225, v172, v172
    v_add_f32 v217, v217, v172
    v_fmac_f32 v225, v173, v173
    v_add_f32 v217, v217, v173
    v_fmac_f32 v225, v174, v174
    v_add_f32 v217, v217, v174
    v_fmac_f32 v225, v175, v175
    v_add_f32 v217, v217, v175
    v_mul_f32 v226, v112, v112
    v_mov_b32 v218, v112
    v_fmac_f32 v226, v113, v113
    v_add_f32 v218, v218, v113
    v_fmac_f32 v226, v114, v114
    v_add_f32 v218, v218, v114
    v_fmac_f32 v226, v115, v115
    v_add_f32 v218, v218, v115
    v_fmac_f32 v226, v144, v144
    v_add_f32 v218, v218, v144
    v_fmac_f32 v226, v145, v145
    v_add_f32 v218, v218, v145
    v_fmac_f32 v226, v146, v146
    v_add_f32 v218, v218, v146
    v_fmac_f32 v226, v147, v147
    v_add_f32 v218, v218, v147
    v_fmac_f32 v226, v176, v176
    v_add_f32 v218, v218, v176
    v_fmac_f32 v226, v177, v177
    v_add_f32 v218, v218, v177
    v_fmac_f32 v226, v178, v178
    v_add_f32 v218, v218, v178
    v_fmac_f32 v226, v179, v179
    v_add_f32 v218, v218, v179
    v_mul_f32 v227, v116, v116
    v_mov_b32 v219, v116
    v_fmac_f32 v227, v117, v117
    v_add_f32 v219, v219, v117
    v_fmac_f32 v227, v118, v118
    v_add_f32 v219, v219, v118
    v_fmac_f32 v227, v119, v119
    v_add_f32 v219, v219, v119
    v_fmac_f32 v227, v148, v148
    v_add_f32 v219, v219, v148
    v_fmac_f32 v227, v149, v149
    v_add_f32 v219, v219, v149
    v_fmac_f32 v227, v150, v150
    v_add_f32 v219, v219, v150
    v_fmac_f32 v227, v151, v151
    v_add_f32 v219, v219, v151
    v_fmac_f32 v227, v180, v180
    v_add_f32 v219, v219, v180
    v_fmac_f32 v227, v181, v181
    v_add_f32 v219, v219, v181
    v_fmac_f32 v227, v182, v182
    v_add_f32 v219, v219, v182
    v_fmac_f32 v227, v183, v183
    v_add_f32 v219, v219, v183
    v_mul_f32 v228, v120, v120
    v_mov_b32 v220, v120
    v_fmac_f32 v228, v121, v121
    v_add_f32 v220, v220, v121
    v_fmac_f32 v228, v122, v122
    v_add_f32 v220, v220, v122
    v_fmac_f32 v228, v123, v123
    v_add_f32 v220, v220, v123
    v_fmac_f32 v228, v152, v152
    v_add_f32 v220, v220, v152
    v_fmac_f32 v228, v153, v153
    v_add_f32 v220, v220, v153
    v_fmac_f32 v228, v154, v154
    v_add_f32 v220, v220, v154
    v_fmac_f32 v228, v155, v155
    v_add_f32 v220, v220, v155
    v_fmac_f32 v228, v184, v184
    v_add_f32 v220, v220, v184
    v_fmac_f32 v228, v185, v185
    v_add_f32 v220, v220, v185
    v_fmac_f32 v228, v186, v186
    v_add_f32 v220, v220, v186
    v_fmac_f32 v228, v187, v187
    v_add_f32 v220, v220, v187
    v_mul_f32 v229, v124, v124
    v_mov_b32 v221, v124
    v_fmac_f32 v229, v125, v125
    v_add_f32 v221, v221, v125
    v_fmac_f32 v229, v126, v126
    v_add_f32 v221, v221, v126
    v_fmac_f32 v229, v127, v127
    v_add_f32 v221, v221, v127
    v_fmac_f32 v229, v156, v156
    v_add_f32 v221, v221, v156
    v_fmac_f32 v229, v157, v157
    v_add_f32 v221, v221, v157
    v_fmac_f32 v229, v158, v158
    v_add_f32 v221, v221, v158
    v_fmac_f32 v229, v159, v159
    v_add_f32 v221, v221, v159
    v_fmac_f32 v229, v188, v188
    v_add_f32 v221, v221, v188
    v_fmac_f32 v229, v189, v189
    v_add_f32 v221, v221, v189
    v_fmac_f32 v229, v190, v190
    v_add_f32 v221, v221, v190
    v_fmac_f32 v229, v191, v191
    v_add_f32 v221, v221, v191
    v_mul_f32 v230, v128, v128
    v_mov_b32 v222, v128
    v_fmac_f32 v230, v129, v129
    v_add_f32 v222, v222, v129
    v_fmac_f32 v230, v130, v130
    v_add_f32 v222, v222, v130
    v_fmac_f32 v230, v131, v131
    v_add_f32 v222, v222, v131
    v_fmac_f32 v230, v160, v160
    v_add_f32 v222, v222, v160
    v_fmac_f32 v230, v161, v161
    v_add_f32 v222, v222, v161
    v_fmac_f32 v230, v162, v162
    v_add_f32 v222, v222, v162
    v_fmac_f32 v230, v163, v163
    v_add_f32 v222, v222, v163
    v_fmac_f32 v230, v192, v192
    v_add_f32 v222, v222, v192
    v_fmac_f32 v230, v193, v193
    v_add_f32 v222, v222, v193
    v_fmac_f32 v230, v194, v194
    v_add_f32 v222, v222, v194
    v_fmac_f32 v230, v195, v195
    v_add_f32 v222, v222, v195
    v_mul_f32 v231, v132, v132
    v_mov_b32 v223, v132
    v_fmac_f32 v231, v133, v133
    v_add_f32 v223, v223, v133
    v_fmac_f32 v231, v134, v134
    v_add_f32 v223, v223, v134
    v_fmac_f32 v231, v135, v135
    v_add_f32 v223, v223, v135
    v_fmac_f32 v231, v164, v164
    v_add_f32 v223, v223, v164
    v_fmac_f32 v231, v165, v165
    v_add_f32 v223, v223, v165
    v_fmac_f32 v231, v166, v166
    v_add_f32 v223, v223, v166
    v_fmac_f32 v231, v167, v167
    v_add_f32 v223, v223, v167
    v_fmac_f32 v231, v196, v196
    v_add_f32 v223, v223, v196
    v_fmac_f32 v231, v197, v197
    v_add_f32 v223, v223, v197
    v_fmac_f32 v231, v198, v198
    v_add_f32 v223, v223, v198
    v_fmac_f32 v231, v199, v199
    v_add_f32 v223, v223, v199
    s_branch L_k45_red
L_k45_zero:
    s_waitcnt vmcnt(0) lgkmcnt(0)
    v_mov_b32 v216, 0
    v_mov_b32 v224, 0
    v_mov_b32 v217, 0
    v_mov_b32 v225, 0
    v_mov_b32 v218, 0
    v_mov_b32 v226, 0
    v_mov_b32 v219, 0
    v_mov_b32 v227, 0
    v_mov_b32 v220, 0
    v_mov_b32 v228, 0
    v_mov_b32 v221, 0
    v_mov_b32 v229, 0
    v_mov_b32 v222, 0
    v_mov_b32 v230, 0
    v_mov_b32 v223, 0
    v_mov_b32 v231, 0
L_k45_red:
    s_lshl_b32 s25, s10, 12
    v_lshlrev_b32 v204, 10, v202
    v_lshl_add_u32 v204, v201, 5, v204
    v_add_u32 v204, s25, v204
    ds_write_b128 v204, v[216:219] offset:8192
    ds_write_b128 v204, v[220:223] offset:8208
    ds_write_b128 v204, v[224:227] offset:8704
    ds_write_b128 v204, v[228:231] offset:8720
    s_waitcnt lgkmcnt(0)
    s_barrier
    ds_read_b32 v16, v214 offset:8192
    ds_read_b32 v17, v214 offset:9216
    ds_read_b32 v18, v214 offset:10240
    ds_read_b32 v19, v214 offset:11264
    ds_read_b32 v20, v214 offset:12288
    ds_read_b32 v21, v214 offset:13312
    ds_read_b32 v22, v214 offset:14336
    ds_read_b32 v23, v214 offset:15360
    ds_read_b32 v24, v214 offset:16384
    ds_read_b32 v25, v214 offset:17408
    ds_read_b32 v26, v214 offset:18432
    ds_read_b32 v27, v214 offset:19456
    ds_read_b32 v28, v214 offset:20480
    ds_read_b32 v29, v214 offset:21504
    ds_read_b32 v30, v214 offset:22528
    ds_read_b32 v31, v214 offset:23552
    s_waitcnt lgkmcnt(0)
    v_add_f32 v16, v16, v17
    v_add_f32 v16, v16, v18
    v_add_f32 v16, v16, v19
    v_add_f32 v16, v16, v20
    v_add_f32 v16, v16, v21
    v_add_f32 v16, v16, v22
    v_add_f32 v16, v16, v23
    v_add_f32 v16, v16, v24
    v_add_f32 v16, v16, v25
    v_add_f32 v16, v16, v26
    v_add_f32 v16, v16, v27
    v_add_f32 v16, v16, v28
    v_add_f32 v16, v16, v29
    v_add_f32 v16, v16, v30
    v_add_f32 v16, v16, v31
    s_mul_i32 s24, s11, 168
    s_mul_i32 s25, s13, 42
    s_add_u32 s24, s24, s25
    s_lshl_b32 s26, s24, 10
    s_add_u32 s26, s26, 146800640
    s_lshl_b32 s24, s12, 10
    s_add_u32 s24, s24, s26
    buffer_store_dword v16, v214, s[16:19], s24 offen sc1
    s_waitcnt vmcnt(0)
    s_barrier
    s_lshl_b32 s27, s11, 2
    s_add_u32 s27, s27, s13
    s_mul_i32 s27, s27, 8448
    s_add_u32 s27, s27, 147849216
    s_cmp_lg_u32 s10, 0
    s_cbranch_scc1 L_k45_wait
    v_mov_b32 v0, 1
    v_mov_b32 v1, 0
    s_mov_b64 exec, 1
    buffer_atomic_add v0, v1, s[16:19], s27 offen sc1
    s_mov_b64 exec, -1
    s_mov_b32 s33, 65536
L_k45_poll:
    s_sleep 8
    buffer_load_dword v2, v1, s[16:19], s27 offen sc1
    s_waitcnt vmcnt(0)
    v_readfirstlane_b32 s34, v2
    s_nop 3
    s_cmp_ge_u32 s34, 42
    s_cbranch_scc1 L_k45_wait
    s_sub_u32 s33, s33, 1
    s_cmp_lg_u32 s33, 0
    s_cbranch_scc1 L_k45_poll
L_k45_wait:
    s_barrier
    buffer_load_dword v0, v214, s[16:19], s26 offen offset:0 sc1
    buffer_load_dword v1, v214, s[16:19], s26 offen offset:1024 sc1
    buffer_load_dword v2, v214, s[16:19], s26 offen offset:2048 sc1
    buffer_load_dword v3, v214, s[16:19], s26 offen offset:3072 sc1
    s_add_u32 s26, s26, 4096
    buffer_load_dword v4, v214, s[16:19], s26 offen offset:0 sc1
    buffer_load_dword v5, v214, s[16:19], s26 offen offset:1024 sc1
    buffer_load_dword v6, v214, s[16:19], s26 offen offset:2048 sc1
    buffer_load_dword v7, v214, s[16:19], s26 offen offset:3072 sc1
    s_add_u32 s26, s26, 4096
    buffer_load_dword v8, v214, s[16:19], s26 offen offset:0 sc1
    buffer_load_dword v9, v214, s[16:19], s26 offen offset:1024 sc1
    buffer_load_dword v10, v214, s[16:19], s26 offen offset:2048 sc1
    buffer_load_dword v11, v214, s[16:19], s26 offen offset:3072 sc1
    s_add_u32 s26, s26, 4096
    buffer_load_dword v12, v214, s[16:19], s26 offen offset:0 sc1
    buffer_load_dword v13, v214, s[16:19], s26 offen offset:1024 sc1
    buffer_load_dword v14, v214, s[16:19], s26 offen offset:2048 sc1
    buffer_load_dword v15, v214, s[16:19], s26 offen offset:3072 sc1
    s_add_u32 s26, s26, 4096
    buffer_load_dword v16, v214, s[16:19], s26 offen offset:0 sc1
    buffer_load_dword v17, v214, s[16:19], s26 offen offset:1024 sc1
    buffer_load_dword v18, v214, s[16:19], s26 offen offset:2048 sc1
    buffer_load_dword v19, v214, s[16:19], s26 offen offset:3072 sc1
    s_add_u32 s26, s26, 4096
    buffer_load_dword v20, v214, s[16:19], s26 offen offset:0 sc1
    buffer_load_dword v21, v214, s[16:19], s26 offen offset:1024 sc1
    buffer_load_dword v22, v214, s[16:19], s26 offen offset:2048 sc1
    buffer_load_dword v23, v214, s[16:19], s26 offen offset:3072 sc1
    s_add_u32 s26, s26, 4096
    buffer_load_dword v24, v214, s[16:19], s26 offen offset:0 sc1
    buffer_load_dword v25, v214, s[16:19], s26 offen offset:1024 sc1
    buffer_load_dword v26, v214, s[16:19], s26 offen offset:2048 sc1
    buffer_load_dword v27, v214, s[16:19], s26 offen offset:3072 sc1
    s_add_u32 s26, s26, 4096
    buffer_load_dword v28, v214, s[16:19], s26 offen offset:0 sc1
    buffer_load_dword v29, v214, s[16:19], s26 offen offset:1024 sc1
    buffer_load_dword v30, v214, s[16:19], s26 offen offset:2048 sc1
    buffer_load_dword v31, v214, s[16:19], s26 offen offset:3072 sc1
    s_add_u32 s26, s26, 4096
    buffer_load_dword v32, v214, s[16:19], s26 offen offset:0 sc1
    buffer_load_dword v33, v214, s[16:19], s26 offen offset:1024 sc1
    buffer_load_dword v34, v214, s[16:19], s26 offen offset:2048 sc1
    buffer_load_dword v35, v214, s[16:19], s26 offen offset:3072 sc1
    s_add_u32 s26, s26, 4096
    buffer_load_dword v36, v214, s[16:19], s26 offen offset:0 sc1
    buffer_load_dword v37, v214, s[16:19], s26 offen offset:1024 sc1
    buffer_load_dword v38, v214, s[16:19], s26 offen offset:2048 sc1
    buffer_load_dword v39, v214, s[16:19], s26 offen offset:3072 sc1
    s_add_u32 s26, s26, 4096
    buffer_load_dword v40, v214, s[16:19], s26 offen offset:0 sc1
    buffer_load_dword v41, v214, s[16:19], s26 offen offset:1024 sc1
    s_waitcnt vmcnt(0)
    v_add_f32 v0, v0, v1
    v_add_f32 v2, v2, v3
    v_add_f32 v4, v4, v5
    v_add_f32 v6, v6, v7
    v_add_f32 v8, v8, v9
    v_add_f32 v10, v10, v11
    v_add_f32 v12, v12, v13
    v_add_f32 v14, v14, v15
    v_add_f32 v16, v16, v17
    v_add_f32 v18, v18, v19
    v_add_f32 v20, v20, v21
    v_add_f32 v22, v22, v23
    v_add_f32 v24, v24, v25
    v_add_f32 v26, v26, v27
    v_add_f32 v28, v28, v29
    v_add_f32 v30, v30, v31
    v_add_f32 v32, v32, v33
    v_add_f32 v34, v34, v35
    v_add_f32 v36, v36, v37
    v_add_f32 v38, v38, v39
    v_add_f32 v40, v40, v41
    v_add_f32 v0, v0, v2
    v_add_f32 v4, v4, v6
    v_add_f32 v8, v8, v10
    v_add_f32 v12, v12, v14
    v_add_f32 v16, v16, v18
    v_add_f32 v20, v20, v22
    v_add_f32 v24, v24, v26
    v_add_f32 v28, v28, v30
    v_add_f32 v32, v32, v34
    v_add_f32 v36, v36, v38
    v_add_f32 v0, v0, v4
    v_add_f32 v8, v8, v12
    v_add_f32 v16, v16, v20
    v_add_f32 v24, v24, v28
    v_add_f32 v32, v32, v36
    v_add_f32 v0, v0, v8
    v_add_f32 v16, v16, v24
    v_add_f32 v32, v32, v40
    v_add_f32 v0, v0, v16
    v_add_f32 v0, v0, v32
    ds_write_b32 v214, v0 offset:24576
    s_waitcnt lgkmcnt(0)
    s_barrier
    s_cmp_ge_u32 s14, 167
    s_cbranch_scc1 L_k45_end
    v_lshlrev_b32 v210, 5, v201
    ds_read_b128 v[44:47], v210 offset:24576
    ds_read_b128 v[48:51], v210 offset:24592
    ds_read_b128 v[52:55], v210 offset:25088
    ds_read_b128 v[56:59], v210 offset:25104
    s_mov_b32 s24, 0x39035177
    s_mov_b32 s25, 0x3727c5ac
    s_waitcnt lgkmcnt(0)
    v_mul_f32 v44, s24, v44
    v_mul_f32 v52, s24, v52
    v_fma_f32 v52, -v44, v44, v52
    v_max_f32 v52, 0, v52
    v_add_f32 v52, s25, v52
    v_rsq_f32 v52, v52
    v_lshlrev_b32 v216, 16, v232
    v_lshlrev_b32 v224, 16, v236
    v_mul_f32 v216, v216, v52
    v_fma_f32 v224, -v44, v216, v224
    v_mul_f32 v45, s24, v45
    v_mul_f32 v53, s24, v53
    v_fma_f32 v53, -v45, v45, v53
    v_max_f32 v53, 0, v53
    v_add_f32 v53, s25, v53
    v_rsq_f32 v53, v53
    v_and_b32 v217, 0xffff0000, v232
    v_and_b32 v225, 0xffff0000, v236
    v_mul_f32 v217, v217, v53
    v_fma_f32 v225, -v45, v217, v225
    v_mul_f32 v46, s24, v46
    v_mul_f32 v54, s24, v54
    v_fma_f32 v54, -v46, v46, v54
    v_max_f32 v54, 0, v54
    v_add_f32 v54, s25, v54
    v_rsq_f32 v54, v54
    v_lshlrev_b32 v218, 16, v233
    v_lshlrev_b32 v226, 16, v237
    v_mul_f32 v218, v218, v54
    v_fma_f32 v226, -v46, v218, v226
    v_mul_f32 v47, s24, v47
    v_mul_f32 v55, s24, v55
    v_fma_f32 v55, -v47, v47, v55
    v_max_f32 v55, 0, v55
    v_add_f32 v55, s25, v55
    v_rsq_f32 v55, v55
    v_and_b32 v219, 0xffff0000, v233
    v_and_b32 v227, 0xffff0000, v237
    v_mul_f32 v219, v219, v55
    v_fma_f32 v227, -v47, v219, v227
    v_mul_f32 v48, s24, v48
    v_mul_f32 v56, s24, v56
    v_fma_f32 v56, -v48, v48, v56
    v_max_f32 v56, 0, v56
    v_add_f32 v56, s25, v56
    v_rsq_f32 v56, v56
    v_lshlrev_b32 v220, 16, v234
    v_lshlrev_b32 v228, 16, v238
    v_mul_f32 v220, v220, v56
    v_fma_f32 v228, -v48, v220, v228
    v_mul_f32 v49, s24, v49
    v_mul_f32 v57, s24, v57
    v_fma_f32 v57, -v49, v49, v57
    v_max_f32 v57, 0, v57
    v_add_f32 v57, s25, v57
    v_rsq_f32 v57, v57
    v_and_b32 v221, 0xffff0000, v234
    v_and_b32 v229, 0xffff0000, v238
    v_mul_f32 v221, v221, v57
    v_fma_f32 v229, -v49, v221, v229
    v_mul_f32 v50, s24, v50
    v_mul_f32 v58, s24, v58
    v_fma_f32 v58, -v50, v50, v58
    v_max_f32 v58, 0, v58
    v_add_f32 v58, s25, v58
    v_rsq_f32 v58, v58
    v_lshlrev_b32 v222, 16, v235
    v_lshlrev_b32 v230, 16, v239
    v_mul_f32 v222, v222, v58
    v_fma_f32 v230, -v50, v222, v230
    v_mul_f32 v51, s24, v51
    v_mul_f32 v59, s24, v59
    v_fma_f32 v59, -v51, v51, v59
    v_max_f32 v59, 0, v59
    v_add_f32 v59, s25, v59
    v_rsq_f32 v59, v59
    v_and_b32 v223, 0xffff0000, v235
    v_and_b32 v231, 0xffff0000, v239
    v_mul_f32 v223, v223, v59
    v_fma_f32 v231, -v51, v223, v231
    s_mul_i32 s24, s11, 8176640
    s_add_u32 s28, s28, s24
    s_addc_u32 s29, s29, 0
    s_mov_b32 s32, s28
    s_and_b32 s33, s29, 0xffff
    s_mov_b32 s34, 8176640
    s_mov_b32 s35, 0x00020000
    s_mul_i32 s24, s14, 49152
    s_lshl_b32 s25, s13, 8
    s_add_u32 s24, s24, s25
    v_lshlrev_b32 v210, 12, v202
    v_lshl_add_u32 v210, v201, 4, v210
    v_add_u32 v210, s24, v210
    s_mov_b32 s26, 0xbdd2d3e8
    v_mov_b32 v211, 0xc0135761
    v_fma_f32 v104, v104, v216, v224
    v_fma_f32 v108, v108, v217, v225
    v_fma_f32 v112, v112, v218, v226
    v_fma_f32 v116, v116, v219, v227
    v_fma_f32 v120, v120, v220, v228
    v_fma_f32 v124, v124, v221, v229
    v_fma_f32 v128, v128, v222, v230
    v_fma_f32 v132, v132, v223, v231
    v_mul_f32 v0, v104, v104
    v_mul_f32 v1, v108, v108
    v_mul_f32 v2, v112, v112
    v_mul_f32 v3, v116, v116
    v_mul_f32 v4, v120, v120
    v_mul_f32 v5, v124, v124
    v_mul_f32 v6, v128, v128
    v_mul_f32 v7, v132, v132
    v_fma_f32 v0, v0, s26, v211
    v_fma_f32 v1, v1, s26, v211
    v_fma_f32 v2, v2, s26, v211
    v_fma_f32 v3, v3, s26, v211
    v_fma_f32 v4, v4, s26, v211
    v_fma_f32 v5, v5, s26, v211
    v_fma_f32 v6, v6, s26, v211
    v_fma_f32 v7, v7, s26, v211
    v_mul_f32 v0, v0, v104
    v_mul_f32 v1, v1, v108
    v_mul_f32 v2, v2, v112
    v_mul_f32 v3, v3, v116
    v_mul_f32 v4, v4, v120
    v_mul_f32 v5, v5, v124
    v_mul_f32 v6, v6, v128
    v_mul_f32 v7, v7, v132
    v_exp_f32 v0, v0
    v_exp_f32 v1, v1
    v_exp_f32 v2, v2
    v_exp_f32 v3, v3
    v_exp_f32 v4, v4
    v_exp_f32 v5, v5
    v_exp_f32 v6, v6
    v_exp_f32 v7, v7
    v_add_f32 v0, 1.0, v0
    v_add_f32 v1, 1.0, v1
    v_add_f32 v2, 1.0, v2
    v_add_f32 v3, 1.0, v3
    v_add_f32 v4, 1.0, v4
    v_add_f32 v5, 1.0, v5
    v_add_f32 v6, 1.0, v6
    v_add_f32 v7, 1.0, v7
    v_rcp_f32 v0, v0
    v_rcp_f32 v1, v1
    v_rcp_f32 v2, v2
    v_rcp_f32 v3, v3
    v_rcp_f32 v4, v4
    v_rcp_f32 v5, v5
    v_rcp_f32 v6, v6
    v_rcp_f32 v7, v7
    v_mul_f32 v0, v0, v104
    v_mul_f32 v1, v1, v108
    v_mul_f32 v2, v2, v112
    v_mul_f32 v3, v3, v116
    v_mul_f32 v4, v4, v120
    v_mul_f32 v5, v5, v124
    v_mul_f32 v6, v6, v128
    v_mul_f32 v7, v7, v132
    v_cvt_pk_bf16_f32 v16, v0, v1
    v_cvt_pk_bf16_f32 v17, v2, v3
    v_cvt_pk_bf16_f32 v18, v4, v5
    v_cvt_pk_bf16_f32 v19, v6, v7
    v_add_u32 v212, 0, v210
    buffer_store_dwordx4 v[16:19], v212, s[32:35], 0 offen
    v_fma_f32 v105, v105, v216, v224
    v_fma_f32 v109, v109, v217, v225
    v_fma_f32 v113, v113, v218, v226
    v_fma_f32 v117, v117, v219, v227
    v_fma_f32 v121, v121, v220, v228
    v_fma_f32 v125, v125, v221, v229
    v_fma_f32 v129, v129, v222, v230
    v_fma_f32 v133, v133, v223, v231
    v_mul_f32 v0, v105, v105
    v_mul_f32 v1, v109, v109
    v_mul_f32 v2, v113, v113
    v_mul_f32 v3, v117, v117
    v_mul_f32 v4, v121, v121
    v_mul_f32 v5, v125, v125
    v_mul_f32 v6, v129, v129
    v_mul_f32 v7, v133, v133
    v_fma_f32 v0, v0, s26, v211
    v_fma_f32 v1, v1, s26, v211
    v_fma_f32 v2, v2, s26, v211
    v_fma_f32 v3, v3, s26, v211
    v_fma_f32 v4, v4, s26, v211
    v_fma_f32 v5, v5, s26, v211
    v_fma_f32 v6, v6, s26, v211
    v_fma_f32 v7, v7, s26, v211
    v_mul_f32 v0, v0, v105
    v_mul_f32 v1, v1, v109
    v_mul_f32 v2, v2, v113
    v_mul_f32 v3, v3, v117
    v_mul_f32 v4, v4, v121
    v_mul_f32 v5, v5, v125
    v_mul_f32 v6, v6, v129
    v_mul_f32 v7, v7, v133
    v_exp_f32 v0, v0
    v_exp_f32 v1, v1
    v_exp_f32 v2, v2
    v_exp_f32 v3, v3
    v_exp_f32 v4, v4
    v_exp_f32 v5, v5
    v_exp_f32 v6, v6
    v_exp_f32 v7, v7
    v_add_f32 v0, 1.0, v0
    v_add_f32 v1, 1.0, v1
    v_add_f32 v2, 1.0, v2
    v_add_f32 v3, 1.0, v3
    v_add_f32 v4, 1.0, v4
    v_add_f32 v5, 1.0, v5
    v_add_f32 v6, 1.0, v6
    v_add_f32 v7, 1.0, v7
    v_rcp_f32 v0, v0
    v_rcp_f32 v1, v1
    v_rcp_f32 v2, v2
    v_rcp_f32 v3, v3
    v_rcp_f32 v4, v4
    v_rcp_f32 v5, v5
    v_rcp_f32 v6, v6
    v_rcp_f32 v7, v7
    v_mul_f32 v0, v0, v105
    v_mul_f32 v1, v1, v109
    v_mul_f32 v2, v2, v113
    v_mul_f32 v3, v3, v117
    v_mul_f32 v4, v4, v121
    v_mul_f32 v5, v5, v125
    v_mul_f32 v6, v6, v129
    v_mul_f32 v7, v7, v133
    v_cvt_pk_bf16_f32 v20, v0, v1
    v_cvt_pk_bf16_f32 v21, v2, v3
    v_cvt_pk_bf16_f32 v22, v4, v5
    v_cvt_pk_bf16_f32 v23, v6, v7
    v_add_u32 v212, 1024, v210
    buffer_store_dwordx4 v[20:23], v212, s[32:35], 0 offen
    v_fma_f32 v106, v106, v216, v224
    v_fma_f32 v110, v110, v217, v225
    v_fma_f32 v114, v114, v218, v226
    v_fma_f32 v118, v118, v219, v227
    v_fma_f32 v122, v122, v220, v228
    v_fma_f32 v126, v126, v221, v229
    v_fma_f32 v130, v130, v222, v230
    v_fma_f32 v134, v134, v223, v231
    v_mul_f32 v0, v106, v106
    v_mul_f32 v1, v110, v110
    v_mul_f32 v2, v114, v114
    v_mul_f32 v3, v118, v118
    v_mul_f32 v4, v122, v122
    v_mul_f32 v5, v126, v126
    v_mul_f32 v6, v130, v130
    v_mul_f32 v7, v134, v134
    v_fma_f32 v0, v0, s26, v211
    v_fma_f32 v1, v1, s26, v211
    v_fma_f32 v2, v2, s26, v211
    v_fma_f32 v3, v3, s26, v211
    v_fma_f32 v4, v4, s26, v211
    v_fma_f32 v5, v5, s26, v211
    v_fma_f32 v6, v6, s26, v211
    v_fma_f32 v7, v7, s26, v211
    v_mul_f32 v0, v0, v106
    v_mul_f32 v1, v1, v110
    v_mul_f32 v2, v2, v114
    v_mul_f32 v3, v3, v118
    v_mul_f32 v4, v4, v122
    v_mul_f32 v5, v5, v126
    v_mul_f32 v6, v6, v130
    v_mul_f32 v7, v7, v134
    v_exp_f32 v0, v0
    v_exp_f32 v1, v1
    v_exp_f32 v2, v2
    v_exp_f32 v3, v3
    v_exp_f32 v4, v4
    v_exp_f32 v5, v5
    v_exp_f32 v6, v6
    v_exp_f32 v7, v7
    v_add_f32 v0, 1.0, v0
    v_add_f32 v1, 1.0, v1
    v_add_f32 v2, 1.0, v2
    v_add_f32 v3, 1.0, v3
    v_add_f32 v4, 1.0, v4
    v_add_f32 v5, 1.0, v5
    v_add_f32 v6, 1.0, v6
    v_add_f32 v7, 1.0, v7
    v_rcp_f32 v0, v0
    v_rcp_f32 v1, v1
    v_rcp_f32 v2, v2
    v_rcp_f32 v3, v3
    v_rcp_f32 v4, v4
    v_rcp_f32 v5, v5
    v_rcp_f32 v6, v6
    v_rcp_f32 v7, v7
    v_mul_f32 v0, v0, v106
    v_mul_f32 v1, v1, v110
    v_mul_f32 v2, v2, v114
    v_mul_f32 v3, v3, v118
    v_mul_f32 v4, v4, v122
    v_mul_f32 v5, v5, v126
    v_mul_f32 v6, v6, v130
    v_mul_f32 v7, v7, v134
    v_cvt_pk_bf16_f32 v24, v0, v1
    v_cvt_pk_bf16_f32 v25, v2, v3
    v_cvt_pk_bf16_f32 v26, v4, v5
    v_cvt_pk_bf16_f32 v27, v6, v7
    v_add_u32 v212, 2048, v210
    buffer_store_dwordx4 v[24:27], v212, s[32:35], 0 offen
    v_fma_f32 v107, v107, v216, v224
    v_fma_f32 v111, v111, v217, v225
    v_fma_f32 v115, v115, v218, v226
    v_fma_f32 v119, v119, v219, v227
    v_fma_f32 v123, v123, v220, v228
    v_fma_f32 v127, v127, v221, v229
    v_fma_f32 v131, v131, v222, v230
    v_fma_f32 v135, v135, v223, v231
    v_mul_f32 v0, v107, v107
    v_mul_f32 v1, v111, v111
    v_mul_f32 v2, v115, v115
    v_mul_f32 v3, v119, v119
    v_mul_f32 v4, v123, v123
    v_mul_f32 v5, v127, v127
    v_mul_f32 v6, v131, v131
    v_mul_f32 v7, v135, v135
    v_fma_f32 v0, v0, s26, v211
    v_fma_f32 v1, v1, s26, v211
    v_fma_f32 v2, v2, s26, v211
    v_fma_f32 v3, v3, s26, v211
    v_fma_f32 v4, v4, s26, v211
    v_fma_f32 v5, v5, s26, v211
    v_fma_f32 v6, v6, s26, v211
    v_fma_f32 v7, v7, s26, v211
    v_mul_f32 v0, v0, v107
    v_mul_f32 v1, v1, v111
    v_mul_f32 v2, v2, v115
    v_mul_f32 v3, v3, v119
    v_mul_f32 v4, v4, v123
    v_mul_f32 v5, v5, v127
    v_mul_f32 v6, v6, v131
    v_mul_f32 v7, v7, v135
    v_exp_f32 v0, v0
    v_exp_f32 v1, v1
    v_exp_f32 v2, v2
    v_exp_f32 v3, v3
    v_exp_f32 v4, v4
    v_exp_f32 v5, v5
    v_exp_f32 v6, v6
    v_exp_f32 v7, v7
    v_add_f32 v0, 1.0, v0
    v_add_f32 v1, 1.0, v1
    v_add_f32 v2, 1.0, v2
    v_add_f32 v3, 1.0, v3
    v_add_f32 v4, 1.0, v4
    v_add_f32 v5, 1.0, v5
    v_add_f32 v6, 1.0, v6
    v_add_f32 v7, 1.0, v7
    v_rcp_f32 v0, v0
    v_rcp_f32 v1, v1
    v_rcp_f32 v2, v2
    v_rcp_f32 v3, v3
    v_rcp_f32 v4, v4
    v_rcp_f32 v5, v5
    v_rcp_f32 v6, v6
    v_rcp_f32 v7, v7
    v_mul_f32 v0, v0, v107
    v_mul_f32 v1, v1, v111
    v_mul_f32 v2, v2, v115
    v_mul_f32 v3, v3, v119
    v_mul_f32 v4, v4, v123
    v_mul_f32 v5, v5, v127
    v_mul_f32 v6, v6, v131
    v_mul_f32 v7, v7, v135
    v_cvt_pk_bf16_f32 v28, v0, v1
    v_cvt_pk_bf16_f32 v29, v2, v3
    v_cvt_pk_bf16_f32 v30, v4, v5
    v_cvt_pk_bf16_f32 v31, v6, v7
    v_add_u32 v212, 3072, v210
    buffer_store_dwordx4 v[28:31], v212, s[32:35], 0 offen
    v_fma_f32 v136, v136, v216, v224
    v_fma_f32 v140, v140, v217, v225
    v_fma_f32 v144, v144, v218, v226
    v_fma_f32 v148, v148, v219, v227
    v_fma_f32 v152, v152, v220, v228
    v_fma_f32 v156, v156, v221, v229
    v_fma_f32 v160, v160, v222, v230
    v_fma_f32 v164, v164, v223, v231
    v_mul_f32 v0, v136, v136
    v_mul_f32 v1, v140, v140
    v_mul_f32 v2, v144, v144
    v_mul_f32 v3, v148, v148
    v_mul_f32 v4, v152, v152
    v_mul_f32 v5, v156, v156
    v_mul_f32 v6, v160, v160
    v_mul_f32 v7, v164, v164
    v_fma_f32 v0, v0, s26, v211
    v_fma_f32 v1, v1, s26, v211
    v_fma_f32 v2, v2, s26, v211
    v_fma_f32 v3, v3, s26, v211
    v_fma_f32 v4, v4, s26, v211
    v_fma_f32 v5, v5, s26, v211
    v_fma_f32 v6, v6, s26, v211
    v_fma_f32 v7, v7, s26, v211
    v_mul_f32 v0, v0, v136
    v_mul_f32 v1, v1, v140
    v_mul_f32 v2, v2, v144
    v_mul_f32 v3, v3, v148
    v_mul_f32 v4, v4, v152
    v_mul_f32 v5, v5, v156
    v_mul_f32 v6, v6, v160
    v_mul_f32 v7, v7, v164
    v_exp_f32 v0, v0
    v_exp_f32 v1, v1
    v_exp_f32 v2, v2
    v_exp_f32 v3, v3
    v_exp_f32 v4, v4
    v_exp_f32 v5, v5
    v_exp_f32 v6, v6
    v_exp_f32 v7, v7
    v_add_f32 v0, 1.0, v0
    v_add_f32 v1, 1.0, v1
    v_add_f32 v2, 1.0, v2
    v_add_f32 v3, 1.0, v3
    v_add_f32 v4, 1.0, v4
    v_add_f32 v5, 1.0, v5
    v_add_f32 v6, 1.0, v6
    v_add_f32 v7, 1.0, v7
    v_rcp_f32 v0, v0
    v_rcp_f32 v1, v1
    v_rcp_f32 v2, v2
    v_rcp_f32 v3, v3
    v_rcp_f32 v4, v4
    v_rcp_f32 v5, v5
    v_rcp_f32 v6, v6
    v_rcp_f32 v7, v7
    v_mul_f32 v0, v0, v136
    v_mul_f32 v1, v1, v140
    v_mul_f32 v2, v2, v144
    v_mul_f32 v3, v3, v148
    v_mul_f32 v4, v4, v152
    v_mul_f32 v5, v5, v156
    v_mul_f32 v6, v6, v160
    v_mul_f32 v7, v7, v164
    v_cvt_pk_bf16_f32 v32, v0, v1
    v_cvt_pk_bf16_f32 v33, v2, v3
    v_cvt_pk_bf16_f32 v34, v4, v5
    v_cvt_pk_bf16_f32 v35, v6, v7
    v_add_u32 v212, 16384, v210
    buffer_store_dwordx4 v[32:35], v212, s[32:35], 0 offen
    v_fma_f32 v137, v137, v216, v224
    v_fma_f32 v141, v141, v217, v225
    v_fma_f32 v145, v145, v218, v226
    v_fma_f32 v149, v149, v219, v227
    v_fma_f32 v153, v153, v220, v228
    v_fma_f32 v157, v157, v221, v229
    v_fma_f32 v161, v161, v222, v230
    v_fma_f32 v165, v165, v223, v231
    v_mul_f32 v0, v137, v137
    v_mul_f32 v1, v141, v141
    v_mul_f32 v2, v145, v145
    v_mul_f32 v3, v149, v149
    v_mul_f32 v4, v153, v153
    v_mul_f32 v5, v157, v157
    v_mul_f32 v6, v161, v161
    v_mul_f32 v7, v165, v165
    v_fma_f32 v0, v0, s26, v211
    v_fma_f32 v1, v1, s26, v211
    v_fma_f32 v2, v2, s26, v211
    v_fma_f32 v3, v3, s26, v211
    v_fma_f32 v4, v4, s26, v211
    v_fma_f32 v5, v5, s26, v211
    v_fma_f32 v6, v6, s26, v211
    v_fma_f32 v7, v7, s26, v211
    v_mul_f32 v0, v0, v137
    v_mul_f32 v1, v1, v141
    v_mul_f32 v2, v2, v145
    v_mul_f32 v3, v3, v149
    v_mul_f32 v4, v4, v153
    v_mul_f32 v5, v5, v157
    v_mul_f32 v6, v6, v161
    v_mul_f32 v7, v7, v165
    v_exp_f32 v0, v0
    v_exp_f32 v1, v1
    v_exp_f32 v2, v2
    v_exp_f32 v3, v3
    v_exp_f32 v4, v4
    v_exp_f32 v5, v5
    v_exp_f32 v6, v6
    v_exp_f32 v7, v7
    v_add_f32 v0, 1.0, v0
    v_add_f32 v1, 1.0, v1
    v_add_f32 v2, 1.0, v2
    v_add_f32 v3, 1.0, v3
    v_add_f32 v4, 1.0, v4
    v_add_f32 v5, 1.0, v5
    v_add_f32 v6, 1.0, v6
    v_add_f32 v7, 1.0, v7
    v_rcp_f32 v0, v0
    v_rcp_f32 v1, v1
    v_rcp_f32 v2, v2
    v_rcp_f32 v3, v3
    v_rcp_f32 v4, v4
    v_rcp_f32 v5, v5
    v_rcp_f32 v6, v6
    v_rcp_f32 v7, v7
    v_mul_f32 v0, v0, v137
    v_mul_f32 v1, v1, v141
    v_mul_f32 v2, v2, v145
    v_mul_f32 v3, v3, v149
    v_mul_f32 v4, v4, v153
    v_mul_f32 v5, v5, v157
    v_mul_f32 v6, v6, v161
    v_mul_f32 v7, v7, v165
    v_cvt_pk_bf16_f32 v36, v0, v1
    v_cvt_pk_bf16_f32 v37, v2, v3
    v_cvt_pk_bf16_f32 v38, v4, v5
    v_cvt_pk_bf16_f32 v39, v6, v7
    v_add_u32 v212, 17408, v210
    buffer_store_dwordx4 v[36:39], v212, s[32:35], 0 offen
    v_fma_f32 v138, v138, v216, v224
    v_fma_f32 v142, v142, v217, v225
    v_fma_f32 v146, v146, v218, v226
    v_fma_f32 v150, v150, v219, v227
    v_fma_f32 v154, v154, v220, v228
    v_fma_f32 v158, v158, v221, v229
    v_fma_f32 v162, v162, v222, v230
    v_fma_f32 v166, v166, v223, v231
    v_mul_f32 v0, v138, v138
    v_mul_f32 v1, v142, v142
    v_mul_f32 v2, v146, v146
    v_mul_f32 v3, v150, v150
    v_mul_f32 v4, v154, v154
    v_mul_f32 v5, v158, v158
    v_mul_f32 v6, v162, v162
    v_mul_f32 v7, v166, v166
    v_fma_f32 v0, v0, s26, v211
    v_fma_f32 v1, v1, s26, v211
    v_fma_f32 v2, v2, s26, v211
    v_fma_f32 v3, v3, s26, v211
    v_fma_f32 v4, v4, s26, v211
    v_fma_f32 v5, v5, s26, v211
    v_fma_f32 v6, v6, s26, v211
    v_fma_f32 v7, v7, s26, v211
    v_mul_f32 v0, v0, v138
    v_mul_f32 v1, v1, v142
    v_mul_f32 v2, v2, v146
    v_mul_f32 v3, v3, v150
    v_mul_f32 v4, v4, v154
    v_mul_f32 v5, v5, v158
    v_mul_f32 v6, v6, v162
    v_mul_f32 v7, v7, v166
    v_exp_f32 v0, v0
    v_exp_f32 v1, v1
    v_exp_f32 v2, v2
    v_exp_f32 v3, v3
    v_exp_f32 v4, v4
    v_exp_f32 v5, v5
    v_exp_f32 v6, v6
    v_exp_f32 v7, v7
    v_add_f32 v0, 1.0, v0
    v_add_f32 v1, 1.0, v1
    v_add_f32 v2, 1.0, v2
    v_add_f32 v3, 1.0, v3
    v_add_f32 v4, 1.0, v4
    v_add_f32 v5, 1.0, v5
    v_add_f32 v6, 1.0, v6
    v_add_f32 v7, 1.0, v7
    v_rcp_f32 v0, v0
    v_rcp_f32 v1, v1
    v_rcp_f32 v2, v2
    v_rcp_f32 v3, v3
    v_rcp_f32 v4, v4
    v_rcp_f32 v5, v5
    v_rcp_f32 v6, v6
    v_rcp_f32 v7, v7
    v_mul_f32 v0, v0, v138
    v_mul_f32 v1, v1, v142
    v_mul_f32 v2, v2, v146
    v_mul_f32 v3, v3, v150
    v_mul_f32 v4, v4, v154
    v_mul_f32 v5, v5, v158
    v_mul_f32 v6, v6, v162
    v_mul_f32 v7, v7, v166
    v_cvt_pk_bf16_f32 v40, v0, v1
    v_cvt_pk_bf16_f32 v41, v2, v3
    v_cvt_pk_bf16_f32 v42, v4, v5
    v_cvt_pk_bf16_f32 v43, v6, v7
    v_add_u32 v212, 18432, v210
    buffer_store_dwordx4 v[40:43], v212, s[32:35], 0 offen
    v_fma_f32 v139, v139, v216, v224
    v_fma_f32 v143, v143, v217, v225
    v_fma_f32 v147, v147, v218, v226
    v_fma_f32 v151, v151, v219, v227
    v_fma_f32 v155, v155, v220, v228
    v_fma_f32 v159, v159, v221, v229
    v_fma_f32 v163, v163, v222, v230
    v_fma_f32 v167, v167, v223, v231
    v_mul_f32 v0, v139, v139
    v_mul_f32 v1, v143, v143
    v_mul_f32 v2, v147, v147
    v_mul_f32 v3, v151, v151
    v_mul_f32 v4, v155, v155
    v_mul_f32 v5, v159, v159
    v_mul_f32 v6, v163, v163
    v_mul_f32 v7, v167, v167
    v_fma_f32 v0, v0, s26, v211
    v_fma_f32 v1, v1, s26, v211
    v_fma_f32 v2, v2, s26, v211
    v_fma_f32 v3, v3, s26, v211
    v_fma_f32 v4, v4, s26, v211
    v_fma_f32 v5, v5, s26, v211
    v_fma_f32 v6, v6, s26, v211
    v_fma_f32 v7, v7, s26, v211
    v_mul_f32 v0, v0, v139
    v_mul_f32 v1, v1, v143
    v_mul_f32 v2, v2, v147
    v_mul_f32 v3, v3, v151
    v_mul_f32 v4, v4, v155
    v_mul_f32 v5, v5, v159
    v_mul_f32 v6, v6, v163
    v_mul_f32 v7, v7, v167
    v_exp_f32 v0, v0
    v_exp_f32 v1, v1
    v_exp_f32 v2, v2
    v_exp_f32 v3, v3
    v_exp_f32 v4, v4
    v_exp_f32 v5, v5
    v_exp_f32 v6, v6
    v_exp_f32 v7, v7
    v_add_f32 v0, 1.0, v0
    v_add_f32 v1, 1.0, v1
    v_add_f32 v2, 1.0, v2
    v_add_f32 v3, 1.0, v3
    v_add_f32 v4, 1.0, v4
    v_add_f32 v5, 1.0, v5
    v_add_f32 v6, 1.0, v6
    v_add_f32 v7, 1.0, v7
    v_rcp_f32 v0, v0
    v_rcp_f32 v1, v1
    v_rcp_f32 v2, v2
    v_rcp_f32 v3, v3
    v_rcp_f32 v4, v4
    v_rcp_f32 v5, v5
    v_rcp_f32 v6, v6
    v_rcp_f32 v7, v7
    v_mul_f32 v0, v0, v139
    v_mul_f32 v1, v1, v143
    v_mul_f32 v2, v2, v147
    v_mul_f32 v3, v3, v151
    v_mul_f32 v4, v4, v155
    v_mul_f32 v5, v5, v159
    v_mul_f32 v6, v6, v163
    v_mul_f32 v7, v7, v167
    v_cvt_pk_bf16_f32 v44, v0, v1
    v_cvt_pk_bf16_f32 v45, v2, v3
    v_cvt_pk_bf16_f32 v46, v4, v5
    v_cvt_pk_bf16_f32 v47, v6, v7
    v_add_u32 v212, 19456, v210
    buffer_store_dwordx4 v[44:47], v212, s[32:35], 0 offen
    v_fma_f32 v168, v168, v216, v224
    v_fma_f32 v172, v172, v217, v225
    v_fma_f32 v176, v176, v218, v226
    v_fma_f32 v180, v180, v219, v227
    v_fma_f32 v184, v184, v220, v228
    v_fma_f32 v188, v188, v221, v229
    v_fma_f32 v192, v192, v222, v230
    v_fma_f32 v196, v196, v223, v231
    v_mul_f32 v0, v168, v168
    v_mul_f32 v1, v172, v172
    v_mul_f32 v2, v176, v176
    v_mul_f32 v3, v180, v180
    v_mul_f32 v4, v184, v184
    v_mul_f32 v5, v188, v188
    v_mul_f32 v6, v192, v192
    v_mul_f32 v7, v196, v196
    v_fma_f32 v0, v0, s26, v211
    v_fma_f32 v1, v1, s26, v211
    v_fma_f32 v2, v2, s26, v211
    v_fma_f32 v3, v3, s26, v211
    v_fma_f32 v4, v4, s26, v211
    v_fma_f32 v5, v5, s26, v211
    v_fma_f32 v6, v6, s26, v211
    v_fma_f32 v7, v7, s26, v211
    v_mul_f32 v0, v0, v168
    v_mul_f32 v1, v1, v172
    v_mul_f32 v2, v2, v176
    v_mul_f32 v3, v3, v180
    v_mul_f32 v4, v4, v184
    v_mul_f32 v5, v5, v188
    v_mul_f32 v6, v6, v192
    v_mul_f32 v7, v7, v196
    v_exp_f32 v0, v0
    v_exp_f32 v1, v1
    v_exp_f32 v2, v2
    v_exp_f32 v3, v3
    v_exp_f32 v4, v4
    v_exp_f32 v5, v5
    v_exp_f32 v6, v6
    v_exp_f32 v7, v7
    v_add_f32 v0, 1.0, v0
    v_add_f32 v1, 1.0, v1
    v_add_f32 v2, 1.0, v2
    v_add_f32 v3, 1.0, v3
    v_add_f32 v4, 1.0, v4
    v_add_f32 v5, 1.0, v5
    v_add_f32 v6, 1.0, v6
    v_add_f32 v7, 1.0, v7
    v_rcp_f32 v0, v0
    v_rcp_f32 v1, v1
    v_rcp_f32 v2, v2
    v_rcp_f32 v3, v3
    v_rcp_f32 v4, v4
    v_rcp_f32 v5, v5
    v_rcp_f32 v6, v6
    v_rcp_f32 v7, v7
    v_mul_f32 v0, v0, v168
    v_mul_f32 v1, v1, v172
    v_mul_f32 v2, v2, v176
    v_mul_f32 v3, v3, v180
    v_mul_f32 v4, v4, v184
    v_mul_f32 v5, v5, v188
    v_mul_f32 v6, v6, v192
    v_mul_f32 v7, v7, v196
    v_cvt_pk_bf16_f32 v16, v0, v1
    v_cvt_pk_bf16_f32 v17, v2, v3
    v_cvt_pk_bf16_f32 v18, v4, v5
    v_cvt_pk_bf16_f32 v19, v6, v7
    v_add_u32 v212, 32768, v210
    buffer_store_dwordx4 v[16:19], v212, s[32:35], 0 offen
    v_fma_f32 v169, v169, v216, v224
    v_fma_f32 v173, v173, v217, v225
    v_fma_f32 v177, v177, v218, v226
    v_fma_f32 v181, v181, v219, v227
    v_fma_f32 v185, v185, v220, v228
    v_fma_f32 v189, v189, v221, v229
    v_fma_f32 v193, v193, v222, v230
    v_fma_f32 v197, v197, v223, v231
    v_mul_f32 v0, v169, v169
    v_mul_f32 v1, v173, v173
    v_mul_f32 v2, v177, v177
    v_mul_f32 v3, v181, v181
    v_mul_f32 v4, v185, v185
    v_mul_f32 v5, v189, v189
    v_mul_f32 v6, v193, v193
    v_mul_f32 v7, v197, v197
    v_fma_f32 v0, v0, s26, v211
    v_fma_f32 v1, v1, s26, v211
    v_fma_f32 v2, v2, s26, v211
    v_fma_f32 v3, v3, s26, v211
    v_fma_f32 v4, v4, s26, v211
    v_fma_f32 v5, v5, s26, v211
    v_fma_f32 v6, v6, s26, v211
    v_fma_f32 v7, v7, s26, v211
    v_mul_f32 v0, v0, v169
    v_mul_f32 v1, v1, v173
    v_mul_f32 v2, v2, v177
    v_mul_f32 v3, v3, v181
    v_mul_f32 v4, v4, v185
    v_mul_f32 v5, v5, v189
    v_mul_f32 v6, v6, v193
    v_mul_f32 v7, v7, v197
    v_exp_f32 v0, v0
    v_exp_f32 v1, v1
    v_exp_f32 v2, v2
    v_exp_f32 v3, v3
    v_exp_f32 v4, v4
    v_exp_f32 v5, v5
    v_exp_f32 v6, v6
    v_exp_f32 v7, v7
    v_add_f32 v0, 1.0, v0
    v_add_f32 v1, 1.0, v1
    v_add_f32 v2, 1.0, v2
    v_add_f32 v3, 1.0, v3
    v_add_f32 v4, 1.0, v4
    v_add_f32 v5, 1.0, v5
    v_add_f32 v6, 1.0, v6
    v_add_f32 v7, 1.0, v7
    v_rcp_f32 v0, v0
    v_rcp_f32 v1, v1
    v_rcp_f32 v2, v2
    v_rcp_f32 v3, v3
    v_rcp_f32 v4, v4
    v_rcp_f32 v5, v5
    v_rcp_f32 v6, v6
    v_rcp_f32 v7, v7
    v_mul_f32 v0, v0, v169
    v_mul_f32 v1, v1, v173
    v_mul_f32 v2, v2, v177
    v_mul_f32 v3, v3, v181
    v_mul_f32 v4, v4, v185
    v_mul_f32 v5, v5, v189
    v_mul_f32 v6, v6, v193
    v_mul_f32 v7, v7, v197
    v_cvt_pk_bf16_f32 v20, v0, v1
    v_cvt_pk_bf16_f32 v21, v2, v3
    v_cvt_pk_bf16_f32 v22, v4, v5
    v_cvt_pk_bf16_f32 v23, v6, v7
    v_add_u32 v212, 33792, v210
    buffer_store_dwordx4 v[20:23], v212, s[32:35], 0 offen
    v_fma_f32 v170, v170, v216, v224
    v_fma_f32 v174, v174, v217, v225
    v_fma_f32 v178, v178, v218, v226
    v_fma_f32 v182, v182, v219, v227
    v_fma_f32 v186, v186, v220, v228
    v_fma_f32 v190, v190, v221, v229
    v_fma_f32 v194, v194, v222, v230
    v_fma_f32 v198, v198, v223, v231
    v_mul_f32 v0, v170, v170
    v_mul_f32 v1, v174, v174
    v_mul_f32 v2, v178, v178
    v_mul_f32 v3, v182, v182
    v_mul_f32 v4, v186, v186
    v_mul_f32 v5, v190, v190
    v_mul_f32 v6, v194, v194
    v_mul_f32 v7, v198, v198
    v_fma_f32 v0, v0, s26, v211
    v_fma_f32 v1, v1, s26, v211
    v_fma_f32 v2, v2, s26, v211
    v_fma_f32 v3, v3, s26, v211
    v_fma_f32 v4, v4, s26, v211
    v_fma_f32 v5, v5, s26, v211
    v_fma_f32 v6, v6, s26, v211
    v_fma_f32 v7, v7, s26, v211
    v_mul_f32 v0, v0, v170
    v_mul_f32 v1, v1, v174
    v_mul_f32 v2, v2, v178
    v_mul_f32 v3, v3, v182
    v_mul_f32 v4, v4, v186
    v_mul_f32 v5, v5, v190
    v_mul_f32 v6, v6, v194
    v_mul_f32 v7, v7, v198
    v_exp_f32 v0, v0
    v_exp_f32 v1, v1
    v_exp_f32 v2, v2
    v_exp_f32 v3, v3
    v_exp_f32 v4, v4
    v_exp_f32 v5, v5
    v_exp_f32 v6, v6
    v_exp_f32 v7, v7
    v_add_f32 v0, 1.0, v0
    v_add_f32 v1, 1.0, v1
    v_add_f32 v2, 1.0, v2
    v_add_f32 v3, 1.0, v3
    v_add_f32 v4, 1.0, v4
    v_add_f32 v5, 1.0, v5
    v_add_f32 v6, 1.0, v6
    v_add_f32 v7, 1.0, v7
    v_rcp_f32 v0, v0
    v_rcp_f32 v1, v1
    v_rcp_f32 v2, v2
    v_rcp_f32 v3, v3
    v_rcp_f32 v4, v4
    v_rcp_f32 v5, v5
    v_rcp_f32 v6, v6
    v_rcp_f32 v7, v7
    v_mul_f32 v0, v0, v170
    v_mul_f32 v1, v1, v174
    v_mul_f32 v2, v2, v178
    v_mul_f32 v3, v3, v182
    v_mul_f32 v4, v4, v186
    v_mul_f32 v5, v5, v190
    v_mul_f32 v6, v6, v194
    v_mul_f32 v7, v7, v198
    v_cvt_pk_bf16_f32 v24, v0, v1
    v_cvt_pk_bf16_f32 v25, v2, v3
    v_cvt_pk_bf16_f32 v26, v4, v5
    v_cvt_pk_bf16_f32 v27, v6, v7
    v_add_u32 v212, 34816, v210
    buffer_store_dwordx4 v[24:27], v212, s[32:35], 0 offen
    v_fma_f32 v171, v171, v216, v224
    v_fma_f32 v175, v175, v217, v225
    v_fma_f32 v179, v179, v218, v226
    v_fma_f32 v183, v183, v219, v227
    v_fma_f32 v187, v187, v220, v228
    v_fma_f32 v191, v191, v221, v229
    v_fma_f32 v195, v195, v222, v230
    v_fma_f32 v199, v199, v223, v231
    v_mul_f32 v0, v171, v171
    v_mul_f32 v1, v175, v175
    v_mul_f32 v2, v179, v179
    v_mul_f32 v3, v183, v183
    v_mul_f32 v4, v187, v187
    v_mul_f32 v5, v191, v191
    v_mul_f32 v6, v195, v195
    v_mul_f32 v7, v199, v199
    v_fma_f32 v0, v0, s26, v211
    v_fma_f32 v1, v1, s26, v211
    v_fma_f32 v2, v2, s26, v211
    v_fma_f32 v3, v3, s26, v211
    v_fma_f32 v4, v4, s26, v211
    v_fma_f32 v5, v5, s26, v211
    v_fma_f32 v6, v6, s26, v211
    v_fma_f32 v7, v7, s26, v211
    v_mul_f32 v0, v0, v171
    v_mul_f32 v1, v1, v175
    v_mul_f32 v2, v2, v179
    v_mul_f32 v3, v3, v183
    v_mul_f32 v4, v4, v187
    v_mul_f32 v5, v5, v191
    v_mul_f32 v6, v6, v195
    v_mul_f32 v7, v7, v199
    v_exp_f32 v0, v0
    v_exp_f32 v1, v1
    v_exp_f32 v2, v2
    v_exp_f32 v3, v3
    v_exp_f32 v4, v4
    v_exp_f32 v5, v5
    v_exp_f32 v6, v6
    v_exp_f32 v7, v7
    v_add_f32 v0, 1.0, v0
    v_add_f32 v1, 1.0, v1
    v_add_f32 v2, 1.0, v2
    v_add_f32 v3, 1.0, v3
    v_add_f32 v4, 1.0, v4
    v_add_f32 v5, 1.0, v5
    v_add_f32 v6, 1.0, v6
    v_add_f32 v7, 1.0, v7
    v_rcp_f32 v0, v0
    v_rcp_f32 v1, v1
    v_rcp_f32 v2, v2
    v_rcp_f32 v3, v3
    v_rcp_f32 v4, v4
    v_rcp_f32 v5, v5
    v_rcp_f32 v6, v6
    v_rcp_f32 v7, v7
    v_mul_f32 v0, v0, v171
    v_mul_f32 v1, v1, v175
    v_mul_f32 v2, v2, v179
    v_mul_f32 v3, v3, v183
    v_mul_f32 v4, v4, v187
    v_mul_f32 v5, v5, v191
    v_mul_f32 v6, v6, v195
    v_mul_f32 v7, v7, v199
    v_cvt_pk_bf16_f32 v28, v0, v1
    v_cvt_pk_bf16_f32 v29, v2, v3
    v_cvt_pk_bf16_f32 v30, v4, v5
    v_cvt_pk_bf16_f32 v31, v6, v7
    v_add_u32 v212, 35840, v210
    buffer_store_dwordx4 v[28:31], v212, s[32:35], 0 offen
L_k45_end:
    s_endpgm
.section .rodata,"a"
.p2align 6
.amdhsa_kernel xform_kernel
  .amdhsa_next_free_vgpr 160
  .amdhsa_next_free_sgpr 96
  .amdhsa_accum_offset 160
  .amdhsa_group_segment_fixed_size 0
  .amdhsa_kernarg_size 56
  .amdhsa_user_sgpr_count 2
  .amdhsa_user_sgpr_kernarg_segment_ptr 1
  .amdhsa_system_sgpr_workgroup_id_x 1
  .amdhsa_float_denorm_mode_32 3
.end_amdhsa_kernel

.p2align 6
.amdhsa_kernel gemm_kernel
  .amdhsa_next_free_vgpr 256
  .amdhsa_next_free_sgpr 96
  .amdhsa_accum_offset 256
  .amdhsa_group_segment_fixed_size 0
  .amdhsa_kernarg_size 56
  .amdhsa_user_sgpr_count 2
  .amdhsa_user_sgpr_kernarg_segment_ptr 1
  .amdhsa_system_sgpr_workgroup_id_x 1
  .amdhsa_float_denorm_mode_32 3
.end_amdhsa_kernel

.p2align 6
.amdhsa_kernel final_kernel
  .amdhsa_next_free_vgpr 240
  .amdhsa_next_free_sgpr 96
  .amdhsa_accum_offset 240
  .amdhsa_group_segment_fixed_size 0
  .amdhsa_kernarg_size 56
  .amdhsa_user_sgpr_count 2
  .amdhsa_user_sgpr_kernarg_segment_ptr 1
  .amdhsa_system_sgpr_workgroup_id_x 1
  .amdhsa_float_denorm_mode_32 3
.end_amdhsa_kernel
```

```asm
; @launch kernel=xform_kernel grid=(1696,1,1) block=(256,1,1) lds=16384
; @launch kernel=gemm_kernel grid=(256,1,1) block=(512,1,1) lds=152576
; @launch kernel=final_kernel grid=(224,1,1) block=(384,1,1) lds=33792
.amdgcn_target "amdgcn-amd-amdhsa--gfx950"
.text
.globl xform_kernel
.p2align 8
.type xform_kernel,@function
xform_kernel:
    s_cmp_ge_u32 s2, 1696
    s_cbranch_scc1 L_k12_end
    s_load_dwordx4 s[4:7], s[0:1], 0
    s_load_dwordx2 s[8:9], s[0:1], 48
    v_and_b32 v144, 63, v0
    v_lshrrev_b32 v149, 6, v0
    v_and_b32 v145, 15, v144
    v_readfirstlane_b32 s10, v149
    v_lshrrev_b32 v146, 4, v144
    s_mov_b32 s30, 0x05040100
    s_mov_b32 s31, 0x07060302
    s_waitcnt lgkmcnt(0)
    s_mov_b32 s16, s8
    s_and_b32 s17, s9, 0xffff
    s_mov_b32 s18, 268435456
    s_mov_b32 s19, 0x00020000
    s_cmp_ge_u32 s2, 672
    s_cbranch_scc1 L_k12_w
    s_cmp_ge_u32 s2, 336
    s_cselect_b32 s11, 1, 0
    s_mul_i32 s12, s11, 336
    s_sub_u32 s12, s2, s12
    s_mul_hi_u32 s14, s12, 536870912
    s_mul_i32 s13, s14, 8
    s_sub_u32 s13, s12, s13
    s_lshl_b32 s14, s14, 2
    s_add_u32 s14, s14, s10
    s_mul_i32 s15, s11, 16384000
    s_add_u32 s4, s4, s15
    s_addc_u32 s5, s5, 0
    s_mov_b32 s20, s4
    s_and_b32 s21, s5, 0xffff
    s_mov_b32 s22, 16384000
    s_mov_b32 s23, 0x00020000
    s_mul_i32 s15, s14, 98304
    s_lshl_b32 s24, s13, 8
    s_add_u32 s15, s15, s24
    v_lshlrev_b32 v147, 14, v146
    v_lshl_add_u32 v147, v145, 4, v147
    v_add_u32 v147, s15, v147
    buffer_load_dwordx4 v[0:3], v147, s[20:23], 0 offen
    v_add_u32 v149, 2048, v147
    buffer_load_dwordx4 v[4:7], v149, s[20:23], 0 offen
    v_add_u32 v149, 4096, v147
    buffer_load_dwordx4 v[8:11], v149, s[20:23], 0 offen
    v_add_u32 v149, 6144, v147
    buffer_load_dwordx4 v[12:15], v149, s[20:23], 0 offen
    v_add_u32 v149, 8192, v147
    buffer_load_dwordx4 v[16:19], v149, s[20:23], 0 offen
    v_add_u32 v149, 10240, v147
    buffer_load_dwordx4 v[20:23], v149, s[20:23], 0 offen
    v_add_u32 v149, 12288, v147
    buffer_load_dwordx4 v[24:27], v149, s[20:23], 0 offen
    v_add_u32 v149, 14336, v147
    buffer_load_dwordx4 v[28:31], v149, s[20:23], 0 offen
    v_add_u32 v149, 65536, v147
    buffer_load_dwordx4 v[32:35], v149, s[20:23], 0 offen
    v_add_u32 v149, 67584, v147
    buffer_load_dwordx4 v[36:39], v149, s[20:23], 0 offen
    v_add_u32 v149, 69632, v147
    buffer_load_dwordx4 v[40:43], v149, s[20:23], 0 offen
    v_add_u32 v149, 71680, v147
    buffer_load_dwordx4 v[44:47], v149, s[20:23], 0 offen
    v_add_u32 v149, 73728, v147
    buffer_load_dwordx4 v[48:51], v149, s[20:23], 0 offen
    v_add_u32 v149, 75776, v147
    buffer_load_dwordx4 v[52:55], v149, s[20:23], 0 offen
    v_add_u32 v149, 77824, v147
    buffer_load_dwordx4 v[56:59], v149, s[20:23], 0 offen
    v_add_u32 v149, 79872, v147
    buffer_load_dwordx4 v[60:63], v149, s[20:23], 0 offen
    v_lshrrev_b32 v149, 2, v145
    v_lshlrev_b32 v149, 1, v149
    v_bfe_u32 v150, v145, 1, 1
    v_add_u32 v149, v149, v150
    s_lshl_b32 s24, s10, 3
    v_add_u32 v149, s24, v149
    v_lshl_add_u32 v149, v149, 1, 1
    v_and_b32 v150, 1, v145
    v_lshlrev_b32 v150, 5, v150
    v_lshlrev_b32 v151, 3, v146
    v_mad_u32_u24 v96, v149, v151, v150
    v_add_u32 v97, v96, v149
    v_add_u32 v98, v97, v149
    v_add_u32 v99, v98, v149
    v_add_u32 v100, v99, v149
    v_add_u32 v101, v100, v149
    v_add_u32 v102, v101, v149
    v_add_u32 v103, v102, v149
    v_and_b32 v96, 127, v96
    v_cvt_f32_u32 v96, v96
    v_mul_f32 v96, 0x3c000000, v96
    v_cos_f32 v96, v96
    v_and_b32 v97, 127, v97
    v_cvt_f32_u32 v97, v97
    v_mul_f32 v97, 0x3c000000, v97
    v_cos_f32 v97, v97
    v_and_b32 v98, 127, v98
    v_cvt_f32_u32 v98, v98
    v_mul_f32 v98, 0x3c000000, v98
    v_cos_f32 v98, v98
    v_and_b32 v99, 127, v99
    v_cvt_f32_u32 v99, v99
    v_mul_f32 v99, 0x3c000000, v99
    v_cos_f32 v99, v99
    v_and_b32 v100, 127, v100
    v_cvt_f32_u32 v100, v100
    v_mul_f32 v100, 0x3c000000, v100
    v_cos_f32 v100, v100
    v_and_b32 v101, 127, v101
    v_cvt_f32_u32 v101, v101
    v_mul_f32 v101, 0x3c000000, v101
    v_cos_f32 v101, v101
    v_and_b32 v102, 127, v102
    v_cvt_f32_u32 v102, v102
    v_mul_f32 v102, 0x3c000000, v102
    v_cos_f32 v102, v102
    v_and_b32 v103, 127, v103
    v_cvt_f32_u32 v103, v103
    v_mul_f32 v103, 0x3c000000, v103
    v_cos_f32 v103, v103
    v_cvt_pk_bf16_f32 v112, v96, v97
    v_cvt_pk_bf16_f32 v113, v98, v99
    v_cvt_pk_bf16_f32 v114, v100, v101
    v_cvt_pk_bf16_f32 v115, v102, v103
    s_lshl_b32 s24, s10, 11
    v_lshlrev_b32 v152, 4, v144
    v_add_u32 v152, s24, v152
    ds_write_b128 v152, v[112:115] offset:0
    v_lshlrev_b32 v151, 3, v146
    v_add_u32 v151, 32, v151
    v_mad_u32_u24 v96, v149, v151, v150
    v_add_u32 v97, v96, v149
    v_add_u32 v98, v97, v149
    v_add_u32 v99, v98, v149
    v_add_u32 v100, v99, v149
    v_add_u32 v101, v100, v149
    v_add_u32 v102, v101, v149
    v_add_u32 v103, v102, v149
    v_and_b32 v96, 127, v96
    v_cvt_f32_u32 v96, v96
    v_mul_f32 v96, 0x3c000000, v96
    v_cos_f32 v96, v96
    v_and_b32 v97, 127, v97
    v_cvt_f32_u32 v97, v97
    v_mul_f32 v97, 0x3c000000, v97
    v_cos_f32 v97, v97
    v_and_b32 v98, 127, v98
    v_cvt_f32_u32 v98, v98
    v_mul_f32 v98, 0x3c000000, v98
    v_cos_f32 v98, v98
    v_and_b32 v99, 127, v99
    v_cvt_f32_u32 v99, v99
    v_mul_f32 v99, 0x3c000000, v99
    v_cos_f32 v99, v99
    v_and_b32 v100, 127, v100
    v_cvt_f32_u32 v100, v100
    v_mul_f32 v100, 0x3c000000, v100
    v_cos_f32 v100, v100
    v_and_b32 v101, 127, v101
    v_cvt_f32_u32 v101, v101
    v_mul_f32 v101, 0x3c000000, v101
    v_cos_f32 v101, v101
    v_and_b32 v102, 127, v102
    v_cvt_f32_u32 v102, v102
    v_mul_f32 v102, 0x3c000000, v102
    v_cos_f32 v102, v102
    v_and_b32 v103, 127, v103
    v_cvt_f32_u32 v103, v103
    v_mul_f32 v103, 0x3c000000, v103
    v_cos_f32 v103, v103
    v_cvt_pk_bf16_f32 v112, v96, v97
    v_cvt_pk_bf16_f32 v113, v98, v99
    v_cvt_pk_bf16_f32 v114, v100, v101
    v_cvt_pk_bf16_f32 v115, v102, v103
    s_lshl_b32 s24, s10, 11
    v_lshlrev_b32 v152, 4, v144
    v_add_u32 v152, s24, v152
    ds_write_b128 v152, v[112:115] offset:1024
    s_waitcnt lgkmcnt(0)
    s_barrier
    v_lshlrev_b32 v152, 4, v144
    ds_read_b128 v[64:67], v152 offset:0
    ds_read_b128 v[68:71], v152 offset:1024
    ds_read_b128 v[72:75], v152 offset:2048
    ds_read_b128 v[76:79], v152 offset:3072
    ds_read_b128 v[80:83], v152 offset:4096
    ds_read_b128 v[84:87], v152 offset:5120
    ds_read_b128 v[88:91], v152 offset:6144
    ds_read_b128 v[92:95], v152 offset:7168
    s_bfe_u32 s24, s14, 0x10003
    s_mul_i32 s24, s24, 3
    v_and_b32 v149, 3, v145
    v_xor_b32 v149, s24, v149
    v_lshlrev_b32 v149, 4, v149
    v_lshrrev_b32 v150, 2, v145
    s_mov_b32 s24, 688128
    v_mad_u32_u24 v149, v150, s24, v149
    s_mov_b32 s24, 43008
    v_mad_u32_u24 v148, v146, s24, v149
    s_mul_i32 s24, s11, 22020096
    s_mul_i32 s25, s13, 2752512
    s_add_u32 s24, s24, s25
    s_lshl_b32 s25, s14, 6
    s_add_u32 s24, s24, s25
    s_add_u32 s24, s24, 67108864
    s_waitcnt vmcnt(0) lgkmcnt(0)
    v_perm_b32 v96, v4, v0, s30
    v_perm_b32 v97, v12, v8, s30
    v_perm_b32 v98, v20, v16, s30
    v_perm_b32 v99, v28, v24, s30
    v_perm_b32 v100, v4, v0, s31
    v_perm_b32 v101, v12, v8, s31
    v_perm_b32 v102, v20, v16, s31
    v_perm_b32 v103, v28, v24, s31
    v_perm_b32 v104, v36, v32, s30
    v_perm_b32 v105, v44, v40, s30
    v_perm_b32 v106, v52, v48, s30
    v_perm_b32 v107, v60, v56, s30
    v_perm_b32 v108, v36, v32, s31
    v_perm_b32 v109, v44, v40, s31
    v_perm_b32 v110, v52, v48, s31
    v_perm_b32 v111, v60, v56, s31
    v_mfma_f32_16x16x32_bf16 v[112:115], v[64:67], v[96:99], 0
    v_mfma_f32_16x16x32_bf16 v[116:119], v[64:67], v[100:103], 0
    v_mfma_f32_16x16x32_bf16 v[120:123], v[72:75], v[96:99], 0
    v_mfma_f32_16x16x32_bf16 v[124:127], v[72:75], v[100:103], 0
    v_mfma_f32_16x16x32_bf16 v[128:131], v[80:83], v[96:99], 0
    v_mfma_f32_16x16x32_bf16 v[132:135], v[80:83], v[100:103], 0
    v_mfma_f32_16x16x32_bf16 v[136:139], v[88:91], v[96:99], 0
    v_mfma_f32_16x16x32_bf16 v[140:143], v[88:91], v[100:103], 0
    v_mfma_f32_16x16x32_bf16 v[112:115], v[68:71], v[104:107], v[112:115]
    v_mfma_f32_16x16x32_bf16 v[116:119], v[68:71], v[108:111], v[116:119]
    v_mfma_f32_16x16x32_bf16 v[120:123], v[76:79], v[104:107], v[120:123]
    v_mfma_f32_16x16x32_bf16 v[124:127], v[76:79], v[108:111], v[124:127]
    v_mfma_f32_16x16x32_bf16 v[128:131], v[84:87], v[104:107], v[128:131]
    v_mfma_f32_16x16x32_bf16 v[132:135], v[84:87], v[108:111], v[132:135]
    v_mfma_f32_16x16x32_bf16 v[136:139], v[92:95], v[104:107], v[136:139]
    v_mfma_f32_16x16x32_bf16 v[140:143], v[92:95], v[108:111], v[140:143]
    v_perm_b32 v96, v5, v1, s30
    v_perm_b32 v97, v13, v9, s30
    v_perm_b32 v98, v21, v17, s30
    v_perm_b32 v99, v29, v25, s30
    v_perm_b32 v100, v5, v1, s31
    v_perm_b32 v101, v13, v9, s31
    v_perm_b32 v102, v21, v17, s31
    v_perm_b32 v103, v29, v25, s31
    v_perm_b32 v104, v37, v33, s30
    v_perm_b32 v105, v45, v41, s30
    v_perm_b32 v106, v53, v49, s30
    v_perm_b32 v107, v61, v57, s30
    v_perm_b32 v108, v37, v33, s31
    v_perm_b32 v109, v45, v41, s31
    v_perm_b32 v110, v53, v49, s31
    v_perm_b32 v111, v61, v57, s31
    v_cvt_pk_bf16_f32 v0, v112, v116
    v_cvt_pk_bf16_f32 v4, v113, v117
    v_cvt_pk_bf16_f32 v8, v114, v118
    v_cvt_pk_bf16_f32 v12, v115, v119
    v_cvt_pk_bf16_f32 v16, v120, v124
    v_cvt_pk_bf16_f32 v20, v121, v125
    v_cvt_pk_bf16_f32 v24, v122, v126
    v_cvt_pk_bf16_f32 v28, v123, v127
    v_cvt_pk_bf16_f32 v32, v128, v132
    v_cvt_pk_bf16_f32 v36, v129, v133
    v_cvt_pk_bf16_f32 v40, v130, v134
    v_cvt_pk_bf16_f32 v44, v131, v135
    v_cvt_pk_bf16_f32 v48, v136, v140
    v_cvt_pk_bf16_f32 v52, v137, v141
    v_cvt_pk_bf16_f32 v56, v138, v142
    v_cvt_pk_bf16_f32 v60, v139, v143
    v_mfma_f32_16x16x32_bf16 v[112:115], v[64:67], v[96:99], 0
    v_mfma_f32_16x16x32_bf16 v[116:119], v[64:67], v[100:103], 0
    v_mfma_f32_16x16x32_bf16 v[120:123], v[72:75], v[96:99], 0
    v_mfma_f32_16x16x32_bf16 v[124:127], v[72:75], v[100:103], 0
    v_mfma_f32_16x16x32_bf16 v[128:131], v[80:83], v[96:99], 0
    v_mfma_f32_16x16x32_bf16 v[132:135], v[80:83], v[100:103], 0
    v_mfma_f32_16x16x32_bf16 v[136:139], v[88:91], v[96:99], 0
    v_mfma_f32_16x16x32_bf16 v[140:143], v[88:91], v[100:103], 0
    v_mfma_f32_16x16x32_bf16 v[112:115], v[68:71], v[104:107], v[112:115]
    v_mfma_f32_16x16x32_bf16 v[116:119], v[68:71], v[108:111], v[116:119]
    v_mfma_f32_16x16x32_bf16 v[120:123], v[76:79], v[104:107], v[120:123]
    v_mfma_f32_16x16x32_bf16 v[124:127], v[76:79], v[108:111], v[124:127]
    v_mfma_f32_16x16x32_bf16 v[128:131], v[84:87], v[104:107], v[128:131]
    v_mfma_f32_16x16x32_bf16 v[132:135], v[84:87], v[108:111], v[132:135]
    v_mfma_f32_16x16x32_bf16 v[136:139], v[92:95], v[104:107], v[136:139]
    v_mfma_f32_16x16x32_bf16 v[140:143], v[92:95], v[108:111], v[140:143]
    v_perm_b32 v96, v6, v2, s30
    v_perm_b32 v97, v14, v10, s30
    v_perm_b32 v98, v22, v18, s30
    v_perm_b32 v99, v30, v26, s30
    v_perm_b32 v100, v6, v2, s31
    v_perm_b32 v101, v14, v10, s31
    v_perm_b32 v102, v22, v18, s31
    v_perm_b32 v103, v30, v26, s31
    v_perm_b32 v104, v38, v34, s30
    v_perm_b32 v105, v46, v42, s30
    v_perm_b32 v106, v54, v50, s30
    v_perm_b32 v107, v62, v58, s30
    v_perm_b32 v108, v38, v34, s31
    v_perm_b32 v109, v46, v42, s31
    v_perm_b32 v110, v54, v50, s31
    v_perm_b32 v111, v62, v58, s31
    v_cvt_pk_bf16_f32 v1, v112, v116
    v_cvt_pk_bf16_f32 v5, v113, v117
    v_cvt_pk_bf16_f32 v9, v114, v118
    v_cvt_pk_bf16_f32 v13, v115, v119
    v_cvt_pk_bf16_f32 v17, v120, v124
    v_cvt_pk_bf16_f32 v21, v121, v125
    v_cvt_pk_bf16_f32 v25, v122, v126
    v_cvt_pk_bf16_f32 v29, v123, v127
    v_cvt_pk_bf16_f32 v33, v128, v132
    v_cvt_pk_bf16_f32 v37, v129, v133
    v_cvt_pk_bf16_f32 v41, v130, v134
    v_cvt_pk_bf16_f32 v45, v131, v135
    v_cvt_pk_bf16_f32 v49, v136, v140
    v_cvt_pk_bf16_f32 v53, v137, v141
    v_cvt_pk_bf16_f32 v57, v138, v142
    v_cvt_pk_bf16_f32 v61, v139, v143
    v_mfma_f32_16x16x32_bf16 v[112:115], v[64:67], v[96:99], 0
    v_mfma_f32_16x16x32_bf16 v[116:119], v[64:67], v[100:103], 0
    v_mfma_f32_16x16x32_bf16 v[120:123], v[72:75], v[96:99], 0
    v_mfma_f32_16x16x32_bf16 v[124:127], v[72:75], v[100:103], 0
    v_mfma_f32_16x16x32_bf16 v[128:131], v[80:83], v[96:99], 0
    v_mfma_f32_16x16x32_bf16 v[132:135], v[80:83], v[100:103], 0
    v_mfma_f32_16x16x32_bf16 v[136:139], v[88:91], v[96:99], 0
    v_mfma_f32_16x16x32_bf16 v[140:143], v[88:91], v[100:103], 0
    v_mfma_f32_16x16x32_bf16 v[112:115], v[68:71], v[104:107], v[112:115]
    v_mfma_f32_16x16x32_bf16 v[116:119], v[68:71], v[108:111], v[116:119]
    v_mfma_f32_16x16x32_bf16 v[120:123], v[76:79], v[104:107], v[120:123]
    v_mfma_f32_16x16x32_bf16 v[124:127], v[76:79], v[108:111], v[124:127]
    v_mfma_f32_16x16x32_bf16 v[128:131], v[84:87], v[104:107], v[128:131]
    v_mfma_f32_16x16x32_bf16 v[132:135], v[84:87], v[108:111], v[132:135]
    v_mfma_f32_16x16x32_bf16 v[136:139], v[92:95], v[104:107], v[136:139]
    v_mfma_f32_16x16x32_bf16 v[140:143], v[92:95], v[108:111], v[140:143]
    v_perm_b32 v96, v7, v3, s30
    v_perm_b32 v97, v15, v11, s30
    v_perm_b32 v98, v23, v19, s30
    v_perm_b32 v99, v31, v27, s30
    v_perm_b32 v100, v7, v3, s31
    v_perm_b32 v101, v15, v11, s31
    v_perm_b32 v102, v23, v19, s31
    v_perm_b32 v103, v31, v27, s31
    v_perm_b32 v104, v39, v35, s30
    v_perm_b32 v105, v47, v43, s30
    v_perm_b32 v106, v55, v51, s30
    v_perm_b32 v107, v63, v59, s30
    v_perm_b32 v108, v39, v35, s31
    v_perm_b32 v109, v47, v43, s31
    v_perm_b32 v110, v55, v51, s31
    v_perm_b32 v111, v63, v59, s31
    v_cvt_pk_bf16_f32 v2, v112, v116
    v_cvt_pk_bf16_f32 v6, v113, v117
    v_cvt_pk_bf16_f32 v10, v114, v118
    v_cvt_pk_bf16_f32 v14, v115, v119
    v_cvt_pk_bf16_f32 v18, v120, v124
    v_cvt_pk_bf16_f32 v22, v121, v125
    v_cvt_pk_bf16_f32 v26, v122, v126
    v_cvt_pk_bf16_f32 v30, v123, v127
    v_cvt_pk_bf16_f32 v34, v128, v132
    v_cvt_pk_bf16_f32 v38, v129, v133
    v_cvt_pk_bf16_f32 v42, v130, v134
    v_cvt_pk_bf16_f32 v46, v131, v135
    v_cvt_pk_bf16_f32 v50, v136, v140
    v_cvt_pk_bf16_f32 v54, v137, v141
    v_cvt_pk_bf16_f32 v58, v138, v142
    v_cvt_pk_bf16_f32 v62, v139, v143
    v_mfma_f32_16x16x32_bf16 v[112:115], v[64:67], v[96:99], 0
    v_mfma_f32_16x16x32_bf16 v[116:119], v[64:67], v[100:103], 0
    v_mfma_f32_16x16x32_bf16 v[120:123], v[72:75], v[96:99], 0
    v_mfma_f32_16x16x32_bf16 v[124:127], v[72:75], v[100:103], 0
    v_mfma_f32_16x16x32_bf16 v[128:131], v[80:83], v[96:99], 0
    v_mfma_f32_16x16x32_bf16 v[132:135], v[80:83], v[100:103], 0
    v_mfma_f32_16x16x32_bf16 v[136:139], v[88:91], v[96:99], 0
    v_mfma_f32_16x16x32_bf16 v[140:143], v[88:91], v[100:103], 0
    v_mfma_f32_16x16x32_bf16 v[112:115], v[68:71], v[104:107], v[112:115]
    v_mfma_f32_16x16x32_bf16 v[116:119], v[68:71], v[108:111], v[116:119]
    v_mfma_f32_16x16x32_bf16 v[120:123], v[76:79], v[104:107], v[120:123]
    v_mfma_f32_16x16x32_bf16 v[124:127], v[76:79], v[108:111], v[124:127]
    v_mfma_f32_16x16x32_bf16 v[128:131], v[84:87], v[104:107], v[128:131]
    v_mfma_f32_16x16x32_bf16 v[132:135], v[84:87], v[108:111], v[132:135]
    v_mfma_f32_16x16x32_bf16 v[136:139], v[92:95], v[104:107], v[136:139]
    v_mfma_f32_16x16x32_bf16 v[140:143], v[92:95], v[108:111], v[140:143]
    s_nop 1
    v_cvt_pk_bf16_f32 v3, v112, v116
    v_cvt_pk_bf16_f32 v7, v113, v117
    v_cvt_pk_bf16_f32 v11, v114, v118
    v_cvt_pk_bf16_f32 v15, v115, v119
    v_cvt_pk_bf16_f32 v19, v120, v124
    v_cvt_pk_bf16_f32 v23, v121, v125
    v_cvt_pk_bf16_f32 v27, v122, v126
    v_cvt_pk_bf16_f32 v31, v123, v127
    v_cvt_pk_bf16_f32 v35, v128, v132
    v_cvt_pk_bf16_f32 v39, v129, v133
    v_cvt_pk_bf16_f32 v43, v130, v134
    v_cvt_pk_bf16_f32 v47, v131, v135
    v_cvt_pk_bf16_f32 v51, v136, v140
    v_cvt_pk_bf16_f32 v55, v137, v141
    v_cvt_pk_bf16_f32 v59, v138, v142
    v_cvt_pk_bf16_f32 v63, v139, v143
    s_add_u32 s25, s24, 0
    buffer_store_dwordx4 v[0:3], v148, s[16:19], s25 offen sc1
    s_add_u32 s25, s24, 10752
    buffer_store_dwordx4 v[4:7], v148, s[16:19], s25 offen sc1
    s_add_u32 s25, s24, 21504
    buffer_store_dwordx4 v[8:11], v148, s[16:19], s25 offen sc1
    s_add_u32 s25, s24, 32256
    buffer_store_dwordx4 v[12:15], v148, s[16:19], s25 offen sc1
    s_add_u32 s25, s24, 172032
    buffer_store_dwordx4 v[16:19], v148, s[16:19], s25 offen sc1
    s_add_u32 s25, s24, 182784
    buffer_store_dwordx4 v[20:23], v148, s[16:19], s25 offen sc1
    s_add_u32 s25, s24, 193536
    buffer_store_dwordx4 v[24:27], v148, s[16:19], s25 offen sc1
    s_add_u32 s25, s24, 204288
    buffer_store_dwordx4 v[28:31], v148, s[16:19], s25 offen sc1
    s_add_u32 s25, s24, 344064
    buffer_store_dwordx4 v[32:35], v148, s[16:19], s25 offen sc1
    s_add_u32 s25, s24, 354816
    buffer_store_dwordx4 v[36:39], v148, s[16:19], s25 offen sc1
    s_add_u32 s25, s24, 365568
    buffer_store_dwordx4 v[40:43], v148, s[16:19], s25 offen sc1
    s_add_u32 s25, s24, 376320
    buffer_store_dwordx4 v[44:47], v148, s[16:19], s25 offen sc1
    s_add_u32 s25, s24, 516096
    buffer_store_dwordx4 v[48:51], v148, s[16:19], s25 offen sc1
    s_add_u32 s25, s24, 526848
    buffer_store_dwordx4 v[52:55], v148, s[16:19], s25 offen sc1
    s_add_u32 s25, s24, 537600
    buffer_store_dwordx4 v[56:59], v148, s[16:19], s25 offen sc1
    s_add_u32 s25, s24, 548352
    buffer_store_dwordx4 v[60:63], v148, s[16:19], s25 offen sc1
    s_endpgm
L_k12_w:
    s_sub_u32 s12, s2, 672
    s_and_b32 s13, s12, 3
    s_lshr_b32 s14, s12, 2
    s_lshl_b32 s14, s14, 2
    s_add_u32 s14, s14, s10
    s_mov_b32 s20, s6
    s_and_b32 s21, s7, 0xffff
    s_mov_b32 s22, 16252928
    s_mov_b32 s23, 0x00020000
    v_and_b32 v149, 1, v146
    v_lshlrev_b32 v147, 23, v149
    v_lshrrev_b32 v149, 2, v145
    v_lshl_add_u32 v147, v149, 6, v147
    v_and_b32 v149, 1, v145
    v_lshl_add_u32 v147, v149, 5, v147
    v_bfe_u32 v149, v145, 1, 1
    v_lshl_add_u32 v147, v149, 3, v147
    s_lshl_b32 s15, s14, 10
    s_lshl_b32 s24, s13, 8
    s_add_u32 s15, s15, s24
    v_add_u32 v147, s15, v147
    buffer_load_dwordx2 v[0:1], v147, s[20:23], 0 offen
    buffer_load_dwordx2 v[2:3], v147, s[20:23], 0 offen offset:16
    v_add_u32 v149, 1048576, v147
    buffer_load_dwordx2 v[4:5], v149, s[20:23], 0 offen
    buffer_load_dwordx2 v[6:7], v149, s[20:23], 0 offen offset:16
    v_add_u32 v149, 2097152, v147
    buffer_load_dwordx2 v[8:9], v149, s[20:23], 0 offen
    buffer_load_dwordx2 v[10:11], v149, s[20:23], 0 offen offset:16
    v_add_u32 v149, 3145728, v147
    buffer_load_dwordx2 v[12:13], v149, s[20:23], 0 offen
    buffer_load_dwordx2 v[14:15], v149, s[20:23], 0 offen offset:16
    v_add_u32 v149, 4194304, v147
    buffer_load_dwordx2 v[16:17], v149, s[20:23], 0 offen
    buffer_load_dwordx2 v[18:19], v149, s[20:23], 0 offen offset:16
    v_add_u32 v149, 5242880, v147
    buffer_load_dwordx2 v[20:21], v149, s[20:23], 0 offen
    buffer_load_dwordx2 v[22:23], v149, s[20:23], 0 offen offset:16
    v_add_u32 v149, 6291456, v147
    buffer_load_dwordx2 v[24:25], v149, s[20:23], 0 offen
    buffer_load_dwordx2 v[26:27], v149, s[20:23], 0 offen offset:16
    v_add_u32 v149, 7340032, v147
    buffer_load_dwordx2 v[28:29], v149, s[20:23], 0 offen
    buffer_load_dwordx2 v[30:31], v149, s[20:23], 0 offen offset:16
    v_lshrrev_b32 v149, 2, v145
    v_lshlrev_b32 v149, 1, v149
    v_bfe_u32 v150, v145, 1, 1
    v_add_u32 v149, v149, v150
    s_lshl_b32 s24, s10, 3
    v_add_u32 v149, s24, v149
    v_lshl_add_u32 v149, v149, 1, 1
    v_and_b32 v150, 1, v145
    v_lshlrev_b32 v150, 5, v150
    v_and_b32 v151, 1, v146
    v_lshlrev_b32 v151, 3, v151
    v_mad_u32_u24 v96, v149, v151, v150
    v_add_u32 v97, v96, v149
    v_add_u32 v98, v97, v149
    v_add_u32 v99, v98, v149
    v_add_u32 v100, v99, v149
    v_add_u32 v101, v100, v149
    v_add_u32 v102, v101, v149
    v_add_u32 v103, v102, v149
    v_cmp_lt_u32 s[26:27], 1, v146
    v_and_b32 v96, 127, v96
    v_cvt_f32_u32 v96, v96
    v_mul_f32 v96, 0x3c000000, v96
    v_cos_f32 v96, v96
    v_and_b32 v97, 127, v97
    v_cvt_f32_u32 v97, v97
    v_mul_f32 v97, 0x3c000000, v97
    v_cos_f32 v97, v97
    v_and_b32 v98, 127, v98
    v_cvt_f32_u32 v98, v98
    v_mul_f32 v98, 0x3c000000, v98
    v_cos_f32 v98, v98
    v_and_b32 v99, 127, v99
    v_cvt_f32_u32 v99, v99
    v_mul_f32 v99, 0x3c000000, v99
    v_cos_f32 v99, v99
    v_and_b32 v100, 127, v100
    v_cvt_f32_u32 v100, v100
    v_mul_f32 v100, 0x3c000000, v100
    v_cos_f32 v100, v100
    v_and_b32 v101, 127, v101
    v_cvt_f32_u32 v101, v101
    v_mul_f32 v101, 0x3c000000, v101
    v_cos_f32 v101, v101
    v_and_b32 v102, 127, v102
    v_cvt_f32_u32 v102, v102
    v_mul_f32 v102, 0x3c000000, v102
    v_cos_f32 v102, v102
    v_and_b32 v103, 127, v103
    v_cvt_f32_u32 v103, v103
    v_mul_f32 v103, 0x3c000000, v103
    v_cos_f32 v103, v103
    v_cvt_pk_bf16_f32 v112, v96, v97
    v_cvt_pk_bf16_f32 v113, v98, v99
    v_cvt_pk_bf16_f32 v114, v100, v101
    v_cvt_pk_bf16_f32 v115, v102, v103
    v_lshlrev_b32 v116, 16, v112
    v_and_b32 v117, 0xffff0000, v112
    v_sub_f32 v96, v96, v116
    v_sub_f32 v97, v97, v117
    v_cvt_pk_bf16_f32 v116, v96, v97
    v_cndmask_b32 v112, v112, v116, s[26:27]
    v_lshlrev_b32 v116, 16, v113
    v_and_b32 v117, 0xffff0000, v113
    v_sub_f32 v98, v98, v116
    v_sub_f32 v99, v99, v117
    v_cvt_pk_bf16_f32 v116, v98, v99
    v_cndmask_b32 v113, v113, v116, s[26:27]
    v_lshlrev_b32 v116, 16, v114
    v_and_b32 v117, 0xffff0000, v114
    v_sub_f32 v100, v100, v116
    v_sub_f32 v101, v101, v117
    v_cvt_pk_bf16_f32 v116, v100, v101
    v_cndmask_b32 v114, v114, v116, s[26:27]
    v_lshlrev_b32 v116, 16, v115
    v_and_b32 v117, 0xffff0000, v115
    v_sub_f32 v102, v102, v116
    v_sub_f32 v103, v103, v117
    v_cvt_pk_bf16_f32 v116, v102, v103
    v_cndmask_b32 v115, v115, v116, s[26:27]
    s_lshl_b32 s24, s10, 10
    v_lshlrev_b32 v152, 4, v144
    v_add_u32 v152, s24, v152
    ds_write_b128 v152, v[112:115]
    s_waitcnt lgkmcnt(0)
    s_barrier
    v_lshlrev_b32 v152, 4, v144
    ds_read_b128 v[64:67], v152 offset:0
    ds_read_b128 v[68:71], v152 offset:1024
    ds_read_b128 v[72:75], v152 offset:2048
    ds_read_b128 v[76:79], v152 offset:3072
    s_and_b32 s24, s14, 3
    s_bfe_u32 s25, s14, 0x10003
    s_lshl_b32 s25, s25, 2
    s_or_b32 s24, s24, s25
    s_lshl_b32 s24, s24, 1
    v_xor_b32 v149, s24, v145
    v_lshlrev_b32 v149, 4, v149
    s_mov_b32 s25, 32768
    v_mul_u32_u24 v148, s25, v146
    v_add_u32 v148, v148, v149
    s_mul_i32 s24, s13, 16777216
    s_lshr_b32 s25, s14, 5
    s_mul_i32 s25, s25, 524288
    s_add_u32 s24, s24, s25
    s_and_b32 s25, s14, 31
    s_lshl_b32 s25, s25, 8
    s_add_u32 s24, s24, s25
    s_waitcnt vmcnt(0) lgkmcnt(0)
    v_perm_b32 v32, v4, v0, s30
    v_perm_b32 v33, v12, v8, s30
    v_perm_b32 v34, v20, v16, s30
    v_perm_b32 v35, v28, v24, s30
    v_perm_b32 v36, v4, v0, s31
    v_perm_b32 v37, v12, v8, s31
    v_perm_b32 v38, v20, v16, s31
    v_perm_b32 v39, v28, v24, s31
    v_perm_b32 v40, v5, v1, s30
    v_perm_b32 v41, v13, v9, s30
    v_perm_b32 v42, v21, v17, s30
    v_perm_b32 v43, v29, v25, s30
    v_perm_b32 v44, v5, v1, s31
    v_perm_b32 v45, v13, v9, s31
    v_perm_b32 v46, v21, v17, s31
    v_perm_b32 v47, v29, v25, s31
    v_perm_b32 v48, v6, v2, s30
    v_perm_b32 v49, v14, v10, s30
    v_perm_b32 v50, v22, v18, s30
    v_perm_b32 v51, v30, v26, s30
    v_perm_b32 v52, v6, v2, s31
    v_perm_b32 v53, v14, v10, s31
    v_perm_b32 v54, v22, v18, s31
    v_perm_b32 v55, v30, v26, s31
    v_perm_b32 v56, v7, v3, s30
    v_perm_b32 v57, v15, v11, s30
    v_perm_b32 v58, v23, v19, s30
    v_perm_b32 v59, v31, v27, s30
    v_perm_b32 v60, v7, v3, s31
    v_perm_b32 v61, v15, v11, s31
    v_perm_b32 v62, v23, v19, s31
    v_perm_b32 v63, v31, v27, s31
    v_mfma_f32_16x16x32_bf16 v[112:115], v[64:67], v[32:35], 0
    v_mfma_f32_16x16x32_bf16 v[116:119], v[64:67], v[36:39], 0
    v_mfma_f32_16x16x32_bf16 v[120:123], v[64:67], v[40:43], 0
    v_mfma_f32_16x16x32_bf16 v[124:127], v[64:67], v[44:47], 0
    v_mfma_f32_16x16x32_bf16 v[128:131], v[64:67], v[48:51], 0
    v_mfma_f32_16x16x32_bf16 v[132:135], v[64:67], v[52:55], 0
    v_mfma_f32_16x16x32_bf16 v[136:139], v[64:67], v[56:59], 0
    v_mfma_f32_16x16x32_bf16 v[140:143], v[64:67], v[60:63], 0
    s_nop 1
    v_cvt_pk_bf16_f32 v0, v112, v116
    s_nop 0
    v_cvt_pk_bf16_f32 v1, v120, v124
    s_nop 0
    v_cvt_pk_bf16_f32 v2, v128, v132
    s_nop 0
    v_cvt_pk_bf16_f32 v3, v136, v140
    v_cvt_pk_bf16_f32 v4, v113, v117
    v_cvt_pk_bf16_f32 v5, v121, v125
    v_cvt_pk_bf16_f32 v6, v129, v133
    v_cvt_pk_bf16_f32 v7, v137, v141
    v_cvt_pk_bf16_f32 v8, v114, v118
    v_cvt_pk_bf16_f32 v9, v122, v126
    v_cvt_pk_bf16_f32 v10, v130, v134
    v_cvt_pk_bf16_f32 v11, v138, v142
    v_cvt_pk_bf16_f32 v12, v115, v119
    v_cvt_pk_bf16_f32 v13, v123, v127
    v_cvt_pk_bf16_f32 v14, v131, v135
    v_cvt_pk_bf16_f32 v15, v139, v143
    s_add_u32 s25, s24, 0
    buffer_store_dwordx4 v[0:3], v148, s[16:19], s25 offen sc1
    s_add_u32 s25, s24, 8192
    buffer_store_dwordx4 v[4:7], v148, s[16:19], s25 offen sc1
    s_add_u32 s25, s24, 16384
    buffer_store_dwordx4 v[8:11], v148, s[16:19], s25 offen sc1
    s_add_u32 s25, s24, 24576
    buffer_store_dwordx4 v[12:15], v148, s[16:19], s25 offen sc1
    v_mfma_f32_16x16x32_bf16 v[112:115], v[68:71], v[32:35], 0
    v_mfma_f32_16x16x32_bf16 v[116:119], v[68:71], v[36:39], 0
    v_mfma_f32_16x16x32_bf16 v[120:123], v[68:71], v[40:43], 0
    v_mfma_f32_16x16x32_bf16 v[124:127], v[68:71], v[44:47], 0
    v_mfma_f32_16x16x32_bf16 v[128:131], v[68:71], v[48:51], 0
    v_mfma_f32_16x16x32_bf16 v[132:135], v[68:71], v[52:55], 0
    v_mfma_f32_16x16x32_bf16 v[136:139], v[68:71], v[56:59], 0
    v_mfma_f32_16x16x32_bf16 v[140:143], v[68:71], v[60:63], 0
    s_nop 1
    v_cvt_pk_bf16_f32 v16, v112, v116
    s_nop 0
    v_cvt_pk_bf16_f32 v17, v120, v124
    s_nop 0
    v_cvt_pk_bf16_f32 v18, v128, v132
    s_nop 0
    v_cvt_pk_bf16_f32 v19, v136, v140
    v_cvt_pk_bf16_f32 v20, v113, v117
    v_cvt_pk_bf16_f32 v21, v121, v125
    v_cvt_pk_bf16_f32 v22, v129, v133
    v_cvt_pk_bf16_f32 v23, v137, v141
    v_cvt_pk_bf16_f32 v24, v114, v118
    v_cvt_pk_bf16_f32 v25, v122, v126
    v_cvt_pk_bf16_f32 v26, v130, v134
    v_cvt_pk_bf16_f32 v27, v138, v142
    v_cvt_pk_bf16_f32 v28, v115, v119
    v_cvt_pk_bf16_f32 v29, v123, v127
    v_cvt_pk_bf16_f32 v30, v131, v135
    v_cvt_pk_bf16_f32 v31, v139, v143
    s_add_u32 s25, s24, 131072
    buffer_store_dwordx4 v[16:19], v148, s[16:19], s25 offen sc1
    s_add_u32 s25, s24, 139264
    buffer_store_dwordx4 v[20:23], v148, s[16:19], s25 offen sc1
    s_add_u32 s25, s24, 147456
    buffer_store_dwordx4 v[24:27], v148, s[16:19], s25 offen sc1
    s_add_u32 s25, s24, 155648
    buffer_store_dwordx4 v[28:31], v148, s[16:19], s25 offen sc1
    v_mfma_f32_16x16x32_bf16 v[112:115], v[72:75], v[32:35], 0
    v_mfma_f32_16x16x32_bf16 v[116:119], v[72:75], v[36:39], 0
    v_mfma_f32_16x16x32_bf16 v[120:123], v[72:75], v[40:43], 0
    v_mfma_f32_16x16x32_bf16 v[124:127], v[72:75], v[44:47], 0
    v_mfma_f32_16x16x32_bf16 v[128:131], v[72:75], v[48:51], 0
    v_mfma_f32_16x16x32_bf16 v[132:135], v[72:75], v[52:55], 0
    v_mfma_f32_16x16x32_bf16 v[136:139], v[72:75], v[56:59], 0
    v_mfma_f32_16x16x32_bf16 v[140:143], v[72:75], v[60:63], 0
    s_nop 1
    v_cvt_pk_bf16_f32 v0, v112, v116
    s_nop 0
    v_cvt_pk_bf16_f32 v1, v120, v124
    s_nop 0
    v_cvt_pk_bf16_f32 v2, v128, v132
    s_nop 0
    v_cvt_pk_bf16_f32 v3, v136, v140
    v_cvt_pk_bf16_f32 v4, v113, v117
    v_cvt_pk_bf16_f32 v5, v121, v125
    v_cvt_pk_bf16_f32 v6, v129, v133
    v_cvt_pk_bf16_f32 v7, v137, v141
    v_cvt_pk_bf16_f32 v8, v114, v118
    v_cvt_pk_bf16_f32 v9, v122, v126
    v_cvt_pk_bf16_f32 v10, v130, v134
    v_cvt_pk_bf16_f32 v11, v138, v142
    v_cvt_pk_bf16_f32 v12, v115, v119
    v_cvt_pk_bf16_f32 v13, v123, v127
    v_cvt_pk_bf16_f32 v14, v131, v135
    v_cvt_pk_bf16_f32 v15, v139, v143
    s_add_u32 s25, s24, 262144
    buffer_store_dwordx4 v[0:3], v148, s[16:19], s25 offen sc1
    s_add_u32 s25, s24, 270336
    buffer_store_dwordx4 v[4:7], v148, s[16:19], s25 offen sc1
    s_add_u32 s25, s24, 278528
    buffer_store_dwordx4 v[8:11], v148, s[16:19], s25 offen sc1
    s_add_u32 s25, s24, 286720
    buffer_store_dwordx4 v[12:15], v148, s[16:19], s25 offen sc1
    v_mfma_f32_16x16x32_bf16 v[112:115], v[76:79], v[32:35], 0
    v_mfma_f32_16x16x32_bf16 v[116:119], v[76:79], v[36:39], 0
    v_mfma_f32_16x16x32_bf16 v[120:123], v[76:79], v[40:43], 0
    v_mfma_f32_16x16x32_bf16 v[124:127], v[76:79], v[44:47], 0
    v_mfma_f32_16x16x32_bf16 v[128:131], v[76:79], v[48:51], 0
    v_mfma_f32_16x16x32_bf16 v[132:135], v[76:79], v[52:55], 0
    v_mfma_f32_16x16x32_bf16 v[136:139], v[76:79], v[56:59], 0
    v_mfma_f32_16x16x32_bf16 v[140:143], v[76:79], v[60:63], 0
    s_nop 1
    v_cvt_pk_bf16_f32 v16, v112, v116
    s_nop 0
    v_cvt_pk_bf16_f32 v17, v120, v124
    s_nop 0
    v_cvt_pk_bf16_f32 v18, v128, v132
    s_nop 0
    v_cvt_pk_bf16_f32 v19, v136, v140
    v_cvt_pk_bf16_f32 v20, v113, v117
    v_cvt_pk_bf16_f32 v21, v121, v125
    v_cvt_pk_bf16_f32 v22, v129, v133
    v_cvt_pk_bf16_f32 v23, v137, v141
    v_cvt_pk_bf16_f32 v24, v114, v118
    v_cvt_pk_bf16_f32 v25, v122, v126
    v_cvt_pk_bf16_f32 v26, v130, v134
    v_cvt_pk_bf16_f32 v27, v138, v142
    v_cvt_pk_bf16_f32 v28, v115, v119
    v_cvt_pk_bf16_f32 v29, v123, v127
    v_cvt_pk_bf16_f32 v30, v131, v135
    v_cvt_pk_bf16_f32 v31, v139, v143
    s_add_u32 s25, s24, 393216
    buffer_store_dwordx4 v[16:19], v148, s[16:19], s25 offen sc1
    s_add_u32 s25, s24, 401408
    buffer_store_dwordx4 v[20:23], v148, s[16:19], s25 offen sc1
    s_add_u32 s25, s24, 409600
    buffer_store_dwordx4 v[24:27], v148, s[16:19], s25 offen sc1
    s_add_u32 s25, s24, 417792
    buffer_store_dwordx4 v[28:31], v148, s[16:19], s25 offen sc1
L_k12_end:
    s_endpgm
.globl gemm_kernel
.p2align 8
.type gemm_kernel,@function
gemm_kernel:
    s_cmp_ge_u32 s2, 256
    s_cbranch_scc1 L_k3_end
    s_load_dwordx2 s[8:9], s[0:1], 48
    v_lshrrev_b32 v253, 6, v0
    v_and_b32 v0, 63, v0
    v_readfirstlane_b32 s10, v253
    s_and_b32 s11, s2, 7
    s_lshr_b32 s12, s2, 3
    s_lshr_b32 s13, s12, 3
    s_lshl_b32 s11, s11, 2
    s_add_u32 s11, s11, s13
    s_bfe_u32 s13, s12, 0x10002
    s_and_b32 s14, s12, 3
    s_and_b32 s15, s10, 3
    s_waitcnt lgkmcnt(0)
    s_mov_b32 s16, s8
    s_and_b32 s17, s9, 0xffff
    s_mov_b32 s18, 268435456
    s_mov_b32 s19, 0x00020000
    s_cmp_ge_u32 s10, 4
    s_cbranch_scc1 L_k3_helper
    v_lshrrev_b32 v253, 4, v0
    v_and_b32 v254, 15, v0
    v_bfe_u32 v255, v254, 3, 1
    v_mul_u32_u24 v255, 3, v255
    v_xor_b32 v255, v255, v253
    v_lshlrev_b32 v255, 4, v255
    v_lshl_add_u32 v250, v254, 6, v255
    v_lshrrev_b32 v255, 2, v254
    v_and_b32 v216, 1, v253
    v_lshl_or_b32 v216, v216, 2, v255
    v_lshl_add_u32 v255, v253, 3, v255
    v_lshlrev_b32 v255, 8, v255
    v_and_b32 v217, 3, v254
    v_lshl_add_u32 v255, v217, 3, v255
    s_lshl_b32 s20, s15, 1
    v_xor_b32 v217, s20, v216
    v_lshl_add_u32 v248, v217, 5, v255
    s_add_u32 s20, s20, 1
    v_xor_b32 v217, s20, v216
    v_lshl_add_u32 v249, v217, 5, v255
    s_mov_b32 s21, 65792
    v_mul_u32_u24 v251, s21, v254
    v_lshl_add_u32 v251, v253, 4, v251
    s_lshl_b32 s20, s15, 6
    v_add_u32 v251, s20, v251
    v_cmp_gt_u32 vcc, 7, v254
    v_mov_b32 v252, 0x80000000
    s_nop 0
    v_cndmask_b32 v252, v252, v251, vcc
    s_mul_i32 s48, s11, 2048
    s_mul_i32 s20, s13, 11579392
    s_add_u32 s48, s48, s20
    s_lshl_b32 s20, s14, 8
    s_add_u32 s48, s48, s20
    s_add_u32 s48, s48, 117440512
    v_mov_b32 v0, 0
    v_mov_b32 v1, 0
    v_mov_b32 v2, 0
    v_mov_b32 v3, 0
    v_mov_b32 v4, 0
    v_mov_b32 v5, 0
    v_mov_b32 v6, 0
    v_mov_b32 v7, 0
    v_mov_b32 v8, 0
    v_mov_b32 v9, 0
    v_mov_b32 v10, 0
    v_mov_b32 v11, 0
    v_mov_b32 v12, 0
    v_mov_b32 v13, 0
    v_mov_b32 v14, 0
    v_mov_b32 v15, 0
    v_mov_b32 v16, 0
    v_mov_b32 v17, 0
    v_mov_b32 v18, 0
    v_mov_b32 v19, 0
    v_mov_b32 v20, 0
    v_mov_b32 v21, 0
    v_mov_b32 v22, 0
    v_mov_b32 v23, 0
    v_mov_b32 v24, 0
    v_mov_b32 v25, 0
    v_mov_b32 v26, 0
    v_mov_b32 v27, 0
    v_mov_b32 v28, 0
    v_mov_b32 v29, 0
    v_mov_b32 v30, 0
    v_mov_b32 v31, 0
    v_mov_b32 v32, 0
    v_mov_b32 v33, 0
    v_mov_b32 v34, 0
    v_mov_b32 v35, 0
    v_mov_b32 v36, 0
    v_mov_b32 v37, 0
    v_mov_b32 v38, 0
    v_mov_b32 v39, 0
    v_mov_b32 v40, 0
    v_mov_b32 v41, 0
    v_mov_b32 v42, 0
    v_mov_b32 v43, 0
    v_mov_b32 v44, 0
    v_mov_b32 v45, 0
    v_mov_b32 v46, 0
    v_mov_b32 v47, 0
    v_mov_b32 v48, 0
    v_mov_b32 v49, 0
    v_mov_b32 v50, 0
    v_mov_b32 v51, 0
    v_mov_b32 v52, 0
    v_mov_b32 v53, 0
    v_mov_b32 v54, 0
    v_mov_b32 v55, 0
    v_mov_b32 v56, 0
    v_mov_b32 v57, 0
    v_mov_b32 v58, 0
    v_mov_b32 v59, 0
    v_mov_b32 v60, 0
    v_mov_b32 v61, 0
    v_mov_b32 v62, 0
    v_mov_b32 v63, 0
    v_mov_b32 v64, 0
    v_mov_b32 v65, 0
    v_mov_b32 v66, 0
    v_mov_b32 v67, 0
    v_mov_b32 v68, 0
    v_mov_b32 v69, 0
    v_mov_b32 v70, 0
    v_mov_b32 v71, 0
    v_mov_b32 v72, 0
    v_mov_b32 v73, 0
    v_mov_b32 v74, 0
    v_mov_b32 v75, 0
    v_mov_b32 v76, 0
    v_mov_b32 v77, 0
    v_mov_b32 v78, 0
    v_mov_b32 v79, 0
    v_mov_b32 v80, 0
    v_mov_b32 v81, 0
    v_mov_b32 v82, 0
    v_mov_b32 v83, 0
    v_mov_b32 v84, 0
    v_mov_b32 v85, 0
    v_mov_b32 v86, 0
    v_mov_b32 v87, 0
    v_mov_b32 v88, 0
    v_mov_b32 v89, 0
    v_mov_b32 v90, 0
    v_mov_b32 v91, 0
    v_mov_b32 v92, 0
    v_mov_b32 v93, 0
    v_mov_b32 v94, 0
    v_mov_b32 v95, 0
    v_mov_b32 v96, 0
    v_mov_b32 v97, 0
    v_mov_b32 v98, 0
    v_mov_b32 v99, 0
    v_mov_b32 v100, 0
    v_mov_b32 v101, 0
    v_mov_b32 v102, 0
    v_mov_b32 v103, 0
    v_mov_b32 v104, 0
    v_mov_b32 v105, 0
    v_mov_b32 v106, 0
    v_mov_b32 v107, 0
    v_mov_b32 v108, 0
    v_mov_b32 v109, 0
    v_mov_b32 v110, 0
    v_mov_b32 v111, 0
    v_mov_b32 v112, 0
    v_mov_b32 v113, 0
    v_mov_b32 v114, 0
    v_mov_b32 v115, 0
    v_mov_b32 v116, 0
    v_mov_b32 v117, 0
    v_mov_b32 v118, 0
    v_mov_b32 v119, 0
    v_mov_b32 v120, 0
    v_mov_b32 v121, 0
    v_mov_b32 v122, 0
    v_mov_b32 v123, 0
    v_mov_b32 v124, 0
    v_mov_b32 v125, 0
    v_mov_b32 v126, 0
    v_mov_b32 v127, 0
    v_mov_b32 v128, 0
    v_mov_b32 v129, 0
    v_mov_b32 v130, 0
    v_mov_b32 v131, 0
    v_mov_b32 v132, 0
    v_mov_b32 v133, 0
    v_mov_b32 v134, 0
    v_mov_b32 v135, 0
    v_mov_b32 v136, 0
    v_mov_b32 v137, 0
    v_mov_b32 v138, 0
    v_mov_b32 v139, 0
    v_mov_b32 v140, 0
    v_mov_b32 v141, 0
    v_mov_b32 v142, 0
    v_mov_b32 v143, 0
    v_mov_b32 v144, 0
    v_mov_b32 v145, 0
    v_mov_b32 v146, 0
    v_mov_b32 v147, 0
    v_mov_b32 v148, 0
    v_mov_b32 v149, 0
    v_mov_b32 v150, 0
    v_mov_b32 v151, 0
    v_mov_b32 v152, 0
    v_mov_b32 v153, 0
    v_mov_b32 v154, 0
    v_mov_b32 v155, 0
    v_mov_b32 v156, 0
    v_mov_b32 v157, 0
    v_mov_b32 v158, 0
    v_mov_b32 v159, 0
    v_mov_b32 v160, 0
    v_mov_b32 v161, 0
    v_mov_b32 v162, 0
    v_mov_b32 v163, 0
    v_mov_b32 v164, 0
    v_mov_b32 v165, 0
    v_mov_b32 v166, 0
    v_mov_b32 v167, 0
    v_mov_b32 v168, 0
    v_mov_b32 v169, 0
    v_mov_b32 v170, 0
    v_mov_b32 v171, 0
    v_mov_b32 v172, 0
    v_mov_b32 v173, 0
    v_mov_b32 v174, 0
    v_mov_b32 v175, 0
    s_barrier
    ds_read_b64_tr_b16 v[176:177], v248 offset:0
    ds_read_b64_tr_b16 v[178:179], v248 offset:1024
    ds_read_b64_tr_b16 v[180:181], v249 offset:0
    ds_read_b64_tr_b16 v[182:183], v249 offset:1024
    ds_read_b64_tr_b16 v[184:185], v248 offset:8192
    ds_read_b64_tr_b16 v[186:187], v248 offset:9216
    ds_read_b64_tr_b16 v[188:189], v249 offset:8192
    ds_read_b64_tr_b16 v[190:191], v249 offset:9216
    ds_read_b128 v[216:219], v250 offset:16384
    ds_read_b128 v[220:223], v250 offset:27136
    ds_read_b128 v[224:227], v250 offset:17408
    ds_read_b128 v[228:231], v250 offset:28160
    s_waitcnt lgkmcnt(4)
    v_xor_b32 v208, 0x80008000, v184
    v_xor_b32 v209, 0x80008000, v185
    v_xor_b32 v210, 0x80008000, v186
    v_xor_b32 v211, 0x80008000, v187
    v_xor_b32 v212, 0x80008000, v188
    v_xor_b32 v213, 0x80008000, v189
    v_xor_b32 v214, 0x80008000, v190
    v_xor_b32 v215, 0x80008000, v191
    s_mov_b32 s46, 7
L_g_loop:
    s_barrier
    s_waitcnt lgkmcnt(2)
    v_mfma_f32_16x16x32_bf16 v[0:3], v[176:179], v[216:219], v[0:3]
    ds_read_b128 v[232:235], v250 offset:18432
    ds_read_b128 v[236:239], v250 offset:29184
    v_mfma_f32_16x16x32_bf16 v[4:7], v[180:183], v[216:219], v[4:7]
    v_mfma_f32_16x16x32_bf16 v[8:11], v[208:211], v[216:219], v[8:11]
    v_mfma_f32_16x16x32_bf16 v[12:15], v[212:215], v[216:219], v[12:15]
    v_mfma_f32_16x16x32_bf16 v[0:3], v[184:187], v[220:223], v[0:3]
    v_mfma_f32_16x16x32_bf16 v[4:7], v[188:191], v[220:223], v[4:7]
    v_mfma_f32_16x16x32_bf16 v[8:11], v[176:179], v[220:223], v[8:11]
    v_mfma_f32_16x16x32_bf16 v[12:15], v[180:183], v[220:223], v[12:15]
    s_waitcnt lgkmcnt(2)
    v_mfma_f32_16x16x32_bf16 v[16:19], v[176:179], v[224:227], v[16:19]
    ds_read_b128 v[240:243], v250 offset:19456
    ds_read_b128 v[244:247], v250 offset:30208
    v_mfma_f32_16x16x32_bf16 v[20:23], v[180:183], v[224:227], v[20:23]
    v_mfma_f32_16x16x32_bf16 v[24:27], v[208:211], v[224:227], v[24:27]
    v_mfma_f32_16x16x32_bf16 v[28:31], v[212:215], v[224:227], v[28:31]
    v_mfma_f32_16x16x32_bf16 v[16:19], v[184:187], v[228:231], v[16:19]
    v_mfma_f32_16x16x32_bf16 v[20:23], v[188:191], v[228:231], v[20:23]
    v_mfma_f32_16x16x32_bf16 v[24:27], v[176:179], v[228:231], v[24:27]
    v_mfma_f32_16x16x32_bf16 v[28:31], v[180:183], v[228:231], v[28:31]
    s_waitcnt lgkmcnt(2)
    v_mfma_f32_16x16x32_bf16 v[32:35], v[176:179], v[232:235], v[32:35]
    ds_read_b128 v[216:219], v250 offset:20480
    ds_read_b128 v[220:223], v250 offset:31232
    v_mfma_f32_16x16x32_bf16 v[36:39], v[180:183], v[232:235], v[36:39]
    v_mfma_f32_16x16x32_bf16 v[40:43], v[208:211], v[232:235], v[40:43]
    v_mfma_f32_16x16x32_bf16 v[44:47], v[212:215], v[232:235], v[44:47]
    v_mfma_f32_16x16x32_bf16 v[32:35], v[184:187], v[236:239], v[32:35]
    v_mfma_f32_16x16x32_bf16 v[36:39], v[188:191], v[236:239], v[36:39]
    v_mfma_f32_16x16x32_bf16 v[40:43], v[176:179], v[236:239], v[40:43]
    v_mfma_f32_16x16x32_bf16 v[44:47], v[180:183], v[236:239], v[44:47]
    s_waitcnt lgkmcnt(2)
    v_mfma_f32_16x16x32_bf16 v[48:51], v[176:179], v[240:243], v[48:51]
    ds_read_b128 v[224:227], v250 offset:21504
    ds_read_b128 v[228:231], v250 offset:32256
    v_mfma_f32_16x16x32_bf16 v[52:55], v[180:183], v[240:243], v[52:55]
    v_mfma_f32_16x16x32_bf16 v[56:59], v[208:211], v[240:243], v[56:59]
    v_mfma_f32_16x16x32_bf16 v[60:63], v[212:215], v[240:243], v[60:63]
    v_mfma_f32_16x16x32_bf16 v[48:51], v[184:187], v[244:247], v[48:51]
    v_mfma_f32_16x16x32_bf16 v[52:55], v[188:191], v[244:247], v[52:55]
    v_mfma_f32_16x16x32_bf16 v[56:59], v[176:179], v[244:247], v[56:59]
    v_mfma_f32_16x16x32_bf16 v[60:63], v[180:183], v[244:247], v[60:63]
    s_waitcnt lgkmcnt(2)
    v_mfma_f32_16x16x32_bf16 v[64:67], v[176:179], v[216:219], v[64:67]
    ds_read_b128 v[232:235], v250 offset:22528
    ds_read_b128 v[236:239], v250 offset:33280
    v_mfma_f32_16x16x32_bf16 v[68:71], v[180:183], v[216:219], v[68:71]
    v_mfma_f32_16x16x32_bf16 v[72:75], v[208:211], v[216:219], v[72:75]
    v_mfma_f32_16x16x32_bf16 v[76:79], v[212:215], v[216:219], v[76:79]
    v_mfma_f32_16x16x32_bf16 v[64:67], v[184:187], v[220:223], v[64:67]
    v_mfma_f32_16x16x32_bf16 v[68:71], v[188:191], v[220:223], v[68:71]
    v_mfma_f32_16x16x32_bf16 v[72:75], v[176:179], v[220:223], v[72:75]
    v_mfma_f32_16x16x32_bf16 v[76:79], v[180:183], v[220:223], v[76:79]
    s_waitcnt lgkmcnt(2)
    v_mfma_f32_16x16x32_bf16 v[80:83], v[176:179], v[224:227], v[80:83]
    ds_read_b128 v[240:243], v250 offset:23552
    ds_read_b128 v[244:247], v250 offset:34304
    v_mfma_f32_16x16x32_bf16 v[84:87], v[180:183], v[224:227], v[84:87]
    v_mfma_f32_16x16x32_bf16 v[88:91], v[208:211], v[224:227], v[88:91]
    v_mfma_f32_16x16x32_bf16 v[92:95], v[212:215], v[224:227], v[92:95]
    v_mfma_f32_16x16x32_bf16 v[80:83], v[184:187], v[228:231], v[80:83]
    v_mfma_f32_16x16x32_bf16 v[84:87], v[188:191], v[228:231], v[84:87]
    v_mfma_f32_16x16x32_bf16 v[88:91], v[176:179], v[228:231], v[88:91]
    v_mfma_f32_16x16x32_bf16 v[92:95], v[180:183], v[228:231], v[92:95]
    s_waitcnt lgkmcnt(2)
    v_mfma_f32_16x16x32_bf16 v[96:99], v[176:179], v[232:235], v[96:99]
    ds_read_b128 v[216:219], v250 offset:24576
    ds_read_b128 v[220:223], v250 offset:35328
    v_mfma_f32_16x16x32_bf16 v[100:103], v[180:183], v[232:235], v[100:103]
    v_mfma_f32_16x16x32_bf16 v[104:107], v[208:211], v[232:235], v[104:107]
    v_mfma_f32_16x16x32_bf16 v[108:111], v[212:215], v[232:235], v[108:111]
    v_mfma_f32_16x16x32_bf16 v[96:99], v[184:187], v[236:239], v[96:99]
    v_add_u32 v248, 0x9400, v248
    v_add_u32 v249, 0x9400, v249
    v_mfma_f32_16x16x32_bf16 v[100:103], v[188:191], v[236:239], v[100:103]
    v_mfma_f32_16x16x32_bf16 v[104:107], v[176:179], v[236:239], v[104:107]
    v_mfma_f32_16x16x32_bf16 v[108:111], v[180:183], v[236:239], v[108:111]
    s_waitcnt lgkmcnt(2)
    v_mfma_f32_16x16x32_bf16 v[112:115], v[176:179], v[240:243], v[112:115]
    ds_read_b128 v[224:227], v250 offset:25600
    ds_read_b128 v[228:231], v250 offset:36352
    v_mfma_f32_16x16x32_bf16 v[116:119], v[180:183], v[240:243], v[116:119]
    v_mfma_f32_16x16x32_bf16 v[120:123], v[208:211], v[240:243], v[120:123]
    v_mfma_f32_16x16x32_bf16 v[124:127], v[212:215], v[240:243], v[124:127]
    ds_read_b64_tr_b16 v[192:193], v248 offset:0
    ds_read_b64_tr_b16 v[194:195], v248 offset:1024
    ds_read_b64_tr_b16 v[196:197], v249 offset:0
    ds_read_b64_tr_b16 v[198:199], v249 offset:1024
    v_mfma_f32_16x16x32_bf16 v[112:115], v[184:187], v[244:247], v[112:115]
    v_mfma_f32_16x16x32_bf16 v[116:119], v[188:191], v[244:247], v[116:119]
    v_mfma_f32_16x16x32_bf16 v[120:123], v[176:179], v[244:247], v[120:123]
    v_mfma_f32_16x16x32_bf16 v[124:127], v[180:183], v[244:247], v[124:127]
    s_waitcnt lgkmcnt(6)
    v_mfma_f32_16x16x32_bf16 v[128:131], v[176:179], v[216:219], v[128:131]
    ds_read_b128 v[232:235], v250 offset:26624
    ds_read_b128 v[236:239], v250 offset:37376
    v_mfma_f32_16x16x32_bf16 v[132:135], v[180:183], v[216:219], v[132:135]
    v_mfma_f32_16x16x32_bf16 v[136:139], v[208:211], v[216:219], v[136:139]
    v_mfma_f32_16x16x32_bf16 v[140:143], v[212:215], v[216:219], v[140:143]
    ds_read_b64_tr_b16 v[200:201], v248 offset:8192
    ds_read_b64_tr_b16 v[202:203], v248 offset:9216
    ds_read_b64_tr_b16 v[204:205], v249 offset:8192
    ds_read_b64_tr_b16 v[206:207], v249 offset:9216
    v_mfma_f32_16x16x32_bf16 v[128:131], v[184:187], v[220:223], v[128:131]
    v_mfma_f32_16x16x32_bf16 v[132:135], v[188:191], v[220:223], v[132:135]
    v_mfma_f32_16x16x32_bf16 v[136:139], v[176:179], v[220:223], v[136:139]
    v_mfma_f32_16x16x32_bf16 v[140:143], v[180:183], v[220:223], v[140:143]
    s_waitcnt lgkmcnt(10)
    v_mfma_f32_16x16x32_bf16 v[144:147], v[176:179], v[224:227], v[144:147]
    v_add_u32 v250, 0x9400, v250
    ds_read_b128 v[240:243], v250 offset:16384
    ds_read_b128 v[244:247], v250 offset:27136
    v_mfma_f32_16x16x32_bf16 v[148:151], v[180:183], v[224:227], v[148:151]
    v_mfma_f32_16x16x32_bf16 v[152:155], v[208:211], v[224:227], v[152:155]
    v_mfma_f32_16x16x32_bf16 v[156:159], v[212:215], v[224:227], v[156:159]
    v_mfma_f32_16x16x32_bf16 v[144:147], v[184:187], v[228:231], v[144:147]
    v_mfma_f32_16x16x32_bf16 v[148:151], v[188:191], v[228:231], v[148:151]
    v_mfma_f32_16x16x32_bf16 v[152:155], v[176:179], v[228:231], v[152:155]
    v_mfma_f32_16x16x32_bf16 v[156:159], v[180:183], v[228:231], v[156:159]
    s_waitcnt lgkmcnt(6)
    v_mfma_f32_16x16x32_bf16 v[160:163], v[176:179], v[232:235], v[160:163]
    ds_read_b128 v[216:219], v250 offset:17408
    ds_read_b128 v[220:223], v250 offset:28160
    v_mfma_f32_16x16x32_bf16 v[164:167], v[180:183], v[232:235], v[164:167]
    v_mfma_f32_16x16x32_bf16 v[168:171], v[208:211], v[232:235], v[168:171]
    v_mfma_f32_16x16x32_bf16 v[172:175], v[212:215], v[232:235], v[172:175]
    s_waitcnt lgkmcnt(4)
    v_xor_b32 v208, 0x80008000, v200
    v_xor_b32 v209, 0x80008000, v201
    v_mfma_f32_16x16x32_bf16 v[160:163], v[184:187], v[236:239], v[160:163]
    v_xor_b32 v210, 0x80008000, v202
    v_xor_b32 v211, 0x80008000, v203
    v_mfma_f32_16x16x32_bf16 v[164:167], v[188:191], v[236:239], v[164:167]
    v_xor_b32 v212, 0x80008000, v204
    v_xor_b32 v213, 0x80008000, v205
    v_mfma_f32_16x16x32_bf16 v[168:171], v[176:179], v[236:239], v[168:171]
    v_xor_b32 v214, 0x80008000, v206
    v_xor_b32 v215, 0x80008000, v207
    v_mfma_f32_16x16x32_bf16 v[172:175], v[180:183], v[236:239], v[172:175]
    s_barrier
    s_waitcnt lgkmcnt(2)
    v_mfma_f32_16x16x32_bf16 v[0:3], v[192:195], v[240:243], v[0:3]
    ds_read_b128 v[224:227], v250 offset:18432
    ds_read_b128 v[228:231], v250 offset:29184
    v_mfma_f32_16x16x32_bf16 v[4:7], v[196:199], v[240:243], v[4:7]
    v_mfma_f32_16x16x32_bf16 v[8:11], v[208:211], v[240:243], v[8:11]
    v_mfma_f32_16x16x32_bf16 v[12:15], v[212:215], v[240:243], v[12:15]
    v_mfma_f32_16x16x32_bf16 v[0:3], v[200:203], v[244:247], v[0:3]
    v_mfma_f32_16x16x32_bf16 v[4:7], v[204:207], v[244:247], v[4:7]
    v_mfma_f32_16x16x32_bf16 v[8:11], v[192:195], v[244:247], v[8:11]
    v_mfma_f32_16x16x32_bf16 v[12:15], v[196:199], v[244:247], v[12:15]
    s_waitcnt lgkmcnt(2)
    v_mfma_f32_16x16x32_bf16 v[16:19], v[192:195], v[216:219], v[16:19]
    ds_read_b128 v[232:235], v250 offset:19456
    ds_read_b128 v[236:239], v250 offset:30208
    v_mfma_f32_16x16x32_bf16 v[20:23], v[196:199], v[216:219], v[20:23]
    v_mfma_f32_16x16x32_bf16 v[24:27], v[208:211], v[216:219], v[24:27]
    v_mfma_f32_16x16x32_bf16 v[28:31], v[212:215], v[216:219], v[28:31]
    v_mfma_f32_16x16x32_bf16 v[16:19], v[200:203], v[220:223], v[16:19]
    v_mfma_f32_16x16x32_bf16 v[20:23], v[204:207], v[220:223], v[20:23]
    v_mfma_f32_16x16x32_bf16 v[24:27], v[192:195], v[220:223], v[24:27]
    v_mfma_f32_16x16x32_bf16 v[28:31], v[196:199], v[220:223], v[28:31]
    s_waitcnt lgkmcnt(2)
    v_mfma_f32_16x16x32_bf16 v[32:35], v[192:195], v[224:227], v[32:35]
    ds_read_b128 v[240:243], v250 offset:20480
    ds_read_b128 v[244:247], v250 offset:31232
    v_mfma_f32_16x16x32_bf16 v[36:39], v[196:199], v[224:227], v[36:39]
    v_mfma_f32_16x16x32_bf16 v[40:43], v[208:211], v[224:227], v[40:43]
    v_mfma_f32_16x16x32_bf16 v[44:47], v[212:215], v[224:227], v[44:47]
    v_mfma_f32_16x16x32_bf16 v[32:35], v[200:203], v[228:231], v[32:35]
    v_mfma_f32_16x16x32_bf16 v[36:39], v[204:207], v[228:231], v[36:39]
    v_mfma_f32_16x16x32_bf16 v[40:43], v[192:195], v[228:231], v[40:43]
    v_mfma_f32_16x16x32_bf16 v[44:47], v[196:199], v[228:231], v[44:47]
    s_waitcnt lgkmcnt(2)
    v_mfma_f32_16x16x32_bf16 v[48:51], v[192:195], v[232:235], v[48:51]
    ds_read_b128 v[216:219], v250 offset:21504
    ds_read_b128 v[220:223], v250 offset:32256
    v_mfma_f32_16x16x32_bf16 v[52:55], v[196:199], v[232:235], v[52:55]
    v_mfma_f32_16x16x32_bf16 v[56:59], v[208:211], v[232:235], v[56:59]
    v_mfma_f32_16x16x32_bf16 v[60:63], v[212:215], v[232:235], v[60:63]
    v_mfma_f32_16x16x32_bf16 v[48:51], v[200:203], v[236:239], v[48:51]
    v_mfma_f32_16x16x32_bf16 v[52:55], v[204:207], v[236:239], v[52:55]
    v_mfma_f32_16x16x32_bf16 v[56:59], v[192:195], v[236:239], v[56:59]
    v_mfma_f32_16x16x32_bf16 v[60:63], v[196:199], v[236:239], v[60:63]
    s_waitcnt lgkmcnt(2)
    v_mfma_f32_16x16x32_bf16 v[64:67], v[192:195], v[240:243], v[64:67]
    ds_read_b128 v[224:227], v250 offset:22528
    ds_read_b128 v[228:231], v250 offset:33280
    v_mfma_f32_16x16x32_bf16 v[68:71], v[196:199], v[240:243], v[68:71]
    v_mfma_f32_16x16x32_bf16 v[72:75], v[208:211], v[240:243], v[72:75]
    v_mfma_f32_16x16x32_bf16 v[76:79], v[212:215], v[240:243], v[76:79]
    v_mfma_f32_16x16x32_bf16 v[64:67], v[200:203], v[244:247], v[64:67]
    v_mfma_f32_16x16x32_bf16 v[68:71], v[204:207], v[244:247], v[68:71]
    v_mfma_f32_16x16x32_bf16 v[72:75], v[192:195], v[244:247], v[72:75]
    v_mfma_f32_16x16x32_bf16 v[76:79], v[196:199], v[244:247], v[76:79]
    s_waitcnt lgkmcnt(2)
    v_mfma_f32_16x16x32_bf16 v[80:83], v[192:195], v[216:219], v[80:83]
    ds_read_b128 v[232:235], v250 offset:23552
    ds_read_b128 v[236:239], v250 offset:34304
    v_mfma_f32_16x16x32_bf16 v[84:87], v[196:199], v[216:219], v[84:87]
    v_mfma_f32_16x16x32_bf16 v[88:91], v[208:211], v[216:219], v[88:91]
    v_mfma_f32_16x16x32_bf16 v[92:95], v[212:215], v[216:219], v[92:95]
    v_mfma_f32_16x16x32_bf16 v[80:83], v[200:203], v[220:223], v[80:83]
    v_mfma_f32_16x16x32_bf16 v[84:87], v[204:207], v[220:223], v[84:87]
    v_mfma_f32_16x16x32_bf16 v[88:91], v[192:195], v[220:223], v[88:91]
    v_mfma_f32_16x16x32_bf16 v[92:95], v[196:199], v[220:223], v[92:95]
    s_waitcnt lgkmcnt(2)
    v_mfma_f32_16x16x32_bf16 v[96:99], v[192:195], v[224:227], v[96:99]
    ds_read_b128 v[240:243], v250 offset:24576
    ds_read_b128 v[244:247], v250 offset:35328
    v_mfma_f32_16x16x32_bf16 v[100:103], v[196:199], v[224:227], v[100:103]
    v_mfma_f32_16x16x32_bf16 v[104:107], v[208:211], v[224:227], v[104:107]
    v_mfma_f32_16x16x32_bf16 v[108:111], v[212:215], v[224:227], v[108:111]
    v_mfma_f32_16x16x32_bf16 v[96:99], v[200:203], v[228:231], v[96:99]
    v_add_u32 v248, 0x9400, v248
    v_add_u32 v249, 0x9400, v249
    v_mfma_f32_16x16x32_bf16 v[100:103], v[204:207], v[228:231], v[100:103]
    v_mfma_f32_16x16x32_bf16 v[104:107], v[192:195], v[228:231], v[104:107]
    v_mfma_f32_16x16x32_bf16 v[108:111], v[196:199], v[228:231], v[108:111]
    s_waitcnt lgkmcnt(2)
    v_mfma_f32_16x16x32_bf16 v[112:115], v[192:195], v[232:235], v[112:115]
    ds_read_b128 v[216:219], v250 offset:25600
    ds_read_b128 v[220:223], v250 offset:36352
    v_mfma_f32_16x16x32_bf16 v[116:119], v[196:199], v[232:235], v[116:119]
    v_mfma_f32_16x16x32_bf16 v[120:123], v[208:211], v[232:235], v[120:123]
    v_mfma_f32_16x16x32_bf16 v[124:127], v[212:215], v[232:235], v[124:127]
    ds_read_b64_tr_b16 v[176:177], v248 offset:0
    ds_read_b64_tr_b16 v[178:179], v248 offset:1024
    ds_read_b64_tr_b16 v[180:181], v249 offset:0
    ds_read_b64_tr_b16 v[182:183], v249 offset:1024
    v_mfma_f32_16x16x32_bf16 v[112:115], v[200:203], v[236:239], v[112:115]
    v_mfma_f32_16x16x32_bf16 v[116:119], v[204:207], v[236:239], v[116:119]
    v_mfma_f32_16x16x32_bf16 v[120:123], v[192:195], v[236:239], v[120:123]
    v_mfma_f32_16x16x32_bf16 v[124:127], v[196:199], v[236:239], v[124:127]
    s_waitcnt lgkmcnt(6)
    v_mfma_f32_16x16x32_bf16 v[128:131], v[192:195], v[240:243], v[128:131]
    ds_read_b128 v[224:227], v250 offset:26624
    ds_read_b128 v[228:231], v250 offset:37376
    v_mfma_f32_16x16x32_bf16 v[132:135], v[196:199], v[240:243], v[132:135]
    v_mfma_f32_16x16x32_bf16 v[136:139], v[208:211], v[240:243], v[136:139]
    v_mfma_f32_16x16x32_bf16 v[140:143], v[212:215], v[240:243], v[140:143]
    ds_read_b64_tr_b16 v[184:185], v248 offset:8192
    ds_read_b64_tr_b16 v[186:187], v248 offset:9216
    ds_read_b64_tr_b16 v[188:189], v249 offset:8192
    ds_read_b64_tr_b16 v[190:191], v249 offset:9216
    v_mfma_f32_16x16x32_bf16 v[128:131], v[200:203], v[244:247], v[128:131]
    v_mfma_f32_16x16x32_bf16 v[132:135], v[204:207], v[244:247], v[132:135]
    v_mfma_f32_16x16x32_bf16 v[136:139], v[192:195], v[244:247], v[136:139]
    v_mfma_f32_16x16x32_bf16 v[140:143], v[196:199], v[244:247], v[140:143]
    s_waitcnt lgkmcnt(10)
    v_mfma_f32_16x16x32_bf16 v[144:147], v[192:195], v[216:219], v[144:147]
    v_add_u32 v250, 0x9400, v250
    ds_read_b128 v[232:235], v250 offset:16384
    ds_read_b128 v[236:239], v250 offset:27136
    v_mfma_f32_16x16x32_bf16 v[148:151], v[196:199], v[216:219], v[148:151]
    v_mfma_f32_16x16x32_bf16 v[152:155], v[208:211], v[216:219], v[152:155]
    v_mfma_f32_16x16x32_bf16 v[156:159], v[212:215], v[216:219], v[156:159]
    v_mfma_f32_16x16x32_bf16 v[144:147], v[200:203], v[220:223], v[144:147]
    v_mfma_f32_16x16x32_bf16 v[148:151], v[204:207], v[220:223], v[148:151]
    v_mfma_f32_16x16x32_bf16 v[152:155], v[192:195], v[220:223], v[152:155]
    v_mfma_f32_16x16x32_bf16 v[156:159], v[196:199], v[220:223], v[156:159]
    s_waitcnt lgkmcnt(6)
    v_mfma_f32_16x16x32_bf16 v[160:163], v[192:195], v[224:227], v[160:163]
    ds_read_b128 v[240:243], v250 offset:17408
    ds_read_b128 v[244:247], v250 offset:28160
    v_mfma_f32_16x16x32_bf16 v[164:167], v[196:199], v[224:227], v[164:167]
    v_mfma_f32_16x16x32_bf16 v[168:171], v[208:211], v[224:227], v[168:171]
    v_mfma_f32_16x16x32_bf16 v[172:175], v[212:215], v[224:227], v[172:175]
    s_waitcnt lgkmcnt(4)
    v_xor_b32 v208, 0x80008000, v184
    v_xor_b32 v209, 0x80008000, v185
    v_mfma_f32_16x16x32_bf16 v[160:163], v[200:203], v[228:231], v[160:163]
    v_xor_b32 v210, 0x80008000, v186
    v_xor_b32 v211, 0x80008000, v187
    v_mfma_f32_16x16x32_bf16 v[164:167], v[204:207], v[228:231], v[164:167]
    v_xor_b32 v212, 0x80008000, v188
    v_xor_b32 v213, 0x80008000, v189
    v_mfma_f32_16x16x32_bf16 v[168:171], v[192:195], v[228:231], v[168:171]
    v_xor_b32 v214, 0x80008000, v190
    v_xor_b32 v215, 0x80008000, v191
    v_mfma_f32_16x16x32_bf16 v[172:175], v[196:199], v[228:231], v[172:175]
    s_barrier
    s_waitcnt lgkmcnt(2)
    v_mfma_f32_16x16x32_bf16 v[0:3], v[176:179], v[232:235], v[0:3]
    ds_read_b128 v[216:219], v250 offset:18432
    ds_read_b128 v[220:223], v250 offset:29184
    v_mfma_f32_16x16x32_bf16 v[4:7], v[180:183], v[232:235], v[4:7]
    v_mfma_f32_16x16x32_bf16 v[8:11], v[208:211], v[232:235], v[8:11]
    v_mfma_f32_16x16x32_bf16 v[12:15], v[212:215], v[232:235], v[12:15]
    v_mfma_f32_16x16x32_bf16 v[0:3], v[184:187], v[236:239], v[0:3]
    v_mfma_f32_16x16x32_bf16 v[4:7], v[188:191], v[236:239], v[4:7]
    v_mfma_f32_16x16x32_bf16 v[8:11], v[176:179], v[236:239], v[8:11]
    v_mfma_f32_16x16x32_bf16 v[12:15], v[180:183], v[236:239], v[12:15]
    s_waitcnt lgkmcnt(2)
    v_mfma_f32_16x16x32_bf16 v[16:19], v[176:179], v[240:243], v[16:19]
    ds_read_b128 v[224:227], v250 offset:19456
    ds_read_b128 v[228:231], v250 offset:30208
    v_mfma_f32_16x16x32_bf16 v[20:23], v[180:183], v[240:243], v[20:23]
    v_mfma_f32_16x16x32_bf16 v[24:27], v[208:211], v[240:243], v[24:27]
    v_mfma_f32_16x16x32_bf16 v[28:31], v[212:215], v[240:243], v[28:31]
    v_mfma_f32_16x16x32_bf16 v[16:19], v[184:187], v[244:247], v[16:19]
    v_mfma_f32_16x16x32_bf16 v[20:23], v[188:191], v[244:247], v[20:23]
    v_mfma_f32_16x16x32_bf16 v[24:27], v[176:179], v[244:247], v[24:27]
    v_mfma_f32_16x16x32_bf16 v[28:31], v[180:183], v[244:247], v[28:31]
    s_waitcnt lgkmcnt(2)
    v_mfma_f32_16x16x32_bf16 v[32:35], v[176:179], v[216:219], v[32:35]
    ds_read_b128 v[232:235], v250 offset:20480
    ds_read_b128 v[236:239], v250 offset:31232
    v_mfma_f32_16x16x32_bf16 v[36:39], v[180:183], v[216:219], v[36:39]
    v_mfma_f32_16x16x32_bf16 v[40:43], v[208:211], v[216:219], v[40:43]
    v_mfma_f32_16x16x32_bf16 v[44:47], v[212:215], v[216:219], v[44:47]
    v_mfma_f32_16x16x32_bf16 v[32:35], v[184:187], v[220:223], v[32:35]
    v_mfma_f32_16x16x32_bf16 v[36:39], v[188:191], v[220:223], v[36:39]
    v_mfma_f32_16x16x32_bf16 v[40:43], v[176:179], v[220:223], v[40:43]
    v_mfma_f32_16x16x32_bf16 v[44:47], v[180:183], v[220:223], v[44:47]
    s_waitcnt lgkmcnt(2)
    v_mfma_f32_16x16x32_bf16 v[48:51], v[176:179], v[224:227], v[48:51]
    ds_read_b128 v[240:243], v250 offset:21504
    ds_read_b128 v[244:247], v250 offset:32256
    v_mfma_f32_16x16x32_bf16 v[52:55], v[180:183], v[224:227], v[52:55]
    v_mfma_f32_16x16x32_bf16 v[56:59], v[208:211], v[224:227], v[56:59]
    v_mfma_f32_16x16x32_bf16 v[60:63], v[212:215], v[224:227], v[60:63]
    v_mfma_f32_16x16x32_bf16 v[48:51], v[184:187], v[228:231], v[48:51]
    v_mfma_f32_16x16x32_bf16 v[52:55], v[188:191], v[228:231], v[52:55]
    v_mfma_f32_16x16x32_bf16 v[56:59], v[176:179], v[228:231], v[56:59]
    v_mfma_f32_16x16x32_bf16 v[60:63], v[180:183], v[228:231], v[60:63]
    s_waitcnt lgkmcnt(2)
    v_mfma_f32_16x16x32_bf16 v[64:67], v[176:179], v[232:235], v[64:67]
    ds_read_b128 v[216:219], v250 offset:22528
    ds_read_b128 v[220:223], v250 offset:33280
    v_mfma_f32_16x16x32_bf16 v[68:71], v[180:183], v[232:235], v[68:71]
    v_mfma_f32_16x16x32_bf16 v[72:75], v[208:211], v[232:235], v[72:75]
    v_mfma_f32_16x16x32_bf16 v[76:79], v[212:215], v[232:235], v[76:79]
    v_mfma_f32_16x16x32_bf16 v[64:67], v[184:187], v[236:239], v[64:67]
    v_mfma_f32_16x16x32_bf16 v[68:71], v[188:191], v[236:239], v[68:71]
    v_mfma_f32_16x16x32_bf16 v[72:75], v[176:179], v[236:239], v[72:75]
    v_mfma_f32_16x16x32_bf16 v[76:79], v[180:183], v[236:239], v[76:79]
    s_waitcnt lgkmcnt(2)
    v_mfma_f32_16x16x32_bf16 v[80:83], v[176:179], v[240:243], v[80:83]
    ds_read_b128 v[224:227], v250 offset:23552
    ds_read_b128 v[228:231], v250 offset:34304
    v_mfma_f32_16x16x32_bf16 v[84:87], v[180:183], v[240:243], v[84:87]
    v_mfma_f32_16x16x32_bf16 v[88:91], v[208:211], v[240:243], v[88:91]
    v_mfma_f32_16x16x32_bf16 v[92:95], v[212:215], v[240:243], v[92:95]
    v_mfma_f32_16x16x32_bf16 v[80:83], v[184:187], v[244:247], v[80:83]
    v_mfma_f32_16x16x32_bf16 v[84:87], v[188:191], v[244:247], v[84:87]
    v_mfma_f32_16x16x32_bf16 v[88:91], v[176:179], v[244:247], v[88:91]
    v_mfma_f32_16x16x32_bf16 v[92:95], v[180:183], v[244:247], v[92:95]
    s_waitcnt lgkmcnt(2)
    v_mfma_f32_16x16x32_bf16 v[96:99], v[176:179], v[216:219], v[96:99]
    ds_read_b128 v[232:235], v250 offset:24576
    ds_read_b128 v[236:239], v250 offset:35328
    v_mfma_f32_16x16x32_bf16 v[100:103], v[180:183], v[216:219], v[100:103]
    v_mfma_f32_16x16x32_bf16 v[104:107], v[208:211], v[216:219], v[104:107]
    v_mfma_f32_16x16x32_bf16 v[108:111], v[212:215], v[216:219], v[108:111]
    v_mfma_f32_16x16x32_bf16 v[96:99], v[184:187], v[220:223], v[96:99]
    v_add_u32 v248, 0x9400, v248
    v_add_u32 v249, 0x9400, v249
    v_mfma_f32_16x16x32_bf16 v[100:103], v[188:191], v[220:223], v[100:103]
    v_mfma_f32_16x16x32_bf16 v[104:107], v[176:179], v[220:223], v[104:107]
    v_mfma_f32_16x16x32_bf16 v[108:111], v[180:183], v[220:223], v[108:111]
    s_waitcnt lgkmcnt(2)
    v_mfma_f32_16x16x32_bf16 v[112:115], v[176:179], v[224:227], v[112:115]
    ds_read_b128 v[240:243], v250 offset:25600
    ds_read_b128 v[244:247], v250 offset:36352
    v_mfma_f32_16x16x32_bf16 v[116:119], v[180:183], v[224:227], v[116:119]
    v_mfma_f32_16x16x32_bf16 v[120:123], v[208:211], v[224:227], v[120:123]
    v_mfma_f32_16x16x32_bf16 v[124:127], v[212:215], v[224:227], v[124:127]
    ds_read_b64_tr_b16 v[192:193], v248 offset:0
    ds_read_b64_tr_b16 v[194:195], v248 offset:1024
    ds_read_b64_tr_b16 v[196:197], v249 offset:0
    ds_read_b64_tr_b16 v[198:199], v249 offset:1024
    v_mfma_f32_16x16x32_bf16 v[112:115], v[184:187], v[228:231], v[112:115]
    v_mfma_f32_16x16x32_bf16 v[116:119], v[188:191], v[228:231], v[116:119]
    v_mfma_f32_16x16x32_bf16 v[120:123], v[176:179], v[228:231], v[120:123]
    v_mfma_f32_16x16x32_bf16 v[124:127], v[180:183], v[228:231], v[124:127]
    s_waitcnt lgkmcnt(6)
    v_mfma_f32_16x16x32_bf16 v[128:131], v[176:179], v[232:235], v[128:131]
    ds_read_b128 v[216:219], v250 offset:26624
    ds_read_b128 v[220:223], v250 offset:37376
    v_mfma_f32_16x16x32_bf16 v[132:135], v[180:183], v[232:235], v[132:135]
    v_mfma_f32_16x16x32_bf16 v[136:139], v[208:211], v[232:235], v[136:139]
    v_mfma_f32_16x16x32_bf16 v[140:143], v[212:215], v[232:235], v[140:143]
    ds_read_b64_tr_b16 v[200:201], v248 offset:8192
    ds_read_b64_tr_b16 v[202:203], v248 offset:9216
    ds_read_b64_tr_b16 v[204:205], v249 offset:8192
    ds_read_b64_tr_b16 v[206:207], v249 offset:9216
    v_mfma_f32_16x16x32_bf16 v[128:131], v[184:187], v[236:239], v[128:131]
    v_mfma_f32_16x16x32_bf16 v[132:135], v[188:191], v[236:239], v[132:135]
    v_mfma_f32_16x16x32_bf16 v[136:139], v[176:179], v[236:239], v[136:139]
    v_mfma_f32_16x16x32_bf16 v[140:143], v[180:183], v[236:239], v[140:143]
    s_waitcnt lgkmcnt(10)
    v_mfma_f32_16x16x32_bf16 v[144:147], v[176:179], v[240:243], v[144:147]
    v_add_u32 v250, 0x9400, v250
    ds_read_b128 v[224:227], v250 offset:16384
    ds_read_b128 v[228:231], v250 offset:27136
    v_mfma_f32_16x16x32_bf16 v[148:151], v[180:183], v[240:243], v[148:151]
    v_mfma_f32_16x16x32_bf16 v[152:155], v[208:211], v[240:243], v[152:155]
    v_mfma_f32_16x16x32_bf16 v[156:159], v[212:215], v[240:243], v[156:159]
    v_mfma_f32_16x16x32_bf16 v[144:147], v[184:187], v[244:247], v[144:147]
    v_mfma_f32_16x16x32_bf16 v[148:151], v[188:191], v[244:247], v[148:151]
    v_mfma_f32_16x16x32_bf16 v[152:155], v[176:179], v[244:247], v[152:155]
    v_mfma_f32_16x16x32_bf16 v[156:159], v[180:183], v[244:247], v[156:159]
    s_waitcnt lgkmcnt(6)
    v_mfma_f32_16x16x32_bf16 v[160:163], v[176:179], v[216:219], v[160:163]
    ds_read_b128 v[232:235], v250 offset:17408
    ds_read_b128 v[236:239], v250 offset:28160
    v_mfma_f32_16x16x32_bf16 v[164:167], v[180:183], v[216:219], v[164:167]
    v_mfma_f32_16x16x32_bf16 v[168:171], v[208:211], v[216:219], v[168:171]
    v_mfma_f32_16x16x32_bf16 v[172:175], v[212:215], v[216:219], v[172:175]
    s_waitcnt lgkmcnt(4)
    v_xor_b32 v208, 0x80008000, v200
    v_xor_b32 v209, 0x80008000, v201
    v_mfma_f32_16x16x32_bf16 v[160:163], v[184:187], v[220:223], v[160:163]
    v_xor_b32 v210, 0x80008000, v202
    v_xor_b32 v211, 0x80008000, v203
    v_mfma_f32_16x16x32_bf16 v[164:167], v[188:191], v[220:223], v[164:167]
    v_xor_b32 v212, 0x80008000, v204
    v_xor_b32 v213, 0x80008000, v205
    v_mfma_f32_16x16x32_bf16 v[168:171], v[176:179], v[220:223], v[168:171]
    v_xor_b32 v214, 0x80008000, v206
    v_xor_b32 v215, 0x80008000, v207
    v_mfma_f32_16x16x32_bf16 v[172:175], v[180:183], v[220:223], v[172:175]
    s_barrier
    s_waitcnt lgkmcnt(2)
    v_mfma_f32_16x16x32_bf16 v[0:3], v[192:195], v[224:227], v[0:3]
    ds_read_b128 v[240:243], v250 offset:18432
    ds_read_b128 v[244:247], v250 offset:29184
    v_mfma_f32_16x16x32_bf16 v[4:7], v[196:199], v[224:227], v[4:7]
    v_mfma_f32_16x16x32_bf16 v[8:11], v[208:211], v[224:227], v[8:11]
    v_mfma_f32_16x16x32_bf16 v[12:15], v[212:215], v[224:227], v[12:15]
    v_mfma_f32_16x16x32_bf16 v[0:3], v[200:203], v[228:231], v[0:3]
    v_mfma_f32_16x16x32_bf16 v[4:7], v[204:207], v[228:231], v[4:7]
    v_mfma_f32_16x16x32_bf16 v[8:11], v[192:195], v[228:231], v[8:11]
    v_mfma_f32_16x16x32_bf16 v[12:15], v[196:199], v[228:231], v[12:15]
    s_waitcnt lgkmcnt(2)
    v_mfma_f32_16x16x32_bf16 v[16:19], v[192:195], v[232:235], v[16:19]
    ds_read_b128 v[216:219], v250 offset:19456
    ds_read_b128 v[220:223], v250 offset:30208
    v_mfma_f32_16x16x32_bf16 v[20:23], v[196:199], v[232:235], v[20:23]
    v_mfma_f32_16x16x32_bf16 v[24:27], v[208:211], v[232:235], v[24:27]
    v_mfma_f32_16x16x32_bf16 v[28:31], v[212:215], v[232:235], v[28:31]
    v_mfma_f32_16x16x32_bf16 v[16:19], v[200:203], v[236:239], v[16:19]
    v_mfma_f32_16x16x32_bf16 v[20:23], v[204:207], v[236:239], v[20:23]
    v_mfma_f32_16x16x32_bf16 v[24:27], v[192:195], v[236:239], v[24:27]
    v_mfma_f32_16x16x32_bf16 v[28:31], v[196:199], v[236:239], v[28:31]
    s_waitcnt lgkmcnt(2)
    v_mfma_f32_16x16x32_bf16 v[32:35], v[192:195], v[240:243], v[32:35]
    ds_read_b128 v[224:227], v250 offset:20480
    ds_read_b128 v[228:231], v250 offset:31232
    v_mfma_f32_16x16x32_bf16 v[36:39], v[196:199], v[240:243], v[36:39]
    v_mfma_f32_16x16x32_bf16 v[40:43], v[208:211], v[240:243], v[40:43]
    v_mfma_f32_16x16x32_bf16 v[44:47], v[212:215], v[240:243], v[44:47]
    v_mfma_f32_16x16x32_bf16 v[32:35], v[200:203], v[244:247], v[32:35]
    v_mfma_f32_16x16x32_bf16 v[36:39], v[204:207], v[244:247], v[36:39]
    v_mfma_f32_16x16x32_bf16 v[40:43], v[192:195], v[244:247], v[40:43]
    v_mfma_f32_16x16x32_bf16 v[44:47], v[196:199], v[244:247], v[44:47]
    s_waitcnt lgkmcnt(2)
    v_mfma_f32_16x16x32_bf16 v[48:51], v[192:195], v[216:219], v[48:51]
    ds_read_b128 v[232:235], v250 offset:21504
    ds_read_b128 v[236:239], v250 offset:32256
    v_mfma_f32_16x16x32_bf16 v[52:55], v[196:199], v[216:219], v[52:55]
    v_mfma_f32_16x16x32_bf16 v[56:59], v[208:211], v[216:219], v[56:59]
    v_mfma_f32_16x16x32_bf16 v[60:63], v[212:215], v[216:219], v[60:63]
    v_mfma_f32_16x16x32_bf16 v[48:51], v[200:203], v[220:223], v[48:51]
    v_mfma_f32_16x16x32_bf16 v[52:55], v[204:207], v[220:223], v[52:55]
    v_mfma_f32_16x16x32_bf16 v[56:59], v[192:195], v[220:223], v[56:59]
    v_mfma_f32_16x16x32_bf16 v[60:63], v[196:199], v[220:223], v[60:63]
    s_waitcnt lgkmcnt(2)
    v_mfma_f32_16x16x32_bf16 v[64:67], v[192:195], v[224:227], v[64:67]
    ds_read_b128 v[240:243], v250 offset:22528
    ds_read_b128 v[244:247], v250 offset:33280
    v_mfma_f32_16x16x32_bf16 v[68:71], v[196:199], v[224:227], v[68:71]
    v_mfma_f32_16x16x32_bf16 v[72:75], v[208:211], v[224:227], v[72:75]
    v_mfma_f32_16x16x32_bf16 v[76:79], v[212:215], v[224:227], v[76:79]
    v_mfma_f32_16x16x32_bf16 v[64:67], v[200:203], v[228:231], v[64:67]
    v_mfma_f32_16x16x32_bf16 v[68:71], v[204:207], v[228:231], v[68:71]
    v_mfma_f32_16x16x32_bf16 v[72:75], v[192:195], v[228:231], v[72:75]
    v_mfma_f32_16x16x32_bf16 v[76:79], v[196:199], v[228:231], v[76:79]
    s_waitcnt lgkmcnt(2)
    v_mfma_f32_16x16x32_bf16 v[80:83], v[192:195], v[232:235], v[80:83]
    ds_read_b128 v[216:219], v250 offset:23552
    ds_read_b128 v[220:223], v250 offset:34304
    v_mfma_f32_16x16x32_bf16 v[84:87], v[196:199], v[232:235], v[84:87]
    v_mfma_f32_16x16x32_bf16 v[88:91], v[208:211], v[232:235], v[88:91]
    v_mfma_f32_16x16x32_bf16 v[92:95], v[212:215], v[232:235], v[92:95]
    v_mfma_f32_16x16x32_bf16 v[80:83], v[200:203], v[236:239], v[80:83]
    v_mfma_f32_16x16x32_bf16 v[84:87], v[204:207], v[236:239], v[84:87]
    v_mfma_f32_16x16x32_bf16 v[88:91], v[192:195], v[236:239], v[88:91]
    v_mfma_f32_16x16x32_bf16 v[92:95], v[196:199], v[236:239], v[92:95]
    s_waitcnt lgkmcnt(2)
    v_mfma_f32_16x16x32_bf16 v[96:99], v[192:195], v[240:243], v[96:99]
    ds_read_b128 v[224:227], v250 offset:24576
    ds_read_b128 v[228:231], v250 offset:35328
    v_mfma_f32_16x16x32_bf16 v[100:103], v[196:199], v[240:243], v[100:103]
    v_mfma_f32_16x16x32_bf16 v[104:107], v[208:211], v[240:243], v[104:107]
    v_mfma_f32_16x16x32_bf16 v[108:111], v[212:215], v[240:243], v[108:111]
    v_mfma_f32_16x16x32_bf16 v[96:99], v[200:203], v[244:247], v[96:99]
    v_add_u32 v248, 0xfffe4400, v248
    v_add_u32 v249, 0xfffe4400, v249
    v_mfma_f32_16x16x32_bf16 v[100:103], v[204:207], v[244:247], v[100:103]
    v_mfma_f32_16x16x32_bf16 v[104:107], v[192:195], v[244:247], v[104:107]
    v_mfma_f32_16x16x32_bf16 v[108:111], v[196:199], v[244:247], v[108:111]
    s_waitcnt lgkmcnt(2)
    v_mfma_f32_16x16x32_bf16 v[112:115], v[192:195], v[216:219], v[112:115]
    ds_read_b128 v[232:235], v250 offset:25600
    ds_read_b128 v[236:239], v250 offset:36352
    v_mfma_f32_16x16x32_bf16 v[116:119], v[196:199], v[216:219], v[116:119]
    v_mfma_f32_16x16x32_bf16 v[120:123], v[208:211], v[216:219], v[120:123]
    v_mfma_f32_16x16x32_bf16 v[124:127], v[212:215], v[216:219], v[124:127]
    ds_read_b64_tr_b16 v[176:177], v248 offset:0
    ds_read_b64_tr_b16 v[178:179], v248 offset:1024
    ds_read_b64_tr_b16 v[180:181], v249 offset:0
    ds_read_b64_tr_b16 v[182:183], v249 offset:1024
    v_mfma_f32_16x16x32_bf16 v[112:115], v[200:203], v[220:223], v[112:115]
    v_mfma_f32_16x16x32_bf16 v[116:119], v[204:207], v[220:223], v[116:119]
    v_mfma_f32_16x16x32_bf16 v[120:123], v[192:195], v[220:223], v[120:123]
    v_mfma_f32_16x16x32_bf16 v[124:127], v[196:199], v[220:223], v[124:127]
    s_waitcnt lgkmcnt(6)
    v_mfma_f32_16x16x32_bf16 v[128:131], v[192:195], v[224:227], v[128:131]
    ds_read_b128 v[240:243], v250 offset:26624
    ds_read_b128 v[244:247], v250 offset:37376
    v_mfma_f32_16x16x32_bf16 v[132:135], v[196:199], v[224:227], v[132:135]
    v_mfma_f32_16x16x32_bf16 v[136:139], v[208:211], v[224:227], v[136:139]
    v_mfma_f32_16x16x32_bf16 v[140:143], v[212:215], v[224:227], v[140:143]
    ds_read_b64_tr_b16 v[184:185], v248 offset:8192
    ds_read_b64_tr_b16 v[186:187], v248 offset:9216
    ds_read_b64_tr_b16 v[188:189], v249 offset:8192
    ds_read_b64_tr_b16 v[190:191], v249 offset:9216
    v_mfma_f32_16x16x32_bf16 v[128:131], v[200:203], v[228:231], v[128:131]
    v_mfma_f32_16x16x32_bf16 v[132:135], v[204:207], v[228:231], v[132:135]
    v_mfma_f32_16x16x32_bf16 v[136:139], v[192:195], v[228:231], v[136:139]
    v_mfma_f32_16x16x32_bf16 v[140:143], v[196:199], v[228:231], v[140:143]
    s_waitcnt lgkmcnt(10)
    v_mfma_f32_16x16x32_bf16 v[144:147], v[192:195], v[232:235], v[144:147]
    v_add_u32 v250, 0xfffe4400, v250
    ds_read_b128 v[216:219], v250 offset:16384
    ds_read_b128 v[220:223], v250 offset:27136
    v_mfma_f32_16x16x32_bf16 v[148:151], v[196:199], v[232:235], v[148:151]
    v_mfma_f32_16x16x32_bf16 v[152:155], v[208:211], v[232:235], v[152:155]
    v_mfma_f32_16x16x32_bf16 v[156:159], v[212:215], v[232:235], v[156:159]
    v_mfma_f32_16x16x32_bf16 v[144:147], v[200:203], v[236:239], v[144:147]
    v_mfma_f32_16x16x32_bf16 v[148:151], v[204:207], v[236:239], v[148:151]
    v_mfma_f32_16x16x32_bf16 v[152:155], v[192:195], v[236:239], v[152:155]
    v_mfma_f32_16x16x32_bf16 v[156:159], v[196:199], v[236:239], v[156:159]
    s_waitcnt lgkmcnt(6)
    v_mfma_f32_16x16x32_bf16 v[160:163], v[192:195], v[240:243], v[160:163]
    ds_read_b128 v[224:227], v250 offset:17408
    ds_read_b128 v[228:231], v250 offset:28160
    v_mfma_f32_16x16x32_bf16 v[164:167], v[196:199], v[240:243], v[164:167]
    v_mfma_f32_16x16x32_bf16 v[168:171], v[208:211], v[240:243], v[168:171]
    v_mfma_f32_16x16x32_bf16 v[172:175], v[212:215], v[240:243], v[172:175]
    s_waitcnt lgkmcnt(4)
    v_xor_b32 v208, 0x80008000, v184
    v_xor_b32 v209, 0x80008000, v185
    v_mfma_f32_16x16x32_bf16 v[160:163], v[200:203], v[244:247], v[160:163]
    v_xor_b32 v210, 0x80008000, v186
    v_xor_b32 v211, 0x80008000, v187
    v_mfma_f32_16x16x32_bf16 v[164:167], v[204:207], v[244:247], v[164:167]
    v_xor_b32 v212, 0x80008000, v188
    v_xor_b32 v213, 0x80008000, v189
    v_mfma_f32_16x16x32_bf16 v[168:171], v[192:195], v[244:247], v[168:171]
    v_xor_b32 v214, 0x80008000, v190
    v_xor_b32 v215, 0x80008000, v191
    v_mfma_f32_16x16x32_bf16 v[172:175], v[196:199], v[244:247], v[172:175]
    s_sub_u32 s46, s46, 1
    s_cmp_lg_u32 s46, 0
    s_cbranch_scc1 L_g_loop
    s_barrier
    s_waitcnt lgkmcnt(2)
    v_mfma_f32_16x16x32_bf16 v[0:3], v[176:179], v[216:219], v[0:3]
    ds_read_b128 v[232:235], v250 offset:18432
    ds_read_b128 v[236:239], v250 offset:29184
    v_mfma_f32_16x16x32_bf16 v[4:7], v[180:183], v[216:219], v[4:7]
    v_mfma_f32_16x16x32_bf16 v[8:11], v[208:211], v[216:219], v[8:11]
    v_mfma_f32_16x16x32_bf16 v[12:15], v[212:215], v[216:219], v[12:15]
    v_mfma_f32_16x16x32_bf16 v[0:3], v[184:187], v[220:223], v[0:3]
    v_mfma_f32_16x16x32_bf16 v[4:7], v[188:191], v[220:223], v[4:7]
    v_mfma_f32_16x16x32_bf16 v[8:11], v[176:179], v[220:223], v[8:11]
    v_mfma_f32_16x16x32_bf16 v[12:15], v[180:183], v[220:223], v[12:15]
    s_waitcnt lgkmcnt(2)
    v_mfma_f32_16x16x32_bf16 v[16:19], v[176:179], v[224:227], v[16:19]
    ds_read_b128 v[240:243], v250 offset:19456
    ds_read_b128 v[244:247], v250 offset:30208
    v_mfma_f32_16x16x32_bf16 v[20:23], v[180:183], v[224:227], v[20:23]
    v_mfma_f32_16x16x32_bf16 v[24:27], v[208:211], v[224:227], v[24:27]
    v_mfma_f32_16x16x32_bf16 v[28:31], v[212:215], v[224:227], v[28:31]
    v_mfma_f32_16x16x32_bf16 v[16:19], v[184:187], v[228:231], v[16:19]
    v_mfma_f32_16x16x32_bf16 v[20:23], v[188:191], v[228:231], v[20:23]
    v_mfma_f32_16x16x32_bf16 v[24:27], v[176:179], v[228:231], v[24:27]
    v_mfma_f32_16x16x32_bf16 v[28:31], v[180:183], v[228:231], v[28:31]
    s_waitcnt lgkmcnt(2)
    v_mfma_f32_16x16x32_bf16 v[32:35], v[176:179], v[232:235], v[32:35]
    ds_read_b128 v[216:219], v250 offset:20480
    ds_read_b128 v[220:223], v250 offset:31232
    v_mfma_f32_16x16x32_bf16 v[36:39], v[180:183], v[232:235], v[36:39]
    v_mfma_f32_16x16x32_bf16 v[40:43], v[208:211], v[232:235], v[40:43]
    v_mfma_f32_16x16x32_bf16 v[44:47], v[212:215], v[232:235], v[44:47]
    v_mfma_f32_16x16x32_bf16 v[32:35], v[184:187], v[236:239], v[32:35]
    v_mfma_f32_16x16x32_bf16 v[36:39], v[188:191], v[236:239], v[36:39]
    v_mfma_f32_16x16x32_bf16 v[40:43], v[176:179], v[236:239], v[40:43]
    v_mfma_f32_16x16x32_bf16 v[44:47], v[180:183], v[236:239], v[44:47]
    s_waitcnt lgkmcnt(2)
    v_mfma_f32_16x16x32_bf16 v[48:51], v[176:179], v[240:243], v[48:51]
    ds_read_b128 v[224:227], v250 offset:21504
    ds_read_b128 v[228:231], v250 offset:32256
    v_mfma_f32_16x16x32_bf16 v[52:55], v[180:183], v[240:243], v[52:55]
    v_mfma_f32_16x16x32_bf16 v[56:59], v[208:211], v[240:243], v[56:59]
    v_mfma_f32_16x16x32_bf16 v[60:63], v[212:215], v[240:243], v[60:63]
    v_mfma_f32_16x16x32_bf16 v[48:51], v[184:187], v[244:247], v[48:51]
    v_mfma_f32_16x16x32_bf16 v[52:55], v[188:191], v[244:247], v[52:55]
    v_mfma_f32_16x16x32_bf16 v[56:59], v[176:179], v[244:247], v[56:59]
    v_mfma_f32_16x16x32_bf16 v[60:63], v[180:183], v[244:247], v[60:63]
    s_waitcnt lgkmcnt(2)
    v_mfma_f32_16x16x32_bf16 v[64:67], v[176:179], v[216:219], v[64:67]
    ds_read_b128 v[232:235], v250 offset:22528
    ds_read_b128 v[236:239], v250 offset:33280
    v_mfma_f32_16x16x32_bf16 v[68:71], v[180:183], v[216:219], v[68:71]
    v_mfma_f32_16x16x32_bf16 v[72:75], v[208:211], v[216:219], v[72:75]
    v_mfma_f32_16x16x32_bf16 v[76:79], v[212:215], v[216:219], v[76:79]
    v_mfma_f32_16x16x32_bf16 v[64:67], v[184:187], v[220:223], v[64:67]
    v_mfma_f32_16x16x32_bf16 v[68:71], v[188:191], v[220:223], v[68:71]
    v_mfma_f32_16x16x32_bf16 v[72:75], v[176:179], v[220:223], v[72:75]
    v_mfma_f32_16x16x32_bf16 v[76:79], v[180:183], v[220:223], v[76:79]
    s_waitcnt lgkmcnt(2)
    v_mfma_f32_16x16x32_bf16 v[80:83], v[176:179], v[224:227], v[80:83]
    ds_read_b128 v[240:243], v250 offset:23552
    ds_read_b128 v[244:247], v250 offset:34304
    v_mfma_f32_16x16x32_bf16 v[84:87], v[180:183], v[224:227], v[84:87]
    v_mfma_f32_16x16x32_bf16 v[88:91], v[208:211], v[224:227], v[88:91]
    v_mfma_f32_16x16x32_bf16 v[92:95], v[212:215], v[224:227], v[92:95]
    v_mfma_f32_16x16x32_bf16 v[80:83], v[184:187], v[228:231], v[80:83]
    v_mfma_f32_16x16x32_bf16 v[84:87], v[188:191], v[228:231], v[84:87]
    v_mfma_f32_16x16x32_bf16 v[88:91], v[176:179], v[228:231], v[88:91]
    v_mfma_f32_16x16x32_bf16 v[92:95], v[180:183], v[228:231], v[92:95]
    s_waitcnt lgkmcnt(2)
    v_mfma_f32_16x16x32_bf16 v[96:99], v[176:179], v[232:235], v[96:99]
    ds_read_b128 v[216:219], v250 offset:24576
    ds_read_b128 v[220:223], v250 offset:35328
    v_mfma_f32_16x16x32_bf16 v[100:103], v[180:183], v[232:235], v[100:103]
    v_mfma_f32_16x16x32_bf16 v[104:107], v[208:211], v[232:235], v[104:107]
    v_mfma_f32_16x16x32_bf16 v[108:111], v[212:215], v[232:235], v[108:111]
    v_mfma_f32_16x16x32_bf16 v[96:99], v[184:187], v[236:239], v[96:99]
    v_add_u32 v248, 0x9400, v248
    v_add_u32 v249, 0x9400, v249
    v_mfma_f32_16x16x32_bf16 v[100:103], v[188:191], v[236:239], v[100:103]
    v_mfma_f32_16x16x32_bf16 v[104:107], v[176:179], v[236:239], v[104:107]
    v_mfma_f32_16x16x32_bf16 v[108:111], v[180:183], v[236:239], v[108:111]
    s_waitcnt lgkmcnt(2)
    v_mfma_f32_16x16x32_bf16 v[112:115], v[176:179], v[240:243], v[112:115]
    ds_read_b128 v[224:227], v250 offset:25600
    ds_read_b128 v[228:231], v250 offset:36352
    v_mfma_f32_16x16x32_bf16 v[116:119], v[180:183], v[240:243], v[116:119]
    v_mfma_f32_16x16x32_bf16 v[120:123], v[208:211], v[240:243], v[120:123]
    v_mfma_f32_16x16x32_bf16 v[124:127], v[212:215], v[240:243], v[124:127]
    ds_read_b64_tr_b16 v[192:193], v248 offset:0
    ds_read_b64_tr_b16 v[194:195], v248 offset:1024
    ds_read_b64_tr_b16 v[196:197], v249 offset:0
    ds_read_b64_tr_b16 v[198:199], v249 offset:1024
    v_mfma_f32_16x16x32_bf16 v[112:115], v[184:187], v[244:247], v[112:115]
    v_mfma_f32_16x16x32_bf16 v[116:119], v[188:191], v[244:247], v[116:119]
    v_mfma_f32_16x16x32_bf16 v[120:123], v[176:179], v[244:247], v[120:123]
    v_mfma_f32_16x16x32_bf16 v[124:127], v[180:183], v[244:247], v[124:127]
    s_waitcnt lgkmcnt(6)
    v_mfma_f32_16x16x32_bf16 v[128:131], v[176:179], v[216:219], v[128:131]
    ds_read_b128 v[232:235], v250 offset:26624
    ds_read_b128 v[236:239], v250 offset:37376
    v_mfma_f32_16x16x32_bf16 v[132:135], v[180:183], v[216:219], v[132:135]
    v_mfma_f32_16x16x32_bf16 v[136:139], v[208:211], v[216:219], v[136:139]
    v_mfma_f32_16x16x32_bf16 v[140:143], v[212:215], v[216:219], v[140:143]
    ds_read_b64_tr_b16 v[200:201], v248 offset:8192
    ds_read_b64_tr_b16 v[202:203], v248 offset:9216
    ds_read_b64_tr_b16 v[204:205], v249 offset:8192
    ds_read_b64_tr_b16 v[206:207], v249 offset:9216
    v_mfma_f32_16x16x32_bf16 v[128:131], v[184:187], v[220:223], v[128:131]
    v_mfma_f32_16x16x32_bf16 v[132:135], v[188:191], v[220:223], v[132:135]
    v_mfma_f32_16x16x32_bf16 v[136:139], v[176:179], v[220:223], v[136:139]
    v_mfma_f32_16x16x32_bf16 v[140:143], v[180:183], v[220:223], v[140:143]
    s_waitcnt lgkmcnt(10)
    v_mfma_f32_16x16x32_bf16 v[144:147], v[176:179], v[224:227], v[144:147]
    v_add_u32 v250, 0x9400, v250
    ds_read_b128 v[240:243], v250 offset:16384
    ds_read_b128 v[244:247], v250 offset:27136
    v_mfma_f32_16x16x32_bf16 v[148:151], v[180:183], v[224:227], v[148:151]
    v_mfma_f32_16x16x32_bf16 v[152:155], v[208:211], v[224:227], v[152:155]
    v_mfma_f32_16x16x32_bf16 v[156:159], v[212:215], v[224:227], v[156:159]
    v_mfma_f32_16x16x32_bf16 v[144:147], v[184:187], v[228:231], v[144:147]
    v_mfma_f32_16x16x32_bf16 v[148:151], v[188:191], v[228:231], v[148:151]
    v_mfma_f32_16x16x32_bf16 v[152:155], v[176:179], v[228:231], v[152:155]
    v_mfma_f32_16x16x32_bf16 v[156:159], v[180:183], v[228:231], v[156:159]
    s_waitcnt lgkmcnt(6)
    v_mfma_f32_16x16x32_bf16 v[160:163], v[176:179], v[232:235], v[160:163]
    ds_read_b128 v[216:219], v250 offset:17408
    ds_read_b128 v[220:223], v250 offset:28160
    v_mfma_f32_16x16x32_bf16 v[164:167], v[180:183], v[232:235], v[164:167]
    v_mfma_f32_16x16x32_bf16 v[168:171], v[208:211], v[232:235], v[168:171]
    v_mfma_f32_16x16x32_bf16 v[172:175], v[212:215], v[232:235], v[172:175]
    s_waitcnt lgkmcnt(4)
    v_xor_b32 v208, 0x80008000, v200
    v_xor_b32 v209, 0x80008000, v201
    v_mfma_f32_16x16x32_bf16 v[160:163], v[184:187], v[236:239], v[160:163]
    v_xor_b32 v210, 0x80008000, v202
    v_xor_b32 v211, 0x80008000, v203
    v_mfma_f32_16x16x32_bf16 v[164:167], v[188:191], v[236:239], v[164:167]
    v_xor_b32 v212, 0x80008000, v204
    v_xor_b32 v213, 0x80008000, v205
    v_mfma_f32_16x16x32_bf16 v[168:171], v[176:179], v[236:239], v[168:171]
    v_xor_b32 v214, 0x80008000, v206
    v_xor_b32 v215, 0x80008000, v207
    v_mfma_f32_16x16x32_bf16 v[172:175], v[180:183], v[236:239], v[172:175]
    s_barrier
    s_waitcnt lgkmcnt(2)
    v_mfma_f32_16x16x32_bf16 v[0:3], v[192:195], v[240:243], v[0:3]
    ds_read_b128 v[224:227], v250 offset:18432
    ds_read_b128 v[228:231], v250 offset:29184
    v_mfma_f32_16x16x32_bf16 v[4:7], v[196:199], v[240:243], v[4:7]
    v_mfma_f32_16x16x32_bf16 v[8:11], v[208:211], v[240:243], v[8:11]
    v_mfma_f32_16x16x32_bf16 v[12:15], v[212:215], v[240:243], v[12:15]
    v_mfma_f32_16x16x32_bf16 v[0:3], v[200:203], v[244:247], v[0:3]
    v_mfma_f32_16x16x32_bf16 v[4:7], v[204:207], v[244:247], v[4:7]
    v_mfma_f32_16x16x32_bf16 v[8:11], v[192:195], v[244:247], v[8:11]
    v_mfma_f32_16x16x32_bf16 v[12:15], v[196:199], v[244:247], v[12:15]
    s_waitcnt lgkmcnt(2)
    v_mfma_f32_16x16x32_bf16 v[16:19], v[192:195], v[216:219], v[16:19]
    ds_read_b128 v[232:235], v250 offset:19456
    ds_read_b128 v[236:239], v250 offset:30208
    v_mfma_f32_16x16x32_bf16 v[20:23], v[196:199], v[216:219], v[20:23]
    v_mfma_f32_16x16x32_bf16 v[24:27], v[208:211], v[216:219], v[24:27]
    v_mfma_f32_16x16x32_bf16 v[28:31], v[212:215], v[216:219], v[28:31]
    v_mfma_f32_16x16x32_bf16 v[16:19], v[200:203], v[220:223], v[16:19]
    v_mfma_f32_16x16x32_bf16 v[20:23], v[204:207], v[220:223], v[20:23]
    v_mfma_f32_16x16x32_bf16 v[24:27], v[192:195], v[220:223], v[24:27]
    v_mfma_f32_16x16x32_bf16 v[28:31], v[196:199], v[220:223], v[28:31]
    s_waitcnt lgkmcnt(2)
    v_mfma_f32_16x16x32_bf16 v[32:35], v[192:195], v[224:227], v[32:35]
    ds_read_b128 v[240:243], v250 offset:20480
    ds_read_b128 v[244:247], v250 offset:31232
    v_mfma_f32_16x16x32_bf16 v[36:39], v[196:199], v[224:227], v[36:39]
    v_mfma_f32_16x16x32_bf16 v[40:43], v[208:211], v[224:227], v[40:43]
    v_mfma_f32_16x16x32_bf16 v[44:47], v[212:215], v[224:227], v[44:47]
    v_mfma_f32_16x16x32_bf16 v[32:35], v[200:203], v[228:231], v[32:35]
    v_mfma_f32_16x16x32_bf16 v[36:39], v[204:207], v[228:231], v[36:39]
    v_mfma_f32_16x16x32_bf16 v[40:43], v[192:195], v[228:231], v[40:43]
    v_mfma_f32_16x16x32_bf16 v[44:47], v[196:199], v[228:231], v[44:47]
    s_waitcnt lgkmcnt(2)
    v_mfma_f32_16x16x32_bf16 v[48:51], v[192:195], v[232:235], v[48:51]
    ds_read_b128 v[216:219], v250 offset:21504
    ds_read_b128 v[220:223], v250 offset:32256
    v_mfma_f32_16x16x32_bf16 v[52:55], v[196:199], v[232:235], v[52:55]
    v_mfma_f32_16x16x32_bf16 v[56:59], v[208:211], v[232:235], v[56:59]
    v_mfma_f32_16x16x32_bf16 v[60:63], v[212:215], v[232:235], v[60:63]
    v_mfma_f32_16x16x32_bf16 v[48:51], v[200:203], v[236:239], v[48:51]
    v_mfma_f32_16x16x32_bf16 v[52:55], v[204:207], v[236:239], v[52:55]
    v_mfma_f32_16x16x32_bf16 v[56:59], v[192:195], v[236:239], v[56:59]
    v_mfma_f32_16x16x32_bf16 v[60:63], v[196:199], v[236:239], v[60:63]
    s_waitcnt lgkmcnt(2)
    v_mfma_f32_16x16x32_bf16 v[64:67], v[192:195], v[240:243], v[64:67]
    ds_read_b128 v[224:227], v250 offset:22528
    ds_read_b128 v[228:231], v250 offset:33280
    v_mfma_f32_16x16x32_bf16 v[68:71], v[196:199], v[240:243], v[68:71]
    v_mfma_f32_16x16x32_bf16 v[72:75], v[208:211], v[240:243], v[72:75]
    v_mfma_f32_16x16x32_bf16 v[76:79], v[212:215], v[240:243], v[76:79]
    v_mfma_f32_16x16x32_bf16 v[64:67], v[200:203], v[244:247], v[64:67]
    v_mfma_f32_16x16x32_bf16 v[68:71], v[204:207], v[244:247], v[68:71]
    v_mfma_f32_16x16x32_bf16 v[72:75], v[192:195], v[244:247], v[72:75]
    v_mfma_f32_16x16x32_bf16 v[76:79], v[196:199], v[244:247], v[76:79]
    s_waitcnt lgkmcnt(2)
    v_mfma_f32_16x16x32_bf16 v[80:83], v[192:195], v[216:219], v[80:83]
    ds_read_b128 v[232:235], v250 offset:23552
    ds_read_b128 v[236:239], v250 offset:34304
    v_mfma_f32_16x16x32_bf16 v[84:87], v[196:199], v[216:219], v[84:87]
    v_mfma_f32_16x16x32_bf16 v[88:91], v[208:211], v[216:219], v[88:91]
    v_mfma_f32_16x16x32_bf16 v[92:95], v[212:215], v[216:219], v[92:95]
    v_mfma_f32_16x16x32_bf16 v[80:83], v[200:203], v[220:223], v[80:83]
    v_mfma_f32_16x16x32_bf16 v[84:87], v[204:207], v[220:223], v[84:87]
    v_mfma_f32_16x16x32_bf16 v[88:91], v[192:195], v[220:223], v[88:91]
    v_mfma_f32_16x16x32_bf16 v[92:95], v[196:199], v[220:223], v[92:95]
    s_waitcnt lgkmcnt(2)
    v_mfma_f32_16x16x32_bf16 v[96:99], v[192:195], v[224:227], v[96:99]
    ds_read_b128 v[240:243], v250 offset:24576
    ds_read_b128 v[244:247], v250 offset:35328
    v_mfma_f32_16x16x32_bf16 v[100:103], v[196:199], v[224:227], v[100:103]
    v_mfma_f32_16x16x32_bf16 v[104:107], v[208:211], v[224:227], v[104:107]
    v_mfma_f32_16x16x32_bf16 v[108:111], v[212:215], v[224:227], v[108:111]
    v_mfma_f32_16x16x32_bf16 v[96:99], v[200:203], v[228:231], v[96:99]
    v_add_u32 v248, 0x9400, v248
    v_add_u32 v249, 0x9400, v249
    v_mfma_f32_16x16x32_bf16 v[100:103], v[204:207], v[228:231], v[100:103]
    v_mfma_f32_16x16x32_bf16 v[104:107], v[192:195], v[228:231], v[104:107]
    v_mfma_f32_16x16x32_bf16 v[108:111], v[196:199], v[228:231], v[108:111]
    s_waitcnt lgkmcnt(2)
    v_mfma_f32_16x16x32_bf16 v[112:115], v[192:195], v[232:235], v[112:115]
    ds_read_b128 v[216:219], v250 offset:25600
    ds_read_b128 v[220:223], v250 offset:36352
    v_mfma_f32_16x16x32_bf16 v[116:119], v[196:199], v[232:235], v[116:119]
    v_mfma_f32_16x16x32_bf16 v[120:123], v[208:211], v[232:235], v[120:123]
    v_mfma_f32_16x16x32_bf16 v[124:127], v[212:215], v[232:235], v[124:127]
    ds_read_b64_tr_b16 v[176:177], v248 offset:0
    ds_read_b64_tr_b16 v[178:179], v248 offset:1024
    ds_read_b64_tr_b16 v[180:181], v249 offset:0
    ds_read_b64_tr_b16 v[182:183], v249 offset:1024
    v_mfma_f32_16x16x32_bf16 v[112:115], v[200:203], v[236:239], v[112:115]
    v_mfma_f32_16x16x32_bf16 v[116:119], v[204:207], v[236:239], v[116:119]
    v_mfma_f32_16x16x32_bf16 v[120:123], v[192:195], v[236:239], v[120:123]
    v_mfma_f32_16x16x32_bf16 v[124:127], v[196:199], v[236:239], v[124:127]
    s_waitcnt lgkmcnt(6)
    v_mfma_f32_16x16x32_bf16 v[128:131], v[192:195], v[240:243], v[128:131]
    ds_read_b128 v[224:227], v250 offset:26624
    ds_read_b128 v[228:231], v250 offset:37376
    v_mfma_f32_16x16x32_bf16 v[132:135], v[196:199], v[240:243], v[132:135]
    v_mfma_f32_16x16x32_bf16 v[136:139], v[208:211], v[240:243], v[136:139]
    v_mfma_f32_16x16x32_bf16 v[140:143], v[212:215], v[240:243], v[140:143]
    ds_read_b64_tr_b16 v[184:185], v248 offset:8192
    ds_read_b64_tr_b16 v[186:187], v248 offset:9216
    ds_read_b64_tr_b16 v[188:189], v249 offset:8192
    ds_read_b64_tr_b16 v[190:191], v249 offset:9216
    v_mfma_f32_16x16x32_bf16 v[128:131], v[200:203], v[244:247], v[128:131]
    v_mfma_f32_16x16x32_bf16 v[132:135], v[204:207], v[244:247], v[132:135]
    v_mfma_f32_16x16x32_bf16 v[136:139], v[192:195], v[244:247], v[136:139]
    v_mfma_f32_16x16x32_bf16 v[140:143], v[196:199], v[244:247], v[140:143]
    s_waitcnt lgkmcnt(10)
    v_mfma_f32_16x16x32_bf16 v[144:147], v[192:195], v[216:219], v[144:147]
    v_add_u32 v250, 0x9400, v250
    ds_read_b128 v[232:235], v250 offset:16384
    ds_read_b128 v[236:239], v250 offset:27136
    v_mfma_f32_16x16x32_bf16 v[148:151], v[196:199], v[216:219], v[148:151]
    v_mfma_f32_16x16x32_bf16 v[152:155], v[208:211], v[216:219], v[152:155]
    v_mfma_f32_16x16x32_bf16 v[156:159], v[212:215], v[216:219], v[156:159]
    v_mfma_f32_16x16x32_bf16 v[144:147], v[200:203], v[220:223], v[144:147]
    v_mfma_f32_16x16x32_bf16 v[148:151], v[204:207], v[220:223], v[148:151]
    v_mfma_f32_16x16x32_bf16 v[152:155], v[192:195], v[220:223], v[152:155]
    v_mfma_f32_16x16x32_bf16 v[156:159], v[196:199], v[220:223], v[156:159]
    s_waitcnt lgkmcnt(6)
    v_mfma_f32_16x16x32_bf16 v[160:163], v[192:195], v[224:227], v[160:163]
    ds_read_b128 v[240:243], v250 offset:17408
    ds_read_b128 v[244:247], v250 offset:28160
    v_mfma_f32_16x16x32_bf16 v[164:167], v[196:199], v[224:227], v[164:167]
    v_mfma_f32_16x16x32_bf16 v[168:171], v[208:211], v[224:227], v[168:171]
    v_mfma_f32_16x16x32_bf16 v[172:175], v[212:215], v[224:227], v[172:175]
    s_waitcnt lgkmcnt(4)
    v_xor_b32 v208, 0x80008000, v184
    v_xor_b32 v209, 0x80008000, v185
    v_mfma_f32_16x16x32_bf16 v[160:163], v[200:203], v[228:231], v[160:163]
    v_xor_b32 v210, 0x80008000, v186
    v_xor_b32 v211, 0x80008000, v187
    v_mfma_f32_16x16x32_bf16 v[164:167], v[204:207], v[228:231], v[164:167]
    v_xor_b32 v212, 0x80008000, v188
    v_xor_b32 v213, 0x80008000, v189
    v_mfma_f32_16x16x32_bf16 v[168:171], v[192:195], v[228:231], v[168:171]
    v_xor_b32 v214, 0x80008000, v190
    v_xor_b32 v215, 0x80008000, v191
    v_mfma_f32_16x16x32_bf16 v[172:175], v[196:199], v[228:231], v[172:175]
    s_barrier
    s_waitcnt lgkmcnt(2)
    v_mfma_f32_16x16x32_bf16 v[0:3], v[176:179], v[232:235], v[0:3]
    ds_read_b128 v[216:219], v250 offset:18432
    ds_read_b128 v[220:223], v250 offset:29184
    v_mfma_f32_16x16x32_bf16 v[4:7], v[180:183], v[232:235], v[4:7]
    v_mfma_f32_16x16x32_bf16 v[8:11], v[208:211], v[232:235], v[8:11]
    v_mfma_f32_16x16x32_bf16 v[12:15], v[212:215], v[232:235], v[12:15]
    v_mfma_f32_16x16x32_bf16 v[0:3], v[184:187], v[236:239], v[0:3]
    v_mfma_f32_16x16x32_bf16 v[4:7], v[188:191], v[236:239], v[4:7]
    v_mfma_f32_16x16x32_bf16 v[8:11], v[176:179], v[236:239], v[8:11]
    v_mfma_f32_16x16x32_bf16 v[12:15], v[180:183], v[236:239], v[12:15]
    s_waitcnt lgkmcnt(2)
    v_mfma_f32_16x16x32_bf16 v[16:19], v[176:179], v[240:243], v[16:19]
    ds_read_b128 v[224:227], v250 offset:19456
    ds_read_b128 v[228:231], v250 offset:30208
    v_mfma_f32_16x16x32_bf16 v[20:23], v[180:183], v[240:243], v[20:23]
    v_mfma_f32_16x16x32_bf16 v[24:27], v[208:211], v[240:243], v[24:27]
    v_mfma_f32_16x16x32_bf16 v[28:31], v[212:215], v[240:243], v[28:31]
    v_mfma_f32_16x16x32_bf16 v[16:19], v[184:187], v[244:247], v[16:19]
    v_mfma_f32_16x16x32_bf16 v[20:23], v[188:191], v[244:247], v[20:23]
    v_mfma_f32_16x16x32_bf16 v[24:27], v[176:179], v[244:247], v[24:27]
    v_mfma_f32_16x16x32_bf16 v[28:31], v[180:183], v[244:247], v[28:31]
    s_waitcnt lgkmcnt(2)
    v_mfma_f32_16x16x32_bf16 v[32:35], v[176:179], v[216:219], v[32:35]
    ds_read_b128 v[232:235], v250 offset:20480
    ds_read_b128 v[236:239], v250 offset:31232
    v_mfma_f32_16x16x32_bf16 v[36:39], v[180:183], v[216:219], v[36:39]
    v_mfma_f32_16x16x32_bf16 v[40:43], v[208:211], v[216:219], v[40:43]
    v_mfma_f32_16x16x32_bf16 v[44:47], v[212:215], v[216:219], v[44:47]
    v_mfma_f32_16x16x32_bf16 v[32:35], v[184:187], v[220:223], v[32:35]
    v_mfma_f32_16x16x32_bf16 v[36:39], v[188:191], v[220:223], v[36:39]
    v_mfma_f32_16x16x32_bf16 v[40:43], v[176:179], v[220:223], v[40:43]
    v_mfma_f32_16x16x32_bf16 v[44:47], v[180:183], v[220:223], v[44:47]
    s_waitcnt lgkmcnt(2)
    v_mfma_f32_16x16x32_bf16 v[48:51], v[176:179], v[224:227], v[48:51]
    ds_read_b128 v[240:243], v250 offset:21504
    ds_read_b128 v[244:247], v250 offset:32256
    v_mfma_f32_16x16x32_bf16 v[52:55], v[180:183], v[224:227], v[52:55]
    v_mfma_f32_16x16x32_bf16 v[56:59], v[208:211], v[224:227], v[56:59]
    v_mfma_f32_16x16x32_bf16 v[60:63], v[212:215], v[224:227], v[60:63]
    v_mfma_f32_16x16x32_bf16 v[48:51], v[184:187], v[228:231], v[48:51]
    v_mfma_f32_16x16x32_bf16 v[52:55], v[188:191], v[228:231], v[52:55]
    v_mfma_f32_16x16x32_bf16 v[56:59], v[176:179], v[228:231], v[56:59]
    v_mfma_f32_16x16x32_bf16 v[60:63], v[180:183], v[228:231], v[60:63]
    s_waitcnt lgkmcnt(2)
    v_mfma_f32_16x16x32_bf16 v[64:67], v[176:179], v[232:235], v[64:67]
    ds_read_b128 v[216:219], v250 offset:22528
    ds_read_b128 v[220:223], v250 offset:33280
    v_mfma_f32_16x16x32_bf16 v[68:71], v[180:183], v[232:235], v[68:71]
    v_mfma_f32_16x16x32_bf16 v[72:75], v[208:211], v[232:235], v[72:75]
    v_mfma_f32_16x16x32_bf16 v[76:79], v[212:215], v[232:235], v[76:79]
    v_mfma_f32_16x16x32_bf16 v[64:67], v[184:187], v[236:239], v[64:67]
    v_mfma_f32_16x16x32_bf16 v[68:71], v[188:191], v[236:239], v[68:71]
    v_mfma_f32_16x16x32_bf16 v[72:75], v[176:179], v[236:239], v[72:75]
    v_mfma_f32_16x16x32_bf16 v[76:79], v[180:183], v[236:239], v[76:79]
    s_waitcnt lgkmcnt(2)
    v_mfma_f32_16x16x32_bf16 v[80:83], v[176:179], v[240:243], v[80:83]
    ds_read_b128 v[224:227], v250 offset:23552
    ds_read_b128 v[228:231], v250 offset:34304
    v_mfma_f32_16x16x32_bf16 v[84:87], v[180:183], v[240:243], v[84:87]
    v_mfma_f32_16x16x32_bf16 v[88:91], v[208:211], v[240:243], v[88:91]
    v_mfma_f32_16x16x32_bf16 v[92:95], v[212:215], v[240:243], v[92:95]
    v_mfma_f32_16x16x32_bf16 v[80:83], v[184:187], v[244:247], v[80:83]
    v_mfma_f32_16x16x32_bf16 v[84:87], v[188:191], v[244:247], v[84:87]
    v_mfma_f32_16x16x32_bf16 v[88:91], v[176:179], v[244:247], v[88:91]
    v_mfma_f32_16x16x32_bf16 v[92:95], v[180:183], v[244:247], v[92:95]
    s_waitcnt lgkmcnt(2)
    v_mfma_f32_16x16x32_bf16 v[96:99], v[176:179], v[216:219], v[96:99]
    ds_read_b128 v[232:235], v250 offset:24576
    ds_read_b128 v[236:239], v250 offset:35328
    v_mfma_f32_16x16x32_bf16 v[100:103], v[180:183], v[216:219], v[100:103]
    v_mfma_f32_16x16x32_bf16 v[104:107], v[208:211], v[216:219], v[104:107]
    v_mfma_f32_16x16x32_bf16 v[108:111], v[212:215], v[216:219], v[108:111]
    v_mfma_f32_16x16x32_bf16 v[96:99], v[184:187], v[220:223], v[96:99]
    v_add_u32 v248, 0x9400, v248
    v_add_u32 v249, 0x9400, v249
    v_mfma_f32_16x16x32_bf16 v[100:103], v[188:191], v[220:223], v[100:103]
    v_mfma_f32_16x16x32_bf16 v[104:107], v[176:179], v[220:223], v[104:107]
    v_mfma_f32_16x16x32_bf16 v[108:111], v[180:183], v[220:223], v[108:111]
    s_waitcnt lgkmcnt(2)
    v_mfma_f32_16x16x32_bf16 v[112:115], v[176:179], v[224:227], v[112:115]
    ds_read_b128 v[240:243], v250 offset:25600
    ds_read_b128 v[244:247], v250 offset:36352
    v_mfma_f32_16x16x32_bf16 v[116:119], v[180:183], v[224:227], v[116:119]
    v_mfma_f32_16x16x32_bf16 v[120:123], v[208:211], v[224:227], v[120:123]
    v_mfma_f32_16x16x32_bf16 v[124:127], v[212:215], v[224:227], v[124:127]
    ds_read_b64_tr_b16 v[192:193], v248 offset:0
    ds_read_b64_tr_b16 v[194:195], v248 offset:1024
    ds_read_b64_tr_b16 v[196:197], v249 offset:0
    ds_read_b64_tr_b16 v[198:199], v249 offset:1024
    v_mfma_f32_16x16x32_bf16 v[112:115], v[184:187], v[228:231], v[112:115]
    v_mfma_f32_16x16x32_bf16 v[116:119], v[188:191], v[228:231], v[116:119]
    v_mfma_f32_16x16x32_bf16 v[120:123], v[176:179], v[228:231], v[120:123]
    v_mfma_f32_16x16x32_bf16 v[124:127], v[180:183], v[228:231], v[124:127]
    s_waitcnt lgkmcnt(6)
    v_mfma_f32_16x16x32_bf16 v[128:131], v[176:179], v[232:235], v[128:131]
    ds_read_b128 v[216:219], v250 offset:26624
    ds_read_b128 v[220:223], v250 offset:37376
    v_mfma_f32_16x16x32_bf16 v[132:135], v[180:183], v[232:235], v[132:135]
    v_mfma_f32_16x16x32_bf16 v[136:139], v[208:211], v[232:235], v[136:139]
    v_mfma_f32_16x16x32_bf16 v[140:143], v[212:215], v[232:235], v[140:143]
    ds_read_b64_tr_b16 v[200:201], v248 offset:8192
    ds_read_b64_tr_b16 v[202:203], v248 offset:9216
    ds_read_b64_tr_b16 v[204:205], v249 offset:8192
    ds_read_b64_tr_b16 v[206:207], v249 offset:9216
    v_mfma_f32_16x16x32_bf16 v[128:131], v[184:187], v[236:239], v[128:131]
    v_mfma_f32_16x16x32_bf16 v[132:135], v[188:191], v[236:239], v[132:135]
    v_mfma_f32_16x16x32_bf16 v[136:139], v[176:179], v[236:239], v[136:139]
    v_mfma_f32_16x16x32_bf16 v[140:143], v[180:183], v[236:239], v[140:143]
    s_waitcnt lgkmcnt(10)
    v_mfma_f32_16x16x32_bf16 v[144:147], v[176:179], v[240:243], v[144:147]
    v_add_u32 v250, 0x9400, v250
    ds_read_b128 v[224:227], v250 offset:16384
    ds_read_b128 v[228:231], v250 offset:27136
    v_mfma_f32_16x16x32_bf16 v[148:151], v[180:183], v[240:243], v[148:151]
    v_mfma_f32_16x16x32_bf16 v[152:155], v[208:211], v[240:243], v[152:155]
    v_mfma_f32_16x16x32_bf16 v[156:159], v[212:215], v[240:243], v[156:159]
    v_mfma_f32_16x16x32_bf16 v[144:147], v[184:187], v[244:247], v[144:147]
    v_mfma_f32_16x16x32_bf16 v[148:151], v[188:191], v[244:247], v[148:151]
    v_mfma_f32_16x16x32_bf16 v[152:155], v[176:179], v[244:247], v[152:155]
    v_mfma_f32_16x16x32_bf16 v[156:159], v[180:183], v[244:247], v[156:159]
    s_waitcnt lgkmcnt(6)
    v_mfma_f32_16x16x32_bf16 v[160:163], v[176:179], v[216:219], v[160:163]
    ds_read_b128 v[232:235], v250 offset:17408
    ds_read_b128 v[236:239], v250 offset:28160
    v_mfma_f32_16x16x32_bf16 v[164:167], v[180:183], v[216:219], v[164:167]
    v_mfma_f32_16x16x32_bf16 v[168:171], v[208:211], v[216:219], v[168:171]
    v_mfma_f32_16x16x32_bf16 v[172:175], v[212:215], v[216:219], v[172:175]
    s_waitcnt lgkmcnt(4)
    v_xor_b32 v208, 0x80008000, v200
    v_xor_b32 v209, 0x80008000, v201
    v_mfma_f32_16x16x32_bf16 v[160:163], v[184:187], v[220:223], v[160:163]
    v_xor_b32 v210, 0x80008000, v202
    v_xor_b32 v211, 0x80008000, v203
    v_mfma_f32_16x16x32_bf16 v[164:167], v[188:191], v[220:223], v[164:167]
    v_xor_b32 v212, 0x80008000, v204
    v_xor_b32 v213, 0x80008000, v205
    v_mfma_f32_16x16x32_bf16 v[168:171], v[176:179], v[220:223], v[168:171]
    v_xor_b32 v214, 0x80008000, v206
    v_xor_b32 v215, 0x80008000, v207
    v_mfma_f32_16x16x32_bf16 v[172:175], v[180:183], v[220:223], v[172:175]
    s_waitcnt lgkmcnt(2)
    v_mfma_f32_16x16x32_bf16 v[0:3], v[192:195], v[224:227], v[0:3]
    ds_read_b128 v[240:243], v250 offset:18432
    ds_read_b128 v[244:247], v250 offset:29184
    v_mfma_f32_16x16x32_bf16 v[4:7], v[196:199], v[224:227], v[4:7]
    v_mfma_f32_16x16x32_bf16 v[8:11], v[208:211], v[224:227], v[8:11]
    v_mfma_f32_16x16x32_bf16 v[12:15], v[212:215], v[224:227], v[12:15]
    v_mfma_f32_16x16x32_bf16 v[0:3], v[200:203], v[228:231], v[0:3]
    v_mfma_f32_16x16x32_bf16 v[4:7], v[204:207], v[228:231], v[4:7]
    v_mfma_f32_16x16x32_bf16 v[8:11], v[192:195], v[228:231], v[8:11]
    v_mfma_f32_16x16x32_bf16 v[12:15], v[196:199], v[228:231], v[12:15]
    s_waitcnt lgkmcnt(2)
    v_mfma_f32_16x16x32_bf16 v[16:19], v[192:195], v[232:235], v[16:19]
    ds_read_b128 v[216:219], v250 offset:19456
    ds_read_b128 v[220:223], v250 offset:30208
    v_mfma_f32_16x16x32_bf16 v[20:23], v[196:199], v[232:235], v[20:23]
    v_mfma_f32_16x16x32_bf16 v[24:27], v[208:211], v[232:235], v[24:27]
    v_mfma_f32_16x16x32_bf16 v[28:31], v[212:215], v[232:235], v[28:31]
    v_mfma_f32_16x16x32_bf16 v[16:19], v[200:203], v[236:239], v[16:19]
    v_mfma_f32_16x16x32_bf16 v[20:23], v[204:207], v[236:239], v[20:23]
    v_mfma_f32_16x16x32_bf16 v[24:27], v[192:195], v[236:239], v[24:27]
    v_mfma_f32_16x16x32_bf16 v[28:31], v[196:199], v[236:239], v[28:31]
    s_waitcnt lgkmcnt(2)
    v_mfma_f32_16x16x32_bf16 v[32:35], v[192:195], v[240:243], v[32:35]
    ds_read_b128 v[224:227], v250 offset:20480
    ds_read_b128 v[228:231], v250 offset:31232
    v_mfma_f32_16x16x32_bf16 v[36:39], v[196:199], v[240:243], v[36:39]
    v_mfma_f32_16x16x32_bf16 v[40:43], v[208:211], v[240:243], v[40:43]
    v_mfma_f32_16x16x32_bf16 v[44:47], v[212:215], v[240:243], v[44:47]
    v_mfma_f32_16x16x32_bf16 v[32:35], v[200:203], v[244:247], v[32:35]
    v_mfma_f32_16x16x32_bf16 v[36:39], v[204:207], v[244:247], v[36:39]
    v_mfma_f32_16x16x32_bf16 v[40:43], v[192:195], v[244:247], v[40:43]
    v_mfma_f32_16x16x32_bf16 v[44:47], v[196:199], v[244:247], v[44:47]
    s_waitcnt lgkmcnt(2)
    v_mfma_f32_16x16x32_bf16 v[48:51], v[192:195], v[216:219], v[48:51]
    ds_read_b128 v[232:235], v250 offset:21504
    ds_read_b128 v[236:239], v250 offset:32256
    v_mfma_f32_16x16x32_bf16 v[52:55], v[196:199], v[216:219], v[52:55]
    v_mfma_f32_16x16x32_bf16 v[56:59], v[208:211], v[216:219], v[56:59]
    v_mfma_f32_16x16x32_bf16 v[60:63], v[212:215], v[216:219], v[60:63]
    v_mfma_f32_16x16x32_bf16 v[48:51], v[200:203], v[220:223], v[48:51]
    v_mfma_f32_16x16x32_bf16 v[52:55], v[204:207], v[220:223], v[52:55]
    v_mfma_f32_16x16x32_bf16 v[56:59], v[192:195], v[220:223], v[56:59]
    v_mfma_f32_16x16x32_bf16 v[60:63], v[196:199], v[220:223], v[60:63]
    s_waitcnt lgkmcnt(2)
    v_mfma_f32_16x16x32_bf16 v[64:67], v[192:195], v[224:227], v[64:67]
    ds_read_b128 v[240:243], v250 offset:22528
    ds_read_b128 v[244:247], v250 offset:33280
    v_mfma_f32_16x16x32_bf16 v[68:71], v[196:199], v[224:227], v[68:71]
    v_mfma_f32_16x16x32_bf16 v[72:75], v[208:211], v[224:227], v[72:75]
    v_mfma_f32_16x16x32_bf16 v[76:79], v[212:215], v[224:227], v[76:79]
    v_mfma_f32_16x16x32_bf16 v[64:67], v[200:203], v[228:231], v[64:67]
    v_mfma_f32_16x16x32_bf16 v[68:71], v[204:207], v[228:231], v[68:71]
    v_mfma_f32_16x16x32_bf16 v[72:75], v[192:195], v[228:231], v[72:75]
    v_mfma_f32_16x16x32_bf16 v[76:79], v[196:199], v[228:231], v[76:79]
    s_waitcnt lgkmcnt(2)
    v_mfma_f32_16x16x32_bf16 v[80:83], v[192:195], v[232:235], v[80:83]
    ds_read_b128 v[216:219], v250 offset:23552
    ds_read_b128 v[220:223], v250 offset:34304
    v_mfma_f32_16x16x32_bf16 v[84:87], v[196:199], v[232:235], v[84:87]
    v_mfma_f32_16x16x32_bf16 v[88:91], v[208:211], v[232:235], v[88:91]
    v_mfma_f32_16x16x32_bf16 v[92:95], v[212:215], v[232:235], v[92:95]
    v_mfma_f32_16x16x32_bf16 v[80:83], v[200:203], v[236:239], v[80:83]
    v_mfma_f32_16x16x32_bf16 v[84:87], v[204:207], v[236:239], v[84:87]
    v_mfma_f32_16x16x32_bf16 v[88:91], v[192:195], v[236:239], v[88:91]
    v_mfma_f32_16x16x32_bf16 v[92:95], v[196:199], v[236:239], v[92:95]
    s_waitcnt lgkmcnt(2)
    v_mfma_f32_16x16x32_bf16 v[96:99], v[192:195], v[240:243], v[96:99]
    ds_read_b128 v[224:227], v250 offset:24576
    ds_read_b128 v[228:231], v250 offset:35328
    v_mfma_f32_16x16x32_bf16 v[100:103], v[196:199], v[240:243], v[100:103]
    v_mfma_f32_16x16x32_bf16 v[104:107], v[208:211], v[240:243], v[104:107]
    v_mfma_f32_16x16x32_bf16 v[108:111], v[212:215], v[240:243], v[108:111]
    v_mfma_f32_16x16x32_bf16 v[96:99], v[200:203], v[244:247], v[96:99]
    v_mfma_f32_16x16x32_bf16 v[100:103], v[204:207], v[244:247], v[100:103]
    v_mfma_f32_16x16x32_bf16 v[104:107], v[192:195], v[244:247], v[104:107]
    v_mfma_f32_16x16x32_bf16 v[108:111], v[196:199], v[244:247], v[108:111]
    s_waitcnt lgkmcnt(2)
    v_mfma_f32_16x16x32_bf16 v[112:115], v[192:195], v[216:219], v[112:115]
    ds_read_b128 v[232:235], v250 offset:25600
    ds_read_b128 v[236:239], v250 offset:36352
    v_mfma_f32_16x16x32_bf16 v[116:119], v[196:199], v[216:219], v[116:119]
    v_mfma_f32_16x16x32_bf16 v[120:123], v[208:211], v[216:219], v[120:123]
    v_mfma_f32_16x16x32_bf16 v[124:127], v[212:215], v[216:219], v[124:127]
    v_mfma_f32_16x16x32_bf16 v[112:115], v[200:203], v[220:223], v[112:115]
    v_mfma_f32_16x16x32_bf16 v[116:119], v[204:207], v[220:223], v[116:119]
    v_mfma_f32_16x16x32_bf16 v[120:123], v[192:195], v[220:223], v[120:123]
    v_mfma_f32_16x16x32_bf16 v[124:127], v[196:199], v[220:223], v[124:127]
    s_waitcnt lgkmcnt(2)
    v_mfma_f32_16x16x32_bf16 v[128:131], v[192:195], v[224:227], v[128:131]
    ds_read_b128 v[240:243], v250 offset:26624
    ds_read_b128 v[244:247], v250 offset:37376
    v_mfma_f32_16x16x32_bf16 v[132:135], v[196:199], v[224:227], v[132:135]
    v_mfma_f32_16x16x32_bf16 v[136:139], v[208:211], v[224:227], v[136:139]
    v_mfma_f32_16x16x32_bf16 v[140:143], v[212:215], v[224:227], v[140:143]
    v_mfma_f32_16x16x32_bf16 v[128:131], v[200:203], v[228:231], v[128:131]
    v_mfma_f32_16x16x32_bf16 v[132:135], v[204:207], v[228:231], v[132:135]
    v_mfma_f32_16x16x32_bf16 v[136:139], v[192:195], v[228:231], v[136:139]
    v_mfma_f32_16x16x32_bf16 v[140:143], v[196:199], v[228:231], v[140:143]
    s_waitcnt lgkmcnt(2)
    v_mfma_f32_16x16x32_bf16 v[144:147], v[192:195], v[232:235], v[144:147]
    v_mfma_f32_16x16x32_bf16 v[148:151], v[196:199], v[232:235], v[148:151]
    v_mfma_f32_16x16x32_bf16 v[152:155], v[208:211], v[232:235], v[152:155]
    v_mfma_f32_16x16x32_bf16 v[156:159], v[212:215], v[232:235], v[156:159]
    v_mfma_f32_16x16x32_bf16 v[144:147], v[200:203], v[236:239], v[144:147]
    v_mfma_f32_16x16x32_bf16 v[148:151], v[204:207], v[236:239], v[148:151]
    v_mfma_f32_16x16x32_bf16 v[152:155], v[192:195], v[236:239], v[152:155]
    v_mfma_f32_16x16x32_bf16 v[156:159], v[196:199], v[236:239], v[156:159]
    s_waitcnt lgkmcnt(0)
    v_mfma_f32_16x16x32_bf16 v[160:163], v[192:195], v[240:243], v[160:163]
    v_mfma_f32_16x16x32_bf16 v[164:167], v[196:199], v[240:243], v[164:167]
    v_mfma_f32_16x16x32_bf16 v[168:171], v[208:211], v[240:243], v[168:171]
    v_mfma_f32_16x16x32_bf16 v[172:175], v[212:215], v[240:243], v[172:175]
    v_mfma_f32_16x16x32_bf16 v[160:163], v[200:203], v[244:247], v[160:163]
    v_mfma_f32_16x16x32_bf16 v[164:167], v[204:207], v[244:247], v[164:167]
    v_mfma_f32_16x16x32_bf16 v[168:171], v[192:195], v[244:247], v[168:171]
    v_mfma_f32_16x16x32_bf16 v[172:175], v[196:199], v[244:247], v[172:175]
    s_nop 7
    v_cvt_pk_bf16_f32 v0, v0, v1
    v_cvt_pk_bf16_f32 v1, v2, v3
    v_cvt_pk_bf16_f32 v2, v4, v5
    v_cvt_pk_bf16_f32 v3, v6, v7
    s_add_u32 s47, s48, 0
    buffer_store_dwordx4 v[0:3], v251, s[16:19], s47 offen sc1
    v_cvt_pk_bf16_f32 v8, v8, v9
    v_cvt_pk_bf16_f32 v9, v10, v11
    v_cvt_pk_bf16_f32 v10, v12, v13
    v_cvt_pk_bf16_f32 v11, v14, v15
    s_add_u32 s47, s48, 1024
    buffer_store_dwordx4 v[8:11], v251, s[16:19], s47 offen sc1
    v_cvt_pk_bf16_f32 v16, v16, v17
    v_cvt_pk_bf16_f32 v17, v18, v19
    v_cvt_pk_bf16_f32 v18, v20, v21
    v_cvt_pk_bf16_f32 v19, v22, v23
    s_add_u32 s47, s48, 1052672
    buffer_store_dwordx4 v[16:19], v251, s[16:19], s47 offen sc1
    v_cvt_pk_bf16_f32 v24, v24, v25
    v_cvt_pk_bf16_f32 v25, v26, v27
    v_cvt_pk_bf16_f32 v26, v28, v29
    v_cvt_pk_bf16_f32 v27, v30, v31
    s_add_u32 s47, s48, 1053696
    buffer_store_dwordx4 v[24:27], v251, s[16:19], s47 offen sc1
    v_cvt_pk_bf16_f32 v32, v32, v33
    v_cvt_pk_bf16_f32 v33, v34, v35
    v_cvt_pk_bf16_f32 v34, v36, v37
    v_cvt_pk_bf16_f32 v35, v38, v39
    s_add_u32 s47, s48, 2105344
    buffer_store_dwordx4 v[32:35], v251, s[16:19], s47 offen sc1
    v_cvt_pk_bf16_f32 v40, v40, v41
    v_cvt_pk_bf16_f32 v41, v42, v43
    v_cvt_pk_bf16_f32 v42, v44, v45
    v_cvt_pk_bf16_f32 v43, v46, v47
    s_add_u32 s47, s48, 2106368
    buffer_store_dwordx4 v[40:43], v251, s[16:19], s47 offen sc1
    v_cvt_pk_bf16_f32 v48, v48, v49
    v_cvt_pk_bf16_f32 v49, v50, v51
    v_cvt_pk_bf16_f32 v50, v52, v53
    v_cvt_pk_bf16_f32 v51, v54, v55
    s_add_u32 s47, s48, 3158016
    buffer_store_dwordx4 v[48:51], v251, s[16:19], s47 offen sc1
    v_cvt_pk_bf16_f32 v56, v56, v57
    v_cvt_pk_bf16_f32 v57, v58, v59
    v_cvt_pk_bf16_f32 v58, v60, v61
    v_cvt_pk_bf16_f32 v59, v62, v63
    s_add_u32 s47, s48, 3159040
    buffer_store_dwordx4 v[56:59], v251, s[16:19], s47 offen sc1
    v_cvt_pk_bf16_f32 v64, v64, v65
    v_cvt_pk_bf16_f32 v65, v66, v67
    v_cvt_pk_bf16_f32 v66, v68, v69
    v_cvt_pk_bf16_f32 v67, v70, v71
    s_add_u32 s47, s48, 4210688
    buffer_store_dwordx4 v[64:67], v251, s[16:19], s47 offen sc1
    v_cvt_pk_bf16_f32 v72, v72, v73
    v_cvt_pk_bf16_f32 v73, v74, v75
    v_cvt_pk_bf16_f32 v74, v76, v77
    v_cvt_pk_bf16_f32 v75, v78, v79
    s_add_u32 s47, s48, 4211712
    buffer_store_dwordx4 v[72:75], v251, s[16:19], s47 offen sc1
    v_cvt_pk_bf16_f32 v80, v80, v81
    v_cvt_pk_bf16_f32 v81, v82, v83
    v_cvt_pk_bf16_f32 v82, v84, v85
    v_cvt_pk_bf16_f32 v83, v86, v87
    s_add_u32 s47, s48, 5263360
    buffer_store_dwordx4 v[80:83], v251, s[16:19], s47 offen sc1
    v_cvt_pk_bf16_f32 v88, v88, v89
    v_cvt_pk_bf16_f32 v89, v90, v91
    v_cvt_pk_bf16_f32 v90, v92, v93
    v_cvt_pk_bf16_f32 v91, v94, v95
    s_add_u32 s47, s48, 5264384
    buffer_store_dwordx4 v[88:91], v251, s[16:19], s47 offen sc1
    v_cvt_pk_bf16_f32 v96, v96, v97
    v_cvt_pk_bf16_f32 v97, v98, v99
    v_cvt_pk_bf16_f32 v98, v100, v101
    v_cvt_pk_bf16_f32 v99, v102, v103
    s_add_u32 s47, s48, 6316032
    buffer_store_dwordx4 v[96:99], v251, s[16:19], s47 offen sc1
    v_cvt_pk_bf16_f32 v104, v104, v105
    v_cvt_pk_bf16_f32 v105, v106, v107
    v_cvt_pk_bf16_f32 v106, v108, v109
    v_cvt_pk_bf16_f32 v107, v110, v111
    s_add_u32 s47, s48, 6317056
    buffer_store_dwordx4 v[104:107], v251, s[16:19], s47 offen sc1
    v_cvt_pk_bf16_f32 v112, v112, v113
    v_cvt_pk_bf16_f32 v113, v114, v115
    v_cvt_pk_bf16_f32 v114, v116, v117
    v_cvt_pk_bf16_f32 v115, v118, v119
    s_add_u32 s47, s48, 7368704
    buffer_store_dwordx4 v[112:115], v251, s[16:19], s47 offen sc1
    v_cvt_pk_bf16_f32 v120, v120, v121
    v_cvt_pk_bf16_f32 v121, v122, v123
    v_cvt_pk_bf16_f32 v122, v124, v125
    v_cvt_pk_bf16_f32 v123, v126, v127
    s_add_u32 s47, s48, 7369728
    buffer_store_dwordx4 v[120:123], v251, s[16:19], s47 offen sc1
    v_cvt_pk_bf16_f32 v128, v128, v129
    v_cvt_pk_bf16_f32 v129, v130, v131
    v_cvt_pk_bf16_f32 v130, v132, v133
    v_cvt_pk_bf16_f32 v131, v134, v135
    s_add_u32 s47, s48, 8421376
    buffer_store_dwordx4 v[128:131], v251, s[16:19], s47 offen sc1
    v_cvt_pk_bf16_f32 v136, v136, v137
    v_cvt_pk_bf16_f32 v137, v138, v139
    v_cvt_pk_bf16_f32 v138, v140, v141
    v_cvt_pk_bf16_f32 v139, v142, v143
    s_add_u32 s47, s48, 8422400
    buffer_store_dwordx4 v[136:139], v251, s[16:19], s47 offen sc1
    v_cvt_pk_bf16_f32 v144, v144, v145
    v_cvt_pk_bf16_f32 v145, v146, v147
    v_cvt_pk_bf16_f32 v146, v148, v149
    v_cvt_pk_bf16_f32 v147, v150, v151
    s_add_u32 s47, s48, 9474048
    buffer_store_dwordx4 v[144:147], v251, s[16:19], s47 offen sc1
    v_cvt_pk_bf16_f32 v152, v152, v153
    v_cvt_pk_bf16_f32 v153, v154, v155
    v_cvt_pk_bf16_f32 v154, v156, v157
    v_cvt_pk_bf16_f32 v155, v158, v159
    s_add_u32 s47, s48, 9475072
    buffer_store_dwordx4 v[152:155], v251, s[16:19], s47 offen sc1
    v_cvt_pk_bf16_f32 v160, v160, v161
    v_cvt_pk_bf16_f32 v161, v162, v163
    v_cvt_pk_bf16_f32 v162, v164, v165
    v_cvt_pk_bf16_f32 v163, v166, v167
    s_add_u32 s47, s48, 10526720
    buffer_store_dwordx4 v[160:163], v252, s[16:19], s47 offen sc1
    v_cvt_pk_bf16_f32 v168, v168, v169
    v_cvt_pk_bf16_f32 v169, v170, v171
    v_cvt_pk_bf16_f32 v170, v172, v173
    v_cvt_pk_bf16_f32 v171, v174, v175
    s_add_u32 s47, s48, 10527744
    buffer_store_dwordx4 v[168:171], v252, s[16:19], s47 offen sc1
    s_endpgm
L_k3_helper:
    s_mul_i32 s40, s11, 16384
    s_mul_i32 s20, s14, 16777216
    s_add_u32 s40, s40, s20
    s_mul_i32 s41, s11, 21504
    s_mul_i32 s20, s13, 22020096
    s_add_u32 s41, s41, s20
    s_add_u32 s41, s41, 67108864
    s_lshl_b32 s42, s15, 12
    s_mul_i32 s43, s15, 5376
    v_lshlrev_b32 v1, 4, v0
    v_add_u32 v2, s43, v1
    v_add_u32 v1, s42, v1
    s_add_u32 s43, s43, 16384
    s_cmp_ge_u32 s2, 8
    s_cbranch_scc1 L_nozero
    s_cmp_lg_u32 s15, 0
    s_cbranch_scc1 L_nozero
    s_mul_i32 s20, s2, 8448
    s_add_u32 s20, s20, 147849216
    v_mov_b32 v3, 0
    v_lshlrev_b32 v4, 2, v0
    buffer_store_dword v3, v4, s[16:19], s20 offen
L_nozero:
    s_add_u32 m0, s42, 0
    s_nop 0
    buffer_load_dwordx4 v1, s[16:19], s40 offen offset:0 lds
    buffer_load_dwordx4 v1, s[16:19], s40 offen offset:1024 lds
    buffer_load_dwordx4 v1, s[16:19], s40 offen offset:2048 lds
    buffer_load_dwordx4 v1, s[16:19], s40 offen offset:3072 lds
    s_add_u32 s40, s40, 524288
    s_add_u32 m0, s43, 0
    s_nop 0
    buffer_load_dwordx4 v2, s[16:19], s41 offen offset:0 lds
    buffer_load_dwordx4 v2, s[16:19], s41 offen offset:1024 lds
    buffer_load_dwordx4 v2, s[16:19], s41 offen offset:2048 lds
    buffer_load_dwordx4 v2, s[16:19], s41 offen offset:3072 lds
    s_add_u32 m0, s43, 4096
    s_add_u32 s49, s41, 4096
    buffer_load_dwordx4 v2, s[16:19], s49 offen lds
    s_mov_b64 exec, 0xffff
    buffer_load_dwordx4 v2, s[16:19], s49 offen offset:1024 lds
    s_mov_b64 exec, -1
    s_add_u32 s41, s41, 688128
    s_add_u32 m0, s42, 37888
    s_nop 0
    buffer_load_dwordx4 v1, s[16:19], s40 offen offset:0 lds
    buffer_load_dwordx4 v1, s[16:19], s40 offen offset:1024 lds
    buffer_load_dwordx4 v1, s[16:19], s40 offen offset:2048 lds
    buffer_load_dwordx4 v1, s[16:19], s40 offen offset:3072 lds
    s_add_u32 s40, s40, 524288
    s_add_u32 m0, s43, 37888
    s_nop 0
    buffer_load_dwordx4 v2, s[16:19], s41 offen offset:0 lds
    buffer_load_dwordx4 v2, s[16:19], s41 offen offset:1024 lds
    buffer_load_dwordx4 v2, s[16:19], s41 offen offset:2048 lds
    buffer_load_dwordx4 v2, s[16:19], s41 offen offset:3072 lds
    s_add_u32 m0, s43, 41984
    s_add_u32 s49, s41, 4096
    buffer_load_dwordx4 v2, s[16:19], s49 offen lds
    s_mov_b64 exec, 0xffff
    buffer_load_dwordx4 v2, s[16:19], s49 offen offset:1024 lds
    s_mov_b64 exec, -1
    s_add_u32 s41, s41, 688128
    s_add_u32 m0, s42, 75776
    s_nop 0
    buffer_load_dwordx4 v1, s[16:19], s40 offen offset:0 lds
    buffer_load_dwordx4 v1, s[16:19], s40 offen offset:1024 lds
    buffer_load_dwordx4 v1, s[16:19], s40 offen offset:2048 lds
    buffer_load_dwordx4 v1, s[16:19], s40 offen offset:3072 lds
    s_add_u32 s40, s40, 524288
    s_add_u32 m0, s43, 75776
    s_nop 0
    buffer_load_dwordx4 v2, s[16:19], s41 offen offset:0 lds
    buffer_load_dwordx4 v2, s[16:19], s41 offen offset:1024 lds
    buffer_load_dwordx4 v2, s[16:19], s41 offen offset:2048 lds
    buffer_load_dwordx4 v2, s[16:19], s41 offen offset:3072 lds
    s_add_u32 m0, s43, 79872
    s_add_u32 s49, s41, 4096
    buffer_load_dwordx4 v2, s[16:19], s49 offen lds
    s_mov_b64 exec, 0xffff
    buffer_load_dwordx4 v2, s[16:19], s49 offen offset:1024 lds
    s_mov_b64 exec, -1
    s_add_u32 s41, s41, 688128
    s_waitcnt vmcnt(20)
    s_barrier
    s_mov_b32 s46, 7
L_h_loop:
    s_waitcnt vmcnt(10)
    s_barrier
    s_add_u32 m0, s42, 113664
    s_nop 0
    buffer_load_dwordx4 v1, s[16:19], s40 offen offset:0 lds
    buffer_load_dwordx4 v1, s[16:19], s40 offen offset:1024 lds
    buffer_load_dwordx4 v1, s[16:19], s40 offen offset:2048 lds
    buffer_load_dwordx4 v1, s[16:19], s40 offen offset:3072 lds
    s_add_u32 s40, s40, 524288
    s_add_u32 m0, s43, 113664
    s_nop 0
    buffer_load_dwordx4 v2, s[16:19], s41 offen offset:0 lds
    buffer_load_dwordx4 v2, s[16:19], s41 offen offset:1024 lds
    buffer_load_dwordx4 v2, s[16:19], s41 offen offset:2048 lds
    buffer_load_dwordx4 v2, s[16:19], s41 offen offset:3072 lds
    s_add_u32 m0, s43, 117760
    s_add_u32 s49, s41, 4096
    buffer_load_dwordx4 v2, s[16:19], s49 offen lds
    s_mov_b64 exec, 0xffff
    buffer_load_dwordx4 v2, s[16:19], s49 offen offset:1024 lds
    s_mov_b64 exec, -1
    s_add_u32 s41, s41, 688128
    s_waitcnt vmcnt(10)
    s_barrier
    s_add_u32 m0, s42, 0
    s_nop 0
    buffer_load_dwordx4 v1, s[16:19], s40 offen offset:0 lds
    buffer_load_dwordx4 v1, s[16:19], s40 offen offset:1024 lds
    buffer_load_dwordx4 v1, s[16:19], s40 offen offset:2048 lds
    buffer_load_dwordx4 v1, s[16:19], s40 offen offset:3072 lds
    s_add_u32 s40, s40, 524288
    s_add_u32 m0, s43, 0
    s_nop 0
    buffer_load_dwordx4 v2, s[16:19], s41 offen offset:0 lds
    buffer_load_dwordx4 v2, s[16:19], s41 offen offset:1024 lds
    buffer_load_dwordx4 v2, s[16:19], s41 offen offset:2048 lds
    buffer_load_dwordx4 v2, s[16:19], s41 offen offset:3072 lds
    s_add_u32 m0, s43, 4096
    s_add_u32 s49, s41, 4096
    buffer_load_dwordx4 v2, s[16:19], s49 offen lds
    s_mov_b64 exec, 0xffff
    buffer_load_dwordx4 v2, s[16:19], s49 offen offset:1024 lds
    s_mov_b64 exec, -1
    s_add_u32 s41, s41, 688128
    s_waitcnt vmcnt(10)
    s_barrier
    s_add_u32 m0, s42, 37888
    s_nop 0
    buffer_load_dwordx4 v1, s[16:19], s40 offen offset:0 lds
    buffer_load_dwordx4 v1, s[16:19], s40 offen offset:1024 lds
    buffer_load_dwordx4 v1, s[16:19], s40 offen offset:2048 lds
    buffer_load_dwordx4 v1, s[16:19], s40 offen offset:3072 lds
    s_add_u32 s40, s40, 524288
    s_add_u32 m0, s43, 37888
    s_nop 0
    buffer_load_dwordx4 v2, s[16:19], s41 offen offset:0 lds
    buffer_load_dwordx4 v2, s[16:19], s41 offen offset:1024 lds
    buffer_load_dwordx4 v2, s[16:19], s41 offen offset:2048 lds
    buffer_load_dwordx4 v2, s[16:19], s41 offen offset:3072 lds
    s_add_u32 m0, s43, 41984
    s_add_u32 s49, s41, 4096
    buffer_load_dwordx4 v2, s[16:19], s49 offen lds
    s_mov_b64 exec, 0xffff
    buffer_load_dwordx4 v2, s[16:19], s49 offen offset:1024 lds
    s_mov_b64 exec, -1
    s_add_u32 s41, s41, 688128
    s_waitcnt vmcnt(10)
    s_barrier
    s_add_u32 m0, s42, 75776
    s_nop 0
    buffer_load_dwordx4 v1, s[16:19], s40 offen offset:0 lds
    buffer_load_dwordx4 v1, s[16:19], s40 offen offset:1024 lds
    buffer_load_dwordx4 v1, s[16:19], s40 offen offset:2048 lds
    buffer_load_dwordx4 v1, s[16:19], s40 offen offset:3072 lds
    s_add_u32 s40, s40, 524288
    s_add_u32 m0, s43, 75776
    s_nop 0
    buffer_load_dwordx4 v2, s[16:19], s41 offen offset:0 lds
    buffer_load_dwordx4 v2, s[16:19], s41 offen offset:1024 lds
    buffer_load_dwordx4 v2, s[16:19], s41 offen offset:2048 lds
    buffer_load_dwordx4 v2, s[16:19], s41 offen offset:3072 lds
    s_add_u32 m0, s43, 79872
    s_add_u32 s49, s41, 4096
    buffer_load_dwordx4 v2, s[16:19], s49 offen lds
    s_mov_b64 exec, 0xffff
    buffer_load_dwordx4 v2, s[16:19], s49 offen offset:1024 lds
    s_mov_b64 exec, -1
    s_add_u32 s41, s41, 688128
    s_sub_u32 s46, s46, 1
    s_cmp_lg_u32 s46, 0
    s_cbranch_scc1 L_h_loop
    s_waitcnt vmcnt(10)
    s_barrier
    s_add_u32 m0, s42, 113664
    s_nop 0
    buffer_load_dwordx4 v1, s[16:19], s40 offen offset:0 lds
    buffer_load_dwordx4 v1, s[16:19], s40 offen offset:1024 lds
    buffer_load_dwordx4 v1, s[16:19], s40 offen offset:2048 lds
    buffer_load_dwordx4 v1, s[16:19], s40 offen offset:3072 lds
    s_add_u32 s40, s40, 524288
    s_add_u32 m0, s43, 113664
    s_nop 0
    buffer_load_dwordx4 v2, s[16:19], s41 offen offset:0 lds
    buffer_load_dwordx4 v2, s[16:19], s41 offen offset:1024 lds
    buffer_load_dwordx4 v2, s[16:19], s41 offen offset:2048 lds
    buffer_load_dwordx4 v2, s[16:19], s41 offen offset:3072 lds
    s_add_u32 m0, s43, 117760
    s_add_u32 s49, s41, 4096
    buffer_load_dwordx4 v2, s[16:19], s49 offen lds
    s_mov_b64 exec, 0xffff
    buffer_load_dwordx4 v2, s[16:19], s49 offen offset:1024 lds
    s_mov_b64 exec, -1
    s_add_u32 s41, s41, 688128
    s_waitcnt vmcnt(10)
    s_barrier
    s_waitcnt vmcnt(0)
    s_barrier
    s_endpgm
L_k3_end:
    s_endpgm
.globl final_kernel
.p2align 8
.type final_kernel,@function
final_kernel:
    s_cmp_ge_u32 s2, 224
    s_cbranch_scc1 L_k45_end
    s_load_dwordx4 s[4:7], s[0:1], 16
    s_load_dwordx2 s[8:9], s[0:1], 48
    s_load_dwordx2 s[28:29], s[0:1], 32
    v_lshlrev_b32 v214, 2, v0
    v_and_b32 v200, 63, v0
    v_lshrrev_b32 v204, 6, v0
    v_and_b32 v201, 15, v200
    v_readfirstlane_b32 s10, v204
    v_lshrrev_b32 v202, 4, v200
    s_mov_b32 s30, 0x05040100
    s_mov_b32 s31, 0x07060302
    s_and_b32 s13, s2, 3
    s_lshr_b32 s12, s2, 2
    s_cmp_ge_u32 s12, 28
    s_cselect_b32 s11, 1, 0
    s_mul_i32 s15, s11, 28
    s_sub_u32 s12, s12, s15
    s_mul_i32 s14, s12, 6
    s_add_u32 s14, s14, s10
    s_waitcnt lgkmcnt(0)
    s_mov_b32 s16, s8
    s_and_b32 s17, s9, 0xffff
    s_mov_b32 s18, 268435456
    s_mov_b32 s19, 0x00020000
    s_mov_b32 s24, 8192
    v_mul_u32_u24 v203, s24, v202
    v_lshl_add_u32 v203, v201, 4, v203
    s_mul_i32 s24, s11, 11579392
    s_mul_i32 s25, s14, 65792
    s_add_u32 s24, s24, s25
    s_lshl_b32 s25, s13, 8
    s_add_u32 s24, s24, s25
    s_add_u32 s24, s24, 117440512
    s_add_u32 s25, s24, 0
    buffer_load_dwordx4 v[0:3], v203, s[16:19], s25 offen
    s_add_u32 s25, s24, 1024
    buffer_load_dwordx4 v[4:7], v203, s[16:19], s25 offen
    s_add_u32 s25, s24, 2048
    buffer_load_dwordx4 v[8:11], v203, s[16:19], s25 offen
    s_add_u32 s25, s24, 3072
    buffer_load_dwordx4 v[12:15], v203, s[16:19], s25 offen
    s_add_u32 s25, s24, 4096
    buffer_load_dwordx4 v[16:19], v203, s[16:19], s25 offen
    s_add_u32 s25, s24, 5120
    buffer_load_dwordx4 v[20:23], v203, s[16:19], s25 offen
    s_add_u32 s25, s24, 6144
    buffer_load_dwordx4 v[24:27], v203, s[16:19], s25 offen
    s_add_u32 s25, s24, 7168
    buffer_load_dwordx4 v[28:31], v203, s[16:19], s25 offen
    s_add_u32 s25, s24, 32768
    buffer_load_dwordx4 v[32:35], v203, s[16:19], s25 offen
    s_add_u32 s25, s24, 33792
    buffer_load_dwordx4 v[36:39], v203, s[16:19], s25 offen
    s_add_u32 s25, s24, 34816
    buffer_load_dwordx4 v[40:43], v203, s[16:19], s25 offen
    s_add_u32 s25, s24, 35840
    buffer_load_dwordx4 v[44:47], v203, s[16:19], s25 offen
    s_add_u32 s25, s24, 36864
    buffer_load_dwordx4 v[48:51], v203, s[16:19], s25 offen
    s_add_u32 s25, s24, 37888
    buffer_load_dwordx4 v[52:55], v203, s[16:19], s25 offen
    s_add_u32 s25, s24, 38912
    buffer_load_dwordx4 v[56:59], v203, s[16:19], s25 offen
    s_add_u32 s25, s24, 39936
    buffer_load_dwordx4 v[60:63], v203, s[16:19], s25 offen
    s_cmp_ge_u32 s10, 3
    s_cbranch_scc1 L_k45_notab
    s_lshl_b32 s25, s10, 4
    v_add_u32 v204, s25, v201
    v_lshlrev_b32 v205, 3, v202
    v_add_u32 v205, 1, v205
    v_mul_u32_u24 v88, v205, v204
    v_add_u32 v89, 32, v88
    v_add_u32 v205, 2, v205
    v_mul_u32_u24 v90, v205, v204
    v_add_u32 v91, 32, v90
    v_add_u32 v205, 2, v205
    v_mul_u32_u24 v92, v205, v204
    v_add_u32 v93, 32, v92
    v_add_u32 v205, 2, v205
    v_mul_u32_u24 v94, v205, v204
    v_add_u32 v95, 32, v94
    v_and_b32 v88, 127, v88
    v_cvt_f32_u32 v88, v88
    v_mul_f32 v88, 0x3c000000, v88
    v_cos_f32 v88, v88
    v_and_b32 v89, 127, v89
    v_cvt_f32_u32 v89, v89
    v_mul_f32 v89, 0x3c000000, v89
    v_cos_f32 v89, v89
    v_and_b32 v90, 127, v90
    v_cvt_f32_u32 v90, v90
    v_mul_f32 v90, 0x3c000000, v90
    v_cos_f32 v90, v90
    v_and_b32 v91, 127, v91
    v_cvt_f32_u32 v91, v91
    v_mul_f32 v91, 0x3c000000, v91
    v_cos_f32 v91, v91
    v_and_b32 v92, 127, v92
    v_cvt_f32_u32 v92, v92
    v_mul_f32 v92, 0x3c000000, v92
    v_cos_f32 v92, v92
    v_and_b32 v93, 127, v93
    v_cvt_f32_u32 v93, v93
    v_mul_f32 v93, 0x3c000000, v93
    v_cos_f32 v93, v93
    v_and_b32 v94, 127, v94
    v_cvt_f32_u32 v94, v94
    v_mul_f32 v94, 0x3c000000, v94
    v_cos_f32 v94, v94
    v_and_b32 v95, 127, v95
    v_cvt_f32_u32 v95, v95
    v_mul_f32 v95, 0x3c000000, v95
    v_cos_f32 v95, v95
    v_mul_f32 v88, 0x3d000000, v88
    v_mul_f32 v89, 0x3d000000, v89
    v_mul_f32 v90, 0x3d000000, v90
    v_mul_f32 v91, 0x3d000000, v91
    v_mul_f32 v92, 0x3d000000, v92
    v_mul_f32 v93, 0x3d000000, v93
    v_mul_f32 v94, 0x3d000000, v94
    v_mul_f32 v95, 0x3d000000, v95
    v_cvt_pk_bf16_f32 v104, v88, v89
    v_cvt_pk_bf16_f32 v105, v90, v91
    v_cvt_pk_bf16_f32 v106, v92, v93
    v_cvt_pk_bf16_f32 v107, v94, v95
    s_lshl_b32 s25, s10, 11
    v_lshlrev_b32 v207, 4, v200
    v_add_u32 v207, s25, v207
    ds_write_b128 v207, v[104:107] offset:0
    v_lshlrev_b32 v205, 3, v202
    v_add_u32 v205, 33, v205
    v_mul_u32_u24 v88, v205, v204
    v_add_u32 v89, 32, v88
    v_add_u32 v205, 2, v205
    v_mul_u32_u24 v90, v205, v204
    v_add_u32 v91, 32, v90
    v_add_u32 v205, 2, v205
    v_mul_u32_u24 v92, v205, v204
    v_add_u32 v93, 32, v92
    v_add_u32 v205, 2, v205
    v_mul_u32_u24 v94, v205, v204
    v_add_u32 v95, 32, v94
    v_and_b32 v88, 127, v88
    v_cvt_f32_u32 v88, v88
    v_mul_f32 v88, 0x3c000000, v88
    v_cos_f32 v88, v88
    v_and_b32 v89, 127, v89
    v_cvt_f32_u32 v89, v89
    v_mul_f32 v89, 0x3c000000, v89
    v_cos_f32 v89, v89
    v_and_b32 v90, 127, v90
    v_cvt_f32_u32 v90, v90
    v_mul_f32 v90, 0x3c000000, v90
    v_cos_f32 v90, v90
    v_and_b32 v91, 127, v91
    v_cvt_f32_u32 v91, v91
    v_mul_f32 v91, 0x3c000000, v91
    v_cos_f32 v91, v91
    v_and_b32 v92, 127, v92
    v_cvt_f32_u32 v92, v92
    v_mul_f32 v92, 0x3c000000, v92
    v_cos_f32 v92, v92
    v_and_b32 v93, 127, v93
    v_cvt_f32_u32 v93, v93
    v_mul_f32 v93, 0x3c000000, v93
    v_cos_f32 v93, v93
    v_and_b32 v94, 127, v94
    v_cvt_f32_u32 v94, v94
    v_mul_f32 v94, 0x3c000000, v94
    v_cos_f32 v94, v94
    v_and_b32 v95, 127, v95
    v_cvt_f32_u32 v95, v95
    v_mul_f32 v95, 0x3c000000, v95
    v_cos_f32 v95, v95
    v_mul_f32 v88, 0x3d000000, v88
    v_mul_f32 v89, 0x3d000000, v89
    v_mul_f32 v90, 0x3d000000, v90
    v_mul_f32 v91, 0x3d000000, v91
    v_mul_f32 v92, 0x3d000000, v92
    v_mul_f32 v93, 0x3d000000, v93
    v_mul_f32 v94, 0x3d000000, v94
    v_mul_f32 v95, 0x3d000000, v95
    v_cvt_pk_bf16_f32 v104, v88, v89
    v_cvt_pk_bf16_f32 v105, v90, v91
    v_cvt_pk_bf16_f32 v106, v92, v93
    v_cvt_pk_bf16_f32 v107, v94, v95
    s_lshl_b32 s25, s10, 11
    v_lshlrev_b32 v207, 4, v200
    v_add_u32 v207, s25, v207
    ds_write_b128 v207, v[104:107] offset:1024
L_k45_notab:
    s_mov_b32 s20, s4
    s_and_b32 s21, s5, 0xffff
    s_mov_b32 s22, 1024
    s_mov_b32 s23, 0x00020000
    s_mov_b32 s36, s6
    s_and_b32 s37, s7, 0xffff
    s_mov_b32 s38, 1024
    s_mov_b32 s39, 0x00020000
    v_lshlrev_b32 v210, 4, v201
    s_lshl_b32 s25, s13, 8
    buffer_load_dwordx4 v[232:235], v210, s[20:23], s25 offen
    buffer_load_dwordx4 v[236:239], v210, s[36:39], s25 offen
    s_waitcnt lgkmcnt(0)
    s_barrier
    v_lshlrev_b32 v207, 4, v200
    ds_read_b128 v[64:67], v207 offset:0
    ds_read_b128 v[68:71], v207 offset:1024
    ds_read_b128 v[72:75], v207 offset:2048
    ds_read_b128 v[76:79], v207 offset:3072
    ds_read_b128 v[80:83], v207 offset:4096
    ds_read_b128 v[84:87], v207 offset:5120
    s_cmp_ge_u32 s14, 167
    s_cbranch_scc1 L_k45_zero
    s_waitcnt lgkmcnt(0)
    s_cmp_lg_u32 s14, 166
    s_cbranch_scc1 L_k45_full
    v_cmp_gt_i32 vcc, 17, v201
    s_nop 1
    v_cndmask_b32 v64, 0, v64, vcc
    v_cndmask_b32 v65, 0, v65, vcc
    v_cndmask_b32 v66, 0, v66, vcc
    v_cndmask_b32 v67, 0, v67, vcc
    v_cndmask_b32 v68, 0, v68, vcc
    v_cndmask_b32 v69, 0, v69, vcc
    v_cndmask_b32 v70, 0, v70, vcc
    v_cndmask_b32 v71, 0, v71, vcc
    v_cmp_gt_i32 vcc, 1, v201
    s_nop 1
    v_cndmask_b32 v72, 0, v72, vcc
    v_cndmask_b32 v73, 0, v73, vcc
    v_cndmask_b32 v74, 0, v74, vcc
    v_cndmask_b32 v75, 0, v75, vcc
    v_cndmask_b32 v76, 0, v76, vcc
    v_cndmask_b32 v77, 0, v77, vcc
    v_cndmask_b32 v78, 0, v78, vcc
    v_cndmask_b32 v79, 0, v79, vcc
    v_cmp_gt_i32 vcc, 0, v201
    s_nop 1
    v_cndmask_b32 v80, 0, v80, vcc
    v_cndmask_b32 v81, 0, v81, vcc
    v_cndmask_b32 v82, 0, v82, vcc
    v_cndmask_b32 v83, 0, v83, vcc
    v_cndmask_b32 v84, 0, v84, vcc
    v_cndmask_b32 v85, 0, v85, vcc
    v_cndmask_b32 v86, 0, v86, vcc
    v_cndmask_b32 v87, 0, v87, vcc
L_k45_full:
    s_waitcnt vmcnt(2)
    v_perm_b32 v88, v4, v0, s30
    v_perm_b32 v89, v12, v8, s30
    v_perm_b32 v90, v20, v16, s30
    v_perm_b32 v91, v28, v24, s30
    v_perm_b32 v92, v4, v0, s31
    v_perm_b32 v93, v12, v8, s31
    v_perm_b32 v94, v20, v16, s31
    v_perm_b32 v95, v28, v24, s31
    v_perm_b32 v96, v36, v32, s30
    v_perm_b32 v97, v44, v40, s30
    v_perm_b32 v98, v52, v48, s30
    v_perm_b32 v99, v60, v56, s30
    v_perm_b32 v100, v36, v32, s31
    v_perm_b32 v101, v44, v40, s31
    v_perm_b32 v102, v52, v48, s31
    v_perm_b32 v103, v60, v56, s31
    v_mfma_f32_16x16x32_bf16 v[104:107], v[64:67], v[88:91], 0
    v_mfma_f32_16x16x32_bf16 v[108:111], v[64:67], v[92:95], 0
    v_mfma_f32_16x16x32_bf16 v[136:139], v[72:75], v[88:91], 0
    v_mfma_f32_16x16x32_bf16 v[140:143], v[72:75], v[92:95], 0
    v_mfma_f32_16x16x32_bf16 v[168:171], v[80:83], v[88:91], 0
    v_mfma_f32_16x16x32_bf16 v[172:175], v[80:83], v[92:95], 0
    v_mfma_f32_16x16x32_bf16 v[104:107], v[68:71], v[96:99], v[104:107]
    v_mfma_f32_16x16x32_bf16 v[108:111], v[68:71], v[100:103], v[108:111]
    v_mfma_f32_16x16x32_bf16 v[136:139], v[76:79], v[96:99], v[136:139]
    v_mfma_f32_16x16x32_bf16 v[140:143], v[76:79], v[100:103], v[140:143]
    v_mfma_f32_16x16x32_bf16 v[168:171], v[84:87], v[96:99], v[168:171]
    v_mfma_f32_16x16x32_bf16 v[172:175], v[84:87], v[100:103], v[172:175]
    v_perm_b32 v88, v5, v1, s30
    v_perm_b32 v89, v13, v9, s30
    v_perm_b32 v90, v21, v17, s30
    v_perm_b32 v91, v29, v25, s30
    v_perm_b32 v92, v5, v1, s31
    v_perm_b32 v93, v13, v9, s31
    v_perm_b32 v94, v21, v17, s31
    v_perm_b32 v95, v29, v25, s31
    v_perm_b32 v96, v37, v33, s30
    v_perm_b32 v97, v45, v41, s30
    v_perm_b32 v98, v53, v49, s30
    v_perm_b32 v99, v61, v57, s30
    v_perm_b32 v100, v37, v33, s31
    v_perm_b32 v101, v45, v41, s31
    v_perm_b32 v102, v53, v49, s31
    v_perm_b32 v103, v61, v57, s31
    v_mfma_f32_16x16x32_bf16 v[112:115], v[64:67], v[88:91], 0
    v_mfma_f32_16x16x32_bf16 v[116:119], v[64:67], v[92:95], 0
    v_mfma_f32_16x16x32_bf16 v[144:147], v[72:75], v[88:91], 0
    v_mfma_f32_16x16x32_bf16 v[148:151], v[72:75], v[92:95], 0
    v_mfma_f32_16x16x32_bf16 v[176:179], v[80:83], v[88:91], 0
    v_mfma_f32_16x16x32_bf16 v[180:183], v[80:83], v[92:95], 0
    v_mfma_f32_16x16x32_bf16 v[112:115], v[68:71], v[96:99], v[112:115]
    v_mfma_f32_16x16x32_bf16 v[116:119], v[68:71], v[100:103], v[116:119]
    v_mfma_f32_16x16x32_bf16 v[144:147], v[76:79], v[96:99], v[144:147]
    v_mfma_f32_16x16x32_bf16 v[148:151], v[76:79], v[100:103], v[148:151]
    v_mfma_f32_16x16x32_bf16 v[176:179], v[84:87], v[96:99], v[176:179]
    v_mfma_f32_16x16x32_bf16 v[180:183], v[84:87], v[100:103], v[180:183]
    v_perm_b32 v88, v6, v2, s30
    v_perm_b32 v89, v14, v10, s30
    v_perm_b32 v90, v22, v18, s30
    v_perm_b32 v91, v30, v26, s30
    v_perm_b32 v92, v6, v2, s31
    v_perm_b32 v93, v14, v10, s31
    v_perm_b32 v94, v22, v18, s31
    v_perm_b32 v95, v30, v26, s31
    v_perm_b32 v96, v38, v34, s30
    v_perm_b32 v97, v46, v42, s30
    v_perm_b32 v98, v54, v50, s30
    v_perm_b32 v99, v62, v58, s30
    v_perm_b32 v100, v38, v34, s31
    v_perm_b32 v101, v46, v42, s31
    v_perm_b32 v102, v54, v50, s31
    v_perm_b32 v103, v62, v58, s31
    v_mfma_f32_16x16x32_bf16 v[120:123], v[64:67], v[88:91], 0
    v_mfma_f32_16x16x32_bf16 v[124:127], v[64:67], v[92:95], 0
    v_mfma_f32_16x16x32_bf16 v[152:155], v[72:75], v[88:91], 0
    v_mfma_f32_16x16x32_bf16 v[156:159], v[72:75], v[92:95], 0
    v_mfma_f32_16x16x32_bf16 v[184:187], v[80:83], v[88:91], 0
    v_mfma_f32_16x16x32_bf16 v[188:191], v[80:83], v[92:95], 0
    v_mfma_f32_16x16x32_bf16 v[120:123], v[68:71], v[96:99], v[120:123]
    v_mfma_f32_16x16x32_bf16 v[124:127], v[68:71], v[100:103], v[124:127]
    v_mfma_f32_16x16x32_bf16 v[152:155], v[76:79], v[96:99], v[152:155]
    v_mfma_f32_16x16x32_bf16 v[156:159], v[76:79], v[100:103], v[156:159]
    v_mfma_f32_16x16x32_bf16 v[184:187], v[84:87], v[96:99], v[184:187]
    v_mfma_f32_16x16x32_bf16 v[188:191], v[84:87], v[100:103], v[188:191]
    v_perm_b32 v88, v7, v3, s30
    v_perm_b32 v89, v15, v11, s30
    v_perm_b32 v90, v23, v19, s30
    v_perm_b32 v91, v31, v27, s30
    v_perm_b32 v92, v7, v3, s31
    v_perm_b32 v93, v15, v11, s31
    v_perm_b32 v94, v23, v19, s31
    v_perm_b32 v95, v31, v27, s31
    v_perm_b32 v96, v39, v35, s30
    v_perm_b32 v97, v47, v43, s30
    v_perm_b32 v98, v55, v51, s30
    v_perm_b32 v99, v63, v59, s30
    v_perm_b32 v100, v39, v35, s31
    v_perm_b32 v101, v47, v43, s31
    v_perm_b32 v102, v55, v51, s31
    v_perm_b32 v103, v63, v59, s31
    v_mfma_f32_16x16x32_bf16 v[128:131], v[64:67], v[88:91], 0
    v_mfma_f32_16x16x32_bf16 v[132:135], v[64:67], v[92:95], 0
    v_mfma_f32_16x16x32_bf16 v[160:163], v[72:75], v[88:91], 0
    v_mfma_f32_16x16x32_bf16 v[164:167], v[72:75], v[92:95], 0
    v_mfma_f32_16x16x32_bf16 v[192:195], v[80:83], v[88:91], 0
    v_mfma_f32_16x16x32_bf16 v[196:199], v[80:83], v[92:95], 0
    v_mfma_f32_16x16x32_bf16 v[128:131], v[68:71], v[96:99], v[128:131]
    v_mfma_f32_16x16x32_bf16 v[132:135], v[68:71], v[100:103], v[132:135]
    v_mfma_f32_16x16x32_bf16 v[160:163], v[76:79], v[96:99], v[160:163]
    v_mfma_f32_16x16x32_bf16 v[164:167], v[76:79], v[100:103], v[164:167]
    v_mfma_f32_16x16x32_bf16 v[192:195], v[84:87], v[96:99], v[192:195]
    v_mfma_f32_16x16x32_bf16 v[196:199], v[84:87], v[100:103], v[196:199]
    s_nop 7
    v_mul_f32 v224, v104, v104
    v_mov_b32 v216, v104
    v_fmac_f32 v224, v105, v105
    v_add_f32 v216, v216, v105
    v_fmac_f32 v224, v106, v106
    v_add_f32 v216, v216, v106
    v_fmac_f32 v224, v107, v107
    v_add_f32 v216, v216, v107
    v_fmac_f32 v224, v136, v136
    v_add_f32 v216, v216, v136
    v_fmac_f32 v224, v137, v137
    v_add_f32 v216, v216, v137
    v_fmac_f32 v224, v138, v138
    v_add_f32 v216, v216, v138
    v_fmac_f32 v224, v139, v139
    v_add_f32 v216, v216, v139
    v_fmac_f32 v224, v168, v168
    v_add_f32 v216, v216, v168
    v_fmac_f32 v224, v169, v169
    v_add_f32 v216, v216, v169
    v_fmac_f32 v224, v170, v170
    v_add_f32 v216, v216, v170
    v_fmac_f32 v224, v171, v171
    v_add_f32 v216, v216, v171
    v_mul_f32 v225, v108, v108
    v_mov_b32 v217, v108
    v_fmac_f32 v225, v109, v109
    v_add_f32 v217, v217, v109
    v_fmac_f32 v225, v110, v110
    v_add_f32 v217, v217, v110
    v_fmac_f32 v225, v111, v111
    v_add_f32 v217, v217, v111
    v_fmac_f32 v225, v140, v140
    v_add_f32 v217, v217, v140
    v_fmac_f32 v225, v141, v141
    v_add_f32 v217, v217, v141
    v_fmac_f32 v225, v142, v142
    v_add_f32 v217, v217, v142
    v_fmac_f32 v225, v143, v143
    v_add_f32 v217, v217, v143
    v_fmac_f32 v225, v172, v172
    v_add_f32 v217, v217, v172
    v_fmac_f32 v225, v173, v173
    v_add_f32 v217, v217, v173
    v_fmac_f32 v225, v174, v174
    v_add_f32 v217, v217, v174
    v_fmac_f32 v225, v175, v175
    v_add_f32 v217, v217, v175
    v_mul_f32 v226, v112, v112
    v_mov_b32 v218, v112
    v_fmac_f32 v226, v113, v113
    v_add_f32 v218, v218, v113
    v_fmac_f32 v226, v114, v114
    v_add_f32 v218, v218, v114
    v_fmac_f32 v226, v115, v115
    v_add_f32 v218, v218, v115
    v_fmac_f32 v226, v144, v144
    v_add_f32 v218, v218, v144
    v_fmac_f32 v226, v145, v145
    v_add_f32 v218, v218, v145
    v_fmac_f32 v226, v146, v146
    v_add_f32 v218, v218, v146
    v_fmac_f32 v226, v147, v147
    v_add_f32 v218, v218, v147
    v_fmac_f32 v226, v176, v176
    v_add_f32 v218, v218, v176
    v_fmac_f32 v226, v177, v177
    v_add_f32 v218, v218, v177
    v_fmac_f32 v226, v178, v178
    v_add_f32 v218, v218, v178
    v_fmac_f32 v226, v179, v179
    v_add_f32 v218, v218, v179
    v_mul_f32 v227, v116, v116
    v_mov_b32 v219, v116
    v_fmac_f32 v227, v117, v117
    v_add_f32 v219, v219, v117
    v_fmac_f32 v227, v118, v118
    v_add_f32 v219, v219, v118
    v_fmac_f32 v227, v119, v119
    v_add_f32 v219, v219, v119
    v_fmac_f32 v227, v148, v148
    v_add_f32 v219, v219, v148
    v_fmac_f32 v227, v149, v149
    v_add_f32 v219, v219, v149
    v_fmac_f32 v227, v150, v150
    v_add_f32 v219, v219, v150
    v_fmac_f32 v227, v151, v151
    v_add_f32 v219, v219, v151
    v_fmac_f32 v227, v180, v180
    v_add_f32 v219, v219, v180
    v_fmac_f32 v227, v181, v181
    v_add_f32 v219, v219, v181
    v_fmac_f32 v227, v182, v182
    v_add_f32 v219, v219, v182
    v_fmac_f32 v227, v183, v183
    v_add_f32 v219, v219, v183
    v_mul_f32 v228, v120, v120
    v_mov_b32 v220, v120
    v_fmac_f32 v228, v121, v121
    v_add_f32 v220, v220, v121
    v_fmac_f32 v228, v122, v122
    v_add_f32 v220, v220, v122
    v_fmac_f32 v228, v123, v123
    v_add_f32 v220, v220, v123
    v_fmac_f32 v228, v152, v152
    v_add_f32 v220, v220, v152
    v_fmac_f32 v228, v153, v153
    v_add_f32 v220, v220, v153
    v_fmac_f32 v228, v154, v154
    v_add_f32 v220, v220, v154
    v_fmac_f32 v228, v155, v155
    v_add_f32 v220, v220, v155
    v_fmac_f32 v228, v184, v184
    v_add_f32 v220, v220, v184
    v_fmac_f32 v228, v185, v185
    v_add_f32 v220, v220, v185
    v_fmac_f32 v228, v186, v186
    v_add_f32 v220, v220, v186
    v_fmac_f32 v228, v187, v187
    v_add_f32 v220, v220, v187
    v_mul_f32 v229, v124, v124
    v_mov_b32 v221, v124
    v_fmac_f32 v229, v125, v125
    v_add_f32 v221, v221, v125
    v_fmac_f32 v229, v126, v126
    v_add_f32 v221, v221, v126
    v_fmac_f32 v229, v127, v127
    v_add_f32 v221, v221, v127
    v_fmac_f32 v229, v156, v156
    v_add_f32 v221, v221, v156
    v_fmac_f32 v229, v157, v157
    v_add_f32 v221, v221, v157
    v_fmac_f32 v229, v158, v158
    v_add_f32 v221, v221, v158
    v_fmac_f32 v229, v159, v159
    v_add_f32 v221, v221, v159
    v_fmac_f32 v229, v188, v188
    v_add_f32 v221, v221, v188
    v_fmac_f32 v229, v189, v189
    v_add_f32 v221, v221, v189
    v_fmac_f32 v229, v190, v190
    v_add_f32 v221, v221, v190
    v_fmac_f32 v229, v191, v191
    v_add_f32 v221, v221, v191
    v_mul_f32 v230, v128, v128
    v_mov_b32 v222, v128
    v_fmac_f32 v230, v129, v129
    v_add_f32 v222, v222, v129
    v_fmac_f32 v230, v130, v130
    v_add_f32 v222, v222, v130
    v_fmac_f32 v230, v131, v131
    v_add_f32 v222, v222, v131
    v_fmac_f32 v230, v160, v160
    v_add_f32 v222, v222, v160
    v_fmac_f32 v230, v161, v161
    v_add_f32 v222, v222, v161
    v_fmac_f32 v230, v162, v162
    v_add_f32 v222, v222, v162
    v_fmac_f32 v230, v163, v163
    v_add_f32 v222, v222, v163
    v_fmac_f32 v230, v192, v192
    v_add_f32 v222, v222, v192
    v_fmac_f32 v230, v193, v193
    v_add_f32 v222, v222, v193
    v_fmac_f32 v230, v194, v194
    v_add_f32 v222, v222, v194
    v_fmac_f32 v230, v195, v195
    v_add_f32 v222, v222, v195
    v_mul_f32 v231, v132, v132
    v_mov_b32 v223, v132
    v_fmac_f32 v231, v133, v133
    v_add_f32 v223, v223, v133
    v_fmac_f32 v231, v134, v134
    v_add_f32 v223, v223, v134
    v_fmac_f32 v231, v135, v135
    v_add_f32 v223, v223, v135
    v_fmac_f32 v231, v164, v164
    v_add_f32 v223, v223, v164
    v_fmac_f32 v231, v165, v165
    v_add_f32 v223, v223, v165
    v_fmac_f32 v231, v166, v166
    v_add_f32 v223, v223, v166
    v_fmac_f32 v231, v167, v167
    v_add_f32 v223, v223, v167
    v_fmac_f32 v231, v196, v196
    v_add_f32 v223, v223, v196
    v_fmac_f32 v231, v197, v197
    v_add_f32 v223, v223, v197
    v_fmac_f32 v231, v198, v198
    v_add_f32 v223, v223, v198
    v_fmac_f32 v231, v199, v199
    v_add_f32 v223, v223, v199
    s_branch L_k45_red
L_k45_zero:
    s_waitcnt vmcnt(0) lgkmcnt(0)
    v_mov_b32 v216, 0
    v_mov_b32 v224, 0
    v_mov_b32 v217, 0
    v_mov_b32 v225, 0
    v_mov_b32 v218, 0
    v_mov_b32 v226, 0
    v_mov_b32 v219, 0
    v_mov_b32 v227, 0
    v_mov_b32 v220, 0
    v_mov_b32 v228, 0
    v_mov_b32 v221, 0
    v_mov_b32 v229, 0
    v_mov_b32 v222, 0
    v_mov_b32 v230, 0
    v_mov_b32 v223, 0
    v_mov_b32 v231, 0
L_k45_red:
    s_lshl_b32 s25, s10, 12
    v_lshlrev_b32 v204, 10, v202
    v_lshl_add_u32 v204, v201, 5, v204
    v_add_u32 v204, s25, v204
    ds_write_b128 v204, v[216:219] offset:8192
    ds_write_b128 v204, v[220:223] offset:8208
    ds_write_b128 v204, v[224:227] offset:8704
    ds_write_b128 v204, v[228:231] offset:8720
    s_waitcnt lgkmcnt(0)
    s_barrier
    s_cmp_ge_u32 s10, 4
    s_cbranch_scc1 L_k45_nored
    ds_read_b32 v16, v214 offset:8192
    ds_read_b32 v17, v214 offset:9216
    ds_read_b32 v18, v214 offset:10240
    ds_read_b32 v19, v214 offset:11264
    ds_read_b32 v20, v214 offset:12288
    ds_read_b32 v21, v214 offset:13312
    ds_read_b32 v22, v214 offset:14336
    ds_read_b32 v23, v214 offset:15360
    ds_read_b32 v24, v214 offset:16384
    ds_read_b32 v25, v214 offset:17408
    ds_read_b32 v26, v214 offset:18432
    ds_read_b32 v27, v214 offset:19456
    ds_read_b32 v28, v214 offset:20480
    ds_read_b32 v29, v214 offset:21504
    ds_read_b32 v30, v214 offset:22528
    ds_read_b32 v31, v214 offset:23552
    ds_read_b32 v32, v214 offset:24576
    ds_read_b32 v33, v214 offset:25600
    ds_read_b32 v34, v214 offset:26624
    ds_read_b32 v35, v214 offset:27648
    ds_read_b32 v36, v214 offset:28672
    ds_read_b32 v37, v214 offset:29696
    ds_read_b32 v38, v214 offset:30720
    ds_read_b32 v39, v214 offset:31744
    s_waitcnt lgkmcnt(0)
    v_add_f32 v16, v16, v17
    v_add_f32 v16, v16, v18
    v_add_f32 v16, v16, v19
    v_add_f32 v16, v16, v20
    v_add_f32 v16, v16, v21
    v_add_f32 v16, v16, v22
    v_add_f32 v16, v16, v23
    v_add_f32 v16, v16, v24
    v_add_f32 v16, v16, v25
    v_add_f32 v16, v16, v26
    v_add_f32 v16, v16, v27
    v_add_f32 v16, v16, v28
    v_add_f32 v16, v16, v29
    v_add_f32 v16, v16, v30
    v_add_f32 v16, v16, v31
    v_add_f32 v16, v16, v32
    v_add_f32 v16, v16, v33
    v_add_f32 v16, v16, v34
    v_add_f32 v16, v16, v35
    v_add_f32 v16, v16, v36
    v_add_f32 v16, v16, v37
    v_add_f32 v16, v16, v38
    v_add_f32 v16, v16, v39
L_k45_nored:
    s_mul_i32 s24, s11, 112
    s_mul_i32 s25, s13, 28
    s_add_u32 s24, s24, s25
    s_lshl_b32 s26, s24, 10
    s_add_u32 s26, s26, 146800640
    s_lshl_b32 s24, s12, 10
    s_add_u32 s24, s24, s26
    s_cmp_ge_u32 s10, 4
    s_cbranch_scc1 L_k45_nost
    buffer_store_dword v16, v214, s[16:19], s24 offen sc1
L_k45_nost:
    s_waitcnt vmcnt(0)
    s_barrier
    s_lshl_b32 s27, s11, 2
    s_add_u32 s27, s27, s13
    s_mul_i32 s27, s27, 8448
    s_add_u32 s27, s27, 147849216
    s_cmp_lg_u32 s10, 0
    s_cbranch_scc1 L_k45_wait
    v_mov_b32 v0, 1
    v_mov_b32 v1, 0
    s_mov_b64 exec, 1
    buffer_atomic_add v0, v1, s[16:19], s27 offen sc1
    s_mov_b64 exec, -1
    s_mov_b32 s33, 65536
L_k45_poll:
    s_sleep 8
    buffer_load_dword v2, v1, s[16:19], s27 offen sc1
    s_waitcnt vmcnt(0)
    v_readfirstlane_b32 s34, v2
    s_nop 3
    s_cmp_ge_u32 s34, 28
    s_cbranch_scc1 L_k45_wait
    s_sub_u32 s33, s33, 1
    s_cmp_lg_u32 s33, 0
    s_cbranch_scc1 L_k45_poll
L_k45_wait:
    s_barrier
    s_cmp_ge_u32 s10, 4
    s_cbranch_scc1 L_k45_nosum
    buffer_load_dword v0, v214, s[16:19], s26 offen offset:0 sc1
    buffer_load_dword v1, v214, s[16:19], s26 offen offset:1024 sc1
    buffer_load_dword v2, v214, s[16:19], s26 offen offset:2048 sc1
    buffer_load_dword v3, v214, s[16:19], s26 offen offset:3072 sc1
    s_add_u32 s26, s26, 4096
    buffer_load_dword v4, v214, s[16:19], s26 offen offset:0 sc1
    buffer_load_dword v5, v214, s[16:19], s26 offen offset:1024 sc1
    buffer_load_dword v6, v214, s[16:19], s26 offen offset:2048 sc1
    buffer_load_dword v7, v214, s[16:19], s26 offen offset:3072 sc1
    s_add_u32 s26, s26, 4096
    buffer_load_dword v8, v214, s[16:19], s26 offen offset:0 sc1
    buffer_load_dword v9, v214, s[16:19], s26 offen offset:1024 sc1
    buffer_load_dword v10, v214, s[16:19], s26 offen offset:2048 sc1
    buffer_load_dword v11, v214, s[16:19], s26 offen offset:3072 sc1
    s_add_u32 s26, s26, 4096
    buffer_load_dword v12, v214, s[16:19], s26 offen offset:0 sc1
    buffer_load_dword v13, v214, s[16:19], s26 offen offset:1024 sc1
    buffer_load_dword v14, v214, s[16:19], s26 offen offset:2048 sc1
    buffer_load_dword v15, v214, s[16:19], s26 offen offset:3072 sc1
    s_add_u32 s26, s26, 4096
    buffer_load_dword v16, v214, s[16:19], s26 offen offset:0 sc1
    buffer_load_dword v17, v214, s[16:19], s26 offen offset:1024 sc1
    buffer_load_dword v18, v214, s[16:19], s26 offen offset:2048 sc1
    buffer_load_dword v19, v214, s[16:19], s26 offen offset:3072 sc1
    s_add_u32 s26, s26, 4096
    buffer_load_dword v20, v214, s[16:19], s26 offen offset:0 sc1
    buffer_load_dword v21, v214, s[16:19], s26 offen offset:1024 sc1
    buffer_load_dword v22, v214, s[16:19], s26 offen offset:2048 sc1
    buffer_load_dword v23, v214, s[16:19], s26 offen offset:3072 sc1
    s_add_u32 s26, s26, 4096
    buffer_load_dword v24, v214, s[16:19], s26 offen offset:0 sc1
    buffer_load_dword v25, v214, s[16:19], s26 offen offset:1024 sc1
    buffer_load_dword v26, v214, s[16:19], s26 offen offset:2048 sc1
    buffer_load_dword v27, v214, s[16:19], s26 offen offset:3072 sc1
    s_waitcnt vmcnt(0)
    v_add_f32 v0, v0, v1
    v_add_f32 v2, v2, v3
    v_add_f32 v4, v4, v5
    v_add_f32 v6, v6, v7
    v_add_f32 v8, v8, v9
    v_add_f32 v10, v10, v11
    v_add_f32 v12, v12, v13
    v_add_f32 v14, v14, v15
    v_add_f32 v16, v16, v17
    v_add_f32 v18, v18, v19
    v_add_f32 v20, v20, v21
    v_add_f32 v22, v22, v23
    v_add_f32 v24, v24, v25
    v_add_f32 v26, v26, v27
    v_add_f32 v0, v0, v2
    v_add_f32 v4, v4, v6
    v_add_f32 v8, v8, v10
    v_add_f32 v12, v12, v14
    v_add_f32 v16, v16, v18
    v_add_f32 v20, v20, v22
    v_add_f32 v24, v24, v26
    v_add_f32 v0, v0, v4
    v_add_f32 v8, v8, v12
    v_add_f32 v16, v16, v20
    v_add_f32 v0, v0, v8
    v_add_f32 v16, v16, v24
    v_add_f32 v0, v0, v16
    ds_write_b32 v214, v0 offset:32768
L_k45_nosum:
    s_waitcnt lgkmcnt(0)
    s_barrier
    s_cmp_ge_u32 s14, 167
    s_cbranch_scc1 L_k45_end
    v_lshlrev_b32 v210, 5, v201
    ds_read_b128 v[44:47], v210 offset:32768
    ds_read_b128 v[48:51], v210 offset:32784
    ds_read_b128 v[52:55], v210 offset:33280
    ds_read_b128 v[56:59], v210 offset:33296
    s_mov_b32 s24, 0x39035177
    s_mov_b32 s25, 0x3727c5ac
    s_waitcnt lgkmcnt(0)
    v_mul_f32 v44, s24, v44
    v_mul_f32 v52, s24, v52
    v_fma_f32 v52, -v44, v44, v52
    v_max_f32 v52, 0, v52
    v_add_f32 v52, s25, v52
    v_rsq_f32 v52, v52
    v_lshlrev_b32 v216, 16, v232
    v_lshlrev_b32 v224, 16, v236
    v_mul_f32 v216, v216, v52
    v_fma_f32 v224, -v44, v216, v224
    v_mul_f32 v45, s24, v45
    v_mul_f32 v53, s24, v53
    v_fma_f32 v53, -v45, v45, v53
    v_max_f32 v53, 0, v53
    v_add_f32 v53, s25, v53
    v_rsq_f32 v53, v53
    v_and_b32 v217, 0xffff0000, v232
    v_and_b32 v225, 0xffff0000, v236
    v_mul_f32 v217, v217, v53
    v_fma_f32 v225, -v45, v217, v225
    v_mul_f32 v46, s24, v46
    v_mul_f32 v54, s24, v54
    v_fma_f32 v54, -v46, v46, v54
    v_max_f32 v54, 0, v54
    v_add_f32 v54, s25, v54
    v_rsq_f32 v54, v54
    v_lshlrev_b32 v218, 16, v233
    v_lshlrev_b32 v226, 16, v237
    v_mul_f32 v218, v218, v54
    v_fma_f32 v226, -v46, v218, v226
    v_mul_f32 v47, s24, v47
    v_mul_f32 v55, s24, v55
    v_fma_f32 v55, -v47, v47, v55
    v_max_f32 v55, 0, v55
    v_add_f32 v55, s25, v55
    v_rsq_f32 v55, v55
    v_and_b32 v219, 0xffff0000, v233
    v_and_b32 v227, 0xffff0000, v237
    v_mul_f32 v219, v219, v55
    v_fma_f32 v227, -v47, v219, v227
    v_mul_f32 v48, s24, v48
    v_mul_f32 v56, s24, v56
    v_fma_f32 v56, -v48, v48, v56
    v_max_f32 v56, 0, v56
    v_add_f32 v56, s25, v56
    v_rsq_f32 v56, v56
    v_lshlrev_b32 v220, 16, v234
    v_lshlrev_b32 v228, 16, v238
    v_mul_f32 v220, v220, v56
    v_fma_f32 v228, -v48, v220, v228
    v_mul_f32 v49, s24, v49
    v_mul_f32 v57, s24, v57
    v_fma_f32 v57, -v49, v49, v57
    v_max_f32 v57, 0, v57
    v_add_f32 v57, s25, v57
    v_rsq_f32 v57, v57
    v_and_b32 v221, 0xffff0000, v234
    v_and_b32 v229, 0xffff0000, v238
    v_mul_f32 v221, v221, v57
    v_fma_f32 v229, -v49, v221, v229
    v_mul_f32 v50, s24, v50
    v_mul_f32 v58, s24, v58
    v_fma_f32 v58, -v50, v50, v58
    v_max_f32 v58, 0, v58
    v_add_f32 v58, s25, v58
    v_rsq_f32 v58, v58
    v_lshlrev_b32 v222, 16, v235
    v_lshlrev_b32 v230, 16, v239
    v_mul_f32 v222, v222, v58
    v_fma_f32 v230, -v50, v222, v230
    v_mul_f32 v51, s24, v51
    v_mul_f32 v59, s24, v59
    v_fma_f32 v59, -v51, v51, v59
    v_max_f32 v59, 0, v59
    v_add_f32 v59, s25, v59
    v_rsq_f32 v59, v59
    v_and_b32 v223, 0xffff0000, v235
    v_and_b32 v231, 0xffff0000, v239
    v_mul_f32 v223, v223, v59
    v_fma_f32 v231, -v51, v223, v231
    s_mul_i32 s24, s11, 8176640
    s_add_u32 s28, s28, s24
    s_addc_u32 s29, s29, 0
    s_mov_b32 s32, s28
    s_and_b32 s33, s29, 0xffff
    s_mov_b32 s34, 8176640
    s_mov_b32 s35, 0x00020000
    s_mul_i32 s24, s14, 49152
    s_lshl_b32 s25, s13, 8
    s_add_u32 s24, s24, s25
    v_lshlrev_b32 v210, 12, v202
    v_lshl_add_u32 v210, v201, 4, v210
    v_add_u32 v210, s24, v210
    s_mov_b32 s26, 0xbdd2d3e8
    v_mov_b32 v211, 0xc0135761
    v_fma_f32 v104, v104, v216, v224
    v_fma_f32 v108, v108, v217, v225
    v_fma_f32 v112, v112, v218, v226
    v_fma_f32 v116, v116, v219, v227
    v_fma_f32 v120, v120, v220, v228
    v_fma_f32 v124, v124, v221, v229
    v_fma_f32 v128, v128, v222, v230
    v_fma_f32 v132, v132, v223, v231
    v_mul_f32 v0, v104, v104
    v_mul_f32 v1, v108, v108
    v_mul_f32 v2, v112, v112
    v_mul_f32 v3, v116, v116
    v_mul_f32 v4, v120, v120
    v_mul_f32 v5, v124, v124
    v_mul_f32 v6, v128, v128
    v_mul_f32 v7, v132, v132
    v_fma_f32 v0, v0, s26, v211
    v_fma_f32 v1, v1, s26, v211
    v_fma_f32 v2, v2, s26, v211
    v_fma_f32 v3, v3, s26, v211
    v_fma_f32 v4, v4, s26, v211
    v_fma_f32 v5, v5, s26, v211
    v_fma_f32 v6, v6, s26, v211
    v_fma_f32 v7, v7, s26, v211
    v_mul_f32 v0, v0, v104
    v_mul_f32 v1, v1, v108
    v_mul_f32 v2, v2, v112
    v_mul_f32 v3, v3, v116
    v_mul_f32 v4, v4, v120
    v_mul_f32 v5, v5, v124
    v_mul_f32 v6, v6, v128
    v_mul_f32 v7, v7, v132
    v_exp_f32 v0, v0
    v_exp_f32 v1, v1
    v_exp_f32 v2, v2
    v_exp_f32 v3, v3
    v_exp_f32 v4, v4
    v_exp_f32 v5, v5
    v_exp_f32 v6, v6
    v_exp_f32 v7, v7
    v_add_f32 v0, 1.0, v0
    v_add_f32 v1, 1.0, v1
    v_add_f32 v2, 1.0, v2
    v_add_f32 v3, 1.0, v3
    v_add_f32 v4, 1.0, v4
    v_add_f32 v5, 1.0, v5
    v_add_f32 v6, 1.0, v6
    v_add_f32 v7, 1.0, v7
    v_rcp_f32 v0, v0
    v_rcp_f32 v1, v1
    v_rcp_f32 v2, v2
    v_rcp_f32 v3, v3
    v_rcp_f32 v4, v4
    v_rcp_f32 v5, v5
    v_rcp_f32 v6, v6
    v_rcp_f32 v7, v7
    v_mul_f32 v0, v0, v104
    v_mul_f32 v1, v1, v108
    v_mul_f32 v2, v2, v112
    v_mul_f32 v3, v3, v116
    v_mul_f32 v4, v4, v120
    v_mul_f32 v5, v5, v124
    v_mul_f32 v6, v6, v128
    v_mul_f32 v7, v7, v132
    v_cvt_pk_bf16_f32 v16, v0, v1
    v_cvt_pk_bf16_f32 v17, v2, v3
    v_cvt_pk_bf16_f32 v18, v4, v5
    v_cvt_pk_bf16_f32 v19, v6, v7
    v_add_u32 v212, 0, v210
    buffer_store_dwordx4 v[16:19], v212, s[32:35], 0 offen sc1
    v_fma_f32 v105, v105, v216, v224
    v_fma_f32 v109, v109, v217, v225
    v_fma_f32 v113, v113, v218, v226
    v_fma_f32 v117, v117, v219, v227
    v_fma_f32 v121, v121, v220, v228
    v_fma_f32 v125, v125, v221, v229
    v_fma_f32 v129, v129, v222, v230
    v_fma_f32 v133, v133, v223, v231
    v_mul_f32 v0, v105, v105
    v_mul_f32 v1, v109, v109
    v_mul_f32 v2, v113, v113
    v_mul_f32 v3, v117, v117
    v_mul_f32 v4, v121, v121
    v_mul_f32 v5, v125, v125
    v_mul_f32 v6, v129, v129
    v_mul_f32 v7, v133, v133
    v_fma_f32 v0, v0, s26, v211
    v_fma_f32 v1, v1, s26, v211
    v_fma_f32 v2, v2, s26, v211
    v_fma_f32 v3, v3, s26, v211
    v_fma_f32 v4, v4, s26, v211
    v_fma_f32 v5, v5, s26, v211
    v_fma_f32 v6, v6, s26, v211
    v_fma_f32 v7, v7, s26, v211
    v_mul_f32 v0, v0, v105
    v_mul_f32 v1, v1, v109
    v_mul_f32 v2, v2, v113
    v_mul_f32 v3, v3, v117
    v_mul_f32 v4, v4, v121
    v_mul_f32 v5, v5, v125
    v_mul_f32 v6, v6, v129
    v_mul_f32 v7, v7, v133
    v_exp_f32 v0, v0
    v_exp_f32 v1, v1
    v_exp_f32 v2, v2
    v_exp_f32 v3, v3
    v_exp_f32 v4, v4
    v_exp_f32 v5, v5
    v_exp_f32 v6, v6
    v_exp_f32 v7, v7
    v_add_f32 v0, 1.0, v0
    v_add_f32 v1, 1.0, v1
    v_add_f32 v2, 1.0, v2
    v_add_f32 v3, 1.0, v3
    v_add_f32 v4, 1.0, v4
    v_add_f32 v5, 1.0, v5
    v_add_f32 v6, 1.0, v6
    v_add_f32 v7, 1.0, v7
    v_rcp_f32 v0, v0
    v_rcp_f32 v1, v1
    v_rcp_f32 v2, v2
    v_rcp_f32 v3, v3
    v_rcp_f32 v4, v4
    v_rcp_f32 v5, v5
    v_rcp_f32 v6, v6
    v_rcp_f32 v7, v7
    v_mul_f32 v0, v0, v105
    v_mul_f32 v1, v1, v109
    v_mul_f32 v2, v2, v113
    v_mul_f32 v3, v3, v117
    v_mul_f32 v4, v4, v121
    v_mul_f32 v5, v5, v125
    v_mul_f32 v6, v6, v129
    v_mul_f32 v7, v7, v133
    v_cvt_pk_bf16_f32 v20, v0, v1
    v_cvt_pk_bf16_f32 v21, v2, v3
    v_cvt_pk_bf16_f32 v22, v4, v5
    v_cvt_pk_bf16_f32 v23, v6, v7
    v_add_u32 v212, 1024, v210
    buffer_store_dwordx4 v[20:23], v212, s[32:35], 0 offen sc1
    v_fma_f32 v106, v106, v216, v224
    v_fma_f32 v110, v110, v217, v225
    v_fma_f32 v114, v114, v218, v226
    v_fma_f32 v118, v118, v219, v227
    v_fma_f32 v122, v122, v220, v228
    v_fma_f32 v126, v126, v221, v229
    v_fma_f32 v130, v130, v222, v230
    v_fma_f32 v134, v134, v223, v231
    v_mul_f32 v0, v106, v106
    v_mul_f32 v1, v110, v110
    v_mul_f32 v2, v114, v114
    v_mul_f32 v3, v118, v118
    v_mul_f32 v4, v122, v122
    v_mul_f32 v5, v126, v126
    v_mul_f32 v6, v130, v130
    v_mul_f32 v7, v134, v134
    v_fma_f32 v0, v0, s26, v211
    v_fma_f32 v1, v1, s26, v211
    v_fma_f32 v2, v2, s26, v211
    v_fma_f32 v3, v3, s26, v211
    v_fma_f32 v4, v4, s26, v211
    v_fma_f32 v5, v5, s26, v211
    v_fma_f32 v6, v6, s26, v211
    v_fma_f32 v7, v7, s26, v211
    v_mul_f32 v0, v0, v106
    v_mul_f32 v1, v1, v110
    v_mul_f32 v2, v2, v114
    v_mul_f32 v3, v3, v118
    v_mul_f32 v4, v4, v122
    v_mul_f32 v5, v5, v126
    v_mul_f32 v6, v6, v130
    v_mul_f32 v7, v7, v134
    v_exp_f32 v0, v0
    v_exp_f32 v1, v1
    v_exp_f32 v2, v2
    v_exp_f32 v3, v3
    v_exp_f32 v4, v4
    v_exp_f32 v5, v5
    v_exp_f32 v6, v6
    v_exp_f32 v7, v7
    v_add_f32 v0, 1.0, v0
    v_add_f32 v1, 1.0, v1
    v_add_f32 v2, 1.0, v2
    v_add_f32 v3, 1.0, v3
    v_add_f32 v4, 1.0, v4
    v_add_f32 v5, 1.0, v5
    v_add_f32 v6, 1.0, v6
    v_add_f32 v7, 1.0, v7
    v_rcp_f32 v0, v0
    v_rcp_f32 v1, v1
    v_rcp_f32 v2, v2
    v_rcp_f32 v3, v3
    v_rcp_f32 v4, v4
    v_rcp_f32 v5, v5
    v_rcp_f32 v6, v6
    v_rcp_f32 v7, v7
    v_mul_f32 v0, v0, v106
    v_mul_f32 v1, v1, v110
    v_mul_f32 v2, v2, v114
    v_mul_f32 v3, v3, v118
    v_mul_f32 v4, v4, v122
    v_mul_f32 v5, v5, v126
    v_mul_f32 v6, v6, v130
    v_mul_f32 v7, v7, v134
    v_cvt_pk_bf16_f32 v24, v0, v1
    v_cvt_pk_bf16_f32 v25, v2, v3
    v_cvt_pk_bf16_f32 v26, v4, v5
    v_cvt_pk_bf16_f32 v27, v6, v7
    v_add_u32 v212, 2048, v210
    buffer_store_dwordx4 v[24:27], v212, s[32:35], 0 offen sc1
    v_fma_f32 v107, v107, v216, v224
    v_fma_f32 v111, v111, v217, v225
    v_fma_f32 v115, v115, v218, v226
    v_fma_f32 v119, v119, v219, v227
    v_fma_f32 v123, v123, v220, v228
    v_fma_f32 v127, v127, v221, v229
    v_fma_f32 v131, v131, v222, v230
    v_fma_f32 v135, v135, v223, v231
    v_mul_f32 v0, v107, v107
    v_mul_f32 v1, v111, v111
    v_mul_f32 v2, v115, v115
    v_mul_f32 v3, v119, v119
    v_mul_f32 v4, v123, v123
    v_mul_f32 v5, v127, v127
    v_mul_f32 v6, v131, v131
    v_mul_f32 v7, v135, v135
    v_fma_f32 v0, v0, s26, v211
    v_fma_f32 v1, v1, s26, v211
    v_fma_f32 v2, v2, s26, v211
    v_fma_f32 v3, v3, s26, v211
    v_fma_f32 v4, v4, s26, v211
    v_fma_f32 v5, v5, s26, v211
    v_fma_f32 v6, v6, s26, v211
    v_fma_f32 v7, v7, s26, v211
    v_mul_f32 v0, v0, v107
    v_mul_f32 v1, v1, v111
    v_mul_f32 v2, v2, v115
    v_mul_f32 v3, v3, v119
    v_mul_f32 v4, v4, v123
    v_mul_f32 v5, v5, v127
    v_mul_f32 v6, v6, v131
    v_mul_f32 v7, v7, v135
    v_exp_f32 v0, v0
    v_exp_f32 v1, v1
    v_exp_f32 v2, v2
    v_exp_f32 v3, v3
    v_exp_f32 v4, v4
    v_exp_f32 v5, v5
    v_exp_f32 v6, v6
    v_exp_f32 v7, v7
    v_add_f32 v0, 1.0, v0
    v_add_f32 v1, 1.0, v1
    v_add_f32 v2, 1.0, v2
    v_add_f32 v3, 1.0, v3
    v_add_f32 v4, 1.0, v4
    v_add_f32 v5, 1.0, v5
    v_add_f32 v6, 1.0, v6
    v_add_f32 v7, 1.0, v7
    v_rcp_f32 v0, v0
    v_rcp_f32 v1, v1
    v_rcp_f32 v2, v2
    v_rcp_f32 v3, v3
    v_rcp_f32 v4, v4
    v_rcp_f32 v5, v5
    v_rcp_f32 v6, v6
    v_rcp_f32 v7, v7
    v_mul_f32 v0, v0, v107
    v_mul_f32 v1, v1, v111
    v_mul_f32 v2, v2, v115
    v_mul_f32 v3, v3, v119
    v_mul_f32 v4, v4, v123
    v_mul_f32 v5, v5, v127
    v_mul_f32 v6, v6, v131
    v_mul_f32 v7, v7, v135
    v_cvt_pk_bf16_f32 v28, v0, v1
    v_cvt_pk_bf16_f32 v29, v2, v3
    v_cvt_pk_bf16_f32 v30, v4, v5
    v_cvt_pk_bf16_f32 v31, v6, v7
    v_add_u32 v212, 3072, v210
    buffer_store_dwordx4 v[28:31], v212, s[32:35], 0 offen sc1
    v_fma_f32 v136, v136, v216, v224
    v_fma_f32 v140, v140, v217, v225
    v_fma_f32 v144, v144, v218, v226
    v_fma_f32 v148, v148, v219, v227
    v_fma_f32 v152, v152, v220, v228
    v_fma_f32 v156, v156, v221, v229
    v_fma_f32 v160, v160, v222, v230
    v_fma_f32 v164, v164, v223, v231
    v_mul_f32 v0, v136, v136
    v_mul_f32 v1, v140, v140
    v_mul_f32 v2, v144, v144
    v_mul_f32 v3, v148, v148
    v_mul_f32 v4, v152, v152
    v_mul_f32 v5, v156, v156
    v_mul_f32 v6, v160, v160
    v_mul_f32 v7, v164, v164
    v_fma_f32 v0, v0, s26, v211
    v_fma_f32 v1, v1, s26, v211
    v_fma_f32 v2, v2, s26, v211
    v_fma_f32 v3, v3, s26, v211
    v_fma_f32 v4, v4, s26, v211
    v_fma_f32 v5, v5, s26, v211
    v_fma_f32 v6, v6, s26, v211
    v_fma_f32 v7, v7, s26, v211
    v_mul_f32 v0, v0, v136
    v_mul_f32 v1, v1, v140
    v_mul_f32 v2, v2, v144
    v_mul_f32 v3, v3, v148
    v_mul_f32 v4, v4, v152
    v_mul_f32 v5, v5, v156
    v_mul_f32 v6, v6, v160
    v_mul_f32 v7, v7, v164
    v_exp_f32 v0, v0
    v_exp_f32 v1, v1
    v_exp_f32 v2, v2
    v_exp_f32 v3, v3
    v_exp_f32 v4, v4
    v_exp_f32 v5, v5
    v_exp_f32 v6, v6
    v_exp_f32 v7, v7
    v_add_f32 v0, 1.0, v0
    v_add_f32 v1, 1.0, v1
    v_add_f32 v2, 1.0, v2
    v_add_f32 v3, 1.0, v3
    v_add_f32 v4, 1.0, v4
    v_add_f32 v5, 1.0, v5
    v_add_f32 v6, 1.0, v6
    v_add_f32 v7, 1.0, v7
    v_rcp_f32 v0, v0
    v_rcp_f32 v1, v1
    v_rcp_f32 v2, v2
    v_rcp_f32 v3, v3
    v_rcp_f32 v4, v4
    v_rcp_f32 v5, v5
    v_rcp_f32 v6, v6
    v_rcp_f32 v7, v7
    v_mul_f32 v0, v0, v136
    v_mul_f32 v1, v1, v140
    v_mul_f32 v2, v2, v144
    v_mul_f32 v3, v3, v148
    v_mul_f32 v4, v4, v152
    v_mul_f32 v5, v5, v156
    v_mul_f32 v6, v6, v160
    v_mul_f32 v7, v7, v164
    v_cvt_pk_bf16_f32 v32, v0, v1
    v_cvt_pk_bf16_f32 v33, v2, v3
    v_cvt_pk_bf16_f32 v34, v4, v5
    v_cvt_pk_bf16_f32 v35, v6, v7
    v_add_u32 v212, 16384, v210
    buffer_store_dwordx4 v[32:35], v212, s[32:35], 0 offen sc1
    v_fma_f32 v137, v137, v216, v224
    v_fma_f32 v141, v141, v217, v225
    v_fma_f32 v145, v145, v218, v226
    v_fma_f32 v149, v149, v219, v227
    v_fma_f32 v153, v153, v220, v228
    v_fma_f32 v157, v157, v221, v229
    v_fma_f32 v161, v161, v222, v230
    v_fma_f32 v165, v165, v223, v231
    v_mul_f32 v0, v137, v137
    v_mul_f32 v1, v141, v141
    v_mul_f32 v2, v145, v145
    v_mul_f32 v3, v149, v149
    v_mul_f32 v4, v153, v153
    v_mul_f32 v5, v157, v157
    v_mul_f32 v6, v161, v161
    v_mul_f32 v7, v165, v165
    v_fma_f32 v0, v0, s26, v211
    v_fma_f32 v1, v1, s26, v211
    v_fma_f32 v2, v2, s26, v211
    v_fma_f32 v3, v3, s26, v211
    v_fma_f32 v4, v4, s26, v211
    v_fma_f32 v5, v5, s26, v211
    v_fma_f32 v6, v6, s26, v211
    v_fma_f32 v7, v7, s26, v211
    v_mul_f32 v0, v0, v137
    v_mul_f32 v1, v1, v141
    v_mul_f32 v2, v2, v145
    v_mul_f32 v3, v3, v149
    v_mul_f32 v4, v4, v153
    v_mul_f32 v5, v5, v157
    v_mul_f32 v6, v6, v161
    v_mul_f32 v7, v7, v165
    v_exp_f32 v0, v0
    v_exp_f32 v1, v1
    v_exp_f32 v2, v2
    v_exp_f32 v3, v3
    v_exp_f32 v4, v4
    v_exp_f32 v5, v5
    v_exp_f32 v6, v6
    v_exp_f32 v7, v7
    v_add_f32 v0, 1.0, v0
    v_add_f32 v1, 1.0, v1
    v_add_f32 v2, 1.0, v2
    v_add_f32 v3, 1.0, v3
    v_add_f32 v4, 1.0, v4
    v_add_f32 v5, 1.0, v5
    v_add_f32 v6, 1.0, v6
    v_add_f32 v7, 1.0, v7
    v_rcp_f32 v0, v0
    v_rcp_f32 v1, v1
    v_rcp_f32 v2, v2
    v_rcp_f32 v3, v3
    v_rcp_f32 v4, v4
    v_rcp_f32 v5, v5
    v_rcp_f32 v6, v6
    v_rcp_f32 v7, v7
    v_mul_f32 v0, v0, v137
    v_mul_f32 v1, v1, v141
    v_mul_f32 v2, v2, v145
    v_mul_f32 v3, v3, v149
    v_mul_f32 v4, v4, v153
    v_mul_f32 v5, v5, v157
    v_mul_f32 v6, v6, v161
    v_mul_f32 v7, v7, v165
    v_cvt_pk_bf16_f32 v36, v0, v1
    v_cvt_pk_bf16_f32 v37, v2, v3
    v_cvt_pk_bf16_f32 v38, v4, v5
    v_cvt_pk_bf16_f32 v39, v6, v7
    v_add_u32 v212, 17408, v210
    buffer_store_dwordx4 v[36:39], v212, s[32:35], 0 offen sc1
    v_fma_f32 v138, v138, v216, v224
    v_fma_f32 v142, v142, v217, v225
    v_fma_f32 v146, v146, v218, v226
    v_fma_f32 v150, v150, v219, v227
    v_fma_f32 v154, v154, v220, v228
    v_fma_f32 v158, v158, v221, v229
    v_fma_f32 v162, v162, v222, v230
    v_fma_f32 v166, v166, v223, v231
    v_mul_f32 v0, v138, v138
    v_mul_f32 v1, v142, v142
    v_mul_f32 v2, v146, v146
    v_mul_f32 v3, v150, v150
    v_mul_f32 v4, v154, v154
    v_mul_f32 v5, v158, v158
    v_mul_f32 v6, v162, v162
    v_mul_f32 v7, v166, v166
    v_fma_f32 v0, v0, s26, v211
    v_fma_f32 v1, v1, s26, v211
    v_fma_f32 v2, v2, s26, v211
    v_fma_f32 v3, v3, s26, v211
    v_fma_f32 v4, v4, s26, v211
    v_fma_f32 v5, v5, s26, v211
    v_fma_f32 v6, v6, s26, v211
    v_fma_f32 v7, v7, s26, v211
    v_mul_f32 v0, v0, v138
    v_mul_f32 v1, v1, v142
    v_mul_f32 v2, v2, v146
    v_mul_f32 v3, v3, v150
    v_mul_f32 v4, v4, v154
    v_mul_f32 v5, v5, v158
    v_mul_f32 v6, v6, v162
    v_mul_f32 v7, v7, v166
    v_exp_f32 v0, v0
    v_exp_f32 v1, v1
    v_exp_f32 v2, v2
    v_exp_f32 v3, v3
    v_exp_f32 v4, v4
    v_exp_f32 v5, v5
    v_exp_f32 v6, v6
    v_exp_f32 v7, v7
    v_add_f32 v0, 1.0, v0
    v_add_f32 v1, 1.0, v1
    v_add_f32 v2, 1.0, v2
    v_add_f32 v3, 1.0, v3
    v_add_f32 v4, 1.0, v4
    v_add_f32 v5, 1.0, v5
    v_add_f32 v6, 1.0, v6
    v_add_f32 v7, 1.0, v7
    v_rcp_f32 v0, v0
    v_rcp_f32 v1, v1
    v_rcp_f32 v2, v2
    v_rcp_f32 v3, v3
    v_rcp_f32 v4, v4
    v_rcp_f32 v5, v5
    v_rcp_f32 v6, v6
    v_rcp_f32 v7, v7
    v_mul_f32 v0, v0, v138
    v_mul_f32 v1, v1, v142
    v_mul_f32 v2, v2, v146
    v_mul_f32 v3, v3, v150
    v_mul_f32 v4, v4, v154
    v_mul_f32 v5, v5, v158
    v_mul_f32 v6, v6, v162
    v_mul_f32 v7, v7, v166
    v_cvt_pk_bf16_f32 v40, v0, v1
    v_cvt_pk_bf16_f32 v41, v2, v3
    v_cvt_pk_bf16_f32 v42, v4, v5
    v_cvt_pk_bf16_f32 v43, v6, v7
    v_add_u32 v212, 18432, v210
    buffer_store_dwordx4 v[40:43], v212, s[32:35], 0 offen sc1
    v_fma_f32 v139, v139, v216, v224
    v_fma_f32 v143, v143, v217, v225
    v_fma_f32 v147, v147, v218, v226
    v_fma_f32 v151, v151, v219, v227
    v_fma_f32 v155, v155, v220, v228
    v_fma_f32 v159, v159, v221, v229
    v_fma_f32 v163, v163, v222, v230
    v_fma_f32 v167, v167, v223, v231
    v_mul_f32 v0, v139, v139
    v_mul_f32 v1, v143, v143
    v_mul_f32 v2, v147, v147
    v_mul_f32 v3, v151, v151
    v_mul_f32 v4, v155, v155
    v_mul_f32 v5, v159, v159
    v_mul_f32 v6, v163, v163
    v_mul_f32 v7, v167, v167
    v_fma_f32 v0, v0, s26, v211
    v_fma_f32 v1, v1, s26, v211
    v_fma_f32 v2, v2, s26, v211
    v_fma_f32 v3, v3, s26, v211
    v_fma_f32 v4, v4, s26, v211
    v_fma_f32 v5, v5, s26, v211
    v_fma_f32 v6, v6, s26, v211
    v_fma_f32 v7, v7, s26, v211
    v_mul_f32 v0, v0, v139
    v_mul_f32 v1, v1, v143
    v_mul_f32 v2, v2, v147
    v_mul_f32 v3, v3, v151
    v_mul_f32 v4, v4, v155
    v_mul_f32 v5, v5, v159
    v_mul_f32 v6, v6, v163
    v_mul_f32 v7, v7, v167
    v_exp_f32 v0, v0
    v_exp_f32 v1, v1
    v_exp_f32 v2, v2
    v_exp_f32 v3, v3
    v_exp_f32 v4, v4
    v_exp_f32 v5, v5
    v_exp_f32 v6, v6
    v_exp_f32 v7, v7
    v_add_f32 v0, 1.0, v0
    v_add_f32 v1, 1.0, v1
    v_add_f32 v2, 1.0, v2
    v_add_f32 v3, 1.0, v3
    v_add_f32 v4, 1.0, v4
    v_add_f32 v5, 1.0, v5
    v_add_f32 v6, 1.0, v6
    v_add_f32 v7, 1.0, v7
    v_rcp_f32 v0, v0
    v_rcp_f32 v1, v1
    v_rcp_f32 v2, v2
    v_rcp_f32 v3, v3
    v_rcp_f32 v4, v4
    v_rcp_f32 v5, v5
    v_rcp_f32 v6, v6
    v_rcp_f32 v7, v7
    v_mul_f32 v0, v0, v139
    v_mul_f32 v1, v1, v143
    v_mul_f32 v2, v2, v147
    v_mul_f32 v3, v3, v151
    v_mul_f32 v4, v4, v155
    v_mul_f32 v5, v5, v159
    v_mul_f32 v6, v6, v163
    v_mul_f32 v7, v7, v167
    v_cvt_pk_bf16_f32 v44, v0, v1
    v_cvt_pk_bf16_f32 v45, v2, v3
    v_cvt_pk_bf16_f32 v46, v4, v5
    v_cvt_pk_bf16_f32 v47, v6, v7
    v_add_u32 v212, 19456, v210
    buffer_store_dwordx4 v[44:47], v212, s[32:35], 0 offen sc1
    v_fma_f32 v168, v168, v216, v224
    v_fma_f32 v172, v172, v217, v225
    v_fma_f32 v176, v176, v218, v226
    v_fma_f32 v180, v180, v219, v227
    v_fma_f32 v184, v184, v220, v228
    v_fma_f32 v188, v188, v221, v229
    v_fma_f32 v192, v192, v222, v230
    v_fma_f32 v196, v196, v223, v231
    v_mul_f32 v0, v168, v168
    v_mul_f32 v1, v172, v172
    v_mul_f32 v2, v176, v176
    v_mul_f32 v3, v180, v180
    v_mul_f32 v4, v184, v184
    v_mul_f32 v5, v188, v188
    v_mul_f32 v6, v192, v192
    v_mul_f32 v7, v196, v196
    v_fma_f32 v0, v0, s26, v211
    v_fma_f32 v1, v1, s26, v211
    v_fma_f32 v2, v2, s26, v211
    v_fma_f32 v3, v3, s26, v211
    v_fma_f32 v4, v4, s26, v211
    v_fma_f32 v5, v5, s26, v211
    v_fma_f32 v6, v6, s26, v211
    v_fma_f32 v7, v7, s26, v211
    v_mul_f32 v0, v0, v168
    v_mul_f32 v1, v1, v172
    v_mul_f32 v2, v2, v176
    v_mul_f32 v3, v3, v180
    v_mul_f32 v4, v4, v184
    v_mul_f32 v5, v5, v188
    v_mul_f32 v6, v6, v192
    v_mul_f32 v7, v7, v196
    v_exp_f32 v0, v0
    v_exp_f32 v1, v1
    v_exp_f32 v2, v2
    v_exp_f32 v3, v3
    v_exp_f32 v4, v4
    v_exp_f32 v5, v5
    v_exp_f32 v6, v6
    v_exp_f32 v7, v7
    v_add_f32 v0, 1.0, v0
    v_add_f32 v1, 1.0, v1
    v_add_f32 v2, 1.0, v2
    v_add_f32 v3, 1.0, v3
    v_add_f32 v4, 1.0, v4
    v_add_f32 v5, 1.0, v5
    v_add_f32 v6, 1.0, v6
    v_add_f32 v7, 1.0, v7
    v_rcp_f32 v0, v0
    v_rcp_f32 v1, v1
    v_rcp_f32 v2, v2
    v_rcp_f32 v3, v3
    v_rcp_f32 v4, v4
    v_rcp_f32 v5, v5
    v_rcp_f32 v6, v6
    v_rcp_f32 v7, v7
    v_mul_f32 v0, v0, v168
    v_mul_f32 v1, v1, v172
    v_mul_f32 v2, v2, v176
    v_mul_f32 v3, v3, v180
    v_mul_f32 v4, v4, v184
    v_mul_f32 v5, v5, v188
    v_mul_f32 v6, v6, v192
    v_mul_f32 v7, v7, v196
    v_cvt_pk_bf16_f32 v16, v0, v1
    v_cvt_pk_bf16_f32 v17, v2, v3
    v_cvt_pk_bf16_f32 v18, v4, v5
    v_cvt_pk_bf16_f32 v19, v6, v7
    v_add_u32 v212, 32768, v210
    buffer_store_dwordx4 v[16:19], v212, s[32:35], 0 offen sc1
    v_fma_f32 v169, v169, v216, v224
    v_fma_f32 v173, v173, v217, v225
    v_fma_f32 v177, v177, v218, v226
    v_fma_f32 v181, v181, v219, v227
    v_fma_f32 v185, v185, v220, v228
    v_fma_f32 v189, v189, v221, v229
    v_fma_f32 v193, v193, v222, v230
    v_fma_f32 v197, v197, v223, v231
    v_mul_f32 v0, v169, v169
    v_mul_f32 v1, v173, v173
    v_mul_f32 v2, v177, v177
    v_mul_f32 v3, v181, v181
    v_mul_f32 v4, v185, v185
    v_mul_f32 v5, v189, v189
    v_mul_f32 v6, v193, v193
    v_mul_f32 v7, v197, v197
    v_fma_f32 v0, v0, s26, v211
    v_fma_f32 v1, v1, s26, v211
    v_fma_f32 v2, v2, s26, v211
    v_fma_f32 v3, v3, s26, v211
    v_fma_f32 v4, v4, s26, v211
    v_fma_f32 v5, v5, s26, v211
    v_fma_f32 v6, v6, s26, v211
    v_fma_f32 v7, v7, s26, v211
    v_mul_f32 v0, v0, v169
    v_mul_f32 v1, v1, v173
    v_mul_f32 v2, v2, v177
    v_mul_f32 v3, v3, v181
    v_mul_f32 v4, v4, v185
    v_mul_f32 v5, v5, v189
    v_mul_f32 v6, v6, v193
    v_mul_f32 v7, v7, v197
    v_exp_f32 v0, v0
    v_exp_f32 v1, v1
    v_exp_f32 v2, v2
    v_exp_f32 v3, v3
    v_exp_f32 v4, v4
    v_exp_f32 v5, v5
    v_exp_f32 v6, v6
    v_exp_f32 v7, v7
    v_add_f32 v0, 1.0, v0
    v_add_f32 v1, 1.0, v1
    v_add_f32 v2, 1.0, v2
    v_add_f32 v3, 1.0, v3
    v_add_f32 v4, 1.0, v4
    v_add_f32 v5, 1.0, v5
    v_add_f32 v6, 1.0, v6
    v_add_f32 v7, 1.0, v7
    v_rcp_f32 v0, v0
    v_rcp_f32 v1, v1
    v_rcp_f32 v2, v2
    v_rcp_f32 v3, v3
    v_rcp_f32 v4, v4
    v_rcp_f32 v5, v5
    v_rcp_f32 v6, v6
    v_rcp_f32 v7, v7
    v_mul_f32 v0, v0, v169
    v_mul_f32 v1, v1, v173
    v_mul_f32 v2, v2, v177
    v_mul_f32 v3, v3, v181
    v_mul_f32 v4, v4, v185
    v_mul_f32 v5, v5, v189
    v_mul_f32 v6, v6, v193
    v_mul_f32 v7, v7, v197
    v_cvt_pk_bf16_f32 v20, v0, v1
    v_cvt_pk_bf16_f32 v21, v2, v3
    v_cvt_pk_bf16_f32 v22, v4, v5
    v_cvt_pk_bf16_f32 v23, v6, v7
    v_add_u32 v212, 33792, v210
    buffer_store_dwordx4 v[20:23], v212, s[32:35], 0 offen sc1
    v_fma_f32 v170, v170, v216, v224
    v_fma_f32 v174, v174, v217, v225
    v_fma_f32 v178, v178, v218, v226
    v_fma_f32 v182, v182, v219, v227
    v_fma_f32 v186, v186, v220, v228
    v_fma_f32 v190, v190, v221, v229
    v_fma_f32 v194, v194, v222, v230
    v_fma_f32 v198, v198, v223, v231
    v_mul_f32 v0, v170, v170
    v_mul_f32 v1, v174, v174
    v_mul_f32 v2, v178, v178
    v_mul_f32 v3, v182, v182
    v_mul_f32 v4, v186, v186
    v_mul_f32 v5, v190, v190
    v_mul_f32 v6, v194, v194
    v_mul_f32 v7, v198, v198
    v_fma_f32 v0, v0, s26, v211
    v_fma_f32 v1, v1, s26, v211
    v_fma_f32 v2, v2, s26, v211
    v_fma_f32 v3, v3, s26, v211
    v_fma_f32 v4, v4, s26, v211
    v_fma_f32 v5, v5, s26, v211
    v_fma_f32 v6, v6, s26, v211
    v_fma_f32 v7, v7, s26, v211
    v_mul_f32 v0, v0, v170
    v_mul_f32 v1, v1, v174
    v_mul_f32 v2, v2, v178
    v_mul_f32 v3, v3, v182
    v_mul_f32 v4, v4, v186
    v_mul_f32 v5, v5, v190
    v_mul_f32 v6, v6, v194
    v_mul_f32 v7, v7, v198
    v_exp_f32 v0, v0
    v_exp_f32 v1, v1
    v_exp_f32 v2, v2
    v_exp_f32 v3, v3
    v_exp_f32 v4, v4
    v_exp_f32 v5, v5
    v_exp_f32 v6, v6
    v_exp_f32 v7, v7
    v_add_f32 v0, 1.0, v0
    v_add_f32 v1, 1.0, v1
    v_add_f32 v2, 1.0, v2
    v_add_f32 v3, 1.0, v3
    v_add_f32 v4, 1.0, v4
    v_add_f32 v5, 1.0, v5
    v_add_f32 v6, 1.0, v6
    v_add_f32 v7, 1.0, v7
    v_rcp_f32 v0, v0
    v_rcp_f32 v1, v1
    v_rcp_f32 v2, v2
    v_rcp_f32 v3, v3
    v_rcp_f32 v4, v4
    v_rcp_f32 v5, v5
    v_rcp_f32 v6, v6
    v_rcp_f32 v7, v7
    v_mul_f32 v0, v0, v170
    v_mul_f32 v1, v1, v174
    v_mul_f32 v2, v2, v178
    v_mul_f32 v3, v3, v182
    v_mul_f32 v4, v4, v186
    v_mul_f32 v5, v5, v190
    v_mul_f32 v6, v6, v194
    v_mul_f32 v7, v7, v198
    v_cvt_pk_bf16_f32 v24, v0, v1
    v_cvt_pk_bf16_f32 v25, v2, v3
    v_cvt_pk_bf16_f32 v26, v4, v5
    v_cvt_pk_bf16_f32 v27, v6, v7
    v_add_u32 v212, 34816, v210
    buffer_store_dwordx4 v[24:27], v212, s[32:35], 0 offen sc1
    v_fma_f32 v171, v171, v216, v224
    v_fma_f32 v175, v175, v217, v225
    v_fma_f32 v179, v179, v218, v226
    v_fma_f32 v183, v183, v219, v227
    v_fma_f32 v187, v187, v220, v228
    v_fma_f32 v191, v191, v221, v229
    v_fma_f32 v195, v195, v222, v230
    v_fma_f32 v199, v199, v223, v231
    v_mul_f32 v0, v171, v171
    v_mul_f32 v1, v175, v175
    v_mul_f32 v2, v179, v179
    v_mul_f32 v3, v183, v183
    v_mul_f32 v4, v187, v187
    v_mul_f32 v5, v191, v191
    v_mul_f32 v6, v195, v195
    v_mul_f32 v7, v199, v199
    v_fma_f32 v0, v0, s26, v211
    v_fma_f32 v1, v1, s26, v211
    v_fma_f32 v2, v2, s26, v211
    v_fma_f32 v3, v3, s26, v211
    v_fma_f32 v4, v4, s26, v211
    v_fma_f32 v5, v5, s26, v211
    v_fma_f32 v6, v6, s26, v211
    v_fma_f32 v7, v7, s26, v211
    v_mul_f32 v0, v0, v171
    v_mul_f32 v1, v1, v175
    v_mul_f32 v2, v2, v179
    v_mul_f32 v3, v3, v183
    v_mul_f32 v4, v4, v187
    v_mul_f32 v5, v5, v191
    v_mul_f32 v6, v6, v195
    v_mul_f32 v7, v7, v199
    v_exp_f32 v0, v0
    v_exp_f32 v1, v1
    v_exp_f32 v2, v2
    v_exp_f32 v3, v3
    v_exp_f32 v4, v4
    v_exp_f32 v5, v5
    v_exp_f32 v6, v6
    v_exp_f32 v7, v7
    v_add_f32 v0, 1.0, v0
    v_add_f32 v1, 1.0, v1
    v_add_f32 v2, 1.0, v2
    v_add_f32 v3, 1.0, v3
    v_add_f32 v4, 1.0, v4
    v_add_f32 v5, 1.0, v5
    v_add_f32 v6, 1.0, v6
    v_add_f32 v7, 1.0, v7
    v_rcp_f32 v0, v0
    v_rcp_f32 v1, v1
    v_rcp_f32 v2, v2
    v_rcp_f32 v3, v3
    v_rcp_f32 v4, v4
    v_rcp_f32 v5, v5
    v_rcp_f32 v6, v6
    v_rcp_f32 v7, v7
    v_mul_f32 v0, v0, v171
    v_mul_f32 v1, v1, v175
    v_mul_f32 v2, v2, v179
    v_mul_f32 v3, v3, v183
    v_mul_f32 v4, v4, v187
    v_mul_f32 v5, v5, v191
    v_mul_f32 v6, v6, v195
    v_mul_f32 v7, v7, v199
    v_cvt_pk_bf16_f32 v28, v0, v1
    v_cvt_pk_bf16_f32 v29, v2, v3
    v_cvt_pk_bf16_f32 v30, v4, v5
    v_cvt_pk_bf16_f32 v31, v6, v7
    v_add_u32 v212, 35840, v210
    buffer_store_dwordx4 v[28:31], v212, s[32:35], 0 offen sc1
L_k45_end:
    s_endpgm
.section .rodata,"a"
.p2align 6
.amdhsa_kernel xform_kernel
  .amdhsa_next_free_vgpr 160
  .amdhsa_next_free_sgpr 96
  .amdhsa_accum_offset 160
  .amdhsa_group_segment_fixed_size 0
  .amdhsa_kernarg_size 56
  .amdhsa_user_sgpr_count 2
  .amdhsa_user_sgpr_kernarg_segment_ptr 1
  .amdhsa_system_sgpr_workgroup_id_x 1
  .amdhsa_float_denorm_mode_32 3
.end_amdhsa_kernel

.p2align 6
.amdhsa_kernel gemm_kernel
  .amdhsa_next_free_vgpr 256
  .amdhsa_next_free_sgpr 96
  .amdhsa_accum_offset 256
  .amdhsa_group_segment_fixed_size 0
  .amdhsa_kernarg_size 56
  .amdhsa_user_sgpr_count 2
  .amdhsa_user_sgpr_kernarg_segment_ptr 1
  .amdhsa_system_sgpr_workgroup_id_x 1
  .amdhsa_float_denorm_mode_32 3
.end_amdhsa_kernel

.p2align 6
.amdhsa_kernel final_kernel
  .amdhsa_next_free_vgpr 240
  .amdhsa_next_free_sgpr 96
  .amdhsa_accum_offset 240
  .amdhsa_group_segment_fixed_size 0
  .amdhsa_kernarg_size 56
  .amdhsa_user_sgpr_count 2
  .amdhsa_user_sgpr_kernarg_segment_ptr 1
  .amdhsa_system_sgpr_workgroup_id_x 1
  .amdhsa_float_denorm_mode_32 3
.end_amdhsa_kernel
```

```asm
; @launch kernel=xform_kernel grid=(256,1,1) block=(256,1,1) lds=12352
; @launch kernel=gemm_kernel grid=(256,1,1) block=(512,1,1) lds=155648
; @launch kernel=final_kernel grid=(224,1,1) block=(384,1,1) lds=33792
.amdgcn_target "amdgcn-amd-amdhsa--gfx950"
.text
.globl xform_kernel
.p2align 8
.type xform_kernel,@function
xform_kernel:
    s_cmp_ge_u32 s2, 256
    s_cbranch_scc1 L_k12_end
    s_load_dwordx4 s[4:7], s[0:1], 0
    s_load_dwordx4 s[36:39], s[0:1], 40
    v_and_b32 v208, 63, v0
    v_lshrrev_b32 v213, 6, v0
    v_and_b32 v209, 15, v208
    v_readfirstlane_b32 s10, v213
    v_lshrrev_b32 v210, 4, v208
    v_lshlrev_b32 v223, 4, v208
    v_mov_b32 v222, 0
    s_mov_b32 s30, 0x05040100
    s_mov_b32 s31, 0x07060302
    s_mov_b32 s32, 0x01000100
    s_mov_b32 s33, 0x03020302
    s_mov_b32 s40, s2
    s_add_u32 s42, s2, 256
    s_mov_b32 s41, 0
    s_mov_b32 s43, 0
    v_lshlrev_b32 v224, 14, v210
    v_lshl_add_u32 v224, v209, 4, v224
    v_lshlrev_b32 v225, 22, v210
    v_lshrrev_b32 v213, 2, v209
    v_lshl_add_u32 v225, v213, 6, v225
    v_and_b32 v213, 1, v209
    v_lshl_add_u32 v225, v213, 5, v225
    v_bfe_u32 v213, v209, 1, 1
    v_lshl_add_u32 v225, v213, 3, v225
    v_lshrrev_b32 v213, 2, v209
    s_mov_b32 s24, 688128
    v_mul_u32_u24 v226, s24, v213
    s_mov_b32 s24, 43008
    v_mad_u32_u24 v226, v210, s24, v226
    s_mov_b32 s24, 32768
    v_mul_u32_u24 v227, s24, v210
    s_waitcnt lgkmcnt(0)
    s_mov_b32 s16, s38
    s_and_b32 s17, s39, 0xffff
    s_mov_b32 s18, 268435456
    s_mov_b32 s19, 0x00020000
    s_mov_b32 s44, s36
    s_and_b32 s45, s37, 0xffff
    s_mov_b32 s46, 256
    s_mov_b32 s47, 0x00020000
    s_cmp_ge_u32 s40, 1696
    s_cbranch_scc1 L_ld_done0
    s_cmp_ge_u32 s40, 672
    s_cbranch_scc1 L_ld_w0
    s_cmp_ge_u32 s40, 336
    s_cselect_b32 s11, 1, 0
    s_mul_i32 s12, s11, 336
    s_sub_u32 s12, s40, s12
    s_and_b32 s13, s12, 7
    s_lshr_b32 s14, s12, 3
    s_lshl_b32 s14, s14, 2
    s_add_u32 s14, s14, s10
    s_mul_i32 s15, s11, 16384000
    s_add_u32 s34, s4, s15
    s_addc_u32 s35, s5, 0
    s_mov_b32 s20, s34
    s_and_b32 s21, s35, 0xffff
    s_mov_b32 s22, 16384000
    s_mov_b32 s23, 0x00020000
    s_mul_i32 s15, s14, 98304
    s_lshl_b32 s24, s13, 8
    s_add_u32 s15, s15, s24
    s_add_u32 s25, s15, 0
    buffer_load_dwordx4 v[0:3], v224, s[20:23], s25 offen
    s_add_u32 s25, s15, 2048
    buffer_load_dwordx4 v[4:7], v224, s[20:23], s25 offen
    s_add_u32 s25, s15, 4096
    buffer_load_dwordx4 v[8:11], v224, s[20:23], s25 offen
    s_add_u32 s25, s15, 6144
    buffer_load_dwordx4 v[12:15], v224, s[20:23], s25 offen
    s_add_u32 s25, s15, 8192
    buffer_load_dwordx4 v[16:19], v224, s[20:23], s25 offen
    s_add_u32 s25, s15, 10240
    buffer_load_dwordx4 v[20:23], v224, s[20:23], s25 offen
    s_add_u32 s25, s15, 12288
    buffer_load_dwordx4 v[24:27], v224, s[20:23], s25 offen
    s_add_u32 s25, s15, 14336
    buffer_load_dwordx4 v[28:31], v224, s[20:23], s25 offen
    s_add_u32 s25, s15, 65536
    buffer_load_dwordx4 v[32:35], v224, s[20:23], s25 offen
    s_add_u32 s25, s15, 67584
    buffer_load_dwordx4 v[36:39], v224, s[20:23], s25 offen
    s_add_u32 s25, s15, 69632
    buffer_load_dwordx4 v[40:43], v224, s[20:23], s25 offen
    s_add_u32 s25, s15, 71680
    buffer_load_dwordx4 v[44:47], v224, s[20:23], s25 offen
    s_add_u32 s25, s15, 73728
    buffer_load_dwordx4 v[48:51], v224, s[20:23], s25 offen
    s_add_u32 s25, s15, 75776
    buffer_load_dwordx4 v[52:55], v224, s[20:23], s25 offen
    s_add_u32 s25, s15, 77824
    buffer_load_dwordx4 v[56:59], v224, s[20:23], s25 offen
    s_add_u32 s25, s15, 79872
    buffer_load_dwordx4 v[60:63], v224, s[20:23], s25 offen
    s_branch L_ld_done0
L_ld_w0:
    s_sub_u32 s12, s40, 672
    s_and_b32 s13, s12, 3
    s_lshr_b32 s14, s12, 2
    s_lshl_b32 s14, s14, 2
    s_add_u32 s14, s14, s10
    s_mov_b32 s20, s6
    s_and_b32 s21, s7, 0xffff
    s_mov_b32 s22, 16252928
    s_mov_b32 s23, 0x00020000
    s_lshl_b32 s15, s14, 10
    s_lshl_b32 s24, s13, 8
    s_add_u32 s15, s15, s24
    s_add_u32 s25, s15, 0
    buffer_load_dwordx2 v[0:1], v225, s[20:23], s25 offen
    buffer_load_dwordx2 v[2:3], v225, s[20:23], s25 offen offset:16
    s_add_u32 s25, s15, 1048576
    buffer_load_dwordx2 v[4:5], v225, s[20:23], s25 offen
    buffer_load_dwordx2 v[6:7], v225, s[20:23], s25 offen offset:16
    s_add_u32 s25, s15, 2097152
    buffer_load_dwordx2 v[8:9], v225, s[20:23], s25 offen
    buffer_load_dwordx2 v[10:11], v225, s[20:23], s25 offen offset:16
    s_add_u32 s25, s15, 3145728
    buffer_load_dwordx2 v[12:13], v225, s[20:23], s25 offen
    buffer_load_dwordx2 v[14:15], v225, s[20:23], s25 offen offset:16
L_ld_done0:
    v_lshrrev_b32 v213, 2, v209
    v_lshlrev_b32 v213, 1, v213
    v_bfe_u32 v214, v209, 1, 1
    v_add_u32 v213, v213, v214
    s_lshl_b32 s24, s10, 3
    v_add_u32 v213, s24, v213
    v_lshl_add_u32 v213, v213, 1, 1
    v_and_b32 v214, 1, v209
    v_lshlrev_b32 v214, 5, v214
    v_lshlrev_b32 v215, 3, v210
    v_mad_u32_u24 v160, v213, v215, v214
    v_add_u32 v161, v160, v213
    v_add_u32 v162, v161, v213
    v_add_u32 v163, v162, v213
    v_add_u32 v164, v163, v213
    v_add_u32 v165, v164, v213
    v_add_u32 v166, v165, v213
    v_add_u32 v167, v166, v213
    v_and_b32 v160, 127, v160
    v_cvt_f32_u32 v160, v160
    v_mul_f32 v160, 0x3c000000, v160
    v_cos_f32 v160, v160
    v_and_b32 v161, 127, v161
    v_cvt_f32_u32 v161, v161
    v_mul_f32 v161, 0x3c000000, v161
    v_cos_f32 v161, v161
    v_and_b32 v162, 127, v162
    v_cvt_f32_u32 v162, v162
    v_mul_f32 v162, 0x3c000000, v162
    v_cos_f32 v162, v162
    v_and_b32 v163, 127, v163
    v_cvt_f32_u32 v163, v163
    v_mul_f32 v163, 0x3c000000, v163
    v_cos_f32 v163, v163
    v_and_b32 v164, 127, v164
    v_cvt_f32_u32 v164, v164
    v_mul_f32 v164, 0x3c000000, v164
    v_cos_f32 v164, v164
    v_and_b32 v165, 127, v165
    v_cvt_f32_u32 v165, v165
    v_mul_f32 v165, 0x3c000000, v165
    v_cos_f32 v165, v165
    v_and_b32 v166, 127, v166
    v_cvt_f32_u32 v166, v166
    v_mul_f32 v166, 0x3c000000, v166
    v_cos_f32 v166, v166
    v_and_b32 v167, 127, v167
    v_cvt_f32_u32 v167, v167
    v_mul_f32 v167, 0x3c000000, v167
    v_cos_f32 v167, v167
    v_cvt_pk_bf16_f32 v176, v160, v161
    v_cvt_pk_bf16_f32 v177, v162, v163
    v_cvt_pk_bf16_f32 v178, v164, v165
    v_cvt_pk_bf16_f32 v179, v166, v167
    s_lshl_b32 s24, s10, 11
    v_add_u32 v216, s24, v223
    ds_write_b128 v216, v[176:179] offset:0
    v_lshlrev_b32 v215, 3, v210
    v_add_u32 v215, 32, v215
    v_mad_u32_u24 v160, v213, v215, v214
    v_add_u32 v161, v160, v213
    v_add_u32 v162, v161, v213
    v_add_u32 v163, v162, v213
    v_add_u32 v164, v163, v213
    v_add_u32 v165, v164, v213
    v_add_u32 v166, v165, v213
    v_add_u32 v167, v166, v213
    v_and_b32 v160, 127, v160
    v_cvt_f32_u32 v160, v160
    v_mul_f32 v160, 0x3c000000, v160
    v_cos_f32 v160, v160
    v_and_b32 v161, 127, v161
    v_cvt_f32_u32 v161, v161
    v_mul_f32 v161, 0x3c000000, v161
    v_cos_f32 v161, v161
    v_and_b32 v162, 127, v162
    v_cvt_f32_u32 v162, v162
    v_mul_f32 v162, 0x3c000000, v162
    v_cos_f32 v162, v162
    v_and_b32 v163, 127, v163
    v_cvt_f32_u32 v163, v163
    v_mul_f32 v163, 0x3c000000, v163
    v_cos_f32 v163, v163
    v_and_b32 v164, 127, v164
    v_cvt_f32_u32 v164, v164
    v_mul_f32 v164, 0x3c000000, v164
    v_cos_f32 v164, v164
    v_and_b32 v165, 127, v165
    v_cvt_f32_u32 v165, v165
    v_mul_f32 v165, 0x3c000000, v165
    v_cos_f32 v165, v165
    v_and_b32 v166, 127, v166
    v_cvt_f32_u32 v166, v166
    v_mul_f32 v166, 0x3c000000, v166
    v_cos_f32 v166, v166
    v_and_b32 v167, 127, v167
    v_cvt_f32_u32 v167, v167
    v_mul_f32 v167, 0x3c000000, v167
    v_cos_f32 v167, v167
    v_cvt_pk_bf16_f32 v176, v160, v161
    v_cvt_pk_bf16_f32 v177, v162, v163
    v_cvt_pk_bf16_f32 v178, v164, v165
    v_cvt_pk_bf16_f32 v179, v166, v167
    s_lshl_b32 s24, s10, 11
    v_add_u32 v216, s24, v223
    ds_write_b128 v216, v[176:179] offset:1024
    v_lshlrev_b32 v215, 2, v210
    v_mad_u32_u24 v160, v213, v215, v214
    v_add_u32 v161, v160, v213
    v_add_u32 v162, v161, v213
    v_add_u32 v163, v162, v213
    v_and_b32 v160, 127, v160
    v_cvt_f32_u32 v160, v160
    v_mul_f32 v160, 0x3c000000, v160
    v_cos_f32 v160, v160
    v_and_b32 v161, 127, v161
    v_cvt_f32_u32 v161, v161
    v_mul_f32 v161, 0x3c000000, v161
    v_cos_f32 v161, v161
    v_and_b32 v162, 127, v162
    v_cvt_f32_u32 v162, v162
    v_mul_f32 v162, 0x3c000000, v162
    v_cos_f32 v162, v162
    v_and_b32 v163, 127, v163
    v_cvt_f32_u32 v163, v163
    v_mul_f32 v163, 0x3c000000, v163
    v_cos_f32 v163, v163
    v_cvt_pk_bf16_f32 v180, v160, v160
    v_lshlrev_b32 v181, 16, v180
    v_sub_f32 v181, v160, v181
    v_cvt_pk_bf16_f32 v181, v181, v181
    v_perm_b32 v176, v181, v180, s30
    v_cvt_pk_bf16_f32 v180, v161, v161
    v_lshlrev_b32 v181, 16, v180
    v_sub_f32 v181, v161, v181
    v_cvt_pk_bf16_f32 v181, v181, v181
    v_perm_b32 v177, v181, v180, s30
    v_cvt_pk_bf16_f32 v180, v162, v162
    v_lshlrev_b32 v181, 16, v180
    v_sub_f32 v181, v162, v181
    v_cvt_pk_bf16_f32 v181, v181, v181
    v_perm_b32 v178, v181, v180, s30
    v_cvt_pk_bf16_f32 v180, v163, v163
    v_lshlrev_b32 v181, 16, v180
    v_sub_f32 v181, v163, v181
    v_cvt_pk_bf16_f32 v181, v181, v181
    v_perm_b32 v179, v181, v180, s30
    s_lshl_b32 s24, s10, 10
    v_add_u32 v216, s24, v223
    ds_write_b128 v216, v[176:179] offset:8192
    s_waitcnt lgkmcnt(0)
    s_barrier
L_k12_loop:
    s_cmp_lg_u32 s10, 0
    s_cbranch_scc1 L_nofetch0
    v_mov_b32 v221, 1
    s_mov_b64 exec, 1
    buffer_atomic_add v221, v222, s[44:47], 0 offen sc0 sc1
    s_mov_b64 exec, -1
L_nofetch0:
    s_cmp_ge_u32 s42, 1696
    s_cbranch_scc1 L_ld_done1
    s_cmp_ge_u32 s42, 672
    s_cbranch_scc1 L_ld_w1
    s_cmp_ge_u32 s42, 336
    s_cselect_b32 s11, 1, 0
    s_mul_i32 s12, s11, 336
    s_sub_u32 s12, s42, s12
    s_and_b32 s13, s12, 7
    s_lshr_b32 s14, s12, 3
    s_lshl_b32 s14, s14, 2
    s_add_u32 s14, s14, s10
    s_mul_i32 s15, s11, 16384000
    s_add_u32 s34, s4, s15
    s_addc_u32 s35, s5, 0
    s_mov_b32 s20, s34
    s_and_b32 s21, s35, 0xffff
    s_mov_b32 s22, 16384000
    s_mov_b32 s23, 0x00020000
    s_mul_i32 s15, s14, 98304
    s_lshl_b32 s24, s13, 8
    s_add_u32 s15, s15, s24
    s_add_u32 s25, s15, 0
    buffer_load_dwordx4 v[64:67], v224, s[20:23], s25 offen
    s_add_u32 s25, s15, 2048
    buffer_load_dwordx4 v[68:71], v224, s[20:23], s25 offen
    s_add_u32 s25, s15, 4096
    buffer_load_dwordx4 v[72:75], v224, s[20:23], s25 offen
    s_add_u32 s25, s15, 6144
    buffer_load_dwordx4 v[76:79], v224, s[20:23], s25 offen
    s_add_u32 s25, s15, 8192
    buffer_load_dwordx4 v[80:83], v224, s[20:23], s25 offen
    s_add_u32 s25, s15, 10240
    buffer_load_dwordx4 v[84:87], v224, s[20:23], s25 offen
    s_add_u32 s25, s15, 12288
    buffer_load_dwordx4 v[88:91], v224, s[20:23], s25 offen
    s_add_u32 s25, s15, 14336
    buffer_load_dwordx4 v[92:95], v224, s[20:23], s25 offen
    s_add_u32 s25, s15, 65536
    buffer_load_dwordx4 v[96:99], v224, s[20:23], s25 offen
    s_add_u32 s25, s15, 67584
    buffer_load_dwordx4 v[100:103], v224, s[20:23], s25 offen
    s_add_u32 s25, s15, 69632
    buffer_load_dwordx4 v[104:107], v224, s[20:23], s25 offen
    s_add_u32 s25, s15, 71680
    buffer_load_dwordx4 v[108:111], v224, s[20:23], s25 offen
    s_add_u32 s25, s15, 73728
    buffer_load_dwordx4 v[112:115], v224, s[20:23], s25 offen
    s_add_u32 s25, s15, 75776
    buffer_load_dwordx4 v[116:119], v224, s[20:23], s25 offen
    s_add_u32 s25, s15, 77824
    buffer_load_dwordx4 v[120:123], v224, s[20:23], s25 offen
    s_add_u32 s25, s15, 79872
    buffer_load_dwordx4 v[124:127], v224, s[20:23], s25 offen
    s_branch L_ld_done1
L_ld_w1:
    s_sub_u32 s12, s42, 672
    s_and_b32 s13, s12, 3
    s_lshr_b32 s14, s12, 2
    s_lshl_b32 s14, s14, 2
    s_add_u32 s14, s14, s10
    s_mov_b32 s20, s6
    s_and_b32 s21, s7, 0xffff
    s_mov_b32 s22, 16252928
    s_mov_b32 s23, 0x00020000
    s_lshl_b32 s15, s14, 10
    s_lshl_b32 s24, s13, 8
    s_add_u32 s15, s15, s24
    s_add_u32 s25, s15, 0
    buffer_load_dwordx2 v[64:65], v225, s[20:23], s25 offen
    buffer_load_dwordx2 v[66:67], v225, s[20:23], s25 offen offset:16
    s_add_u32 s25, s15, 1048576
    buffer_load_dwordx2 v[68:69], v225, s[20:23], s25 offen
    buffer_load_dwordx2 v[70:71], v225, s[20:23], s25 offen offset:16
    s_add_u32 s25, s15, 2097152
    buffer_load_dwordx2 v[72:73], v225, s[20:23], s25 offen
    buffer_load_dwordx2 v[74:75], v225, s[20:23], s25 offen offset:16
    s_add_u32 s25, s15, 3145728
    buffer_load_dwordx2 v[76:77], v225, s[20:23], s25 offen
    buffer_load_dwordx2 v[78:79], v225, s[20:23], s25 offen offset:16
L_ld_done1:
    s_cmp_lg_u32 s43, 0
    s_cbranch_scc1 L_notfirst
    s_cmp_ge_u32 s42, 1696
    s_cbranch_scc1 L_w0_f
    s_cmp_ge_u32 s42, 672
    s_cbranch_scc1 L_w8_f
    s_waitcnt vmcnt(16)
    s_branch L_wd_f
L_w8_f:
    s_waitcnt vmcnt(8)
    s_branch L_wd_f
L_w0_f:
    s_waitcnt vmcnt(0)
L_wd_f:
    s_mov_b32 s43, 1
    s_branch L_wfin
L_notfirst:
    s_cmp_ge_u32 s42, 1696
    s_cbranch_scc1 L_w0_a0
    s_cmp_ge_u32 s42, 672
    s_cbranch_scc1 L_w8_a0
    s_waitcnt vmcnt(32)
    s_branch L_wd_a0
L_w8_a0:
    s_waitcnt vmcnt(24)
    s_branch L_wd_a0
L_w0_a0:
    s_waitcnt vmcnt(16)
L_wd_a0:
L_wfin:
    s_cmp_ge_u32 s40, 672
    s_cbranch_scc1 L_cw0
    s_cmp_ge_u32 s40, 336
    s_cselect_b32 s11, 1, 0
    s_mul_i32 s12, s11, 336
    s_sub_u32 s12, s40, s12
    s_and_b32 s13, s12, 7
    s_lshr_b32 s14, s12, 3
    s_lshl_b32 s14, s14, 2
    s_add_u32 s14, s14, s10
    ds_read_b128 v[128:131], v223 offset:0
    ds_read_b128 v[132:135], v223 offset:1024
    ds_read_b128 v[136:139], v223 offset:2048
    ds_read_b128 v[140:143], v223 offset:3072
    ds_read_b128 v[144:147], v223 offset:4096
    ds_read_b128 v[148:151], v223 offset:5120
    ds_read_b128 v[152:155], v223 offset:6144
    ds_read_b128 v[156:159], v223 offset:7168
    s_bfe_u32 s24, s14, 0x10003
    s_mul_i32 s24, s24, 3
    v_and_b32 v213, 3, v209
    v_xor_b32 v213, s24, v213
    v_lshl_add_u32 v212, v213, 4, v226
    s_mul_i32 s24, s11, 22020096
    s_mul_i32 s25, s13, 2752512
    s_add_u32 s24, s24, s25
    s_lshl_b32 s25, s14, 6
    s_add_u32 s24, s24, s25
    s_add_u32 s24, s24, 67108864
    v_perm_b32 v160, v4, v0, s30
    v_perm_b32 v161, v12, v8, s30
    v_perm_b32 v162, v20, v16, s30
    v_perm_b32 v163, v28, v24, s30
    v_perm_b32 v164, v4, v0, s31
    v_perm_b32 v165, v12, v8, s31
    v_perm_b32 v166, v20, v16, s31
    v_perm_b32 v167, v28, v24, s31
    v_perm_b32 v168, v36, v32, s30
    v_perm_b32 v169, v44, v40, s30
    v_perm_b32 v170, v52, v48, s30
    v_perm_b32 v171, v60, v56, s30
    v_perm_b32 v172, v36, v32, s31
    v_perm_b32 v173, v44, v40, s31
    v_perm_b32 v174, v52, v48, s31
    v_perm_b32 v175, v60, v56, s31
    s_waitcnt lgkmcnt(0)
    v_mfma_f32_16x16x32_bf16 v[176:179], v[128:131], v[160:163], 0
    v_mfma_f32_16x16x32_bf16 v[180:183], v[128:131], v[164:167], 0
    v_mfma_f32_16x16x32_bf16 v[184:187], v[136:139], v[160:163], 0
    v_mfma_f32_16x16x32_bf16 v[188:191], v[136:139], v[164:167], 0
    v_mfma_f32_16x16x32_bf16 v[192:195], v[144:147], v[160:163], 0
    v_mfma_f32_16x16x32_bf16 v[196:199], v[144:147], v[164:167], 0
    v_mfma_f32_16x16x32_bf16 v[200:203], v[152:155], v[160:163], 0
    v_mfma_f32_16x16x32_bf16 v[204:207], v[152:155], v[164:167], 0
    v_mfma_f32_16x16x32_bf16 v[176:179], v[132:135], v[168:171], v[176:179]
    v_mfma_f32_16x16x32_bf16 v[180:183], v[132:135], v[172:175], v[180:183]
    v_mfma_f32_16x16x32_bf16 v[184:187], v[140:143], v[168:171], v[184:187]
    v_mfma_f32_16x16x32_bf16 v[188:191], v[140:143], v[172:175], v[188:191]
    v_mfma_f32_16x16x32_bf16 v[192:195], v[148:151], v[168:171], v[192:195]
    v_mfma_f32_16x16x32_bf16 v[196:199], v[148:151], v[172:175], v[196:199]
    v_mfma_f32_16x16x32_bf16 v[200:203], v[156:159], v[168:171], v[200:203]
    v_mfma_f32_16x16x32_bf16 v[204:207], v[156:159], v[172:175], v[204:207]
    v_perm_b32 v160, v5, v1, s30
    v_perm_b32 v161, v13, v9, s30
    v_perm_b32 v162, v21, v17, s30
    v_perm_b32 v163, v29, v25, s30
    v_perm_b32 v164, v5, v1, s31
    v_perm_b32 v165, v13, v9, s31
    v_perm_b32 v166, v21, v17, s31
    v_perm_b32 v167, v29, v25, s31
    v_perm_b32 v168, v37, v33, s30
    v_perm_b32 v169, v45, v41, s30
    v_perm_b32 v170, v53, v49, s30
    v_perm_b32 v171, v61, v57, s30
    v_perm_b32 v172, v37, v33, s31
    v_perm_b32 v173, v45, v41, s31
    v_perm_b32 v174, v53, v49, s31
    v_perm_b32 v175, v61, v57, s31
    v_cvt_pk_bf16_f32 v0, v176, v180
    v_cvt_pk_bf16_f32 v4, v177, v181
    v_cvt_pk_bf16_f32 v8, v178, v182
    v_cvt_pk_bf16_f32 v12, v179, v183
    v_cvt_pk_bf16_f32 v16, v184, v188
    v_cvt_pk_bf16_f32 v20, v185, v189
    v_cvt_pk_bf16_f32 v24, v186, v190
    v_cvt_pk_bf16_f32 v28, v187, v191
    v_cvt_pk_bf16_f32 v32, v192, v196
    v_cvt_pk_bf16_f32 v36, v193, v197
    v_cvt_pk_bf16_f32 v40, v194, v198
    v_cvt_pk_bf16_f32 v44, v195, v199
    v_cvt_pk_bf16_f32 v48, v200, v204
    v_cvt_pk_bf16_f32 v52, v201, v205
    v_cvt_pk_bf16_f32 v56, v202, v206
    v_cvt_pk_bf16_f32 v60, v203, v207
    v_mfma_f32_16x16x32_bf16 v[176:179], v[128:131], v[160:163], 0
    v_mfma_f32_16x16x32_bf16 v[180:183], v[128:131], v[164:167], 0
    v_mfma_f32_16x16x32_bf16 v[184:187], v[136:139], v[160:163], 0
    v_mfma_f32_16x16x32_bf16 v[188:191], v[136:139], v[164:167], 0
    v_mfma_f32_16x16x32_bf16 v[192:195], v[144:147], v[160:163], 0
    v_mfma_f32_16x16x32_bf16 v[196:199], v[144:147], v[164:167], 0
    v_mfma_f32_16x16x32_bf16 v[200:203], v[152:155], v[160:163], 0
    v_mfma_f32_16x16x32_bf16 v[204:207], v[152:155], v[164:167], 0
    v_mfma_f32_16x16x32_bf16 v[176:179], v[132:135], v[168:171], v[176:179]
    v_mfma_f32_16x16x32_bf16 v[180:183], v[132:135], v[172:175], v[180:183]
    v_mfma_f32_16x16x32_bf16 v[184:187], v[140:143], v[168:171], v[184:187]
    v_mfma_f32_16x16x32_bf16 v[188:191], v[140:143], v[172:175], v[188:191]
    v_mfma_f32_16x16x32_bf16 v[192:195], v[148:151], v[168:171], v[192:195]
    v_mfma_f32_16x16x32_bf16 v[196:199], v[148:151], v[172:175], v[196:199]
    v_mfma_f32_16x16x32_bf16 v[200:203], v[156:159], v[168:171], v[200:203]
    v_mfma_f32_16x16x32_bf16 v[204:207], v[156:159], v[172:175], v[204:207]
    v_perm_b32 v160, v6, v2, s30
    v_perm_b32 v161, v14, v10, s30
    v_perm_b32 v162, v22, v18, s30
    v_perm_b32 v163, v30, v26, s30
    v_perm_b32 v164, v6, v2, s31
    v_perm_b32 v165, v14, v10, s31
    v_perm_b32 v166, v22, v18, s31
    v_perm_b32 v167, v30, v26, s31
    v_perm_b32 v168, v38, v34, s30
    v_perm_b32 v169, v46, v42, s30
    v_perm_b32 v170, v54, v50, s30
    v_perm_b32 v171, v62, v58, s30
    v_perm_b32 v172, v38, v34, s31
    v_perm_b32 v173, v46, v42, s31
    v_perm_b32 v174, v54, v50, s31
    v_perm_b32 v175, v62, v58, s31
    v_cvt_pk_bf16_f32 v1, v176, v180
    v_cvt_pk_bf16_f32 v5, v177, v181
    v_cvt_pk_bf16_f32 v9, v178, v182
    v_cvt_pk_bf16_f32 v13, v179, v183
    v_cvt_pk_bf16_f32 v17, v184, v188
    v_cvt_pk_bf16_f32 v21, v185, v189
    v_cvt_pk_bf16_f32 v25, v186, v190
    v_cvt_pk_bf16_f32 v29, v187, v191
    v_cvt_pk_bf16_f32 v33, v192, v196
    v_cvt_pk_bf16_f32 v37, v193, v197
    v_cvt_pk_bf16_f32 v41, v194, v198
    v_cvt_pk_bf16_f32 v45, v195, v199
    v_cvt_pk_bf16_f32 v49, v200, v204
    v_cvt_pk_bf16_f32 v53, v201, v205
    v_cvt_pk_bf16_f32 v57, v202, v206
    v_cvt_pk_bf16_f32 v61, v203, v207
    v_mfma_f32_16x16x32_bf16 v[176:179], v[128:131], v[160:163], 0
    v_mfma_f32_16x16x32_bf16 v[180:183], v[128:131], v[164:167], 0
    v_mfma_f32_16x16x32_bf16 v[184:187], v[136:139], v[160:163], 0
    v_mfma_f32_16x16x32_bf16 v[188:191], v[136:139], v[164:167], 0
    v_mfma_f32_16x16x32_bf16 v[192:195], v[144:147], v[160:163], 0
    v_mfma_f32_16x16x32_bf16 v[196:199], v[144:147], v[164:167], 0
    v_mfma_f32_16x16x32_bf16 v[200:203], v[152:155], v[160:163], 0
    v_mfma_f32_16x16x32_bf16 v[204:207], v[152:155], v[164:167], 0
    v_mfma_f32_16x16x32_bf16 v[176:179], v[132:135], v[168:171], v[176:179]
    v_mfma_f32_16x16x32_bf16 v[180:183], v[132:135], v[172:175], v[180:183]
    v_mfma_f32_16x16x32_bf16 v[184:187], v[140:143], v[168:171], v[184:187]
    v_mfma_f32_16x16x32_bf16 v[188:191], v[140:143], v[172:175], v[188:191]
    v_mfma_f32_16x16x32_bf16 v[192:195], v[148:151], v[168:171], v[192:195]
    v_mfma_f32_16x16x32_bf16 v[196:199], v[148:151], v[172:175], v[196:199]
    v_mfma_f32_16x16x32_bf16 v[200:203], v[156:159], v[168:171], v[200:203]
    v_mfma_f32_16x16x32_bf16 v[204:207], v[156:159], v[172:175], v[204:207]
    v_perm_b32 v160, v7, v3, s30
    v_perm_b32 v161, v15, v11, s30
    v_perm_b32 v162, v23, v19, s30
    v_perm_b32 v163, v31, v27, s30
    v_perm_b32 v164, v7, v3, s31
    v_perm_b32 v165, v15, v11, s31
    v_perm_b32 v166, v23, v19, s31
    v_perm_b32 v167, v31, v27, s31
    v_perm_b32 v168, v39, v35, s30
    v_perm_b32 v169, v47, v43, s30
    v_perm_b32 v170, v55, v51, s30
    v_perm_b32 v171, v63, v59, s30
    v_perm_b32 v172, v39, v35, s31
    v_perm_b32 v173, v47, v43, s31
    v_perm_b32 v174, v55, v51, s31
    v_perm_b32 v175, v63, v59, s31
    v_cvt_pk_bf16_f32 v2, v176, v180
    v_cvt_pk_bf16_f32 v6, v177, v181
    v_cvt_pk_bf16_f32 v10, v178, v182
    v_cvt_pk_bf16_f32 v14, v179, v183
    v_cvt_pk_bf16_f32 v18, v184, v188
    v_cvt_pk_bf16_f32 v22, v185, v189
    v_cvt_pk_bf16_f32 v26, v186, v190
    v_cvt_pk_bf16_f32 v30, v187, v191
    v_cvt_pk_bf16_f32 v34, v192, v196
    v_cvt_pk_bf16_f32 v38, v193, v197
    v_cvt_pk_bf16_f32 v42, v194, v198
    v_cvt_pk_bf16_f32 v46, v195, v199
    v_cvt_pk_bf16_f32 v50, v200, v204
    v_cvt_pk_bf16_f32 v54, v201, v205
    v_cvt_pk_bf16_f32 v58, v202, v206
    v_cvt_pk_bf16_f32 v62, v203, v207
    v_mfma_f32_16x16x32_bf16 v[176:179], v[128:131], v[160:163], 0
    v_mfma_f32_16x16x32_bf16 v[180:183], v[128:131], v[164:167], 0
    v_mfma_f32_16x16x32_bf16 v[184:187], v[136:139], v[160:163], 0
    v_mfma_f32_16x16x32_bf16 v[188:191], v[136:139], v[164:167], 0
    v_mfma_f32_16x16x32_bf16 v[192:195], v[144:147], v[160:163], 0
    v_mfma_f32_16x16x32_bf16 v[196:199], v[144:147], v[164:167], 0
    v_mfma_f32_16x16x32_bf16 v[200:203], v[152:155], v[160:163], 0
    v_mfma_f32_16x16x32_bf16 v[204:207], v[152:155], v[164:167], 0
    v_mfma_f32_16x16x32_bf16 v[176:179], v[132:135], v[168:171], v[176:179]
    v_mfma_f32_16x16x32_bf16 v[180:183], v[132:135], v[172:175], v[180:183]
    v_mfma_f32_16x16x32_bf16 v[184:187], v[140:143], v[168:171], v[184:187]
    v_mfma_f32_16x16x32_bf16 v[188:191], v[140:143], v[172:175], v[188:191]
    v_mfma_f32_16x16x32_bf16 v[192:195], v[148:151], v[168:171], v[192:195]
    v_mfma_f32_16x16x32_bf16 v[196:199], v[148:151], v[172:175], v[196:199]
    v_mfma_f32_16x16x32_bf16 v[200:203], v[156:159], v[168:171], v[200:203]
    v_mfma_f32_16x16x32_bf16 v[204:207], v[156:159], v[172:175], v[204:207]
    s_nop 1
    v_cvt_pk_bf16_f32 v3, v176, v180
    v_cvt_pk_bf16_f32 v7, v177, v181
    v_cvt_pk_bf16_f32 v11, v178, v182
    v_cvt_pk_bf16_f32 v15, v179, v183
    v_cvt_pk_bf16_f32 v19, v184, v188
    v_cvt_pk_bf16_f32 v23, v185, v189
    v_cvt_pk_bf16_f32 v27, v186, v190
    v_cvt_pk_bf16_f32 v31, v187, v191
    v_cvt_pk_bf16_f32 v35, v192, v196
    v_cvt_pk_bf16_f32 v39, v193, v197
    v_cvt_pk_bf16_f32 v43, v194, v198
    v_cvt_pk_bf16_f32 v47, v195, v199
    v_cvt_pk_bf16_f32 v51, v200, v204
    v_cvt_pk_bf16_f32 v55, v201, v205
    v_cvt_pk_bf16_f32 v59, v202, v206
    v_cvt_pk_bf16_f32 v63, v203, v207
    s_add_u32 s25, s24, 0
    buffer_store_dwordx4 v[0:3], v212, s[16:19], s25 offen sc1
    s_add_u32 s25, s24, 10752
    buffer_store_dwordx4 v[4:7], v212, s[16:19], s25 offen sc1
    s_add_u32 s25, s24, 21504
    buffer_store_dwordx4 v[8:11], v212, s[16:19], s25 offen sc1
    s_add_u32 s25, s24, 32256
    buffer_store_dwordx4 v[12:15], v212, s[16:19], s25 offen sc1
    s_add_u32 s25, s24, 172032
    buffer_store_dwordx4 v[16:19], v212, s[16:19], s25 offen sc1
    s_add_u32 s25, s24, 182784
    buffer_store_dwordx4 v[20:23], v212, s[16:19], s25 offen sc1
    s_add_u32 s25, s24, 193536
    buffer_store_dwordx4 v[24:27], v212, s[16:19], s25 offen sc1
    s_add_u32 s25, s24, 204288
    buffer_store_dwordx4 v[28:31], v212, s[16:19], s25 offen sc1
    s_add_u32 s25, s24, 344064
    buffer_store_dwordx4 v[32:35], v212, s[16:19], s25 offen sc1
    s_add_u32 s25, s24, 354816
    buffer_store_dwordx4 v[36:39], v212, s[16:19], s25 offen sc1
    s_add_u32 s25, s24, 365568
    buffer_store_dwordx4 v[40:43], v212, s[16:19], s25 offen sc1
    s_add_u32 s25, s24, 376320
    buffer_store_dwordx4 v[44:47], v212, s[16:19], s25 offen sc1
    s_add_u32 s25, s24, 516096
    buffer_store_dwordx4 v[48:51], v212, s[16:19], s25 offen sc1
    s_add_u32 s25, s24, 526848
    buffer_store_dwordx4 v[52:55], v212, s[16:19], s25 offen sc1
    s_add_u32 s25, s24, 537600
    buffer_store_dwordx4 v[56:59], v212, s[16:19], s25 offen sc1
    s_add_u32 s25, s24, 548352
    buffer_store_dwordx4 v[60:63], v212, s[16:19], s25 offen sc1
    s_branch L_next0
L_cw0:
    s_sub_u32 s12, s40, 672
    s_and_b32 s13, s12, 3
    s_lshr_b32 s14, s12, 2
    s_lshl_b32 s14, s14, 2
    s_add_u32 s14, s14, s10
    ds_read_b128 v[128:131], v223 offset:8192
    ds_read_b128 v[132:135], v223 offset:9216
    ds_read_b128 v[136:139], v223 offset:10240
    ds_read_b128 v[140:143], v223 offset:11264
    s_and_b32 s24, s14, 3
    s_bfe_u32 s25, s14, 0x10003
    s_lshl_b32 s25, s25, 2
    s_or_b32 s24, s24, s25
    s_lshl_b32 s24, s24, 1
    v_xor_b32 v213, s24, v209
    v_lshl_add_u32 v212, v213, 4, v227
    s_mul_i32 s24, s13, 16777216
    s_lshr_b32 s25, s14, 5
    s_mul_i32 s25, s25, 524288
    s_add_u32 s24, s24, s25
    s_and_b32 s25, s14, 31
    s_lshl_b32 s25, s25, 8
    s_add_u32 s24, s24, s25
    v_perm_b32 v16, v0, v0, s32
    v_perm_b32 v17, v4, v4, s32
    v_perm_b32 v18, v8, v8, s32
    v_perm_b32 v19, v12, v12, s32
    v_perm_b32 v20, v0, v0, s33
    v_perm_b32 v21, v4, v4, s33
    v_perm_b32 v22, v8, v8, s33
    v_perm_b32 v23, v12, v12, s33
    v_perm_b32 v24, v1, v1, s32
    v_perm_b32 v25, v5, v5, s32
    v_perm_b32 v26, v9, v9, s32
    v_perm_b32 v27, v13, v13, s32
    v_perm_b32 v28, v1, v1, s33
    v_perm_b32 v29, v5, v5, s33
    v_perm_b32 v30, v9, v9, s33
    v_perm_b32 v31, v13, v13, s33
    v_perm_b32 v32, v2, v2, s32
    v_perm_b32 v33, v6, v6, s32
    v_perm_b32 v34, v10, v10, s32
    v_perm_b32 v35, v14, v14, s32
    v_perm_b32 v36, v2, v2, s33
    v_perm_b32 v37, v6, v6, s33
    v_perm_b32 v38, v10, v10, s33
    v_perm_b32 v39, v14, v14, s33
    v_perm_b32 v40, v3, v3, s32
    v_perm_b32 v41, v7, v7, s32
    v_perm_b32 v42, v11, v11, s32
    v_perm_b32 v43, v15, v15, s32
    v_perm_b32 v44, v3, v3, s33
    v_perm_b32 v45, v7, v7, s33
    v_perm_b32 v46, v11, v11, s33
    v_perm_b32 v47, v15, v15, s33
    s_waitcnt lgkmcnt(0)
    v_mfma_f32_16x16x32_bf16 v[176:179], v[128:131], v[16:19], 0
    v_mfma_f32_16x16x32_bf16 v[180:183], v[128:131], v[20:23], 0
    v_mfma_f32_16x16x32_bf16 v[184:187], v[128:131], v[24:27], 0
    v_mfma_f32_16x16x32_bf16 v[188:191], v[128:131], v[28:31], 0
    v_mfma_f32_16x16x32_bf16 v[192:195], v[128:131], v[32:35], 0
    v_mfma_f32_16x16x32_bf16 v[196:199], v[128:131], v[36:39], 0
    v_mfma_f32_16x16x32_bf16 v[200:203], v[128:131], v[40:43], 0
    v_mfma_f32_16x16x32_bf16 v[204:207], v[128:131], v[44:47], 0
    s_nop 1
    v_cvt_pk_bf16_f32 v0, v176, v180
    s_nop 0
    v_cvt_pk_bf16_f32 v1, v184, v188
    s_nop 0
    v_cvt_pk_bf16_f32 v2, v192, v196
    s_nop 0
    v_cvt_pk_bf16_f32 v3, v200, v204
    v_cvt_pk_bf16_f32 v4, v177, v181
    v_cvt_pk_bf16_f32 v5, v185, v189
    v_cvt_pk_bf16_f32 v6, v193, v197
    v_cvt_pk_bf16_f32 v7, v201, v205
    v_cvt_pk_bf16_f32 v8, v178, v182
    v_cvt_pk_bf16_f32 v9, v186, v190
    v_cvt_pk_bf16_f32 v10, v194, v198
    v_cvt_pk_bf16_f32 v11, v202, v206
    v_cvt_pk_bf16_f32 v12, v179, v183
    v_cvt_pk_bf16_f32 v13, v187, v191
    v_cvt_pk_bf16_f32 v14, v195, v199
    v_cvt_pk_bf16_f32 v15, v203, v207
    s_add_u32 s25, s24, 0
    buffer_store_dwordx4 v[0:3], v212, s[16:19], s25 offen sc1
    s_add_u32 s25, s24, 8192
    buffer_store_dwordx4 v[4:7], v212, s[16:19], s25 offen sc1
    s_add_u32 s25, s24, 16384
    buffer_store_dwordx4 v[8:11], v212, s[16:19], s25 offen sc1
    s_add_u32 s25, s24, 24576
    buffer_store_dwordx4 v[12:15], v212, s[16:19], s25 offen sc1
    v_mfma_f32_16x16x32_bf16 v[176:179], v[132:135], v[16:19], 0
    v_mfma_f32_16x16x32_bf16 v[180:183], v[132:135], v[20:23], 0
    v_mfma_f32_16x16x32_bf16 v[184:187], v[132:135], v[24:27], 0
    v_mfma_f32_16x16x32_bf16 v[188:191], v[132:135], v[28:31], 0
    v_mfma_f32_16x16x32_bf16 v[192:195], v[132:135], v[32:35], 0
    v_mfma_f32_16x16x32_bf16 v[196:199], v[132:135], v[36:39], 0
    v_mfma_f32_16x16x32_bf16 v[200:203], v[132:135], v[40:43], 0
    v_mfma_f32_16x16x32_bf16 v[204:207], v[132:135], v[44:47], 0
    s_nop 1
    v_cvt_pk_bf16_f32 v48, v176, v180
    s_nop 0
    v_cvt_pk_bf16_f32 v49, v184, v188
    s_nop 0
    v_cvt_pk_bf16_f32 v50, v192, v196
    s_nop 0
    v_cvt_pk_bf16_f32 v51, v200, v204
    v_cvt_pk_bf16_f32 v52, v177, v181
    v_cvt_pk_bf16_f32 v53, v185, v189
    v_cvt_pk_bf16_f32 v54, v193, v197
    v_cvt_pk_bf16_f32 v55, v201, v205
    v_cvt_pk_bf16_f32 v56, v178, v182
    v_cvt_pk_bf16_f32 v57, v186, v190
    v_cvt_pk_bf16_f32 v58, v194, v198
    v_cvt_pk_bf16_f32 v59, v202, v206
    v_cvt_pk_bf16_f32 v60, v179, v183
    v_cvt_pk_bf16_f32 v61, v187, v191
    v_cvt_pk_bf16_f32 v62, v195, v199
    v_cvt_pk_bf16_f32 v63, v203, v207
    s_add_u32 s25, s24, 131072
    buffer_store_dwordx4 v[48:51], v212, s[16:19], s25 offen sc1
    s_add_u32 s25, s24, 139264
    buffer_store_dwordx4 v[52:55], v212, s[16:19], s25 offen sc1
    s_add_u32 s25, s24, 147456
    buffer_store_dwordx4 v[56:59], v212, s[16:19], s25 offen sc1
    s_add_u32 s25, s24, 155648
    buffer_store_dwordx4 v[60:63], v212, s[16:19], s25 offen sc1
    v_mfma_f32_16x16x32_bf16 v[176:179], v[136:139], v[16:19], 0
    v_mfma_f32_16x16x32_bf16 v[180:183], v[136:139], v[20:23], 0
    v_mfma_f32_16x16x32_bf16 v[184:187], v[136:139], v[24:27], 0
    v_mfma_f32_16x16x32_bf16 v[188:191], v[136:139], v[28:31], 0
    v_mfma_f32_16x16x32_bf16 v[192:195], v[136:139], v[32:35], 0
    v_mfma_f32_16x16x32_bf16 v[196:199], v[136:139], v[36:39], 0
    v_mfma_f32_16x16x32_bf16 v[200:203], v[136:139], v[40:43], 0
    v_mfma_f32_16x16x32_bf16 v[204:207], v[136:139], v[44:47], 0
    s_nop 1
    v_cvt_pk_bf16_f32 v0, v176, v180
    s_nop 0
    v_cvt_pk_bf16_f32 v1, v184, v188
    s_nop 0
    v_cvt_pk_bf16_f32 v2, v192, v196
    s_nop 0
    v_cvt_pk_bf16_f32 v3, v200, v204
    v_cvt_pk_bf16_f32 v4, v177, v181
    v_cvt_pk_bf16_f32 v5, v185, v189
    v_cvt_pk_bf16_f32 v6, v193, v197
    v_cvt_pk_bf16_f32 v7, v201, v205
    v_cvt_pk_bf16_f32 v8, v178, v182
    v_cvt_pk_bf16_f32 v9, v186, v190
    v_cvt_pk_bf16_f32 v10, v194, v198
    v_cvt_pk_bf16_f32 v11, v202, v206
    v_cvt_pk_bf16_f32 v12, v179, v183
    v_cvt_pk_bf16_f32 v13, v187, v191
    v_cvt_pk_bf16_f32 v14, v195, v199
    v_cvt_pk_bf16_f32 v15, v203, v207
    s_add_u32 s25, s24, 262144
    buffer_store_dwordx4 v[0:3], v212, s[16:19], s25 offen sc1
    s_add_u32 s25, s24, 270336
    buffer_store_dwordx4 v[4:7], v212, s[16:19], s25 offen sc1
    s_add_u32 s25, s24, 278528
    buffer_store_dwordx4 v[8:11], v212, s[16:19], s25 offen sc1
    s_add_u32 s25, s24, 286720
    buffer_store_dwordx4 v[12:15], v212, s[16:19], s25 offen sc1
    v_mfma_f32_16x16x32_bf16 v[176:179], v[140:143], v[16:19], 0
    v_mfma_f32_16x16x32_bf16 v[180:183], v[140:143], v[20:23], 0
    v_mfma_f32_16x16x32_bf16 v[184:187], v[140:143], v[24:27], 0
    v_mfma_f32_16x16x32_bf16 v[188:191], v[140:143], v[28:31], 0
    v_mfma_f32_16x16x32_bf16 v[192:195], v[140:143], v[32:35], 0
    v_mfma_f32_16x16x32_bf16 v[196:199], v[140:143], v[36:39], 0
    v_mfma_f32_16x16x32_bf16 v[200:203], v[140:143], v[40:43], 0
    v_mfma_f32_16x16x32_bf16 v[204:207], v[140:143], v[44:47], 0
    s_nop 1
    v_cvt_pk_bf16_f32 v48, v176, v180
    s_nop 0
    v_cvt_pk_bf16_f32 v49, v184, v188
    s_nop 0
    v_cvt_pk_bf16_f32 v50, v192, v196
    s_nop 0
    v_cvt_pk_bf16_f32 v51, v200, v204
    v_cvt_pk_bf16_f32 v52, v177, v181
    v_cvt_pk_bf16_f32 v53, v185, v189
    v_cvt_pk_bf16_f32 v54, v193, v197
    v_cvt_pk_bf16_f32 v55, v201, v205
    v_cvt_pk_bf16_f32 v56, v178, v182
    v_cvt_pk_bf16_f32 v57, v186, v190
    v_cvt_pk_bf16_f32 v58, v194, v198
    v_cvt_pk_bf16_f32 v59, v202, v206
    v_cvt_pk_bf16_f32 v60, v179, v183
    v_cvt_pk_bf16_f32 v61, v187, v191
    v_cvt_pk_bf16_f32 v62, v195, v199
    v_cvt_pk_bf16_f32 v63, v203, v207
    s_add_u32 s25, s24, 393216
    buffer_store_dwordx4 v[48:51], v212, s[16:19], s25 offen sc1
    s_add_u32 s25, s24, 401408
    buffer_store_dwordx4 v[52:55], v212, s[16:19], s25 offen sc1
    s_add_u32 s25, s24, 409600
    buffer_store_dwordx4 v[56:59], v212, s[16:19], s25 offen sc1
    s_add_u32 s25, s24, 417792
    buffer_store_dwordx4 v[60:63], v212, s[16:19], s25 offen sc1
L_next0:
    s_cmp_lg_u32 s10, 0
    s_cbranch_scc1 L_pub0
    s_cmp_ge_u32 s42, 1696
    s_cbranch_scc1 L_w0_p0
    s_cmp_ge_u32 s42, 672
    s_cbranch_scc1 L_w8_p0
    s_waitcnt vmcnt(32)
    s_branch L_wd_p0
L_w8_p0:
    s_waitcnt vmcnt(24)
    s_branch L_wd_p0
L_w0_p0:
    s_waitcnt vmcnt(16)
L_wd_p0:
    v_add_u32 v221, 512, v221
    v_mov_b32 v213, s41
    s_mov_b64 exec, 1
    ds_write_b32 v213, v221 offset:12288
    s_mov_b64 exec, -1
L_pub0:
    s_waitcnt lgkmcnt(0)
    s_barrier
    v_mov_b32 v213, s41
    ds_read_b32 v214, v213 offset:12288
    s_xor_b32 s41, s41, 4
    s_mov_b32 s40, s42
    s_waitcnt lgkmcnt(0)
    v_readfirstlane_b32 s42, v214
    s_cmp_ge_u32 s40, 1696
    s_cbranch_scc1 L_k12_end
    s_cmp_lg_u32 s10, 0
    s_cbranch_scc1 L_nofetch1
    v_mov_b32 v221, 1
    s_mov_b64 exec, 1
    buffer_atomic_add v221, v222, s[44:47], 0 offen sc0 sc1
    s_mov_b64 exec, -1
L_nofetch1:
    s_cmp_ge_u32 s42, 1696
    s_cbranch_scc1 L_ld_done2
    s_cmp_ge_u32 s42, 672
    s_cbranch_scc1 L_ld_w2
    s_cmp_ge_u32 s42, 336
    s_cselect_b32 s11, 1, 0
    s_mul_i32 s12, s11, 336
    s_sub_u32 s12, s42, s12
    s_and_b32 s13, s12, 7
    s_lshr_b32 s14, s12, 3
    s_lshl_b32 s14, s14, 2
    s_add_u32 s14, s14, s10
    s_mul_i32 s15, s11, 16384000
    s_add_u32 s34, s4, s15
    s_addc_u32 s35, s5, 0
    s_mov_b32 s20, s34
    s_and_b32 s21, s35, 0xffff
    s_mov_b32 s22, 16384000
    s_mov_b32 s23, 0x00020000
    s_mul_i32 s15, s14, 98304
    s_lshl_b32 s24, s13, 8
    s_add_u32 s15, s15, s24
    s_add_u32 s25, s15, 0
    buffer_load_dwordx4 v[0:3], v224, s[20:23], s25 offen
    s_add_u32 s25, s15, 2048
    buffer_load_dwordx4 v[4:7], v224, s[20:23], s25 offen
    s_add_u32 s25, s15, 4096
    buffer_load_dwordx4 v[8:11], v224, s[20:23], s25 offen
    s_add_u32 s25, s15, 6144
    buffer_load_dwordx4 v[12:15], v224, s[20:23], s25 offen
    s_add_u32 s25, s15, 8192
    buffer_load_dwordx4 v[16:19], v224, s[20:23], s25 offen
    s_add_u32 s25, s15, 10240
    buffer_load_dwordx4 v[20:23], v224, s[20:23], s25 offen
    s_add_u32 s25, s15, 12288
    buffer_load_dwordx4 v[24:27], v224, s[20:23], s25 offen
    s_add_u32 s25, s15, 14336
    buffer_load_dwordx4 v[28:31], v224, s[20:23], s25 offen
    s_add_u32 s25, s15, 65536
    buffer_load_dwordx4 v[32:35], v224, s[20:23], s25 offen
    s_add_u32 s25, s15, 67584
    buffer_load_dwordx4 v[36:39], v224, s[20:23], s25 offen
    s_add_u32 s25, s15, 69632
    buffer_load_dwordx4 v[40:43], v224, s[20:23], s25 offen
    s_add_u32 s25, s15, 71680
    buffer_load_dwordx4 v[44:47], v224, s[20:23], s25 offen
    s_add_u32 s25, s15, 73728
    buffer_load_dwordx4 v[48:51], v224, s[20:23], s25 offen
    s_add_u32 s25, s15, 75776
    buffer_load_dwordx4 v[52:55], v224, s[20:23], s25 offen
    s_add_u32 s25, s15, 77824
    buffer_load_dwordx4 v[56:59], v224, s[20:23], s25 offen
    s_add_u32 s25, s15, 79872
    buffer_load_dwordx4 v[60:63], v224, s[20:23], s25 offen
    s_branch L_ld_done2
L_ld_w2:
    s_sub_u32 s12, s42, 672
    s_and_b32 s13, s12, 3
    s_lshr_b32 s14, s12, 2
    s_lshl_b32 s14, s14, 2
    s_add_u32 s14, s14, s10
    s_mov_b32 s20, s6
    s_and_b32 s21, s7, 0xffff
    s_mov_b32 s22, 16252928
    s_mov_b32 s23, 0x00020000
    s_lshl_b32 s15, s14, 10
    s_lshl_b32 s24, s13, 8
    s_add_u32 s15, s15, s24
    s_add_u32 s25, s15, 0
    buffer_load_dwordx2 v[0:1], v225, s[20:23], s25 offen
    buffer_load_dwordx2 v[2:3], v225, s[20:23], s25 offen offset:16
    s_add_u32 s25, s15, 1048576
    buffer_load_dwordx2 v[4:5], v225, s[20:23], s25 offen
    buffer_load_dwordx2 v[6:7], v225, s[20:23], s25 offen offset:16
    s_add_u32 s25, s15, 2097152
    buffer_load_dwordx2 v[8:9], v225, s[20:23], s25 offen
    buffer_load_dwordx2 v[10:11], v225, s[20:23], s25 offen offset:16
    s_add_u32 s25, s15, 3145728
    buffer_load_dwordx2 v[12:13], v225, s[20:23], s25 offen
    buffer_load_dwordx2 v[14:15], v225, s[20:23], s25 offen offset:16
L_ld_done2:
    s_cmp_ge_u32 s42, 1696
    s_cbranch_scc1 L_w0_a1
    s_cmp_ge_u32 s42, 672
    s_cbranch_scc1 L_w8_a1
    s_waitcnt vmcnt(32)
    s_branch L_wd_a1
L_w8_a1:
    s_waitcnt vmcnt(24)
    s_branch L_wd_a1
L_w0_a1:
    s_waitcnt vmcnt(16)
L_wd_a1:
    s_cmp_ge_u32 s40, 672
    s_cbranch_scc1 L_cw1
    s_cmp_ge_u32 s40, 336
    s_cselect_b32 s11, 1, 0
    s_mul_i32 s12, s11, 336
    s_sub_u32 s12, s40, s12
    s_and_b32 s13, s12, 7
    s_lshr_b32 s14, s12, 3
    s_lshl_b32 s14, s14, 2
    s_add_u32 s14, s14, s10
    ds_read_b128 v[128:131], v223 offset:0
    ds_read_b128 v[132:135], v223 offset:1024
    ds_read_b128 v[136:139], v223 offset:2048
    ds_read_b128 v[140:143], v223 offset:3072
    ds_read_b128 v[144:147], v223 offset:4096
    ds_read_b128 v[148:151], v223 offset:5120
    ds_read_b128 v[152:155], v223 offset:6144
    ds_read_b128 v[156:159], v223 offset:7168
    s_bfe_u32 s24, s14, 0x10003
    s_mul_i32 s24, s24, 3
    v_and_b32 v213, 3, v209
    v_xor_b32 v213, s24, v213
    v_lshl_add_u32 v212, v213, 4, v226
    s_mul_i32 s24, s11, 22020096
    s_mul_i32 s25, s13, 2752512
    s_add_u32 s24, s24, s25
    s_lshl_b32 s25, s14, 6
    s_add_u32 s24, s24, s25
    s_add_u32 s24, s24, 67108864
    v_perm_b32 v160, v68, v64, s30
    v_perm_b32 v161, v76, v72, s30
    v_perm_b32 v162, v84, v80, s30
    v_perm_b32 v163, v92, v88, s30
    v_perm_b32 v164, v68, v64, s31
    v_perm_b32 v165, v76, v72, s31
    v_perm_b32 v166, v84, v80, s31
    v_perm_b32 v167, v92, v88, s31
    v_perm_b32 v168, v100, v96, s30
    v_perm_b32 v169, v108, v104, s30
    v_perm_b32 v170, v116, v112, s30
    v_perm_b32 v171, v124, v120, s30
    v_perm_b32 v172, v100, v96, s31
    v_perm_b32 v173, v108, v104, s31
    v_perm_b32 v174, v116, v112, s31
    v_perm_b32 v175, v124, v120, s31
    s_waitcnt lgkmcnt(0)
    v_mfma_f32_16x16x32_bf16 v[176:179], v[128:131], v[160:163], 0
    v_mfma_f32_16x16x32_bf16 v[180:183], v[128:131], v[164:167], 0
    v_mfma_f32_16x16x32_bf16 v[184:187], v[136:139], v[160:163], 0
    v_mfma_f32_16x16x32_bf16 v[188:191], v[136:139], v[164:167], 0
    v_mfma_f32_16x16x32_bf16 v[192:195], v[144:147], v[160:163], 0
    v_mfma_f32_16x16x32_bf16 v[196:199], v[144:147], v[164:167], 0
    v_mfma_f32_16x16x32_bf16 v[200:203], v[152:155], v[160:163], 0
    v_mfma_f32_16x16x32_bf16 v[204:207], v[152:155], v[164:167], 0
    v_mfma_f32_16x16x32_bf16 v[176:179], v[132:135], v[168:171], v[176:179]
    v_mfma_f32_16x16x32_bf16 v[180:183], v[132:135], v[172:175], v[180:183]
    v_mfma_f32_16x16x32_bf16 v[184:187], v[140:143], v[168:171], v[184:187]
    v_mfma_f32_16x16x32_bf16 v[188:191], v[140:143], v[172:175], v[188:191]
    v_mfma_f32_16x16x32_bf16 v[192:195], v[148:151], v[168:171], v[192:195]
    v_mfma_f32_16x16x32_bf16 v[196:199], v[148:151], v[172:175], v[196:199]
    v_mfma_f32_16x16x32_bf16 v[200:203], v[156:159], v[168:171], v[200:203]
    v_mfma_f32_16x16x32_bf16 v[204:207], v[156:159], v[172:175], v[204:207]
    v_perm_b32 v160, v69, v65, s30
    v_perm_b32 v161, v77, v73, s30
    v_perm_b32 v162, v85, v81, s30
    v_perm_b32 v163, v93, v89, s30
    v_perm_b32 v164, v69, v65, s31
    v_perm_b32 v165, v77, v73, s31
    v_perm_b32 v166, v85, v81, s31
    v_perm_b32 v167, v93, v89, s31
    v_perm_b32 v168, v101, v97, s30
    v_perm_b32 v169, v109, v105, s30
    v_perm_b32 v170, v117, v113, s30
    v_perm_b32 v171, v125, v121, s30
    v_perm_b32 v172, v101, v97, s31
    v_perm_b32 v173, v109, v105, s31
    v_perm_b32 v174, v117, v113, s31
    v_perm_b32 v175, v125, v121, s31
    v_cvt_pk_bf16_f32 v64, v176, v180
    v_cvt_pk_bf16_f32 v68, v177, v181
    v_cvt_pk_bf16_f32 v72, v178, v182
    v_cvt_pk_bf16_f32 v76, v179, v183
    v_cvt_pk_bf16_f32 v80, v184, v188
    v_cvt_pk_bf16_f32 v84, v185, v189
    v_cvt_pk_bf16_f32 v88, v186, v190
    v_cvt_pk_bf16_f32 v92, v187, v191
    v_cvt_pk_bf16_f32 v96, v192, v196
    v_cvt_pk_bf16_f32 v100, v193, v197
    v_cvt_pk_bf16_f32 v104, v194, v198
    v_cvt_pk_bf16_f32 v108, v195, v199
    v_cvt_pk_bf16_f32 v112, v200, v204
    v_cvt_pk_bf16_f32 v116, v201, v205
    v_cvt_pk_bf16_f32 v120, v202, v206
    v_cvt_pk_bf16_f32 v124, v203, v207
    v_mfma_f32_16x16x32_bf16 v[176:179], v[128:131], v[160:163], 0
    v_mfma_f32_16x16x32_bf16 v[180:183], v[128:131], v[164:167], 0
    v_mfma_f32_16x16x32_bf16 v[184:187], v[136:139], v[160:163], 0
    v_mfma_f32_16x16x32_bf16 v[188:191], v[136:139], v[164:167], 0
    v_mfma_f32_16x16x32_bf16 v[192:195], v[144:147], v[160:163], 0
    v_mfma_f32_16x16x32_bf16 v[196:199], v[144:147], v[164:167], 0
    v_mfma_f32_16x16x32_bf16 v[200:203], v[152:155], v[160:163], 0
    v_mfma_f32_16x16x32_bf16 v[204:207], v[152:155], v[164:167], 0
    v_mfma_f32_16x16x32_bf16 v[176:179], v[132:135], v[168:171], v[176:179]
    v_mfma_f32_16x16x32_bf16 v[180:183], v[132:135], v[172:175], v[180:183]
    v_mfma_f32_16x16x32_bf16 v[184:187], v[140:143], v[168:171], v[184:187]
    v_mfma_f32_16x16x32_bf16 v[188:191], v[140:143], v[172:175], v[188:191]
    v_mfma_f32_16x16x32_bf16 v[192:195], v[148:151], v[168:171], v[192:195]
    v_mfma_f32_16x16x32_bf16 v[196:199], v[148:151], v[172:175], v[196:199]
    v_mfma_f32_16x16x32_bf16 v[200:203], v[156:159], v[168:171], v[200:203]
    v_mfma_f32_16x16x32_bf16 v[204:207], v[156:159], v[172:175], v[204:207]
    v_perm_b32 v160, v70, v66, s30
    v_perm_b32 v161, v78, v74, s30
    v_perm_b32 v162, v86, v82, s30
    v_perm_b32 v163, v94, v90, s30
    v_perm_b32 v164, v70, v66, s31
    v_perm_b32 v165, v78, v74, s31
    v_perm_b32 v166, v86, v82, s31
    v_perm_b32 v167, v94, v90, s31
    v_perm_b32 v168, v102, v98, s30
    v_perm_b32 v169, v110, v106, s30
    v_perm_b32 v170, v118, v114, s30
    v_perm_b32 v171, v126, v122, s30
    v_perm_b32 v172, v102, v98, s31
    v_perm_b32 v173, v110, v106, s31
    v_perm_b32 v174, v118, v114, s31
    v_perm_b32 v175, v126, v122, s31
    v_cvt_pk_bf16_f32 v65, v176, v180
    v_cvt_pk_bf16_f32 v69, v177, v181
    v_cvt_pk_bf16_f32 v73, v178, v182
    v_cvt_pk_bf16_f32 v77, v179, v183
    v_cvt_pk_bf16_f32 v81, v184, v188
    v_cvt_pk_bf16_f32 v85, v185, v189
    v_cvt_pk_bf16_f32 v89, v186, v190
    v_cvt_pk_bf16_f32 v93, v187, v191
    v_cvt_pk_bf16_f32 v97, v192, v196
    v_cvt_pk_bf16_f32 v101, v193, v197
    v_cvt_pk_bf16_f32 v105, v194, v198
    v_cvt_pk_bf16_f32 v109, v195, v199
    v_cvt_pk_bf16_f32 v113, v200, v204
    v_cvt_pk_bf16_f32 v117, v201, v205
    v_cvt_pk_bf16_f32 v121, v202, v206
    v_cvt_pk_bf16_f32 v125, v203, v207
    v_mfma_f32_16x16x32_bf16 v[176:179], v[128:131], v[160:163], 0
    v_mfma_f32_16x16x32_bf16 v[180:183], v[128:131], v[164:167], 0
    v_mfma_f32_16x16x32_bf16 v[184:187], v[136:139], v[160:163], 0
    v_mfma_f32_16x16x32_bf16 v[188:191], v[136:139], v[164:167], 0
    v_mfma_f32_16x16x32_bf16 v[192:195], v[144:147], v[160:163], 0
    v_mfma_f32_16x16x32_bf16 v[196:199], v[144:147], v[164:167], 0
    v_mfma_f32_16x16x32_bf16 v[200:203], v[152:155], v[160:163], 0
    v_mfma_f32_16x16x32_bf16 v[204:207], v[152:155], v[164:167], 0
    v_mfma_f32_16x16x32_bf16 v[176:179], v[132:135], v[168:171], v[176:179]
    v_mfma_f32_16x16x32_bf16 v[180:183], v[132:135], v[172:175], v[180:183]
    v_mfma_f32_16x16x32_bf16 v[184:187], v[140:143], v[168:171], v[184:187]
    v_mfma_f32_16x16x32_bf16 v[188:191], v[140:143], v[172:175], v[188:191]
    v_mfma_f32_16x16x32_bf16 v[192:195], v[148:151], v[168:171], v[192:195]
    v_mfma_f32_16x16x32_bf16 v[196:199], v[148:151], v[172:175], v[196:199]
    v_mfma_f32_16x16x32_bf16 v[200:203], v[156:159], v[168:171], v[200:203]
    v_mfma_f32_16x16x32_bf16 v[204:207], v[156:159], v[172:175], v[204:207]
    v_perm_b32 v160, v71, v67, s30
    v_perm_b32 v161, v79, v75, s30
    v_perm_b32 v162, v87, v83, s30
    v_perm_b32 v163, v95, v91, s30
    v_perm_b32 v164, v71, v67, s31
    v_perm_b32 v165, v79, v75, s31
    v_perm_b32 v166, v87, v83, s31
    v_perm_b32 v167, v95, v91, s31
    v_perm_b32 v168, v103, v99, s30
    v_perm_b32 v169, v111, v107, s30
    v_perm_b32 v170, v119, v115, s30
    v_perm_b32 v171, v127, v123, s30
    v_perm_b32 v172, v103, v99, s31
    v_perm_b32 v173, v111, v107, s31
    v_perm_b32 v174, v119, v115, s31
    v_perm_b32 v175, v127, v123, s31
    v_cvt_pk_bf16_f32 v66, v176, v180
    v_cvt_pk_bf16_f32 v70, v177, v181
    v_cvt_pk_bf16_f32 v74, v178, v182
    v_cvt_pk_bf16_f32 v78, v179, v183
    v_cvt_pk_bf16_f32 v82, v184, v188
    v_cvt_pk_bf16_f32 v86, v185, v189
    v_cvt_pk_bf16_f32 v90, v186, v190
    v_cvt_pk_bf16_f32 v94, v187, v191
    v_cvt_pk_bf16_f32 v98, v192, v196
    v_cvt_pk_bf16_f32 v102, v193, v197
    v_cvt_pk_bf16_f32 v106, v194, v198
    v_cvt_pk_bf16_f32 v110, v195, v199
    v_cvt_pk_bf16_f32 v114, v200, v204
    v_cvt_pk_bf16_f32 v118, v201, v205
    v_cvt_pk_bf16_f32 v122, v202, v206
    v_cvt_pk_bf16_f32 v126, v203, v207
    v_mfma_f32_16x16x32_bf16 v[176:179], v[128:131], v[160:163], 0
    v_mfma_f32_16x16x32_bf16 v[180:183], v[128:131], v[164:167], 0
    v_mfma_f32_16x16x32_bf16 v[184:187], v[136:139], v[160:163], 0
    v_mfma_f32_16x16x32_bf16 v[188:191], v[136:139], v[164:167], 0
    v_mfma_f32_16x16x32_bf16 v[192:195], v[144:147], v[160:163], 0
    v_mfma_f32_16x16x32_bf16 v[196:199], v[144:147], v[164:167], 0
    v_mfma_f32_16x16x32_bf16 v[200:203], v[152:155], v[160:163], 0
    v_mfma_f32_16x16x32_bf16 v[204:207], v[152:155], v[164:167], 0
    v_mfma_f32_16x16x32_bf16 v[176:179], v[132:135], v[168:171], v[176:179]
    v_mfma_f32_16x16x32_bf16 v[180:183], v[132:135], v[172:175], v[180:183]
    v_mfma_f32_16x16x32_bf16 v[184:187], v[140:143], v[168:171], v[184:187]
    v_mfma_f32_16x16x32_bf16 v[188:191], v[140:143], v[172:175], v[188:191]
    v_mfma_f32_16x16x32_bf16 v[192:195], v[148:151], v[168:171], v[192:195]
    v_mfma_f32_16x16x32_bf16 v[196:199], v[148:151], v[172:175], v[196:199]
    v_mfma_f32_16x16x32_bf16 v[200:203], v[156:159], v[168:171], v[200:203]
    v_mfma_f32_16x16x32_bf16 v[204:207], v[156:159], v[172:175], v[204:207]
    s_nop 1
    v_cvt_pk_bf16_f32 v67, v176, v180
    v_cvt_pk_bf16_f32 v71, v177, v181
    v_cvt_pk_bf16_f32 v75, v178, v182
    v_cvt_pk_bf16_f32 v79, v179, v183
    v_cvt_pk_bf16_f32 v83, v184, v188
    v_cvt_pk_bf16_f32 v87, v185, v189
    v_cvt_pk_bf16_f32 v91, v186, v190
    v_cvt_pk_bf16_f32 v95, v187, v191
    v_cvt_pk_bf16_f32 v99, v192, v196
    v_cvt_pk_bf16_f32 v103, v193, v197
    v_cvt_pk_bf16_f32 v107, v194, v198
    v_cvt_pk_bf16_f32 v111, v195, v199
    v_cvt_pk_bf16_f32 v115, v200, v204
    v_cvt_pk_bf16_f32 v119, v201, v205
    v_cvt_pk_bf16_f32 v123, v202, v206
    v_cvt_pk_bf16_f32 v127, v203, v207
    s_add_u32 s25, s24, 0
    buffer_store_dwordx4 v[64:67], v212, s[16:19], s25 offen sc1
    s_add_u32 s25, s24, 10752
    buffer_store_dwordx4 v[68:71], v212, s[16:19], s25 offen sc1
    s_add_u32 s25, s24, 21504
    buffer_store_dwordx4 v[72:75], v212, s[16:19], s25 offen sc1
    s_add_u32 s25, s24, 32256
    buffer_store_dwordx4 v[76:79], v212, s[16:19], s25 offen sc1
    s_add_u32 s25, s24, 172032
    buffer_store_dwordx4 v[80:83], v212, s[16:19], s25 offen sc1
    s_add_u32 s25, s24, 182784
    buffer_store_dwordx4 v[84:87], v212, s[16:19], s25 offen sc1
    s_add_u32 s25, s24, 193536
    buffer_store_dwordx4 v[88:91], v212, s[16:19], s25 offen sc1
    s_add_u32 s25, s24, 204288
    buffer_store_dwordx4 v[92:95], v212, s[16:19], s25 offen sc1
    s_add_u32 s25, s24, 344064
    buffer_store_dwordx4 v[96:99], v212, s[16:19], s25 offen sc1
    s_add_u32 s25, s24, 354816
    buffer_store_dwordx4 v[100:103], v212, s[16:19], s25 offen sc1
    s_add_u32 s25, s24, 365568
    buffer_store_dwordx4 v[104:107], v212, s[16:19], s25 offen sc1
    s_add_u32 s25, s24, 376320
    buffer_store_dwordx4 v[108:111], v212, s[16:19], s25 offen sc1
    s_add_u32 s25, s24, 516096
    buffer_store_dwordx4 v[112:115], v212, s[16:19], s25 offen sc1
    s_add_u32 s25, s24, 526848
    buffer_store_dwordx4 v[116:119], v212, s[16:19], s25 offen sc1
    s_add_u32 s25, s24, 537600
    buffer_store_dwordx4 v[120:123], v212, s[16:19], s25 offen sc1
    s_add_u32 s25, s24, 548352
    buffer_store_dwordx4 v[124:127], v212, s[16:19], s25 offen sc1
    s_branch L_next1
L_cw1:
    s_sub_u32 s12, s40, 672
    s_and_b32 s13, s12, 3
    s_lshr_b32 s14, s12, 2
    s_lshl_b32 s14, s14, 2
    s_add_u32 s14, s14, s10
    ds_read_b128 v[128:131], v223 offset:8192
    ds_read_b128 v[132:135], v223 offset:9216
    ds_read_b128 v[136:139], v223 offset:10240
    ds_read_b128 v[140:143], v223 offset:11264
    s_and_b32 s24, s14, 3
    s_bfe_u32 s25, s14, 0x10003
    s_lshl_b32 s25, s25, 2
    s_or_b32 s24, s24, s25
    s_lshl_b32 s24, s24, 1
    v_xor_b32 v213, s24, v209
    v_lshl_add_u32 v212, v213, 4, v227
    s_mul_i32 s24, s13, 16777216
    s_lshr_b32 s25, s14, 5
    s_mul_i32 s25, s25, 524288
    s_add_u32 s24, s24, s25
    s_and_b32 s25, s14, 31
    s_lshl_b32 s25, s25, 8
    s_add_u32 s24, s24, s25
    v_perm_b32 v80, v64, v64, s32
    v_perm_b32 v81, v68, v68, s32
    v_perm_b32 v82, v72, v72, s32
    v_perm_b32 v83, v76, v76, s32
    v_perm_b32 v84, v64, v64, s33
    v_perm_b32 v85, v68, v68, s33
    v_perm_b32 v86, v72, v72, s33
    v_perm_b32 v87, v76, v76, s33
    v_perm_b32 v88, v65, v65, s32
    v_perm_b32 v89, v69, v69, s32
    v_perm_b32 v90, v73, v73, s32
    v_perm_b32 v91, v77, v77, s32
    v_perm_b32 v92, v65, v65, s33
    v_perm_b32 v93, v69, v69, s33
    v_perm_b32 v94, v73, v73, s33
    v_perm_b32 v95, v77, v77, s33
    v_perm_b32 v96, v66, v66, s32
    v_perm_b32 v97, v70, v70, s32
    v_perm_b32 v98, v74, v74, s32
    v_perm_b32 v99, v78, v78, s32
    v_perm_b32 v100, v66, v66, s33
    v_perm_b32 v101, v70, v70, s33
    v_perm_b32 v102, v74, v74, s33
    v_perm_b32 v103, v78, v78, s33
    v_perm_b32 v104, v67, v67, s32
    v_perm_b32 v105, v71, v71, s32
    v_perm_b32 v106, v75, v75, s32
    v_perm_b32 v107, v79, v79, s32
    v_perm_b32 v108, v67, v67, s33
    v_perm_b32 v109, v71, v71, s33
    v_perm_b32 v110, v75, v75, s33
    v_perm_b32 v111, v79, v79, s33
    s_waitcnt lgkmcnt(0)
    v_mfma_f32_16x16x32_bf16 v[176:179], v[128:131], v[80:83], 0
    v_mfma_f32_16x16x32_bf16 v[180:183], v[128:131], v[84:87], 0
    v_mfma_f32_16x16x32_bf16 v[184:187], v[128:131], v[88:91], 0
    v_mfma_f32_16x16x32_bf16 v[188:191], v[128:131], v[92:95], 0
    v_mfma_f32_16x16x32_bf16 v[192:195], v[128:131], v[96:99], 0
    v_mfma_f32_16x16x32_bf16 v[196:199], v[128:131], v[100:103], 0
    v_mfma_f32_16x16x32_bf16 v[200:203], v[128:131], v[104:107], 0
    v_mfma_f32_16x16x32_bf16 v[204:207], v[128:131], v[108:111], 0
    s_nop 1
    v_cvt_pk_bf16_f32 v64, v176, v180
    s_nop 0
    v_cvt_pk_bf16_f32 v65, v184, v188
    s_nop 0
    v_cvt_pk_bf16_f32 v66, v192, v196
    s_nop 0
    v_cvt_pk_bf16_f32 v67, v200, v204
    v_cvt_pk_bf16_f32 v68, v177, v181
    v_cvt_pk_bf16_f32 v69, v185, v189
    v_cvt_pk_bf16_f32 v70, v193, v197
    v_cvt_pk_bf16_f32 v71, v201, v205
    v_cvt_pk_bf16_f32 v72, v178, v182
    v_cvt_pk_bf16_f32 v73, v186, v190
    v_cvt_pk_bf16_f32 v74, v194, v198
    v_cvt_pk_bf16_f32 v75, v202, v206
    v_cvt_pk_bf16_f32 v76, v179, v183
    v_cvt_pk_bf16_f32 v77, v187, v191
    v_cvt_pk_bf16_f32 v78, v195, v199
    v_cvt_pk_bf16_f32 v79, v203, v207
    s_add_u32 s25, s24, 0
    buffer_store_dwordx4 v[64:67], v212, s[16:19], s25 offen sc1
    s_add_u32 s25, s24, 8192
    buffer_store_dwordx4 v[68:71], v212, s[16:19], s25 offen sc1
    s_add_u32 s25, s24, 16384
    buffer_store_dwordx4 v[72:75], v212, s[16:19], s25 offen sc1
    s_add_u32 s25, s24, 24576
    buffer_store_dwordx4 v[76:79], v212, s[16:19], s25 offen sc1
    v_mfma_f32_16x16x32_bf16 v[176:179], v[132:135], v[80:83], 0
    v_mfma_f32_16x16x32_bf16 v[180:183], v[132:135], v[84:87], 0
    v_mfma_f32_16x16x32_bf16 v[184:187], v[132:135], v[88:91], 0
    v_mfma_f32_16x16x32_bf16 v[188:191], v[132:135], v[92:95], 0
    v_mfma_f32_16x16x32_bf16 v[192:195], v[132:135], v[96:99], 0
    v_mfma_f32_16x16x32_bf16 v[196:199], v[132:135], v[100:103], 0
    v_mfma_f32_16x16x32_bf16 v[200:203], v[132:135], v[104:107], 0
    v_mfma_f32_16x16x32_bf16 v[204:207], v[132:135], v[108:111], 0
    s_nop 1
    v_cvt_pk_bf16_f32 v112, v176, v180
    s_nop 0
    v_cvt_pk_bf16_f32 v113, v184, v188
    s_nop 0
    v_cvt_pk_bf16_f32 v114, v192, v196
    s_nop 0
    v_cvt_pk_bf16_f32 v115, v200, v204
    v_cvt_pk_bf16_f32 v116, v177, v181
    v_cvt_pk_bf16_f32 v117, v185, v189
    v_cvt_pk_bf16_f32 v118, v193, v197
    v_cvt_pk_bf16_f32 v119, v201, v205
    v_cvt_pk_bf16_f32 v120, v178, v182
    v_cvt_pk_bf16_f32 v121, v186, v190
    v_cvt_pk_bf16_f32 v122, v194, v198
    v_cvt_pk_bf16_f32 v123, v202, v206
    v_cvt_pk_bf16_f32 v124, v179, v183
    v_cvt_pk_bf16_f32 v125, v187, v191
    v_cvt_pk_bf16_f32 v126, v195, v199
    v_cvt_pk_bf16_f32 v127, v203, v207
    s_add_u32 s25, s24, 131072
    buffer_store_dwordx4 v[112:115], v212, s[16:19], s25 offen sc1
    s_add_u32 s25, s24, 139264
    buffer_store_dwordx4 v[116:119], v212, s[16:19], s25 offen sc1
    s_add_u32 s25, s24, 147456
    buffer_store_dwordx4 v[120:123], v212, s[16:19], s25 offen sc1
    s_add_u32 s25, s24, 155648
    buffer_store_dwordx4 v[124:127], v212, s[16:19], s25 offen sc1
    v_mfma_f32_16x16x32_bf16 v[176:179], v[136:139], v[80:83], 0
    v_mfma_f32_16x16x32_bf16 v[180:183], v[136:139], v[84:87], 0
    v_mfma_f32_16x16x32_bf16 v[184:187], v[136:139], v[88:91], 0
    v_mfma_f32_16x16x32_bf16 v[188:191], v[136:139], v[92:95], 0
    v_mfma_f32_16x16x32_bf16 v[192:195], v[136:139], v[96:99], 0
    v_mfma_f32_16x16x32_bf16 v[196:199], v[136:139], v[100:103], 0
    v_mfma_f32_16x16x32_bf16 v[200:203], v[136:139], v[104:107], 0
    v_mfma_f32_16x16x32_bf16 v[204:207], v[136:139], v[108:111], 0
    s_nop 1
    v_cvt_pk_bf16_f32 v64, v176, v180
    s_nop 0
    v_cvt_pk_bf16_f32 v65, v184, v188
    s_nop 0
    v_cvt_pk_bf16_f32 v66, v192, v196
    s_nop 0
    v_cvt_pk_bf16_f32 v67, v200, v204
    v_cvt_pk_bf16_f32 v68, v177, v181
    v_cvt_pk_bf16_f32 v69, v185, v189
    v_cvt_pk_bf16_f32 v70, v193, v197
    v_cvt_pk_bf16_f32 v71, v201, v205
    v_cvt_pk_bf16_f32 v72, v178, v182
    v_cvt_pk_bf16_f32 v73, v186, v190
    v_cvt_pk_bf16_f32 v74, v194, v198
    v_cvt_pk_bf16_f32 v75, v202, v206
    v_cvt_pk_bf16_f32 v76, v179, v183
    v_cvt_pk_bf16_f32 v77, v187, v191
    v_cvt_pk_bf16_f32 v78, v195, v199
    v_cvt_pk_bf16_f32 v79, v203, v207
    s_add_u32 s25, s24, 262144
    buffer_store_dwordx4 v[64:67], v212, s[16:19], s25 offen sc1
    s_add_u32 s25, s24, 270336
    buffer_store_dwordx4 v[68:71], v212, s[16:19], s25 offen sc1
    s_add_u32 s25, s24, 278528
    buffer_store_dwordx4 v[72:75], v212, s[16:19], s25 offen sc1
    s_add_u32 s25, s24, 286720
    buffer_store_dwordx4 v[76:79], v212, s[16:19], s25 offen sc1
    v_mfma_f32_16x16x32_bf16 v[176:179], v[140:143], v[80:83], 0
    v_mfma_f32_16x16x32_bf16 v[180:183], v[140:143], v[84:87], 0
    v_mfma_f32_16x16x32_bf16 v[184:187], v[140:143], v[88:91], 0
    v_mfma_f32_16x16x32_bf16 v[188:191], v[140:143], v[92:95], 0
    v_mfma_f32_16x16x32_bf16 v[192:195], v[140:143], v[96:99], 0
    v_mfma_f32_16x16x32_bf16 v[196:199], v[140:143], v[100:103], 0
    v_mfma_f32_16x16x32_bf16 v[200:203], v[140:143], v[104:107], 0
    v_mfma_f32_16x16x32_bf16 v[204:207], v[140:143], v[108:111], 0
    s_nop 1
    v_cvt_pk_bf16_f32 v112, v176, v180
    s_nop 0
    v_cvt_pk_bf16_f32 v113, v184, v188
    s_nop 0
    v_cvt_pk_bf16_f32 v114, v192, v196
    s_nop 0
    v_cvt_pk_bf16_f32 v115, v200, v204
    v_cvt_pk_bf16_f32 v116, v177, v181
    v_cvt_pk_bf16_f32 v117, v185, v189
    v_cvt_pk_bf16_f32 v118, v193, v197
    v_cvt_pk_bf16_f32 v119, v201, v205
    v_cvt_pk_bf16_f32 v120, v178, v182
    v_cvt_pk_bf16_f32 v121, v186, v190
    v_cvt_pk_bf16_f32 v122, v194, v198
    v_cvt_pk_bf16_f32 v123, v202, v206
    v_cvt_pk_bf16_f32 v124, v179, v183
    v_cvt_pk_bf16_f32 v125, v187, v191
    v_cvt_pk_bf16_f32 v126, v195, v199
    v_cvt_pk_bf16_f32 v127, v203, v207
    s_add_u32 s25, s24, 393216
    buffer_store_dwordx4 v[112:115], v212, s[16:19], s25 offen sc1
    s_add_u32 s25, s24, 401408
    buffer_store_dwordx4 v[116:119], v212, s[16:19], s25 offen sc1
    s_add_u32 s25, s24, 409600
    buffer_store_dwordx4 v[120:123], v212, s[16:19], s25 offen sc1
    s_add_u32 s25, s24, 417792
    buffer_store_dwordx4 v[124:127], v212, s[16:19], s25 offen sc1
L_next1:
    s_cmp_lg_u32 s10, 0
    s_cbranch_scc1 L_pub1
    s_cmp_ge_u32 s42, 1696
    s_cbranch_scc1 L_w0_p1
    s_cmp_ge_u32 s42, 672
    s_cbranch_scc1 L_w8_p1
    s_waitcnt vmcnt(32)
    s_branch L_wd_p1
L_w8_p1:
    s_waitcnt vmcnt(24)
    s_branch L_wd_p1
L_w0_p1:
    s_waitcnt vmcnt(16)
L_wd_p1:
    v_add_u32 v221, 512, v221
    v_mov_b32 v213, s41
    s_mov_b64 exec, 1
    ds_write_b32 v213, v221 offset:12288
    s_mov_b64 exec, -1
L_pub1:
    s_waitcnt lgkmcnt(0)
    s_barrier
    v_mov_b32 v213, s41
    ds_read_b32 v214, v213 offset:12288
    s_xor_b32 s41, s41, 4
    s_mov_b32 s40, s42
    s_waitcnt lgkmcnt(0)
    v_readfirstlane_b32 s42, v214
    s_cmp_ge_u32 s40, 1696
    s_cbranch_scc1 L_k12_end
    s_branch L_k12_loop
L_k12_end:
    s_endpgm
.globl gemm_kernel
.p2align 8
.type gemm_kernel,@function
gemm_kernel:
    s_cmp_ge_u32 s2, 256
    s_cbranch_scc1 L_k3_end
    s_load_dwordx2 s[8:9], s[0:1], 48
    v_lshrrev_b32 v253, 6, v0
    v_and_b32 v0, 63, v0
    v_readfirstlane_b32 s10, v253
    s_and_b32 s11, s2, 7
    s_lshr_b32 s12, s2, 3
    s_lshr_b32 s13, s12, 3
    s_lshl_b32 s11, s11, 2
    s_add_u32 s11, s11, s13
    s_bfe_u32 s13, s12, 0x10002
    s_and_b32 s14, s12, 3
    s_and_b32 s15, s10, 3
    s_waitcnt lgkmcnt(0)
    s_mov_b32 s16, s8
    s_and_b32 s17, s9, 0xffff
    s_mov_b32 s18, 268435456
    s_mov_b32 s19, 0x00020000
    s_cmp_ge_u32 s10, 4
    s_cbranch_scc1 L_k3_helper
    v_lshrrev_b32 v253, 4, v0
    v_and_b32 v254, 15, v0
    v_bfe_u32 v255, v254, 3, 1
    v_mul_u32_u24 v255, 3, v255
    v_xor_b32 v255, v255, v253
    v_lshlrev_b32 v255, 4, v255
    v_lshl_add_u32 v250, v254, 6, v255
    v_lshrrev_b32 v255, 2, v254
    v_and_b32 v216, 1, v253
    v_lshl_or_b32 v216, v216, 2, v255
    v_lshl_add_u32 v255, v253, 3, v255
    v_lshlrev_b32 v255, 8, v255
    v_and_b32 v217, 3, v254
    v_lshl_add_u32 v255, v217, 3, v255
    s_lshl_b32 s20, s15, 1
    s_add_u32 s20, s20, s13
    v_xor_b32 v217, s20, v216
    v_lshl_add_u32 v248, v217, 5, v255
    s_xor_b32 s20, s20, 1
    v_xor_b32 v217, s20, v216
    v_lshl_add_u32 v249, v217, 5, v255
    s_mov_b32 s21, 65792
    v_mul_u32_u24 v251, s21, v254
    v_lshl_add_u32 v251, v253, 4, v251
    s_lshl_b32 s23, s15, 6
    v_add_u32 v251, s23, v251
    v_and_b32 v255, 7, v254
    v_mul_u32_u24 v252, s21, v255
    v_lshrrev_b32 v216, 3, v254
    v_xor_b32 v216, s13, v216
    s_mov_b32 s22, 11579392
    v_mul_lo_u32 v216, v216, s22
    v_add_u32 v252, v252, v216
    v_lshl_add_u32 v252, v253, 4, v252
    s_lshl_b32 s22, s13, 3
    s_add_u32 s22, s22, s23
    v_add_u32 v252, s22, v252
    v_cmp_gt_u32 vcc, 7, v255
    v_mov_b32 v216, 0x80000000
    s_nop 0
    v_cndmask_b32 v252, v216, v252, vcc
    s_mul_i32 s48, s11, 2048
    s_lshl_b32 s20, s14, 8
    s_add_u32 s48, s48, s20
    s_add_u32 s48, s48, 117440512
    s_add_u32 s49, s48, 10526720
    s_mul_i32 s20, s13, 11579392
    s_add_u32 s48, s48, s20
    v_mov_b32 v0, 0
    v_mov_b32 v1, 0
    v_mov_b32 v2, 0
    v_mov_b32 v3, 0
    v_mov_b32 v4, 0
    v_mov_b32 v5, 0
    v_mov_b32 v6, 0
    v_mov_b32 v7, 0
    v_mov_b32 v8, 0
    v_mov_b32 v9, 0
    v_mov_b32 v10, 0
    v_mov_b32 v11, 0
    v_mov_b32 v12, 0
    v_mov_b32 v13, 0
    v_mov_b32 v14, 0
    v_mov_b32 v15, 0
    v_mov_b32 v16, 0
    v_mov_b32 v17, 0
    v_mov_b32 v18, 0
    v_mov_b32 v19, 0
    v_mov_b32 v20, 0
    v_mov_b32 v21, 0
    v_mov_b32 v22, 0
    v_mov_b32 v23, 0
    v_mov_b32 v24, 0
    v_mov_b32 v25, 0
    v_mov_b32 v26, 0
    v_mov_b32 v27, 0
    v_mov_b32 v28, 0
    v_mov_b32 v29, 0
    v_mov_b32 v30, 0
    v_mov_b32 v31, 0
    v_mov_b32 v32, 0
    v_mov_b32 v33, 0
    v_mov_b32 v34, 0
    v_mov_b32 v35, 0
    v_mov_b32 v36, 0
    v_mov_b32 v37, 0
    v_mov_b32 v38, 0
    v_mov_b32 v39, 0
    v_mov_b32 v40, 0
    v_mov_b32 v41, 0
    v_mov_b32 v42, 0
    v_mov_b32 v43, 0
    v_mov_b32 v44, 0
    v_mov_b32 v45, 0
    v_mov_b32 v46, 0
    v_mov_b32 v47, 0
    v_mov_b32 v48, 0
    v_mov_b32 v49, 0
    v_mov_b32 v50, 0
    v_mov_b32 v51, 0
    v_mov_b32 v52, 0
    v_mov_b32 v53, 0
    v_mov_b32 v54, 0
    v_mov_b32 v55, 0
    v_mov_b32 v56, 0
    v_mov_b32 v57, 0
    v_mov_b32 v58, 0
    v_mov_b32 v59, 0
    v_mov_b32 v60, 0
    v_mov_b32 v61, 0
    v_mov_b32 v62, 0
    v_mov_b32 v63, 0
    v_mov_b32 v64, 0
    v_mov_b32 v65, 0
    v_mov_b32 v66, 0
    v_mov_b32 v67, 0
    v_mov_b32 v68, 0
    v_mov_b32 v69, 0
    v_mov_b32 v70, 0
    v_mov_b32 v71, 0
    v_mov_b32 v72, 0
    v_mov_b32 v73, 0
    v_mov_b32 v74, 0
    v_mov_b32 v75, 0
    v_mov_b32 v76, 0
    v_mov_b32 v77, 0
    v_mov_b32 v78, 0
    v_mov_b32 v79, 0
    v_mov_b32 v80, 0
    v_mov_b32 v81, 0
    v_mov_b32 v82, 0
    v_mov_b32 v83, 0
    v_mov_b32 v84, 0
    v_mov_b32 v85, 0
    v_mov_b32 v86, 0
    v_mov_b32 v87, 0
    v_mov_b32 v88, 0
    v_mov_b32 v89, 0
    v_mov_b32 v90, 0
    v_mov_b32 v91, 0
    v_mov_b32 v92, 0
    v_mov_b32 v93, 0
    v_mov_b32 v94, 0
    v_mov_b32 v95, 0
    v_mov_b32 v96, 0
    v_mov_b32 v97, 0
    v_mov_b32 v98, 0
    v_mov_b32 v99, 0
    v_mov_b32 v100, 0
    v_mov_b32 v101, 0
    v_mov_b32 v102, 0
    v_mov_b32 v103, 0
    v_mov_b32 v104, 0
    v_mov_b32 v105, 0
    v_mov_b32 v106, 0
    v_mov_b32 v107, 0
    v_mov_b32 v108, 0
    v_mov_b32 v109, 0
    v_mov_b32 v110, 0
    v_mov_b32 v111, 0
    v_mov_b32 v112, 0
    v_mov_b32 v113, 0
    v_mov_b32 v114, 0
    v_mov_b32 v115, 0
    v_mov_b32 v116, 0
    v_mov_b32 v117, 0
    v_mov_b32 v118, 0
    v_mov_b32 v119, 0
    v_mov_b32 v120, 0
    v_mov_b32 v121, 0
    v_mov_b32 v122, 0
    v_mov_b32 v123, 0
    v_mov_b32 v124, 0
    v_mov_b32 v125, 0
    v_mov_b32 v126, 0
    v_mov_b32 v127, 0
    v_mov_b32 v128, 0
    v_mov_b32 v129, 0
    v_mov_b32 v130, 0
    v_mov_b32 v131, 0
    v_mov_b32 v132, 0
    v_mov_b32 v133, 0
    v_mov_b32 v134, 0
    v_mov_b32 v135, 0
    v_mov_b32 v136, 0
    v_mov_b32 v137, 0
    v_mov_b32 v138, 0
    v_mov_b32 v139, 0
    v_mov_b32 v140, 0
    v_mov_b32 v141, 0
    v_mov_b32 v142, 0
    v_mov_b32 v143, 0
    v_mov_b32 v144, 0
    v_mov_b32 v145, 0
    v_mov_b32 v146, 0
    v_mov_b32 v147, 0
    v_mov_b32 v148, 0
    v_mov_b32 v149, 0
    v_mov_b32 v150, 0
    v_mov_b32 v151, 0
    v_mov_b32 v152, 0
    v_mov_b32 v153, 0
    v_mov_b32 v154, 0
    v_mov_b32 v155, 0
    v_mov_b32 v156, 0
    v_mov_b32 v157, 0
    v_mov_b32 v158, 0
    v_mov_b32 v159, 0
    v_mov_b32 v160, 0
    v_mov_b32 v161, 0
    v_mov_b32 v162, 0
    v_mov_b32 v163, 0
    v_mov_b32 v164, 0
    v_mov_b32 v165, 0
    v_mov_b32 v166, 0
    v_mov_b32 v167, 0
    s_barrier
    ds_read_b64_tr_b16 v[176:177], v248 offset:0
    ds_read_b64_tr_b16 v[178:179], v248 offset:1024
    ds_read_b64_tr_b16 v[180:181], v249 offset:0
    ds_read_b64_tr_b16 v[182:183], v249 offset:1024
    ds_read_b64_tr_b16 v[184:185], v248 offset:8192
    ds_read_b64_tr_b16 v[186:187], v248 offset:9216
    ds_read_b64_tr_b16 v[188:189], v249 offset:8192
    ds_read_b64_tr_b16 v[190:191], v249 offset:9216
    ds_read_b128 v[216:219], v250 offset:16384
    ds_read_b128 v[220:223], v250 offset:27648
    ds_read_b128 v[224:227], v250 offset:17408
    ds_read_b128 v[228:231], v250 offset:28672
    s_waitcnt lgkmcnt(4)
    v_xor_b32 v208, 0x80008000, v184
    v_xor_b32 v209, 0x80008000, v185
    v_xor_b32 v210, 0x80008000, v186
    v_xor_b32 v211, 0x80008000, v187
    v_xor_b32 v212, 0x80008000, v188
    v_xor_b32 v213, 0x80008000, v189
    v_xor_b32 v214, 0x80008000, v190
    v_xor_b32 v215, 0x80008000, v191
    s_mov_b32 s46, 7
L_g_loop:
    s_barrier
    s_waitcnt lgkmcnt(2)
    v_mfma_f32_16x16x32_bf16 v[0:3], v[176:179], v[216:219], v[0:3]
    ds_read_b128 v[232:235], v250 offset:18432
    ds_read_b128 v[236:239], v250 offset:29696
    v_mfma_f32_16x16x32_bf16 v[4:7], v[180:183], v[216:219], v[4:7]
    v_mfma_f32_16x16x32_bf16 v[8:11], v[208:211], v[216:219], v[8:11]
    v_mfma_f32_16x16x32_bf16 v[12:15], v[212:215], v[216:219], v[12:15]
    v_mfma_f32_16x16x32_bf16 v[0:3], v[184:187], v[220:223], v[0:3]
    v_mfma_f32_16x16x32_bf16 v[4:7], v[188:191], v[220:223], v[4:7]
    v_mfma_f32_16x16x32_bf16 v[8:11], v[176:179], v[220:223], v[8:11]
    v_mfma_f32_16x16x32_bf16 v[12:15], v[180:183], v[220:223], v[12:15]
    s_waitcnt lgkmcnt(2)
    v_mfma_f32_16x16x32_bf16 v[16:19], v[176:179], v[224:227], v[16:19]
    ds_read_b128 v[240:243], v250 offset:19456
    ds_read_b128 v[244:247], v250 offset:30720
    v_mfma_f32_16x16x32_bf16 v[20:23], v[180:183], v[224:227], v[20:23]
    v_mfma_f32_16x16x32_bf16 v[24:27], v[208:211], v[224:227], v[24:27]
    v_mfma_f32_16x16x32_bf16 v[28:31], v[212:215], v[224:227], v[28:31]
    v_mfma_f32_16x16x32_bf16 v[16:19], v[184:187], v[228:231], v[16:19]
    v_mfma_f32_16x16x32_bf16 v[20:23], v[188:191], v[228:231], v[20:23]
    v_mfma_f32_16x16x32_bf16 v[24:27], v[176:179], v[228:231], v[24:27]
    v_mfma_f32_16x16x32_bf16 v[28:31], v[180:183], v[228:231], v[28:31]
    s_waitcnt lgkmcnt(2)
    v_mfma_f32_16x16x32_bf16 v[32:35], v[176:179], v[232:235], v[32:35]
    ds_read_b128 v[216:219], v250 offset:20480
    ds_read_b128 v[220:223], v250 offset:31744
    v_mfma_f32_16x16x32_bf16 v[36:39], v[180:183], v[232:235], v[36:39]
    v_mfma_f32_16x16x32_bf16 v[40:43], v[208:211], v[232:235], v[40:43]
    v_mfma_f32_16x16x32_bf16 v[44:47], v[212:215], v[232:235], v[44:47]
    v_mfma_f32_16x16x32_bf16 v[32:35], v[184:187], v[236:239], v[32:35]
    v_mfma_f32_16x16x32_bf16 v[36:39], v[188:191], v[236:239], v[36:39]
    v_mfma_f32_16x16x32_bf16 v[40:43], v[176:179], v[236:239], v[40:43]
    v_mfma_f32_16x16x32_bf16 v[44:47], v[180:183], v[236:239], v[44:47]
    s_waitcnt lgkmcnt(2)
    v_mfma_f32_16x16x32_bf16 v[48:51], v[176:179], v[240:243], v[48:51]
    ds_read_b128 v[224:227], v250 offset:21504
    ds_read_b128 v[228:231], v250 offset:32768
    v_mfma_f32_16x16x32_bf16 v[52:55], v[180:183], v[240:243], v[52:55]
    v_mfma_f32_16x16x32_bf16 v[56:59], v[208:211], v[240:243], v[56:59]
    v_mfma_f32_16x16x32_bf16 v[60:63], v[212:215], v[240:243], v[60:63]
    v_mfma_f32_16x16x32_bf16 v[48:51], v[184:187], v[244:247], v[48:51]
    v_mfma_f32_16x16x32_bf16 v[52:55], v[188:191], v[244:247], v[52:55]
    v_mfma_f32_16x16x32_bf16 v[56:59], v[176:179], v[244:247], v[56:59]
    v_mfma_f32_16x16x32_bf16 v[60:63], v[180:183], v[244:247], v[60:63]
    s_waitcnt lgkmcnt(2)
    v_mfma_f32_16x16x32_bf16 v[64:67], v[176:179], v[216:219], v[64:67]
    ds_read_b128 v[232:235], v250 offset:22528
    ds_read_b128 v[236:239], v250 offset:33792
    v_mfma_f32_16x16x32_bf16 v[68:71], v[180:183], v[216:219], v[68:71]
    v_mfma_f32_16x16x32_bf16 v[72:75], v[208:211], v[216:219], v[72:75]
    v_mfma_f32_16x16x32_bf16 v[76:79], v[212:215], v[216:219], v[76:79]
    v_mfma_f32_16x16x32_bf16 v[64:67], v[184:187], v[220:223], v[64:67]
    v_mfma_f32_16x16x32_bf16 v[68:71], v[188:191], v[220:223], v[68:71]
    v_mfma_f32_16x16x32_bf16 v[72:75], v[176:179], v[220:223], v[72:75]
    v_mfma_f32_16x16x32_bf16 v[76:79], v[180:183], v[220:223], v[76:79]
    s_waitcnt lgkmcnt(2)
    v_mfma_f32_16x16x32_bf16 v[80:83], v[176:179], v[224:227], v[80:83]
    ds_read_b128 v[240:243], v250 offset:23552
    ds_read_b128 v[244:247], v250 offset:34816
    v_mfma_f32_16x16x32_bf16 v[84:87], v[180:183], v[224:227], v[84:87]
    v_mfma_f32_16x16x32_bf16 v[88:91], v[208:211], v[224:227], v[88:91]
    v_mfma_f32_16x16x32_bf16 v[92:95], v[212:215], v[224:227], v[92:95]
    v_mfma_f32_16x16x32_bf16 v[80:83], v[184:187], v[228:231], v[80:83]
    v_add_u32 v248, 0x9800, v248
    v_add_u32 v249, 0x9800, v249
    v_mfma_f32_16x16x32_bf16 v[84:87], v[188:191], v[228:231], v[84:87]
    v_mfma_f32_16x16x32_bf16 v[88:91], v[176:179], v[228:231], v[88:91]
    v_mfma_f32_16x16x32_bf16 v[92:95], v[180:183], v[228:231], v[92:95]
    s_waitcnt lgkmcnt(2)
    v_mfma_f32_16x16x32_bf16 v[96:99], v[176:179], v[232:235], v[96:99]
    ds_read_b128 v[216:219], v250 offset:24576
    ds_read_b128 v[220:223], v250 offset:35840
    v_mfma_f32_16x16x32_bf16 v[100:103], v[180:183], v[232:235], v[100:103]
    v_mfma_f32_16x16x32_bf16 v[104:107], v[208:211], v[232:235], v[104:107]
    v_mfma_f32_16x16x32_bf16 v[108:111], v[212:215], v[232:235], v[108:111]
    ds_read_b64_tr_b16 v[192:193], v248 offset:0
    ds_read_b64_tr_b16 v[194:195], v248 offset:1024
    ds_read_b64_tr_b16 v[196:197], v249 offset:0
    ds_read_b64_tr_b16 v[198:199], v249 offset:1024
    v_mfma_f32_16x16x32_bf16 v[96:99], v[184:187], v[236:239], v[96:99]
    v_mfma_f32_16x16x32_bf16 v[100:103], v[188:191], v[236:239], v[100:103]
    v_mfma_f32_16x16x32_bf16 v[104:107], v[176:179], v[236:239], v[104:107]
    v_mfma_f32_16x16x32_bf16 v[108:111], v[180:183], v[236:239], v[108:111]
    s_waitcnt lgkmcnt(6)
    v_mfma_f32_16x16x32_bf16 v[112:115], v[176:179], v[240:243], v[112:115]
    ds_read_b128 v[224:227], v250 offset:25600
    ds_read_b128 v[228:231], v250 offset:36864
    v_mfma_f32_16x16x32_bf16 v[116:119], v[180:183], v[240:243], v[116:119]
    v_mfma_f32_16x16x32_bf16 v[120:123], v[208:211], v[240:243], v[120:123]
    v_mfma_f32_16x16x32_bf16 v[124:127], v[212:215], v[240:243], v[124:127]
    ds_read_b64_tr_b16 v[200:201], v248 offset:8192
    ds_read_b64_tr_b16 v[202:203], v248 offset:9216
    ds_read_b64_tr_b16 v[204:205], v249 offset:8192
    ds_read_b64_tr_b16 v[206:207], v249 offset:9216
    v_mfma_f32_16x16x32_bf16 v[112:115], v[184:187], v[244:247], v[112:115]
    v_mfma_f32_16x16x32_bf16 v[116:119], v[188:191], v[244:247], v[116:119]
    v_mfma_f32_16x16x32_bf16 v[120:123], v[176:179], v[244:247], v[120:123]
    v_mfma_f32_16x16x32_bf16 v[124:127], v[180:183], v[244:247], v[124:127]
    s_waitcnt lgkmcnt(10)
    v_mfma_f32_16x16x32_bf16 v[128:131], v[176:179], v[216:219], v[128:131]
    ds_read_b128 v[232:235], v250 offset:26624
    ds_read_b128 v[236:239], v250 offset:37888
    v_mfma_f32_16x16x32_bf16 v[132:135], v[180:183], v[216:219], v[132:135]
    v_mfma_f32_16x16x32_bf16 v[136:139], v[208:211], v[216:219], v[136:139]
    v_mfma_f32_16x16x32_bf16 v[140:143], v[212:215], v[216:219], v[140:143]
    v_mfma_f32_16x16x32_bf16 v[128:131], v[184:187], v[220:223], v[128:131]
    v_mfma_f32_16x16x32_bf16 v[132:135], v[188:191], v[220:223], v[132:135]
    v_mfma_f32_16x16x32_bf16 v[136:139], v[176:179], v[220:223], v[136:139]
    v_mfma_f32_16x16x32_bf16 v[140:143], v[180:183], v[220:223], v[140:143]
    s_waitcnt lgkmcnt(6)
    v_mfma_f32_16x16x32_bf16 v[144:147], v[176:179], v[224:227], v[144:147]
    v_add_u32 v250, 0x9800, v250
    ds_read_b128 v[240:243], v250 offset:16384
    ds_read_b128 v[244:247], v250 offset:27648
    v_mfma_f32_16x16x32_bf16 v[148:151], v[180:183], v[224:227], v[148:151]
    v_mfma_f32_16x16x32_bf16 v[152:155], v[208:211], v[224:227], v[152:155]
    v_mfma_f32_16x16x32_bf16 v[156:159], v[212:215], v[224:227], v[156:159]
    v_mfma_f32_16x16x32_bf16 v[144:147], v[184:187], v[228:231], v[144:147]
    s_waitcnt lgkmcnt(4)
    v_xor_b32 v212, 0x80008000, v204
    v_xor_b32 v213, 0x80008000, v205
    v_mfma_f32_16x16x32_bf16 v[148:151], v[188:191], v[228:231], v[148:151]
    v_xor_b32 v214, 0x80008000, v206
    v_xor_b32 v215, 0x80008000, v207
    v_mfma_f32_16x16x32_bf16 v[152:155], v[176:179], v[228:231], v[152:155]
    v_mfma_f32_16x16x32_bf16 v[156:159], v[180:183], v[228:231], v[156:159]
    s_waitcnt lgkmcnt(2)
    v_mfma_f32_16x16x32_bf16 v[160:163], v[176:179], v[232:235], v[160:163]
    ds_read_b128 v[216:219], v250 offset:17408
    ds_read_b128 v[220:223], v250 offset:28672
    v_mfma_f32_16x16x32_bf16 v[164:167], v[208:211], v[232:235], v[164:167]
    v_xor_b32 v208, 0x80008000, v200
    v_xor_b32 v209, 0x80008000, v201
    v_mfma_f32_16x16x32_bf16 v[160:163], v[184:187], v[236:239], v[160:163]
    v_xor_b32 v210, 0x80008000, v202
    v_xor_b32 v211, 0x80008000, v203
    v_mfma_f32_16x16x32_bf16 v[164:167], v[176:179], v[236:239], v[164:167]
    s_barrier
    s_waitcnt lgkmcnt(2)
    v_mfma_f32_16x16x32_bf16 v[0:3], v[192:195], v[240:243], v[0:3]
    ds_read_b128 v[224:227], v250 offset:18432
    ds_read_b128 v[228:231], v250 offset:29696
    v_mfma_f32_16x16x32_bf16 v[4:7], v[196:199], v[240:243], v[4:7]
    v_mfma_f32_16x16x32_bf16 v[8:11], v[208:211], v[240:243], v[8:11]
    v_mfma_f32_16x16x32_bf16 v[12:15], v[212:215], v[240:243], v[12:15]
    v_mfma_f32_16x16x32_bf16 v[0:3], v[200:203], v[244:247], v[0:3]
    v_mfma_f32_16x16x32_bf16 v[4:7], v[204:207], v[244:247], v[4:7]
    v_mfma_f32_16x16x32_bf16 v[8:11], v[192:195], v[244:247], v[8:11]
    v_mfma_f32_16x16x32_bf16 v[12:15], v[196:199], v[244:247], v[12:15]
    s_waitcnt lgkmcnt(2)
    v_mfma_f32_16x16x32_bf16 v[16:19], v[192:195], v[216:219], v[16:19]
    ds_read_b128 v[232:235], v250 offset:19456
    ds_read_b128 v[236:239], v250 offset:30720
    v_mfma_f32_16x16x32_bf16 v[20:23], v[196:199], v[216:219], v[20:23]
    v_mfma_f32_16x16x32_bf16 v[24:27], v[208:211], v[216:219], v[24:27]
    v_mfma_f32_16x16x32_bf16 v[28:31], v[212:215], v[216:219], v[28:31]
    v_mfma_f32_16x16x32_bf16 v[16:19], v[200:203], v[220:223], v[16:19]
    v_mfma_f32_16x16x32_bf16 v[20:23], v[204:207], v[220:223], v[20:23]
    v_mfma_f32_16x16x32_bf16 v[24:27], v[192:195], v[220:223], v[24:27]
    v_mfma_f32_16x16x32_bf16 v[28:31], v[196:199], v[220:223], v[28:31]
    s_waitcnt lgkmcnt(2)
    v_mfma_f32_16x16x32_bf16 v[32:35], v[192:195], v[224:227], v[32:35]
    ds_read_b128 v[240:243], v250 offset:20480
    ds_read_b128 v[244:247], v250 offset:31744
    v_mfma_f32_16x16x32_bf16 v[36:39], v[196:199], v[224:227], v[36:39]
    v_mfma_f32_16x16x32_bf16 v[40:43], v[208:211], v[224:227], v[40:43]
    v_mfma_f32_16x16x32_bf16 v[44:47], v[212:215], v[224:227], v[44:47]
    v_mfma_f32_16x16x32_bf16 v[32:35], v[200:203], v[228:231], v[32:35]
    v_mfma_f32_16x16x32_bf16 v[36:39], v[204:207], v[228:231], v[36:39]
    v_mfma_f32_16x16x32_bf16 v[40:43], v[192:195], v[228:231], v[40:43]
    v_mfma_f32_16x16x32_bf16 v[44:47], v[196:199], v[228:231], v[44:47]
    s_waitcnt lgkmcnt(2)
    v_mfma_f32_16x16x32_bf16 v[48:51], v[192:195], v[232:235], v[48:51]
    ds_read_b128 v[216:219], v250 offset:21504
    ds_read_b128 v[220:223], v250 offset:32768
    v_mfma_f32_16x16x32_bf16 v[52:55], v[196:199], v[232:235], v[52:55]
    v_mfma_f32_16x16x32_bf16 v[56:59], v[208:211], v[232:235], v[56:59]
    v_mfma_f32_16x16x32_bf16 v[60:63], v[212:215], v[232:235], v[60:63]
    v_mfma_f32_16x16x32_bf16 v[48:51], v[200:203], v[236:239], v[48:51]
    v_mfma_f32_16x16x32_bf16 v[52:55], v[204:207], v[236:239], v[52:55]
    v_mfma_f32_16x16x32_bf16 v[56:59], v[192:195], v[236:239], v[56:59]
    v_mfma_f32_16x16x32_bf16 v[60:63], v[196:199], v[236:239], v[60:63]
    s_waitcnt lgkmcnt(2)
    v_mfma_f32_16x16x32_bf16 v[64:67], v[192:195], v[240:243], v[64:67]
    ds_read_b128 v[224:227], v250 offset:22528
    ds_read_b128 v[228:231], v250 offset:33792
    v_mfma_f32_16x16x32_bf16 v[68:71], v[196:199], v[240:243], v[68:71]
    v_mfma_f32_16x16x32_bf16 v[72:75], v[208:211], v[240:243], v[72:75]
    v_mfma_f32_16x16x32_bf16 v[76:79], v[212:215], v[240:243], v[76:79]
    v_mfma_f32_16x16x32_bf16 v[64:67], v[200:203], v[244:247], v[64:67]
    v_mfma_f32_16x16x32_bf16 v[68:71], v[204:207], v[244:247], v[68:71]
    v_mfma_f32_16x16x32_bf16 v[72:75], v[192:195], v[244:247], v[72:75]
    v_mfma_f32_16x16x32_bf16 v[76:79], v[196:199], v[244:247], v[76:79]
    s_waitcnt lgkmcnt(2)
    v_mfma_f32_16x16x32_bf16 v[80:83], v[192:195], v[216:219], v[80:83]
    ds_read_b128 v[232:235], v250 offset:23552
    ds_read_b128 v[236:239], v250 offset:34816
    v_mfma_f32_16x16x32_bf16 v[84:87], v[196:199], v[216:219], v[84:87]
    v_mfma_f32_16x16x32_bf16 v[88:91], v[208:211], v[216:219], v[88:91]
    v_mfma_f32_16x16x32_bf16 v[92:95], v[212:215], v[216:219], v[92:95]
    v_mfma_f32_16x16x32_bf16 v[80:83], v[200:203], v[220:223], v[80:83]
    v_add_u32 v248, 0x9800, v248
    v_add_u32 v249, 0x9800, v249
    v_mfma_f32_16x16x32_bf16 v[84:87], v[204:207], v[220:223], v[84:87]
    v_mfma_f32_16x16x32_bf16 v[88:91], v[192:195], v[220:223], v[88:91]
    v_mfma_f32_16x16x32_bf16 v[92:95], v[196:199], v[220:223], v[92:95]
    s_waitcnt lgkmcnt(2)
    v_mfma_f32_16x16x32_bf16 v[96:99], v[192:195], v[224:227], v[96:99]
    ds_read_b128 v[240:243], v250 offset:24576
    ds_read_b128 v[244:247], v250 offset:35840
    v_mfma_f32_16x16x32_bf16 v[100:103], v[196:199], v[224:227], v[100:103]
    v_mfma_f32_16x16x32_bf16 v[104:107], v[208:211], v[224:227], v[104:107]
    v_mfma_f32_16x16x32_bf16 v[108:111], v[212:215], v[224:227], v[108:111]
    ds_read_b64_tr_b16 v[176:177], v248 offset:0
    ds_read_b64_tr_b16 v[178:179], v248 offset:1024
    ds_read_b64_tr_b16 v[180:181], v249 offset:0
    ds_read_b64_tr_b16 v[182:183], v249 offset:1024
    v_mfma_f32_16x16x32_bf16 v[96:99], v[200:203], v[228:231], v[96:99]
    v_mfma_f32_16x16x32_bf16 v[100:103], v[204:207], v[228:231], v[100:103]
    v_mfma_f32_16x16x32_bf16 v[104:107], v[192:195], v[228:231], v[104:107]
    v_mfma_f32_16x16x32_bf16 v[108:111], v[196:199], v[228:231], v[108:111]
    s_waitcnt lgkmcnt(6)
    v_mfma_f32_16x16x32_bf16 v[112:115], v[192:195], v[232:235], v[112:115]
    ds_read_b128 v[216:219], v250 offset:25600
    ds_read_b128 v[220:223], v250 offset:36864
    v_mfma_f32_16x16x32_bf16 v[116:119], v[196:199], v[232:235], v[116:119]
    v_mfma_f32_16x16x32_bf16 v[120:123], v[208:211], v[232:235], v[120:123]
    v_mfma_f32_16x16x32_bf16 v[124:127], v[212:215], v[232:235], v[124:127]
    ds_read_b64_tr_b16 v[184:185], v248 offset:8192
    ds_read_b64_tr_b16 v[186:187], v248 offset:9216
    ds_read_b64_tr_b16 v[188:189], v249 offset:8192
    ds_read_b64_tr_b16 v[190:191], v249 offset:9216
    v_mfma_f32_16x16x32_bf16 v[112:115], v[200:203], v[236:239], v[112:115]
    v_mfma_f32_16x16x32_bf16 v[116:119], v[204:207], v[236:239], v[116:119]
    v_mfma_f32_16x16x32_bf16 v[120:123], v[192:195], v[236:239], v[120:123]
    v_mfma_f32_16x16x32_bf16 v[124:127], v[196:199], v[236:239], v[124:127]
    s_waitcnt lgkmcnt(10)
    v_mfma_f32_16x16x32_bf16 v[128:131], v[192:195], v[240:243], v[128:131]
    ds_read_b128 v[224:227], v250 offset:26624
    ds_read_b128 v[228:231], v250 offset:37888
    v_mfma_f32_16x16x32_bf16 v[132:135], v[196:199], v[240:243], v[132:135]
    v_mfma_f32_16x16x32_bf16 v[136:139], v[208:211], v[240:243], v[136:139]
    v_mfma_f32_16x16x32_bf16 v[140:143], v[212:215], v[240:243], v[140:143]
    v_mfma_f32_16x16x32_bf16 v[128:131], v[200:203], v[244:247], v[128:131]
    v_mfma_f32_16x16x32_bf16 v[132:135], v[204:207], v[244:247], v[132:135]
    v_mfma_f32_16x16x32_bf16 v[136:139], v[192:195], v[244:247], v[136:139]
    v_mfma_f32_16x16x32_bf16 v[140:143], v[196:199], v[244:247], v[140:143]
    s_waitcnt lgkmcnt(6)
    v_mfma_f32_16x16x32_bf16 v[144:147], v[192:195], v[216:219], v[144:147]
    v_add_u32 v250, 0x9800, v250
    ds_read_b128 v[232:235], v250 offset:16384
    ds_read_b128 v[236:239], v250 offset:27648
    v_mfma_f32_16x16x32_bf16 v[148:151], v[196:199], v[216:219], v[148:151]
    v_mfma_f32_16x16x32_bf16 v[152:155], v[208:211], v[216:219], v[152:155]
    v_mfma_f32_16x16x32_bf16 v[156:159], v[212:215], v[216:219], v[156:159]
    v_mfma_f32_16x16x32_bf16 v[144:147], v[200:203], v[220:223], v[144:147]
    s_waitcnt lgkmcnt(4)
    v_xor_b32 v212, 0x80008000, v188
    v_xor_b32 v213, 0x80008000, v189
    v_mfma_f32_16x16x32_bf16 v[148:151], v[204:207], v[220:223], v[148:151]
    v_xor_b32 v214, 0x80008000, v190
    v_xor_b32 v215, 0x80008000, v191
    v_mfma_f32_16x16x32_bf16 v[152:155], v[192:195], v[220:223], v[152:155]
    v_mfma_f32_16x16x32_bf16 v[156:159], v[196:199], v[220:223], v[156:159]
    s_waitcnt lgkmcnt(2)
    v_mfma_f32_16x16x32_bf16 v[160:163], v[192:195], v[224:227], v[160:163]
    ds_read_b128 v[240:243], v250 offset:17408
    ds_read_b128 v[244:247], v250 offset:28672
    v_mfma_f32_16x16x32_bf16 v[164:167], v[208:211], v[224:227], v[164:167]
    v_xor_b32 v208, 0x80008000, v184
    v_xor_b32 v209, 0x80008000, v185
    v_mfma_f32_16x16x32_bf16 v[160:163], v[200:203], v[228:231], v[160:163]
    v_xor_b32 v210, 0x80008000, v186
    v_xor_b32 v211, 0x80008000, v187
    v_mfma_f32_16x16x32_bf16 v[164:167], v[192:195], v[228:231], v[164:167]
    s_barrier
    s_waitcnt lgkmcnt(2)
    v_mfma_f32_16x16x32_bf16 v[0:3], v[176:179], v[232:235], v[0:3]
    ds_read_b128 v[216:219], v250 offset:18432
    ds_read_b128 v[220:223], v250 offset:29696
    v_mfma_f32_16x16x32_bf16 v[4:7], v[180:183], v[232:235], v[4:7]
    v_mfma_f32_16x16x32_bf16 v[8:11], v[208:211], v[232:235], v[8:11]
    v_mfma_f32_16x16x32_bf16 v[12:15], v[212:215], v[232:235], v[12:15]
    v_mfma_f32_16x16x32_bf16 v[0:3], v[184:187], v[236:239], v[0:3]
    v_mfma_f32_16x16x32_bf16 v[4:7], v[188:191], v[236:239], v[4:7]
    v_mfma_f32_16x16x32_bf16 v[8:11], v[176:179], v[236:239], v[8:11]
    v_mfma_f32_16x16x32_bf16 v[12:15], v[180:183], v[236:239], v[12:15]
    s_waitcnt lgkmcnt(2)
    v_mfma_f32_16x16x32_bf16 v[16:19], v[176:179], v[240:243], v[16:19]
    ds_read_b128 v[224:227], v250 offset:19456
    ds_read_b128 v[228:231], v250 offset:30720
    v_mfma_f32_16x16x32_bf16 v[20:23], v[180:183], v[240:243], v[20:23]
    v_mfma_f32_16x16x32_bf16 v[24:27], v[208:211], v[240:243], v[24:27]
    v_mfma_f32_16x16x32_bf16 v[28:31], v[212:215], v[240:243], v[28:31]
    v_mfma_f32_16x16x32_bf16 v[16:19], v[184:187], v[244:247], v[16:19]
    v_mfma_f32_16x16x32_bf16 v[20:23], v[188:191], v[244:247], v[20:23]
    v_mfma_f32_16x16x32_bf16 v[24:27], v[176:179], v[244:247], v[24:27]
    v_mfma_f32_16x16x32_bf16 v[28:31], v[180:183], v[244:247], v[28:31]
    s_waitcnt lgkmcnt(2)
    v_mfma_f32_16x16x32_bf16 v[32:35], v[176:179], v[216:219], v[32:35]
    ds_read_b128 v[232:235], v250 offset:20480
    ds_read_b128 v[236:239], v250 offset:31744
    v_mfma_f32_16x16x32_bf16 v[36:39], v[180:183], v[216:219], v[36:39]
    v_mfma_f32_16x16x32_bf16 v[40:43], v[208:211], v[216:219], v[40:43]
    v_mfma_f32_16x16x32_bf16 v[44:47], v[212:215], v[216:219], v[44:47]
    v_mfma_f32_16x16x32_bf16 v[32:35], v[184:187], v[220:223], v[32:35]
    v_mfma_f32_16x16x32_bf16 v[36:39], v[188:191], v[220:223], v[36:39]
    v_mfma_f32_16x16x32_bf16 v[40:43], v[176:179], v[220:223], v[40:43]
    v_mfma_f32_16x16x32_bf16 v[44:47], v[180:183], v[220:223], v[44:47]
    s_waitcnt lgkmcnt(2)
    v_mfma_f32_16x16x32_bf16 v[48:51], v[176:179], v[224:227], v[48:51]
    ds_read_b128 v[240:243], v250 offset:21504
    ds_read_b128 v[244:247], v250 offset:32768
    v_mfma_f32_16x16x32_bf16 v[52:55], v[180:183], v[224:227], v[52:55]
    v_mfma_f32_16x16x32_bf16 v[56:59], v[208:211], v[224:227], v[56:59]
    v_mfma_f32_16x16x32_bf16 v[60:63], v[212:215], v[224:227], v[60:63]
    v_mfma_f32_16x16x32_bf16 v[48:51], v[184:187], v[228:231], v[48:51]
    v_mfma_f32_16x16x32_bf16 v[52:55], v[188:191], v[228:231], v[52:55]
    v_mfma_f32_16x16x32_bf16 v[56:59], v[176:179], v[228:231], v[56:59]
    v_mfma_f32_16x16x32_bf16 v[60:63], v[180:183], v[228:231], v[60:63]
    s_waitcnt lgkmcnt(2)
    v_mfma_f32_16x16x32_bf16 v[64:67], v[176:179], v[232:235], v[64:67]
    ds_read_b128 v[216:219], v250 offset:22528
    ds_read_b128 v[220:223], v250 offset:33792
    v_mfma_f32_16x16x32_bf16 v[68:71], v[180:183], v[232:235], v[68:71]
    v_mfma_f32_16x16x32_bf16 v[72:75], v[208:211], v[232:235], v[72:75]
    v_mfma_f32_16x16x32_bf16 v[76:79], v[212:215], v[232:235], v[76:79]
    v_mfma_f32_16x16x32_bf16 v[64:67], v[184:187], v[236:239], v[64:67]
    v_mfma_f32_16x16x32_bf16 v[68:71], v[188:191], v[236:239], v[68:71]
    v_mfma_f32_16x16x32_bf16 v[72:75], v[176:179], v[236:239], v[72:75]
    v_mfma_f32_16x16x32_bf16 v[76:79], v[180:183], v[236:239], v[76:79]
    s_waitcnt lgkmcnt(2)
    v_mfma_f32_16x16x32_bf16 v[80:83], v[176:179], v[240:243], v[80:83]
    ds_read_b128 v[224:227], v250 offset:23552
    ds_read_b128 v[228:231], v250 offset:34816
    v_mfma_f32_16x16x32_bf16 v[84:87], v[180:183], v[240:243], v[84:87]
    v_mfma_f32_16x16x32_bf16 v[88:91], v[208:211], v[240:243], v[88:91]
    v_mfma_f32_16x16x32_bf16 v[92:95], v[212:215], v[240:243], v[92:95]
    v_mfma_f32_16x16x32_bf16 v[80:83], v[184:187], v[244:247], v[80:83]
    v_add_u32 v248, 0x9800, v248
    v_add_u32 v249, 0x9800, v249
    v_mfma_f32_16x16x32_bf16 v[84:87], v[188:191], v[244:247], v[84:87]
    v_mfma_f32_16x16x32_bf16 v[88:91], v[176:179], v[244:247], v[88:91]
    v_mfma_f32_16x16x32_bf16 v[92:95], v[180:183], v[244:247], v[92:95]
    s_waitcnt lgkmcnt(2)
    v_mfma_f32_16x16x32_bf16 v[96:99], v[176:179], v[216:219], v[96:99]
    ds_read_b128 v[232:235], v250 offset:24576
    ds_read_b128 v[236:239], v250 offset:35840
    v_mfma_f32_16x16x32_bf16 v[100:103], v[180:183], v[216:219], v[100:103]
    v_mfma_f32_16x16x32_bf16 v[104:107], v[208:211], v[216:219], v[104:107]
    v_mfma_f32_16x16x32_bf16 v[108:111], v[212:215], v[216:219], v[108:111]
    ds_read_b64_tr_b16 v[192:193], v248 offset:0
    ds_read_b64_tr_b16 v[194:195], v248 offset:1024
    ds_read_b64_tr_b16 v[196:197], v249 offset:0
    ds_read_b64_tr_b16 v[198:199], v249 offset:1024
    v_mfma_f32_16x16x32_bf16 v[96:99], v[184:187], v[220:223], v[96:99]
    v_mfma_f32_16x16x32_bf16 v[100:103], v[188:191], v[220:223], v[100:103]
    v_mfma_f32_16x16x32_bf16 v[104:107], v[176:179], v[220:223], v[104:107]
    v_mfma_f32_16x16x32_bf16 v[108:111], v[180:183], v[220:223], v[108:111]
    s_waitcnt lgkmcnt(6)
    v_mfma_f32_16x16x32_bf16 v[112:115], v[176:179], v[224:227], v[112:115]
    ds_read_b128 v[240:243], v250 offset:25600
    ds_read_b128 v[244:247], v250 offset:36864
    v_mfma_f32_16x16x32_bf16 v[116:119], v[180:183], v[224:227], v[116:119]
    v_mfma_f32_16x16x32_bf16 v[120:123], v[208:211], v[224:227], v[120:123]
    v_mfma_f32_16x16x32_bf16 v[124:127], v[212:215], v[224:227], v[124:127]
    ds_read_b64_tr_b16 v[200:201], v248 offset:8192
    ds_read_b64_tr_b16 v[202:203], v248 offset:9216
    ds_read_b64_tr_b16 v[204:205], v249 offset:8192
    ds_read_b64_tr_b16 v[206:207], v249 offset:9216
    v_mfma_f32_16x16x32_bf16 v[112:115], v[184:187], v[228:231], v[112:115]
    v_mfma_f32_16x16x32_bf16 v[116:119], v[188:191], v[228:231], v[116:119]
    v_mfma_f32_16x16x32_bf16 v[120:123], v[176:179], v[228:231], v[120:123]
    v_mfma_f32_16x16x32_bf16 v[124:127], v[180:183], v[228:231], v[124:127]
    s_waitcnt lgkmcnt(10)
    v_mfma_f32_16x16x32_bf16 v[128:131], v[176:179], v[232:235], v[128:131]
    ds_read_b128 v[216:219], v250 offset:26624
    ds_read_b128 v[220:223], v250 offset:37888
    v_mfma_f32_16x16x32_bf16 v[132:135], v[180:183], v[232:235], v[132:135]
    v_mfma_f32_16x16x32_bf16 v[136:139], v[208:211], v[232:235], v[136:139]
    v_mfma_f32_16x16x32_bf16 v[140:143], v[212:215], v[232:235], v[140:143]
    v_mfma_f32_16x16x32_bf16 v[128:131], v[184:187], v[236:239], v[128:131]
    v_mfma_f32_16x16x32_bf16 v[132:135], v[188:191], v[236:239], v[132:135]
    v_mfma_f32_16x16x32_bf16 v[136:139], v[176:179], v[236:239], v[136:139]
    v_mfma_f32_16x16x32_bf16 v[140:143], v[180:183], v[236:239], v[140:143]
    s_waitcnt lgkmcnt(6)
    v_mfma_f32_16x16x32_bf16 v[144:147], v[176:179], v[240:243], v[144:147]
    v_add_u32 v250, 0x9800, v250
    ds_read_b128 v[224:227], v250 offset:16384
    ds_read_b128 v[228:231], v250 offset:27648
    v_mfma_f32_16x16x32_bf16 v[148:151], v[180:183], v[240:243], v[148:151]
    v_mfma_f32_16x16x32_bf16 v[152:155], v[208:211], v[240:243], v[152:155]
    v_mfma_f32_16x16x32_bf16 v[156:159], v[212:215], v[240:243], v[156:159]
    v_mfma_f32_16x16x32_bf16 v[144:147], v[184:187], v[244:247], v[144:147]
    s_waitcnt lgkmcnt(4)
    v_xor_b32 v212, 0x80008000, v204
    v_xor_b32 v213, 0x80008000, v205
    v_mfma_f32_16x16x32_bf16 v[148:151], v[188:191], v[244:247], v[148:151]
    v_xor_b32 v214, 0x80008000, v206
    v_xor_b32 v215, 0x80008000, v207
    v_mfma_f32_16x16x32_bf16 v[152:155], v[176:179], v[244:247], v[152:155]
    v_mfma_f32_16x16x32_bf16 v[156:159], v[180:183], v[244:247], v[156:159]
    s_waitcnt lgkmcnt(2)
    v_mfma_f32_16x16x32_bf16 v[160:163], v[176:179], v[216:219], v[160:163]
    ds_read_b128 v[232:235], v250 offset:17408
    ds_read_b128 v[236:239], v250 offset:28672
    v_mfma_f32_16x16x32_bf16 v[164:167], v[208:211], v[216:219], v[164:167]
    v_xor_b32 v208, 0x80008000, v200
    v_xor_b32 v209, 0x80008000, v201
    v_mfma_f32_16x16x32_bf16 v[160:163], v[184:187], v[220:223], v[160:163]
    v_xor_b32 v210, 0x80008000, v202
    v_xor_b32 v211, 0x80008000, v203
    v_mfma_f32_16x16x32_bf16 v[164:167], v[176:179], v[220:223], v[164:167]
    s_barrier
    s_waitcnt lgkmcnt(2)
    v_mfma_f32_16x16x32_bf16 v[0:3], v[192:195], v[224:227], v[0:3]
    ds_read_b128 v[240:243], v250 offset:18432
    ds_read_b128 v[244:247], v250 offset:29696
    v_mfma_f32_16x16x32_bf16 v[4:7], v[196:199], v[224:227], v[4:7]
    v_mfma_f32_16x16x32_bf16 v[8:11], v[208:211], v[224:227], v[8:11]
    v_mfma_f32_16x16x32_bf16 v[12:15], v[212:215], v[224:227], v[12:15]
    v_mfma_f32_16x16x32_bf16 v[0:3], v[200:203], v[228:231], v[0:3]
    v_mfma_f32_16x16x32_bf16 v[4:7], v[204:207], v[228:231], v[4:7]
    v_mfma_f32_16x16x32_bf16 v[8:11], v[192:195], v[228:231], v[8:11]
    v_mfma_f32_16x16x32_bf16 v[12:15], v[196:199], v[228:231], v[12:15]
    s_waitcnt lgkmcnt(2)
    v_mfma_f32_16x16x32_bf16 v[16:19], v[192:195], v[232:235], v[16:19]
    ds_read_b128 v[216:219], v250 offset:19456
    ds_read_b128 v[220:223], v250 offset:30720
    v_mfma_f32_16x16x32_bf16 v[20:23], v[196:199], v[232:235], v[20:23]
    v_mfma_f32_16x16x32_bf16 v[24:27], v[208:211], v[232:235], v[24:27]
    v_mfma_f32_16x16x32_bf16 v[28:31], v[212:215], v[232:235], v[28:31]
    v_mfma_f32_16x16x32_bf16 v[16:19], v[200:203], v[236:239], v[16:19]
    v_mfma_f32_16x16x32_bf16 v[20:23], v[204:207], v[236:239], v[20:23]
    v_mfma_f32_16x16x32_bf16 v[24:27], v[192:195], v[236:239], v[24:27]
    v_mfma_f32_16x16x32_bf16 v[28:31], v[196:199], v[236:239], v[28:31]
    s_waitcnt lgkmcnt(2)
    v_mfma_f32_16x16x32_bf16 v[32:35], v[192:195], v[240:243], v[32:35]
    ds_read_b128 v[224:227], v250 offset:20480
    ds_read_b128 v[228:231], v250 offset:31744
    v_mfma_f32_16x16x32_bf16 v[36:39], v[196:199], v[240:243], v[36:39]
    v_mfma_f32_16x16x32_bf16 v[40:43], v[208:211], v[240:243], v[40:43]
    v_mfma_f32_16x16x32_bf16 v[44:47], v[212:215], v[240:243], v[44:47]
    v_mfma_f32_16x16x32_bf16 v[32:35], v[200:203], v[244:247], v[32:35]
    v_mfma_f32_16x16x32_bf16 v[36:39], v[204:207], v[244:247], v[36:39]
    v_mfma_f32_16x16x32_bf16 v[40:43], v[192:195], v[244:247], v[40:43]
    v_mfma_f32_16x16x32_bf16 v[44:47], v[196:199], v[244:247], v[44:47]
    s_waitcnt lgkmcnt(2)
    v_mfma_f32_16x16x32_bf16 v[48:51], v[192:195], v[216:219], v[48:51]
    ds_read_b128 v[232:235], v250 offset:21504
    ds_read_b128 v[236:239], v250 offset:32768
    v_mfma_f32_16x16x32_bf16 v[52:55], v[196:199], v[216:219], v[52:55]
    v_mfma_f32_16x16x32_bf16 v[56:59], v[208:211], v[216:219], v[56:59]
    v_mfma_f32_16x16x32_bf16 v[60:63], v[212:215], v[216:219], v[60:63]
    v_mfma_f32_16x16x32_bf16 v[48:51], v[200:203], v[220:223], v[48:51]
    v_mfma_f32_16x16x32_bf16 v[52:55], v[204:207], v[220:223], v[52:55]
    v_mfma_f32_16x16x32_bf16 v[56:59], v[192:195], v[220:223], v[56:59]
    v_mfma_f32_16x16x32_bf16 v[60:63], v[196:199], v[220:223], v[60:63]
    s_waitcnt lgkmcnt(2)
    v_mfma_f32_16x16x32_bf16 v[64:67], v[192:195], v[224:227], v[64:67]
    ds_read_b128 v[240:243], v250 offset:22528
    ds_read_b128 v[244:247], v250 offset:33792
    v_mfma_f32_16x16x32_bf16 v[68:71], v[196:199], v[224:227], v[68:71]
    v_mfma_f32_16x16x32_bf16 v[72:75], v[208:211], v[224:227], v[72:75]
    v_mfma_f32_16x16x32_bf16 v[76:79], v[212:215], v[224:227], v[76:79]
    v_mfma_f32_16x16x32_bf16 v[64:67], v[200:203], v[228:231], v[64:67]
    v_mfma_f32_16x16x32_bf16 v[68:71], v[204:207], v[228:231], v[68:71]
    v_mfma_f32_16x16x32_bf16 v[72:75], v[192:195], v[228:231], v[72:75]
    v_mfma_f32_16x16x32_bf16 v[76:79], v[196:199], v[228:231], v[76:79]
    s_waitcnt lgkmcnt(2)
    v_mfma_f32_16x16x32_bf16 v[80:83], v[192:195], v[232:235], v[80:83]
    ds_read_b128 v[216:219], v250 offset:23552
    ds_read_b128 v[220:223], v250 offset:34816
    v_mfma_f32_16x16x32_bf16 v[84:87], v[196:199], v[232:235], v[84:87]
    v_mfma_f32_16x16x32_bf16 v[88:91], v[208:211], v[232:235], v[88:91]
    v_mfma_f32_16x16x32_bf16 v[92:95], v[212:215], v[232:235], v[92:95]
    v_mfma_f32_16x16x32_bf16 v[80:83], v[200:203], v[236:239], v[80:83]
    v_add_u32 v248, 0xfffe3800, v248
    v_add_u32 v249, 0xfffe3800, v249
    v_mfma_f32_16x16x32_bf16 v[84:87], v[204:207], v[236:239], v[84:87]
    v_mfma_f32_16x16x32_bf16 v[88:91], v[192:195], v[236:239], v[88:91]
    v_mfma_f32_16x16x32_bf16 v[92:95], v[196:199], v[236:239], v[92:95]
    s_waitcnt lgkmcnt(2)
    v_mfma_f32_16x16x32_bf16 v[96:99], v[192:195], v[240:243], v[96:99]
    ds_read_b128 v[224:227], v250 offset:24576
    ds_read_b128 v[228:231], v250 offset:35840
    v_mfma_f32_16x16x32_bf16 v[100:103], v[196:199], v[240:243], v[100:103]
    v_mfma_f32_16x16x32_bf16 v[104:107], v[208:211], v[240:243], v[104:107]
    v_mfma_f32_16x16x32_bf16 v[108:111], v[212:215], v[240:243], v[108:111]
    ds_read_b64_tr_b16 v[176:177], v248 offset:0
    ds_read_b64_tr_b16 v[178:179], v248 offset:1024
    ds_read_b64_tr_b16 v[180:181], v249 offset:0
    ds_read_b64_tr_b16 v[182:183], v249 offset:1024
    v_mfma_f32_16x16x32_bf16 v[96:99], v[200:203], v[244:247], v[96:99]
    v_mfma_f32_16x16x32_bf16 v[100:103], v[204:207], v[244:247], v[100:103]
    v_mfma_f32_16x16x32_bf16 v[104:107], v[192:195], v[244:247], v[104:107]
    v_mfma_f32_16x16x32_bf16 v[108:111], v[196:199], v[244:247], v[108:111]
    s_waitcnt lgkmcnt(6)
    v_mfma_f32_16x16x32_bf16 v[112:115], v[192:195], v[216:219], v[112:115]
    ds_read_b128 v[232:235], v250 offset:25600
    ds_read_b128 v[236:239], v250 offset:36864
    v_mfma_f32_16x16x32_bf16 v[116:119], v[196:199], v[216:219], v[116:119]
    v_mfma_f32_16x16x32_bf16 v[120:123], v[208:211], v[216:219], v[120:123]
    v_mfma_f32_16x16x32_bf16 v[124:127], v[212:215], v[216:219], v[124:127]
    ds_read_b64_tr_b16 v[184:185], v248 offset:8192
    ds_read_b64_tr_b16 v[186:187], v248 offset:9216
    ds_read_b64_tr_b16 v[188:189], v249 offset:8192
    ds_read_b64_tr_b16 v[190:191], v249 offset:9216
    v_mfma_f32_16x16x32_bf16 v[112:115], v[200:203], v[220:223], v[112:115]
    v_mfma_f32_16x16x32_bf16 v[116:119], v[204:207], v[220:223], v[116:119]
    v_mfma_f32_16x16x32_bf16 v[120:123], v[192:195], v[220:223], v[120:123]
    v_mfma_f32_16x16x32_bf16 v[124:127], v[196:199], v[220:223], v[124:127]
    s_waitcnt lgkmcnt(10)
    v_mfma_f32_16x16x32_bf16 v[128:131], v[192:195], v[224:227], v[128:131]
    ds_read_b128 v[240:243], v250 offset:26624
    ds_read_b128 v[244:247], v250 offset:37888
    v_mfma_f32_16x16x32_bf16 v[132:135], v[196:199], v[224:227], v[132:135]
    v_mfma_f32_16x16x32_bf16 v[136:139], v[208:211], v[224:227], v[136:139]
    v_mfma_f32_16x16x32_bf16 v[140:143], v[212:215], v[224:227], v[140:143]
    v_mfma_f32_16x16x32_bf16 v[128:131], v[200:203], v[228:231], v[128:131]
    v_mfma_f32_16x16x32_bf16 v[132:135], v[204:207], v[228:231], v[132:135]
    v_mfma_f32_16x16x32_bf16 v[136:139], v[192:195], v[228:231], v[136:139]
    v_mfma_f32_16x16x32_bf16 v[140:143], v[196:199], v[228:231], v[140:143]
    s_waitcnt lgkmcnt(6)
    v_mfma_f32_16x16x32_bf16 v[144:147], v[192:195], v[232:235], v[144:147]
    v_add_u32 v250, 0xfffe3800, v250
    ds_read_b128 v[216:219], v250 offset:16384
    ds_read_b128 v[220:223], v250 offset:27648
    v_mfma_f32_16x16x32_bf16 v[148:151], v[196:199], v[232:235], v[148:151]
    v_mfma_f32_16x16x32_bf16 v[152:155], v[208:211], v[232:235], v[152:155]
    v_mfma_f32_16x16x32_bf16 v[156:159], v[212:215], v[232:235], v[156:159]
    v_mfma_f32_16x16x32_bf16 v[144:147], v[200:203], v[236:239], v[144:147]
    s_waitcnt lgkmcnt(4)
    v_xor_b32 v212, 0x80008000, v188
    v_xor_b32 v213, 0x80008000, v189
    v_mfma_f32_16x16x32_bf16 v[148:151], v[204:207], v[236:239], v[148:151]
    v_xor_b32 v214, 0x80008000, v190
    v_xor_b32 v215, 0x80008000, v191
    v_mfma_f32_16x16x32_bf16 v[152:155], v[192:195], v[236:239], v[152:155]
    v_mfma_f32_16x16x32_bf16 v[156:159], v[196:199], v[236:239], v[156:159]
    s_waitcnt lgkmcnt(2)
    v_mfma_f32_16x16x32_bf16 v[160:163], v[192:195], v[240:243], v[160:163]
    ds_read_b128 v[224:227], v250 offset:17408
    ds_read_b128 v[228:231], v250 offset:28672
    v_mfma_f32_16x16x32_bf16 v[164:167], v[208:211], v[240:243], v[164:167]
    v_xor_b32 v208, 0x80008000, v184
    v_xor_b32 v209, 0x80008000, v185
    v_mfma_f32_16x16x32_bf16 v[160:163], v[200:203], v[244:247], v[160:163]
    v_xor_b32 v210, 0x80008000, v186
    v_xor_b32 v211, 0x80008000, v187
    v_mfma_f32_16x16x32_bf16 v[164:167], v[192:195], v[244:247], v[164:167]
    s_sub_u32 s46, s46, 1
    s_cmp_lg_u32 s46, 0
    s_cbranch_scc1 L_g_loop
    s_barrier
    s_waitcnt lgkmcnt(2)
    v_mfma_f32_16x16x32_bf16 v[0:3], v[176:179], v[216:219], v[0:3]
    ds_read_b128 v[232:235], v250 offset:18432
    ds_read_b128 v[236:239], v250 offset:29696
    v_mfma_f32_16x16x32_bf16 v[4:7], v[180:183], v[216:219], v[4:7]
    v_mfma_f32_16x16x32_bf16 v[8:11], v[208:211], v[216:219], v[8:11]
    v_mfma_f32_16x16x32_bf16 v[12:15], v[212:215], v[216:219], v[12:15]
    v_mfma_f32_16x16x32_bf16 v[0:3], v[184:187], v[220:223], v[0:3]
    v_mfma_f32_16x16x32_bf16 v[4:7], v[188:191], v[220:223], v[4:7]
    v_mfma_f32_16x16x32_bf16 v[8:11], v[176:179], v[220:223], v[8:11]
    v_mfma_f32_16x16x32_bf16 v[12:15], v[180:183], v[220:223], v[12:15]
    s_waitcnt lgkmcnt(2)
    v_mfma_f32_16x16x32_bf16 v[16:19], v[176:179], v[224:227], v[16:19]
    ds_read_b128 v[240:243], v250 offset:19456
    ds_read_b128 v[244:247], v250 offset:30720
    v_mfma_f32_16x16x32_bf16 v[20:23], v[180:183], v[224:227], v[20:23]
    v_mfma_f32_16x16x32_bf16 v[24:27], v[208:211], v[224:227], v[24:27]
    v_mfma_f32_16x16x32_bf16 v[28:31], v[212:215], v[224:227], v[28:31]
    v_mfma_f32_16x16x32_bf16 v[16:19], v[184:187], v[228:231], v[16:19]
    v_mfma_f32_16x16x32_bf16 v[20:23], v[188:191], v[228:231], v[20:23]
    v_mfma_f32_16x16x32_bf16 v[24:27], v[176:179], v[228:231], v[24:27]
    v_mfma_f32_16x16x32_bf16 v[28:31], v[180:183], v[228:231], v[28:31]
    s_waitcnt lgkmcnt(2)
    v_mfma_f32_16x16x32_bf16 v[32:35], v[176:179], v[232:235], v[32:35]
    ds_read_b128 v[216:219], v250 offset:20480
    ds_read_b128 v[220:223], v250 offset:31744
    v_mfma_f32_16x16x32_bf16 v[36:39], v[180:183], v[232:235], v[36:39]
    v_mfma_f32_16x16x32_bf16 v[40:43], v[208:211], v[232:235], v[40:43]
    v_mfma_f32_16x16x32_bf16 v[44:47], v[212:215], v[232:235], v[44:47]
    v_mfma_f32_16x16x32_bf16 v[32:35], v[184:187], v[236:239], v[32:35]
    v_mfma_f32_16x16x32_bf16 v[36:39], v[188:191], v[236:239], v[36:39]
    v_mfma_f32_16x16x32_bf16 v[40:43], v[176:179], v[236:239], v[40:43]
    v_mfma_f32_16x16x32_bf16 v[44:47], v[180:183], v[236:239], v[44:47]
    s_waitcnt lgkmcnt(2)
    v_mfma_f32_16x16x32_bf16 v[48:51], v[176:179], v[240:243], v[48:51]
    ds_read_b128 v[224:227], v250 offset:21504
    ds_read_b128 v[228:231], v250 offset:32768
    v_mfma_f32_16x16x32_bf16 v[52:55], v[180:183], v[240:243], v[52:55]
    v_mfma_f32_16x16x32_bf16 v[56:59], v[208:211], v[240:243], v[56:59]
    v_mfma_f32_16x16x32_bf16 v[60:63], v[212:215], v[240:243], v[60:63]
    v_mfma_f32_16x16x32_bf16 v[48:51], v[184:187], v[244:247], v[48:51]
    v_mfma_f32_16x16x32_bf16 v[52:55], v[188:191], v[244:247], v[52:55]
    v_mfma_f32_16x16x32_bf16 v[56:59], v[176:179], v[244:247], v[56:59]
    v_mfma_f32_16x16x32_bf16 v[60:63], v[180:183], v[244:247], v[60:63]
    s_waitcnt lgkmcnt(2)
    v_mfma_f32_16x16x32_bf16 v[64:67], v[176:179], v[216:219], v[64:67]
    ds_read_b128 v[232:235], v250 offset:22528
    ds_read_b128 v[236:239], v250 offset:33792
    v_mfma_f32_16x16x32_bf16 v[68:71], v[180:183], v[216:219], v[68:71]
    v_mfma_f32_16x16x32_bf16 v[72:75], v[208:211], v[216:219], v[72:75]
    v_mfma_f32_16x16x32_bf16 v[76:79], v[212:215], v[216:219], v[76:79]
    v_mfma_f32_16x16x32_bf16 v[64:67], v[184:187], v[220:223], v[64:67]
    v_mfma_f32_16x16x32_bf16 v[68:71], v[188:191], v[220:223], v[68:71]
    v_mfma_f32_16x16x32_bf16 v[72:75], v[176:179], v[220:223], v[72:75]
    v_mfma_f32_16x16x32_bf16 v[76:79], v[180:183], v[220:223], v[76:79]
    s_waitcnt lgkmcnt(2)
    v_mfma_f32_16x16x32_bf16 v[80:83], v[176:179], v[224:227], v[80:83]
    ds_read_b128 v[240:243], v250 offset:23552
    ds_read_b128 v[244:247], v250 offset:34816
    v_mfma_f32_16x16x32_bf16 v[84:87], v[180:183], v[224:227], v[84:87]
    v_mfma_f32_16x16x32_bf16 v[88:91], v[208:211], v[224:227], v[88:91]
    v_mfma_f32_16x16x32_bf16 v[92:95], v[212:215], v[224:227], v[92:95]
    v_mfma_f32_16x16x32_bf16 v[80:83], v[184:187], v[228:231], v[80:83]
    v_add_u32 v248, 0x9800, v248
    v_add_u32 v249, 0x9800, v249
    v_mfma_f32_16x16x32_bf16 v[84:87], v[188:191], v[228:231], v[84:87]
    v_mfma_f32_16x16x32_bf16 v[88:91], v[176:179], v[228:231], v[88:91]
    v_mfma_f32_16x16x32_bf16 v[92:95], v[180:183], v[228:231], v[92:95]
    s_waitcnt lgkmcnt(2)
    v_mfma_f32_16x16x32_bf16 v[96:99], v[176:179], v[232:235], v[96:99]
    ds_read_b128 v[216:219], v250 offset:24576
    ds_read_b128 v[220:223], v250 offset:35840
    v_mfma_f32_16x16x32_bf16 v[100:103], v[180:183], v[232:235], v[100:103]
    v_mfma_f32_16x16x32_bf16 v[104:107], v[208:211], v[232:235], v[104:107]
    v_mfma_f32_16x16x32_bf16 v[108:111], v[212:215], v[232:235], v[108:111]
    ds_read_b64_tr_b16 v[192:193], v248 offset:0
    ds_read_b64_tr_b16 v[194:195], v248 offset:1024
    ds_read_b64_tr_b16 v[196:197], v249 offset:0
    ds_read_b64_tr_b16 v[198:199], v249 offset:1024
    v_mfma_f32_16x16x32_bf16 v[96:99], v[184:187], v[236:239], v[96:99]
    v_mfma_f32_16x16x32_bf16 v[100:103], v[188:191], v[236:239], v[100:103]
    v_mfma_f32_16x16x32_bf16 v[104:107], v[176:179], v[236:239], v[104:107]
    v_mfma_f32_16x16x32_bf16 v[108:111], v[180:183], v[236:239], v[108:111]
    s_waitcnt lgkmcnt(6)
    v_mfma_f32_16x16x32_bf16 v[112:115], v[176:179], v[240:243], v[112:115]
    ds_read_b128 v[224:227], v250 offset:25600
    ds_read_b128 v[228:231], v250 offset:36864
    v_mfma_f32_16x16x32_bf16 v[116:119], v[180:183], v[240:243], v[116:119]
    v_mfma_f32_16x16x32_bf16 v[120:123], v[208:211], v[240:243], v[120:123]
    v_mfma_f32_16x16x32_bf16 v[124:127], v[212:215], v[240:243], v[124:127]
    ds_read_b64_tr_b16 v[200:201], v248 offset:8192
    ds_read_b64_tr_b16 v[202:203], v248 offset:9216
    ds_read_b64_tr_b16 v[204:205], v249 offset:8192
    ds_read_b64_tr_b16 v[206:207], v249 offset:9216
    v_mfma_f32_16x16x32_bf16 v[112:115], v[184:187], v[244:247], v[112:115]
    v_mfma_f32_16x16x32_bf16 v[116:119], v[188:191], v[244:247], v[116:119]
    v_mfma_f32_16x16x32_bf16 v[120:123], v[176:179], v[244:247], v[120:123]
    v_mfma_f32_16x16x32_bf16 v[124:127], v[180:183], v[244:247], v[124:127]
    s_waitcnt lgkmcnt(10)
    v_mfma_f32_16x16x32_bf16 v[128:131], v[176:179], v[216:219], v[128:131]
    ds_read_b128 v[232:235], v250 offset:26624
    ds_read_b128 v[236:239], v250 offset:37888
    v_mfma_f32_16x16x32_bf16 v[132:135], v[180:183], v[216:219], v[132:135]
    v_mfma_f32_16x16x32_bf16 v[136:139], v[208:211], v[216:219], v[136:139]
    v_mfma_f32_16x16x32_bf16 v[140:143], v[212:215], v[216:219], v[140:143]
    v_mfma_f32_16x16x32_bf16 v[128:131], v[184:187], v[220:223], v[128:131]
    v_mfma_f32_16x16x32_bf16 v[132:135], v[188:191], v[220:223], v[132:135]
    v_mfma_f32_16x16x32_bf16 v[136:139], v[176:179], v[220:223], v[136:139]
    v_mfma_f32_16x16x32_bf16 v[140:143], v[180:183], v[220:223], v[140:143]
    s_waitcnt lgkmcnt(6)
    v_mfma_f32_16x16x32_bf16 v[144:147], v[176:179], v[224:227], v[144:147]
    v_add_u32 v250, 0x9800, v250
    ds_read_b128 v[240:243], v250 offset:16384
    ds_read_b128 v[244:247], v250 offset:27648
    v_mfma_f32_16x16x32_bf16 v[148:151], v[180:183], v[224:227], v[148:151]
    v_mfma_f32_16x16x32_bf16 v[152:155], v[208:211], v[224:227], v[152:155]
    v_mfma_f32_16x16x32_bf16 v[156:159], v[212:215], v[224:227], v[156:159]
    v_mfma_f32_16x16x32_bf16 v[144:147], v[184:187], v[228:231], v[144:147]
    s_waitcnt lgkmcnt(4)
    v_xor_b32 v212, 0x80008000, v204
    v_xor_b32 v213, 0x80008000, v205
    v_mfma_f32_16x16x32_bf16 v[148:151], v[188:191], v[228:231], v[148:151]
    v_xor_b32 v214, 0x80008000, v206
    v_xor_b32 v215, 0x80008000, v207
    v_mfma_f32_16x16x32_bf16 v[152:155], v[176:179], v[228:231], v[152:155]
    v_mfma_f32_16x16x32_bf16 v[156:159], v[180:183], v[228:231], v[156:159]
    s_waitcnt lgkmcnt(2)
    v_mfma_f32_16x16x32_bf16 v[160:163], v[176:179], v[232:235], v[160:163]
    ds_read_b128 v[216:219], v250 offset:17408
    ds_read_b128 v[220:223], v250 offset:28672
    v_mfma_f32_16x16x32_bf16 v[164:167], v[208:211], v[232:235], v[164:167]
    v_xor_b32 v208, 0x80008000, v200
    v_xor_b32 v209, 0x80008000, v201
    v_mfma_f32_16x16x32_bf16 v[160:163], v[184:187], v[236:239], v[160:163]
    v_xor_b32 v210, 0x80008000, v202
    v_xor_b32 v211, 0x80008000, v203
    v_mfma_f32_16x16x32_bf16 v[164:167], v[176:179], v[236:239], v[164:167]
    s_barrier
    s_waitcnt lgkmcnt(2)
    v_mfma_f32_16x16x32_bf16 v[0:3], v[192:195], v[240:243], v[0:3]
    ds_read_b128 v[224:227], v250 offset:18432
    ds_read_b128 v[228:231], v250 offset:29696
    v_mfma_f32_16x16x32_bf16 v[4:7], v[196:199], v[240:243], v[4:7]
    v_mfma_f32_16x16x32_bf16 v[8:11], v[208:211], v[240:243], v[8:11]
    v_mfma_f32_16x16x32_bf16 v[12:15], v[212:215], v[240:243], v[12:15]
    v_mfma_f32_16x16x32_bf16 v[0:3], v[200:203], v[244:247], v[0:3]
    v_mfma_f32_16x16x32_bf16 v[4:7], v[204:207], v[244:247], v[4:7]
    v_mfma_f32_16x16x32_bf16 v[8:11], v[192:195], v[244:247], v[8:11]
    v_mfma_f32_16x16x32_bf16 v[12:15], v[196:199], v[244:247], v[12:15]
    s_waitcnt lgkmcnt(2)
    v_mfma_f32_16x16x32_bf16 v[16:19], v[192:195], v[216:219], v[16:19]
    ds_read_b128 v[232:235], v250 offset:19456
    ds_read_b128 v[236:239], v250 offset:30720
    v_mfma_f32_16x16x32_bf16 v[20:23], v[196:199], v[216:219], v[20:23]
    v_mfma_f32_16x16x32_bf16 v[24:27], v[208:211], v[216:219], v[24:27]
    v_mfma_f32_16x16x32_bf16 v[28:31], v[212:215], v[216:219], v[28:31]
    v_mfma_f32_16x16x32_bf16 v[16:19], v[200:203], v[220:223], v[16:19]
    v_mfma_f32_16x16x32_bf16 v[20:23], v[204:207], v[220:223], v[20:23]
    v_mfma_f32_16x16x32_bf16 v[24:27], v[192:195], v[220:223], v[24:27]
    v_mfma_f32_16x16x32_bf16 v[28:31], v[196:199], v[220:223], v[28:31]
    s_waitcnt lgkmcnt(2)
    v_mfma_f32_16x16x32_bf16 v[32:35], v[192:195], v[224:227], v[32:35]
    ds_read_b128 v[240:243], v250 offset:20480
    ds_read_b128 v[244:247], v250 offset:31744
    v_mfma_f32_16x16x32_bf16 v[36:39], v[196:199], v[224:227], v[36:39]
    v_mfma_f32_16x16x32_bf16 v[40:43], v[208:211], v[224:227], v[40:43]
    v_mfma_f32_16x16x32_bf16 v[44:47], v[212:215], v[224:227], v[44:47]
    v_mfma_f32_16x16x32_bf16 v[32:35], v[200:203], v[228:231], v[32:35]
    v_mfma_f32_16x16x32_bf16 v[36:39], v[204:207], v[228:231], v[36:39]
    v_mfma_f32_16x16x32_bf16 v[40:43], v[192:195], v[228:231], v[40:43]
    v_mfma_f32_16x16x32_bf16 v[44:47], v[196:199], v[228:231], v[44:47]
    s_waitcnt lgkmcnt(2)
    v_mfma_f32_16x16x32_bf16 v[48:51], v[192:195], v[232:235], v[48:51]
    ds_read_b128 v[216:219], v250 offset:21504
    ds_read_b128 v[220:223], v250 offset:32768
    v_mfma_f32_16x16x32_bf16 v[52:55], v[196:199], v[232:235], v[52:55]
    v_mfma_f32_16x16x32_bf16 v[56:59], v[208:211], v[232:235], v[56:59]
    v_mfma_f32_16x16x32_bf16 v[60:63], v[212:215], v[232:235], v[60:63]
    v_mfma_f32_16x16x32_bf16 v[48:51], v[200:203], v[236:239], v[48:51]
    v_mfma_f32_16x16x32_bf16 v[52:55], v[204:207], v[236:239], v[52:55]
    v_mfma_f32_16x16x32_bf16 v[56:59], v[192:195], v[236:239], v[56:59]
    v_mfma_f32_16x16x32_bf16 v[60:63], v[196:199], v[236:239], v[60:63]
    s_waitcnt lgkmcnt(2)
    v_mfma_f32_16x16x32_bf16 v[64:67], v[192:195], v[240:243], v[64:67]
    ds_read_b128 v[224:227], v250 offset:22528
    ds_read_b128 v[228:231], v250 offset:33792
    v_mfma_f32_16x16x32_bf16 v[68:71], v[196:199], v[240:243], v[68:71]
    v_mfma_f32_16x16x32_bf16 v[72:75], v[208:211], v[240:243], v[72:75]
    v_mfma_f32_16x16x32_bf16 v[76:79], v[212:215], v[240:243], v[76:79]
    v_mfma_f32_16x16x32_bf16 v[64:67], v[200:203], v[244:247], v[64:67]
    v_mfma_f32_16x16x32_bf16 v[68:71], v[204:207], v[244:247], v[68:71]
    v_mfma_f32_16x16x32_bf16 v[72:75], v[192:195], v[244:247], v[72:75]
    v_mfma_f32_16x16x32_bf16 v[76:79], v[196:199], v[244:247], v[76:79]
    s_waitcnt lgkmcnt(2)
    v_mfma_f32_16x16x32_bf16 v[80:83], v[192:195], v[216:219], v[80:83]
    ds_read_b128 v[232:235], v250 offset:23552
    ds_read_b128 v[236:239], v250 offset:34816
    v_mfma_f32_16x16x32_bf16 v[84:87], v[196:199], v[216:219], v[84:87]
    v_mfma_f32_16x16x32_bf16 v[88:91], v[208:211], v[216:219], v[88:91]
    v_mfma_f32_16x16x32_bf16 v[92:95], v[212:215], v[216:219], v[92:95]
    v_mfma_f32_16x16x32_bf16 v[80:83], v[200:203], v[220:223], v[80:83]
    v_add_u32 v248, 0x9800, v248
    v_add_u32 v249, 0x9800, v249
    v_mfma_f32_16x16x32_bf16 v[84:87], v[204:207], v[220:223], v[84:87]
    v_mfma_f32_16x16x32_bf16 v[88:91], v[192:195], v[220:223], v[88:91]
    v_mfma_f32_16x16x32_bf16 v[92:95], v[196:199], v[220:223], v[92:95]
    s_waitcnt lgkmcnt(2)
    v_mfma_f32_16x16x32_bf16 v[96:99], v[192:195], v[224:227], v[96:99]
    ds_read_b128 v[240:243], v250 offset:24576
    ds_read_b128 v[244:247], v250 offset:35840
    v_mfma_f32_16x16x32_bf16 v[100:103], v[196:199], v[224:227], v[100:103]
    v_mfma_f32_16x16x32_bf16 v[104:107], v[208:211], v[224:227], v[104:107]
    v_mfma_f32_16x16x32_bf16 v[108:111], v[212:215], v[224:227], v[108:111]
    ds_read_b64_tr_b16 v[176:177], v248 offset:0
    ds_read_b64_tr_b16 v[178:179], v248 offset:1024
    ds_read_b64_tr_b16 v[180:181], v249 offset:0
    ds_read_b64_tr_b16 v[182:183], v249 offset:1024
    v_mfma_f32_16x16x32_bf16 v[96:99], v[200:203], v[228:231], v[96:99]
    v_mfma_f32_16x16x32_bf16 v[100:103], v[204:207], v[228:231], v[100:103]
    v_mfma_f32_16x16x32_bf16 v[104:107], v[192:195], v[228:231], v[104:107]
    v_mfma_f32_16x16x32_bf16 v[108:111], v[196:199], v[228:231], v[108:111]
    s_waitcnt lgkmcnt(6)
    v_mfma_f32_16x16x32_bf16 v[112:115], v[192:195], v[232:235], v[112:115]
    ds_read_b128 v[216:219], v250 offset:25600
    ds_read_b128 v[220:223], v250 offset:36864
    v_mfma_f32_16x16x32_bf16 v[116:119], v[196:199], v[232:235], v[116:119]
    v_mfma_f32_16x16x32_bf16 v[120:123], v[208:211], v[232:235], v[120:123]
    v_mfma_f32_16x16x32_bf16 v[124:127], v[212:215], v[232:235], v[124:127]
    ds_read_b64_tr_b16 v[184:185], v248 offset:8192
    ds_read_b64_tr_b16 v[186:187], v248 offset:9216
    ds_read_b64_tr_b16 v[188:189], v249 offset:8192
    ds_read_b64_tr_b16 v[190:191], v249 offset:9216
    v_mfma_f32_16x16x32_bf16 v[112:115], v[200:203], v[236:239], v[112:115]
    v_mfma_f32_16x16x32_bf16 v[116:119], v[204:207], v[236:239], v[116:119]
    v_mfma_f32_16x16x32_bf16 v[120:123], v[192:195], v[236:239], v[120:123]
    v_mfma_f32_16x16x32_bf16 v[124:127], v[196:199], v[236:239], v[124:127]
    s_waitcnt lgkmcnt(10)
    v_mfma_f32_16x16x32_bf16 v[128:131], v[192:195], v[240:243], v[128:131]
    ds_read_b128 v[224:227], v250 offset:26624
    ds_read_b128 v[228:231], v250 offset:37888
    v_mfma_f32_16x16x32_bf16 v[132:135], v[196:199], v[240:243], v[132:135]
    v_mfma_f32_16x16x32_bf16 v[136:139], v[208:211], v[240:243], v[136:139]
    v_mfma_f32_16x16x32_bf16 v[140:143], v[212:215], v[240:243], v[140:143]
    v_mfma_f32_16x16x32_bf16 v[128:131], v[200:203], v[244:247], v[128:131]
    v_mfma_f32_16x16x32_bf16 v[132:135], v[204:207], v[244:247], v[132:135]
    v_mfma_f32_16x16x32_bf16 v[136:139], v[192:195], v[244:247], v[136:139]
    v_mfma_f32_16x16x32_bf16 v[140:143], v[196:199], v[244:247], v[140:143]
    s_waitcnt lgkmcnt(6)
    v_mfma_f32_16x16x32_bf16 v[144:147], v[192:195], v[216:219], v[144:147]
    v_add_u32 v250, 0x9800, v250
    ds_read_b128 v[232:235], v250 offset:16384
    ds_read_b128 v[236:239], v250 offset:27648
    v_mfma_f32_16x16x32_bf16 v[148:151], v[196:199], v[216:219], v[148:151]
    v_mfma_f32_16x16x32_bf16 v[152:155], v[208:211], v[216:219], v[152:155]
    v_mfma_f32_16x16x32_bf16 v[156:159], v[212:215], v[216:219], v[156:159]
    v_mfma_f32_16x16x32_bf16 v[144:147], v[200:203], v[220:223], v[144:147]
    s_waitcnt lgkmcnt(4)
    v_xor_b32 v212, 0x80008000, v188
    v_xor_b32 v213, 0x80008000, v189
    v_mfma_f32_16x16x32_bf16 v[148:151], v[204:207], v[220:223], v[148:151]
    v_xor_b32 v214, 0x80008000, v190
    v_xor_b32 v215, 0x80008000, v191
    v_mfma_f32_16x16x32_bf16 v[152:155], v[192:195], v[220:223], v[152:155]
    v_mfma_f32_16x16x32_bf16 v[156:159], v[196:199], v[220:223], v[156:159]
    s_waitcnt lgkmcnt(2)
    v_mfma_f32_16x16x32_bf16 v[160:163], v[192:195], v[224:227], v[160:163]
    ds_read_b128 v[240:243], v250 offset:17408
    ds_read_b128 v[244:247], v250 offset:28672
    v_mfma_f32_16x16x32_bf16 v[164:167], v[208:211], v[224:227], v[164:167]
    v_xor_b32 v208, 0x80008000, v184
    v_xor_b32 v209, 0x80008000, v185
    v_mfma_f32_16x16x32_bf16 v[160:163], v[200:203], v[228:231], v[160:163]
    v_xor_b32 v210, 0x80008000, v186
    v_xor_b32 v211, 0x80008000, v187
    v_mfma_f32_16x16x32_bf16 v[164:167], v[192:195], v[228:231], v[164:167]
    s_barrier
    s_cmp_lg_u32 s13, 0
    s_cbranch_scc1 L_epi_b1
    v_add_u32 v248, 0x9800, v248
    v_add_u32 v249, 0x9800, v249
    v_add_u32 v253, 38912, v250
    ds_read_b64_tr_b16 v[192:193], v248 offset:0
    ds_read_b64_tr_b16 v[194:195], v248 offset:1024
    ds_read_b64_tr_b16 v[196:197], v249 offset:0
    ds_read_b64_tr_b16 v[198:199], v249 offset:1024
    ds_read_b64_tr_b16 v[200:201], v248 offset:8192
    ds_read_b64_tr_b16 v[202:203], v248 offset:9216
    ds_read_b64_tr_b16 v[204:205], v249 offset:8192
    ds_read_b64_tr_b16 v[206:207], v249 offset:9216
    s_waitcnt lgkmcnt(10)
    v_mfma_f32_16x16x32_bf16 v[0:3], v[176:179], v[232:235], v[0:3]
    ds_read_b128 v[216:219], v250 offset:18432
    ds_read_b128 v[220:223], v250 offset:29696
    v_mfma_f32_16x16x32_bf16 v[4:7], v[180:183], v[232:235], v[4:7]
    v_mfma_f32_16x16x32_bf16 v[8:11], v[208:211], v[232:235], v[8:11]
    v_mfma_f32_16x16x32_bf16 v[12:15], v[212:215], v[232:235], v[12:15]
    v_mfma_f32_16x16x32_bf16 v[0:3], v[184:187], v[236:239], v[0:3]
    v_mfma_f32_16x16x32_bf16 v[4:7], v[188:191], v[236:239], v[4:7]
    v_mfma_f32_16x16x32_bf16 v[8:11], v[176:179], v[236:239], v[8:11]
    v_mfma_f32_16x16x32_bf16 v[12:15], v[180:183], v[236:239], v[12:15]
    s_waitcnt lgkmcnt(10)
    v_mfma_f32_16x16x32_bf16 v[16:19], v[176:179], v[240:243], v[16:19]
    ds_read_b128 v[224:227], v253 offset:16384
    ds_read_b128 v[228:231], v253 offset:27648
    v_mfma_f32_16x16x32_bf16 v[20:23], v[180:183], v[240:243], v[20:23]
    v_mfma_f32_16x16x32_bf16 v[24:27], v[208:211], v[240:243], v[24:27]
    v_mfma_f32_16x16x32_bf16 v[28:31], v[212:215], v[240:243], v[28:31]
    v_mfma_f32_16x16x32_bf16 v[16:19], v[184:187], v[244:247], v[16:19]
    v_mfma_f32_16x16x32_bf16 v[20:23], v[188:191], v[244:247], v[20:23]
    v_mfma_f32_16x16x32_bf16 v[24:27], v[176:179], v[244:247], v[24:27]
    v_mfma_f32_16x16x32_bf16 v[28:31], v[180:183], v[244:247], v[28:31]
    s_waitcnt lgkmcnt(2)
    v_mfma_f32_16x16x32_bf16 v[32:35], v[176:179], v[216:219], v[32:35]
    ds_read_b128 v[232:235], v250 offset:19456
    ds_read_b128 v[236:239], v250 offset:30720
    v_mfma_f32_16x16x32_bf16 v[36:39], v[180:183], v[216:219], v[36:39]
    v_mfma_f32_16x16x32_bf16 v[40:43], v[208:211], v[216:219], v[40:43]
    v_mfma_f32_16x16x32_bf16 v[44:47], v[212:215], v[216:219], v[44:47]
    v_mfma_f32_16x16x32_bf16 v[32:35], v[184:187], v[220:223], v[32:35]
    v_mfma_f32_16x16x32_bf16 v[36:39], v[188:191], v[220:223], v[36:39]
    v_mfma_f32_16x16x32_bf16 v[40:43], v[176:179], v[220:223], v[40:43]
    v_mfma_f32_16x16x32_bf16 v[44:47], v[180:183], v[220:223], v[44:47]
    v_xor_b32 v168, 0x80008000, v200
    v_xor_b32 v169, 0x80008000, v201
    v_xor_b32 v170, 0x80008000, v202
    v_xor_b32 v171, 0x80008000, v203
    v_xor_b32 v172, 0x80008000, v204
    v_xor_b32 v173, 0x80008000, v205
    v_xor_b32 v174, 0x80008000, v206
    v_xor_b32 v175, 0x80008000, v207
    s_waitcnt lgkmcnt(2)
    v_mfma_f32_16x16x32_bf16 v[0:3], v[192:195], v[224:227], v[0:3]
    ds_read_b128 v[240:243], v253 offset:17408
    ds_read_b128 v[244:247], v253 offset:28672
    v_mfma_f32_16x16x32_bf16 v[4:7], v[196:199], v[224:227], v[4:7]
    v_mfma_f32_16x16x32_bf16 v[8:11], v[168:171], v[224:227], v[8:11]
    v_mfma_f32_16x16x32_bf16 v[12:15], v[172:175], v[224:227], v[12:15]
    v_mfma_f32_16x16x32_bf16 v[0:3], v[200:203], v[228:231], v[0:3]
    v_mfma_f32_16x16x32_bf16 v[4:7], v[204:207], v[228:231], v[4:7]
    v_mfma_f32_16x16x32_bf16 v[8:11], v[192:195], v[228:231], v[8:11]
    v_mfma_f32_16x16x32_bf16 v[12:15], v[196:199], v[228:231], v[12:15]
    s_waitcnt lgkmcnt(2)
    v_mfma_f32_16x16x32_bf16 v[48:51], v[176:179], v[232:235], v[48:51]
    ds_read_b128 v[216:219], v250 offset:20480
    ds_read_b128 v[220:223], v250 offset:31744
    v_mfma_f32_16x16x32_bf16 v[52:55], v[180:183], v[232:235], v[52:55]
    v_mfma_f32_16x16x32_bf16 v[56:59], v[208:211], v[232:235], v[56:59]
    v_mfma_f32_16x16x32_bf16 v[60:63], v[212:215], v[232:235], v[60:63]
    v_mfma_f32_16x16x32_bf16 v[48:51], v[184:187], v[236:239], v[48:51]
    v_mfma_f32_16x16x32_bf16 v[52:55], v[188:191], v[236:239], v[52:55]
    v_mfma_f32_16x16x32_bf16 v[56:59], v[176:179], v[236:239], v[56:59]
    v_mfma_f32_16x16x32_bf16 v[60:63], v[180:183], v[236:239], v[60:63]
    s_waitcnt lgkmcnt(2)
    v_mfma_f32_16x16x32_bf16 v[16:19], v[192:195], v[240:243], v[16:19]
    ds_read_b128 v[224:227], v253 offset:18432
    ds_read_b128 v[228:231], v253 offset:29696
    v_mfma_f32_16x16x32_bf16 v[20:23], v[196:199], v[240:243], v[20:23]
    v_cvt_pk_bf16_f32 v0, v0, v1
    v_cvt_pk_bf16_f32 v1, v2, v3
    v_mfma_f32_16x16x32_bf16 v[24:27], v[168:171], v[240:243], v[24:27]
    v_cvt_pk_bf16_f32 v2, v4, v5
    v_cvt_pk_bf16_f32 v3, v6, v7
    v_mfma_f32_16x16x32_bf16 v[28:31], v[172:175], v[240:243], v[28:31]
    s_add_u32 s47, s48, 0
    buffer_store_dwordx4 v[0:3], v251, s[16:19], s47 offen sc1
    v_mfma_f32_16x16x32_bf16 v[16:19], v[200:203], v[244:247], v[16:19]
    v_cvt_pk_bf16_f32 v8, v8, v9
    v_cvt_pk_bf16_f32 v9, v10, v11
    v_mfma_f32_16x16x32_bf16 v[20:23], v[204:207], v[244:247], v[20:23]
    v_cvt_pk_bf16_f32 v10, v12, v13
    v_cvt_pk_bf16_f32 v11, v14, v15
    v_mfma_f32_16x16x32_bf16 v[24:27], v[192:195], v[244:247], v[24:27]
    s_add_u32 s47, s48, 1024
    buffer_store_dwordx4 v[8:11], v251, s[16:19], s47 offen sc1
    v_mfma_f32_16x16x32_bf16 v[28:31], v[196:199], v[244:247], v[28:31]
    s_waitcnt lgkmcnt(2)
    v_mfma_f32_16x16x32_bf16 v[64:67], v[176:179], v[216:219], v[64:67]
    ds_read_b128 v[232:235], v250 offset:21504
    ds_read_b128 v[236:239], v250 offset:32768
    v_mfma_f32_16x16x32_bf16 v[68:71], v[180:183], v[216:219], v[68:71]
    v_mfma_f32_16x16x32_bf16 v[72:75], v[208:211], v[216:219], v[72:75]
    v_mfma_f32_16x16x32_bf16 v[76:79], v[212:215], v[216:219], v[76:79]
    v_mfma_f32_16x16x32_bf16 v[64:67], v[184:187], v[220:223], v[64:67]
    v_mfma_f32_16x16x32_bf16 v[68:71], v[188:191], v[220:223], v[68:71]
    v_mfma_f32_16x16x32_bf16 v[72:75], v[176:179], v[220:223], v[72:75]
    v_mfma_f32_16x16x32_bf16 v[76:79], v[180:183], v[220:223], v[76:79]
    s_waitcnt lgkmcnt(2)
    v_mfma_f32_16x16x32_bf16 v[32:35], v[192:195], v[224:227], v[32:35]
    ds_read_b128 v[240:243], v253 offset:19456
    ds_read_b128 v[244:247], v253 offset:30720
    v_mfma_f32_16x16x32_bf16 v[36:39], v[196:199], v[224:227], v[36:39]
    v_cvt_pk_bf16_f32 v16, v16, v17
    v_cvt_pk_bf16_f32 v17, v18, v19
    v_mfma_f32_16x16x32_bf16 v[40:43], v[168:171], v[224:227], v[40:43]
    v_cvt_pk_bf16_f32 v18, v20, v21
    v_cvt_pk_bf16_f32 v19, v22, v23
    v_mfma_f32_16x16x32_bf16 v[44:47], v[172:175], v[224:227], v[44:47]
    s_add_u32 s47, s48, 1052672
    buffer_store_dwordx4 v[16:19], v251, s[16:19], s47 offen sc1
    v_mfma_f32_16x16x32_bf16 v[32:35], v[200:203], v[228:231], v[32:35]
    v_cvt_pk_bf16_f32 v24, v24, v25
    v_cvt_pk_bf16_f32 v25, v26, v27
    v_mfma_f32_16x16x32_bf16 v[36:39], v[204:207], v[228:231], v[36:39]
    v_cvt_pk_bf16_f32 v26, v28, v29
    v_cvt_pk_bf16_f32 v27, v30, v31
    v_mfma_f32_16x16x32_bf16 v[40:43], v[192:195], v[228:231], v[40:43]
    s_add_u32 s47, s48, 1053696
    buffer_store_dwordx4 v[24:27], v251, s[16:19], s47 offen sc1
    v_mfma_f32_16x16x32_bf16 v[44:47], v[196:199], v[228:231], v[44:47]
    s_waitcnt lgkmcnt(2)
    v_mfma_f32_16x16x32_bf16 v[80:83], v[176:179], v[232:235], v[80:83]
    ds_read_b128 v[216:219], v250 offset:22528
    ds_read_b128 v[220:223], v250 offset:33792
    v_mfma_f32_16x16x32_bf16 v[84:87], v[180:183], v[232:235], v[84:87]
    v_mfma_f32_16x16x32_bf16 v[88:91], v[208:211], v[232:235], v[88:91]
    v_mfma_f32_16x16x32_bf16 v[92:95], v[212:215], v[232:235], v[92:95]
    v_mfma_f32_16x16x32_bf16 v[80:83], v[184:187], v[236:239], v[80:83]
    v_mfma_f32_16x16x32_bf16 v[84:87], v[188:191], v[236:239], v[84:87]
    v_mfma_f32_16x16x32_bf16 v[88:91], v[176:179], v[236:239], v[88:91]
    v_mfma_f32_16x16x32_bf16 v[92:95], v[180:183], v[236:239], v[92:95]
    s_waitcnt lgkmcnt(2)
    v_mfma_f32_16x16x32_bf16 v[48:51], v[192:195], v[240:243], v[48:51]
    ds_read_b128 v[224:227], v253 offset:20480
    ds_read_b128 v[228:231], v253 offset:31744
    v_mfma_f32_16x16x32_bf16 v[52:55], v[196:199], v[240:243], v[52:55]
    v_cvt_pk_bf16_f32 v32, v32, v33
    v_cvt_pk_bf16_f32 v33, v34, v35
    v_mfma_f32_16x16x32_bf16 v[56:59], v[168:171], v[240:243], v[56:59]
    v_cvt_pk_bf16_f32 v34, v36, v37
    v_cvt_pk_bf16_f32 v35, v38, v39
    v_mfma_f32_16x16x32_bf16 v[60:63], v[172:175], v[240:243], v[60:63]
    s_add_u32 s47, s48, 2105344
    buffer_store_dwordx4 v[32:35], v251, s[16:19], s47 offen sc1
    v_mfma_f32_16x16x32_bf16 v[48:51], v[200:203], v[244:247], v[48:51]
    v_cvt_pk_bf16_f32 v40, v40, v41
    v_cvt_pk_bf16_f32 v41, v42, v43
    v_mfma_f32_16x16x32_bf16 v[52:55], v[204:207], v[244:247], v[52:55]
    v_cvt_pk_bf16_f32 v42, v44, v45
    v_cvt_pk_bf16_f32 v43, v46, v47
    v_mfma_f32_16x16x32_bf16 v[56:59], v[192:195], v[244:247], v[56:59]
    s_add_u32 s47, s48, 2106368
    buffer_store_dwordx4 v[40:43], v251, s[16:19], s47 offen sc1
    v_mfma_f32_16x16x32_bf16 v[60:63], v[196:199], v[244:247], v[60:63]
    s_waitcnt lgkmcnt(2)
    v_mfma_f32_16x16x32_bf16 v[96:99], v[176:179], v[216:219], v[96:99]
    ds_read_b128 v[232:235], v250 offset:23552
    ds_read_b128 v[236:239], v250 offset:34816
    v_mfma_f32_16x16x32_bf16 v[100:103], v[180:183], v[216:219], v[100:103]
    v_mfma_f32_16x16x32_bf16 v[104:107], v[208:211], v[216:219], v[104:107]
    v_mfma_f32_16x16x32_bf16 v[108:111], v[212:215], v[216:219], v[108:111]
    v_mfma_f32_16x16x32_bf16 v[96:99], v[184:187], v[220:223], v[96:99]
    v_mfma_f32_16x16x32_bf16 v[100:103], v[188:191], v[220:223], v[100:103]
    v_mfma_f32_16x16x32_bf16 v[104:107], v[176:179], v[220:223], v[104:107]
    v_mfma_f32_16x16x32_bf16 v[108:111], v[180:183], v[220:223], v[108:111]
    s_waitcnt lgkmcnt(2)
    v_mfma_f32_16x16x32_bf16 v[64:67], v[192:195], v[224:227], v[64:67]
    ds_read_b128 v[240:243], v253 offset:21504
    ds_read_b128 v[244:247], v253 offset:32768
    v_mfma_f32_16x16x32_bf16 v[68:71], v[196:199], v[224:227], v[68:71]
    v_cvt_pk_bf16_f32 v48, v48, v49
    v_cvt_pk_bf16_f32 v49, v50, v51
    v_mfma_f32_16x16x32_bf16 v[72:75], v[168:171], v[224:227], v[72:75]
    v_cvt_pk_bf16_f32 v50, v52, v53
    v_cvt_pk_bf16_f32 v51, v54, v55
    v_mfma_f32_16x16x32_bf16 v[76:79], v[172:175], v[224:227], v[76:79]
    s_add_u32 s47, s48, 3158016
    buffer_store_dwordx4 v[48:51], v251, s[16:19], s47 offen sc1
    v_mfma_f32_16x16x32_bf16 v[64:67], v[200:203], v[228:231], v[64:67]
    v_cvt_pk_bf16_f32 v56, v56, v57
    v_cvt_pk_bf16_f32 v57, v58, v59
    v_mfma_f32_16x16x32_bf16 v[68:71], v[204:207], v[228:231], v[68:71]
    v_cvt_pk_bf16_f32 v58, v60, v61
    v_cvt_pk_bf16_f32 v59, v62, v63
    v_mfma_f32_16x16x32_bf16 v[72:75], v[192:195], v[228:231], v[72:75]
    s_add_u32 s47, s48, 3159040
    buffer_store_dwordx4 v[56:59], v251, s[16:19], s47 offen sc1
    v_mfma_f32_16x16x32_bf16 v[76:79], v[196:199], v[228:231], v[76:79]
    s_waitcnt lgkmcnt(2)
    v_mfma_f32_16x16x32_bf16 v[112:115], v[176:179], v[232:235], v[112:115]
    ds_read_b128 v[216:219], v250 offset:24576
    ds_read_b128 v[220:223], v250 offset:35840
    v_mfma_f32_16x16x32_bf16 v[116:119], v[180:183], v[232:235], v[116:119]
    v_mfma_f32_16x16x32_bf16 v[120:123], v[208:211], v[232:235], v[120:123]
    v_mfma_f32_16x16x32_bf16 v[124:127], v[212:215], v[232:235], v[124:127]
    v_mfma_f32_16x16x32_bf16 v[112:115], v[184:187], v[236:239], v[112:115]
    v_mfma_f32_16x16x32_bf16 v[116:119], v[188:191], v[236:239], v[116:119]
    v_mfma_f32_16x16x32_bf16 v[120:123], v[176:179], v[236:239], v[120:123]
    v_mfma_f32_16x16x32_bf16 v[124:127], v[180:183], v[236:239], v[124:127]
    s_waitcnt lgkmcnt(2)
    v_mfma_f32_16x16x32_bf16 v[80:83], v[192:195], v[240:243], v[80:83]
    ds_read_b128 v[224:227], v253 offset:22528
    ds_read_b128 v[228:231], v253 offset:33792
    v_mfma_f32_16x16x32_bf16 v[84:87], v[196:199], v[240:243], v[84:87]
    v_cvt_pk_bf16_f32 v64, v64, v65
    v_cvt_pk_bf16_f32 v65, v66, v67
    v_mfma_f32_16x16x32_bf16 v[88:91], v[168:171], v[240:243], v[88:91]
    v_cvt_pk_bf16_f32 v66, v68, v69
    v_cvt_pk_bf16_f32 v67, v70, v71
    v_mfma_f32_16x16x32_bf16 v[92:95], v[172:175], v[240:243], v[92:95]
    s_add_u32 s47, s48, 4210688
    buffer_store_dwordx4 v[64:67], v251, s[16:19], s47 offen sc1
    v_mfma_f32_16x16x32_bf16 v[80:83], v[200:203], v[244:247], v[80:83]
    v_cvt_pk_bf16_f32 v72, v72, v73
    v_cvt_pk_bf16_f32 v73, v74, v75
    v_mfma_f32_16x16x32_bf16 v[84:87], v[204:207], v[244:247], v[84:87]
    v_cvt_pk_bf16_f32 v74, v76, v77
    v_cvt_pk_bf16_f32 v75, v78, v79
    v_mfma_f32_16x16x32_bf16 v[88:91], v[192:195], v[244:247], v[88:91]
    s_add_u32 s47, s48, 4211712
    buffer_store_dwordx4 v[72:75], v251, s[16:19], s47 offen sc1
    v_mfma_f32_16x16x32_bf16 v[92:95], v[196:199], v[244:247], v[92:95]
    s_waitcnt lgkmcnt(2)
    v_mfma_f32_16x16x32_bf16 v[128:131], v[176:179], v[216:219], v[128:131]
    ds_read_b128 v[232:235], v250 offset:25600
    ds_read_b128 v[236:239], v250 offset:36864
    v_mfma_f32_16x16x32_bf16 v[132:135], v[180:183], v[216:219], v[132:135]
    v_mfma_f32_16x16x32_bf16 v[136:139], v[208:211], v[216:219], v[136:139]
    v_mfma_f32_16x16x32_bf16 v[140:143], v[212:215], v[216:219], v[140:143]
    v_mfma_f32_16x16x32_bf16 v[128:131], v[184:187], v[220:223], v[128:131]
    v_mfma_f32_16x16x32_bf16 v[132:135], v[188:191], v[220:223], v[132:135]
    v_mfma_f32_16x16x32_bf16 v[136:139], v[176:179], v[220:223], v[136:139]
    v_mfma_f32_16x16x32_bf16 v[140:143], v[180:183], v[220:223], v[140:143]
    s_waitcnt lgkmcnt(2)
    v_mfma_f32_16x16x32_bf16 v[96:99], v[192:195], v[224:227], v[96:99]
    ds_read_b128 v[240:243], v253 offset:23552
    ds_read_b128 v[244:247], v253 offset:34816
    v_mfma_f32_16x16x32_bf16 v[100:103], v[196:199], v[224:227], v[100:103]
    v_cvt_pk_bf16_f32 v80, v80, v81
    v_cvt_pk_bf16_f32 v81, v82, v83
    v_mfma_f32_16x16x32_bf16 v[104:107], v[168:171], v[224:227], v[104:107]
    v_cvt_pk_bf16_f32 v82, v84, v85
    v_cvt_pk_bf16_f32 v83, v86, v87
    v_mfma_f32_16x16x32_bf16 v[108:111], v[172:175], v[224:227], v[108:111]
    s_add_u32 s47, s48, 5263360
    buffer_store_dwordx4 v[80:83], v251, s[16:19], s47 offen sc1
    v_mfma_f32_16x16x32_bf16 v[96:99], v[200:203], v[228:231], v[96:99]
    v_cvt_pk_bf16_f32 v88, v88, v89
    v_cvt_pk_bf16_f32 v89, v90, v91
    v_mfma_f32_16x16x32_bf16 v[100:103], v[204:207], v[228:231], v[100:103]
    v_cvt_pk_bf16_f32 v90, v92, v93
    v_cvt_pk_bf16_f32 v91, v94, v95
    v_mfma_f32_16x16x32_bf16 v[104:107], v[192:195], v[228:231], v[104:107]
    s_add_u32 s47, s48, 5264384
    buffer_store_dwordx4 v[88:91], v251, s[16:19], s47 offen sc1
    v_mfma_f32_16x16x32_bf16 v[108:111], v[196:199], v[228:231], v[108:111]
    s_waitcnt lgkmcnt(2)
    v_mfma_f32_16x16x32_bf16 v[144:147], v[176:179], v[232:235], v[144:147]
    ds_read_b128 v[216:219], v250 offset:26624
    ds_read_b128 v[220:223], v250 offset:37888
    v_mfma_f32_16x16x32_bf16 v[148:151], v[180:183], v[232:235], v[148:151]
    v_mfma_f32_16x16x32_bf16 v[152:155], v[208:211], v[232:235], v[152:155]
    v_mfma_f32_16x16x32_bf16 v[156:159], v[212:215], v[232:235], v[156:159]
    v_mfma_f32_16x16x32_bf16 v[144:147], v[184:187], v[236:239], v[144:147]
    v_mfma_f32_16x16x32_bf16 v[148:151], v[188:191], v[236:239], v[148:151]
    v_mfma_f32_16x16x32_bf16 v[152:155], v[176:179], v[236:239], v[152:155]
    v_mfma_f32_16x16x32_bf16 v[156:159], v[180:183], v[236:239], v[156:159]
    s_waitcnt lgkmcnt(2)
    v_mfma_f32_16x16x32_bf16 v[112:115], v[192:195], v[240:243], v[112:115]
    ds_read_b128 v[224:227], v253 offset:24576
    ds_read_b128 v[228:231], v253 offset:35840
    v_mfma_f32_16x16x32_bf16 v[116:119], v[196:199], v[240:243], v[116:119]
    v_cvt_pk_bf16_f32 v96, v96, v97
    v_cvt_pk_bf16_f32 v97, v98, v99
    v_mfma_f32_16x16x32_bf16 v[120:123], v[168:171], v[240:243], v[120:123]
    v_cvt_pk_bf16_f32 v98, v100, v101
    v_cvt_pk_bf16_f32 v99, v102, v103
    v_mfma_f32_16x16x32_bf16 v[124:127], v[172:175], v[240:243], v[124:127]
    s_add_u32 s47, s48, 6316032
    buffer_store_dwordx4 v[96:99], v251, s[16:19], s47 offen sc1
    v_mfma_f32_16x16x32_bf16 v[112:115], v[200:203], v[244:247], v[112:115]
    v_cvt_pk_bf16_f32 v104, v104, v105
    v_cvt_pk_bf16_f32 v105, v106, v107
    v_mfma_f32_16x16x32_bf16 v[116:119], v[204:207], v[244:247], v[116:119]
    v_cvt_pk_bf16_f32 v106, v108, v109
    v_cvt_pk_bf16_f32 v107, v110, v111
    v_mfma_f32_16x16x32_bf16 v[120:123], v[192:195], v[244:247], v[120:123]
    s_add_u32 s47, s48, 6317056
    buffer_store_dwordx4 v[104:107], v251, s[16:19], s47 offen sc1
    v_mfma_f32_16x16x32_bf16 v[124:127], v[196:199], v[244:247], v[124:127]
    s_waitcnt lgkmcnt(2)
    v_mfma_f32_16x16x32_bf16 v[160:163], v[176:179], v[216:219], v[160:163]
    ds_read_b128 v[232:235], v253 offset:25600
    ds_read_b128 v[236:239], v253 offset:36864
    v_mfma_f32_16x16x32_bf16 v[164:167], v[208:211], v[216:219], v[164:167]
    v_mfma_f32_16x16x32_bf16 v[160:163], v[184:187], v[220:223], v[160:163]
    v_mfma_f32_16x16x32_bf16 v[164:167], v[176:179], v[220:223], v[164:167]
    s_waitcnt lgkmcnt(2)
    v_mfma_f32_16x16x32_bf16 v[128:131], v[192:195], v[224:227], v[128:131]
    ds_read_b128 v[240:243], v253 offset:26624
    ds_read_b128 v[244:247], v253 offset:37888
    v_mfma_f32_16x16x32_bf16 v[132:135], v[196:199], v[224:227], v[132:135]
    v_cvt_pk_bf16_f32 v112, v112, v113
    v_cvt_pk_bf16_f32 v113, v114, v115
    v_mfma_f32_16x16x32_bf16 v[136:139], v[168:171], v[224:227], v[136:139]
    v_cvt_pk_bf16_f32 v114, v116, v117
    v_cvt_pk_bf16_f32 v115, v118, v119
    v_mfma_f32_16x16x32_bf16 v[140:143], v[172:175], v[224:227], v[140:143]
    s_add_u32 s47, s48, 7368704
    buffer_store_dwordx4 v[112:115], v251, s[16:19], s47 offen sc1
    v_mfma_f32_16x16x32_bf16 v[128:131], v[200:203], v[228:231], v[128:131]
    v_cvt_pk_bf16_f32 v120, v120, v121
    v_cvt_pk_bf16_f32 v121, v122, v123
    v_mfma_f32_16x16x32_bf16 v[132:135], v[204:207], v[228:231], v[132:135]
    v_cvt_pk_bf16_f32 v122, v124, v125
    v_cvt_pk_bf16_f32 v123, v126, v127
    v_mfma_f32_16x16x32_bf16 v[136:139], v[192:195], v[228:231], v[136:139]
    s_add_u32 s47, s48, 7369728
    buffer_store_dwordx4 v[120:123], v251, s[16:19], s47 offen sc1
    v_mfma_f32_16x16x32_bf16 v[140:143], v[196:199], v[228:231], v[140:143]
    s_waitcnt lgkmcnt(2)
    v_mfma_f32_16x16x32_bf16 v[144:147], v[192:195], v[232:235], v[144:147]
    v_mfma_f32_16x16x32_bf16 v[148:151], v[196:199], v[232:235], v[148:151]
    v_mfma_f32_16x16x32_bf16 v[152:155], v[168:171], v[232:235], v[152:155]
    v_mfma_f32_16x16x32_bf16 v[156:159], v[172:175], v[232:235], v[156:159]
    v_mfma_f32_16x16x32_bf16 v[144:147], v[200:203], v[236:239], v[144:147]
    v_mfma_f32_16x16x32_bf16 v[148:151], v[204:207], v[236:239], v[148:151]
    v_mfma_f32_16x16x32_bf16 v[152:155], v[192:195], v[236:239], v[152:155]
    v_mfma_f32_16x16x32_bf16 v[156:159], v[196:199], v[236:239], v[156:159]
    s_waitcnt lgkmcnt(0)
    v_mfma_f32_16x16x32_bf16 v[160:163], v[192:195], v[240:243], v[160:163]
    v_mfma_f32_16x16x32_bf16 v[164:167], v[168:171], v[240:243], v[164:167]
    v_cvt_pk_bf16_f32 v128, v128, v129
    v_cvt_pk_bf16_f32 v129, v130, v131
    v_mfma_f32_16x16x32_bf16 v[160:163], v[200:203], v[244:247], v[160:163]
    v_cvt_pk_bf16_f32 v130, v132, v133
    v_cvt_pk_bf16_f32 v131, v134, v135
    v_mfma_f32_16x16x32_bf16 v[164:167], v[192:195], v[244:247], v[164:167]
    s_add_u32 s47, s48, 8421376
    buffer_store_dwordx4 v[128:131], v251, s[16:19], s47 offen sc1
    s_nop 7
    v_cvt_pk_bf16_f32 v136, v136, v137
    v_cvt_pk_bf16_f32 v137, v138, v139
    v_cvt_pk_bf16_f32 v138, v140, v141
    v_cvt_pk_bf16_f32 v139, v142, v143
    s_add_u32 s47, s48, 8422400
    buffer_store_dwordx4 v[136:139], v251, s[16:19], s47 offen sc1
    v_cvt_pk_bf16_f32 v144, v144, v145
    v_cvt_pk_bf16_f32 v145, v146, v147
    v_cvt_pk_bf16_f32 v146, v148, v149
    v_cvt_pk_bf16_f32 v147, v150, v151
    s_add_u32 s47, s48, 9474048
    buffer_store_dwordx4 v[144:147], v251, s[16:19], s47 offen sc1
    v_cvt_pk_bf16_f32 v152, v152, v153
    v_cvt_pk_bf16_f32 v153, v154, v155
    v_cvt_pk_bf16_f32 v154, v156, v157
    v_cvt_pk_bf16_f32 v155, v158, v159
    s_add_u32 s47, s48, 9475072
    buffer_store_dwordx4 v[152:155], v251, s[16:19], s47 offen sc1
    v_cvt_pk_bf16_f32 v160, v160, v161
    v_cvt_pk_bf16_f32 v161, v162, v163
    s_add_u32 s47, s49, 0
    buffer_store_dwordx2 v[160:161], v252, s[16:19], s47 offen sc1
    v_cvt_pk_bf16_f32 v164, v164, v165
    v_cvt_pk_bf16_f32 v165, v166, v167
    s_add_u32 s47, s49, 1024
    buffer_store_dwordx2 v[164:165], v252, s[16:19], s47 offen sc1
    s_branch L_epi_done
L_epi_b1:
    v_add_u32 v248, 0x9800, v248
    v_add_u32 v249, 0x9800, v249
    v_add_u32 v253, 38912, v250
    ds_read_b64_tr_b16 v[192:193], v248 offset:0
    ds_read_b64_tr_b16 v[194:195], v248 offset:1024
    ds_read_b64_tr_b16 v[196:197], v249 offset:0
    ds_read_b64_tr_b16 v[198:199], v249 offset:1024
    ds_read_b64_tr_b16 v[200:201], v248 offset:8192
    ds_read_b64_tr_b16 v[202:203], v248 offset:9216
    ds_read_b64_tr_b16 v[204:205], v249 offset:8192
    ds_read_b64_tr_b16 v[206:207], v249 offset:9216
    s_waitcnt lgkmcnt(10)
    v_mfma_f32_16x16x32_bf16 v[0:3], v[176:179], v[232:235], v[0:3]
    ds_read_b128 v[216:219], v250 offset:18432
    ds_read_b128 v[220:223], v250 offset:29696
    v_mfma_f32_16x16x32_bf16 v[4:7], v[180:183], v[232:235], v[4:7]
    v_mfma_f32_16x16x32_bf16 v[8:11], v[208:211], v[232:235], v[8:11]
    v_mfma_f32_16x16x32_bf16 v[12:15], v[212:215], v[232:235], v[12:15]
    v_mfma_f32_16x16x32_bf16 v[0:3], v[184:187], v[236:239], v[0:3]
    v_mfma_f32_16x16x32_bf16 v[4:7], v[188:191], v[236:239], v[4:7]
    v_mfma_f32_16x16x32_bf16 v[8:11], v[176:179], v[236:239], v[8:11]
    v_mfma_f32_16x16x32_bf16 v[12:15], v[180:183], v[236:239], v[12:15]
    s_waitcnt lgkmcnt(10)
    v_mfma_f32_16x16x32_bf16 v[16:19], v[176:179], v[240:243], v[16:19]
    ds_read_b128 v[224:227], v253 offset:16384
    ds_read_b128 v[228:231], v253 offset:27648
    v_mfma_f32_16x16x32_bf16 v[20:23], v[180:183], v[240:243], v[20:23]
    v_mfma_f32_16x16x32_bf16 v[24:27], v[208:211], v[240:243], v[24:27]
    v_mfma_f32_16x16x32_bf16 v[28:31], v[212:215], v[240:243], v[28:31]
    v_mfma_f32_16x16x32_bf16 v[16:19], v[184:187], v[244:247], v[16:19]
    v_mfma_f32_16x16x32_bf16 v[20:23], v[188:191], v[244:247], v[20:23]
    v_mfma_f32_16x16x32_bf16 v[24:27], v[176:179], v[244:247], v[24:27]
    v_mfma_f32_16x16x32_bf16 v[28:31], v[180:183], v[244:247], v[28:31]
    s_waitcnt lgkmcnt(2)
    v_mfma_f32_16x16x32_bf16 v[32:35], v[176:179], v[216:219], v[32:35]
    ds_read_b128 v[232:235], v250 offset:19456
    ds_read_b128 v[236:239], v250 offset:30720
    v_mfma_f32_16x16x32_bf16 v[36:39], v[180:183], v[216:219], v[36:39]
    v_mfma_f32_16x16x32_bf16 v[40:43], v[208:211], v[216:219], v[40:43]
    v_mfma_f32_16x16x32_bf16 v[44:47], v[212:215], v[216:219], v[44:47]
    v_mfma_f32_16x16x32_bf16 v[32:35], v[184:187], v[220:223], v[32:35]
    v_mfma_f32_16x16x32_bf16 v[36:39], v[188:191], v[220:223], v[36:39]
    v_mfma_f32_16x16x32_bf16 v[40:43], v[176:179], v[220:223], v[40:43]
    v_mfma_f32_16x16x32_bf16 v[44:47], v[180:183], v[220:223], v[44:47]
    v_xor_b32 v168, 0x80008000, v200
    v_xor_b32 v169, 0x80008000, v201
    v_xor_b32 v170, 0x80008000, v202
    v_xor_b32 v171, 0x80008000, v203
    v_xor_b32 v172, 0x80008000, v204
    v_xor_b32 v173, 0x80008000, v205
    v_xor_b32 v174, 0x80008000, v206
    v_xor_b32 v175, 0x80008000, v207
    s_waitcnt lgkmcnt(2)
    v_mfma_f32_16x16x32_bf16 v[0:3], v[192:195], v[224:227], v[0:3]
    ds_read_b128 v[240:243], v253 offset:17408
    ds_read_b128 v[244:247], v253 offset:28672
    v_mfma_f32_16x16x32_bf16 v[4:7], v[196:199], v[224:227], v[4:7]
    v_mfma_f32_16x16x32_bf16 v[8:11], v[168:171], v[224:227], v[8:11]
    v_mfma_f32_16x16x32_bf16 v[12:15], v[172:175], v[224:227], v[12:15]
    v_mfma_f32_16x16x32_bf16 v[0:3], v[200:203], v[228:231], v[0:3]
    v_mfma_f32_16x16x32_bf16 v[4:7], v[204:207], v[228:231], v[4:7]
    v_mfma_f32_16x16x32_bf16 v[8:11], v[192:195], v[228:231], v[8:11]
    v_mfma_f32_16x16x32_bf16 v[12:15], v[196:199], v[228:231], v[12:15]
    s_waitcnt lgkmcnt(2)
    v_mfma_f32_16x16x32_bf16 v[48:51], v[176:179], v[232:235], v[48:51]
    ds_read_b128 v[216:219], v250 offset:20480
    ds_read_b128 v[220:223], v250 offset:31744
    v_mfma_f32_16x16x32_bf16 v[52:55], v[180:183], v[232:235], v[52:55]
    v_mfma_f32_16x16x32_bf16 v[56:59], v[208:211], v[232:235], v[56:59]
    v_mfma_f32_16x16x32_bf16 v[60:63], v[212:215], v[232:235], v[60:63]
    v_mfma_f32_16x16x32_bf16 v[48:51], v[184:187], v[236:239], v[48:51]
    v_mfma_f32_16x16x32_bf16 v[52:55], v[188:191], v[236:239], v[52:55]
    v_mfma_f32_16x16x32_bf16 v[56:59], v[176:179], v[236:239], v[56:59]
    v_mfma_f32_16x16x32_bf16 v[60:63], v[180:183], v[236:239], v[60:63]
    s_waitcnt lgkmcnt(2)
    v_mfma_f32_16x16x32_bf16 v[16:19], v[192:195], v[240:243], v[16:19]
    ds_read_b128 v[224:227], v253 offset:18432
    ds_read_b128 v[228:231], v253 offset:29696
    v_mfma_f32_16x16x32_bf16 v[20:23], v[196:199], v[240:243], v[20:23]
    v_cvt_pk_bf16_f32 v4, v4, v5
    v_cvt_pk_bf16_f32 v5, v6, v7
    v_mfma_f32_16x16x32_bf16 v[24:27], v[168:171], v[240:243], v[24:27]
    v_cvt_pk_bf16_f32 v6, v0, v1
    v_cvt_pk_bf16_f32 v7, v2, v3
    v_mfma_f32_16x16x32_bf16 v[28:31], v[172:175], v[240:243], v[28:31]
    s_add_u32 s47, s48, 0
    buffer_store_dwordx4 v[4:7], v251, s[16:19], s47 offen sc1
    v_mfma_f32_16x16x32_bf16 v[16:19], v[200:203], v[244:247], v[16:19]
    v_cvt_pk_bf16_f32 v12, v12, v13
    v_cvt_pk_bf16_f32 v13, v14, v15
    v_mfma_f32_16x16x32_bf16 v[20:23], v[204:207], v[244:247], v[20:23]
    v_cvt_pk_bf16_f32 v14, v8, v9
    v_cvt_pk_bf16_f32 v15, v10, v11
    v_mfma_f32_16x16x32_bf16 v[24:27], v[192:195], v[244:247], v[24:27]
    s_add_u32 s47, s48, 1024
    buffer_store_dwordx4 v[12:15], v251, s[16:19], s47 offen sc1
    v_mfma_f32_16x16x32_bf16 v[28:31], v[196:199], v[244:247], v[28:31]
    s_waitcnt lgkmcnt(2)
    v_mfma_f32_16x16x32_bf16 v[64:67], v[176:179], v[216:219], v[64:67]
    ds_read_b128 v[232:235], v250 offset:21504
    ds_read_b128 v[236:239], v250 offset:32768
    v_mfma_f32_16x16x32_bf16 v[68:71], v[180:183], v[216:219], v[68:71]
    v_mfma_f32_16x16x32_bf16 v[72:75], v[208:211], v[216:219], v[72:75]
    v_mfma_f32_16x16x32_bf16 v[76:79], v[212:215], v[216:219], v[76:79]
    v_mfma_f32_16x16x32_bf16 v[64:67], v[184:187], v[220:223], v[64:67]
    v_mfma_f32_16x16x32_bf16 v[68:71], v[188:191], v[220:223], v[68:71]
    v_mfma_f32_16x16x32_bf16 v[72:75], v[176:179], v[220:223], v[72:75]
    v_mfma_f32_16x16x32_bf16 v[76:79], v[180:183], v[220:223], v[76:79]
    s_waitcnt lgkmcnt(2)
    v_mfma_f32_16x16x32_bf16 v[32:35], v[192:195], v[224:227], v[32:35]
    ds_read_b128 v[240:243], v253 offset:19456
    ds_read_b128 v[244:247], v253 offset:30720
    v_mfma_f32_16x16x32_bf16 v[36:39], v[196:199], v[224:227], v[36:39]
    v_cvt_pk_bf16_f32 v20, v20, v21
    v_cvt_pk_bf16_f32 v21, v22, v23
    v_mfma_f32_16x16x32_bf16 v[40:43], v[168:171], v[224:227], v[40:43]
    v_cvt_pk_bf16_f32 v22, v16, v17
    v_cvt_pk_bf16_f32 v23, v18, v19
    v_mfma_f32_16x16x32_bf16 v[44:47], v[172:175], v[224:227], v[44:47]
    s_add_u32 s47, s48, 1052672
    buffer_store_dwordx4 v[20:23], v251, s[16:19], s47 offen sc1
    v_mfma_f32_16x16x32_bf16 v[32:35], v[200:203], v[228:231], v[32:35]
    v_cvt_pk_bf16_f32 v28, v28, v29
    v_cvt_pk_bf16_f32 v29, v30, v31
    v_mfma_f32_16x16x32_bf16 v[36:39], v[204:207], v[228:231], v[36:39]
    v_cvt_pk_bf16_f32 v30, v24, v25
    v_cvt_pk_bf16_f32 v31, v26, v27
    v_mfma_f32_16x16x32_bf16 v[40:43], v[192:195], v[228:231], v[40:43]
    s_add_u32 s47, s48, 1053696
    buffer_store_dwordx4 v[28:31], v251, s[16:19], s47 offen sc1
    v_mfma_f32_16x16x32_bf16 v[44:47], v[196:199], v[228:231], v[44:47]
    s_waitcnt lgkmcnt(2)
    v_mfma_f32_16x16x32_bf16 v[80:83], v[176:179], v[232:235], v[80:83]
    ds_read_b128 v[216:219], v250 offset:22528
    ds_read_b128 v[220:223], v250 offset:33792
    v_mfma_f32_16x16x32_bf16 v[84:87], v[180:183], v[232:235], v[84:87]
    v_mfma_f32_16x16x32_bf16 v[88:91], v[208:211], v[232:235], v[88:91]
    v_mfma_f32_16x16x32_bf16 v[92:95], v[212:215], v[232:235], v[92:95]
    v_mfma_f32_16x16x32_bf16 v[80:83], v[184:187], v[236:239], v[80:83]
    v_mfma_f32_16x16x32_bf16 v[84:87], v[188:191], v[236:239], v[84:87]
    v_mfma_f32_16x16x32_bf16 v[88:91], v[176:179], v[236:239], v[88:91]
    v_mfma_f32_16x16x32_bf16 v[92:95], v[180:183], v[236:239], v[92:95]
    s_waitcnt lgkmcnt(2)
    v_mfma_f32_16x16x32_bf16 v[48:51], v[192:195], v[240:243], v[48:51]
    ds_read_b128 v[224:227], v253 offset:20480
    ds_read_b128 v[228:231], v253 offset:31744
    v_mfma_f32_16x16x32_bf16 v[52:55], v[196:199], v[240:243], v[52:55]
    v_cvt_pk_bf16_f32 v36, v36, v37
    v_cvt_pk_bf16_f32 v37, v38, v39
    v_mfma_f32_16x16x32_bf16 v[56:59], v[168:171], v[240:243], v[56:59]
    v_cvt_pk_bf16_f32 v38, v32, v33
    v_cvt_pk_bf16_f32 v39, v34, v35
    v_mfma_f32_16x16x32_bf16 v[60:63], v[172:175], v[240:243], v[60:63]
    s_add_u32 s47, s48, 2105344
    buffer_store_dwordx4 v[36:39], v251, s[16:19], s47 offen sc1
    v_mfma_f32_16x16x32_bf16 v[48:51], v[200:203], v[244:247], v[48:51]
    v_cvt_pk_bf16_f32 v44, v44, v45
    v_cvt_pk_bf16_f32 v45, v46, v47
    v_mfma_f32_16x16x32_bf16 v[52:55], v[204:207], v[244:247], v[52:55]
    v_cvt_pk_bf16_f32 v46, v40, v41
    v_cvt_pk_bf16_f32 v47, v42, v43
    v_mfma_f32_16x16x32_bf16 v[56:59], v[192:195], v[244:247], v[56:59]
    s_add_u32 s47, s48, 2106368
    buffer_store_dwordx4 v[44:47], v251, s[16:19], s47 offen sc1
    v_mfma_f32_16x16x32_bf16 v[60:63], v[196:199], v[244:247], v[60:63]
    s_waitcnt lgkmcnt(2)
    v_mfma_f32_16x16x32_bf16 v[96:99], v[176:179], v[216:219], v[96:99]
    ds_read_b128 v[232:235], v250 offset:23552
    ds_read_b128 v[236:239], v250 offset:34816
    v_mfma_f32_16x16x32_bf16 v[100:103], v[180:183], v[216:219], v[100:103]
    v_mfma_f32_16x16x32_bf16 v[104:107], v[208:211], v[216:219], v[104:107]
    v_mfma_f32_16x16x32_bf16 v[108:111], v[212:215], v[216:219], v[108:111]
    v_mfma_f32_16x16x32_bf16 v[96:99], v[184:187], v[220:223], v[96:99]
    v_mfma_f32_16x16x32_bf16 v[100:103], v[188:191], v[220:223], v[100:103]
    v_mfma_f32_16x16x32_bf16 v[104:107], v[176:179], v[220:223], v[104:107]
    v_mfma_f32_16x16x32_bf16 v[108:111], v[180:183], v[220:223], v[108:111]
    s_waitcnt lgkmcnt(2)
    v_mfma_f32_16x16x32_bf16 v[64:67], v[192:195], v[224:227], v[64:67]
    ds_read_b128 v[240:243], v253 offset:21504
    ds_read_b128 v[244:247], v253 offset:32768
    v_mfma_f32_16x16x32_bf16 v[68:71], v[196:199], v[224:227], v[68:71]
    v_cvt_pk_bf16_f32 v52, v52, v53
    v_cvt_pk_bf16_f32 v53, v54, v55
    v_mfma_f32_16x16x32_bf16 v[72:75], v[168:171], v[224:227], v[72:75]
    v_cvt_pk_bf16_f32 v54, v48, v49
    v_cvt_pk_bf16_f32 v55, v50, v51
    v_mfma_f32_16x16x32_bf16 v[76:79], v[172:175], v[224:227], v[76:79]
    s_add_u32 s47, s48, 3158016
    buffer_store_dwordx4 v[52:55], v251, s[16:19], s47 offen sc1
    v_mfma_f32_16x16x32_bf16 v[64:67], v[200:203], v[228:231], v[64:67]
    v_cvt_pk_bf16_f32 v60, v60, v61
    v_cvt_pk_bf16_f32 v61, v62, v63
    v_mfma_f32_16x16x32_bf16 v[68:71], v[204:207], v[228:231], v[68:71]
    v_cvt_pk_bf16_f32 v62, v56, v57
    v_cvt_pk_bf16_f32 v63, v58, v59
    v_mfma_f32_16x16x32_bf16 v[72:75], v[192:195], v[228:231], v[72:75]
    s_add_u32 s47, s48, 3159040
    buffer_store_dwordx4 v[60:63], v251, s[16:19], s47 offen sc1
    v_mfma_f32_16x16x32_bf16 v[76:79], v[196:199], v[228:231], v[76:79]
    s_waitcnt lgkmcnt(2)
    v_mfma_f32_16x16x32_bf16 v[112:115], v[176:179], v[232:235], v[112:115]
    ds_read_b128 v[216:219], v250 offset:24576
    ds_read_b128 v[220:223], v250 offset:35840
    v_mfma_f32_16x16x32_bf16 v[116:119], v[180:183], v[232:235], v[116:119]
    v_mfma_f32_16x16x32_bf16 v[120:123], v[208:211], v[232:235], v[120:123]
    v_mfma_f32_16x16x32_bf16 v[124:127], v[212:215], v[232:235], v[124:127]
    v_mfma_f32_16x16x32_bf16 v[112:115], v[184:187], v[236:239], v[112:115]
    v_mfma_f32_16x16x32_bf16 v[116:119], v[188:191], v[236:239], v[116:119]
    v_mfma_f32_16x16x32_bf16 v[120:123], v[176:179], v[236:239], v[120:123]
    v_mfma_f32_16x16x32_bf16 v[124:127], v[180:183], v[236:239], v[124:127]
    s_waitcnt lgkmcnt(2)
    v_mfma_f32_16x16x32_bf16 v[80:83], v[192:195], v[240:243], v[80:83]
    ds_read_b128 v[224:227], v253 offset:22528
    ds_read_b128 v[228:231], v253 offset:33792
    v_mfma_f32_16x16x32_bf16 v[84:87], v[196:199], v[240:243], v[84:87]
    v_cvt_pk_bf16_f32 v68, v68, v69
    v_cvt_pk_bf16_f32 v69, v70, v71
    v_mfma_f32_16x16x32_bf16 v[88:91], v[168:171], v[240:243], v[88:91]
    v_cvt_pk_bf16_f32 v70, v64, v65
    v_cvt_pk_bf16_f32 v71, v66, v67
    v_mfma_f32_16x16x32_bf16 v[92:95], v[172:175], v[240:243], v[92:95]
    s_add_u32 s47, s48, 4210688
    buffer_store_dwordx4 v[68:71], v251, s[16:19], s47 offen sc1
    v_mfma_f32_16x16x32_bf16 v[80:83], v[200:203], v[244:247], v[80:83]
    v_cvt_pk_bf16_f32 v76, v76, v77
    v_cvt_pk_bf16_f32 v77, v78, v79
    v_mfma_f32_16x16x32_bf16 v[84:87], v[204:207], v[244:247], v[84:87]
    v_cvt_pk_bf16_f32 v78, v72, v73
    v_cvt_pk_bf16_f32 v79, v74, v75
    v_mfma_f32_16x16x32_bf16 v[88:91], v[192:195], v[244:247], v[88:91]
    s_add_u32 s47, s48, 4211712
    buffer_store_dwordx4 v[76:79], v251, s[16:19], s47 offen sc1
    v_mfma_f32_16x16x32_bf16 v[92:95], v[196:199], v[244:247], v[92:95]
    s_waitcnt lgkmcnt(2)
    v_mfma_f32_16x16x32_bf16 v[128:131], v[176:179], v[216:219], v[128:131]
    ds_read_b128 v[232:235], v250 offset:25600
    ds_read_b128 v[236:239], v250 offset:36864
    v_mfma_f32_16x16x32_bf16 v[132:135], v[180:183], v[216:219], v[132:135]
    v_mfma_f32_16x16x32_bf16 v[136:139], v[208:211], v[216:219], v[136:139]
    v_mfma_f32_16x16x32_bf16 v[140:143], v[212:215], v[216:219], v[140:143]
    v_mfma_f32_16x16x32_bf16 v[128:131], v[184:187], v[220:223], v[128:131]
    v_mfma_f32_16x16x32_bf16 v[132:135], v[188:191], v[220:223], v[132:135]
    v_mfma_f32_16x16x32_bf16 v[136:139], v[176:179], v[220:223], v[136:139]
    v_mfma_f32_16x16x32_bf16 v[140:143], v[180:183], v[220:223], v[140:143]
    s_waitcnt lgkmcnt(2)
    v_mfma_f32_16x16x32_bf16 v[96:99], v[192:195], v[224:227], v[96:99]
    ds_read_b128 v[240:243], v253 offset:23552
    ds_read_b128 v[244:247], v253 offset:34816
    v_mfma_f32_16x16x32_bf16 v[100:103], v[196:199], v[224:227], v[100:103]
    v_cvt_pk_bf16_f32 v84, v84, v85
    v_cvt_pk_bf16_f32 v85, v86, v87
    v_mfma_f32_16x16x32_bf16 v[104:107], v[168:171], v[224:227], v[104:107]
    v_cvt_pk_bf16_f32 v86, v80, v81
    v_cvt_pk_bf16_f32 v87, v82, v83
    v_mfma_f32_16x16x32_bf16 v[108:111], v[172:175], v[224:227], v[108:111]
    s_add_u32 s47, s48, 5263360
    buffer_store_dwordx4 v[84:87], v251, s[16:19], s47 offen sc1
    v_mfma_f32_16x16x32_bf16 v[96:99], v[200:203], v[228:231], v[96:99]
    v_cvt_pk_bf16_f32 v92, v92, v93
    v_cvt_pk_bf16_f32 v93, v94, v95
    v_mfma_f32_16x16x32_bf16 v[100:103], v[204:207], v[228:231], v[100:103]
    v_cvt_pk_bf16_f32 v94, v88, v89
    v_cvt_pk_bf16_f32 v95, v90, v91
    v_mfma_f32_16x16x32_bf16 v[104:107], v[192:195], v[228:231], v[104:107]
    s_add_u32 s47, s48, 5264384
    buffer_store_dwordx4 v[92:95], v251, s[16:19], s47 offen sc1
    v_mfma_f32_16x16x32_bf16 v[108:111], v[196:199], v[228:231], v[108:111]
    s_waitcnt lgkmcnt(2)
    v_mfma_f32_16x16x32_bf16 v[144:147], v[176:179], v[232:235], v[144:147]
    ds_read_b128 v[216:219], v250 offset:26624
    ds_read_b128 v[220:223], v250 offset:37888
    v_mfma_f32_16x16x32_bf16 v[148:151], v[180:183], v[232:235], v[148:151]
    v_mfma_f32_16x16x32_bf16 v[152:155], v[208:211], v[232:235], v[152:155]
    v_mfma_f32_16x16x32_bf16 v[156:159], v[212:215], v[232:235], v[156:159]
    v_mfma_f32_16x16x32_bf16 v[144:147], v[184:187], v[236:239], v[144:147]
    v_mfma_f32_16x16x32_bf16 v[148:151], v[188:191], v[236:239], v[148:151]
    v_mfma_f32_16x16x32_bf16 v[152:155], v[176:179], v[236:239], v[152:155]
    v_mfma_f32_16x16x32_bf16 v[156:159], v[180:183], v[236:239], v[156:159]
    s_waitcnt lgkmcnt(2)
    v_mfma_f32_16x16x32_bf16 v[112:115], v[192:195], v[240:243], v[112:115]
    ds_read_b128 v[224:227], v253 offset:24576
    ds_read_b128 v[228:231], v253 offset:35840
    v_mfma_f32_16x16x32_bf16 v[116:119], v[196:199], v[240:243], v[116:119]
    v_cvt_pk_bf16_f32 v100, v100, v101
    v_cvt_pk_bf16_f32 v101, v102, v103
    v_mfma_f32_16x16x32_bf16 v[120:123], v[168:171], v[240:243], v[120:123]
    v_cvt_pk_bf16_f32 v102, v96, v97
    v_cvt_pk_bf16_f32 v103, v98, v99
    v_mfma_f32_16x16x32_bf16 v[124:127], v[172:175], v[240:243], v[124:127]
    s_add_u32 s47, s48, 6316032
    buffer_store_dwordx4 v[100:103], v251, s[16:19], s47 offen sc1
    v_mfma_f32_16x16x32_bf16 v[112:115], v[200:203], v[244:247], v[112:115]
    v_cvt_pk_bf16_f32 v108, v108, v109
    v_cvt_pk_bf16_f32 v109, v110, v111
    v_mfma_f32_16x16x32_bf16 v[116:119], v[204:207], v[244:247], v[116:119]
    v_cvt_pk_bf16_f32 v110, v104, v105
    v_cvt_pk_bf16_f32 v111, v106, v107
    v_mfma_f32_16x16x32_bf16 v[120:123], v[192:195], v[244:247], v[120:123]
    s_add_u32 s47, s48, 6317056
    buffer_store_dwordx4 v[108:111], v251, s[16:19], s47 offen sc1
    v_mfma_f32_16x16x32_bf16 v[124:127], v[196:199], v[244:247], v[124:127]
    s_waitcnt lgkmcnt(2)
    v_mfma_f32_16x16x32_bf16 v[160:163], v[176:179], v[216:219], v[160:163]
    ds_read_b128 v[232:235], v253 offset:25600
    ds_read_b128 v[236:239], v253 offset:36864
    v_mfma_f32_16x16x32_bf16 v[164:167], v[208:211], v[216:219], v[164:167]
    v_mfma_f32_16x16x32_bf16 v[160:163], v[184:187], v[220:223], v[160:163]
    v_mfma_f32_16x16x32_bf16 v[164:167], v[176:179], v[220:223], v[164:167]
    s_waitcnt lgkmcnt(2)
    v_mfma_f32_16x16x32_bf16 v[128:131], v[192:195], v[224:227], v[128:131]
    ds_read_b128 v[240:243], v253 offset:26624
    ds_read_b128 v[244:247], v253 offset:37888
    v_mfma_f32_16x16x32_bf16 v[132:135], v[196:199], v[224:227], v[132:135]
    v_cvt_pk_bf16_f32 v116, v116, v117
    v_cvt_pk_bf16_f32 v117, v118, v119
    v_mfma_f32_16x16x32_bf16 v[136:139], v[168:171], v[224:227], v[136:139]
    v_cvt_pk_bf16_f32 v118, v112, v113
    v_cvt_pk_bf16_f32 v119, v114, v115
    v_mfma_f32_16x16x32_bf16 v[140:143], v[172:175], v[224:227], v[140:143]
    s_add_u32 s47, s48, 7368704
    buffer_store_dwordx4 v[116:119], v251, s[16:19], s47 offen sc1
    v_mfma_f32_16x16x32_bf16 v[128:131], v[200:203], v[228:231], v[128:131]
    v_cvt_pk_bf16_f32 v124, v124, v125
    v_cvt_pk_bf16_f32 v125, v126, v127
    v_mfma_f32_16x16x32_bf16 v[132:135], v[204:207], v[228:231], v[132:135]
    v_cvt_pk_bf16_f32 v126, v120, v121
    v_cvt_pk_bf16_f32 v127, v122, v123
    v_mfma_f32_16x16x32_bf16 v[136:139], v[192:195], v[228:231], v[136:139]
    s_add_u32 s47, s48, 7369728
    buffer_store_dwordx4 v[124:127], v251, s[16:19], s47 offen sc1
    v_mfma_f32_16x16x32_bf16 v[140:143], v[196:199], v[228:231], v[140:143]
    s_waitcnt lgkmcnt(2)
    v_mfma_f32_16x16x32_bf16 v[144:147], v[192:195], v[232:235], v[144:147]
    v_mfma_f32_16x16x32_bf16 v[148:151], v[196:199], v[232:235], v[148:151]
    v_mfma_f32_16x16x32_bf16 v[152:155], v[168:171], v[232:235], v[152:155]
    v_mfma_f32_16x16x32_bf16 v[156:159], v[172:175], v[232:235], v[156:159]
    v_mfma_f32_16x16x32_bf16 v[144:147], v[200:203], v[236:239], v[144:147]
    v_mfma_f32_16x16x32_bf16 v[148:151], v[204:207], v[236:239], v[148:151]
    v_mfma_f32_16x16x32_bf16 v[152:155], v[192:195], v[236:239], v[152:155]
    v_mfma_f32_16x16x32_bf16 v[156:159], v[196:199], v[236:239], v[156:159]
    s_waitcnt lgkmcnt(0)
    v_mfma_f32_16x16x32_bf16 v[160:163], v[192:195], v[240:243], v[160:163]
    v_mfma_f32_16x16x32_bf16 v[164:167], v[168:171], v[240:243], v[164:167]
    v_cvt_pk_bf16_f32 v132, v132, v133
    v_cvt_pk_bf16_f32 v133, v134, v135
    v_mfma_f32_16x16x32_bf16 v[160:163], v[200:203], v[244:247], v[160:163]
    v_cvt_pk_bf16_f32 v134, v128, v129
    v_cvt_pk_bf16_f32 v135, v130, v131
    v_mfma_f32_16x16x32_bf16 v[164:167], v[192:195], v[244:247], v[164:167]
    s_add_u32 s47, s48, 8421376
    buffer_store_dwordx4 v[132:135], v251, s[16:19], s47 offen sc1
    s_nop 7
    v_cvt_pk_bf16_f32 v140, v140, v141
    v_cvt_pk_bf16_f32 v141, v142, v143
    v_cvt_pk_bf16_f32 v142, v136, v137
    v_cvt_pk_bf16_f32 v143, v138, v139
    s_add_u32 s47, s48, 8422400
    buffer_store_dwordx4 v[140:143], v251, s[16:19], s47 offen sc1
    v_cvt_pk_bf16_f32 v148, v148, v149
    v_cvt_pk_bf16_f32 v149, v150, v151
    v_cvt_pk_bf16_f32 v150, v144, v145
    v_cvt_pk_bf16_f32 v151, v146, v147
    s_add_u32 s47, s48, 9474048
    buffer_store_dwordx4 v[148:151], v251, s[16:19], s47 offen sc1
    v_cvt_pk_bf16_f32 v156, v156, v157
    v_cvt_pk_bf16_f32 v157, v158, v159
    v_cvt_pk_bf16_f32 v158, v152, v153
    v_cvt_pk_bf16_f32 v159, v154, v155
    s_add_u32 s47, s48, 9475072
    buffer_store_dwordx4 v[156:159], v251, s[16:19], s47 offen sc1
    v_cvt_pk_bf16_f32 v160, v160, v161
    v_cvt_pk_bf16_f32 v161, v162, v163
    s_add_u32 s47, s49, 0
    buffer_store_dwordx2 v[160:161], v252, s[16:19], s47 offen sc1
    v_cvt_pk_bf16_f32 v164, v164, v165
    v_cvt_pk_bf16_f32 v165, v166, v167
    s_add_u32 s47, s49, 1024
    buffer_store_dwordx2 v[164:165], v252, s[16:19], s47 offen sc1
L_epi_done:
    s_endpgm
L_k3_helper:
    s_mul_i32 s40, s11, 16384
    s_mul_i32 s20, s14, 16777216
    s_add_u32 s40, s40, s20
    s_mul_i32 s41, s11, 21504
    s_mul_i32 s20, s13, 22020096
    s_add_u32 s41, s41, s20
    s_add_u32 s41, s41, 67108864
    s_lshl_b32 s42, s15, 12
    s_mul_i32 s43, s15, 5632
    s_lshr_b32 s20, s15, 1
    s_lshl_b32 s21, s20, 9
    s_sub_u32 s21, s43, s21
    v_lshlrev_b32 v1, 4, v0
    v_add_u32 v2, s21, v1
    s_add_u32 s22, s21, 4096
    v_add_u32 v5, s22, v1
    s_mov_b32 s44, s41
    s_bitcmp1_b32 s15, 0
    s_cbranch_scc0 L_six_even
    s_mul_i32 s22, s20, 10752
    s_add_u32 s22, s22, 9216
    v_lshrrev_b32 v5, 2, v0
    v_lshlrev_b32 v5, 6, v5
    v_and_b32 v3, 3, v0
    v_xor_b32 v3, 3, v3
    v_lshl_add_u32 v5, v3, 4, v5
    v_add_u32 v5, s22, v5
    s_mul_i32 s44, s11, 21504
    s_xor_b32 s22, s13, 1
    s_mul_i32 s22, s22, 22020096
    s_add_u32 s44, s44, s22
    s_add_u32 s44, s44, 67108864
L_six_even:
    s_mov_b32 s50, -1
    s_mov_b32 s51, 0
    v_add_u32 v1, s42, v1
    s_add_u32 s43, s43, 16384
    s_cmp_ge_u32 s2, 8
    s_cbranch_scc1 L_nozero
    s_cmp_lg_u32 s15, 0
    s_cbranch_scc1 L_nozero
    s_mul_i32 s20, s2, 8448
    s_add_u32 s20, s20, 147849216
    v_mov_b32 v3, 0
    v_lshlrev_b32 v4, 2, v0
    buffer_store_dword v3, v4, s[16:19], s20 offen
L_nozero:
    s_add_u32 m0, s42, 0
    s_nop 0
    buffer_load_dwordx4 v1, s[16:19], s40 offen offset:0 lds
    buffer_load_dwordx4 v1, s[16:19], s40 offen offset:1024 lds
    buffer_load_dwordx4 v1, s[16:19], s40 offen offset:2048 lds
    buffer_load_dwordx4 v1, s[16:19], s40 offen offset:3072 lds
    s_add_u32 s40, s40, 524288
    s_add_u32 m0, s43, 0
    s_nop 0
    buffer_load_dwordx4 v2, s[16:19], s41 offen offset:0 lds
    buffer_load_dwordx4 v2, s[16:19], s41 offen offset:1024 lds
    buffer_load_dwordx4 v2, s[16:19], s41 offen offset:2048 lds
    buffer_load_dwordx4 v2, s[16:19], s41 offen offset:3072 lds
    s_add_u32 m0, s43, 4096
    s_add_u32 s49, s41, 4096
    buffer_load_dwordx4 v2, s[16:19], s49 offen lds
    s_mov_b64 exec, s[50:51]
    buffer_load_dwordx4 v5, s[16:19], s44 offen offset:1024 lds
    s_mov_b64 exec, -1
    s_add_u32 s41, s41, 688128
    s_add_u32 s44, s44, 688128
    s_add_u32 m0, s42, 38912
    s_nop 0
    buffer_load_dwordx4 v1, s[16:19], s40 offen offset:0 lds
    buffer_load_dwordx4 v1, s[16:19], s40 offen offset:1024 lds
    buffer_load_dwordx4 v1, s[16:19], s40 offen offset:2048 lds
    buffer_load_dwordx4 v1, s[16:19], s40 offen offset:3072 lds
    s_add_u32 s40, s40, 524288
    s_add_u32 m0, s43, 38912
    s_nop 0
    buffer_load_dwordx4 v2, s[16:19], s41 offen offset:0 lds
    buffer_load_dwordx4 v2, s[16:19], s41 offen offset:1024 lds
    buffer_load_dwordx4 v2, s[16:19], s41 offen offset:2048 lds
    buffer_load_dwordx4 v2, s[16:19], s41 offen offset:3072 lds
    s_add_u32 m0, s43, 43008
    s_add_u32 s49, s41, 4096
    buffer_load_dwordx4 v2, s[16:19], s49 offen lds
    s_mov_b64 exec, s[50:51]
    buffer_load_dwordx4 v5, s[16:19], s44 offen offset:1024 lds
    s_mov_b64 exec, -1
    s_add_u32 s41, s41, 688128
    s_add_u32 s44, s44, 688128
    s_add_u32 m0, s42, 77824
    s_nop 0
    buffer_load_dwordx4 v1, s[16:19], s40 offen offset:0 lds
    buffer_load_dwordx4 v1, s[16:19], s40 offen offset:1024 lds
    buffer_load_dwordx4 v1, s[16:19], s40 offen offset:2048 lds
    buffer_load_dwordx4 v1, s[16:19], s40 offen offset:3072 lds
    s_add_u32 s40, s40, 524288
    s_add_u32 m0, s43, 77824
    s_nop 0
    buffer_load_dwordx4 v2, s[16:19], s41 offen offset:0 lds
    buffer_load_dwordx4 v2, s[16:19], s41 offen offset:1024 lds
    buffer_load_dwordx4 v2, s[16:19], s41 offen offset:2048 lds
    buffer_load_dwordx4 v2, s[16:19], s41 offen offset:3072 lds
    s_add_u32 m0, s43, 81920
    s_add_u32 s49, s41, 4096
    buffer_load_dwordx4 v2, s[16:19], s49 offen lds
    s_mov_b64 exec, s[50:51]
    buffer_load_dwordx4 v5, s[16:19], s44 offen offset:1024 lds
    s_mov_b64 exec, -1
    s_add_u32 s41, s41, 688128
    s_add_u32 s44, s44, 688128
    s_waitcnt vmcnt(20)
    s_barrier
    s_mov_b32 s46, 7
L_h_loop:
    s_waitcnt vmcnt(10)
    s_barrier
    s_add_u32 m0, s42, 116736
    s_nop 0
    buffer_load_dwordx4 v1, s[16:19], s40 offen offset:0 lds
    buffer_load_dwordx4 v1, s[16:19], s40 offen offset:1024 lds
    buffer_load_dwordx4 v1, s[16:19], s40 offen offset:2048 lds
    buffer_load_dwordx4 v1, s[16:19], s40 offen offset:3072 lds
    s_add_u32 s40, s40, 524288
    s_add_u32 m0, s43, 116736
    s_nop 0
    buffer_load_dwordx4 v2, s[16:19], s41 offen offset:0 lds
    buffer_load_dwordx4 v2, s[16:19], s41 offen offset:1024 lds
    buffer_load_dwordx4 v2, s[16:19], s41 offen offset:2048 lds
    buffer_load_dwordx4 v2, s[16:19], s41 offen offset:3072 lds
    s_add_u32 m0, s43, 120832
    s_add_u32 s49, s41, 4096
    buffer_load_dwordx4 v2, s[16:19], s49 offen lds
    s_mov_b64 exec, s[50:51]
    buffer_load_dwordx4 v5, s[16:19], s44 offen offset:1024 lds
    s_mov_b64 exec, -1
    s_add_u32 s41, s41, 688128
    s_add_u32 s44, s44, 688128
    s_waitcnt vmcnt(10)
    s_barrier
    s_add_u32 m0, s42, 0
    s_nop 0
    buffer_load_dwordx4 v1, s[16:19], s40 offen offset:0 lds
    buffer_load_dwordx4 v1, s[16:19], s40 offen offset:1024 lds
    buffer_load_dwordx4 v1, s[16:19], s40 offen offset:2048 lds
    buffer_load_dwordx4 v1, s[16:19], s40 offen offset:3072 lds
    s_add_u32 s40, s40, 524288
    s_add_u32 m0, s43, 0
    s_nop 0
    buffer_load_dwordx4 v2, s[16:19], s41 offen offset:0 lds
    buffer_load_dwordx4 v2, s[16:19], s41 offen offset:1024 lds
    buffer_load_dwordx4 v2, s[16:19], s41 offen offset:2048 lds
    buffer_load_dwordx4 v2, s[16:19], s41 offen offset:3072 lds
    s_add_u32 m0, s43, 4096
    s_add_u32 s49, s41, 4096
    buffer_load_dwordx4 v2, s[16:19], s49 offen lds
    s_mov_b64 exec, s[50:51]
    buffer_load_dwordx4 v5, s[16:19], s44 offen offset:1024 lds
    s_mov_b64 exec, -1
    s_add_u32 s41, s41, 688128
    s_add_u32 s44, s44, 688128
    s_waitcnt vmcnt(10)
    s_barrier
    s_add_u32 m0, s42, 38912
    s_nop 0
    buffer_load_dwordx4 v1, s[16:19], s40 offen offset:0 lds
    buffer_load_dwordx4 v1, s[16:19], s40 offen offset:1024 lds
    buffer_load_dwordx4 v1, s[16:19], s40 offen offset:2048 lds
    buffer_load_dwordx4 v1, s[16:19], s40 offen offset:3072 lds
    s_add_u32 s40, s40, 524288
    s_add_u32 m0, s43, 38912
    s_nop 0
    buffer_load_dwordx4 v2, s[16:19], s41 offen offset:0 lds
    buffer_load_dwordx4 v2, s[16:19], s41 offen offset:1024 lds
    buffer_load_dwordx4 v2, s[16:19], s41 offen offset:2048 lds
    buffer_load_dwordx4 v2, s[16:19], s41 offen offset:3072 lds
    s_add_u32 m0, s43, 43008
    s_add_u32 s49, s41, 4096
    buffer_load_dwordx4 v2, s[16:19], s49 offen lds
    s_mov_b64 exec, s[50:51]
    buffer_load_dwordx4 v5, s[16:19], s44 offen offset:1024 lds
    s_mov_b64 exec, -1
    s_add_u32 s41, s41, 688128
    s_add_u32 s44, s44, 688128
    s_waitcnt vmcnt(10)
    s_barrier
    s_add_u32 m0, s42, 77824
    s_nop 0
    buffer_load_dwordx4 v1, s[16:19], s40 offen offset:0 lds
    buffer_load_dwordx4 v1, s[16:19], s40 offen offset:1024 lds
    buffer_load_dwordx4 v1, s[16:19], s40 offen offset:2048 lds
    buffer_load_dwordx4 v1, s[16:19], s40 offen offset:3072 lds
    s_add_u32 s40, s40, 524288
    s_add_u32 m0, s43, 77824
    s_nop 0
    buffer_load_dwordx4 v2, s[16:19], s41 offen offset:0 lds
    buffer_load_dwordx4 v2, s[16:19], s41 offen offset:1024 lds
    buffer_load_dwordx4 v2, s[16:19], s41 offen offset:2048 lds
    buffer_load_dwordx4 v2, s[16:19], s41 offen offset:3072 lds
    s_add_u32 m0, s43, 81920
    s_add_u32 s49, s41, 4096
    buffer_load_dwordx4 v2, s[16:19], s49 offen lds
    s_mov_b64 exec, s[50:51]
    buffer_load_dwordx4 v5, s[16:19], s44 offen offset:1024 lds
    s_mov_b64 exec, -1
    s_add_u32 s41, s41, 688128
    s_add_u32 s44, s44, 688128
    s_sub_u32 s46, s46, 1
    s_cmp_lg_u32 s46, 0
    s_cbranch_scc1 L_h_loop
    s_waitcnt vmcnt(10)
    s_barrier
    s_add_u32 m0, s42, 116736
    s_nop 0
    buffer_load_dwordx4 v1, s[16:19], s40 offen offset:0 lds
    buffer_load_dwordx4 v1, s[16:19], s40 offen offset:1024 lds
    buffer_load_dwordx4 v1, s[16:19], s40 offen offset:2048 lds
    buffer_load_dwordx4 v1, s[16:19], s40 offen offset:3072 lds
    s_add_u32 s40, s40, 524288
    s_add_u32 m0, s43, 116736
    s_nop 0
    buffer_load_dwordx4 v2, s[16:19], s41 offen offset:0 lds
    buffer_load_dwordx4 v2, s[16:19], s41 offen offset:1024 lds
    buffer_load_dwordx4 v2, s[16:19], s41 offen offset:2048 lds
    buffer_load_dwordx4 v2, s[16:19], s41 offen offset:3072 lds
    s_add_u32 m0, s43, 120832
    s_add_u32 s49, s41, 4096
    buffer_load_dwordx4 v2, s[16:19], s49 offen lds
    s_mov_b64 exec, s[50:51]
    buffer_load_dwordx4 v5, s[16:19], s44 offen offset:1024 lds
    s_mov_b64 exec, -1
    s_add_u32 s41, s41, 688128
    s_add_u32 s44, s44, 688128
    s_waitcnt vmcnt(10)
    s_barrier
    s_waitcnt vmcnt(0)
    s_barrier
    s_endpgm
L_k3_end:
    s_endpgm
.globl final_kernel
.p2align 8
.type final_kernel,@function
final_kernel:
    s_cmp_ge_u32 s2, 224
    s_cbranch_scc1 L_k45_end
    s_load_dwordx4 s[4:7], s[0:1], 16
    s_load_dwordx2 s[8:9], s[0:1], 48
    s_load_dwordx2 s[28:29], s[0:1], 32
    v_lshlrev_b32 v214, 2, v0
    v_and_b32 v200, 63, v0
    v_lshrrev_b32 v204, 6, v0
    v_and_b32 v201, 15, v200
    v_readfirstlane_b32 s10, v204
    v_lshrrev_b32 v202, 4, v200
    s_mov_b32 s30, 0x05040100
    s_mov_b32 s31, 0x07060302
    s_and_b32 s13, s2, 3
    s_lshr_b32 s12, s2, 2
    s_cmp_ge_u32 s12, 28
    s_cselect_b32 s11, 1, 0
    s_mul_i32 s15, s11, 28
    s_sub_u32 s12, s12, s15
    s_mul_i32 s14, s12, 6
    s_add_u32 s14, s14, s10
    s_waitcnt lgkmcnt(0)
    s_mov_b32 s16, s8
    s_and_b32 s17, s9, 0xffff
    s_mov_b32 s18, 268435456
    s_mov_b32 s19, 0x00020000
    s_mov_b32 s24, 8192
    v_mul_u32_u24 v203, s24, v202
    v_lshl_add_u32 v203, v201, 4, v203
    s_mul_i32 s24, s11, 11579392
    s_mul_i32 s25, s14, 65792
    s_add_u32 s24, s24, s25
    s_lshl_b32 s25, s13, 8
    s_add_u32 s24, s24, s25
    s_add_u32 s24, s24, 117440512
    s_add_u32 s25, s24, 0
    buffer_load_dwordx4 v[0:3], v203, s[16:19], s25 offen
    s_add_u32 s25, s24, 1024
    buffer_load_dwordx4 v[4:7], v203, s[16:19], s25 offen
    s_add_u32 s25, s24, 2048
    buffer_load_dwordx4 v[8:11], v203, s[16:19], s25 offen
    s_add_u32 s25, s24, 3072
    buffer_load_dwordx4 v[12:15], v203, s[16:19], s25 offen
    s_add_u32 s25, s24, 4096
    buffer_load_dwordx4 v[16:19], v203, s[16:19], s25 offen
    s_add_u32 s25, s24, 5120
    buffer_load_dwordx4 v[20:23], v203, s[16:19], s25 offen
    s_add_u32 s25, s24, 6144
    buffer_load_dwordx4 v[24:27], v203, s[16:19], s25 offen
    s_add_u32 s25, s24, 7168
    buffer_load_dwordx4 v[28:31], v203, s[16:19], s25 offen
    s_add_u32 s25, s24, 32768
    buffer_load_dwordx4 v[32:35], v203, s[16:19], s25 offen
    s_add_u32 s25, s24, 33792
    buffer_load_dwordx4 v[36:39], v203, s[16:19], s25 offen
    s_add_u32 s25, s24, 34816
    buffer_load_dwordx4 v[40:43], v203, s[16:19], s25 offen
    s_add_u32 s25, s24, 35840
    buffer_load_dwordx4 v[44:47], v203, s[16:19], s25 offen
    s_add_u32 s25, s24, 36864
    buffer_load_dwordx4 v[48:51], v203, s[16:19], s25 offen
    s_add_u32 s25, s24, 37888
    buffer_load_dwordx4 v[52:55], v203, s[16:19], s25 offen
    s_add_u32 s25, s24, 38912
    buffer_load_dwordx4 v[56:59], v203, s[16:19], s25 offen
    s_add_u32 s25, s24, 39936
    buffer_load_dwordx4 v[60:63], v203, s[16:19], s25 offen
    s_cmp_ge_u32 s10, 3
    s_cbranch_scc1 L_k45_notab
    s_lshl_b32 s25, s10, 4
    v_add_u32 v204, s25, v201
    v_lshlrev_b32 v205, 3, v202
    v_add_u32 v205, 1, v205
    v_mul_u32_u24 v88, v205, v204
    v_add_u32 v89, 32, v88
    v_add_u32 v205, 2, v205
    v_mul_u32_u24 v90, v205, v204
    v_add_u32 v91, 32, v90
    v_add_u32 v205, 2, v205
    v_mul_u32_u24 v92, v205, v204
    v_add_u32 v93, 32, v92
    v_add_u32 v205, 2, v205
    v_mul_u32_u24 v94, v205, v204
    v_add_u32 v95, 32, v94
    v_and_b32 v88, 127, v88
    v_cvt_f32_u32 v88, v88
    v_mul_f32 v88, 0x3c000000, v88
    v_cos_f32 v88, v88
    v_and_b32 v89, 127, v89
    v_cvt_f32_u32 v89, v89
    v_mul_f32 v89, 0x3c000000, v89
    v_cos_f32 v89, v89
    v_and_b32 v90, 127, v90
    v_cvt_f32_u32 v90, v90
    v_mul_f32 v90, 0x3c000000, v90
    v_cos_f32 v90, v90
    v_and_b32 v91, 127, v91
    v_cvt_f32_u32 v91, v91
    v_mul_f32 v91, 0x3c000000, v91
    v_cos_f32 v91, v91
    v_and_b32 v92, 127, v92
    v_cvt_f32_u32 v92, v92
    v_mul_f32 v92, 0x3c000000, v92
    v_cos_f32 v92, v92
    v_and_b32 v93, 127, v93
    v_cvt_f32_u32 v93, v93
    v_mul_f32 v93, 0x3c000000, v93
    v_cos_f32 v93, v93
    v_and_b32 v94, 127, v94
    v_cvt_f32_u32 v94, v94
    v_mul_f32 v94, 0x3c000000, v94
    v_cos_f32 v94, v94
    v_and_b32 v95, 127, v95
    v_cvt_f32_u32 v95, v95
    v_mul_f32 v95, 0x3c000000, v95
    v_cos_f32 v95, v95
    v_mul_f32 v88, 0x3d000000, v88
    v_mul_f32 v89, 0x3d000000, v89
    v_mul_f32 v90, 0x3d000000, v90
    v_mul_f32 v91, 0x3d000000, v91
    v_mul_f32 v92, 0x3d000000, v92
    v_mul_f32 v93, 0x3d000000, v93
    v_mul_f32 v94, 0x3d000000, v94
    v_mul_f32 v95, 0x3d000000, v95
    v_cvt_pk_bf16_f32 v104, v88, v89
    v_cvt_pk_bf16_f32 v105, v90, v91
    v_cvt_pk_bf16_f32 v106, v92, v93
    v_cvt_pk_bf16_f32 v107, v94, v95
    s_lshl_b32 s25, s10, 11
    v_lshlrev_b32 v207, 4, v200
    v_add_u32 v207, s25, v207
    ds_write_b128 v207, v[104:107] offset:0
    v_lshlrev_b32 v205, 3, v202
    v_add_u32 v205, 33, v205
    v_mul_u32_u24 v88, v205, v204
    v_add_u32 v89, 32, v88
    v_add_u32 v205, 2, v205
    v_mul_u32_u24 v90, v205, v204
    v_add_u32 v91, 32, v90
    v_add_u32 v205, 2, v205
    v_mul_u32_u24 v92, v205, v204
    v_add_u32 v93, 32, v92
    v_add_u32 v205, 2, v205
    v_mul_u32_u24 v94, v205, v204
    v_add_u32 v95, 32, v94
    v_and_b32 v88, 127, v88
    v_cvt_f32_u32 v88, v88
    v_mul_f32 v88, 0x3c000000, v88
    v_cos_f32 v88, v88
    v_and_b32 v89, 127, v89
    v_cvt_f32_u32 v89, v89
    v_mul_f32 v89, 0x3c000000, v89
    v_cos_f32 v89, v89
    v_and_b32 v90, 127, v90
    v_cvt_f32_u32 v90, v90
    v_mul_f32 v90, 0x3c000000, v90
    v_cos_f32 v90, v90
    v_and_b32 v91, 127, v91
    v_cvt_f32_u32 v91, v91
    v_mul_f32 v91, 0x3c000000, v91
    v_cos_f32 v91, v91
    v_and_b32 v92, 127, v92
    v_cvt_f32_u32 v92, v92
    v_mul_f32 v92, 0x3c000000, v92
    v_cos_f32 v92, v92
    v_and_b32 v93, 127, v93
    v_cvt_f32_u32 v93, v93
    v_mul_f32 v93, 0x3c000000, v93
    v_cos_f32 v93, v93
    v_and_b32 v94, 127, v94
    v_cvt_f32_u32 v94, v94
    v_mul_f32 v94, 0x3c000000, v94
    v_cos_f32 v94, v94
    v_and_b32 v95, 127, v95
    v_cvt_f32_u32 v95, v95
    v_mul_f32 v95, 0x3c000000, v95
    v_cos_f32 v95, v95
    v_mul_f32 v88, 0x3d000000, v88
    v_mul_f32 v89, 0x3d000000, v89
    v_mul_f32 v90, 0x3d000000, v90
    v_mul_f32 v91, 0x3d000000, v91
    v_mul_f32 v92, 0x3d000000, v92
    v_mul_f32 v93, 0x3d000000, v93
    v_mul_f32 v94, 0x3d000000, v94
    v_mul_f32 v95, 0x3d000000, v95
    v_cvt_pk_bf16_f32 v104, v88, v89
    v_cvt_pk_bf16_f32 v105, v90, v91
    v_cvt_pk_bf16_f32 v106, v92, v93
    v_cvt_pk_bf16_f32 v107, v94, v95
    s_lshl_b32 s25, s10, 11
    v_lshlrev_b32 v207, 4, v200
    v_add_u32 v207, s25, v207
    ds_write_b128 v207, v[104:107] offset:1024
L_k45_notab:
    s_mov_b32 s20, s4
    s_and_b32 s21, s5, 0xffff
    s_mov_b32 s22, 1024
    s_mov_b32 s23, 0x00020000
    s_mov_b32 s36, s6
    s_and_b32 s37, s7, 0xffff
    s_mov_b32 s38, 1024
    s_mov_b32 s39, 0x00020000
    v_lshlrev_b32 v210, 4, v201
    s_lshl_b32 s25, s13, 8
    buffer_load_dwordx4 v[232:235], v210, s[20:23], s25 offen
    buffer_load_dwordx4 v[236:239], v210, s[36:39], s25 offen
    s_waitcnt lgkmcnt(0)
    s_barrier
    v_lshlrev_b32 v207, 4, v200
    ds_read_b128 v[64:67], v207 offset:0
    ds_read_b128 v[68:71], v207 offset:1024
    ds_read_b128 v[72:75], v207 offset:2048
    ds_read_b128 v[76:79], v207 offset:3072
    ds_read_b128 v[80:83], v207 offset:4096
    ds_read_b128 v[84:87], v207 offset:5120
    s_cmp_ge_u32 s14, 167
    s_cbranch_scc1 L_k45_zero
    s_waitcnt lgkmcnt(0)
    s_cmp_lg_u32 s14, 166
    s_cbranch_scc1 L_k45_full
    v_cmp_gt_i32 vcc, 17, v201
    s_nop 1
    v_cndmask_b32 v64, 0, v64, vcc
    v_cndmask_b32 v65, 0, v65, vcc
    v_cndmask_b32 v66, 0, v66, vcc
    v_cndmask_b32 v67, 0, v67, vcc
    v_cndmask_b32 v68, 0, v68, vcc
    v_cndmask_b32 v69, 0, v69, vcc
    v_cndmask_b32 v70, 0, v70, vcc
    v_cndmask_b32 v71, 0, v71, vcc
    v_cmp_gt_i32 vcc, 1, v201
    s_nop 1
    v_cndmask_b32 v72, 0, v72, vcc
    v_cndmask_b32 v73, 0, v73, vcc
    v_cndmask_b32 v74, 0, v74, vcc
    v_cndmask_b32 v75, 0, v75, vcc
    v_cndmask_b32 v76, 0, v76, vcc
    v_cndmask_b32 v77, 0, v77, vcc
    v_cndmask_b32 v78, 0, v78, vcc
    v_cndmask_b32 v79, 0, v79, vcc
    v_cmp_gt_i32 vcc, 0, v201
    s_nop 1
    v_cndmask_b32 v80, 0, v80, vcc
    v_cndmask_b32 v81, 0, v81, vcc
    v_cndmask_b32 v82, 0, v82, vcc
    v_cndmask_b32 v83, 0, v83, vcc
    v_cndmask_b32 v84, 0, v84, vcc
    v_cndmask_b32 v85, 0, v85, vcc
    v_cndmask_b32 v86, 0, v86, vcc
    v_cndmask_b32 v87, 0, v87, vcc
L_k45_full:
    s_waitcnt vmcnt(2)
    v_perm_b32 v88, v4, v0, s30
    v_perm_b32 v89, v12, v8, s30
    v_perm_b32 v90, v20, v16, s30
    v_perm_b32 v91, v28, v24, s30
    v_perm_b32 v92, v4, v0, s31
    v_perm_b32 v93, v12, v8, s31
    v_perm_b32 v94, v20, v16, s31
    v_perm_b32 v95, v28, v24, s31
    v_perm_b32 v96, v36, v32, s30
    v_perm_b32 v97, v44, v40, s30
    v_perm_b32 v98, v52, v48, s30
    v_perm_b32 v99, v60, v56, s30
    v_perm_b32 v100, v36, v32, s31
    v_perm_b32 v101, v44, v40, s31
    v_perm_b32 v102, v52, v48, s31
    v_perm_b32 v103, v60, v56, s31
    v_mfma_f32_16x16x32_bf16 v[104:107], v[64:67], v[88:91], 0
    v_mfma_f32_16x16x32_bf16 v[108:111], v[64:67], v[92:95], 0
    v_mfma_f32_16x16x32_bf16 v[136:139], v[72:75], v[88:91], 0
    v_mfma_f32_16x16x32_bf16 v[140:143], v[72:75], v[92:95], 0
    v_mfma_f32_16x16x32_bf16 v[168:171], v[80:83], v[88:91], 0
    v_mfma_f32_16x16x32_bf16 v[172:175], v[80:83], v[92:95], 0
    v_mfma_f32_16x16x32_bf16 v[104:107], v[68:71], v[96:99], v[104:107]
    v_mfma_f32_16x16x32_bf16 v[108:111], v[68:71], v[100:103], v[108:111]
    v_mfma_f32_16x16x32_bf16 v[136:139], v[76:79], v[96:99], v[136:139]
    v_mfma_f32_16x16x32_bf16 v[140:143], v[76:79], v[100:103], v[140:143]
    v_mfma_f32_16x16x32_bf16 v[168:171], v[84:87], v[96:99], v[168:171]
    v_mfma_f32_16x16x32_bf16 v[172:175], v[84:87], v[100:103], v[172:175]
    v_perm_b32 v88, v5, v1, s30
    v_perm_b32 v89, v13, v9, s30
    v_perm_b32 v90, v21, v17, s30
    v_perm_b32 v91, v29, v25, s30
    v_perm_b32 v92, v5, v1, s31
    v_perm_b32 v93, v13, v9, s31
    v_perm_b32 v94, v21, v17, s31
    v_perm_b32 v95, v29, v25, s31
    v_perm_b32 v96, v37, v33, s30
    v_perm_b32 v97, v45, v41, s30
    v_perm_b32 v98, v53, v49, s30
    v_perm_b32 v99, v61, v57, s30
    v_perm_b32 v100, v37, v33, s31
    v_perm_b32 v101, v45, v41, s31
    v_perm_b32 v102, v53, v49, s31
    v_perm_b32 v103, v61, v57, s31
    v_mfma_f32_16x16x32_bf16 v[112:115], v[64:67], v[88:91], 0
    v_mfma_f32_16x16x32_bf16 v[116:119], v[64:67], v[92:95], 0
    v_mfma_f32_16x16x32_bf16 v[144:147], v[72:75], v[88:91], 0
    v_mfma_f32_16x16x32_bf16 v[148:151], v[72:75], v[92:95], 0
    v_mfma_f32_16x16x32_bf16 v[176:179], v[80:83], v[88:91], 0
    v_mfma_f32_16x16x32_bf16 v[180:183], v[80:83], v[92:95], 0
    v_mfma_f32_16x16x32_bf16 v[112:115], v[68:71], v[96:99], v[112:115]
    v_mfma_f32_16x16x32_bf16 v[116:119], v[68:71], v[100:103], v[116:119]
    v_mfma_f32_16x16x32_bf16 v[144:147], v[76:79], v[96:99], v[144:147]
    v_mfma_f32_16x16x32_bf16 v[148:151], v[76:79], v[100:103], v[148:151]
    v_mfma_f32_16x16x32_bf16 v[176:179], v[84:87], v[96:99], v[176:179]
    v_mfma_f32_16x16x32_bf16 v[180:183], v[84:87], v[100:103], v[180:183]
    v_perm_b32 v88, v6, v2, s30
    v_perm_b32 v89, v14, v10, s30
    v_perm_b32 v90, v22, v18, s30
    v_perm_b32 v91, v30, v26, s30
    v_perm_b32 v92, v6, v2, s31
    v_perm_b32 v93, v14, v10, s31
    v_perm_b32 v94, v22, v18, s31
    v_perm_b32 v95, v30, v26, s31
    v_perm_b32 v96, v38, v34, s30
    v_perm_b32 v97, v46, v42, s30
    v_perm_b32 v98, v54, v50, s30
    v_perm_b32 v99, v62, v58, s30
    v_perm_b32 v100, v38, v34, s31
    v_perm_b32 v101, v46, v42, s31
    v_perm_b32 v102, v54, v50, s31
    v_perm_b32 v103, v62, v58, s31
    v_mfma_f32_16x16x32_bf16 v[120:123], v[64:67], v[88:91], 0
    v_mfma_f32_16x16x32_bf16 v[124:127], v[64:67], v[92:95], 0
    v_mfma_f32_16x16x32_bf16 v[152:155], v[72:75], v[88:91], 0
    v_mfma_f32_16x16x32_bf16 v[156:159], v[72:75], v[92:95], 0
    v_mfma_f32_16x16x32_bf16 v[184:187], v[80:83], v[88:91], 0
    v_mfma_f32_16x16x32_bf16 v[188:191], v[80:83], v[92:95], 0
    v_mfma_f32_16x16x32_bf16 v[120:123], v[68:71], v[96:99], v[120:123]
    v_mfma_f32_16x16x32_bf16 v[124:127], v[68:71], v[100:103], v[124:127]
    v_mfma_f32_16x16x32_bf16 v[152:155], v[76:79], v[96:99], v[152:155]
    v_mfma_f32_16x16x32_bf16 v[156:159], v[76:79], v[100:103], v[156:159]
    v_mfma_f32_16x16x32_bf16 v[184:187], v[84:87], v[96:99], v[184:187]
    v_mfma_f32_16x16x32_bf16 v[188:191], v[84:87], v[100:103], v[188:191]
    v_perm_b32 v88, v7, v3, s30
    v_perm_b32 v89, v15, v11, s30
    v_perm_b32 v90, v23, v19, s30
    v_perm_b32 v91, v31, v27, s30
    v_perm_b32 v92, v7, v3, s31
    v_perm_b32 v93, v15, v11, s31
    v_perm_b32 v94, v23, v19, s31
    v_perm_b32 v95, v31, v27, s31
    v_perm_b32 v96, v39, v35, s30
    v_perm_b32 v97, v47, v43, s30
    v_perm_b32 v98, v55, v51, s30
    v_perm_b32 v99, v63, v59, s30
    v_perm_b32 v100, v39, v35, s31
    v_perm_b32 v101, v47, v43, s31
    v_perm_b32 v102, v55, v51, s31
    v_perm_b32 v103, v63, v59, s31
    v_mfma_f32_16x16x32_bf16 v[128:131], v[64:67], v[88:91], 0
    v_mfma_f32_16x16x32_bf16 v[132:135], v[64:67], v[92:95], 0
    v_mfma_f32_16x16x32_bf16 v[160:163], v[72:75], v[88:91], 0
    v_mfma_f32_16x16x32_bf16 v[164:167], v[72:75], v[92:95], 0
    v_mfma_f32_16x16x32_bf16 v[192:195], v[80:83], v[88:91], 0
    v_mfma_f32_16x16x32_bf16 v[196:199], v[80:83], v[92:95], 0
    v_mfma_f32_16x16x32_bf16 v[128:131], v[68:71], v[96:99], v[128:131]
    v_mfma_f32_16x16x32_bf16 v[132:135], v[68:71], v[100:103], v[132:135]
    v_mfma_f32_16x16x32_bf16 v[160:163], v[76:79], v[96:99], v[160:163]
    v_mfma_f32_16x16x32_bf16 v[164:167], v[76:79], v[100:103], v[164:167]
    v_mfma_f32_16x16x32_bf16 v[192:195], v[84:87], v[96:99], v[192:195]
    v_mfma_f32_16x16x32_bf16 v[196:199], v[84:87], v[100:103], v[196:199]
    s_nop 7
    v_mul_f32 v224, v104, v104
    v_mov_b32 v216, v104
    v_fmac_f32 v224, v105, v105
    v_add_f32 v216, v216, v105
    v_fmac_f32 v224, v106, v106
    v_add_f32 v216, v216, v106
    v_fmac_f32 v224, v107, v107
    v_add_f32 v216, v216, v107
    v_fmac_f32 v224, v136, v136
    v_add_f32 v216, v216, v136
    v_fmac_f32 v224, v137, v137
    v_add_f32 v216, v216, v137
    v_fmac_f32 v224, v138, v138
    v_add_f32 v216, v216, v138
    v_fmac_f32 v224, v139, v139
    v_add_f32 v216, v216, v139
    v_fmac_f32 v224, v168, v168
    v_add_f32 v216, v216, v168
    v_fmac_f32 v224, v169, v169
    v_add_f32 v216, v216, v169
    v_fmac_f32 v224, v170, v170
    v_add_f32 v216, v216, v170
    v_fmac_f32 v224, v171, v171
    v_add_f32 v216, v216, v171
    v_mul_f32 v225, v108, v108
    v_mov_b32 v217, v108
    v_fmac_f32 v225, v109, v109
    v_add_f32 v217, v217, v109
    v_fmac_f32 v225, v110, v110
    v_add_f32 v217, v217, v110
    v_fmac_f32 v225, v111, v111
    v_add_f32 v217, v217, v111
    v_fmac_f32 v225, v140, v140
    v_add_f32 v217, v217, v140
    v_fmac_f32 v225, v141, v141
    v_add_f32 v217, v217, v141
    v_fmac_f32 v225, v142, v142
    v_add_f32 v217, v217, v142
    v_fmac_f32 v225, v143, v143
    v_add_f32 v217, v217, v143
    v_fmac_f32 v225, v172, v172
    v_add_f32 v217, v217, v172
    v_fmac_f32 v225, v173, v173
    v_add_f32 v217, v217, v173
    v_fmac_f32 v225, v174, v174
    v_add_f32 v217, v217, v174
    v_fmac_f32 v225, v175, v175
    v_add_f32 v217, v217, v175
    v_mul_f32 v226, v112, v112
    v_mov_b32 v218, v112
    v_fmac_f32 v226, v113, v113
    v_add_f32 v218, v218, v113
    v_fmac_f32 v226, v114, v114
    v_add_f32 v218, v218, v114
    v_fmac_f32 v226, v115, v115
    v_add_f32 v218, v218, v115
    v_fmac_f32 v226, v144, v144
    v_add_f32 v218, v218, v144
    v_fmac_f32 v226, v145, v145
    v_add_f32 v218, v218, v145
    v_fmac_f32 v226, v146, v146
    v_add_f32 v218, v218, v146
    v_fmac_f32 v226, v147, v147
    v_add_f32 v218, v218, v147
    v_fmac_f32 v226, v176, v176
    v_add_f32 v218, v218, v176
    v_fmac_f32 v226, v177, v177
    v_add_f32 v218, v218, v177
    v_fmac_f32 v226, v178, v178
    v_add_f32 v218, v218, v178
    v_fmac_f32 v226, v179, v179
    v_add_f32 v218, v218, v179
    v_mul_f32 v227, v116, v116
    v_mov_b32 v219, v116
    v_fmac_f32 v227, v117, v117
    v_add_f32 v219, v219, v117
    v_fmac_f32 v227, v118, v118
    v_add_f32 v219, v219, v118
    v_fmac_f32 v227, v119, v119
    v_add_f32 v219, v219, v119
    v_fmac_f32 v227, v148, v148
    v_add_f32 v219, v219, v148
    v_fmac_f32 v227, v149, v149
    v_add_f32 v219, v219, v149
    v_fmac_f32 v227, v150, v150
    v_add_f32 v219, v219, v150
    v_fmac_f32 v227, v151, v151
    v_add_f32 v219, v219, v151
    v_fmac_f32 v227, v180, v180
    v_add_f32 v219, v219, v180
    v_fmac_f32 v227, v181, v181
    v_add_f32 v219, v219, v181
    v_fmac_f32 v227, v182, v182
    v_add_f32 v219, v219, v182
    v_fmac_f32 v227, v183, v183
    v_add_f32 v219, v219, v183
    v_mul_f32 v228, v120, v120
    v_mov_b32 v220, v120
    v_fmac_f32 v228, v121, v121
    v_add_f32 v220, v220, v121
    v_fmac_f32 v228, v122, v122
    v_add_f32 v220, v220, v122
    v_fmac_f32 v228, v123, v123
    v_add_f32 v220, v220, v123
    v_fmac_f32 v228, v152, v152
    v_add_f32 v220, v220, v152
    v_fmac_f32 v228, v153, v153
    v_add_f32 v220, v220, v153
    v_fmac_f32 v228, v154, v154
    v_add_f32 v220, v220, v154
    v_fmac_f32 v228, v155, v155
    v_add_f32 v220, v220, v155
    v_fmac_f32 v228, v184, v184
    v_add_f32 v220, v220, v184
    v_fmac_f32 v228, v185, v185
    v_add_f32 v220, v220, v185
    v_fmac_f32 v228, v186, v186
    v_add_f32 v220, v220, v186
    v_fmac_f32 v228, v187, v187
    v_add_f32 v220, v220, v187
    v_mul_f32 v229, v124, v124
    v_mov_b32 v221, v124
    v_fmac_f32 v229, v125, v125
    v_add_f32 v221, v221, v125
    v_fmac_f32 v229, v126, v126
    v_add_f32 v221, v221, v126
    v_fmac_f32 v229, v127, v127
    v_add_f32 v221, v221, v127
    v_fmac_f32 v229, v156, v156
    v_add_f32 v221, v221, v156
    v_fmac_f32 v229, v157, v157
    v_add_f32 v221, v221, v157
    v_fmac_f32 v229, v158, v158
    v_add_f32 v221, v221, v158
    v_fmac_f32 v229, v159, v159
    v_add_f32 v221, v221, v159
    v_fmac_f32 v229, v188, v188
    v_add_f32 v221, v221, v188
    v_fmac_f32 v229, v189, v189
    v_add_f32 v221, v221, v189
    v_fmac_f32 v229, v190, v190
    v_add_f32 v221, v221, v190
    v_fmac_f32 v229, v191, v191
    v_add_f32 v221, v221, v191
    v_mul_f32 v230, v128, v128
    v_mov_b32 v222, v128
    v_fmac_f32 v230, v129, v129
    v_add_f32 v222, v222, v129
    v_fmac_f32 v230, v130, v130
    v_add_f32 v222, v222, v130
    v_fmac_f32 v230, v131, v131
    v_add_f32 v222, v222, v131
    v_fmac_f32 v230, v160, v160
    v_add_f32 v222, v222, v160
    v_fmac_f32 v230, v161, v161
    v_add_f32 v222, v222, v161
    v_fmac_f32 v230, v162, v162
    v_add_f32 v222, v222, v162
    v_fmac_f32 v230, v163, v163
    v_add_f32 v222, v222, v163
    v_fmac_f32 v230, v192, v192
    v_add_f32 v222, v222, v192
    v_fmac_f32 v230, v193, v193
    v_add_f32 v222, v222, v193
    v_fmac_f32 v230, v194, v194
    v_add_f32 v222, v222, v194
    v_fmac_f32 v230, v195, v195
    v_add_f32 v222, v222, v195
    v_mul_f32 v231, v132, v132
    v_mov_b32 v223, v132
    v_fmac_f32 v231, v133, v133
    v_add_f32 v223, v223, v133
    v_fmac_f32 v231, v134, v134
    v_add_f32 v223, v223, v134
    v_fmac_f32 v231, v135, v135
    v_add_f32 v223, v223, v135
    v_fmac_f32 v231, v164, v164
    v_add_f32 v223, v223, v164
    v_fmac_f32 v231, v165, v165
    v_add_f32 v223, v223, v165
    v_fmac_f32 v231, v166, v166
    v_add_f32 v223, v223, v166
    v_fmac_f32 v231, v167, v167
    v_add_f32 v223, v223, v167
    v_fmac_f32 v231, v196, v196
    v_add_f32 v223, v223, v196
    v_fmac_f32 v231, v197, v197
    v_add_f32 v223, v223, v197
    v_fmac_f32 v231, v198, v198
    v_add_f32 v223, v223, v198
    v_fmac_f32 v231, v199, v199
    v_add_f32 v223, v223, v199
    s_branch L_k45_red
L_k45_zero:
    s_waitcnt vmcnt(0) lgkmcnt(0)
    v_mov_b32 v216, 0
    v_mov_b32 v224, 0
    v_mov_b32 v217, 0
    v_mov_b32 v225, 0
    v_mov_b32 v218, 0
    v_mov_b32 v226, 0
    v_mov_b32 v219, 0
    v_mov_b32 v227, 0
    v_mov_b32 v220, 0
    v_mov_b32 v228, 0
    v_mov_b32 v221, 0
    v_mov_b32 v229, 0
    v_mov_b32 v222, 0
    v_mov_b32 v230, 0
    v_mov_b32 v223, 0
    v_mov_b32 v231, 0
L_k45_red:
    s_lshl_b32 s25, s10, 12
    v_lshlrev_b32 v204, 10, v202
    v_lshl_add_u32 v204, v201, 5, v204
    v_add_u32 v204, s25, v204
    ds_write_b128 v204, v[216:219] offset:8192
    ds_write_b128 v204, v[220:223] offset:8208
    ds_write_b128 v204, v[224:227] offset:8704
    ds_write_b128 v204, v[228:231] offset:8720
    s_waitcnt lgkmcnt(0)
    s_barrier
    s_cmp_ge_u32 s10, 4
    s_cbranch_scc1 L_k45_nored
    ds_read_b32 v16, v214 offset:8192
    ds_read_b32 v17, v214 offset:9216
    ds_read_b32 v18, v214 offset:10240
    ds_read_b32 v19, v214 offset:11264
    ds_read_b32 v20, v214 offset:12288
    ds_read_b32 v21, v214 offset:13312
    ds_read_b32 v22, v214 offset:14336
    ds_read_b32 v23, v214 offset:15360
    ds_read_b32 v24, v214 offset:16384
    ds_read_b32 v25, v214 offset:17408
    ds_read_b32 v26, v214 offset:18432
    ds_read_b32 v27, v214 offset:19456
    ds_read_b32 v28, v214 offset:20480
    ds_read_b32 v29, v214 offset:21504
    ds_read_b32 v30, v214 offset:22528
    ds_read_b32 v31, v214 offset:23552
    ds_read_b32 v32, v214 offset:24576
    ds_read_b32 v33, v214 offset:25600
    ds_read_b32 v34, v214 offset:26624
    ds_read_b32 v35, v214 offset:27648
    ds_read_b32 v36, v214 offset:28672
    ds_read_b32 v37, v214 offset:29696
    ds_read_b32 v38, v214 offset:30720
    ds_read_b32 v39, v214 offset:31744
    s_waitcnt lgkmcnt(0)
    v_add_f32 v16, v16, v17
    v_add_f32 v16, v16, v18
    v_add_f32 v16, v16, v19
    v_add_f32 v16, v16, v20
    v_add_f32 v16, v16, v21
    v_add_f32 v16, v16, v22
    v_add_f32 v16, v16, v23
    v_add_f32 v16, v16, v24
    v_add_f32 v16, v16, v25
    v_add_f32 v16, v16, v26
    v_add_f32 v16, v16, v27
    v_add_f32 v16, v16, v28
    v_add_f32 v16, v16, v29
    v_add_f32 v16, v16, v30
    v_add_f32 v16, v16, v31
    v_add_f32 v16, v16, v32
    v_add_f32 v16, v16, v33
    v_add_f32 v16, v16, v34
    v_add_f32 v16, v16, v35
    v_add_f32 v16, v16, v36
    v_add_f32 v16, v16, v37
    v_add_f32 v16, v16, v38
    v_add_f32 v16, v16, v39
L_k45_nored:
    s_mul_i32 s24, s11, 112
    s_mul_i32 s25, s13, 28
    s_add_u32 s24, s24, s25
    s_lshl_b32 s26, s24, 10
    s_add_u32 s26, s26, 146800640
    s_lshl_b32 s24, s12, 10
    s_add_u32 s24, s24, s26
    s_cmp_ge_u32 s10, 4
    s_cbranch_scc1 L_k45_nost
    buffer_store_dword v16, v214, s[16:19], s24 offen sc1
L_k45_nost:
    s_waitcnt vmcnt(0)
    s_barrier
    s_lshl_b32 s27, s11, 2
    s_add_u32 s27, s27, s13
    s_mul_i32 s27, s27, 8448
    s_add_u32 s27, s27, 147849216
    s_cmp_lg_u32 s10, 0
    s_cbranch_scc1 L_k45_wait
    v_mov_b32 v0, 1
    v_mov_b32 v1, 0
    s_mov_b64 exec, 1
    buffer_atomic_add v0, v1, s[16:19], s27 offen sc1
    s_mov_b64 exec, -1
    s_mov_b32 s33, 65536
L_k45_poll:
    s_sleep 8
    buffer_load_dword v2, v1, s[16:19], s27 offen sc1
    s_waitcnt vmcnt(0)
    v_readfirstlane_b32 s34, v2
    s_nop 3
    s_cmp_ge_u32 s34, 28
    s_cbranch_scc1 L_k45_wait
    s_sub_u32 s33, s33, 1
    s_cmp_lg_u32 s33, 0
    s_cbranch_scc1 L_k45_poll
L_k45_wait:
    s_barrier
    s_cmp_ge_u32 s10, 4
    s_cbranch_scc1 L_k45_nosum
    buffer_load_dword v0, v214, s[16:19], s26 offen offset:0 sc1
    buffer_load_dword v1, v214, s[16:19], s26 offen offset:1024 sc1
    buffer_load_dword v2, v214, s[16:19], s26 offen offset:2048 sc1
    buffer_load_dword v3, v214, s[16:19], s26 offen offset:3072 sc1
    s_add_u32 s26, s26, 4096
    buffer_load_dword v4, v214, s[16:19], s26 offen offset:0 sc1
    buffer_load_dword v5, v214, s[16:19], s26 offen offset:1024 sc1
    buffer_load_dword v6, v214, s[16:19], s26 offen offset:2048 sc1
    buffer_load_dword v7, v214, s[16:19], s26 offen offset:3072 sc1
    s_add_u32 s26, s26, 4096
    buffer_load_dword v8, v214, s[16:19], s26 offen offset:0 sc1
    buffer_load_dword v9, v214, s[16:19], s26 offen offset:1024 sc1
    buffer_load_dword v10, v214, s[16:19], s26 offen offset:2048 sc1
    buffer_load_dword v11, v214, s[16:19], s26 offen offset:3072 sc1
    s_add_u32 s26, s26, 4096
    buffer_load_dword v12, v214, s[16:19], s26 offen offset:0 sc1
    buffer_load_dword v13, v214, s[16:19], s26 offen offset:1024 sc1
    buffer_load_dword v14, v214, s[16:19], s26 offen offset:2048 sc1
    buffer_load_dword v15, v214, s[16:19], s26 offen offset:3072 sc1
    s_add_u32 s26, s26, 4096
    buffer_load_dword v16, v214, s[16:19], s26 offen offset:0 sc1
    buffer_load_dword v17, v214, s[16:19], s26 offen offset:1024 sc1
    buffer_load_dword v18, v214, s[16:19], s26 offen offset:2048 sc1
    buffer_load_dword v19, v214, s[16:19], s26 offen offset:3072 sc1
    s_add_u32 s26, s26, 4096
    buffer_load_dword v20, v214, s[16:19], s26 offen offset:0 sc1
    buffer_load_dword v21, v214, s[16:19], s26 offen offset:1024 sc1
    buffer_load_dword v22, v214, s[16:19], s26 offen offset:2048 sc1
    buffer_load_dword v23, v214, s[16:19], s26 offen offset:3072 sc1
    s_add_u32 s26, s26, 4096
    buffer_load_dword v24, v214, s[16:19], s26 offen offset:0 sc1
    buffer_load_dword v25, v214, s[16:19], s26 offen offset:1024 sc1
    buffer_load_dword v26, v214, s[16:19], s26 offen offset:2048 sc1
    buffer_load_dword v27, v214, s[16:19], s26 offen offset:3072 sc1
    s_waitcnt vmcnt(0)
    v_add_f32 v0, v0, v1
    v_add_f32 v2, v2, v3
    v_add_f32 v4, v4, v5
    v_add_f32 v6, v6, v7
    v_add_f32 v8, v8, v9
    v_add_f32 v10, v10, v11
    v_add_f32 v12, v12, v13
    v_add_f32 v14, v14, v15
    v_add_f32 v16, v16, v17
    v_add_f32 v18, v18, v19
    v_add_f32 v20, v20, v21
    v_add_f32 v22, v22, v23
    v_add_f32 v24, v24, v25
    v_add_f32 v26, v26, v27
    v_add_f32 v0, v0, v2
    v_add_f32 v4, v4, v6
    v_add_f32 v8, v8, v10
    v_add_f32 v12, v12, v14
    v_add_f32 v16, v16, v18
    v_add_f32 v20, v20, v22
    v_add_f32 v24, v24, v26
    v_add_f32 v0, v0, v4
    v_add_f32 v8, v8, v12
    v_add_f32 v16, v16, v20
    v_add_f32 v0, v0, v8
    v_add_f32 v16, v16, v24
    v_add_f32 v0, v0, v16
    ds_write_b32 v214, v0 offset:32768
L_k45_nosum:
    s_waitcnt lgkmcnt(0)
    s_barrier
    s_cmp_ge_u32 s14, 167
    s_cbranch_scc1 L_k45_end
    v_lshlrev_b32 v210, 5, v201
    ds_read_b128 v[44:47], v210 offset:32768
    ds_read_b128 v[48:51], v210 offset:32784
    ds_read_b128 v[52:55], v210 offset:33280
    ds_read_b128 v[56:59], v210 offset:33296
    s_mov_b32 s24, 0x39035177
    s_mov_b32 s25, 0x3727c5ac
    s_waitcnt lgkmcnt(0)
    v_mul_f32 v44, s24, v44
    v_mul_f32 v52, s24, v52
    v_fma_f32 v52, -v44, v44, v52
    v_max_f32 v52, 0, v52
    v_add_f32 v52, s25, v52
    v_rsq_f32 v52, v52
    v_lshlrev_b32 v216, 16, v232
    v_lshlrev_b32 v224, 16, v236
    v_mul_f32 v216, v216, v52
    v_fma_f32 v224, -v44, v216, v224
    v_mul_f32 v45, s24, v45
    v_mul_f32 v53, s24, v53
    v_fma_f32 v53, -v45, v45, v53
    v_max_f32 v53, 0, v53
    v_add_f32 v53, s25, v53
    v_rsq_f32 v53, v53
    v_and_b32 v217, 0xffff0000, v232
    v_and_b32 v225, 0xffff0000, v236
    v_mul_f32 v217, v217, v53
    v_fma_f32 v225, -v45, v217, v225
    v_mul_f32 v46, s24, v46
    v_mul_f32 v54, s24, v54
    v_fma_f32 v54, -v46, v46, v54
    v_max_f32 v54, 0, v54
    v_add_f32 v54, s25, v54
    v_rsq_f32 v54, v54
    v_lshlrev_b32 v218, 16, v233
    v_lshlrev_b32 v226, 16, v237
    v_mul_f32 v218, v218, v54
    v_fma_f32 v226, -v46, v218, v226
    v_mul_f32 v47, s24, v47
    v_mul_f32 v55, s24, v55
    v_fma_f32 v55, -v47, v47, v55
    v_max_f32 v55, 0, v55
    v_add_f32 v55, s25, v55
    v_rsq_f32 v55, v55
    v_and_b32 v219, 0xffff0000, v233
    v_and_b32 v227, 0xffff0000, v237
    v_mul_f32 v219, v219, v55
    v_fma_f32 v227, -v47, v219, v227
    v_mul_f32 v48, s24, v48
    v_mul_f32 v56, s24, v56
    v_fma_f32 v56, -v48, v48, v56
    v_max_f32 v56, 0, v56
    v_add_f32 v56, s25, v56
    v_rsq_f32 v56, v56
    v_lshlrev_b32 v220, 16, v234
    v_lshlrev_b32 v228, 16, v238
    v_mul_f32 v220, v220, v56
    v_fma_f32 v228, -v48, v220, v228
    v_mul_f32 v49, s24, v49
    v_mul_f32 v57, s24, v57
    v_fma_f32 v57, -v49, v49, v57
    v_max_f32 v57, 0, v57
    v_add_f32 v57, s25, v57
    v_rsq_f32 v57, v57
    v_and_b32 v221, 0xffff0000, v234
    v_and_b32 v229, 0xffff0000, v238
    v_mul_f32 v221, v221, v57
    v_fma_f32 v229, -v49, v221, v229
    v_mul_f32 v50, s24, v50
    v_mul_f32 v58, s24, v58
    v_fma_f32 v58, -v50, v50, v58
    v_max_f32 v58, 0, v58
    v_add_f32 v58, s25, v58
    v_rsq_f32 v58, v58
    v_lshlrev_b32 v222, 16, v235
    v_lshlrev_b32 v230, 16, v239
    v_mul_f32 v222, v222, v58
    v_fma_f32 v230, -v50, v222, v230
    v_mul_f32 v51, s24, v51
    v_mul_f32 v59, s24, v59
    v_fma_f32 v59, -v51, v51, v59
    v_max_f32 v59, 0, v59
    v_add_f32 v59, s25, v59
    v_rsq_f32 v59, v59
    v_and_b32 v223, 0xffff0000, v235
    v_and_b32 v231, 0xffff0000, v239
    v_mul_f32 v223, v223, v59
    v_fma_f32 v231, -v51, v223, v231
    s_mul_i32 s24, s11, 8176640
    s_add_u32 s28, s28, s24
    s_addc_u32 s29, s29, 0
    s_mov_b32 s32, s28
    s_and_b32 s33, s29, 0xffff
    s_mov_b32 s34, 8176640
    s_mov_b32 s35, 0x00020000
    s_mul_i32 s24, s14, 49152
    s_lshl_b32 s25, s13, 8
    s_add_u32 s24, s24, s25
    v_lshlrev_b32 v210, 12, v202
    v_lshl_add_u32 v210, v201, 4, v210
    v_add_u32 v210, s24, v210
    s_mov_b32 s26, 0xbdd2d3e8
    v_mov_b32 v211, 0xc0135761
    v_fma_f32 v104, v104, v216, v224
    v_fma_f32 v108, v108, v217, v225
    v_fma_f32 v112, v112, v218, v226
    v_fma_f32 v116, v116, v219, v227
    v_fma_f32 v120, v120, v220, v228
    v_fma_f32 v124, v124, v221, v229
    v_fma_f32 v128, v128, v222, v230
    v_fma_f32 v132, v132, v223, v231
    v_mul_f32 v0, v104, v104
    v_mul_f32 v1, v108, v108
    v_mul_f32 v2, v112, v112
    v_mul_f32 v3, v116, v116
    v_mul_f32 v4, v120, v120
    v_mul_f32 v5, v124, v124
    v_mul_f32 v6, v128, v128
    v_mul_f32 v7, v132, v132
    v_fma_f32 v0, v0, s26, v211
    v_fma_f32 v1, v1, s26, v211
    v_fma_f32 v2, v2, s26, v211
    v_fma_f32 v3, v3, s26, v211
    v_fma_f32 v4, v4, s26, v211
    v_fma_f32 v5, v5, s26, v211
    v_fma_f32 v6, v6, s26, v211
    v_fma_f32 v7, v7, s26, v211
    v_mul_f32 v0, v0, v104
    v_mul_f32 v1, v1, v108
    v_mul_f32 v2, v2, v112
    v_mul_f32 v3, v3, v116
    v_mul_f32 v4, v4, v120
    v_mul_f32 v5, v5, v124
    v_mul_f32 v6, v6, v128
    v_mul_f32 v7, v7, v132
    v_exp_f32 v0, v0
    v_exp_f32 v1, v1
    v_exp_f32 v2, v2
    v_exp_f32 v3, v3
    v_exp_f32 v4, v4
    v_exp_f32 v5, v5
    v_exp_f32 v6, v6
    v_exp_f32 v7, v7
    v_add_f32 v0, 1.0, v0
    v_add_f32 v1, 1.0, v1
    v_add_f32 v2, 1.0, v2
    v_add_f32 v3, 1.0, v3
    v_add_f32 v4, 1.0, v4
    v_add_f32 v5, 1.0, v5
    v_add_f32 v6, 1.0, v6
    v_add_f32 v7, 1.0, v7
    v_rcp_f32 v0, v0
    v_rcp_f32 v1, v1
    v_rcp_f32 v2, v2
    v_rcp_f32 v3, v3
    v_rcp_f32 v4, v4
    v_rcp_f32 v5, v5
    v_rcp_f32 v6, v6
    v_rcp_f32 v7, v7
    v_mul_f32 v0, v0, v104
    v_mul_f32 v1, v1, v108
    v_mul_f32 v2, v2, v112
    v_mul_f32 v3, v3, v116
    v_mul_f32 v4, v4, v120
    v_mul_f32 v5, v5, v124
    v_mul_f32 v6, v6, v128
    v_mul_f32 v7, v7, v132
    v_cvt_pk_bf16_f32 v16, v0, v1
    v_cvt_pk_bf16_f32 v17, v2, v3
    v_cvt_pk_bf16_f32 v18, v4, v5
    v_cvt_pk_bf16_f32 v19, v6, v7
    v_add_u32 v212, 0, v210
    buffer_store_dwordx4 v[16:19], v212, s[32:35], 0 offen sc1
    v_fma_f32 v105, v105, v216, v224
    v_fma_f32 v109, v109, v217, v225
    v_fma_f32 v113, v113, v218, v226
    v_fma_f32 v117, v117, v219, v227
    v_fma_f32 v121, v121, v220, v228
    v_fma_f32 v125, v125, v221, v229
    v_fma_f32 v129, v129, v222, v230
    v_fma_f32 v133, v133, v223, v231
    v_mul_f32 v0, v105, v105
    v_mul_f32 v1, v109, v109
    v_mul_f32 v2, v113, v113
    v_mul_f32 v3, v117, v117
    v_mul_f32 v4, v121, v121
    v_mul_f32 v5, v125, v125
    v_mul_f32 v6, v129, v129
    v_mul_f32 v7, v133, v133
    v_fma_f32 v0, v0, s26, v211
    v_fma_f32 v1, v1, s26, v211
    v_fma_f32 v2, v2, s26, v211
    v_fma_f32 v3, v3, s26, v211
    v_fma_f32 v4, v4, s26, v211
    v_fma_f32 v5, v5, s26, v211
    v_fma_f32 v6, v6, s26, v211
    v_fma_f32 v7, v7, s26, v211
    v_mul_f32 v0, v0, v105
    v_mul_f32 v1, v1, v109
    v_mul_f32 v2, v2, v113
    v_mul_f32 v3, v3, v117
    v_mul_f32 v4, v4, v121
    v_mul_f32 v5, v5, v125
    v_mul_f32 v6, v6, v129
    v_mul_f32 v7, v7, v133
    v_exp_f32 v0, v0
    v_exp_f32 v1, v1
    v_exp_f32 v2, v2
    v_exp_f32 v3, v3
    v_exp_f32 v4, v4
    v_exp_f32 v5, v5
    v_exp_f32 v6, v6
    v_exp_f32 v7, v7
    v_add_f32 v0, 1.0, v0
    v_add_f32 v1, 1.0, v1
    v_add_f32 v2, 1.0, v2
    v_add_f32 v3, 1.0, v3
    v_add_f32 v4, 1.0, v4
    v_add_f32 v5, 1.0, v5
    v_add_f32 v6, 1.0, v6
    v_add_f32 v7, 1.0, v7
    v_rcp_f32 v0, v0
    v_rcp_f32 v1, v1
    v_rcp_f32 v2, v2
    v_rcp_f32 v3, v3
    v_rcp_f32 v4, v4
    v_rcp_f32 v5, v5
    v_rcp_f32 v6, v6
    v_rcp_f32 v7, v7
    v_mul_f32 v0, v0, v105
    v_mul_f32 v1, v1, v109
    v_mul_f32 v2, v2, v113
    v_mul_f32 v3, v3, v117
    v_mul_f32 v4, v4, v121
    v_mul_f32 v5, v5, v125
    v_mul_f32 v6, v6, v129
    v_mul_f32 v7, v7, v133
    v_cvt_pk_bf16_f32 v20, v0, v1
    v_cvt_pk_bf16_f32 v21, v2, v3
    v_cvt_pk_bf16_f32 v22, v4, v5
    v_cvt_pk_bf16_f32 v23, v6, v7
    v_add_u32 v212, 1024, v210
    buffer_store_dwordx4 v[20:23], v212, s[32:35], 0 offen sc1
    v_fma_f32 v106, v106, v216, v224
    v_fma_f32 v110, v110, v217, v225
    v_fma_f32 v114, v114, v218, v226
    v_fma_f32 v118, v118, v219, v227
    v_fma_f32 v122, v122, v220, v228
    v_fma_f32 v126, v126, v221, v229
    v_fma_f32 v130, v130, v222, v230
    v_fma_f32 v134, v134, v223, v231
    v_mul_f32 v0, v106, v106
    v_mul_f32 v1, v110, v110
    v_mul_f32 v2, v114, v114
    v_mul_f32 v3, v118, v118
    v_mul_f32 v4, v122, v122
    v_mul_f32 v5, v126, v126
    v_mul_f32 v6, v130, v130
    v_mul_f32 v7, v134, v134
    v_fma_f32 v0, v0, s26, v211
    v_fma_f32 v1, v1, s26, v211
    v_fma_f32 v2, v2, s26, v211
    v_fma_f32 v3, v3, s26, v211
    v_fma_f32 v4, v4, s26, v211
    v_fma_f32 v5, v5, s26, v211
    v_fma_f32 v6, v6, s26, v211
    v_fma_f32 v7, v7, s26, v211
    v_mul_f32 v0, v0, v106
    v_mul_f32 v1, v1, v110
    v_mul_f32 v2, v2, v114
    v_mul_f32 v3, v3, v118
    v_mul_f32 v4, v4, v122
    v_mul_f32 v5, v5, v126
    v_mul_f32 v6, v6, v130
    v_mul_f32 v7, v7, v134
    v_exp_f32 v0, v0
    v_exp_f32 v1, v1
    v_exp_f32 v2, v2
    v_exp_f32 v3, v3
    v_exp_f32 v4, v4
    v_exp_f32 v5, v5
    v_exp_f32 v6, v6
    v_exp_f32 v7, v7
    v_add_f32 v0, 1.0, v0
    v_add_f32 v1, 1.0, v1
    v_add_f32 v2, 1.0, v2
    v_add_f32 v3, 1.0, v3
    v_add_f32 v4, 1.0, v4
    v_add_f32 v5, 1.0, v5
    v_add_f32 v6, 1.0, v6
    v_add_f32 v7, 1.0, v7
    v_rcp_f32 v0, v0
    v_rcp_f32 v1, v1
    v_rcp_f32 v2, v2
    v_rcp_f32 v3, v3
    v_rcp_f32 v4, v4
    v_rcp_f32 v5, v5
    v_rcp_f32 v6, v6
    v_rcp_f32 v7, v7
    v_mul_f32 v0, v0, v106
    v_mul_f32 v1, v1, v110
    v_mul_f32 v2, v2, v114
    v_mul_f32 v3, v3, v118
    v_mul_f32 v4, v4, v122
    v_mul_f32 v5, v5, v126
    v_mul_f32 v6, v6, v130
    v_mul_f32 v7, v7, v134
    v_cvt_pk_bf16_f32 v24, v0, v1
    v_cvt_pk_bf16_f32 v25, v2, v3
    v_cvt_pk_bf16_f32 v26, v4, v5
    v_cvt_pk_bf16_f32 v27, v6, v7
    v_add_u32 v212, 2048, v210
    buffer_store_dwordx4 v[24:27], v212, s[32:35], 0 offen sc1
    v_fma_f32 v107, v107, v216, v224
    v_fma_f32 v111, v111, v217, v225
    v_fma_f32 v115, v115, v218, v226
    v_fma_f32 v119, v119, v219, v227
    v_fma_f32 v123, v123, v220, v228
    v_fma_f32 v127, v127, v221, v229
    v_fma_f32 v131, v131, v222, v230
    v_fma_f32 v135, v135, v223, v231
    v_mul_f32 v0, v107, v107
    v_mul_f32 v1, v111, v111
    v_mul_f32 v2, v115, v115
    v_mul_f32 v3, v119, v119
    v_mul_f32 v4, v123, v123
    v_mul_f32 v5, v127, v127
    v_mul_f32 v6, v131, v131
    v_mul_f32 v7, v135, v135
    v_fma_f32 v0, v0, s26, v211
    v_fma_f32 v1, v1, s26, v211
    v_fma_f32 v2, v2, s26, v211
    v_fma_f32 v3, v3, s26, v211
    v_fma_f32 v4, v4, s26, v211
    v_fma_f32 v5, v5, s26, v211
    v_fma_f32 v6, v6, s26, v211
    v_fma_f32 v7, v7, s26, v211
    v_mul_f32 v0, v0, v107
    v_mul_f32 v1, v1, v111
    v_mul_f32 v2, v2, v115
    v_mul_f32 v3, v3, v119
    v_mul_f32 v4, v4, v123
    v_mul_f32 v5, v5, v127
    v_mul_f32 v6, v6, v131
    v_mul_f32 v7, v7, v135
    v_exp_f32 v0, v0
    v_exp_f32 v1, v1
    v_exp_f32 v2, v2
    v_exp_f32 v3, v3
    v_exp_f32 v4, v4
    v_exp_f32 v5, v5
    v_exp_f32 v6, v6
    v_exp_f32 v7, v7
    v_add_f32 v0, 1.0, v0
    v_add_f32 v1, 1.0, v1
    v_add_f32 v2, 1.0, v2
    v_add_f32 v3, 1.0, v3
    v_add_f32 v4, 1.0, v4
    v_add_f32 v5, 1.0, v5
    v_add_f32 v6, 1.0, v6
    v_add_f32 v7, 1.0, v7
    v_rcp_f32 v0, v0
    v_rcp_f32 v1, v1
    v_rcp_f32 v2, v2
    v_rcp_f32 v3, v3
    v_rcp_f32 v4, v4
    v_rcp_f32 v5, v5
    v_rcp_f32 v6, v6
    v_rcp_f32 v7, v7
    v_mul_f32 v0, v0, v107
    v_mul_f32 v1, v1, v111
    v_mul_f32 v2, v2, v115
    v_mul_f32 v3, v3, v119
    v_mul_f32 v4, v4, v123
    v_mul_f32 v5, v5, v127
    v_mul_f32 v6, v6, v131
    v_mul_f32 v7, v7, v135
    v_cvt_pk_bf16_f32 v28, v0, v1
    v_cvt_pk_bf16_f32 v29, v2, v3
    v_cvt_pk_bf16_f32 v30, v4, v5
    v_cvt_pk_bf16_f32 v31, v6, v7
    v_add_u32 v212, 3072, v210
    buffer_store_dwordx4 v[28:31], v212, s[32:35], 0 offen sc1
    v_fma_f32 v136, v136, v216, v224
    v_fma_f32 v140, v140, v217, v225
    v_fma_f32 v144, v144, v218, v226
    v_fma_f32 v148, v148, v219, v227
    v_fma_f32 v152, v152, v220, v228
    v_fma_f32 v156, v156, v221, v229
    v_fma_f32 v160, v160, v222, v230
    v_fma_f32 v164, v164, v223, v231
    v_mul_f32 v0, v136, v136
    v_mul_f32 v1, v140, v140
    v_mul_f32 v2, v144, v144
    v_mul_f32 v3, v148, v148
    v_mul_f32 v4, v152, v152
    v_mul_f32 v5, v156, v156
    v_mul_f32 v6, v160, v160
    v_mul_f32 v7, v164, v164
    v_fma_f32 v0, v0, s26, v211
    v_fma_f32 v1, v1, s26, v211
    v_fma_f32 v2, v2, s26, v211
    v_fma_f32 v3, v3, s26, v211
    v_fma_f32 v4, v4, s26, v211
    v_fma_f32 v5, v5, s26, v211
    v_fma_f32 v6, v6, s26, v211
    v_fma_f32 v7, v7, s26, v211
    v_mul_f32 v0, v0, v136
    v_mul_f32 v1, v1, v140
    v_mul_f32 v2, v2, v144
    v_mul_f32 v3, v3, v148
    v_mul_f32 v4, v4, v152
    v_mul_f32 v5, v5, v156
    v_mul_f32 v6, v6, v160
    v_mul_f32 v7, v7, v164
    v_exp_f32 v0, v0
    v_exp_f32 v1, v1
    v_exp_f32 v2, v2
    v_exp_f32 v3, v3
    v_exp_f32 v4, v4
    v_exp_f32 v5, v5
    v_exp_f32 v6, v6
    v_exp_f32 v7, v7
    v_add_f32 v0, 1.0, v0
    v_add_f32 v1, 1.0, v1
    v_add_f32 v2, 1.0, v2
    v_add_f32 v3, 1.0, v3
    v_add_f32 v4, 1.0, v4
    v_add_f32 v5, 1.0, v5
    v_add_f32 v6, 1.0, v6
    v_add_f32 v7, 1.0, v7
    v_rcp_f32 v0, v0
    v_rcp_f32 v1, v1
    v_rcp_f32 v2, v2
    v_rcp_f32 v3, v3
    v_rcp_f32 v4, v4
    v_rcp_f32 v5, v5
    v_rcp_f32 v6, v6
    v_rcp_f32 v7, v7
    v_mul_f32 v0, v0, v136
    v_mul_f32 v1, v1, v140
    v_mul_f32 v2, v2, v144
    v_mul_f32 v3, v3, v148
    v_mul_f32 v4, v4, v152
    v_mul_f32 v5, v5, v156
    v_mul_f32 v6, v6, v160
    v_mul_f32 v7, v7, v164
    v_cvt_pk_bf16_f32 v32, v0, v1
    v_cvt_pk_bf16_f32 v33, v2, v3
    v_cvt_pk_bf16_f32 v34, v4, v5
    v_cvt_pk_bf16_f32 v35, v6, v7
    v_add_u32 v212, 16384, v210
    buffer_store_dwordx4 v[32:35], v212, s[32:35], 0 offen sc1
    v_fma_f32 v137, v137, v216, v224
    v_fma_f32 v141, v141, v217, v225
    v_fma_f32 v145, v145, v218, v226
    v_fma_f32 v149, v149, v219, v227
    v_fma_f32 v153, v153, v220, v228
    v_fma_f32 v157, v157, v221, v229
    v_fma_f32 v161, v161, v222, v230
    v_fma_f32 v165, v165, v223, v231
    v_mul_f32 v0, v137, v137
    v_mul_f32 v1, v141, v141
    v_mul_f32 v2, v145, v145
    v_mul_f32 v3, v149, v149
    v_mul_f32 v4, v153, v153
    v_mul_f32 v5, v157, v157
    v_mul_f32 v6, v161, v161
    v_mul_f32 v7, v165, v165
    v_fma_f32 v0, v0, s26, v211
    v_fma_f32 v1, v1, s26, v211
    v_fma_f32 v2, v2, s26, v211
    v_fma_f32 v3, v3, s26, v211
    v_fma_f32 v4, v4, s26, v211
    v_fma_f32 v5, v5, s26, v211
    v_fma_f32 v6, v6, s26, v211
    v_fma_f32 v7, v7, s26, v211
    v_mul_f32 v0, v0, v137
    v_mul_f32 v1, v1, v141
    v_mul_f32 v2, v2, v145
    v_mul_f32 v3, v3, v149
    v_mul_f32 v4, v4, v153
    v_mul_f32 v5, v5, v157
    v_mul_f32 v6, v6, v161
    v_mul_f32 v7, v7, v165
    v_exp_f32 v0, v0
    v_exp_f32 v1, v1
    v_exp_f32 v2, v2
    v_exp_f32 v3, v3
    v_exp_f32 v4, v4
    v_exp_f32 v5, v5
    v_exp_f32 v6, v6
    v_exp_f32 v7, v7
    v_add_f32 v0, 1.0, v0
    v_add_f32 v1, 1.0, v1
    v_add_f32 v2, 1.0, v2
    v_add_f32 v3, 1.0, v3
    v_add_f32 v4, 1.0, v4
    v_add_f32 v5, 1.0, v5
    v_add_f32 v6, 1.0, v6
    v_add_f32 v7, 1.0, v7
    v_rcp_f32 v0, v0
    v_rcp_f32 v1, v1
    v_rcp_f32 v2, v2
    v_rcp_f32 v3, v3
    v_rcp_f32 v4, v4
    v_rcp_f32 v5, v5
    v_rcp_f32 v6, v6
    v_rcp_f32 v7, v7
    v_mul_f32 v0, v0, v137
    v_mul_f32 v1, v1, v141
    v_mul_f32 v2, v2, v145
    v_mul_f32 v3, v3, v149
    v_mul_f32 v4, v4, v153
    v_mul_f32 v5, v5, v157
    v_mul_f32 v6, v6, v161
    v_mul_f32 v7, v7, v165
    v_cvt_pk_bf16_f32 v36, v0, v1
    v_cvt_pk_bf16_f32 v37, v2, v3
    v_cvt_pk_bf16_f32 v38, v4, v5
    v_cvt_pk_bf16_f32 v39, v6, v7
    v_add_u32 v212, 17408, v210
    buffer_store_dwordx4 v[36:39], v212, s[32:35], 0 offen sc1
    v_fma_f32 v138, v138, v216, v224
    v_fma_f32 v142, v142, v217, v225
    v_fma_f32 v146, v146, v218, v226
    v_fma_f32 v150, v150, v219, v227
    v_fma_f32 v154, v154, v220, v228
    v_fma_f32 v158, v158, v221, v229
    v_fma_f32 v162, v162, v222, v230
    v_fma_f32 v166, v166, v223, v231
    v_mul_f32 v0, v138, v138
    v_mul_f32 v1, v142, v142
    v_mul_f32 v2, v146, v146
    v_mul_f32 v3, v150, v150
    v_mul_f32 v4, v154, v154
    v_mul_f32 v5, v158, v158
    v_mul_f32 v6, v162, v162
    v_mul_f32 v7, v166, v166
    v_fma_f32 v0, v0, s26, v211
    v_fma_f32 v1, v1, s26, v211
    v_fma_f32 v2, v2, s26, v211
    v_fma_f32 v3, v3, s26, v211
    v_fma_f32 v4, v4, s26, v211
    v_fma_f32 v5, v5, s26, v211
    v_fma_f32 v6, v6, s26, v211
    v_fma_f32 v7, v7, s26, v211
    v_mul_f32 v0, v0, v138
    v_mul_f32 v1, v1, v142
    v_mul_f32 v2, v2, v146
    v_mul_f32 v3, v3, v150
    v_mul_f32 v4, v4, v154
    v_mul_f32 v5, v5, v158
    v_mul_f32 v6, v6, v162
    v_mul_f32 v7, v7, v166
    v_exp_f32 v0, v0
    v_exp_f32 v1, v1
    v_exp_f32 v2, v2
    v_exp_f32 v3, v3
    v_exp_f32 v4, v4
    v_exp_f32 v5, v5
    v_exp_f32 v6, v6
    v_exp_f32 v7, v7
    v_add_f32 v0, 1.0, v0
    v_add_f32 v1, 1.0, v1
    v_add_f32 v2, 1.0, v2
    v_add_f32 v3, 1.0, v3
    v_add_f32 v4, 1.0, v4
    v_add_f32 v5, 1.0, v5
    v_add_f32 v6, 1.0, v6
    v_add_f32 v7, 1.0, v7
    v_rcp_f32 v0, v0
    v_rcp_f32 v1, v1
    v_rcp_f32 v2, v2
    v_rcp_f32 v3, v3
    v_rcp_f32 v4, v4
    v_rcp_f32 v5, v5
    v_rcp_f32 v6, v6
    v_rcp_f32 v7, v7
    v_mul_f32 v0, v0, v138
    v_mul_f32 v1, v1, v142
    v_mul_f32 v2, v2, v146
    v_mul_f32 v3, v3, v150
    v_mul_f32 v4, v4, v154
    v_mul_f32 v5, v5, v158
    v_mul_f32 v6, v6, v162
    v_mul_f32 v7, v7, v166
    v_cvt_pk_bf16_f32 v40, v0, v1
    v_cvt_pk_bf16_f32 v41, v2, v3
    v_cvt_pk_bf16_f32 v42, v4, v5
    v_cvt_pk_bf16_f32 v43, v6, v7
    v_add_u32 v212, 18432, v210
    buffer_store_dwordx4 v[40:43], v212, s[32:35], 0 offen sc1
    v_fma_f32 v139, v139, v216, v224
    v_fma_f32 v143, v143, v217, v225
    v_fma_f32 v147, v147, v218, v226
    v_fma_f32 v151, v151, v219, v227
    v_fma_f32 v155, v155, v220, v228
    v_fma_f32 v159, v159, v221, v229
    v_fma_f32 v163, v163, v222, v230
    v_fma_f32 v167, v167, v223, v231
    v_mul_f32 v0, v139, v139
    v_mul_f32 v1, v143, v143
    v_mul_f32 v2, v147, v147
    v_mul_f32 v3, v151, v151
    v_mul_f32 v4, v155, v155
    v_mul_f32 v5, v159, v159
    v_mul_f32 v6, v163, v163
    v_mul_f32 v7, v167, v167
    v_fma_f32 v0, v0, s26, v211
    v_fma_f32 v1, v1, s26, v211
    v_fma_f32 v2, v2, s26, v211
    v_fma_f32 v3, v3, s26, v211
    v_fma_f32 v4, v4, s26, v211
    v_fma_f32 v5, v5, s26, v211
    v_fma_f32 v6, v6, s26, v211
    v_fma_f32 v7, v7, s26, v211
    v_mul_f32 v0, v0, v139
    v_mul_f32 v1, v1, v143
    v_mul_f32 v2, v2, v147
    v_mul_f32 v3, v3, v151
    v_mul_f32 v4, v4, v155
    v_mul_f32 v5, v5, v159
    v_mul_f32 v6, v6, v163
    v_mul_f32 v7, v7, v167
    v_exp_f32 v0, v0
    v_exp_f32 v1, v1
    v_exp_f32 v2, v2
    v_exp_f32 v3, v3
    v_exp_f32 v4, v4
    v_exp_f32 v5, v5
    v_exp_f32 v6, v6
    v_exp_f32 v7, v7
    v_add_f32 v0, 1.0, v0
    v_add_f32 v1, 1.0, v1
    v_add_f32 v2, 1.0, v2
    v_add_f32 v3, 1.0, v3
    v_add_f32 v4, 1.0, v4
    v_add_f32 v5, 1.0, v5
    v_add_f32 v6, 1.0, v6
    v_add_f32 v7, 1.0, v7
    v_rcp_f32 v0, v0
    v_rcp_f32 v1, v1
    v_rcp_f32 v2, v2
    v_rcp_f32 v3, v3
    v_rcp_f32 v4, v4
    v_rcp_f32 v5, v5
    v_rcp_f32 v6, v6
    v_rcp_f32 v7, v7
    v_mul_f32 v0, v0, v139
    v_mul_f32 v1, v1, v143
    v_mul_f32 v2, v2, v147
    v_mul_f32 v3, v3, v151
    v_mul_f32 v4, v4, v155
    v_mul_f32 v5, v5, v159
    v_mul_f32 v6, v6, v163
    v_mul_f32 v7, v7, v167
    v_cvt_pk_bf16_f32 v44, v0, v1
    v_cvt_pk_bf16_f32 v45, v2, v3
    v_cvt_pk_bf16_f32 v46, v4, v5
    v_cvt_pk_bf16_f32 v47, v6, v7
    v_add_u32 v212, 19456, v210
    buffer_store_dwordx4 v[44:47], v212, s[32:35], 0 offen sc1
    v_fma_f32 v168, v168, v216, v224
    v_fma_f32 v172, v172, v217, v225
    v_fma_f32 v176, v176, v218, v226
    v_fma_f32 v180, v180, v219, v227
    v_fma_f32 v184, v184, v220, v228
    v_fma_f32 v188, v188, v221, v229
    v_fma_f32 v192, v192, v222, v230
    v_fma_f32 v196, v196, v223, v231
    v_mul_f32 v0, v168, v168
    v_mul_f32 v1, v172, v172
    v_mul_f32 v2, v176, v176
    v_mul_f32 v3, v180, v180
    v_mul_f32 v4, v184, v184
    v_mul_f32 v5, v188, v188
    v_mul_f32 v6, v192, v192
    v_mul_f32 v7, v196, v196
    v_fma_f32 v0, v0, s26, v211
    v_fma_f32 v1, v1, s26, v211
    v_fma_f32 v2, v2, s26, v211
    v_fma_f32 v3, v3, s26, v211
    v_fma_f32 v4, v4, s26, v211
    v_fma_f32 v5, v5, s26, v211
    v_fma_f32 v6, v6, s26, v211
    v_fma_f32 v7, v7, s26, v211
    v_mul_f32 v0, v0, v168
    v_mul_f32 v1, v1, v172
    v_mul_f32 v2, v2, v176
    v_mul_f32 v3, v3, v180
    v_mul_f32 v4, v4, v184
    v_mul_f32 v5, v5, v188
    v_mul_f32 v6, v6, v192
    v_mul_f32 v7, v7, v196
    v_exp_f32 v0, v0
    v_exp_f32 v1, v1
    v_exp_f32 v2, v2
    v_exp_f32 v3, v3
    v_exp_f32 v4, v4
    v_exp_f32 v5, v5
    v_exp_f32 v6, v6
    v_exp_f32 v7, v7
    v_add_f32 v0, 1.0, v0
    v_add_f32 v1, 1.0, v1
    v_add_f32 v2, 1.0, v2
    v_add_f32 v3, 1.0, v3
    v_add_f32 v4, 1.0, v4
    v_add_f32 v5, 1.0, v5
    v_add_f32 v6, 1.0, v6
    v_add_f32 v7, 1.0, v7
    v_rcp_f32 v0, v0
    v_rcp_f32 v1, v1
    v_rcp_f32 v2, v2
    v_rcp_f32 v3, v3
    v_rcp_f32 v4, v4
    v_rcp_f32 v5, v5
    v_rcp_f32 v6, v6
    v_rcp_f32 v7, v7
    v_mul_f32 v0, v0, v168
    v_mul_f32 v1, v1, v172
    v_mul_f32 v2, v2, v176
    v_mul_f32 v3, v3, v180
    v_mul_f32 v4, v4, v184
    v_mul_f32 v5, v5, v188
    v_mul_f32 v6, v6, v192
    v_mul_f32 v7, v7, v196
    v_cvt_pk_bf16_f32 v16, v0, v1
    v_cvt_pk_bf16_f32 v17, v2, v3
    v_cvt_pk_bf16_f32 v18, v4, v5
    v_cvt_pk_bf16_f32 v19, v6, v7
    v_add_u32 v212, 32768, v210
    buffer_store_dwordx4 v[16:19], v212, s[32:35], 0 offen sc1
    v_fma_f32 v169, v169, v216, v224
    v_fma_f32 v173, v173, v217, v225
    v_fma_f32 v177, v177, v218, v226
    v_fma_f32 v181, v181, v219, v227
    v_fma_f32 v185, v185, v220, v228
    v_fma_f32 v189, v189, v221, v229
    v_fma_f32 v193, v193, v222, v230
    v_fma_f32 v197, v197, v223, v231
    v_mul_f32 v0, v169, v169
    v_mul_f32 v1, v173, v173
    v_mul_f32 v2, v177, v177
    v_mul_f32 v3, v181, v181
    v_mul_f32 v4, v185, v185
    v_mul_f32 v5, v189, v189
    v_mul_f32 v6, v193, v193
    v_mul_f32 v7, v197, v197
    v_fma_f32 v0, v0, s26, v211
    v_fma_f32 v1, v1, s26, v211
    v_fma_f32 v2, v2, s26, v211
    v_fma_f32 v3, v3, s26, v211
    v_fma_f32 v4, v4, s26, v211
    v_fma_f32 v5, v5, s26, v211
    v_fma_f32 v6, v6, s26, v211
    v_fma_f32 v7, v7, s26, v211
    v_mul_f32 v0, v0, v169
    v_mul_f32 v1, v1, v173
    v_mul_f32 v2, v2, v177
    v_mul_f32 v3, v3, v181
    v_mul_f32 v4, v4, v185
    v_mul_f32 v5, v5, v189
    v_mul_f32 v6, v6, v193
    v_mul_f32 v7, v7, v197
    v_exp_f32 v0, v0
    v_exp_f32 v1, v1
    v_exp_f32 v2, v2
    v_exp_f32 v3, v3
    v_exp_f32 v4, v4
    v_exp_f32 v5, v5
    v_exp_f32 v6, v6
    v_exp_f32 v7, v7
    v_add_f32 v0, 1.0, v0
    v_add_f32 v1, 1.0, v1
    v_add_f32 v2, 1.0, v2
    v_add_f32 v3, 1.0, v3
    v_add_f32 v4, 1.0, v4
    v_add_f32 v5, 1.0, v5
    v_add_f32 v6, 1.0, v6
    v_add_f32 v7, 1.0, v7
    v_rcp_f32 v0, v0
    v_rcp_f32 v1, v1
    v_rcp_f32 v2, v2
    v_rcp_f32 v3, v3
    v_rcp_f32 v4, v4
    v_rcp_f32 v5, v5
    v_rcp_f32 v6, v6
    v_rcp_f32 v7, v7
    v_mul_f32 v0, v0, v169
    v_mul_f32 v1, v1, v173
    v_mul_f32 v2, v2, v177
    v_mul_f32 v3, v3, v181
    v_mul_f32 v4, v4, v185
    v_mul_f32 v5, v5, v189
    v_mul_f32 v6, v6, v193
    v_mul_f32 v7, v7, v197
    v_cvt_pk_bf16_f32 v20, v0, v1
    v_cvt_pk_bf16_f32 v21, v2, v3
    v_cvt_pk_bf16_f32 v22, v4, v5
    v_cvt_pk_bf16_f32 v23, v6, v7
    v_add_u32 v212, 33792, v210
    buffer_store_dwordx4 v[20:23], v212, s[32:35], 0 offen sc1
    v_fma_f32 v170, v170, v216, v224
    v_fma_f32 v174, v174, v217, v225
    v_fma_f32 v178, v178, v218, v226
    v_fma_f32 v182, v182, v219, v227
    v_fma_f32 v186, v186, v220, v228
    v_fma_f32 v190, v190, v221, v229
    v_fma_f32 v194, v194, v222, v230
    v_fma_f32 v198, v198, v223, v231
    v_mul_f32 v0, v170, v170
    v_mul_f32 v1, v174, v174
    v_mul_f32 v2, v178, v178
    v_mul_f32 v3, v182, v182
    v_mul_f32 v4, v186, v186
    v_mul_f32 v5, v190, v190
    v_mul_f32 v6, v194, v194
    v_mul_f32 v7, v198, v198
    v_fma_f32 v0, v0, s26, v211
    v_fma_f32 v1, v1, s26, v211
    v_fma_f32 v2, v2, s26, v211
    v_fma_f32 v3, v3, s26, v211
    v_fma_f32 v4, v4, s26, v211
    v_fma_f32 v5, v5, s26, v211
    v_fma_f32 v6, v6, s26, v211
    v_fma_f32 v7, v7, s26, v211
    v_mul_f32 v0, v0, v170
    v_mul_f32 v1, v1, v174
    v_mul_f32 v2, v2, v178
    v_mul_f32 v3, v3, v182
    v_mul_f32 v4, v4, v186
    v_mul_f32 v5, v5, v190
    v_mul_f32 v6, v6, v194
    v_mul_f32 v7, v7, v198
    v_exp_f32 v0, v0
    v_exp_f32 v1, v1
    v_exp_f32 v2, v2
    v_exp_f32 v3, v3
    v_exp_f32 v4, v4
    v_exp_f32 v5, v5
    v_exp_f32 v6, v6
    v_exp_f32 v7, v7
    v_add_f32 v0, 1.0, v0
    v_add_f32 v1, 1.0, v1
    v_add_f32 v2, 1.0, v2
    v_add_f32 v3, 1.0, v3
    v_add_f32 v4, 1.0, v4
    v_add_f32 v5, 1.0, v5
    v_add_f32 v6, 1.0, v6
    v_add_f32 v7, 1.0, v7
    v_rcp_f32 v0, v0
    v_rcp_f32 v1, v1
    v_rcp_f32 v2, v2
    v_rcp_f32 v3, v3
    v_rcp_f32 v4, v4
    v_rcp_f32 v5, v5
    v_rcp_f32 v6, v6
    v_rcp_f32 v7, v7
    v_mul_f32 v0, v0, v170
    v_mul_f32 v1, v1, v174
    v_mul_f32 v2, v2, v178
    v_mul_f32 v3, v3, v182
    v_mul_f32 v4, v4, v186
    v_mul_f32 v5, v5, v190
    v_mul_f32 v6, v6, v194
    v_mul_f32 v7, v7, v198
    v_cvt_pk_bf16_f32 v24, v0, v1
    v_cvt_pk_bf16_f32 v25, v2, v3
    v_cvt_pk_bf16_f32 v26, v4, v5
    v_cvt_pk_bf16_f32 v27, v6, v7
    v_add_u32 v212, 34816, v210
    buffer_store_dwordx4 v[24:27], v212, s[32:35], 0 offen sc1
    v_fma_f32 v171, v171, v216, v224
    v_fma_f32 v175, v175, v217, v225
    v_fma_f32 v179, v179, v218, v226
    v_fma_f32 v183, v183, v219, v227
    v_fma_f32 v187, v187, v220, v228
    v_fma_f32 v191, v191, v221, v229
    v_fma_f32 v195, v195, v222, v230
    v_fma_f32 v199, v199, v223, v231
    v_mul_f32 v0, v171, v171
    v_mul_f32 v1, v175, v175
    v_mul_f32 v2, v179, v179
    v_mul_f32 v3, v183, v183
    v_mul_f32 v4, v187, v187
    v_mul_f32 v5, v191, v191
    v_mul_f32 v6, v195, v195
    v_mul_f32 v7, v199, v199
    v_fma_f32 v0, v0, s26, v211
    v_fma_f32 v1, v1, s26, v211
    v_fma_f32 v2, v2, s26, v211
    v_fma_f32 v3, v3, s26, v211
    v_fma_f32 v4, v4, s26, v211
    v_fma_f32 v5, v5, s26, v211
    v_fma_f32 v6, v6, s26, v211
    v_fma_f32 v7, v7, s26, v211
    v_mul_f32 v0, v0, v171
    v_mul_f32 v1, v1, v175
    v_mul_f32 v2, v2, v179
    v_mul_f32 v3, v3, v183
    v_mul_f32 v4, v4, v187
    v_mul_f32 v5, v5, v191
    v_mul_f32 v6, v6, v195
    v_mul_f32 v7, v7, v199
    v_exp_f32 v0, v0
    v_exp_f32 v1, v1
    v_exp_f32 v2, v2
    v_exp_f32 v3, v3
    v_exp_f32 v4, v4
    v_exp_f32 v5, v5
    v_exp_f32 v6, v6
    v_exp_f32 v7, v7
    v_add_f32 v0, 1.0, v0
    v_add_f32 v1, 1.0, v1
    v_add_f32 v2, 1.0, v2
    v_add_f32 v3, 1.0, v3
    v_add_f32 v4, 1.0, v4
    v_add_f32 v5, 1.0, v5
    v_add_f32 v6, 1.0, v6
    v_add_f32 v7, 1.0, v7
    v_rcp_f32 v0, v0
    v_rcp_f32 v1, v1
    v_rcp_f32 v2, v2
    v_rcp_f32 v3, v3
    v_rcp_f32 v4, v4
    v_rcp_f32 v5, v5
    v_rcp_f32 v6, v6
    v_rcp_f32 v7, v7
    v_mul_f32 v0, v0, v171
    v_mul_f32 v1, v1, v175
    v_mul_f32 v2, v2, v179
    v_mul_f32 v3, v3, v183
    v_mul_f32 v4, v4, v187
    v_mul_f32 v5, v5, v191
    v_mul_f32 v6, v6, v195
    v_mul_f32 v7, v7, v199
    v_cvt_pk_bf16_f32 v28, v0, v1
    v_cvt_pk_bf16_f32 v29, v2, v3
    v_cvt_pk_bf16_f32 v30, v4, v5
    v_cvt_pk_bf16_f32 v31, v6, v7
    v_add_u32 v212, 35840, v210
    buffer_store_dwordx4 v[28:31], v212, s[32:35], 0 offen sc1
L_k45_end:
    s_endpgm
.section .rodata,"a"
.p2align 6
.amdhsa_kernel xform_kernel
  .amdhsa_next_free_vgpr 232
  .amdhsa_next_free_sgpr 96
  .amdhsa_accum_offset 232
  .amdhsa_group_segment_fixed_size 0
  .amdhsa_kernarg_size 56
  .amdhsa_user_sgpr_count 2
  .amdhsa_user_sgpr_kernarg_segment_ptr 1
  .amdhsa_system_sgpr_workgroup_id_x 1
  .amdhsa_float_denorm_mode_32 3
.end_amdhsa_kernel

.p2align 6
.amdhsa_kernel gemm_kernel
  .amdhsa_next_free_vgpr 256
  .amdhsa_next_free_sgpr 96
  .amdhsa_accum_offset 256
  .amdhsa_group_segment_fixed_size 0
  .amdhsa_kernarg_size 56
  .amdhsa_user_sgpr_count 2
  .amdhsa_user_sgpr_kernarg_segment_ptr 1
  .amdhsa_system_sgpr_workgroup_id_x 1
  .amdhsa_float_denorm_mode_32 3
.end_amdhsa_kernel

.p2align 6
.amdhsa_kernel final_kernel
  .amdhsa_next_free_vgpr 240
  .amdhsa_next_free_sgpr 96
  .amdhsa_accum_offset 240
  .amdhsa_group_segment_fixed_size 0
  .amdhsa_kernarg_size 56
  .amdhsa_user_sgpr_count 2
  .amdhsa_user_sgpr_kernarg_segment_ptr 1
  .amdhsa_system_sgpr_workgroup_id_x 1
  .amdhsa_float_denorm_mode_32 3
.end_amdhsa_kernel
```

```asm
; @launch kernel=xform_kernel grid=(256,1,1) block=(256,1,1) lds=12352
; @launch kernel=gemm_kernel grid=(256,1,1) block=(512,1,1) lds=155648
; @launch kernel=final_kernel grid=(224,1,1) block=(512,1,1) lds=82944
.amdgcn_target "amdgcn-amd-amdhsa--gfx950"
.text
.globl xform_kernel
.p2align 8
.type xform_kernel,@function
xform_kernel:
    s_cmp_ge_u32 s2, 256
    s_cbranch_scc1 L_k12_end
    s_load_dwordx4 s[4:7], s[0:1], 0
    s_load_dwordx4 s[36:39], s[0:1], 40
    v_and_b32 v208, 63, v0
    v_lshrrev_b32 v213, 6, v0
    v_and_b32 v209, 15, v208
    v_readfirstlane_b32 s10, v213
    v_lshrrev_b32 v210, 4, v208
    v_lshlrev_b32 v223, 4, v208
    v_mov_b32 v222, 0
    s_mov_b32 s30, 0x05040100
    s_mov_b32 s31, 0x07060302
    s_mov_b32 s32, 0x01000100
    s_mov_b32 s33, 0x03020302
    s_mov_b32 s40, s2
    s_add_u32 s42, s2, 256
    s_mov_b32 s41, 0
    s_mov_b32 s43, 0
    v_lshlrev_b32 v224, 14, v210
    v_lshl_add_u32 v224, v209, 4, v224
    v_lshlrev_b32 v225, 22, v210
    v_lshrrev_b32 v213, 2, v209
    v_lshl_add_u32 v225, v213, 6, v225
    v_and_b32 v213, 1, v209
    v_lshl_add_u32 v225, v213, 5, v225
    v_bfe_u32 v213, v209, 1, 1
    v_lshl_add_u32 v225, v213, 3, v225
    v_lshrrev_b32 v213, 2, v209
    s_mov_b32 s24, 688128
    v_mul_u32_u24 v226, s24, v213
    s_mov_b32 s24, 43008
    v_mad_u32_u24 v226, v210, s24, v226
    s_mov_b32 s24, 32768
    v_mul_u32_u24 v227, s24, v210
    s_waitcnt lgkmcnt(0)
    s_mov_b32 s16, s38
    s_and_b32 s17, s39, 0xffff
    s_mov_b32 s18, 268435456
    s_mov_b32 s19, 0x00020000
    s_mov_b32 s44, s36
    s_and_b32 s45, s37, 0xffff
    s_mov_b32 s46, 256
    s_mov_b32 s47, 0x00020000
    s_cmp_ge_u32 s40, 1696
    s_cbranch_scc1 L_ld_done0
    s_cmp_ge_u32 s40, 672
    s_cbranch_scc1 L_ld_w0
    s_cmp_ge_u32 s40, 336
    s_cselect_b32 s11, 1, 0
    s_mul_i32 s12, s11, 336
    s_sub_u32 s12, s40, s12
    s_and_b32 s13, s12, 7
    s_lshr_b32 s14, s12, 3
    s_lshl_b32 s14, s14, 2
    s_add_u32 s14, s14, s10
    s_mul_i32 s15, s11, 16384000
    s_add_u32 s34, s4, s15
    s_addc_u32 s35, s5, 0
    s_mov_b32 s20, s34
    s_and_b32 s21, s35, 0xffff
    s_mov_b32 s22, 16384000
    s_mov_b32 s23, 0x00020000
    s_mul_i32 s15, s14, 98304
    s_lshl_b32 s24, s13, 8
    s_add_u32 s15, s15, s24
    s_add_u32 s25, s15, 0
    buffer_load_dwordx4 v[0:3], v224, s[20:23], s25 offen
    s_add_u32 s25, s15, 2048
    buffer_load_dwordx4 v[4:7], v224, s[20:23], s25 offen
    s_add_u32 s25, s15, 4096
    buffer_load_dwordx4 v[8:11], v224, s[20:23], s25 offen
    s_add_u32 s25, s15, 6144
    buffer_load_dwordx4 v[12:15], v224, s[20:23], s25 offen
    s_add_u32 s25, s15, 8192
    buffer_load_dwordx4 v[16:19], v224, s[20:23], s25 offen
    s_add_u32 s25, s15, 10240
    buffer_load_dwordx4 v[20:23], v224, s[20:23], s25 offen
    s_add_u32 s25, s15, 12288
    buffer_load_dwordx4 v[24:27], v224, s[20:23], s25 offen
    s_add_u32 s25, s15, 14336
    buffer_load_dwordx4 v[28:31], v224, s[20:23], s25 offen
    s_add_u32 s25, s15, 65536
    buffer_load_dwordx4 v[32:35], v224, s[20:23], s25 offen
    s_add_u32 s25, s15, 67584
    buffer_load_dwordx4 v[36:39], v224, s[20:23], s25 offen
    s_add_u32 s25, s15, 69632
    buffer_load_dwordx4 v[40:43], v224, s[20:23], s25 offen
    s_add_u32 s25, s15, 71680
    buffer_load_dwordx4 v[44:47], v224, s[20:23], s25 offen
    s_add_u32 s25, s15, 73728
    buffer_load_dwordx4 v[48:51], v224, s[20:23], s25 offen
    s_add_u32 s25, s15, 75776
    buffer_load_dwordx4 v[52:55], v224, s[20:23], s25 offen
    s_add_u32 s25, s15, 77824
    buffer_load_dwordx4 v[56:59], v224, s[20:23], s25 offen
    s_add_u32 s25, s15, 79872
    buffer_load_dwordx4 v[60:63], v224, s[20:23], s25 offen
    s_branch L_ld_done0
L_ld_w0:
    s_sub_u32 s12, s40, 672
    s_and_b32 s13, s12, 3
    s_lshr_b32 s14, s12, 2
    s_lshl_b32 s14, s14, 2
    s_add_u32 s14, s14, s10
    s_mov_b32 s20, s6
    s_and_b32 s21, s7, 0xffff
    s_mov_b32 s22, 16252928
    s_mov_b32 s23, 0x00020000
    s_lshl_b32 s15, s14, 10
    s_lshl_b32 s24, s13, 8
    s_add_u32 s15, s15, s24
    s_add_u32 s25, s15, 0
    buffer_load_dwordx2 v[0:1], v225, s[20:23], s25 offen
    buffer_load_dwordx2 v[2:3], v225, s[20:23], s25 offen offset:16
    s_add_u32 s25, s15, 1048576
    buffer_load_dwordx2 v[4:5], v225, s[20:23], s25 offen
    buffer_load_dwordx2 v[6:7], v225, s[20:23], s25 offen offset:16
    s_add_u32 s25, s15, 2097152
    buffer_load_dwordx2 v[8:9], v225, s[20:23], s25 offen
    buffer_load_dwordx2 v[10:11], v225, s[20:23], s25 offen offset:16
    s_add_u32 s25, s15, 3145728
    buffer_load_dwordx2 v[12:13], v225, s[20:23], s25 offen
    buffer_load_dwordx2 v[14:15], v225, s[20:23], s25 offen offset:16
L_ld_done0:
    v_lshrrev_b32 v213, 2, v209
    v_lshlrev_b32 v213, 1, v213
    v_bfe_u32 v214, v209, 1, 1
    v_add_u32 v213, v213, v214
    s_lshl_b32 s24, s10, 3
    v_add_u32 v213, s24, v213
    v_lshl_add_u32 v213, v213, 1, 1
    v_and_b32 v214, 1, v209
    v_lshlrev_b32 v214, 5, v214
    v_lshlrev_b32 v215, 3, v210
    v_mad_u32_u24 v160, v213, v215, v214
    v_add_u32 v161, v160, v213
    v_add_u32 v162, v161, v213
    v_add_u32 v163, v162, v213
    v_add_u32 v164, v163, v213
    v_add_u32 v165, v164, v213
    v_add_u32 v166, v165, v213
    v_add_u32 v167, v166, v213
    v_and_b32 v160, 127, v160
    v_cvt_f32_u32 v160, v160
    v_mul_f32 v160, 0x3c000000, v160
    v_cos_f32 v160, v160
    v_and_b32 v161, 127, v161
    v_cvt_f32_u32 v161, v161
    v_mul_f32 v161, 0x3c000000, v161
    v_cos_f32 v161, v161
    v_and_b32 v162, 127, v162
    v_cvt_f32_u32 v162, v162
    v_mul_f32 v162, 0x3c000000, v162
    v_cos_f32 v162, v162
    v_and_b32 v163, 127, v163
    v_cvt_f32_u32 v163, v163
    v_mul_f32 v163, 0x3c000000, v163
    v_cos_f32 v163, v163
    v_and_b32 v164, 127, v164
    v_cvt_f32_u32 v164, v164
    v_mul_f32 v164, 0x3c000000, v164
    v_cos_f32 v164, v164
    v_and_b32 v165, 127, v165
    v_cvt_f32_u32 v165, v165
    v_mul_f32 v165, 0x3c000000, v165
    v_cos_f32 v165, v165
    v_and_b32 v166, 127, v166
    v_cvt_f32_u32 v166, v166
    v_mul_f32 v166, 0x3c000000, v166
    v_cos_f32 v166, v166
    v_and_b32 v167, 127, v167
    v_cvt_f32_u32 v167, v167
    v_mul_f32 v167, 0x3c000000, v167
    v_cos_f32 v167, v167
    v_cvt_pk_bf16_f32 v176, v160, v161
    v_cvt_pk_bf16_f32 v177, v162, v163
    v_cvt_pk_bf16_f32 v178, v164, v165
    v_cvt_pk_bf16_f32 v179, v166, v167
    s_lshl_b32 s24, s10, 11
    v_add_u32 v216, s24, v223
    ds_write_b128 v216, v[176:179] offset:0
    v_lshlrev_b32 v215, 3, v210
    v_add_u32 v215, 32, v215
    v_mad_u32_u24 v160, v213, v215, v214
    v_add_u32 v161, v160, v213
    v_add_u32 v162, v161, v213
    v_add_u32 v163, v162, v213
    v_add_u32 v164, v163, v213
    v_add_u32 v165, v164, v213
    v_add_u32 v166, v165, v213
    v_add_u32 v167, v166, v213
    v_and_b32 v160, 127, v160
    v_cvt_f32_u32 v160, v160
    v_mul_f32 v160, 0x3c000000, v160
    v_cos_f32 v160, v160
    v_and_b32 v161, 127, v161
    v_cvt_f32_u32 v161, v161
    v_mul_f32 v161, 0x3c000000, v161
    v_cos_f32 v161, v161
    v_and_b32 v162, 127, v162
    v_cvt_f32_u32 v162, v162
    v_mul_f32 v162, 0x3c000000, v162
    v_cos_f32 v162, v162
    v_and_b32 v163, 127, v163
    v_cvt_f32_u32 v163, v163
    v_mul_f32 v163, 0x3c000000, v163
    v_cos_f32 v163, v163
    v_and_b32 v164, 127, v164
    v_cvt_f32_u32 v164, v164
    v_mul_f32 v164, 0x3c000000, v164
    v_cos_f32 v164, v164
    v_and_b32 v165, 127, v165
    v_cvt_f32_u32 v165, v165
    v_mul_f32 v165, 0x3c000000, v165
    v_cos_f32 v165, v165
    v_and_b32 v166, 127, v166
    v_cvt_f32_u32 v166, v166
    v_mul_f32 v166, 0x3c000000, v166
    v_cos_f32 v166, v166
    v_and_b32 v167, 127, v167
    v_cvt_f32_u32 v167, v167
    v_mul_f32 v167, 0x3c000000, v167
    v_cos_f32 v167, v167
    v_cvt_pk_bf16_f32 v176, v160, v161
    v_cvt_pk_bf16_f32 v177, v162, v163
    v_cvt_pk_bf16_f32 v178, v164, v165
    v_cvt_pk_bf16_f32 v179, v166, v167
    s_lshl_b32 s24, s10, 11
    v_add_u32 v216, s24, v223
    ds_write_b128 v216, v[176:179] offset:1024
    v_lshlrev_b32 v215, 2, v210
    v_mad_u32_u24 v160, v213, v215, v214
    v_add_u32 v161, v160, v213
    v_add_u32 v162, v161, v213
    v_add_u32 v163, v162, v213
    v_and_b32 v160, 127, v160
    v_cvt_f32_u32 v160, v160
    v_mul_f32 v160, 0x3c000000, v160
    v_cos_f32 v160, v160
    v_and_b32 v161, 127, v161
    v_cvt_f32_u32 v161, v161
    v_mul_f32 v161, 0x3c000000, v161
    v_cos_f32 v161, v161
    v_and_b32 v162, 127, v162
    v_cvt_f32_u32 v162, v162
    v_mul_f32 v162, 0x3c000000, v162
    v_cos_f32 v162, v162
    v_and_b32 v163, 127, v163
    v_cvt_f32_u32 v163, v163
    v_mul_f32 v163, 0x3c000000, v163
    v_cos_f32 v163, v163
    v_cvt_pk_bf16_f32 v180, v160, v160
    v_lshlrev_b32 v181, 16, v180
    v_sub_f32 v181, v160, v181
    v_cvt_pk_bf16_f32 v181, v181, v181
    v_perm_b32 v176, v181, v180, s30
    v_cvt_pk_bf16_f32 v180, v161, v161
    v_lshlrev_b32 v181, 16, v180
    v_sub_f32 v181, v161, v181
    v_cvt_pk_bf16_f32 v181, v181, v181
    v_perm_b32 v177, v181, v180, s30
    v_cvt_pk_bf16_f32 v180, v162, v162
    v_lshlrev_b32 v181, 16, v180
    v_sub_f32 v181, v162, v181
    v_cvt_pk_bf16_f32 v181, v181, v181
    v_perm_b32 v178, v181, v180, s30
    v_cvt_pk_bf16_f32 v180, v163, v163
    v_lshlrev_b32 v181, 16, v180
    v_sub_f32 v181, v163, v181
    v_cvt_pk_bf16_f32 v181, v181, v181
    v_perm_b32 v179, v181, v180, s30
    s_lshl_b32 s24, s10, 10
    v_add_u32 v216, s24, v223
    ds_write_b128 v216, v[176:179] offset:8192
    s_waitcnt lgkmcnt(0)
    s_barrier
L_k12_loop:
    s_cmp_lg_u32 s10, 0
    s_cbranch_scc1 L_nofetch0
    v_mov_b32 v221, 1
    s_mov_b64 exec, 1
    buffer_atomic_add v221, v222, s[44:47], 0 offen sc0 sc1
    s_mov_b64 exec, -1
L_nofetch0:
    s_cmp_ge_u32 s42, 1696
    s_cbranch_scc1 L_ld_done1
    s_cmp_ge_u32 s42, 672
    s_cbranch_scc1 L_ld_w1
    s_cmp_ge_u32 s42, 336
    s_cselect_b32 s11, 1, 0
    s_mul_i32 s12, s11, 336
    s_sub_u32 s12, s42, s12
    s_and_b32 s13, s12, 7
    s_lshr_b32 s14, s12, 3
    s_lshl_b32 s14, s14, 2
    s_add_u32 s14, s14, s10
    s_mul_i32 s15, s11, 16384000
    s_add_u32 s34, s4, s15
    s_addc_u32 s35, s5, 0
    s_mov_b32 s20, s34
    s_and_b32 s21, s35, 0xffff
    s_mov_b32 s22, 16384000
    s_mov_b32 s23, 0x00020000
    s_mul_i32 s15, s14, 98304
    s_lshl_b32 s24, s13, 8
    s_add_u32 s15, s15, s24
    s_add_u32 s25, s15, 0
    buffer_load_dwordx4 v[64:67], v224, s[20:23], s25 offen
    s_add_u32 s25, s15, 2048
    buffer_load_dwordx4 v[68:71], v224, s[20:23], s25 offen
    s_add_u32 s25, s15, 4096
    buffer_load_dwordx4 v[72:75], v224, s[20:23], s25 offen
    s_add_u32 s25, s15, 6144
    buffer_load_dwordx4 v[76:79], v224, s[20:23], s25 offen
    s_add_u32 s25, s15, 8192
    buffer_load_dwordx4 v[80:83], v224, s[20:23], s25 offen
    s_add_u32 s25, s15, 10240
    buffer_load_dwordx4 v[84:87], v224, s[20:23], s25 offen
    s_add_u32 s25, s15, 12288
    buffer_load_dwordx4 v[88:91], v224, s[20:23], s25 offen
    s_add_u32 s25, s15, 14336
    buffer_load_dwordx4 v[92:95], v224, s[20:23], s25 offen
    s_add_u32 s25, s15, 65536
    buffer_load_dwordx4 v[96:99], v224, s[20:23], s25 offen
    s_add_u32 s25, s15, 67584
    buffer_load_dwordx4 v[100:103], v224, s[20:23], s25 offen
    s_add_u32 s25, s15, 69632
    buffer_load_dwordx4 v[104:107], v224, s[20:23], s25 offen
    s_add_u32 s25, s15, 71680
    buffer_load_dwordx4 v[108:111], v224, s[20:23], s25 offen
    s_add_u32 s25, s15, 73728
    buffer_load_dwordx4 v[112:115], v224, s[20:23], s25 offen
    s_add_u32 s25, s15, 75776
    buffer_load_dwordx4 v[116:119], v224, s[20:23], s25 offen
    s_add_u32 s25, s15, 77824
    buffer_load_dwordx4 v[120:123], v224, s[20:23], s25 offen
    s_add_u32 s25, s15, 79872
    buffer_load_dwordx4 v[124:127], v224, s[20:23], s25 offen
    s_branch L_ld_done1
L_ld_w1:
    s_sub_u32 s12, s42, 672
    s_and_b32 s13, s12, 3
    s_lshr_b32 s14, s12, 2
    s_lshl_b32 s14, s14, 2
    s_add_u32 s14, s14, s10
    s_mov_b32 s20, s6
    s_and_b32 s21, s7, 0xffff
    s_mov_b32 s22, 16252928
    s_mov_b32 s23, 0x00020000
    s_lshl_b32 s15, s14, 10
    s_lshl_b32 s24, s13, 8
    s_add_u32 s15, s15, s24
    s_add_u32 s25, s15, 0
    buffer_load_dwordx2 v[64:65], v225, s[20:23], s25 offen
    buffer_load_dwordx2 v[66:67], v225, s[20:23], s25 offen offset:16
    s_add_u32 s25, s15, 1048576
    buffer_load_dwordx2 v[68:69], v225, s[20:23], s25 offen
    buffer_load_dwordx2 v[70:71], v225, s[20:23], s25 offen offset:16
    s_add_u32 s25, s15, 2097152
    buffer_load_dwordx2 v[72:73], v225, s[20:23], s25 offen
    buffer_load_dwordx2 v[74:75], v225, s[20:23], s25 offen offset:16
    s_add_u32 s25, s15, 3145728
    buffer_load_dwordx2 v[76:77], v225, s[20:23], s25 offen
    buffer_load_dwordx2 v[78:79], v225, s[20:23], s25 offen offset:16
L_ld_done1:
    s_cmp_lg_u32 s43, 0
    s_cbranch_scc1 L_notfirst
    s_cmp_ge_u32 s42, 1696
    s_cbranch_scc1 L_w0_f
    s_cmp_ge_u32 s42, 672
    s_cbranch_scc1 L_w8_f
    s_waitcnt vmcnt(16)
    s_branch L_wd_f
L_w8_f:
    s_waitcnt vmcnt(8)
    s_branch L_wd_f
L_w0_f:
    s_waitcnt vmcnt(0)
L_wd_f:
    s_mov_b32 s43, 1
    s_branch L_wfin
L_notfirst:
    s_cmp_ge_u32 s42, 1696
    s_cbranch_scc1 L_w0_a0
    s_cmp_ge_u32 s42, 672
    s_cbranch_scc1 L_w8_a0
    s_waitcnt vmcnt(32)
    s_branch L_wd_a0
L_w8_a0:
    s_waitcnt vmcnt(24)
    s_branch L_wd_a0
L_w0_a0:
    s_waitcnt vmcnt(16)
L_wd_a0:
L_wfin:
    s_cmp_ge_u32 s40, 672
    s_cbranch_scc1 L_cw0
    s_cmp_ge_u32 s40, 336
    s_cselect_b32 s11, 1, 0
    s_mul_i32 s12, s11, 336
    s_sub_u32 s12, s40, s12
    s_and_b32 s13, s12, 7
    s_lshr_b32 s14, s12, 3
    s_lshl_b32 s14, s14, 2
    s_add_u32 s14, s14, s10
    ds_read_b128 v[128:131], v223 offset:0
    ds_read_b128 v[132:135], v223 offset:1024
    ds_read_b128 v[136:139], v223 offset:2048
    ds_read_b128 v[140:143], v223 offset:3072
    ds_read_b128 v[144:147], v223 offset:4096
    ds_read_b128 v[148:151], v223 offset:5120
    ds_read_b128 v[152:155], v223 offset:6144
    ds_read_b128 v[156:159], v223 offset:7168
    s_bfe_u32 s24, s14, 0x10003
    s_mul_i32 s24, s24, 3
    v_and_b32 v213, 3, v209
    v_xor_b32 v213, s24, v213
    v_lshl_add_u32 v212, v213, 4, v226
    s_mul_i32 s24, s11, 22020096
    s_mul_i32 s25, s13, 2752512
    s_add_u32 s24, s24, s25
    s_lshl_b32 s25, s14, 6
    s_add_u32 s24, s24, s25
    s_add_u32 s24, s24, 67108864
    v_perm_b32 v160, v4, v0, s30
    v_perm_b32 v161, v12, v8, s30
    v_perm_b32 v162, v20, v16, s30
    v_perm_b32 v163, v28, v24, s30
    v_perm_b32 v164, v4, v0, s31
    v_perm_b32 v165, v12, v8, s31
    v_perm_b32 v166, v20, v16, s31
    v_perm_b32 v167, v28, v24, s31
    v_perm_b32 v168, v36, v32, s30
    v_perm_b32 v169, v44, v40, s30
    v_perm_b32 v170, v52, v48, s30
    v_perm_b32 v171, v60, v56, s30
    v_perm_b32 v172, v36, v32, s31
    v_perm_b32 v173, v44, v40, s31
    v_perm_b32 v174, v52, v48, s31
    v_perm_b32 v175, v60, v56, s31
    s_waitcnt lgkmcnt(0)
    v_mfma_f32_16x16x32_bf16 v[176:179], v[128:131], v[160:163], 0
    v_mfma_f32_16x16x32_bf16 v[180:183], v[128:131], v[164:167], 0
    v_mfma_f32_16x16x32_bf16 v[184:187], v[136:139], v[160:163], 0
    v_mfma_f32_16x16x32_bf16 v[188:191], v[136:139], v[164:167], 0
    v_mfma_f32_16x16x32_bf16 v[192:195], v[144:147], v[160:163], 0
    v_mfma_f32_16x16x32_bf16 v[196:199], v[144:147], v[164:167], 0
    v_mfma_f32_16x16x32_bf16 v[200:203], v[152:155], v[160:163], 0
    v_mfma_f32_16x16x32_bf16 v[204:207], v[152:155], v[164:167], 0
    v_mfma_f32_16x16x32_bf16 v[176:179], v[132:135], v[168:171], v[176:179]
    v_mfma_f32_16x16x32_bf16 v[180:183], v[132:135], v[172:175], v[180:183]
    v_mfma_f32_16x16x32_bf16 v[184:187], v[140:143], v[168:171], v[184:187]
    v_mfma_f32_16x16x32_bf16 v[188:191], v[140:143], v[172:175], v[188:191]
    v_mfma_f32_16x16x32_bf16 v[192:195], v[148:151], v[168:171], v[192:195]
    v_mfma_f32_16x16x32_bf16 v[196:199], v[148:151], v[172:175], v[196:199]
    v_mfma_f32_16x16x32_bf16 v[200:203], v[156:159], v[168:171], v[200:203]
    v_mfma_f32_16x16x32_bf16 v[204:207], v[156:159], v[172:175], v[204:207]
    v_perm_b32 v160, v5, v1, s30
    v_perm_b32 v161, v13, v9, s30
    v_perm_b32 v162, v21, v17, s30
    v_perm_b32 v163, v29, v25, s30
    v_perm_b32 v164, v5, v1, s31
    v_perm_b32 v165, v13, v9, s31
    v_perm_b32 v166, v21, v17, s31
    v_perm_b32 v167, v29, v25, s31
    v_perm_b32 v168, v37, v33, s30
    v_perm_b32 v169, v45, v41, s30
    v_perm_b32 v170, v53, v49, s30
    v_perm_b32 v171, v61, v57, s30
    v_perm_b32 v172, v37, v33, s31
    v_perm_b32 v173, v45, v41, s31
    v_perm_b32 v174, v53, v49, s31
    v_perm_b32 v175, v61, v57, s31
    v_cvt_pk_bf16_f32 v0, v176, v180
    v_cvt_pk_bf16_f32 v4, v177, v181
    v_cvt_pk_bf16_f32 v8, v178, v182
    v_cvt_pk_bf16_f32 v12, v179, v183
    v_cvt_pk_bf16_f32 v16, v184, v188
    v_cvt_pk_bf16_f32 v20, v185, v189
    v_cvt_pk_bf16_f32 v24, v186, v190
    v_cvt_pk_bf16_f32 v28, v187, v191
    v_cvt_pk_bf16_f32 v32, v192, v196
    v_cvt_pk_bf16_f32 v36, v193, v197
    v_cvt_pk_bf16_f32 v40, v194, v198
    v_cvt_pk_bf16_f32 v44, v195, v199
    v_cvt_pk_bf16_f32 v48, v200, v204
    v_cvt_pk_bf16_f32 v52, v201, v205
    v_cvt_pk_bf16_f32 v56, v202, v206
    v_cvt_pk_bf16_f32 v60, v203, v207
    v_mfma_f32_16x16x32_bf16 v[176:179], v[128:131], v[160:163], 0
    v_mfma_f32_16x16x32_bf16 v[180:183], v[128:131], v[164:167], 0
    v_mfma_f32_16x16x32_bf16 v[184:187], v[136:139], v[160:163], 0
    v_mfma_f32_16x16x32_bf16 v[188:191], v[136:139], v[164:167], 0
    v_mfma_f32_16x16x32_bf16 v[192:195], v[144:147], v[160:163], 0
    v_mfma_f32_16x16x32_bf16 v[196:199], v[144:147], v[164:167], 0
    v_mfma_f32_16x16x32_bf16 v[200:203], v[152:155], v[160:163], 0
    v_mfma_f32_16x16x32_bf16 v[204:207], v[152:155], v[164:167], 0
    v_mfma_f32_16x16x32_bf16 v[176:179], v[132:135], v[168:171], v[176:179]
    v_mfma_f32_16x16x32_bf16 v[180:183], v[132:135], v[172:175], v[180:183]
    v_mfma_f32_16x16x32_bf16 v[184:187], v[140:143], v[168:171], v[184:187]
    v_mfma_f32_16x16x32_bf16 v[188:191], v[140:143], v[172:175], v[188:191]
    v_mfma_f32_16x16x32_bf16 v[192:195], v[148:151], v[168:171], v[192:195]
    v_mfma_f32_16x16x32_bf16 v[196:199], v[148:151], v[172:175], v[196:199]
    v_mfma_f32_16x16x32_bf16 v[200:203], v[156:159], v[168:171], v[200:203]
    v_mfma_f32_16x16x32_bf16 v[204:207], v[156:159], v[172:175], v[204:207]
    v_perm_b32 v160, v6, v2, s30
    v_perm_b32 v161, v14, v10, s30
    v_perm_b32 v162, v22, v18, s30
    v_perm_b32 v163, v30, v26, s30
    v_perm_b32 v164, v6, v2, s31
    v_perm_b32 v165, v14, v10, s31
    v_perm_b32 v166, v22, v18, s31
    v_perm_b32 v167, v30, v26, s31
    v_perm_b32 v168, v38, v34, s30
    v_perm_b32 v169, v46, v42, s30
    v_perm_b32 v170, v54, v50, s30
    v_perm_b32 v171, v62, v58, s30
    v_perm_b32 v172, v38, v34, s31
    v_perm_b32 v173, v46, v42, s31
    v_perm_b32 v174, v54, v50, s31
    v_perm_b32 v175, v62, v58, s31
    v_cvt_pk_bf16_f32 v1, v176, v180
    v_cvt_pk_bf16_f32 v5, v177, v181
    v_cvt_pk_bf16_f32 v9, v178, v182
    v_cvt_pk_bf16_f32 v13, v179, v183
    v_cvt_pk_bf16_f32 v17, v184, v188
    v_cvt_pk_bf16_f32 v21, v185, v189
    v_cvt_pk_bf16_f32 v25, v186, v190
    v_cvt_pk_bf16_f32 v29, v187, v191
    v_cvt_pk_bf16_f32 v33, v192, v196
    v_cvt_pk_bf16_f32 v37, v193, v197
    v_cvt_pk_bf16_f32 v41, v194, v198
    v_cvt_pk_bf16_f32 v45, v195, v199
    v_cvt_pk_bf16_f32 v49, v200, v204
    v_cvt_pk_bf16_f32 v53, v201, v205
    v_cvt_pk_bf16_f32 v57, v202, v206
    v_cvt_pk_bf16_f32 v61, v203, v207
    v_mfma_f32_16x16x32_bf16 v[176:179], v[128:131], v[160:163], 0
    v_mfma_f32_16x16x32_bf16 v[180:183], v[128:131], v[164:167], 0
    v_mfma_f32_16x16x32_bf16 v[184:187], v[136:139], v[160:163], 0
    v_mfma_f32_16x16x32_bf16 v[188:191], v[136:139], v[164:167], 0
    v_mfma_f32_16x16x32_bf16 v[192:195], v[144:147], v[160:163], 0
    v_mfma_f32_16x16x32_bf16 v[196:199], v[144:147], v[164:167], 0
    v_mfma_f32_16x16x32_bf16 v[200:203], v[152:155], v[160:163], 0
    v_mfma_f32_16x16x32_bf16 v[204:207], v[152:155], v[164:167], 0
    v_mfma_f32_16x16x32_bf16 v[176:179], v[132:135], v[168:171], v[176:179]
    v_mfma_f32_16x16x32_bf16 v[180:183], v[132:135], v[172:175], v[180:183]
    v_mfma_f32_16x16x32_bf16 v[184:187], v[140:143], v[168:171], v[184:187]
    v_mfma_f32_16x16x32_bf16 v[188:191], v[140:143], v[172:175], v[188:191]
    v_mfma_f32_16x16x32_bf16 v[192:195], v[148:151], v[168:171], v[192:195]
    v_mfma_f32_16x16x32_bf16 v[196:199], v[148:151], v[172:175], v[196:199]
    v_mfma_f32_16x16x32_bf16 v[200:203], v[156:159], v[168:171], v[200:203]
    v_mfma_f32_16x16x32_bf16 v[204:207], v[156:159], v[172:175], v[204:207]
    v_perm_b32 v160, v7, v3, s30
    v_perm_b32 v161, v15, v11, s30
    v_perm_b32 v162, v23, v19, s30
    v_perm_b32 v163, v31, v27, s30
    v_perm_b32 v164, v7, v3, s31
    v_perm_b32 v165, v15, v11, s31
    v_perm_b32 v166, v23, v19, s31
    v_perm_b32 v167, v31, v27, s31
    v_perm_b32 v168, v39, v35, s30
    v_perm_b32 v169, v47, v43, s30
    v_perm_b32 v170, v55, v51, s30
    v_perm_b32 v171, v63, v59, s30
    v_perm_b32 v172, v39, v35, s31
    v_perm_b32 v173, v47, v43, s31
    v_perm_b32 v174, v55, v51, s31
    v_perm_b32 v175, v63, v59, s31
    v_cvt_pk_bf16_f32 v2, v176, v180
    v_cvt_pk_bf16_f32 v6, v177, v181
    v_cvt_pk_bf16_f32 v10, v178, v182
    v_cvt_pk_bf16_f32 v14, v179, v183
    v_cvt_pk_bf16_f32 v18, v184, v188
    v_cvt_pk_bf16_f32 v22, v185, v189
    v_cvt_pk_bf16_f32 v26, v186, v190
    v_cvt_pk_bf16_f32 v30, v187, v191
    v_cvt_pk_bf16_f32 v34, v192, v196
    v_cvt_pk_bf16_f32 v38, v193, v197
    v_cvt_pk_bf16_f32 v42, v194, v198
    v_cvt_pk_bf16_f32 v46, v195, v199
    v_cvt_pk_bf16_f32 v50, v200, v204
    v_cvt_pk_bf16_f32 v54, v201, v205
    v_cvt_pk_bf16_f32 v58, v202, v206
    v_cvt_pk_bf16_f32 v62, v203, v207
    v_mfma_f32_16x16x32_bf16 v[176:179], v[128:131], v[160:163], 0
    v_mfma_f32_16x16x32_bf16 v[180:183], v[128:131], v[164:167], 0
    v_mfma_f32_16x16x32_bf16 v[184:187], v[136:139], v[160:163], 0
    v_mfma_f32_16x16x32_bf16 v[188:191], v[136:139], v[164:167], 0
    v_mfma_f32_16x16x32_bf16 v[192:195], v[144:147], v[160:163], 0
    v_mfma_f32_16x16x32_bf16 v[196:199], v[144:147], v[164:167], 0
    v_mfma_f32_16x16x32_bf16 v[200:203], v[152:155], v[160:163], 0
    v_mfma_f32_16x16x32_bf16 v[204:207], v[152:155], v[164:167], 0
    v_mfma_f32_16x16x32_bf16 v[176:179], v[132:135], v[168:171], v[176:179]
    v_mfma_f32_16x16x32_bf16 v[180:183], v[132:135], v[172:175], v[180:183]
    v_mfma_f32_16x16x32_bf16 v[184:187], v[140:143], v[168:171], v[184:187]
    v_mfma_f32_16x16x32_bf16 v[188:191], v[140:143], v[172:175], v[188:191]
    v_mfma_f32_16x16x32_bf16 v[192:195], v[148:151], v[168:171], v[192:195]
    v_mfma_f32_16x16x32_bf16 v[196:199], v[148:151], v[172:175], v[196:199]
    v_mfma_f32_16x16x32_bf16 v[200:203], v[156:159], v[168:171], v[200:203]
    v_mfma_f32_16x16x32_bf16 v[204:207], v[156:159], v[172:175], v[204:207]
    s_nop 1
    v_cvt_pk_bf16_f32 v3, v176, v180
    v_cvt_pk_bf16_f32 v7, v177, v181
    v_cvt_pk_bf16_f32 v11, v178, v182
    v_cvt_pk_bf16_f32 v15, v179, v183
    v_cvt_pk_bf16_f32 v19, v184, v188
    v_cvt_pk_bf16_f32 v23, v185, v189
    v_cvt_pk_bf16_f32 v27, v186, v190
    v_cvt_pk_bf16_f32 v31, v187, v191
    v_cvt_pk_bf16_f32 v35, v192, v196
    v_cvt_pk_bf16_f32 v39, v193, v197
    v_cvt_pk_bf16_f32 v43, v194, v198
    v_cvt_pk_bf16_f32 v47, v195, v199
    v_cvt_pk_bf16_f32 v51, v200, v204
    v_cvt_pk_bf16_f32 v55, v201, v205
    v_cvt_pk_bf16_f32 v59, v202, v206
    v_cvt_pk_bf16_f32 v63, v203, v207
    s_add_u32 s25, s24, 0
    buffer_store_dwordx4 v[0:3], v212, s[16:19], s25 offen sc1
    s_add_u32 s25, s24, 10752
    buffer_store_dwordx4 v[4:7], v212, s[16:19], s25 offen sc1
    s_add_u32 s25, s24, 21504
    buffer_store_dwordx4 v[8:11], v212, s[16:19], s25 offen sc1
    s_add_u32 s25, s24, 32256
    buffer_store_dwordx4 v[12:15], v212, s[16:19], s25 offen sc1
    s_add_u32 s25, s24, 172032
    buffer_store_dwordx4 v[16:19], v212, s[16:19], s25 offen sc1
    s_add_u32 s25, s24, 182784
    buffer_store_dwordx4 v[20:23], v212, s[16:19], s25 offen sc1
    s_add_u32 s25, s24, 193536
    buffer_store_dwordx4 v[24:27], v212, s[16:19], s25 offen sc1
    s_add_u32 s25, s24, 204288
    buffer_store_dwordx4 v[28:31], v212, s[16:19], s25 offen sc1
    s_add_u32 s25, s24, 344064
    buffer_store_dwordx4 v[32:35], v212, s[16:19], s25 offen sc1
    s_add_u32 s25, s24, 354816
    buffer_store_dwordx4 v[36:39], v212, s[16:19], s25 offen sc1
    s_add_u32 s25, s24, 365568
    buffer_store_dwordx4 v[40:43], v212, s[16:19], s25 offen sc1
    s_add_u32 s25, s24, 376320
    buffer_store_dwordx4 v[44:47], v212, s[16:19], s25 offen sc1
    s_add_u32 s25, s24, 516096
    buffer_store_dwordx4 v[48:51], v212, s[16:19], s25 offen sc1
    s_add_u32 s25, s24, 526848
    buffer_store_dwordx4 v[52:55], v212, s[16:19], s25 offen sc1
    s_add_u32 s25, s24, 537600
    buffer_store_dwordx4 v[56:59], v212, s[16:19], s25 offen sc1
    s_add_u32 s25, s24, 548352
    buffer_store_dwordx4 v[60:63], v212, s[16:19], s25 offen sc1
    s_branch L_next0
L_cw0:
    s_sub_u32 s12, s40, 672
    s_and_b32 s13, s12, 3
    s_lshr_b32 s14, s12, 2
    s_lshl_b32 s14, s14, 2
    s_add_u32 s14, s14, s10
    ds_read_b128 v[128:131], v223 offset:8192
    ds_read_b128 v[132:135], v223 offset:9216
    ds_read_b128 v[136:139], v223 offset:10240
    ds_read_b128 v[140:143], v223 offset:11264
    s_and_b32 s24, s14, 3
    s_bfe_u32 s25, s14, 0x10003
    s_lshl_b32 s25, s25, 2
    s_or_b32 s24, s24, s25
    s_lshl_b32 s24, s24, 1
    v_xor_b32 v213, s24, v209
    v_lshl_add_u32 v212, v213, 4, v227
    s_mul_i32 s24, s13, 16777216
    s_lshr_b32 s25, s14, 5
    s_mul_i32 s25, s25, 524288
    s_add_u32 s24, s24, s25
    s_and_b32 s25, s14, 31
    s_lshl_b32 s25, s25, 8
    s_add_u32 s24, s24, s25
    v_perm_b32 v16, v0, v0, s32
    v_perm_b32 v17, v4, v4, s32
    v_perm_b32 v18, v8, v8, s32
    v_perm_b32 v19, v12, v12, s32
    v_perm_b32 v20, v0, v0, s33
    v_perm_b32 v21, v4, v4, s33
    v_perm_b32 v22, v8, v8, s33
    v_perm_b32 v23, v12, v12, s33
    v_perm_b32 v24, v1, v1, s32
    v_perm_b32 v25, v5, v5, s32
    v_perm_b32 v26, v9, v9, s32
    v_perm_b32 v27, v13, v13, s32
    v_perm_b32 v28, v1, v1, s33
    v_perm_b32 v29, v5, v5, s33
    v_perm_b32 v30, v9, v9, s33
    v_perm_b32 v31, v13, v13, s33
    v_perm_b32 v32, v2, v2, s32
    v_perm_b32 v33, v6, v6, s32
    v_perm_b32 v34, v10, v10, s32
    v_perm_b32 v35, v14, v14, s32
    v_perm_b32 v36, v2, v2, s33
    v_perm_b32 v37, v6, v6, s33
    v_perm_b32 v38, v10, v10, s33
    v_perm_b32 v39, v14, v14, s33
    v_perm_b32 v40, v3, v3, s32
    v_perm_b32 v41, v7, v7, s32
    v_perm_b32 v42, v11, v11, s32
    v_perm_b32 v43, v15, v15, s32
    v_perm_b32 v44, v3, v3, s33
    v_perm_b32 v45, v7, v7, s33
    v_perm_b32 v46, v11, v11, s33
    v_perm_b32 v47, v15, v15, s33
    s_waitcnt lgkmcnt(0)
    v_mfma_f32_16x16x32_bf16 v[176:179], v[128:131], v[16:19], 0
    v_mfma_f32_16x16x32_bf16 v[180:183], v[128:131], v[20:23], 0
    v_mfma_f32_16x16x32_bf16 v[184:187], v[128:131], v[24:27], 0
    v_mfma_f32_16x16x32_bf16 v[188:191], v[128:131], v[28:31], 0
    v_mfma_f32_16x16x32_bf16 v[192:195], v[128:131], v[32:35], 0
    v_mfma_f32_16x16x32_bf16 v[196:199], v[128:131], v[36:39], 0
    v_mfma_f32_16x16x32_bf16 v[200:203], v[128:131], v[40:43], 0
    v_mfma_f32_16x16x32_bf16 v[204:207], v[128:131], v[44:47], 0
    s_nop 1
    v_cvt_pk_bf16_f32 v0, v176, v180
    s_nop 0
    v_cvt_pk_bf16_f32 v1, v184, v188
    s_nop 0
    v_cvt_pk_bf16_f32 v2, v192, v196
    s_nop 0
    v_cvt_pk_bf16_f32 v3, v200, v204
    v_cvt_pk_bf16_f32 v4, v177, v181
    v_cvt_pk_bf16_f32 v5, v185, v189
    v_cvt_pk_bf16_f32 v6, v193, v197
    v_cvt_pk_bf16_f32 v7, v201, v205
    v_cvt_pk_bf16_f32 v8, v178, v182
    v_cvt_pk_bf16_f32 v9, v186, v190
    v_cvt_pk_bf16_f32 v10, v194, v198
    v_cvt_pk_bf16_f32 v11, v202, v206
    v_cvt_pk_bf16_f32 v12, v179, v183
    v_cvt_pk_bf16_f32 v13, v187, v191
    v_cvt_pk_bf16_f32 v14, v195, v199
    v_cvt_pk_bf16_f32 v15, v203, v207
    s_add_u32 s25, s24, 0
    buffer_store_dwordx4 v[0:3], v212, s[16:19], s25 offen sc1
    s_add_u32 s25, s24, 8192
    buffer_store_dwordx4 v[4:7], v212, s[16:19], s25 offen sc1
    s_add_u32 s25, s24, 16384
    buffer_store_dwordx4 v[8:11], v212, s[16:19], s25 offen sc1
    s_add_u32 s25, s24, 24576
    buffer_store_dwordx4 v[12:15], v212, s[16:19], s25 offen sc1
    v_mfma_f32_16x16x32_bf16 v[176:179], v[132:135], v[16:19], 0
    v_mfma_f32_16x16x32_bf16 v[180:183], v[132:135], v[20:23], 0
    v_mfma_f32_16x16x32_bf16 v[184:187], v[132:135], v[24:27], 0
    v_mfma_f32_16x16x32_bf16 v[188:191], v[132:135], v[28:31], 0
    v_mfma_f32_16x16x32_bf16 v[192:195], v[132:135], v[32:35], 0
    v_mfma_f32_16x16x32_bf16 v[196:199], v[132:135], v[36:39], 0
    v_mfma_f32_16x16x32_bf16 v[200:203], v[132:135], v[40:43], 0
    v_mfma_f32_16x16x32_bf16 v[204:207], v[132:135], v[44:47], 0
    s_nop 1
    v_cvt_pk_bf16_f32 v48, v176, v180
    s_nop 0
    v_cvt_pk_bf16_f32 v49, v184, v188
    s_nop 0
    v_cvt_pk_bf16_f32 v50, v192, v196
    s_nop 0
    v_cvt_pk_bf16_f32 v51, v200, v204
    v_cvt_pk_bf16_f32 v52, v177, v181
    v_cvt_pk_bf16_f32 v53, v185, v189
    v_cvt_pk_bf16_f32 v54, v193, v197
    v_cvt_pk_bf16_f32 v55, v201, v205
    v_cvt_pk_bf16_f32 v56, v178, v182
    v_cvt_pk_bf16_f32 v57, v186, v190
    v_cvt_pk_bf16_f32 v58, v194, v198
    v_cvt_pk_bf16_f32 v59, v202, v206
    v_cvt_pk_bf16_f32 v60, v179, v183
    v_cvt_pk_bf16_f32 v61, v187, v191
    v_cvt_pk_bf16_f32 v62, v195, v199
    v_cvt_pk_bf16_f32 v63, v203, v207
    s_add_u32 s25, s24, 131072
    buffer_store_dwordx4 v[48:51], v212, s[16:19], s25 offen sc1
    s_add_u32 s25, s24, 139264
    buffer_store_dwordx4 v[52:55], v212, s[16:19], s25 offen sc1
    s_add_u32 s25, s24, 147456
    buffer_store_dwordx4 v[56:59], v212, s[16:19], s25 offen sc1
    s_add_u32 s25, s24, 155648
    buffer_store_dwordx4 v[60:63], v212, s[16:19], s25 offen sc1
    v_mfma_f32_16x16x32_bf16 v[176:179], v[136:139], v[16:19], 0
    v_mfma_f32_16x16x32_bf16 v[180:183], v[136:139], v[20:23], 0
    v_mfma_f32_16x16x32_bf16 v[184:187], v[136:139], v[24:27], 0
    v_mfma_f32_16x16x32_bf16 v[188:191], v[136:139], v[28:31], 0
    v_mfma_f32_16x16x32_bf16 v[192:195], v[136:139], v[32:35], 0
    v_mfma_f32_16x16x32_bf16 v[196:199], v[136:139], v[36:39], 0
    v_mfma_f32_16x16x32_bf16 v[200:203], v[136:139], v[40:43], 0
    v_mfma_f32_16x16x32_bf16 v[204:207], v[136:139], v[44:47], 0
    s_nop 1
    v_cvt_pk_bf16_f32 v0, v176, v180
    s_nop 0
    v_cvt_pk_bf16_f32 v1, v184, v188
    s_nop 0
    v_cvt_pk_bf16_f32 v2, v192, v196
    s_nop 0
    v_cvt_pk_bf16_f32 v3, v200, v204
    v_cvt_pk_bf16_f32 v4, v177, v181
    v_cvt_pk_bf16_f32 v5, v185, v189
    v_cvt_pk_bf16_f32 v6, v193, v197
    v_cvt_pk_bf16_f32 v7, v201, v205
    v_cvt_pk_bf16_f32 v8, v178, v182
    v_cvt_pk_bf16_f32 v9, v186, v190
    v_cvt_pk_bf16_f32 v10, v194, v198
    v_cvt_pk_bf16_f32 v11, v202, v206
    v_cvt_pk_bf16_f32 v12, v179, v183
    v_cvt_pk_bf16_f32 v13, v187, v191
    v_cvt_pk_bf16_f32 v14, v195, v199
    v_cvt_pk_bf16_f32 v15, v203, v207
    s_add_u32 s25, s24, 262144
    buffer_store_dwordx4 v[0:3], v212, s[16:19], s25 offen sc1
    s_add_u32 s25, s24, 270336
    buffer_store_dwordx4 v[4:7], v212, s[16:19], s25 offen sc1
    s_add_u32 s25, s24, 278528
    buffer_store_dwordx4 v[8:11], v212, s[16:19], s25 offen sc1
    s_add_u32 s25, s24, 286720
    buffer_store_dwordx4 v[12:15], v212, s[16:19], s25 offen sc1
    v_mfma_f32_16x16x32_bf16 v[176:179], v[140:143], v[16:19], 0
    v_mfma_f32_16x16x32_bf16 v[180:183], v[140:143], v[20:23], 0
    v_mfma_f32_16x16x32_bf16 v[184:187], v[140:143], v[24:27], 0
    v_mfma_f32_16x16x32_bf16 v[188:191], v[140:143], v[28:31], 0
    v_mfma_f32_16x16x32_bf16 v[192:195], v[140:143], v[32:35], 0
    v_mfma_f32_16x16x32_bf16 v[196:199], v[140:143], v[36:39], 0
    v_mfma_f32_16x16x32_bf16 v[200:203], v[140:143], v[40:43], 0
    v_mfma_f32_16x16x32_bf16 v[204:207], v[140:143], v[44:47], 0
    s_nop 1
    v_cvt_pk_bf16_f32 v48, v176, v180
    s_nop 0
    v_cvt_pk_bf16_f32 v49, v184, v188
    s_nop 0
    v_cvt_pk_bf16_f32 v50, v192, v196
    s_nop 0
    v_cvt_pk_bf16_f32 v51, v200, v204
    v_cvt_pk_bf16_f32 v52, v177, v181
    v_cvt_pk_bf16_f32 v53, v185, v189
    v_cvt_pk_bf16_f32 v54, v193, v197
    v_cvt_pk_bf16_f32 v55, v201, v205
    v_cvt_pk_bf16_f32 v56, v178, v182
    v_cvt_pk_bf16_f32 v57, v186, v190
    v_cvt_pk_bf16_f32 v58, v194, v198
    v_cvt_pk_bf16_f32 v59, v202, v206
    v_cvt_pk_bf16_f32 v60, v179, v183
    v_cvt_pk_bf16_f32 v61, v187, v191
    v_cvt_pk_bf16_f32 v62, v195, v199
    v_cvt_pk_bf16_f32 v63, v203, v207
    s_add_u32 s25, s24, 393216
    buffer_store_dwordx4 v[48:51], v212, s[16:19], s25 offen sc1
    s_add_u32 s25, s24, 401408
    buffer_store_dwordx4 v[52:55], v212, s[16:19], s25 offen sc1
    s_add_u32 s25, s24, 409600
    buffer_store_dwordx4 v[56:59], v212, s[16:19], s25 offen sc1
    s_add_u32 s25, s24, 417792
    buffer_store_dwordx4 v[60:63], v212, s[16:19], s25 offen sc1
L_next0:
    s_cmp_lg_u32 s10, 0
    s_cbranch_scc1 L_pub0
    s_cmp_ge_u32 s42, 1696
    s_cbranch_scc1 L_w0_p0
    s_cmp_ge_u32 s42, 672
    s_cbranch_scc1 L_w8_p0
    s_waitcnt vmcnt(32)
    s_branch L_wd_p0
L_w8_p0:
    s_waitcnt vmcnt(24)
    s_branch L_wd_p0
L_w0_p0:
    s_waitcnt vmcnt(16)
L_wd_p0:
    v_add_u32 v221, 512, v221
    v_mov_b32 v213, s41
    s_mov_b64 exec, 1
    ds_write_b32 v213, v221 offset:12288
    s_mov_b64 exec, -1
L_pub0:
    s_waitcnt lgkmcnt(0)
    s_barrier
    v_mov_b32 v213, s41
    ds_read_b32 v214, v213 offset:12288
    s_xor_b32 s41, s41, 4
    s_mov_b32 s40, s42
    s_waitcnt lgkmcnt(0)
    v_readfirstlane_b32 s42, v214
    s_cmp_ge_u32 s40, 1696
    s_cbranch_scc1 L_k12_end
    s_cmp_lg_u32 s10, 0
    s_cbranch_scc1 L_nofetch1
    v_mov_b32 v221, 1
    s_mov_b64 exec, 1
    buffer_atomic_add v221, v222, s[44:47], 0 offen sc0 sc1
    s_mov_b64 exec, -1
L_nofetch1:
    s_cmp_ge_u32 s42, 1696
    s_cbranch_scc1 L_ld_done2
    s_cmp_ge_u32 s42, 672
    s_cbranch_scc1 L_ld_w2
    s_cmp_ge_u32 s42, 336
    s_cselect_b32 s11, 1, 0
    s_mul_i32 s12, s11, 336
    s_sub_u32 s12, s42, s12
    s_and_b32 s13, s12, 7
    s_lshr_b32 s14, s12, 3
    s_lshl_b32 s14, s14, 2
    s_add_u32 s14, s14, s10
    s_mul_i32 s15, s11, 16384000
    s_add_u32 s34, s4, s15
    s_addc_u32 s35, s5, 0
    s_mov_b32 s20, s34
    s_and_b32 s21, s35, 0xffff
    s_mov_b32 s22, 16384000
    s_mov_b32 s23, 0x00020000
    s_mul_i32 s15, s14, 98304
    s_lshl_b32 s24, s13, 8
    s_add_u32 s15, s15, s24
    s_add_u32 s25, s15, 0
    buffer_load_dwordx4 v[0:3], v224, s[20:23], s25 offen
    s_add_u32 s25, s15, 2048
    buffer_load_dwordx4 v[4:7], v224, s[20:23], s25 offen
    s_add_u32 s25, s15, 4096
    buffer_load_dwordx4 v[8:11], v224, s[20:23], s25 offen
    s_add_u32 s25, s15, 6144
    buffer_load_dwordx4 v[12:15], v224, s[20:23], s25 offen
    s_add_u32 s25, s15, 8192
    buffer_load_dwordx4 v[16:19], v224, s[20:23], s25 offen
    s_add_u32 s25, s15, 10240
    buffer_load_dwordx4 v[20:23], v224, s[20:23], s25 offen
    s_add_u32 s25, s15, 12288
    buffer_load_dwordx4 v[24:27], v224, s[20:23], s25 offen
    s_add_u32 s25, s15, 14336
    buffer_load_dwordx4 v[28:31], v224, s[20:23], s25 offen
    s_add_u32 s25, s15, 65536
    buffer_load_dwordx4 v[32:35], v224, s[20:23], s25 offen
    s_add_u32 s25, s15, 67584
    buffer_load_dwordx4 v[36:39], v224, s[20:23], s25 offen
    s_add_u32 s25, s15, 69632
    buffer_load_dwordx4 v[40:43], v224, s[20:23], s25 offen
    s_add_u32 s25, s15, 71680
    buffer_load_dwordx4 v[44:47], v224, s[20:23], s25 offen
    s_add_u32 s25, s15, 73728
    buffer_load_dwordx4 v[48:51], v224, s[20:23], s25 offen
    s_add_u32 s25, s15, 75776
    buffer_load_dwordx4 v[52:55], v224, s[20:23], s25 offen
    s_add_u32 s25, s15, 77824
    buffer_load_dwordx4 v[56:59], v224, s[20:23], s25 offen
    s_add_u32 s25, s15, 79872
    buffer_load_dwordx4 v[60:63], v224, s[20:23], s25 offen
    s_branch L_ld_done2
L_ld_w2:
    s_sub_u32 s12, s42, 672
    s_and_b32 s13, s12, 3
    s_lshr_b32 s14, s12, 2
    s_lshl_b32 s14, s14, 2
    s_add_u32 s14, s14, s10
    s_mov_b32 s20, s6
    s_and_b32 s21, s7, 0xffff
    s_mov_b32 s22, 16252928
    s_mov_b32 s23, 0x00020000
    s_lshl_b32 s15, s14, 10
    s_lshl_b32 s24, s13, 8
    s_add_u32 s15, s15, s24
    s_add_u32 s25, s15, 0
    buffer_load_dwordx2 v[0:1], v225, s[20:23], s25 offen
    buffer_load_dwordx2 v[2:3], v225, s[20:23], s25 offen offset:16
    s_add_u32 s25, s15, 1048576
    buffer_load_dwordx2 v[4:5], v225, s[20:23], s25 offen
    buffer_load_dwordx2 v[6:7], v225, s[20:23], s25 offen offset:16
    s_add_u32 s25, s15, 2097152
    buffer_load_dwordx2 v[8:9], v225, s[20:23], s25 offen
    buffer_load_dwordx2 v[10:11], v225, s[20:23], s25 offen offset:16
    s_add_u32 s25, s15, 3145728
    buffer_load_dwordx2 v[12:13], v225, s[20:23], s25 offen
    buffer_load_dwordx2 v[14:15], v225, s[20:23], s25 offen offset:16
L_ld_done2:
    s_cmp_ge_u32 s42, 1696
    s_cbranch_scc1 L_w0_a1
    s_cmp_ge_u32 s42, 672
    s_cbranch_scc1 L_w8_a1
    s_waitcnt vmcnt(32)
    s_branch L_wd_a1
L_w8_a1:
    s_waitcnt vmcnt(24)
    s_branch L_wd_a1
L_w0_a1:
    s_waitcnt vmcnt(16)
L_wd_a1:
    s_cmp_ge_u32 s40, 672
    s_cbranch_scc1 L_cw1
    s_cmp_ge_u32 s40, 336
    s_cselect_b32 s11, 1, 0
    s_mul_i32 s12, s11, 336
    s_sub_u32 s12, s40, s12
    s_and_b32 s13, s12, 7
    s_lshr_b32 s14, s12, 3
    s_lshl_b32 s14, s14, 2
    s_add_u32 s14, s14, s10
    ds_read_b128 v[128:131], v223 offset:0
    ds_read_b128 v[132:135], v223 offset:1024
    ds_read_b128 v[136:139], v223 offset:2048
    ds_read_b128 v[140:143], v223 offset:3072
    ds_read_b128 v[144:147], v223 offset:4096
    ds_read_b128 v[148:151], v223 offset:5120
    ds_read_b128 v[152:155], v223 offset:6144
    ds_read_b128 v[156:159], v223 offset:7168
    s_bfe_u32 s24, s14, 0x10003
    s_mul_i32 s24, s24, 3
    v_and_b32 v213, 3, v209
    v_xor_b32 v213, s24, v213
    v_lshl_add_u32 v212, v213, 4, v226
    s_mul_i32 s24, s11, 22020096
    s_mul_i32 s25, s13, 2752512
    s_add_u32 s24, s24, s25
    s_lshl_b32 s25, s14, 6
    s_add_u32 s24, s24, s25
    s_add_u32 s24, s24, 67108864
    v_perm_b32 v160, v68, v64, s30
    v_perm_b32 v161, v76, v72, s30
    v_perm_b32 v162, v84, v80, s30
    v_perm_b32 v163, v92, v88, s30
    v_perm_b32 v164, v68, v64, s31
    v_perm_b32 v165, v76, v72, s31
    v_perm_b32 v166, v84, v80, s31
    v_perm_b32 v167, v92, v88, s31
    v_perm_b32 v168, v100, v96, s30
    v_perm_b32 v169, v108, v104, s30
    v_perm_b32 v170, v116, v112, s30
    v_perm_b32 v171, v124, v120, s30
    v_perm_b32 v172, v100, v96, s31
    v_perm_b32 v173, v108, v104, s31
    v_perm_b32 v174, v116, v112, s31
    v_perm_b32 v175, v124, v120, s31
    s_waitcnt lgkmcnt(0)
    v_mfma_f32_16x16x32_bf16 v[176:179], v[128:131], v[160:163], 0
    v_mfma_f32_16x16x32_bf16 v[180:183], v[128:131], v[164:167], 0
    v_mfma_f32_16x16x32_bf16 v[184:187], v[136:139], v[160:163], 0
    v_mfma_f32_16x16x32_bf16 v[188:191], v[136:139], v[164:167], 0
    v_mfma_f32_16x16x32_bf16 v[192:195], v[144:147], v[160:163], 0
    v_mfma_f32_16x16x32_bf16 v[196:199], v[144:147], v[164:167], 0
    v_mfma_f32_16x16x32_bf16 v[200:203], v[152:155], v[160:163], 0
    v_mfma_f32_16x16x32_bf16 v[204:207], v[152:155], v[164:167], 0
    v_mfma_f32_16x16x32_bf16 v[176:179], v[132:135], v[168:171], v[176:179]
    v_mfma_f32_16x16x32_bf16 v[180:183], v[132:135], v[172:175], v[180:183]
    v_mfma_f32_16x16x32_bf16 v[184:187], v[140:143], v[168:171], v[184:187]
    v_mfma_f32_16x16x32_bf16 v[188:191], v[140:143], v[172:175], v[188:191]
    v_mfma_f32_16x16x32_bf16 v[192:195], v[148:151], v[168:171], v[192:195]
    v_mfma_f32_16x16x32_bf16 v[196:199], v[148:151], v[172:175], v[196:199]
    v_mfma_f32_16x16x32_bf16 v[200:203], v[156:159], v[168:171], v[200:203]
    v_mfma_f32_16x16x32_bf16 v[204:207], v[156:159], v[172:175], v[204:207]
    v_perm_b32 v160, v69, v65, s30
    v_perm_b32 v161, v77, v73, s30
    v_perm_b32 v162, v85, v81, s30
    v_perm_b32 v163, v93, v89, s30
    v_perm_b32 v164, v69, v65, s31
    v_perm_b32 v165, v77, v73, s31
    v_perm_b32 v166, v85, v81, s31
    v_perm_b32 v167, v93, v89, s31
    v_perm_b32 v168, v101, v97, s30
    v_perm_b32 v169, v109, v105, s30
    v_perm_b32 v170, v117, v113, s30
    v_perm_b32 v171, v125, v121, s30
    v_perm_b32 v172, v101, v97, s31
    v_perm_b32 v173, v109, v105, s31
    v_perm_b32 v174, v117, v113, s31
    v_perm_b32 v175, v125, v121, s31
    v_cvt_pk_bf16_f32 v64, v176, v180
    v_cvt_pk_bf16_f32 v68, v177, v181
    v_cvt_pk_bf16_f32 v72, v178, v182
    v_cvt_pk_bf16_f32 v76, v179, v183
    v_cvt_pk_bf16_f32 v80, v184, v188
    v_cvt_pk_bf16_f32 v84, v185, v189
    v_cvt_pk_bf16_f32 v88, v186, v190
    v_cvt_pk_bf16_f32 v92, v187, v191
    v_cvt_pk_bf16_f32 v96, v192, v196
    v_cvt_pk_bf16_f32 v100, v193, v197
    v_cvt_pk_bf16_f32 v104, v194, v198
    v_cvt_pk_bf16_f32 v108, v195, v199
    v_cvt_pk_bf16_f32 v112, v200, v204
    v_cvt_pk_bf16_f32 v116, v201, v205
    v_cvt_pk_bf16_f32 v120, v202, v206
    v_cvt_pk_bf16_f32 v124, v203, v207
    v_mfma_f32_16x16x32_bf16 v[176:179], v[128:131], v[160:163], 0
    v_mfma_f32_16x16x32_bf16 v[180:183], v[128:131], v[164:167], 0
    v_mfma_f32_16x16x32_bf16 v[184:187], v[136:139], v[160:163], 0
    v_mfma_f32_16x16x32_bf16 v[188:191], v[136:139], v[164:167], 0
    v_mfma_f32_16x16x32_bf16 v[192:195], v[144:147], v[160:163], 0
    v_mfma_f32_16x16x32_bf16 v[196:199], v[144:147], v[164:167], 0
    v_mfma_f32_16x16x32_bf16 v[200:203], v[152:155], v[160:163], 0
    v_mfma_f32_16x16x32_bf16 v[204:207], v[152:155], v[164:167], 0
    v_mfma_f32_16x16x32_bf16 v[176:179], v[132:135], v[168:171], v[176:179]
    v_mfma_f32_16x16x32_bf16 v[180:183], v[132:135], v[172:175], v[180:183]
    v_mfma_f32_16x16x32_bf16 v[184:187], v[140:143], v[168:171], v[184:187]
    v_mfma_f32_16x16x32_bf16 v[188:191], v[140:143], v[172:175], v[188:191]
    v_mfma_f32_16x16x32_bf16 v[192:195], v[148:151], v[168:171], v[192:195]
    v_mfma_f32_16x16x32_bf16 v[196:199], v[148:151], v[172:175], v[196:199]
    v_mfma_f32_16x16x32_bf16 v[200:203], v[156:159], v[168:171], v[200:203]
    v_mfma_f32_16x16x32_bf16 v[204:207], v[156:159], v[172:175], v[204:207]
    v_perm_b32 v160, v70, v66, s30
    v_perm_b32 v161, v78, v74, s30
    v_perm_b32 v162, v86, v82, s30
    v_perm_b32 v163, v94, v90, s30
    v_perm_b32 v164, v70, v66, s31
    v_perm_b32 v165, v78, v74, s31
    v_perm_b32 v166, v86, v82, s31
    v_perm_b32 v167, v94, v90, s31
    v_perm_b32 v168, v102, v98, s30
    v_perm_b32 v169, v110, v106, s30
    v_perm_b32 v170, v118, v114, s30
    v_perm_b32 v171, v126, v122, s30
    v_perm_b32 v172, v102, v98, s31
    v_perm_b32 v173, v110, v106, s31
    v_perm_b32 v174, v118, v114, s31
    v_perm_b32 v175, v126, v122, s31
    v_cvt_pk_bf16_f32 v65, v176, v180
    v_cvt_pk_bf16_f32 v69, v177, v181
    v_cvt_pk_bf16_f32 v73, v178, v182
    v_cvt_pk_bf16_f32 v77, v179, v183
    v_cvt_pk_bf16_f32 v81, v184, v188
    v_cvt_pk_bf16_f32 v85, v185, v189
    v_cvt_pk_bf16_f32 v89, v186, v190
    v_cvt_pk_bf16_f32 v93, v187, v191
    v_cvt_pk_bf16_f32 v97, v192, v196
    v_cvt_pk_bf16_f32 v101, v193, v197
    v_cvt_pk_bf16_f32 v105, v194, v198
    v_cvt_pk_bf16_f32 v109, v195, v199
    v_cvt_pk_bf16_f32 v113, v200, v204
    v_cvt_pk_bf16_f32 v117, v201, v205
    v_cvt_pk_bf16_f32 v121, v202, v206
    v_cvt_pk_bf16_f32 v125, v203, v207
    v_mfma_f32_16x16x32_bf16 v[176:179], v[128:131], v[160:163], 0
    v_mfma_f32_16x16x32_bf16 v[180:183], v[128:131], v[164:167], 0
    v_mfma_f32_16x16x32_bf16 v[184:187], v[136:139], v[160:163], 0
    v_mfma_f32_16x16x32_bf16 v[188:191], v[136:139], v[164:167], 0
    v_mfma_f32_16x16x32_bf16 v[192:195], v[144:147], v[160:163], 0
    v_mfma_f32_16x16x32_bf16 v[196:199], v[144:147], v[164:167], 0
    v_mfma_f32_16x16x32_bf16 v[200:203], v[152:155], v[160:163], 0
    v_mfma_f32_16x16x32_bf16 v[204:207], v[152:155], v[164:167], 0
    v_mfma_f32_16x16x32_bf16 v[176:179], v[132:135], v[168:171], v[176:179]
    v_mfma_f32_16x16x32_bf16 v[180:183], v[132:135], v[172:175], v[180:183]
    v_mfma_f32_16x16x32_bf16 v[184:187], v[140:143], v[168:171], v[184:187]
    v_mfma_f32_16x16x32_bf16 v[188:191], v[140:143], v[172:175], v[188:191]
    v_mfma_f32_16x16x32_bf16 v[192:195], v[148:151], v[168:171], v[192:195]
    v_mfma_f32_16x16x32_bf16 v[196:199], v[148:151], v[172:175], v[196:199]
    v_mfma_f32_16x16x32_bf16 v[200:203], v[156:159], v[168:171], v[200:203]
    v_mfma_f32_16x16x32_bf16 v[204:207], v[156:159], v[172:175], v[204:207]
    v_perm_b32 v160, v71, v67, s30
    v_perm_b32 v161, v79, v75, s30
    v_perm_b32 v162, v87, v83, s30
    v_perm_b32 v163, v95, v91, s30
    v_perm_b32 v164, v71, v67, s31
    v_perm_b32 v165, v79, v75, s31
    v_perm_b32 v166, v87, v83, s31
    v_perm_b32 v167, v95, v91, s31
    v_perm_b32 v168, v103, v99, s30
    v_perm_b32 v169, v111, v107, s30
    v_perm_b32 v170, v119, v115, s30
    v_perm_b32 v171, v127, v123, s30
    v_perm_b32 v172, v103, v99, s31
    v_perm_b32 v173, v111, v107, s31
    v_perm_b32 v174, v119, v115, s31
    v_perm_b32 v175, v127, v123, s31
    v_cvt_pk_bf16_f32 v66, v176, v180
    v_cvt_pk_bf16_f32 v70, v177, v181
    v_cvt_pk_bf16_f32 v74, v178, v182
    v_cvt_pk_bf16_f32 v78, v179, v183
    v_cvt_pk_bf16_f32 v82, v184, v188
    v_cvt_pk_bf16_f32 v86, v185, v189
    v_cvt_pk_bf16_f32 v90, v186, v190
    v_cvt_pk_bf16_f32 v94, v187, v191
    v_cvt_pk_bf16_f32 v98, v192, v196
    v_cvt_pk_bf16_f32 v102, v193, v197
    v_cvt_pk_bf16_f32 v106, v194, v198
    v_cvt_pk_bf16_f32 v110, v195, v199
    v_cvt_pk_bf16_f32 v114, v200, v204
    v_cvt_pk_bf16_f32 v118, v201, v205
    v_cvt_pk_bf16_f32 v122, v202, v206
    v_cvt_pk_bf16_f32 v126, v203, v207
    v_mfma_f32_16x16x32_bf16 v[176:179], v[128:131], v[160:163], 0
    v_mfma_f32_16x16x32_bf16 v[180:183], v[128:131], v[164:167], 0
    v_mfma_f32_16x16x32_bf16 v[184:187], v[136:139], v[160:163], 0
    v_mfma_f32_16x16x32_bf16 v[188:191], v[136:139], v[164:167], 0
    v_mfma_f32_16x16x32_bf16 v[192:195], v[144:147], v[160:163], 0
    v_mfma_f32_16x16x32_bf16 v[196:199], v[144:147], v[164:167], 0
    v_mfma_f32_16x16x32_bf16 v[200:203], v[152:155], v[160:163], 0
    v_mfma_f32_16x16x32_bf16 v[204:207], v[152:155], v[164:167], 0
    v_mfma_f32_16x16x32_bf16 v[176:179], v[132:135], v[168:171], v[176:179]
    v_mfma_f32_16x16x32_bf16 v[180:183], v[132:135], v[172:175], v[180:183]
    v_mfma_f32_16x16x32_bf16 v[184:187], v[140:143], v[168:171], v[184:187]
    v_mfma_f32_16x16x32_bf16 v[188:191], v[140:143], v[172:175], v[188:191]
    v_mfma_f32_16x16x32_bf16 v[192:195], v[148:151], v[168:171], v[192:195]
    v_mfma_f32_16x16x32_bf16 v[196:199], v[148:151], v[172:175], v[196:199]
    v_mfma_f32_16x16x32_bf16 v[200:203], v[156:159], v[168:171], v[200:203]
    v_mfma_f32_16x16x32_bf16 v[204:207], v[156:159], v[172:175], v[204:207]
    s_nop 1
    v_cvt_pk_bf16_f32 v67, v176, v180
    v_cvt_pk_bf16_f32 v71, v177, v181
    v_cvt_pk_bf16_f32 v75, v178, v182
    v_cvt_pk_bf16_f32 v79, v179, v183
    v_cvt_pk_bf16_f32 v83, v184, v188
    v_cvt_pk_bf16_f32 v87, v185, v189
    v_cvt_pk_bf16_f32 v91, v186, v190
    v_cvt_pk_bf16_f32 v95, v187, v191
    v_cvt_pk_bf16_f32 v99, v192, v196
    v_cvt_pk_bf16_f32 v103, v193, v197
    v_cvt_pk_bf16_f32 v107, v194, v198
    v_cvt_pk_bf16_f32 v111, v195, v199
    v_cvt_pk_bf16_f32 v115, v200, v204
    v_cvt_pk_bf16_f32 v119, v201, v205
    v_cvt_pk_bf16_f32 v123, v202, v206
    v_cvt_pk_bf16_f32 v127, v203, v207
    s_add_u32 s25, s24, 0
    buffer_store_dwordx4 v[64:67], v212, s[16:19], s25 offen sc1
    s_add_u32 s25, s24, 10752
    buffer_store_dwordx4 v[68:71], v212, s[16:19], s25 offen sc1
    s_add_u32 s25, s24, 21504
    buffer_store_dwordx4 v[72:75], v212, s[16:19], s25 offen sc1
    s_add_u32 s25, s24, 32256
    buffer_store_dwordx4 v[76:79], v212, s[16:19], s25 offen sc1
    s_add_u32 s25, s24, 172032
    buffer_store_dwordx4 v[80:83], v212, s[16:19], s25 offen sc1
    s_add_u32 s25, s24, 182784
    buffer_store_dwordx4 v[84:87], v212, s[16:19], s25 offen sc1
    s_add_u32 s25, s24, 193536
    buffer_store_dwordx4 v[88:91], v212, s[16:19], s25 offen sc1
    s_add_u32 s25, s24, 204288
    buffer_store_dwordx4 v[92:95], v212, s[16:19], s25 offen sc1
    s_add_u32 s25, s24, 344064
    buffer_store_dwordx4 v[96:99], v212, s[16:19], s25 offen sc1
    s_add_u32 s25, s24, 354816
    buffer_store_dwordx4 v[100:103], v212, s[16:19], s25 offen sc1
    s_add_u32 s25, s24, 365568
    buffer_store_dwordx4 v[104:107], v212, s[16:19], s25 offen sc1
    s_add_u32 s25, s24, 376320
    buffer_store_dwordx4 v[108:111], v212, s[16:19], s25 offen sc1
    s_add_u32 s25, s24, 516096
    buffer_store_dwordx4 v[112:115], v212, s[16:19], s25 offen sc1
    s_add_u32 s25, s24, 526848
    buffer_store_dwordx4 v[116:119], v212, s[16:19], s25 offen sc1
    s_add_u32 s25, s24, 537600
    buffer_store_dwordx4 v[120:123], v212, s[16:19], s25 offen sc1
    s_add_u32 s25, s24, 548352
    buffer_store_dwordx4 v[124:127], v212, s[16:19], s25 offen sc1
    s_branch L_next1
L_cw1:
    s_sub_u32 s12, s40, 672
    s_and_b32 s13, s12, 3
    s_lshr_b32 s14, s12, 2
    s_lshl_b32 s14, s14, 2
    s_add_u32 s14, s14, s10
    ds_read_b128 v[128:131], v223 offset:8192
    ds_read_b128 v[132:135], v223 offset:9216
    ds_read_b128 v[136:139], v223 offset:10240
    ds_read_b128 v[140:143], v223 offset:11264
    s_and_b32 s24, s14, 3
    s_bfe_u32 s25, s14, 0x10003
    s_lshl_b32 s25, s25, 2
    s_or_b32 s24, s24, s25
    s_lshl_b32 s24, s24, 1
    v_xor_b32 v213, s24, v209
    v_lshl_add_u32 v212, v213, 4, v227
    s_mul_i32 s24, s13, 16777216
    s_lshr_b32 s25, s14, 5
    s_mul_i32 s25, s25, 524288
    s_add_u32 s24, s24, s25
    s_and_b32 s25, s14, 31
    s_lshl_b32 s25, s25, 8
    s_add_u32 s24, s24, s25
    v_perm_b32 v80, v64, v64, s32
    v_perm_b32 v81, v68, v68, s32
    v_perm_b32 v82, v72, v72, s32
    v_perm_b32 v83, v76, v76, s32
    v_perm_b32 v84, v64, v64, s33
    v_perm_b32 v85, v68, v68, s33
    v_perm_b32 v86, v72, v72, s33
    v_perm_b32 v87, v76, v76, s33
    v_perm_b32 v88, v65, v65, s32
    v_perm_b32 v89, v69, v69, s32
    v_perm_b32 v90, v73, v73, s32
    v_perm_b32 v91, v77, v77, s32
    v_perm_b32 v92, v65, v65, s33
    v_perm_b32 v93, v69, v69, s33
    v_perm_b32 v94, v73, v73, s33
    v_perm_b32 v95, v77, v77, s33
    v_perm_b32 v96, v66, v66, s32
    v_perm_b32 v97, v70, v70, s32
    v_perm_b32 v98, v74, v74, s32
    v_perm_b32 v99, v78, v78, s32
    v_perm_b32 v100, v66, v66, s33
    v_perm_b32 v101, v70, v70, s33
    v_perm_b32 v102, v74, v74, s33
    v_perm_b32 v103, v78, v78, s33
    v_perm_b32 v104, v67, v67, s32
    v_perm_b32 v105, v71, v71, s32
    v_perm_b32 v106, v75, v75, s32
    v_perm_b32 v107, v79, v79, s32
    v_perm_b32 v108, v67, v67, s33
    v_perm_b32 v109, v71, v71, s33
    v_perm_b32 v110, v75, v75, s33
    v_perm_b32 v111, v79, v79, s33
    s_waitcnt lgkmcnt(0)
    v_mfma_f32_16x16x32_bf16 v[176:179], v[128:131], v[80:83], 0
    v_mfma_f32_16x16x32_bf16 v[180:183], v[128:131], v[84:87], 0
    v_mfma_f32_16x16x32_bf16 v[184:187], v[128:131], v[88:91], 0
    v_mfma_f32_16x16x32_bf16 v[188:191], v[128:131], v[92:95], 0
    v_mfma_f32_16x16x32_bf16 v[192:195], v[128:131], v[96:99], 0
    v_mfma_f32_16x16x32_bf16 v[196:199], v[128:131], v[100:103], 0
    v_mfma_f32_16x16x32_bf16 v[200:203], v[128:131], v[104:107], 0
    v_mfma_f32_16x16x32_bf16 v[204:207], v[128:131], v[108:111], 0
    s_nop 1
    v_cvt_pk_bf16_f32 v64, v176, v180
    s_nop 0
    v_cvt_pk_bf16_f32 v65, v184, v188
    s_nop 0
    v_cvt_pk_bf16_f32 v66, v192, v196
    s_nop 0
    v_cvt_pk_bf16_f32 v67, v200, v204
    v_cvt_pk_bf16_f32 v68, v177, v181
    v_cvt_pk_bf16_f32 v69, v185, v189
    v_cvt_pk_bf16_f32 v70, v193, v197
    v_cvt_pk_bf16_f32 v71, v201, v205
    v_cvt_pk_bf16_f32 v72, v178, v182
    v_cvt_pk_bf16_f32 v73, v186, v190
    v_cvt_pk_bf16_f32 v74, v194, v198
    v_cvt_pk_bf16_f32 v75, v202, v206
    v_cvt_pk_bf16_f32 v76, v179, v183
    v_cvt_pk_bf16_f32 v77, v187, v191
    v_cvt_pk_bf16_f32 v78, v195, v199
    v_cvt_pk_bf16_f32 v79, v203, v207
    s_add_u32 s25, s24, 0
    buffer_store_dwordx4 v[64:67], v212, s[16:19], s25 offen sc1
    s_add_u32 s25, s24, 8192
    buffer_store_dwordx4 v[68:71], v212, s[16:19], s25 offen sc1
    s_add_u32 s25, s24, 16384
    buffer_store_dwordx4 v[72:75], v212, s[16:19], s25 offen sc1
    s_add_u32 s25, s24, 24576
    buffer_store_dwordx4 v[76:79], v212, s[16:19], s25 offen sc1
    v_mfma_f32_16x16x32_bf16 v[176:179], v[132:135], v[80:83], 0
    v_mfma_f32_16x16x32_bf16 v[180:183], v[132:135], v[84:87], 0
    v_mfma_f32_16x16x32_bf16 v[184:187], v[132:135], v[88:91], 0
    v_mfma_f32_16x16x32_bf16 v[188:191], v[132:135], v[92:95], 0
    v_mfma_f32_16x16x32_bf16 v[192:195], v[132:135], v[96:99], 0
    v_mfma_f32_16x16x32_bf16 v[196:199], v[132:135], v[100:103], 0
    v_mfma_f32_16x16x32_bf16 v[200:203], v[132:135], v[104:107], 0
    v_mfma_f32_16x16x32_bf16 v[204:207], v[132:135], v[108:111], 0
    s_nop 1
    v_cvt_pk_bf16_f32 v112, v176, v180
    s_nop 0
    v_cvt_pk_bf16_f32 v113, v184, v188
    s_nop 0
    v_cvt_pk_bf16_f32 v114, v192, v196
    s_nop 0
    v_cvt_pk_bf16_f32 v115, v200, v204
    v_cvt_pk_bf16_f32 v116, v177, v181
    v_cvt_pk_bf16_f32 v117, v185, v189
    v_cvt_pk_bf16_f32 v118, v193, v197
    v_cvt_pk_bf16_f32 v119, v201, v205
    v_cvt_pk_bf16_f32 v120, v178, v182
    v_cvt_pk_bf16_f32 v121, v186, v190
    v_cvt_pk_bf16_f32 v122, v194, v198
    v_cvt_pk_bf16_f32 v123, v202, v206
    v_cvt_pk_bf16_f32 v124, v179, v183
    v_cvt_pk_bf16_f32 v125, v187, v191
    v_cvt_pk_bf16_f32 v126, v195, v199
    v_cvt_pk_bf16_f32 v127, v203, v207
    s_add_u32 s25, s24, 131072
    buffer_store_dwordx4 v[112:115], v212, s[16:19], s25 offen sc1
    s_add_u32 s25, s24, 139264
    buffer_store_dwordx4 v[116:119], v212, s[16:19], s25 offen sc1
    s_add_u32 s25, s24, 147456
    buffer_store_dwordx4 v[120:123], v212, s[16:19], s25 offen sc1
    s_add_u32 s25, s24, 155648
    buffer_store_dwordx4 v[124:127], v212, s[16:19], s25 offen sc1
    v_mfma_f32_16x16x32_bf16 v[176:179], v[136:139], v[80:83], 0
    v_mfma_f32_16x16x32_bf16 v[180:183], v[136:139], v[84:87], 0
    v_mfma_f32_16x16x32_bf16 v[184:187], v[136:139], v[88:91], 0
    v_mfma_f32_16x16x32_bf16 v[188:191], v[136:139], v[92:95], 0
    v_mfma_f32_16x16x32_bf16 v[192:195], v[136:139], v[96:99], 0
    v_mfma_f32_16x16x32_bf16 v[196:199], v[136:139], v[100:103], 0
    v_mfma_f32_16x16x32_bf16 v[200:203], v[136:139], v[104:107], 0
    v_mfma_f32_16x16x32_bf16 v[204:207], v[136:139], v[108:111], 0
    s_nop 1
    v_cvt_pk_bf16_f32 v64, v176, v180
    s_nop 0
    v_cvt_pk_bf16_f32 v65, v184, v188
    s_nop 0
    v_cvt_pk_bf16_f32 v66, v192, v196
    s_nop 0
    v_cvt_pk_bf16_f32 v67, v200, v204
    v_cvt_pk_bf16_f32 v68, v177, v181
    v_cvt_pk_bf16_f32 v69, v185, v189
    v_cvt_pk_bf16_f32 v70, v193, v197
    v_cvt_pk_bf16_f32 v71, v201, v205
    v_cvt_pk_bf16_f32 v72, v178, v182
    v_cvt_pk_bf16_f32 v73, v186, v190
    v_cvt_pk_bf16_f32 v74, v194, v198
    v_cvt_pk_bf16_f32 v75, v202, v206
    v_cvt_pk_bf16_f32 v76, v179, v183
    v_cvt_pk_bf16_f32 v77, v187, v191
    v_cvt_pk_bf16_f32 v78, v195, v199
    v_cvt_pk_bf16_f32 v79, v203, v207
    s_add_u32 s25, s24, 262144
    buffer_store_dwordx4 v[64:67], v212, s[16:19], s25 offen sc1
    s_add_u32 s25, s24, 270336
    buffer_store_dwordx4 v[68:71], v212, s[16:19], s25 offen sc1
    s_add_u32 s25, s24, 278528
    buffer_store_dwordx4 v[72:75], v212, s[16:19], s25 offen sc1
    s_add_u32 s25, s24, 286720
    buffer_store_dwordx4 v[76:79], v212, s[16:19], s25 offen sc1
    v_mfma_f32_16x16x32_bf16 v[176:179], v[140:143], v[80:83], 0
    v_mfma_f32_16x16x32_bf16 v[180:183], v[140:143], v[84:87], 0
    v_mfma_f32_16x16x32_bf16 v[184:187], v[140:143], v[88:91], 0
    v_mfma_f32_16x16x32_bf16 v[188:191], v[140:143], v[92:95], 0
    v_mfma_f32_16x16x32_bf16 v[192:195], v[140:143], v[96:99], 0
    v_mfma_f32_16x16x32_bf16 v[196:199], v[140:143], v[100:103], 0
    v_mfma_f32_16x16x32_bf16 v[200:203], v[140:143], v[104:107], 0
    v_mfma_f32_16x16x32_bf16 v[204:207], v[140:143], v[108:111], 0
    s_nop 1
    v_cvt_pk_bf16_f32 v112, v176, v180
    s_nop 0
    v_cvt_pk_bf16_f32 v113, v184, v188
    s_nop 0
    v_cvt_pk_bf16_f32 v114, v192, v196
    s_nop 0
    v_cvt_pk_bf16_f32 v115, v200, v204
    v_cvt_pk_bf16_f32 v116, v177, v181
    v_cvt_pk_bf16_f32 v117, v185, v189
    v_cvt_pk_bf16_f32 v118, v193, v197
    v_cvt_pk_bf16_f32 v119, v201, v205
    v_cvt_pk_bf16_f32 v120, v178, v182
    v_cvt_pk_bf16_f32 v121, v186, v190
    v_cvt_pk_bf16_f32 v122, v194, v198
    v_cvt_pk_bf16_f32 v123, v202, v206
    v_cvt_pk_bf16_f32 v124, v179, v183
    v_cvt_pk_bf16_f32 v125, v187, v191
    v_cvt_pk_bf16_f32 v126, v195, v199
    v_cvt_pk_bf16_f32 v127, v203, v207
    s_add_u32 s25, s24, 393216
    buffer_store_dwordx4 v[112:115], v212, s[16:19], s25 offen sc1
    s_add_u32 s25, s24, 401408
    buffer_store_dwordx4 v[116:119], v212, s[16:19], s25 offen sc1
    s_add_u32 s25, s24, 409600
    buffer_store_dwordx4 v[120:123], v212, s[16:19], s25 offen sc1
    s_add_u32 s25, s24, 417792
    buffer_store_dwordx4 v[124:127], v212, s[16:19], s25 offen sc1
L_next1:
    s_cmp_lg_u32 s10, 0
    s_cbranch_scc1 L_pub1
    s_cmp_ge_u32 s42, 1696
    s_cbranch_scc1 L_w0_p1
    s_cmp_ge_u32 s42, 672
    s_cbranch_scc1 L_w8_p1
    s_waitcnt vmcnt(32)
    s_branch L_wd_p1
L_w8_p1:
    s_waitcnt vmcnt(24)
    s_branch L_wd_p1
L_w0_p1:
    s_waitcnt vmcnt(16)
L_wd_p1:
    v_add_u32 v221, 512, v221
    v_mov_b32 v213, s41
    s_mov_b64 exec, 1
    ds_write_b32 v213, v221 offset:12288
    s_mov_b64 exec, -1
L_pub1:
    s_waitcnt lgkmcnt(0)
    s_barrier
    v_mov_b32 v213, s41
    ds_read_b32 v214, v213 offset:12288
    s_xor_b32 s41, s41, 4
    s_mov_b32 s40, s42
    s_waitcnt lgkmcnt(0)
    v_readfirstlane_b32 s42, v214
    s_cmp_ge_u32 s40, 1696
    s_cbranch_scc1 L_k12_end
    s_branch L_k12_loop
L_k12_end:
    s_endpgm
.globl gemm_kernel
.p2align 8
.type gemm_kernel,@function
gemm_kernel:
    s_cmp_ge_u32 s2, 256
    s_cbranch_scc1 L_k3_end
    s_load_dwordx2 s[8:9], s[0:1], 48
    v_lshrrev_b32 v253, 6, v0
    v_and_b32 v0, 63, v0
    v_readfirstlane_b32 s10, v253
    s_and_b32 s11, s2, 7
    s_lshr_b32 s12, s2, 3
    s_lshr_b32 s13, s12, 3
    s_lshl_b32 s11, s11, 2
    s_add_u32 s11, s11, s13
    s_bfe_u32 s13, s12, 0x10002
    s_and_b32 s14, s12, 3
    s_and_b32 s15, s10, 3
    s_waitcnt lgkmcnt(0)
    s_mov_b32 s16, s8
    s_and_b32 s17, s9, 0xffff
    s_mov_b32 s18, 268435456
    s_mov_b32 s19, 0x00020000
    s_cmp_ge_u32 s10, 4
    s_cbranch_scc1 L_k3_helper
    v_lshrrev_b32 v253, 4, v0
    v_and_b32 v254, 15, v0
    v_bfe_u32 v255, v254, 3, 1
    v_mul_u32_u24 v255, 3, v255
    v_xor_b32 v255, v255, v253
    v_lshlrev_b32 v255, 4, v255
    v_lshl_add_u32 v250, v254, 6, v255
    v_lshrrev_b32 v255, 2, v254
    v_and_b32 v216, 1, v253
    v_lshl_or_b32 v216, v216, 2, v255
    v_lshl_add_u32 v255, v253, 3, v255
    v_lshlrev_b32 v255, 8, v255
    v_and_b32 v217, 3, v254
    v_lshl_add_u32 v255, v217, 3, v255
    s_lshl_b32 s20, s15, 1
    s_add_u32 s20, s20, s13
    v_xor_b32 v217, s20, v216
    v_lshl_add_u32 v248, v217, 5, v255
    s_xor_b32 s20, s20, 1
    v_xor_b32 v217, s20, v216
    v_lshl_add_u32 v249, v217, 5, v255
    s_mov_b32 s21, 65792
    v_mul_u32_u24 v251, s21, v254
    v_lshl_add_u32 v251, v253, 4, v251
    s_lshl_b32 s23, s15, 6
    v_add_u32 v251, s23, v251
    v_and_b32 v255, 7, v254
    v_mul_u32_u24 v252, s21, v255
    v_lshrrev_b32 v216, 3, v254
    v_xor_b32 v216, s13, v216
    s_mov_b32 s22, 11579392
    v_mul_lo_u32 v216, v216, s22
    v_add_u32 v252, v252, v216
    v_lshl_add_u32 v252, v253, 4, v252
    s_lshl_b32 s22, s13, 3
    s_add_u32 s22, s22, s23
    v_add_u32 v252, s22, v252
    v_cmp_gt_u32 vcc, 7, v255
    v_mov_b32 v216, 0x80000000
    s_nop 0
    v_cndmask_b32 v252, v216, v252, vcc
    s_mul_i32 s48, s11, 2048
    s_lshl_b32 s20, s14, 8
    s_add_u32 s48, s48, s20
    s_add_u32 s48, s48, 117440512
    s_add_u32 s49, s48, 10526720
    s_mul_i32 s20, s13, 11579392
    s_add_u32 s48, s48, s20
    v_mov_b32 v0, 0
    v_mov_b32 v1, 0
    v_mov_b32 v2, 0
    v_mov_b32 v3, 0
    v_mov_b32 v4, 0
    v_mov_b32 v5, 0
    v_mov_b32 v6, 0
    v_mov_b32 v7, 0
    v_mov_b32 v8, 0
    v_mov_b32 v9, 0
    v_mov_b32 v10, 0
    v_mov_b32 v11, 0
    v_mov_b32 v12, 0
    v_mov_b32 v13, 0
    v_mov_b32 v14, 0
    v_mov_b32 v15, 0
    v_mov_b32 v16, 0
    v_mov_b32 v17, 0
    v_mov_b32 v18, 0
    v_mov_b32 v19, 0
    v_mov_b32 v20, 0
    v_mov_b32 v21, 0
    v_mov_b32 v22, 0
    v_mov_b32 v23, 0
    v_mov_b32 v24, 0
    v_mov_b32 v25, 0
    v_mov_b32 v26, 0
    v_mov_b32 v27, 0
    v_mov_b32 v28, 0
    v_mov_b32 v29, 0
    v_mov_b32 v30, 0
    v_mov_b32 v31, 0
    v_mov_b32 v32, 0
    v_mov_b32 v33, 0
    v_mov_b32 v34, 0
    v_mov_b32 v35, 0
    v_mov_b32 v36, 0
    v_mov_b32 v37, 0
    v_mov_b32 v38, 0
    v_mov_b32 v39, 0
    v_mov_b32 v40, 0
    v_mov_b32 v41, 0
    v_mov_b32 v42, 0
    v_mov_b32 v43, 0
    v_mov_b32 v44, 0
    v_mov_b32 v45, 0
    v_mov_b32 v46, 0
    v_mov_b32 v47, 0
    v_mov_b32 v48, 0
    v_mov_b32 v49, 0
    v_mov_b32 v50, 0
    v_mov_b32 v51, 0
    v_mov_b32 v52, 0
    v_mov_b32 v53, 0
    v_mov_b32 v54, 0
    v_mov_b32 v55, 0
    v_mov_b32 v56, 0
    v_mov_b32 v57, 0
    v_mov_b32 v58, 0
    v_mov_b32 v59, 0
    v_mov_b32 v60, 0
    v_mov_b32 v61, 0
    v_mov_b32 v62, 0
    v_mov_b32 v63, 0
    v_mov_b32 v64, 0
    v_mov_b32 v65, 0
    v_mov_b32 v66, 0
    v_mov_b32 v67, 0
    v_mov_b32 v68, 0
    v_mov_b32 v69, 0
    v_mov_b32 v70, 0
    v_mov_b32 v71, 0
    v_mov_b32 v72, 0
    v_mov_b32 v73, 0
    v_mov_b32 v74, 0
    v_mov_b32 v75, 0
    v_mov_b32 v76, 0
    v_mov_b32 v77, 0
    v_mov_b32 v78, 0
    v_mov_b32 v79, 0
    v_mov_b32 v80, 0
    v_mov_b32 v81, 0
    v_mov_b32 v82, 0
    v_mov_b32 v83, 0
    v_mov_b32 v84, 0
    v_mov_b32 v85, 0
    v_mov_b32 v86, 0
    v_mov_b32 v87, 0
    v_mov_b32 v88, 0
    v_mov_b32 v89, 0
    v_mov_b32 v90, 0
    v_mov_b32 v91, 0
    v_mov_b32 v92, 0
    v_mov_b32 v93, 0
    v_mov_b32 v94, 0
    v_mov_b32 v95, 0
    v_mov_b32 v96, 0
    v_mov_b32 v97, 0
    v_mov_b32 v98, 0
    v_mov_b32 v99, 0
    v_mov_b32 v100, 0
    v_mov_b32 v101, 0
    v_mov_b32 v102, 0
    v_mov_b32 v103, 0
    v_mov_b32 v104, 0
    v_mov_b32 v105, 0
    v_mov_b32 v106, 0
    v_mov_b32 v107, 0
    v_mov_b32 v108, 0
    v_mov_b32 v109, 0
    v_mov_b32 v110, 0
    v_mov_b32 v111, 0
    v_mov_b32 v112, 0
    v_mov_b32 v113, 0
    v_mov_b32 v114, 0
    v_mov_b32 v115, 0
    v_mov_b32 v116, 0
    v_mov_b32 v117, 0
    v_mov_b32 v118, 0
    v_mov_b32 v119, 0
    v_mov_b32 v120, 0
    v_mov_b32 v121, 0
    v_mov_b32 v122, 0
    v_mov_b32 v123, 0
    v_mov_b32 v124, 0
    v_mov_b32 v125, 0
    v_mov_b32 v126, 0
    v_mov_b32 v127, 0
    v_mov_b32 v128, 0
    v_mov_b32 v129, 0
    v_mov_b32 v130, 0
    v_mov_b32 v131, 0
    v_mov_b32 v132, 0
    v_mov_b32 v133, 0
    v_mov_b32 v134, 0
    v_mov_b32 v135, 0
    v_mov_b32 v136, 0
    v_mov_b32 v137, 0
    v_mov_b32 v138, 0
    v_mov_b32 v139, 0
    v_mov_b32 v140, 0
    v_mov_b32 v141, 0
    v_mov_b32 v142, 0
    v_mov_b32 v143, 0
    v_mov_b32 v144, 0
    v_mov_b32 v145, 0
    v_mov_b32 v146, 0
    v_mov_b32 v147, 0
    v_mov_b32 v148, 0
    v_mov_b32 v149, 0
    v_mov_b32 v150, 0
    v_mov_b32 v151, 0
    v_mov_b32 v152, 0
    v_mov_b32 v153, 0
    v_mov_b32 v154, 0
    v_mov_b32 v155, 0
    v_mov_b32 v156, 0
    v_mov_b32 v157, 0
    v_mov_b32 v158, 0
    v_mov_b32 v159, 0
    v_mov_b32 v160, 0
    v_mov_b32 v161, 0
    v_mov_b32 v162, 0
    v_mov_b32 v163, 0
    v_mov_b32 v164, 0
    v_mov_b32 v165, 0
    v_mov_b32 v166, 0
    v_mov_b32 v167, 0
    s_barrier
    ds_read_b64_tr_b16 v[176:177], v248 offset:0
    ds_read_b64_tr_b16 v[178:179], v248 offset:1024
    ds_read_b64_tr_b16 v[180:181], v249 offset:0
    ds_read_b64_tr_b16 v[182:183], v249 offset:1024
    ds_read_b64_tr_b16 v[184:185], v248 offset:8192
    ds_read_b64_tr_b16 v[186:187], v248 offset:9216
    ds_read_b64_tr_b16 v[188:189], v249 offset:8192
    ds_read_b64_tr_b16 v[190:191], v249 offset:9216
    ds_read_b128 v[216:219], v250 offset:16384
    ds_read_b128 v[220:223], v250 offset:27648
    ds_read_b128 v[224:227], v250 offset:17408
    ds_read_b128 v[228:231], v250 offset:28672
    s_waitcnt lgkmcnt(4)
    v_xor_b32 v208, 0x80008000, v184
    v_xor_b32 v209, 0x80008000, v185
    v_xor_b32 v210, 0x80008000, v186
    v_xor_b32 v211, 0x80008000, v187
    v_xor_b32 v212, 0x80008000, v188
    v_xor_b32 v213, 0x80008000, v189
    v_xor_b32 v214, 0x80008000, v190
    v_xor_b32 v215, 0x80008000, v191
    s_mov_b32 s46, 7
L_g_loop:
    s_barrier
    s_waitcnt lgkmcnt(2)
    v_mfma_f32_16x16x32_bf16 v[0:3], v[176:179], v[216:219], v[0:3]
    ds_read_b128 v[232:235], v250 offset:18432
    ds_read_b128 v[236:239], v250 offset:29696
    v_mfma_f32_16x16x32_bf16 v[4:7], v[180:183], v[216:219], v[4:7]
    v_mfma_f32_16x16x32_bf16 v[8:11], v[208:211], v[216:219], v[8:11]
    v_mfma_f32_16x16x32_bf16 v[12:15], v[212:215], v[216:219], v[12:15]
    v_mfma_f32_16x16x32_bf16 v[0:3], v[184:187], v[220:223], v[0:3]
    v_mfma_f32_16x16x32_bf16 v[4:7], v[188:191], v[220:223], v[4:7]
    v_mfma_f32_16x16x32_bf16 v[8:11], v[176:179], v[220:223], v[8:11]
    v_mfma_f32_16x16x32_bf16 v[12:15], v[180:183], v[220:223], v[12:15]
    s_waitcnt lgkmcnt(2)
    v_mfma_f32_16x16x32_bf16 v[16:19], v[176:179], v[224:227], v[16:19]
    ds_read_b128 v[240:243], v250 offset:19456
    ds_read_b128 v[244:247], v250 offset:30720
    v_mfma_f32_16x16x32_bf16 v[20:23], v[180:183], v[224:227], v[20:23]
    v_mfma_f32_16x16x32_bf16 v[24:27], v[208:211], v[224:227], v[24:27]
    v_mfma_f32_16x16x32_bf16 v[28:31], v[212:215], v[224:227], v[28:31]
    v_mfma_f32_16x16x32_bf16 v[16:19], v[184:187], v[228:231], v[16:19]
    v_mfma_f32_16x16x32_bf16 v[20:23], v[188:191], v[228:231], v[20:23]
    v_mfma_f32_16x16x32_bf16 v[24:27], v[176:179], v[228:231], v[24:27]
    v_mfma_f32_16x16x32_bf16 v[28:31], v[180:183], v[228:231], v[28:31]
    s_waitcnt lgkmcnt(2)
    v_mfma_f32_16x16x32_bf16 v[32:35], v[176:179], v[232:235], v[32:35]
    ds_read_b128 v[216:219], v250 offset:20480
    ds_read_b128 v[220:223], v250 offset:31744
    v_mfma_f32_16x16x32_bf16 v[36:39], v[180:183], v[232:235], v[36:39]
    v_mfma_f32_16x16x32_bf16 v[40:43], v[208:211], v[232:235], v[40:43]
    v_mfma_f32_16x16x32_bf16 v[44:47], v[212:215], v[232:235], v[44:47]
    v_mfma_f32_16x16x32_bf16 v[32:35], v[184:187], v[236:239], v[32:35]
    v_mfma_f32_16x16x32_bf16 v[36:39], v[188:191], v[236:239], v[36:39]
    v_mfma_f32_16x16x32_bf16 v[40:43], v[176:179], v[236:239], v[40:43]
    v_mfma_f32_16x16x32_bf16 v[44:47], v[180:183], v[236:239], v[44:47]
    s_waitcnt lgkmcnt(2)
    v_mfma_f32_16x16x32_bf16 v[48:51], v[176:179], v[240:243], v[48:51]
    ds_read_b128 v[224:227], v250 offset:21504
    ds_read_b128 v[228:231], v250 offset:32768
    v_mfma_f32_16x16x32_bf16 v[52:55], v[180:183], v[240:243], v[52:55]
    v_mfma_f32_16x16x32_bf16 v[56:59], v[208:211], v[240:243], v[56:59]
    v_mfma_f32_16x16x32_bf16 v[60:63], v[212:215], v[240:243], v[60:63]
    v_mfma_f32_16x16x32_bf16 v[48:51], v[184:187], v[244:247], v[48:51]
    v_mfma_f32_16x16x32_bf16 v[52:55], v[188:191], v[244:247], v[52:55]
    v_mfma_f32_16x16x32_bf16 v[56:59], v[176:179], v[244:247], v[56:59]
    v_mfma_f32_16x16x32_bf16 v[60:63], v[180:183], v[244:247], v[60:63]
    s_waitcnt lgkmcnt(2)
    v_mfma_f32_16x16x32_bf16 v[64:67], v[176:179], v[216:219], v[64:67]
    ds_read_b128 v[232:235], v250 offset:22528
    ds_read_b128 v[236:239], v250 offset:33792
    v_mfma_f32_16x16x32_bf16 v[68:71], v[180:183], v[216:219], v[68:71]
    v_mfma_f32_16x16x32_bf16 v[72:75], v[208:211], v[216:219], v[72:75]
    v_mfma_f32_16x16x32_bf16 v[76:79], v[212:215], v[216:219], v[76:79]
    v_mfma_f32_16x16x32_bf16 v[64:67], v[184:187], v[220:223], v[64:67]
    v_mfma_f32_16x16x32_bf16 v[68:71], v[188:191], v[220:223], v[68:71]
    v_mfma_f32_16x16x32_bf16 v[72:75], v[176:179], v[220:223], v[72:75]
    v_mfma_f32_16x16x32_bf16 v[76:79], v[180:183], v[220:223], v[76:79]
    s_waitcnt lgkmcnt(2)
    v_mfma_f32_16x16x32_bf16 v[80:83], v[176:179], v[224:227], v[80:83]
    ds_read_b128 v[240:243], v250 offset:23552
    ds_read_b128 v[244:247], v250 offset:34816
    v_mfma_f32_16x16x32_bf16 v[84:87], v[180:183], v[224:227], v[84:87]
    v_mfma_f32_16x16x32_bf16 v[88:91], v[208:211], v[224:227], v[88:91]
    v_mfma_f32_16x16x32_bf16 v[92:95], v[212:215], v[224:227], v[92:95]
    v_mfma_f32_16x16x32_bf16 v[80:83], v[184:187], v[228:231], v[80:83]
    v_add_u32 v248, 0x9800, v248
    v_add_u32 v249, 0x9800, v249
    v_mfma_f32_16x16x32_bf16 v[84:87], v[188:191], v[228:231], v[84:87]
    v_mfma_f32_16x16x32_bf16 v[88:91], v[176:179], v[228:231], v[88:91]
    v_mfma_f32_16x16x32_bf16 v[92:95], v[180:183], v[228:231], v[92:95]
    s_waitcnt lgkmcnt(2)
    v_mfma_f32_16x16x32_bf16 v[96:99], v[176:179], v[232:235], v[96:99]
    ds_read_b128 v[216:219], v250 offset:24576
    ds_read_b128 v[220:223], v250 offset:35840
    v_mfma_f32_16x16x32_bf16 v[100:103], v[180:183], v[232:235], v[100:103]
    v_mfma_f32_16x16x32_bf16 v[104:107], v[208:211], v[232:235], v[104:107]
    v_mfma_f32_16x16x32_bf16 v[108:111], v[212:215], v[232:235], v[108:111]
    ds_read_b64_tr_b16 v[192:193], v248 offset:0
    ds_read_b64_tr_b16 v[194:195], v248 offset:1024
    ds_read_b64_tr_b16 v[196:197], v249 offset:0
    ds_read_b64_tr_b16 v[198:199], v249 offset:1024
    v_mfma_f32_16x16x32_bf16 v[96:99], v[184:187], v[236:239], v[96:99]
    v_mfma_f32_16x16x32_bf16 v[100:103], v[188:191], v[236:239], v[100:103]
    v_mfma_f32_16x16x32_bf16 v[104:107], v[176:179], v[236:239], v[104:107]
    v_mfma_f32_16x16x32_bf16 v[108:111], v[180:183], v[236:239], v[108:111]
    s_waitcnt lgkmcnt(6)
    v_mfma_f32_16x16x32_bf16 v[112:115], v[176:179], v[240:243], v[112:115]
    ds_read_b128 v[224:227], v250 offset:25600
    ds_read_b128 v[228:231], v250 offset:36864
    v_mfma_f32_16x16x32_bf16 v[116:119], v[180:183], v[240:243], v[116:119]
    v_mfma_f32_16x16x32_bf16 v[120:123], v[208:211], v[240:243], v[120:123]
    v_mfma_f32_16x16x32_bf16 v[124:127], v[212:215], v[240:243], v[124:127]
    ds_read_b64_tr_b16 v[200:201], v248 offset:8192
    ds_read_b64_tr_b16 v[202:203], v248 offset:9216
    ds_read_b64_tr_b16 v[204:205], v249 offset:8192
    ds_read_b64_tr_b16 v[206:207], v249 offset:9216
    v_mfma_f32_16x16x32_bf16 v[112:115], v[184:187], v[244:247], v[112:115]
    v_mfma_f32_16x16x32_bf16 v[116:119], v[188:191], v[244:247], v[116:119]
    v_mfma_f32_16x16x32_bf16 v[120:123], v[176:179], v[244:247], v[120:123]
    v_mfma_f32_16x16x32_bf16 v[124:127], v[180:183], v[244:247], v[124:127]
    s_waitcnt lgkmcnt(10)
    v_mfma_f32_16x16x32_bf16 v[128:131], v[176:179], v[216:219], v[128:131]
    ds_read_b128 v[232:235], v250 offset:26624
    ds_read_b128 v[236:239], v250 offset:37888
    v_mfma_f32_16x16x32_bf16 v[132:135], v[180:183], v[216:219], v[132:135]
    v_mfma_f32_16x16x32_bf16 v[136:139], v[208:211], v[216:219], v[136:139]
    v_mfma_f32_16x16x32_bf16 v[140:143], v[212:215], v[216:219], v[140:143]
    v_mfma_f32_16x16x32_bf16 v[128:131], v[184:187], v[220:223], v[128:131]
    v_mfma_f32_16x16x32_bf16 v[132:135], v[188:191], v[220:223], v[132:135]
    v_mfma_f32_16x16x32_bf16 v[136:139], v[176:179], v[220:223], v[136:139]
    v_mfma_f32_16x16x32_bf16 v[140:143], v[180:183], v[220:223], v[140:143]
    s_waitcnt lgkmcnt(6)
    v_mfma_f32_16x16x32_bf16 v[144:147], v[176:179], v[224:227], v[144:147]
    v_add_u32 v250, 0x9800, v250
    ds_read_b128 v[240:243], v250 offset:16384
    ds_read_b128 v[244:247], v250 offset:27648
    v_mfma_f32_16x16x32_bf16 v[148:151], v[180:183], v[224:227], v[148:151]
    v_mfma_f32_16x16x32_bf16 v[152:155], v[208:211], v[224:227], v[152:155]
    v_mfma_f32_16x16x32_bf16 v[156:159], v[212:215], v[224:227], v[156:159]
    v_mfma_f32_16x16x32_bf16 v[144:147], v[184:187], v[228:231], v[144:147]
    s_waitcnt lgkmcnt(4)
    v_xor_b32 v212, 0x80008000, v204
    v_xor_b32 v213, 0x80008000, v205
    v_mfma_f32_16x16x32_bf16 v[148:151], v[188:191], v[228:231], v[148:151]
    v_xor_b32 v214, 0x80008000, v206
    v_xor_b32 v215, 0x80008000, v207
    v_mfma_f32_16x16x32_bf16 v[152:155], v[176:179], v[228:231], v[152:155]
    v_mfma_f32_16x16x32_bf16 v[156:159], v[180:183], v[228:231], v[156:159]
    s_waitcnt lgkmcnt(2)
    v_mfma_f32_16x16x32_bf16 v[160:163], v[176:179], v[232:235], v[160:163]
    ds_read_b128 v[216:219], v250 offset:17408
    ds_read_b128 v[220:223], v250 offset:28672
    v_mfma_f32_16x16x32_bf16 v[164:167], v[208:211], v[232:235], v[164:167]
    v_xor_b32 v208, 0x80008000, v200
    v_xor_b32 v209, 0x80008000, v201
    v_mfma_f32_16x16x32_bf16 v[160:163], v[184:187], v[236:239], v[160:163]
    v_xor_b32 v210, 0x80008000, v202
    v_xor_b32 v211, 0x80008000, v203
    v_mfma_f32_16x16x32_bf16 v[164:167], v[176:179], v[236:239], v[164:167]
    s_barrier
    s_waitcnt lgkmcnt(2)
    v_mfma_f32_16x16x32_bf16 v[0:3], v[192:195], v[240:243], v[0:3]
    ds_read_b128 v[224:227], v250 offset:18432
    ds_read_b128 v[228:231], v250 offset:29696
    v_mfma_f32_16x16x32_bf16 v[4:7], v[196:199], v[240:243], v[4:7]
    v_mfma_f32_16x16x32_bf16 v[8:11], v[208:211], v[240:243], v[8:11]
    v_mfma_f32_16x16x32_bf16 v[12:15], v[212:215], v[240:243], v[12:15]
    v_mfma_f32_16x16x32_bf16 v[0:3], v[200:203], v[244:247], v[0:3]
    v_mfma_f32_16x16x32_bf16 v[4:7], v[204:207], v[244:247], v[4:7]
    v_mfma_f32_16x16x32_bf16 v[8:11], v[192:195], v[244:247], v[8:11]
    v_mfma_f32_16x16x32_bf16 v[12:15], v[196:199], v[244:247], v[12:15]
    s_waitcnt lgkmcnt(2)
    v_mfma_f32_16x16x32_bf16 v[16:19], v[192:195], v[216:219], v[16:19]
    ds_read_b128 v[232:235], v250 offset:19456
    ds_read_b128 v[236:239], v250 offset:30720
    v_mfma_f32_16x16x32_bf16 v[20:23], v[196:199], v[216:219], v[20:23]
    v_mfma_f32_16x16x32_bf16 v[24:27], v[208:211], v[216:219], v[24:27]
    v_mfma_f32_16x16x32_bf16 v[28:31], v[212:215], v[216:219], v[28:31]
    v_mfma_f32_16x16x32_bf16 v[16:19], v[200:203], v[220:223], v[16:19]
    v_mfma_f32_16x16x32_bf16 v[20:23], v[204:207], v[220:223], v[20:23]
    v_mfma_f32_16x16x32_bf16 v[24:27], v[192:195], v[220:223], v[24:27]
    v_mfma_f32_16x16x32_bf16 v[28:31], v[196:199], v[220:223], v[28:31]
    s_waitcnt lgkmcnt(2)
    v_mfma_f32_16x16x32_bf16 v[32:35], v[192:195], v[224:227], v[32:35]
    ds_read_b128 v[240:243], v250 offset:20480
    ds_read_b128 v[244:247], v250 offset:31744
    v_mfma_f32_16x16x32_bf16 v[36:39], v[196:199], v[224:227], v[36:39]
    v_mfma_f32_16x16x32_bf16 v[40:43], v[208:211], v[224:227], v[40:43]
    v_mfma_f32_16x16x32_bf16 v[44:47], v[212:215], v[224:227], v[44:47]
    v_mfma_f32_16x16x32_bf16 v[32:35], v[200:203], v[228:231], v[32:35]
    v_mfma_f32_16x16x32_bf16 v[36:39], v[204:207], v[228:231], v[36:39]
    v_mfma_f32_16x16x32_bf16 v[40:43], v[192:195], v[228:231], v[40:43]
    v_mfma_f32_16x16x32_bf16 v[44:47], v[196:199], v[228:231], v[44:47]
    s_waitcnt lgkmcnt(2)
    v_mfma_f32_16x16x32_bf16 v[48:51], v[192:195], v[232:235], v[48:51]
    ds_read_b128 v[216:219], v250 offset:21504
    ds_read_b128 v[220:223], v250 offset:32768
    v_mfma_f32_16x16x32_bf16 v[52:55], v[196:199], v[232:235], v[52:55]
    v_mfma_f32_16x16x32_bf16 v[56:59], v[208:211], v[232:235], v[56:59]
    v_mfma_f32_16x16x32_bf16 v[60:63], v[212:215], v[232:235], v[60:63]
    v_mfma_f32_16x16x32_bf16 v[48:51], v[200:203], v[236:239], v[48:51]
    v_mfma_f32_16x16x32_bf16 v[52:55], v[204:207], v[236:239], v[52:55]
    v_mfma_f32_16x16x32_bf16 v[56:59], v[192:195], v[236:239], v[56:59]
    v_mfma_f32_16x16x32_bf16 v[60:63], v[196:199], v[236:239], v[60:63]
    s_waitcnt lgkmcnt(2)
    v_mfma_f32_16x16x32_bf16 v[64:67], v[192:195], v[240:243], v[64:67]
    ds_read_b128 v[224:227], v250 offset:22528
    ds_read_b128 v[228:231], v250 offset:33792
    v_mfma_f32_16x16x32_bf16 v[68:71], v[196:199], v[240:243], v[68:71]
    v_mfma_f32_16x16x32_bf16 v[72:75], v[208:211], v[240:243], v[72:75]
    v_mfma_f32_16x16x32_bf16 v[76:79], v[212:215], v[240:243], v[76:79]
    v_mfma_f32_16x16x32_bf16 v[64:67], v[200:203], v[244:247], v[64:67]
    v_mfma_f32_16x16x32_bf16 v[68:71], v[204:207], v[244:247], v[68:71]
    v_mfma_f32_16x16x32_bf16 v[72:75], v[192:195], v[244:247], v[72:75]
    v_mfma_f32_16x16x32_bf16 v[76:79], v[196:199], v[244:247], v[76:79]
    s_waitcnt lgkmcnt(2)
    v_mfma_f32_16x16x32_bf16 v[80:83], v[192:195], v[216:219], v[80:83]
    ds_read_b128 v[232:235], v250 offset:23552
    ds_read_b128 v[236:239], v250 offset:34816
    v_mfma_f32_16x16x32_bf16 v[84:87], v[196:199], v[216:219], v[84:87]
    v_mfma_f32_16x16x32_bf16 v[88:91], v[208:211], v[216:219], v[88:91]
    v_mfma_f32_16x16x32_bf16 v[92:95], v[212:215], v[216:219], v[92:95]
    v_mfma_f32_16x16x32_bf16 v[80:83], v[200:203], v[220:223], v[80:83]
    v_add_u32 v248, 0x9800, v248
    v_add_u32 v249, 0x9800, v249
    v_mfma_f32_16x16x32_bf16 v[84:87], v[204:207], v[220:223], v[84:87]
    v_mfma_f32_16x16x32_bf16 v[88:91], v[192:195], v[220:223], v[88:91]
    v_mfma_f32_16x16x32_bf16 v[92:95], v[196:199], v[220:223], v[92:95]
    s_waitcnt lgkmcnt(2)
    v_mfma_f32_16x16x32_bf16 v[96:99], v[192:195], v[224:227], v[96:99]
    ds_read_b128 v[240:243], v250 offset:24576
    ds_read_b128 v[244:247], v250 offset:35840
    v_mfma_f32_16x16x32_bf16 v[100:103], v[196:199], v[224:227], v[100:103]
    v_mfma_f32_16x16x32_bf16 v[104:107], v[208:211], v[224:227], v[104:107]
    v_mfma_f32_16x16x32_bf16 v[108:111], v[212:215], v[224:227], v[108:111]
    ds_read_b64_tr_b16 v[176:177], v248 offset:0
    ds_read_b64_tr_b16 v[178:179], v248 offset:1024
    ds_read_b64_tr_b16 v[180:181], v249 offset:0
    ds_read_b64_tr_b16 v[182:183], v249 offset:1024
    v_mfma_f32_16x16x32_bf16 v[96:99], v[200:203], v[228:231], v[96:99]
    v_mfma_f32_16x16x32_bf16 v[100:103], v[204:207], v[228:231], v[100:103]
    v_mfma_f32_16x16x32_bf16 v[104:107], v[192:195], v[228:231], v[104:107]
    v_mfma_f32_16x16x32_bf16 v[108:111], v[196:199], v[228:231], v[108:111]
    s_waitcnt lgkmcnt(6)
    v_mfma_f32_16x16x32_bf16 v[112:115], v[192:195], v[232:235], v[112:115]
    ds_read_b128 v[216:219], v250 offset:25600
    ds_read_b128 v[220:223], v250 offset:36864
    v_mfma_f32_16x16x32_bf16 v[116:119], v[196:199], v[232:235], v[116:119]
    v_mfma_f32_16x16x32_bf16 v[120:123], v[208:211], v[232:235], v[120:123]
    v_mfma_f32_16x16x32_bf16 v[124:127], v[212:215], v[232:235], v[124:127]
    ds_read_b64_tr_b16 v[184:185], v248 offset:8192
    ds_read_b64_tr_b16 v[186:187], v248 offset:9216
    ds_read_b64_tr_b16 v[188:189], v249 offset:8192
    ds_read_b64_tr_b16 v[190:191], v249 offset:9216
    v_mfma_f32_16x16x32_bf16 v[112:115], v[200:203], v[236:239], v[112:115]
    v_mfma_f32_16x16x32_bf16 v[116:119], v[204:207], v[236:239], v[116:119]
    v_mfma_f32_16x16x32_bf16 v[120:123], v[192:195], v[236:239], v[120:123]
    v_mfma_f32_16x16x32_bf16 v[124:127], v[196:199], v[236:239], v[124:127]
    s_waitcnt lgkmcnt(10)
    v_mfma_f32_16x16x32_bf16 v[128:131], v[192:195], v[240:243], v[128:131]
    ds_read_b128 v[224:227], v250 offset:26624
    ds_read_b128 v[228:231], v250 offset:37888
    v_mfma_f32_16x16x32_bf16 v[132:135], v[196:199], v[240:243], v[132:135]
    v_mfma_f32_16x16x32_bf16 v[136:139], v[208:211], v[240:243], v[136:139]
    v_mfma_f32_16x16x32_bf16 v[140:143], v[212:215], v[240:243], v[140:143]
    v_mfma_f32_16x16x32_bf16 v[128:131], v[200:203], v[244:247], v[128:131]
    v_mfma_f32_16x16x32_bf16 v[132:135], v[204:207], v[244:247], v[132:135]
    v_mfma_f32_16x16x32_bf16 v[136:139], v[192:195], v[244:247], v[136:139]
    v_mfma_f32_16x16x32_bf16 v[140:143], v[196:199], v[244:247], v[140:143]
    s_waitcnt lgkmcnt(6)
    v_mfma_f32_16x16x32_bf16 v[144:147], v[192:195], v[216:219], v[144:147]
    v_add_u32 v250, 0x9800, v250
    ds_read_b128 v[232:235], v250 offset:16384
    ds_read_b128 v[236:239], v250 offset:27648
    v_mfma_f32_16x16x32_bf16 v[148:151], v[196:199], v[216:219], v[148:151]
    v_mfma_f32_16x16x32_bf16 v[152:155], v[208:211], v[216:219], v[152:155]
    v_mfma_f32_16x16x32_bf16 v[156:159], v[212:215], v[216:219], v[156:159]
    v_mfma_f32_16x16x32_bf16 v[144:147], v[200:203], v[220:223], v[144:147]
    s_waitcnt lgkmcnt(4)
    v_xor_b32 v212, 0x80008000, v188
    v_xor_b32 v213, 0x80008000, v189
    v_mfma_f32_16x16x32_bf16 v[148:151], v[204:207], v[220:223], v[148:151]
    v_xor_b32 v214, 0x80008000, v190
    v_xor_b32 v215, 0x80008000, v191
    v_mfma_f32_16x16x32_bf16 v[152:155], v[192:195], v[220:223], v[152:155]
    v_mfma_f32_16x16x32_bf16 v[156:159], v[196:199], v[220:223], v[156:159]
    s_waitcnt lgkmcnt(2)
    v_mfma_f32_16x16x32_bf16 v[160:163], v[192:195], v[224:227], v[160:163]
    ds_read_b128 v[240:243], v250 offset:17408
    ds_read_b128 v[244:247], v250 offset:28672
    v_mfma_f32_16x16x32_bf16 v[164:167], v[208:211], v[224:227], v[164:167]
    v_xor_b32 v208, 0x80008000, v184
    v_xor_b32 v209, 0x80008000, v185
    v_mfma_f32_16x16x32_bf16 v[160:163], v[200:203], v[228:231], v[160:163]
    v_xor_b32 v210, 0x80008000, v186
    v_xor_b32 v211, 0x80008000, v187
    v_mfma_f32_16x16x32_bf16 v[164:167], v[192:195], v[228:231], v[164:167]
    s_barrier
    s_waitcnt lgkmcnt(2)
    v_mfma_f32_16x16x32_bf16 v[0:3], v[176:179], v[232:235], v[0:3]
    ds_read_b128 v[216:219], v250 offset:18432
    ds_read_b128 v[220:223], v250 offset:29696
    v_mfma_f32_16x16x32_bf16 v[4:7], v[180:183], v[232:235], v[4:7]
    v_mfma_f32_16x16x32_bf16 v[8:11], v[208:211], v[232:235], v[8:11]
    v_mfma_f32_16x16x32_bf16 v[12:15], v[212:215], v[232:235], v[12:15]
    v_mfma_f32_16x16x32_bf16 v[0:3], v[184:187], v[236:239], v[0:3]
    v_mfma_f32_16x16x32_bf16 v[4:7], v[188:191], v[236:239], v[4:7]
    v_mfma_f32_16x16x32_bf16 v[8:11], v[176:179], v[236:239], v[8:11]
    v_mfma_f32_16x16x32_bf16 v[12:15], v[180:183], v[236:239], v[12:15]
    s_waitcnt lgkmcnt(2)
    v_mfma_f32_16x16x32_bf16 v[16:19], v[176:179], v[240:243], v[16:19]
    ds_read_b128 v[224:227], v250 offset:19456
    ds_read_b128 v[228:231], v250 offset:30720
    v_mfma_f32_16x16x32_bf16 v[20:23], v[180:183], v[240:243], v[20:23]
    v_mfma_f32_16x16x32_bf16 v[24:27], v[208:211], v[240:243], v[24:27]
    v_mfma_f32_16x16x32_bf16 v[28:31], v[212:215], v[240:243], v[28:31]
    v_mfma_f32_16x16x32_bf16 v[16:19], v[184:187], v[244:247], v[16:19]
    v_mfma_f32_16x16x32_bf16 v[20:23], v[188:191], v[244:247], v[20:23]
    v_mfma_f32_16x16x32_bf16 v[24:27], v[176:179], v[244:247], v[24:27]
    v_mfma_f32_16x16x32_bf16 v[28:31], v[180:183], v[244:247], v[28:31]
    s_waitcnt lgkmcnt(2)
    v_mfma_f32_16x16x32_bf16 v[32:35], v[176:179], v[216:219], v[32:35]
    ds_read_b128 v[232:235], v250 offset:20480
    ds_read_b128 v[236:239], v250 offset:31744
    v_mfma_f32_16x16x32_bf16 v[36:39], v[180:183], v[216:219], v[36:39]
    v_mfma_f32_16x16x32_bf16 v[40:43], v[208:211], v[216:219], v[40:43]
    v_mfma_f32_16x16x32_bf16 v[44:47], v[212:215], v[216:219], v[44:47]
    v_mfma_f32_16x16x32_bf16 v[32:35], v[184:187], v[220:223], v[32:35]
    v_mfma_f32_16x16x32_bf16 v[36:39], v[188:191], v[220:223], v[36:39]
    v_mfma_f32_16x16x32_bf16 v[40:43], v[176:179], v[220:223], v[40:43]
    v_mfma_f32_16x16x32_bf16 v[44:47], v[180:183], v[220:223], v[44:47]
    s_waitcnt lgkmcnt(2)
    v_mfma_f32_16x16x32_bf16 v[48:51], v[176:179], v[224:227], v[48:51]
    ds_read_b128 v[240:243], v250 offset:21504
    ds_read_b128 v[244:247], v250 offset:32768
    v_mfma_f32_16x16x32_bf16 v[52:55], v[180:183], v[224:227], v[52:55]
    v_mfma_f32_16x16x32_bf16 v[56:59], v[208:211], v[224:227], v[56:59]
    v_mfma_f32_16x16x32_bf16 v[60:63], v[212:215], v[224:227], v[60:63]
    v_mfma_f32_16x16x32_bf16 v[48:51], v[184:187], v[228:231], v[48:51]
    v_mfma_f32_16x16x32_bf16 v[52:55], v[188:191], v[228:231], v[52:55]
    v_mfma_f32_16x16x32_bf16 v[56:59], v[176:179], v[228:231], v[56:59]
    v_mfma_f32_16x16x32_bf16 v[60:63], v[180:183], v[228:231], v[60:63]
    s_waitcnt lgkmcnt(2)
    v_mfma_f32_16x16x32_bf16 v[64:67], v[176:179], v[232:235], v[64:67]
    ds_read_b128 v[216:219], v250 offset:22528
    ds_read_b128 v[220:223], v250 offset:33792
    v_mfma_f32_16x16x32_bf16 v[68:71], v[180:183], v[232:235], v[68:71]
    v_mfma_f32_16x16x32_bf16 v[72:75], v[208:211], v[232:235], v[72:75]
    v_mfma_f32_16x16x32_bf16 v[76:79], v[212:215], v[232:235], v[76:79]
    v_mfma_f32_16x16x32_bf16 v[64:67], v[184:187], v[236:239], v[64:67]
    v_mfma_f32_16x16x32_bf16 v[68:71], v[188:191], v[236:239], v[68:71]
    v_mfma_f32_16x16x32_bf16 v[72:75], v[176:179], v[236:239], v[72:75]
    v_mfma_f32_16x16x32_bf16 v[76:79], v[180:183], v[236:239], v[76:79]
    s_waitcnt lgkmcnt(2)
    v_mfma_f32_16x16x32_bf16 v[80:83], v[176:179], v[240:243], v[80:83]
    ds_read_b128 v[224:227], v250 offset:23552
    ds_read_b128 v[228:231], v250 offset:34816
    v_mfma_f32_16x16x32_bf16 v[84:87], v[180:183], v[240:243], v[84:87]
    v_mfma_f32_16x16x32_bf16 v[88:91], v[208:211], v[240:243], v[88:91]
    v_mfma_f32_16x16x32_bf16 v[92:95], v[212:215], v[240:243], v[92:95]
    v_mfma_f32_16x16x32_bf16 v[80:83], v[184:187], v[244:247], v[80:83]
    v_add_u32 v248, 0x9800, v248
    v_add_u32 v249, 0x9800, v249
    v_mfma_f32_16x16x32_bf16 v[84:87], v[188:191], v[244:247], v[84:87]
    v_mfma_f32_16x16x32_bf16 v[88:91], v[176:179], v[244:247], v[88:91]
    v_mfma_f32_16x16x32_bf16 v[92:95], v[180:183], v[244:247], v[92:95]
    s_waitcnt lgkmcnt(2)
    v_mfma_f32_16x16x32_bf16 v[96:99], v[176:179], v[216:219], v[96:99]
    ds_read_b128 v[232:235], v250 offset:24576
    ds_read_b128 v[236:239], v250 offset:35840
    v_mfma_f32_16x16x32_bf16 v[100:103], v[180:183], v[216:219], v[100:103]
    v_mfma_f32_16x16x32_bf16 v[104:107], v[208:211], v[216:219], v[104:107]
    v_mfma_f32_16x16x32_bf16 v[108:111], v[212:215], v[216:219], v[108:111]
    ds_read_b64_tr_b16 v[192:193], v248 offset:0
    ds_read_b64_tr_b16 v[194:195], v248 offset:1024
    ds_read_b64_tr_b16 v[196:197], v249 offset:0
    ds_read_b64_tr_b16 v[198:199], v249 offset:1024
    v_mfma_f32_16x16x32_bf16 v[96:99], v[184:187], v[220:223], v[96:99]
    v_mfma_f32_16x16x32_bf16 v[100:103], v[188:191], v[220:223], v[100:103]
    v_mfma_f32_16x16x32_bf16 v[104:107], v[176:179], v[220:223], v[104:107]
    v_mfma_f32_16x16x32_bf16 v[108:111], v[180:183], v[220:223], v[108:111]
    s_waitcnt lgkmcnt(6)
    v_mfma_f32_16x16x32_bf16 v[112:115], v[176:179], v[224:227], v[112:115]
    ds_read_b128 v[240:243], v250 offset:25600
    ds_read_b128 v[244:247], v250 offset:36864
    v_mfma_f32_16x16x32_bf16 v[116:119], v[180:183], v[224:227], v[116:119]
    v_mfma_f32_16x16x32_bf16 v[120:123], v[208:211], v[224:227], v[120:123]
    v_mfma_f32_16x16x32_bf16 v[124:127], v[212:215], v[224:227], v[124:127]
    ds_read_b64_tr_b16 v[200:201], v248 offset:8192
    ds_read_b64_tr_b16 v[202:203], v248 offset:9216
    ds_read_b64_tr_b16 v[204:205], v249 offset:8192
    ds_read_b64_tr_b16 v[206:207], v249 offset:9216
    v_mfma_f32_16x16x32_bf16 v[112:115], v[184:187], v[228:231], v[112:115]
    v_mfma_f32_16x16x32_bf16 v[116:119], v[188:191], v[228:231], v[116:119]
    v_mfma_f32_16x16x32_bf16 v[120:123], v[176:179], v[228:231], v[120:123]
    v_mfma_f32_16x16x32_bf16 v[124:127], v[180:183], v[228:231], v[124:127]
    s_waitcnt lgkmcnt(10)
    v_mfma_f32_16x16x32_bf16 v[128:131], v[176:179], v[232:235], v[128:131]
    ds_read_b128 v[216:219], v250 offset:26624
    ds_read_b128 v[220:223], v250 offset:37888
    v_mfma_f32_16x16x32_bf16 v[132:135], v[180:183], v[232:235], v[132:135]
    v_mfma_f32_16x16x32_bf16 v[136:139], v[208:211], v[232:235], v[136:139]
    v_mfma_f32_16x16x32_bf16 v[140:143], v[212:215], v[232:235], v[140:143]
    v_mfma_f32_16x16x32_bf16 v[128:131], v[184:187], v[236:239], v[128:131]
    v_mfma_f32_16x16x32_bf16 v[132:135], v[188:191], v[236:239], v[132:135]
    v_mfma_f32_16x16x32_bf16 v[136:139], v[176:179], v[236:239], v[136:139]
    v_mfma_f32_16x16x32_bf16 v[140:143], v[180:183], v[236:239], v[140:143]
    s_waitcnt lgkmcnt(6)
    v_mfma_f32_16x16x32_bf16 v[144:147], v[176:179], v[240:243], v[144:147]
    v_add_u32 v250, 0x9800, v250
    ds_read_b128 v[224:227], v250 offset:16384
    ds_read_b128 v[228:231], v250 offset:27648
    v_mfma_f32_16x16x32_bf16 v[148:151], v[180:183], v[240:243], v[148:151]
    v_mfma_f32_16x16x32_bf16 v[152:155], v[208:211], v[240:243], v[152:155]
    v_mfma_f32_16x16x32_bf16 v[156:159], v[212:215], v[240:243], v[156:159]
    v_mfma_f32_16x16x32_bf16 v[144:147], v[184:187], v[244:247], v[144:147]
    s_waitcnt lgkmcnt(4)
    v_xor_b32 v212, 0x80008000, v204
    v_xor_b32 v213, 0x80008000, v205
    v_mfma_f32_16x16x32_bf16 v[148:151], v[188:191], v[244:247], v[148:151]
    v_xor_b32 v214, 0x80008000, v206
    v_xor_b32 v215, 0x80008000, v207
    v_mfma_f32_16x16x32_bf16 v[152:155], v[176:179], v[244:247], v[152:155]
    v_mfma_f32_16x16x32_bf16 v[156:159], v[180:183], v[244:247], v[156:159]
    s_waitcnt lgkmcnt(2)
    v_mfma_f32_16x16x32_bf16 v[160:163], v[176:179], v[216:219], v[160:163]
    ds_read_b128 v[232:235], v250 offset:17408
    ds_read_b128 v[236:239], v250 offset:28672
    v_mfma_f32_16x16x32_bf16 v[164:167], v[208:211], v[216:219], v[164:167]
    v_xor_b32 v208, 0x80008000, v200
    v_xor_b32 v209, 0x80008000, v201
    v_mfma_f32_16x16x32_bf16 v[160:163], v[184:187], v[220:223], v[160:163]
    v_xor_b32 v210, 0x80008000, v202
    v_xor_b32 v211, 0x80008000, v203
    v_mfma_f32_16x16x32_bf16 v[164:167], v[176:179], v[220:223], v[164:167]
    s_barrier
    s_waitcnt lgkmcnt(2)
    v_mfma_f32_16x16x32_bf16 v[0:3], v[192:195], v[224:227], v[0:3]
    ds_read_b128 v[240:243], v250 offset:18432
    ds_read_b128 v[244:247], v250 offset:29696
    v_mfma_f32_16x16x32_bf16 v[4:7], v[196:199], v[224:227], v[4:7]
    v_mfma_f32_16x16x32_bf16 v[8:11], v[208:211], v[224:227], v[8:11]
    v_mfma_f32_16x16x32_bf16 v[12:15], v[212:215], v[224:227], v[12:15]
    v_mfma_f32_16x16x32_bf16 v[0:3], v[200:203], v[228:231], v[0:3]
    v_mfma_f32_16x16x32_bf16 v[4:7], v[204:207], v[228:231], v[4:7]
    v_mfma_f32_16x16x32_bf16 v[8:11], v[192:195], v[228:231], v[8:11]
    v_mfma_f32_16x16x32_bf16 v[12:15], v[196:199], v[228:231], v[12:15]
    s_waitcnt lgkmcnt(2)
    v_mfma_f32_16x16x32_bf16 v[16:19], v[192:195], v[232:235], v[16:19]
    ds_read_b128 v[216:219], v250 offset:19456
    ds_read_b128 v[220:223], v250 offset:30720
    v_mfma_f32_16x16x32_bf16 v[20:23], v[196:199], v[232:235], v[20:23]
    v_mfma_f32_16x16x32_bf16 v[24:27], v[208:211], v[232:235], v[24:27]
    v_mfma_f32_16x16x32_bf16 v[28:31], v[212:215], v[232:235], v[28:31]
    v_mfma_f32_16x16x32_bf16 v[16:19], v[200:203], v[236:239], v[16:19]
    v_mfma_f32_16x16x32_bf16 v[20:23], v[204:207], v[236:239], v[20:23]
    v_mfma_f32_16x16x32_bf16 v[24:27], v[192:195], v[236:239], v[24:27]
    v_mfma_f32_16x16x32_bf16 v[28:31], v[196:199], v[236:239], v[28:31]
    s_waitcnt lgkmcnt(2)
    v_mfma_f32_16x16x32_bf16 v[32:35], v[192:195], v[240:243], v[32:35]
    ds_read_b128 v[224:227], v250 offset:20480
    ds_read_b128 v[228:231], v250 offset:31744
    v_mfma_f32_16x16x32_bf16 v[36:39], v[196:199], v[240:243], v[36:39]
    v_mfma_f32_16x16x32_bf16 v[40:43], v[208:211], v[240:243], v[40:43]
    v_mfma_f32_16x16x32_bf16 v[44:47], v[212:215], v[240:243], v[44:47]
    v_mfma_f32_16x16x32_bf16 v[32:35], v[200:203], v[244:247], v[32:35]
    v_mfma_f32_16x16x32_bf16 v[36:39], v[204:207], v[244:247], v[36:39]
    v_mfma_f32_16x16x32_bf16 v[40:43], v[192:195], v[244:247], v[40:43]
    v_mfma_f32_16x16x32_bf16 v[44:47], v[196:199], v[244:247], v[44:47]
    s_waitcnt lgkmcnt(2)
    v_mfma_f32_16x16x32_bf16 v[48:51], v[192:195], v[216:219], v[48:51]
    ds_read_b128 v[232:235], v250 offset:21504
    ds_read_b128 v[236:239], v250 offset:32768
    v_mfma_f32_16x16x32_bf16 v[52:55], v[196:199], v[216:219], v[52:55]
    v_mfma_f32_16x16x32_bf16 v[56:59], v[208:211], v[216:219], v[56:59]
    v_mfma_f32_16x16x32_bf16 v[60:63], v[212:215], v[216:219], v[60:63]
    v_mfma_f32_16x16x32_bf16 v[48:51], v[200:203], v[220:223], v[48:51]
    v_mfma_f32_16x16x32_bf16 v[52:55], v[204:207], v[220:223], v[52:55]
    v_mfma_f32_16x16x32_bf16 v[56:59], v[192:195], v[220:223], v[56:59]
    v_mfma_f32_16x16x32_bf16 v[60:63], v[196:199], v[220:223], v[60:63]
    s_waitcnt lgkmcnt(2)
    v_mfma_f32_16x16x32_bf16 v[64:67], v[192:195], v[224:227], v[64:67]
    ds_read_b128 v[240:243], v250 offset:22528
    ds_read_b128 v[244:247], v250 offset:33792
    v_mfma_f32_16x16x32_bf16 v[68:71], v[196:199], v[224:227], v[68:71]
    v_mfma_f32_16x16x32_bf16 v[72:75], v[208:211], v[224:227], v[72:75]
    v_mfma_f32_16x16x32_bf16 v[76:79], v[212:215], v[224:227], v[76:79]
    v_mfma_f32_16x16x32_bf16 v[64:67], v[200:203], v[228:231], v[64:67]
    v_mfma_f32_16x16x32_bf16 v[68:71], v[204:207], v[228:231], v[68:71]
    v_mfma_f32_16x16x32_bf16 v[72:75], v[192:195], v[228:231], v[72:75]
    v_mfma_f32_16x16x32_bf16 v[76:79], v[196:199], v[228:231], v[76:79]
    s_waitcnt lgkmcnt(2)
    v_mfma_f32_16x16x32_bf16 v[80:83], v[192:195], v[232:235], v[80:83]
    ds_read_b128 v[216:219], v250 offset:23552
    ds_read_b128 v[220:223], v250 offset:34816
    v_mfma_f32_16x16x32_bf16 v[84:87], v[196:199], v[232:235], v[84:87]
    v_mfma_f32_16x16x32_bf16 v[88:91], v[208:211], v[232:235], v[88:91]
    v_mfma_f32_16x16x32_bf16 v[92:95], v[212:215], v[232:235], v[92:95]
    v_mfma_f32_16x16x32_bf16 v[80:83], v[200:203], v[236:239], v[80:83]
    v_add_u32 v248, 0xfffe3800, v248
    v_add_u32 v249, 0xfffe3800, v249
    v_mfma_f32_16x16x32_bf16 v[84:87], v[204:207], v[236:239], v[84:87]
    v_mfma_f32_16x16x32_bf16 v[88:91], v[192:195], v[236:239], v[88:91]
    v_mfma_f32_16x16x32_bf16 v[92:95], v[196:199], v[236:239], v[92:95]
    s_waitcnt lgkmcnt(2)
    v_mfma_f32_16x16x32_bf16 v[96:99], v[192:195], v[240:243], v[96:99]
    ds_read_b128 v[224:227], v250 offset:24576
    ds_read_b128 v[228:231], v250 offset:35840
    v_mfma_f32_16x16x32_bf16 v[100:103], v[196:199], v[240:243], v[100:103]
    v_mfma_f32_16x16x32_bf16 v[104:107], v[208:211], v[240:243], v[104:107]
    v_mfma_f32_16x16x32_bf16 v[108:111], v[212:215], v[240:243], v[108:111]
    ds_read_b64_tr_b16 v[176:177], v248 offset:0
    ds_read_b64_tr_b16 v[178:179], v248 offset:1024
    ds_read_b64_tr_b16 v[180:181], v249 offset:0
    ds_read_b64_tr_b16 v[182:183], v249 offset:1024
    v_mfma_f32_16x16x32_bf16 v[96:99], v[200:203], v[244:247], v[96:99]
    v_mfma_f32_16x16x32_bf16 v[100:103], v[204:207], v[244:247], v[100:103]
    v_mfma_f32_16x16x32_bf16 v[104:107], v[192:195], v[244:247], v[104:107]
    v_mfma_f32_16x16x32_bf16 v[108:111], v[196:199], v[244:247], v[108:111]
    s_waitcnt lgkmcnt(6)
    v_mfma_f32_16x16x32_bf16 v[112:115], v[192:195], v[216:219], v[112:115]
    ds_read_b128 v[232:235], v250 offset:25600
    ds_read_b128 v[236:239], v250 offset:36864
    v_mfma_f32_16x16x32_bf16 v[116:119], v[196:199], v[216:219], v[116:119]
    v_mfma_f32_16x16x32_bf16 v[120:123], v[208:211], v[216:219], v[120:123]
    v_mfma_f32_16x16x32_bf16 v[124:127], v[212:215], v[216:219], v[124:127]
    ds_read_b64_tr_b16 v[184:185], v248 offset:8192
    ds_read_b64_tr_b16 v[186:187], v248 offset:9216
    ds_read_b64_tr_b16 v[188:189], v249 offset:8192
    ds_read_b64_tr_b16 v[190:191], v249 offset:9216
    v_mfma_f32_16x16x32_bf16 v[112:115], v[200:203], v[220:223], v[112:115]
    v_mfma_f32_16x16x32_bf16 v[116:119], v[204:207], v[220:223], v[116:119]
    v_mfma_f32_16x16x32_bf16 v[120:123], v[192:195], v[220:223], v[120:123]
    v_mfma_f32_16x16x32_bf16 v[124:127], v[196:199], v[220:223], v[124:127]
    s_waitcnt lgkmcnt(10)
    v_mfma_f32_16x16x32_bf16 v[128:131], v[192:195], v[224:227], v[128:131]
    ds_read_b128 v[240:243], v250 offset:26624
    ds_read_b128 v[244:247], v250 offset:37888
    v_mfma_f32_16x16x32_bf16 v[132:135], v[196:199], v[224:227], v[132:135]
    v_mfma_f32_16x16x32_bf16 v[136:139], v[208:211], v[224:227], v[136:139]
    v_mfma_f32_16x16x32_bf16 v[140:143], v[212:215], v[224:227], v[140:143]
    v_mfma_f32_16x16x32_bf16 v[128:131], v[200:203], v[228:231], v[128:131]
    v_mfma_f32_16x16x32_bf16 v[132:135], v[204:207], v[228:231], v[132:135]
    v_mfma_f32_16x16x32_bf16 v[136:139], v[192:195], v[228:231], v[136:139]
    v_mfma_f32_16x16x32_bf16 v[140:143], v[196:199], v[228:231], v[140:143]
    s_waitcnt lgkmcnt(6)
    v_mfma_f32_16x16x32_bf16 v[144:147], v[192:195], v[232:235], v[144:147]
    v_add_u32 v250, 0xfffe3800, v250
    ds_read_b128 v[216:219], v250 offset:16384
    ds_read_b128 v[220:223], v250 offset:27648
    v_mfma_f32_16x16x32_bf16 v[148:151], v[196:199], v[232:235], v[148:151]
    v_mfma_f32_16x16x32_bf16 v[152:155], v[208:211], v[232:235], v[152:155]
    v_mfma_f32_16x16x32_bf16 v[156:159], v[212:215], v[232:235], v[156:159]
    v_mfma_f32_16x16x32_bf16 v[144:147], v[200:203], v[236:239], v[144:147]
    s_waitcnt lgkmcnt(4)
    v_xor_b32 v212, 0x80008000, v188
    v_xor_b32 v213, 0x80008000, v189
    v_mfma_f32_16x16x32_bf16 v[148:151], v[204:207], v[236:239], v[148:151]
    v_xor_b32 v214, 0x80008000, v190
    v_xor_b32 v215, 0x80008000, v191
    v_mfma_f32_16x16x32_bf16 v[152:155], v[192:195], v[236:239], v[152:155]
    v_mfma_f32_16x16x32_bf16 v[156:159], v[196:199], v[236:239], v[156:159]
    s_waitcnt lgkmcnt(2)
    v_mfma_f32_16x16x32_bf16 v[160:163], v[192:195], v[240:243], v[160:163]
    ds_read_b128 v[224:227], v250 offset:17408
    ds_read_b128 v[228:231], v250 offset:28672
    v_mfma_f32_16x16x32_bf16 v[164:167], v[208:211], v[240:243], v[164:167]
    v_xor_b32 v208, 0x80008000, v184
    v_xor_b32 v209, 0x80008000, v185
    v_mfma_f32_16x16x32_bf16 v[160:163], v[200:203], v[244:247], v[160:163]
    v_xor_b32 v210, 0x80008000, v186
    v_xor_b32 v211, 0x80008000, v187
    v_mfma_f32_16x16x32_bf16 v[164:167], v[192:195], v[244:247], v[164:167]
    s_sub_u32 s46, s46, 1
    s_cmp_lg_u32 s46, 0
    s_cbranch_scc1 L_g_loop
    s_barrier
    s_waitcnt lgkmcnt(2)
    v_mfma_f32_16x16x32_bf16 v[0:3], v[176:179], v[216:219], v[0:3]
    ds_read_b128 v[232:235], v250 offset:18432
    ds_read_b128 v[236:239], v250 offset:29696
    v_mfma_f32_16x16x32_bf16 v[4:7], v[180:183], v[216:219], v[4:7]
    v_mfma_f32_16x16x32_bf16 v[8:11], v[208:211], v[216:219], v[8:11]
    v_mfma_f32_16x16x32_bf16 v[12:15], v[212:215], v[216:219], v[12:15]
    v_mfma_f32_16x16x32_bf16 v[0:3], v[184:187], v[220:223], v[0:3]
    v_mfma_f32_16x16x32_bf16 v[4:7], v[188:191], v[220:223], v[4:7]
    v_mfma_f32_16x16x32_bf16 v[8:11], v[176:179], v[220:223], v[8:11]
    v_mfma_f32_16x16x32_bf16 v[12:15], v[180:183], v[220:223], v[12:15]
    s_waitcnt lgkmcnt(2)
    v_mfma_f32_16x16x32_bf16 v[16:19], v[176:179], v[224:227], v[16:19]
    ds_read_b128 v[240:243], v250 offset:19456
    ds_read_b128 v[244:247], v250 offset:30720
    v_mfma_f32_16x16x32_bf16 v[20:23], v[180:183], v[224:227], v[20:23]
    v_mfma_f32_16x16x32_bf16 v[24:27], v[208:211], v[224:227], v[24:27]
    v_mfma_f32_16x16x32_bf16 v[28:31], v[212:215], v[224:227], v[28:31]
    v_mfma_f32_16x16x32_bf16 v[16:19], v[184:187], v[228:231], v[16:19]
    v_mfma_f32_16x16x32_bf16 v[20:23], v[188:191], v[228:231], v[20:23]
    v_mfma_f32_16x16x32_bf16 v[24:27], v[176:179], v[228:231], v[24:27]
    v_mfma_f32_16x16x32_bf16 v[28:31], v[180:183], v[228:231], v[28:31]
    s_waitcnt lgkmcnt(2)
    v_mfma_f32_16x16x32_bf16 v[32:35], v[176:179], v[232:235], v[32:35]
    ds_read_b128 v[216:219], v250 offset:20480
    ds_read_b128 v[220:223], v250 offset:31744
    v_mfma_f32_16x16x32_bf16 v[36:39], v[180:183], v[232:235], v[36:39]
    v_mfma_f32_16x16x32_bf16 v[40:43], v[208:211], v[232:235], v[40:43]
    v_mfma_f32_16x16x32_bf16 v[44:47], v[212:215], v[232:235], v[44:47]
    v_mfma_f32_16x16x32_bf16 v[32:35], v[184:187], v[236:239], v[32:35]
    v_mfma_f32_16x16x32_bf16 v[36:39], v[188:191], v[236:239], v[36:39]
    v_mfma_f32_16x16x32_bf16 v[40:43], v[176:179], v[236:239], v[40:43]
    v_mfma_f32_16x16x32_bf16 v[44:47], v[180:183], v[236:239], v[44:47]
    s_waitcnt lgkmcnt(2)
    v_mfma_f32_16x16x32_bf16 v[48:51], v[176:179], v[240:243], v[48:51]
    ds_read_b128 v[224:227], v250 offset:21504
    ds_read_b128 v[228:231], v250 offset:32768
    v_mfma_f32_16x16x32_bf16 v[52:55], v[180:183], v[240:243], v[52:55]
    v_mfma_f32_16x16x32_bf16 v[56:59], v[208:211], v[240:243], v[56:59]
    v_mfma_f32_16x16x32_bf16 v[60:63], v[212:215], v[240:243], v[60:63]
    v_mfma_f32_16x16x32_bf16 v[48:51], v[184:187], v[244:247], v[48:51]
    v_mfma_f32_16x16x32_bf16 v[52:55], v[188:191], v[244:247], v[52:55]
    v_mfma_f32_16x16x32_bf16 v[56:59], v[176:179], v[244:247], v[56:59]
    v_mfma_f32_16x16x32_bf16 v[60:63], v[180:183], v[244:247], v[60:63]
    s_waitcnt lgkmcnt(2)
    v_mfma_f32_16x16x32_bf16 v[64:67], v[176:179], v[216:219], v[64:67]
    ds_read_b128 v[232:235], v250 offset:22528
    ds_read_b128 v[236:239], v250 offset:33792
    v_mfma_f32_16x16x32_bf16 v[68:71], v[180:183], v[216:219], v[68:71]
    v_mfma_f32_16x16x32_bf16 v[72:75], v[208:211], v[216:219], v[72:75]
    v_mfma_f32_16x16x32_bf16 v[76:79], v[212:215], v[216:219], v[76:79]
    v_mfma_f32_16x16x32_bf16 v[64:67], v[184:187], v[220:223], v[64:67]
    v_mfma_f32_16x16x32_bf16 v[68:71], v[188:191], v[220:223], v[68:71]
    v_mfma_f32_16x16x32_bf16 v[72:75], v[176:179], v[220:223], v[72:75]
    v_mfma_f32_16x16x32_bf16 v[76:79], v[180:183], v[220:223], v[76:79]
    s_waitcnt lgkmcnt(2)
    v_mfma_f32_16x16x32_bf16 v[80:83], v[176:179], v[224:227], v[80:83]
    ds_read_b128 v[240:243], v250 offset:23552
    ds_read_b128 v[244:247], v250 offset:34816
    v_mfma_f32_16x16x32_bf16 v[84:87], v[180:183], v[224:227], v[84:87]
    v_mfma_f32_16x16x32_bf16 v[88:91], v[208:211], v[224:227], v[88:91]
    v_mfma_f32_16x16x32_bf16 v[92:95], v[212:215], v[224:227], v[92:95]
    v_mfma_f32_16x16x32_bf16 v[80:83], v[184:187], v[228:231], v[80:83]
    v_add_u32 v248, 0x9800, v248
    v_add_u32 v249, 0x9800, v249
    v_mfma_f32_16x16x32_bf16 v[84:87], v[188:191], v[228:231], v[84:87]
    v_mfma_f32_16x16x32_bf16 v[88:91], v[176:179], v[228:231], v[88:91]
    v_mfma_f32_16x16x32_bf16 v[92:95], v[180:183], v[228:231], v[92:95]
    s_waitcnt lgkmcnt(2)
    v_mfma_f32_16x16x32_bf16 v[96:99], v[176:179], v[232:235], v[96:99]
    ds_read_b128 v[216:219], v250 offset:24576
    ds_read_b128 v[220:223], v250 offset:35840
    v_mfma_f32_16x16x32_bf16 v[100:103], v[180:183], v[232:235], v[100:103]
    v_mfma_f32_16x16x32_bf16 v[104:107], v[208:211], v[232:235], v[104:107]
    v_mfma_f32_16x16x32_bf16 v[108:111], v[212:215], v[232:235], v[108:111]
    ds_read_b64_tr_b16 v[192:193], v248 offset:0
    ds_read_b64_tr_b16 v[194:195], v248 offset:1024
    ds_read_b64_tr_b16 v[196:197], v249 offset:0
    ds_read_b64_tr_b16 v[198:199], v249 offset:1024
    v_mfma_f32_16x16x32_bf16 v[96:99], v[184:187], v[236:239], v[96:99]
    v_mfma_f32_16x16x32_bf16 v[100:103], v[188:191], v[236:239], v[100:103]
    v_mfma_f32_16x16x32_bf16 v[104:107], v[176:179], v[236:239], v[104:107]
    v_mfma_f32_16x16x32_bf16 v[108:111], v[180:183], v[236:239], v[108:111]
    s_waitcnt lgkmcnt(6)
    v_mfma_f32_16x16x32_bf16 v[112:115], v[176:179], v[240:243], v[112:115]
    ds_read_b128 v[224:227], v250 offset:25600
    ds_read_b128 v[228:231], v250 offset:36864
    v_mfma_f32_16x16x32_bf16 v[116:119], v[180:183], v[240:243], v[116:119]
    v_mfma_f32_16x16x32_bf16 v[120:123], v[208:211], v[240:243], v[120:123]
    v_mfma_f32_16x16x32_bf16 v[124:127], v[212:215], v[240:243], v[124:127]
    ds_read_b64_tr_b16 v[200:201], v248 offset:8192
    ds_read_b64_tr_b16 v[202:203], v248 offset:9216
    ds_read_b64_tr_b16 v[204:205], v249 offset:8192
    ds_read_b64_tr_b16 v[206:207], v249 offset:9216
    v_mfma_f32_16x16x32_bf16 v[112:115], v[184:187], v[244:247], v[112:115]
    v_mfma_f32_16x16x32_bf16 v[116:119], v[188:191], v[244:247], v[116:119]
    v_mfma_f32_16x16x32_bf16 v[120:123], v[176:179], v[244:247], v[120:123]
    v_mfma_f32_16x16x32_bf16 v[124:127], v[180:183], v[244:247], v[124:127]
    s_waitcnt lgkmcnt(10)
    v_mfma_f32_16x16x32_bf16 v[128:131], v[176:179], v[216:219], v[128:131]
    ds_read_b128 v[232:235], v250 offset:26624
    ds_read_b128 v[236:239], v250 offset:37888
    v_mfma_f32_16x16x32_bf16 v[132:135], v[180:183], v[216:219], v[132:135]
    v_mfma_f32_16x16x32_bf16 v[136:139], v[208:211], v[216:219], v[136:139]
    v_mfma_f32_16x16x32_bf16 v[140:143], v[212:215], v[216:219], v[140:143]
    v_mfma_f32_16x16x32_bf16 v[128:131], v[184:187], v[220:223], v[128:131]
    v_mfma_f32_16x16x32_bf16 v[132:135], v[188:191], v[220:223], v[132:135]
    v_mfma_f32_16x16x32_bf16 v[136:139], v[176:179], v[220:223], v[136:139]
    v_mfma_f32_16x16x32_bf16 v[140:143], v[180:183], v[220:223], v[140:143]
    s_waitcnt lgkmcnt(6)
    v_mfma_f32_16x16x32_bf16 v[144:147], v[176:179], v[224:227], v[144:147]
    v_add_u32 v250, 0x9800, v250
    ds_read_b128 v[240:243], v250 offset:16384
    ds_read_b128 v[244:247], v250 offset:27648
    v_mfma_f32_16x16x32_bf16 v[148:151], v[180:183], v[224:227], v[148:151]
    v_mfma_f32_16x16x32_bf16 v[152:155], v[208:211], v[224:227], v[152:155]
    v_mfma_f32_16x16x32_bf16 v[156:159], v[212:215], v[224:227], v[156:159]
    v_mfma_f32_16x16x32_bf16 v[144:147], v[184:187], v[228:231], v[144:147]
    s_waitcnt lgkmcnt(4)
    v_xor_b32 v212, 0x80008000, v204
    v_xor_b32 v213, 0x80008000, v205
    v_mfma_f32_16x16x32_bf16 v[148:151], v[188:191], v[228:231], v[148:151]
    v_xor_b32 v214, 0x80008000, v206
    v_xor_b32 v215, 0x80008000, v207
    v_mfma_f32_16x16x32_bf16 v[152:155], v[176:179], v[228:231], v[152:155]
    v_mfma_f32_16x16x32_bf16 v[156:159], v[180:183], v[228:231], v[156:159]
    s_waitcnt lgkmcnt(2)
    v_mfma_f32_16x16x32_bf16 v[160:163], v[176:179], v[232:235], v[160:163]
    ds_read_b128 v[216:219], v250 offset:17408
    ds_read_b128 v[220:223], v250 offset:28672
    v_mfma_f32_16x16x32_bf16 v[164:167], v[208:211], v[232:235], v[164:167]
    v_xor_b32 v208, 0x80008000, v200
    v_xor_b32 v209, 0x80008000, v201
    v_mfma_f32_16x16x32_bf16 v[160:163], v[184:187], v[236:239], v[160:163]
    v_xor_b32 v210, 0x80008000, v202
    v_xor_b32 v211, 0x80008000, v203
    v_mfma_f32_16x16x32_bf16 v[164:167], v[176:179], v[236:239], v[164:167]
    s_barrier
    s_waitcnt lgkmcnt(2)
    v_mfma_f32_16x16x32_bf16 v[0:3], v[192:195], v[240:243], v[0:3]
    ds_read_b128 v[224:227], v250 offset:18432
    ds_read_b128 v[228:231], v250 offset:29696
    v_mfma_f32_16x16x32_bf16 v[4:7], v[196:199], v[240:243], v[4:7]
    v_mfma_f32_16x16x32_bf16 v[8:11], v[208:211], v[240:243], v[8:11]
    v_mfma_f32_16x16x32_bf16 v[12:15], v[212:215], v[240:243], v[12:15]
    v_mfma_f32_16x16x32_bf16 v[0:3], v[200:203], v[244:247], v[0:3]
    v_mfma_f32_16x16x32_bf16 v[4:7], v[204:207], v[244:247], v[4:7]
    v_mfma_f32_16x16x32_bf16 v[8:11], v[192:195], v[244:247], v[8:11]
    v_mfma_f32_16x16x32_bf16 v[12:15], v[196:199], v[244:247], v[12:15]
    s_waitcnt lgkmcnt(2)
    v_mfma_f32_16x16x32_bf16 v[16:19], v[192:195], v[216:219], v[16:19]
    ds_read_b128 v[232:235], v250 offset:19456
    ds_read_b128 v[236:239], v250 offset:30720
    v_mfma_f32_16x16x32_bf16 v[20:23], v[196:199], v[216:219], v[20:23]
    v_mfma_f32_16x16x32_bf16 v[24:27], v[208:211], v[216:219], v[24:27]
    v_mfma_f32_16x16x32_bf16 v[28:31], v[212:215], v[216:219], v[28:31]
    v_mfma_f32_16x16x32_bf16 v[16:19], v[200:203], v[220:223], v[16:19]
    v_mfma_f32_16x16x32_bf16 v[20:23], v[204:207], v[220:223], v[20:23]
    v_mfma_f32_16x16x32_bf16 v[24:27], v[192:195], v[220:223], v[24:27]
    v_mfma_f32_16x16x32_bf16 v[28:31], v[196:199], v[220:223], v[28:31]
    s_waitcnt lgkmcnt(2)
    v_mfma_f32_16x16x32_bf16 v[32:35], v[192:195], v[224:227], v[32:35]
    ds_read_b128 v[240:243], v250 offset:20480
    ds_read_b128 v[244:247], v250 offset:31744
    v_mfma_f32_16x16x32_bf16 v[36:39], v[196:199], v[224:227], v[36:39]
    v_mfma_f32_16x16x32_bf16 v[40:43], v[208:211], v[224:227], v[40:43]
    v_mfma_f32_16x16x32_bf16 v[44:47], v[212:215], v[224:227], v[44:47]
    v_mfma_f32_16x16x32_bf16 v[32:35], v[200:203], v[228:231], v[32:35]
    v_mfma_f32_16x16x32_bf16 v[36:39], v[204:207], v[228:231], v[36:39]
    v_mfma_f32_16x16x32_bf16 v[40:43], v[192:195], v[228:231], v[40:43]
    v_mfma_f32_16x16x32_bf16 v[44:47], v[196:199], v[228:231], v[44:47]
    s_waitcnt lgkmcnt(2)
    v_mfma_f32_16x16x32_bf16 v[48:51], v[192:195], v[232:235], v[48:51]
    ds_read_b128 v[216:219], v250 offset:21504
    ds_read_b128 v[220:223], v250 offset:32768
    v_mfma_f32_16x16x32_bf16 v[52:55], v[196:199], v[232:235], v[52:55]
    v_mfma_f32_16x16x32_bf16 v[56:59], v[208:211], v[232:235], v[56:59]
    v_mfma_f32_16x16x32_bf16 v[60:63], v[212:215], v[232:235], v[60:63]
    v_mfma_f32_16x16x32_bf16 v[48:51], v[200:203], v[236:239], v[48:51]
    v_mfma_f32_16x16x32_bf16 v[52:55], v[204:207], v[236:239], v[52:55]
    v_mfma_f32_16x16x32_bf16 v[56:59], v[192:195], v[236:239], v[56:59]
    v_mfma_f32_16x16x32_bf16 v[60:63], v[196:199], v[236:239], v[60:63]
    s_waitcnt lgkmcnt(2)
    v_mfma_f32_16x16x32_bf16 v[64:67], v[192:195], v[240:243], v[64:67]
    ds_read_b128 v[224:227], v250 offset:22528
    ds_read_b128 v[228:231], v250 offset:33792
    v_mfma_f32_16x16x32_bf16 v[68:71], v[196:199], v[240:243], v[68:71]
    v_mfma_f32_16x16x32_bf16 v[72:75], v[208:211], v[240:243], v[72:75]
    v_mfma_f32_16x16x32_bf16 v[76:79], v[212:215], v[240:243], v[76:79]
    v_mfma_f32_16x16x32_bf16 v[64:67], v[200:203], v[244:247], v[64:67]
    v_mfma_f32_16x16x32_bf16 v[68:71], v[204:207], v[244:247], v[68:71]
    v_mfma_f32_16x16x32_bf16 v[72:75], v[192:195], v[244:247], v[72:75]
    v_mfma_f32_16x16x32_bf16 v[76:79], v[196:199], v[244:247], v[76:79]
    s_waitcnt lgkmcnt(2)
    v_mfma_f32_16x16x32_bf16 v[80:83], v[192:195], v[216:219], v[80:83]
    ds_read_b128 v[232:235], v250 offset:23552
    ds_read_b128 v[236:239], v250 offset:34816
    v_mfma_f32_16x16x32_bf16 v[84:87], v[196:199], v[216:219], v[84:87]
    v_mfma_f32_16x16x32_bf16 v[88:91], v[208:211], v[216:219], v[88:91]
    v_mfma_f32_16x16x32_bf16 v[92:95], v[212:215], v[216:219], v[92:95]
    v_mfma_f32_16x16x32_bf16 v[80:83], v[200:203], v[220:223], v[80:83]
    v_add_u32 v248, 0x9800, v248
    v_add_u32 v249, 0x9800, v249
    v_mfma_f32_16x16x32_bf16 v[84:87], v[204:207], v[220:223], v[84:87]
    v_mfma_f32_16x16x32_bf16 v[88:91], v[192:195], v[220:223], v[88:91]
    v_mfma_f32_16x16x32_bf16 v[92:95], v[196:199], v[220:223], v[92:95]
    s_waitcnt lgkmcnt(2)
    v_mfma_f32_16x16x32_bf16 v[96:99], v[192:195], v[224:227], v[96:99]
    ds_read_b128 v[240:243], v250 offset:24576
    ds_read_b128 v[244:247], v250 offset:35840
    v_mfma_f32_16x16x32_bf16 v[100:103], v[196:199], v[224:227], v[100:103]
    v_mfma_f32_16x16x32_bf16 v[104:107], v[208:211], v[224:227], v[104:107]
    v_mfma_f32_16x16x32_bf16 v[108:111], v[212:215], v[224:227], v[108:111]
    ds_read_b64_tr_b16 v[176:177], v248 offset:0
    ds_read_b64_tr_b16 v[178:179], v248 offset:1024
    ds_read_b64_tr_b16 v[180:181], v249 offset:0
    ds_read_b64_tr_b16 v[182:183], v249 offset:1024
    v_mfma_f32_16x16x32_bf16 v[96:99], v[200:203], v[228:231], v[96:99]
    v_mfma_f32_16x16x32_bf16 v[100:103], v[204:207], v[228:231], v[100:103]
    v_mfma_f32_16x16x32_bf16 v[104:107], v[192:195], v[228:231], v[104:107]
    v_mfma_f32_16x16x32_bf16 v[108:111], v[196:199], v[228:231], v[108:111]
    s_waitcnt lgkmcnt(6)
    v_mfma_f32_16x16x32_bf16 v[112:115], v[192:195], v[232:235], v[112:115]
    ds_read_b128 v[216:219], v250 offset:25600
    ds_read_b128 v[220:223], v250 offset:36864
    v_mfma_f32_16x16x32_bf16 v[116:119], v[196:199], v[232:235], v[116:119]
    v_mfma_f32_16x16x32_bf16 v[120:123], v[208:211], v[232:235], v[120:123]
    v_mfma_f32_16x16x32_bf16 v[124:127], v[212:215], v[232:235], v[124:127]
    ds_read_b64_tr_b16 v[184:185], v248 offset:8192
    ds_read_b64_tr_b16 v[186:187], v248 offset:9216
    ds_read_b64_tr_b16 v[188:189], v249 offset:8192
    ds_read_b64_tr_b16 v[190:191], v249 offset:9216
    v_mfma_f32_16x16x32_bf16 v[112:115], v[200:203], v[236:239], v[112:115]
    v_mfma_f32_16x16x32_bf16 v[116:119], v[204:207], v[236:239], v[116:119]
    v_mfma_f32_16x16x32_bf16 v[120:123], v[192:195], v[236:239], v[120:123]
    v_mfma_f32_16x16x32_bf16 v[124:127], v[196:199], v[236:239], v[124:127]
    s_waitcnt lgkmcnt(10)
    v_mfma_f32_16x16x32_bf16 v[128:131], v[192:195], v[240:243], v[128:131]
    ds_read_b128 v[224:227], v250 offset:26624
    ds_read_b128 v[228:231], v250 offset:37888
    v_mfma_f32_16x16x32_bf16 v[132:135], v[196:199], v[240:243], v[132:135]
    v_mfma_f32_16x16x32_bf16 v[136:139], v[208:211], v[240:243], v[136:139]
    v_mfma_f32_16x16x32_bf16 v[140:143], v[212:215], v[240:243], v[140:143]
    v_mfma_f32_16x16x32_bf16 v[128:131], v[200:203], v[244:247], v[128:131]
    v_mfma_f32_16x16x32_bf16 v[132:135], v[204:207], v[244:247], v[132:135]
    v_mfma_f32_16x16x32_bf16 v[136:139], v[192:195], v[244:247], v[136:139]
    v_mfma_f32_16x16x32_bf16 v[140:143], v[196:199], v[244:247], v[140:143]
    s_waitcnt lgkmcnt(6)
    v_mfma_f32_16x16x32_bf16 v[144:147], v[192:195], v[216:219], v[144:147]
    v_add_u32 v250, 0x9800, v250
    ds_read_b128 v[232:235], v250 offset:16384
    ds_read_b128 v[236:239], v250 offset:27648
    v_mfma_f32_16x16x32_bf16 v[148:151], v[196:199], v[216:219], v[148:151]
    v_mfma_f32_16x16x32_bf16 v[152:155], v[208:211], v[216:219], v[152:155]
    v_mfma_f32_16x16x32_bf16 v[156:159], v[212:215], v[216:219], v[156:159]
    v_mfma_f32_16x16x32_bf16 v[144:147], v[200:203], v[220:223], v[144:147]
    s_waitcnt lgkmcnt(4)
    v_xor_b32 v212, 0x80008000, v188
    v_xor_b32 v213, 0x80008000, v189
    v_mfma_f32_16x16x32_bf16 v[148:151], v[204:207], v[220:223], v[148:151]
    v_xor_b32 v214, 0x80008000, v190
    v_xor_b32 v215, 0x80008000, v191
    v_mfma_f32_16x16x32_bf16 v[152:155], v[192:195], v[220:223], v[152:155]
    v_mfma_f32_16x16x32_bf16 v[156:159], v[196:199], v[220:223], v[156:159]
    s_waitcnt lgkmcnt(2)
    v_mfma_f32_16x16x32_bf16 v[160:163], v[192:195], v[224:227], v[160:163]
    ds_read_b128 v[240:243], v250 offset:17408
    ds_read_b128 v[244:247], v250 offset:28672
    v_mfma_f32_16x16x32_bf16 v[164:167], v[208:211], v[224:227], v[164:167]
    v_xor_b32 v208, 0x80008000, v184
    v_xor_b32 v209, 0x80008000, v185
    v_mfma_f32_16x16x32_bf16 v[160:163], v[200:203], v[228:231], v[160:163]
    v_xor_b32 v210, 0x80008000, v186
    v_xor_b32 v211, 0x80008000, v187
    v_mfma_f32_16x16x32_bf16 v[164:167], v[192:195], v[228:231], v[164:167]
    s_barrier
    s_cmp_lg_u32 s13, 0
    s_cbranch_scc1 L_epi_b1
    v_add_u32 v248, 0x9800, v248
    v_add_u32 v249, 0x9800, v249
    v_add_u32 v253, 38912, v250
    ds_read_b64_tr_b16 v[192:193], v248 offset:0
    ds_read_b64_tr_b16 v[194:195], v248 offset:1024
    ds_read_b64_tr_b16 v[196:197], v249 offset:0
    ds_read_b64_tr_b16 v[198:199], v249 offset:1024
    ds_read_b64_tr_b16 v[200:201], v248 offset:8192
    ds_read_b64_tr_b16 v[202:203], v248 offset:9216
    ds_read_b64_tr_b16 v[204:205], v249 offset:8192
    ds_read_b64_tr_b16 v[206:207], v249 offset:9216
    s_waitcnt lgkmcnt(10)
    v_mfma_f32_16x16x32_bf16 v[0:3], v[176:179], v[232:235], v[0:3]
    ds_read_b128 v[216:219], v250 offset:18432
    ds_read_b128 v[220:223], v250 offset:29696
    v_mfma_f32_16x16x32_bf16 v[4:7], v[180:183], v[232:235], v[4:7]
    v_mfma_f32_16x16x32_bf16 v[8:11], v[208:211], v[232:235], v[8:11]
    v_mfma_f32_16x16x32_bf16 v[12:15], v[212:215], v[232:235], v[12:15]
    v_mfma_f32_16x16x32_bf16 v[0:3], v[184:187], v[236:239], v[0:3]
    v_mfma_f32_16x16x32_bf16 v[4:7], v[188:191], v[236:239], v[4:7]
    v_mfma_f32_16x16x32_bf16 v[8:11], v[176:179], v[236:239], v[8:11]
    v_mfma_f32_16x16x32_bf16 v[12:15], v[180:183], v[236:239], v[12:15]
    s_waitcnt lgkmcnt(10)
    v_mfma_f32_16x16x32_bf16 v[16:19], v[176:179], v[240:243], v[16:19]
    ds_read_b128 v[224:227], v253 offset:16384
    ds_read_b128 v[228:231], v253 offset:27648
    v_mfma_f32_16x16x32_bf16 v[20:23], v[180:183], v[240:243], v[20:23]
    v_mfma_f32_16x16x32_bf16 v[24:27], v[208:211], v[240:243], v[24:27]
    v_mfma_f32_16x16x32_bf16 v[28:31], v[212:215], v[240:243], v[28:31]
    v_mfma_f32_16x16x32_bf16 v[16:19], v[184:187], v[244:247], v[16:19]
    v_mfma_f32_16x16x32_bf16 v[20:23], v[188:191], v[244:247], v[20:23]
    v_mfma_f32_16x16x32_bf16 v[24:27], v[176:179], v[244:247], v[24:27]
    v_mfma_f32_16x16x32_bf16 v[28:31], v[180:183], v[244:247], v[28:31]
    s_waitcnt lgkmcnt(2)
    v_mfma_f32_16x16x32_bf16 v[32:35], v[176:179], v[216:219], v[32:35]
    ds_read_b128 v[232:235], v250 offset:19456
    ds_read_b128 v[236:239], v250 offset:30720
    v_mfma_f32_16x16x32_bf16 v[36:39], v[180:183], v[216:219], v[36:39]
    v_mfma_f32_16x16x32_bf16 v[40:43], v[208:211], v[216:219], v[40:43]
    v_mfma_f32_16x16x32_bf16 v[44:47], v[212:215], v[216:219], v[44:47]
    v_mfma_f32_16x16x32_bf16 v[32:35], v[184:187], v[220:223], v[32:35]
    v_mfma_f32_16x16x32_bf16 v[36:39], v[188:191], v[220:223], v[36:39]
    v_mfma_f32_16x16x32_bf16 v[40:43], v[176:179], v[220:223], v[40:43]
    v_mfma_f32_16x16x32_bf16 v[44:47], v[180:183], v[220:223], v[44:47]
    v_xor_b32 v168, 0x80008000, v200
    v_xor_b32 v169, 0x80008000, v201
    v_xor_b32 v170, 0x80008000, v202
    v_xor_b32 v171, 0x80008000, v203
    v_xor_b32 v172, 0x80008000, v204
    v_xor_b32 v173, 0x80008000, v205
    v_xor_b32 v174, 0x80008000, v206
    v_xor_b32 v175, 0x80008000, v207
    s_waitcnt lgkmcnt(2)
    v_mfma_f32_16x16x32_bf16 v[0:3], v[192:195], v[224:227], v[0:3]
    ds_read_b128 v[240:243], v253 offset:17408
    ds_read_b128 v[244:247], v253 offset:28672
    v_mfma_f32_16x16x32_bf16 v[4:7], v[196:199], v[224:227], v[4:7]
    v_mfma_f32_16x16x32_bf16 v[8:11], v[168:171], v[224:227], v[8:11]
    v_mfma_f32_16x16x32_bf16 v[12:15], v[172:175], v[224:227], v[12:15]
    v_mfma_f32_16x16x32_bf16 v[0:3], v[200:203], v[228:231], v[0:3]
    v_mfma_f32_16x16x32_bf16 v[4:7], v[204:207], v[228:231], v[4:7]
    v_mfma_f32_16x16x32_bf16 v[8:11], v[192:195], v[228:231], v[8:11]
    v_mfma_f32_16x16x32_bf16 v[12:15], v[196:199], v[228:231], v[12:15]
    s_waitcnt lgkmcnt(2)
    v_mfma_f32_16x16x32_bf16 v[48:51], v[176:179], v[232:235], v[48:51]
    ds_read_b128 v[216:219], v250 offset:20480
    ds_read_b128 v[220:223], v250 offset:31744
    v_mfma_f32_16x16x32_bf16 v[52:55], v[180:183], v[232:235], v[52:55]
    v_mfma_f32_16x16x32_bf16 v[56:59], v[208:211], v[232:235], v[56:59]
    v_mfma_f32_16x16x32_bf16 v[60:63], v[212:215], v[232:235], v[60:63]
    v_mfma_f32_16x16x32_bf16 v[48:51], v[184:187], v[236:239], v[48:51]
    v_mfma_f32_16x16x32_bf16 v[52:55], v[188:191], v[236:239], v[52:55]
    v_mfma_f32_16x16x32_bf16 v[56:59], v[176:179], v[236:239], v[56:59]
    v_mfma_f32_16x16x32_bf16 v[60:63], v[180:183], v[236:239], v[60:63]
    s_waitcnt lgkmcnt(2)
    v_mfma_f32_16x16x32_bf16 v[16:19], v[192:195], v[240:243], v[16:19]
    ds_read_b128 v[224:227], v253 offset:18432
    ds_read_b128 v[228:231], v253 offset:29696
    v_mfma_f32_16x16x32_bf16 v[20:23], v[196:199], v[240:243], v[20:23]
    v_cvt_pk_bf16_f32 v0, v0, v1
    v_cvt_pk_bf16_f32 v1, v2, v3
    v_mfma_f32_16x16x32_bf16 v[24:27], v[168:171], v[240:243], v[24:27]
    v_cvt_pk_bf16_f32 v2, v4, v5
    v_cvt_pk_bf16_f32 v3, v6, v7
    v_mfma_f32_16x16x32_bf16 v[28:31], v[172:175], v[240:243], v[28:31]
    s_add_u32 s47, s48, 0
    buffer_store_dwordx4 v[0:3], v251, s[16:19], s47 offen sc1
    v_mfma_f32_16x16x32_bf16 v[16:19], v[200:203], v[244:247], v[16:19]
    v_cvt_pk_bf16_f32 v8, v8, v9
    v_cvt_pk_bf16_f32 v9, v10, v11
    v_mfma_f32_16x16x32_bf16 v[20:23], v[204:207], v[244:247], v[20:23]
    v_cvt_pk_bf16_f32 v10, v12, v13
    v_cvt_pk_bf16_f32 v11, v14, v15
    v_mfma_f32_16x16x32_bf16 v[24:27], v[192:195], v[244:247], v[24:27]
    s_add_u32 s47, s48, 1024
    buffer_store_dwordx4 v[8:11], v251, s[16:19], s47 offen sc1
    v_mfma_f32_16x16x32_bf16 v[28:31], v[196:199], v[244:247], v[28:31]
    s_waitcnt lgkmcnt(2)
    v_mfma_f32_16x16x32_bf16 v[64:67], v[176:179], v[216:219], v[64:67]
    ds_read_b128 v[232:235], v250 offset:21504
    ds_read_b128 v[236:239], v250 offset:32768
    v_mfma_f32_16x16x32_bf16 v[68:71], v[180:183], v[216:219], v[68:71]
    v_mfma_f32_16x16x32_bf16 v[72:75], v[208:211], v[216:219], v[72:75]
    v_mfma_f32_16x16x32_bf16 v[76:79], v[212:215], v[216:219], v[76:79]
    v_mfma_f32_16x16x32_bf16 v[64:67], v[184:187], v[220:223], v[64:67]
    v_mfma_f32_16x16x32_bf16 v[68:71], v[188:191], v[220:223], v[68:71]
    v_mfma_f32_16x16x32_bf16 v[72:75], v[176:179], v[220:223], v[72:75]
    v_mfma_f32_16x16x32_bf16 v[76:79], v[180:183], v[220:223], v[76:79]
    s_waitcnt lgkmcnt(2)
    v_mfma_f32_16x16x32_bf16 v[32:35], v[192:195], v[224:227], v[32:35]
    ds_read_b128 v[240:243], v253 offset:19456
    ds_read_b128 v[244:247], v253 offset:30720
    v_mfma_f32_16x16x32_bf16 v[36:39], v[196:199], v[224:227], v[36:39]
    v_cvt_pk_bf16_f32 v16, v16, v17
    v_cvt_pk_bf16_f32 v17, v18, v19
    v_mfma_f32_16x16x32_bf16 v[40:43], v[168:171], v[224:227], v[40:43]
    v_cvt_pk_bf16_f32 v18, v20, v21
    v_cvt_pk_bf16_f32 v19, v22, v23
    v_mfma_f32_16x16x32_bf16 v[44:47], v[172:175], v[224:227], v[44:47]
    s_add_u32 s47, s48, 1052672
    buffer_store_dwordx4 v[16:19], v251, s[16:19], s47 offen sc1
    v_mfma_f32_16x16x32_bf16 v[32:35], v[200:203], v[228:231], v[32:35]
    v_cvt_pk_bf16_f32 v24, v24, v25
    v_cvt_pk_bf16_f32 v25, v26, v27
    v_mfma_f32_16x16x32_bf16 v[36:39], v[204:207], v[228:231], v[36:39]
    v_cvt_pk_bf16_f32 v26, v28, v29
    v_cvt_pk_bf16_f32 v27, v30, v31
    v_mfma_f32_16x16x32_bf16 v[40:43], v[192:195], v[228:231], v[40:43]
    s_add_u32 s47, s48, 1053696
    buffer_store_dwordx4 v[24:27], v251, s[16:19], s47 offen sc1
    v_mfma_f32_16x16x32_bf16 v[44:47], v[196:199], v[228:231], v[44:47]
    s_waitcnt lgkmcnt(2)
    v_mfma_f32_16x16x32_bf16 v[80:83], v[176:179], v[232:235], v[80:83]
    ds_read_b128 v[216:219], v250 offset:22528
    ds_read_b128 v[220:223], v250 offset:33792
    v_mfma_f32_16x16x32_bf16 v[84:87], v[180:183], v[232:235], v[84:87]
    v_mfma_f32_16x16x32_bf16 v[88:91], v[208:211], v[232:235], v[88:91]
    v_mfma_f32_16x16x32_bf16 v[92:95], v[212:215], v[232:235], v[92:95]
    v_mfma_f32_16x16x32_bf16 v[80:83], v[184:187], v[236:239], v[80:83]
    v_mfma_f32_16x16x32_bf16 v[84:87], v[188:191], v[236:239], v[84:87]
    v_mfma_f32_16x16x32_bf16 v[88:91], v[176:179], v[236:239], v[88:91]
    v_mfma_f32_16x16x32_bf16 v[92:95], v[180:183], v[236:239], v[92:95]
    s_waitcnt lgkmcnt(2)
    v_mfma_f32_16x16x32_bf16 v[48:51], v[192:195], v[240:243], v[48:51]
    ds_read_b128 v[224:227], v253 offset:20480
    ds_read_b128 v[228:231], v253 offset:31744
    v_mfma_f32_16x16x32_bf16 v[52:55], v[196:199], v[240:243], v[52:55]
    v_cvt_pk_bf16_f32 v32, v32, v33
    v_cvt_pk_bf16_f32 v33, v34, v35
    v_mfma_f32_16x16x32_bf16 v[56:59], v[168:171], v[240:243], v[56:59]
    v_cvt_pk_bf16_f32 v34, v36, v37
    v_cvt_pk_bf16_f32 v35, v38, v39
    v_mfma_f32_16x16x32_bf16 v[60:63], v[172:175], v[240:243], v[60:63]
    s_add_u32 s47, s48, 2105344
    buffer_store_dwordx4 v[32:35], v251, s[16:19], s47 offen sc1
    v_mfma_f32_16x16x32_bf16 v[48:51], v[200:203], v[244:247], v[48:51]
    v_cvt_pk_bf16_f32 v40, v40, v41
    v_cvt_pk_bf16_f32 v41, v42, v43
    v_mfma_f32_16x16x32_bf16 v[52:55], v[204:207], v[244:247], v[52:55]
    v_cvt_pk_bf16_f32 v42, v44, v45
    v_cvt_pk_bf16_f32 v43, v46, v47
    v_mfma_f32_16x16x32_bf16 v[56:59], v[192:195], v[244:247], v[56:59]
    s_add_u32 s47, s48, 2106368
    buffer_store_dwordx4 v[40:43], v251, s[16:19], s47 offen sc1
    v_mfma_f32_16x16x32_bf16 v[60:63], v[196:199], v[244:247], v[60:63]
    s_waitcnt lgkmcnt(2)
    v_mfma_f32_16x16x32_bf16 v[96:99], v[176:179], v[216:219], v[96:99]
    ds_read_b128 v[232:235], v250 offset:23552
    ds_read_b128 v[236:239], v250 offset:34816
    v_mfma_f32_16x16x32_bf16 v[100:103], v[180:183], v[216:219], v[100:103]
    v_mfma_f32_16x16x32_bf16 v[104:107], v[208:211], v[216:219], v[104:107]
    v_mfma_f32_16x16x32_bf16 v[108:111], v[212:215], v[216:219], v[108:111]
    v_mfma_f32_16x16x32_bf16 v[96:99], v[184:187], v[220:223], v[96:99]
    v_mfma_f32_16x16x32_bf16 v[100:103], v[188:191], v[220:223], v[100:103]
    v_mfma_f32_16x16x32_bf16 v[104:107], v[176:179], v[220:223], v[104:107]
    v_mfma_f32_16x16x32_bf16 v[108:111], v[180:183], v[220:223], v[108:111]
    s_waitcnt lgkmcnt(2)
    v_mfma_f32_16x16x32_bf16 v[64:67], v[192:195], v[224:227], v[64:67]
    ds_read_b128 v[240:243], v253 offset:21504
    ds_read_b128 v[244:247], v253 offset:32768
    v_mfma_f32_16x16x32_bf16 v[68:71], v[196:199], v[224:227], v[68:71]
    v_cvt_pk_bf16_f32 v48, v48, v49
    v_cvt_pk_bf16_f32 v49, v50, v51
    v_mfma_f32_16x16x32_bf16 v[72:75], v[168:171], v[224:227], v[72:75]
    v_cvt_pk_bf16_f32 v50, v52, v53
    v_cvt_pk_bf16_f32 v51, v54, v55
    v_mfma_f32_16x16x32_bf16 v[76:79], v[172:175], v[224:227], v[76:79]
    s_add_u32 s47, s48, 3158016
    buffer_store_dwordx4 v[48:51], v251, s[16:19], s47 offen sc1
    v_mfma_f32_16x16x32_bf16 v[64:67], v[200:203], v[228:231], v[64:67]
    v_cvt_pk_bf16_f32 v56, v56, v57
    v_cvt_pk_bf16_f32 v57, v58, v59
    v_mfma_f32_16x16x32_bf16 v[68:71], v[204:207], v[228:231], v[68:71]
    v_cvt_pk_bf16_f32 v58, v60, v61
    v_cvt_pk_bf16_f32 v59, v62, v63
    v_mfma_f32_16x16x32_bf16 v[72:75], v[192:195], v[228:231], v[72:75]
    s_add_u32 s47, s48, 3159040
    buffer_store_dwordx4 v[56:59], v251, s[16:19], s47 offen sc1
    v_mfma_f32_16x16x32_bf16 v[76:79], v[196:199], v[228:231], v[76:79]
    s_waitcnt lgkmcnt(2)
    v_mfma_f32_16x16x32_bf16 v[112:115], v[176:179], v[232:235], v[112:115]
    ds_read_b128 v[216:219], v250 offset:24576
    ds_read_b128 v[220:223], v250 offset:35840
    v_mfma_f32_16x16x32_bf16 v[116:119], v[180:183], v[232:235], v[116:119]
    v_mfma_f32_16x16x32_bf16 v[120:123], v[208:211], v[232:235], v[120:123]
    v_mfma_f32_16x16x32_bf16 v[124:127], v[212:215], v[232:235], v[124:127]
    v_mfma_f32_16x16x32_bf16 v[112:115], v[184:187], v[236:239], v[112:115]
    v_mfma_f32_16x16x32_bf16 v[116:119], v[188:191], v[236:239], v[116:119]
    v_mfma_f32_16x16x32_bf16 v[120:123], v[176:179], v[236:239], v[120:123]
    v_mfma_f32_16x16x32_bf16 v[124:127], v[180:183], v[236:239], v[124:127]
    s_waitcnt lgkmcnt(2)
    v_mfma_f32_16x16x32_bf16 v[80:83], v[192:195], v[240:243], v[80:83]
    ds_read_b128 v[224:227], v253 offset:22528
    ds_read_b128 v[228:231], v253 offset:33792
    v_mfma_f32_16x16x32_bf16 v[84:87], v[196:199], v[240:243], v[84:87]
    v_cvt_pk_bf16_f32 v64, v64, v65
    v_cvt_pk_bf16_f32 v65, v66, v67
    v_mfma_f32_16x16x32_bf16 v[88:91], v[168:171], v[240:243], v[88:91]
    v_cvt_pk_bf16_f32 v66, v68, v69
    v_cvt_pk_bf16_f32 v67, v70, v71
    v_mfma_f32_16x16x32_bf16 v[92:95], v[172:175], v[240:243], v[92:95]
    s_add_u32 s47, s48, 4210688
    buffer_store_dwordx4 v[64:67], v251, s[16:19], s47 offen sc1
    v_mfma_f32_16x16x32_bf16 v[80:83], v[200:203], v[244:247], v[80:83]
    v_cvt_pk_bf16_f32 v72, v72, v73
    v_cvt_pk_bf16_f32 v73, v74, v75
    v_mfma_f32_16x16x32_bf16 v[84:87], v[204:207], v[244:247], v[84:87]
    v_cvt_pk_bf16_f32 v74, v76, v77
    v_cvt_pk_bf16_f32 v75, v78, v79
    v_mfma_f32_16x16x32_bf16 v[88:91], v[192:195], v[244:247], v[88:91]
    s_add_u32 s47, s48, 4211712
    buffer_store_dwordx4 v[72:75], v251, s[16:19], s47 offen sc1
    v_mfma_f32_16x16x32_bf16 v[92:95], v[196:199], v[244:247], v[92:95]
    s_waitcnt lgkmcnt(2)
    v_mfma_f32_16x16x32_bf16 v[128:131], v[176:179], v[216:219], v[128:131]
    ds_read_b128 v[232:235], v250 offset:25600
    ds_read_b128 v[236:239], v250 offset:36864
    v_mfma_f32_16x16x32_bf16 v[132:135], v[180:183], v[216:219], v[132:135]
    v_mfma_f32_16x16x32_bf16 v[136:139], v[208:211], v[216:219], v[136:139]
    v_mfma_f32_16x16x32_bf16 v[140:143], v[212:215], v[216:219], v[140:143]
    v_mfma_f32_16x16x32_bf16 v[128:131], v[184:187], v[220:223], v[128:131]
    v_mfma_f32_16x16x32_bf16 v[132:135], v[188:191], v[220:223], v[132:135]
    v_mfma_f32_16x16x32_bf16 v[136:139], v[176:179], v[220:223], v[136:139]
    v_mfma_f32_16x16x32_bf16 v[140:143], v[180:183], v[220:223], v[140:143]
    s_waitcnt lgkmcnt(2)
    v_mfma_f32_16x16x32_bf16 v[96:99], v[192:195], v[224:227], v[96:99]
    ds_read_b128 v[240:243], v253 offset:23552
    ds_read_b128 v[244:247], v253 offset:34816
    v_mfma_f32_16x16x32_bf16 v[100:103], v[196:199], v[224:227], v[100:103]
    v_cvt_pk_bf16_f32 v80, v80, v81
    v_cvt_pk_bf16_f32 v81, v82, v83
    v_mfma_f32_16x16x32_bf16 v[104:107], v[168:171], v[224:227], v[104:107]
    v_cvt_pk_bf16_f32 v82, v84, v85
    v_cvt_pk_bf16_f32 v83, v86, v87
    v_mfma_f32_16x16x32_bf16 v[108:111], v[172:175], v[224:227], v[108:111]
    s_add_u32 s47, s48, 5263360
    buffer_store_dwordx4 v[80:83], v251, s[16:19], s47 offen sc1
    v_mfma_f32_16x16x32_bf16 v[96:99], v[200:203], v[228:231], v[96:99]
    v_cvt_pk_bf16_f32 v88, v88, v89
    v_cvt_pk_bf16_f32 v89, v90, v91
    v_mfma_f32_16x16x32_bf16 v[100:103], v[204:207], v[228:231], v[100:103]
    v_cvt_pk_bf16_f32 v90, v92, v93
    v_cvt_pk_bf16_f32 v91, v94, v95
    v_mfma_f32_16x16x32_bf16 v[104:107], v[192:195], v[228:231], v[104:107]
    s_add_u32 s47, s48, 5264384
    buffer_store_dwordx4 v[88:91], v251, s[16:19], s47 offen sc1
    v_mfma_f32_16x16x32_bf16 v[108:111], v[196:199], v[228:231], v[108:111]
    s_waitcnt lgkmcnt(2)
    v_mfma_f32_16x16x32_bf16 v[144:147], v[176:179], v[232:235], v[144:147]
    ds_read_b128 v[216:219], v250 offset:26624
    ds_read_b128 v[220:223], v250 offset:37888
    v_mfma_f32_16x16x32_bf16 v[148:151], v[180:183], v[232:235], v[148:151]
    v_mfma_f32_16x16x32_bf16 v[152:155], v[208:211], v[232:235], v[152:155]
    v_mfma_f32_16x16x32_bf16 v[156:159], v[212:215], v[232:235], v[156:159]
    v_mfma_f32_16x16x32_bf16 v[144:147], v[184:187], v[236:239], v[144:147]
    v_mfma_f32_16x16x32_bf16 v[148:151], v[188:191], v[236:239], v[148:151]
    v_mfma_f32_16x16x32_bf16 v[152:155], v[176:179], v[236:239], v[152:155]
    v_mfma_f32_16x16x32_bf16 v[156:159], v[180:183], v[236:239], v[156:159]
    s_waitcnt lgkmcnt(2)
    v_mfma_f32_16x16x32_bf16 v[112:115], v[192:195], v[240:243], v[112:115]
    ds_read_b128 v[224:227], v253 offset:24576
    ds_read_b128 v[228:231], v253 offset:35840
    v_mfma_f32_16x16x32_bf16 v[116:119], v[196:199], v[240:243], v[116:119]
    v_cvt_pk_bf16_f32 v96, v96, v97
    v_cvt_pk_bf16_f32 v97, v98, v99
    v_mfma_f32_16x16x32_bf16 v[120:123], v[168:171], v[240:243], v[120:123]
    v_cvt_pk_bf16_f32 v98, v100, v101
    v_cvt_pk_bf16_f32 v99, v102, v103
    v_mfma_f32_16x16x32_bf16 v[124:127], v[172:175], v[240:243], v[124:127]
    s_add_u32 s47, s48, 6316032
    buffer_store_dwordx4 v[96:99], v251, s[16:19], s47 offen sc1
    v_mfma_f32_16x16x32_bf16 v[112:115], v[200:203], v[244:247], v[112:115]
    v_cvt_pk_bf16_f32 v104, v104, v105
    v_cvt_pk_bf16_f32 v105, v106, v107
    v_mfma_f32_16x16x32_bf16 v[116:119], v[204:207], v[244:247], v[116:119]
    v_cvt_pk_bf16_f32 v106, v108, v109
    v_cvt_pk_bf16_f32 v107, v110, v111
    v_mfma_f32_16x16x32_bf16 v[120:123], v[192:195], v[244:247], v[120:123]
    s_add_u32 s47, s48, 6317056
    buffer_store_dwordx4 v[104:107], v251, s[16:19], s47 offen sc1
    v_mfma_f32_16x16x32_bf16 v[124:127], v[196:199], v[244:247], v[124:127]
    s_waitcnt lgkmcnt(2)
    v_mfma_f32_16x16x32_bf16 v[160:163], v[176:179], v[216:219], v[160:163]
    ds_read_b128 v[232:235], v253 offset:25600
    ds_read_b128 v[236:239], v253 offset:36864
    v_mfma_f32_16x16x32_bf16 v[164:167], v[208:211], v[216:219], v[164:167]
    v_mfma_f32_16x16x32_bf16 v[160:163], v[184:187], v[220:223], v[160:163]
    v_mfma_f32_16x16x32_bf16 v[164:167], v[176:179], v[220:223], v[164:167]
    s_waitcnt lgkmcnt(2)
    v_mfma_f32_16x16x32_bf16 v[128:131], v[192:195], v[224:227], v[128:131]
    ds_read_b128 v[240:243], v253 offset:26624
    ds_read_b128 v[244:247], v253 offset:37888
    v_mfma_f32_16x16x32_bf16 v[132:135], v[196:199], v[224:227], v[132:135]
    v_cvt_pk_bf16_f32 v112, v112, v113
    v_cvt_pk_bf16_f32 v113, v114, v115
    v_mfma_f32_16x16x32_bf16 v[136:139], v[168:171], v[224:227], v[136:139]
    v_cvt_pk_bf16_f32 v114, v116, v117
    v_cvt_pk_bf16_f32 v115, v118, v119
    v_mfma_f32_16x16x32_bf16 v[140:143], v[172:175], v[224:227], v[140:143]
    s_add_u32 s47, s48, 7368704
    buffer_store_dwordx4 v[112:115], v251, s[16:19], s47 offen sc1
    v_mfma_f32_16x16x32_bf16 v[128:131], v[200:203], v[228:231], v[128:131]
    v_cvt_pk_bf16_f32 v120, v120, v121
    v_cvt_pk_bf16_f32 v121, v122, v123
    v_mfma_f32_16x16x32_bf16 v[132:135], v[204:207], v[228:231], v[132:135]
    v_cvt_pk_bf16_f32 v122, v124, v125
    v_cvt_pk_bf16_f32 v123, v126, v127
    v_mfma_f32_16x16x32_bf16 v[136:139], v[192:195], v[228:231], v[136:139]
    s_add_u32 s47, s48, 7369728
    buffer_store_dwordx4 v[120:123], v251, s[16:19], s47 offen sc1
    v_mfma_f32_16x16x32_bf16 v[140:143], v[196:199], v[228:231], v[140:143]
    s_waitcnt lgkmcnt(2)
    v_mfma_f32_16x16x32_bf16 v[144:147], v[192:195], v[232:235], v[144:147]
    v_mfma_f32_16x16x32_bf16 v[148:151], v[196:199], v[232:235], v[148:151]
    v_mfma_f32_16x16x32_bf16 v[152:155], v[168:171], v[232:235], v[152:155]
    v_mfma_f32_16x16x32_bf16 v[156:159], v[172:175], v[232:235], v[156:159]
    v_mfma_f32_16x16x32_bf16 v[144:147], v[200:203], v[236:239], v[144:147]
    v_mfma_f32_16x16x32_bf16 v[148:151], v[204:207], v[236:239], v[148:151]
    v_mfma_f32_16x16x32_bf16 v[152:155], v[192:195], v[236:239], v[152:155]
    v_mfma_f32_16x16x32_bf16 v[156:159], v[196:199], v[236:239], v[156:159]
    s_waitcnt lgkmcnt(0)
    v_mfma_f32_16x16x32_bf16 v[160:163], v[192:195], v[240:243], v[160:163]
    v_mfma_f32_16x16x32_bf16 v[164:167], v[168:171], v[240:243], v[164:167]
    v_cvt_pk_bf16_f32 v128, v128, v129
    v_cvt_pk_bf16_f32 v129, v130, v131
    v_mfma_f32_16x16x32_bf16 v[160:163], v[200:203], v[244:247], v[160:163]
    v_cvt_pk_bf16_f32 v130, v132, v133
    v_cvt_pk_bf16_f32 v131, v134, v135
    v_mfma_f32_16x16x32_bf16 v[164:167], v[192:195], v[244:247], v[164:167]
    s_add_u32 s47, s48, 8421376
    buffer_store_dwordx4 v[128:131], v251, s[16:19], s47 offen sc1
    s_nop 7
    v_cvt_pk_bf16_f32 v136, v136, v137
    v_cvt_pk_bf16_f32 v137, v138, v139
    v_cvt_pk_bf16_f32 v138, v140, v141
    v_cvt_pk_bf16_f32 v139, v142, v143
    s_add_u32 s47, s48, 8422400
    buffer_store_dwordx4 v[136:139], v251, s[16:19], s47 offen sc1
    v_cvt_pk_bf16_f32 v144, v144, v145
    v_cvt_pk_bf16_f32 v145, v146, v147
    v_cvt_pk_bf16_f32 v146, v148, v149
    v_cvt_pk_bf16_f32 v147, v150, v151
    s_add_u32 s47, s48, 9474048
    buffer_store_dwordx4 v[144:147], v251, s[16:19], s47 offen sc1
    v_cvt_pk_bf16_f32 v152, v152, v153
    v_cvt_pk_bf16_f32 v153, v154, v155
    v_cvt_pk_bf16_f32 v154, v156, v157
    v_cvt_pk_bf16_f32 v155, v158, v159
    s_add_u32 s47, s48, 9475072
    buffer_store_dwordx4 v[152:155], v251, s[16:19], s47 offen sc1
    v_cvt_pk_bf16_f32 v160, v160, v161
    v_cvt_pk_bf16_f32 v161, v162, v163
    s_add_u32 s47, s49, 0
    buffer_store_dwordx2 v[160:161], v252, s[16:19], s47 offen sc1
    v_cvt_pk_bf16_f32 v164, v164, v165
    v_cvt_pk_bf16_f32 v165, v166, v167
    s_add_u32 s47, s49, 1024
    buffer_store_dwordx2 v[164:165], v252, s[16:19], s47 offen sc1
    s_branch L_epi_done
L_epi_b1:
    v_add_u32 v248, 0x9800, v248
    v_add_u32 v249, 0x9800, v249
    v_add_u32 v253, 38912, v250
    ds_read_b64_tr_b16 v[192:193], v248 offset:0
    ds_read_b64_tr_b16 v[194:195], v248 offset:1024
    ds_read_b64_tr_b16 v[196:197], v249 offset:0
    ds_read_b64_tr_b16 v[198:199], v249 offset:1024
    ds_read_b64_tr_b16 v[200:201], v248 offset:8192
    ds_read_b64_tr_b16 v[202:203], v248 offset:9216
    ds_read_b64_tr_b16 v[204:205], v249 offset:8192
    ds_read_b64_tr_b16 v[206:207], v249 offset:9216
    s_waitcnt lgkmcnt(10)
    v_mfma_f32_16x16x32_bf16 v[0:3], v[176:179], v[232:235], v[0:3]
    ds_read_b128 v[216:219], v250 offset:18432
    ds_read_b128 v[220:223], v250 offset:29696
    v_mfma_f32_16x16x32_bf16 v[4:7], v[180:183], v[232:235], v[4:7]
    v_mfma_f32_16x16x32_bf16 v[8:11], v[208:211], v[232:235], v[8:11]
    v_mfma_f32_16x16x32_bf16 v[12:15], v[212:215], v[232:235], v[12:15]
    v_mfma_f32_16x16x32_bf16 v[0:3], v[184:187], v[236:239], v[0:3]
    v_mfma_f32_16x16x32_bf16 v[4:7], v[188:191], v[236:239], v[4:7]
    v_mfma_f32_16x16x32_bf16 v[8:11], v[176:179], v[236:239], v[8:11]
    v_mfma_f32_16x16x32_bf16 v[12:15], v[180:183], v[236:239], v[12:15]
    s_waitcnt lgkmcnt(10)
    v_mfma_f32_16x16x32_bf16 v[16:19], v[176:179], v[240:243], v[16:19]
    ds_read_b128 v[224:227], v253 offset:16384
    ds_read_b128 v[228:231], v253 offset:27648
    v_mfma_f32_16x16x32_bf16 v[20:23], v[180:183], v[240:243], v[20:23]
    v_mfma_f32_16x16x32_bf16 v[24:27], v[208:211], v[240:243], v[24:27]
    v_mfma_f32_16x16x32_bf16 v[28:31], v[212:215], v[240:243], v[28:31]
    v_mfma_f32_16x16x32_bf16 v[16:19], v[184:187], v[244:247], v[16:19]
    v_mfma_f32_16x16x32_bf16 v[20:23], v[188:191], v[244:247], v[20:23]
    v_mfma_f32_16x16x32_bf16 v[24:27], v[176:179], v[244:247], v[24:27]
    v_mfma_f32_16x16x32_bf16 v[28:31], v[180:183], v[244:247], v[28:31]
    s_waitcnt lgkmcnt(2)
    v_mfma_f32_16x16x32_bf16 v[32:35], v[176:179], v[216:219], v[32:35]
    ds_read_b128 v[232:235], v250 offset:19456
    ds_read_b128 v[236:239], v250 offset:30720
    v_mfma_f32_16x16x32_bf16 v[36:39], v[180:183], v[216:219], v[36:39]
    v_mfma_f32_16x16x32_bf16 v[40:43], v[208:211], v[216:219], v[40:43]
    v_mfma_f32_16x16x32_bf16 v[44:47], v[212:215], v[216:219], v[44:47]
    v_mfma_f32_16x16x32_bf16 v[32:35], v[184:187], v[220:223], v[32:35]
    v_mfma_f32_16x16x32_bf16 v[36:39], v[188:191], v[220:223], v[36:39]
    v_mfma_f32_16x16x32_bf16 v[40:43], v[176:179], v[220:223], v[40:43]
    v_mfma_f32_16x16x32_bf16 v[44:47], v[180:183], v[220:223], v[44:47]
    v_xor_b32 v168, 0x80008000, v200
    v_xor_b32 v169, 0x80008000, v201
    v_xor_b32 v170, 0x80008000, v202
    v_xor_b32 v171, 0x80008000, v203
    v_xor_b32 v172, 0x80008000, v204
    v_xor_b32 v173, 0x80008000, v205
    v_xor_b32 v174, 0x80008000, v206
    v_xor_b32 v175, 0x80008000, v207
    s_waitcnt lgkmcnt(2)
    v_mfma_f32_16x16x32_bf16 v[0:3], v[192:195], v[224:227], v[0:3]
    ds_read_b128 v[240:243], v253 offset:17408
    ds_read_b128 v[244:247], v253 offset:28672
    v_mfma_f32_16x16x32_bf16 v[4:7], v[196:199], v[224:227], v[4:7]
    v_mfma_f32_16x16x32_bf16 v[8:11], v[168:171], v[224:227], v[8:11]
    v_mfma_f32_16x16x32_bf16 v[12:15], v[172:175], v[224:227], v[12:15]
    v_mfma_f32_16x16x32_bf16 v[0:3], v[200:203], v[228:231], v[0:3]
    v_mfma_f32_16x16x32_bf16 v[4:7], v[204:207], v[228:231], v[4:7]
    v_mfma_f32_16x16x32_bf16 v[8:11], v[192:195], v[228:231], v[8:11]
    v_mfma_f32_16x16x32_bf16 v[12:15], v[196:199], v[228:231], v[12:15]
    s_waitcnt lgkmcnt(2)
    v_mfma_f32_16x16x32_bf16 v[48:51], v[176:179], v[232:235], v[48:51]
    ds_read_b128 v[216:219], v250 offset:20480
    ds_read_b128 v[220:223], v250 offset:31744
    v_mfma_f32_16x16x32_bf16 v[52:55], v[180:183], v[232:235], v[52:55]
    v_mfma_f32_16x16x32_bf16 v[56:59], v[208:211], v[232:235], v[56:59]
    v_mfma_f32_16x16x32_bf16 v[60:63], v[212:215], v[232:235], v[60:63]
    v_mfma_f32_16x16x32_bf16 v[48:51], v[184:187], v[236:239], v[48:51]
    v_mfma_f32_16x16x32_bf16 v[52:55], v[188:191], v[236:239], v[52:55]
    v_mfma_f32_16x16x32_bf16 v[56:59], v[176:179], v[236:239], v[56:59]
    v_mfma_f32_16x16x32_bf16 v[60:63], v[180:183], v[236:239], v[60:63]
    s_waitcnt lgkmcnt(2)
    v_mfma_f32_16x16x32_bf16 v[16:19], v[192:195], v[240:243], v[16:19]
    ds_read_b128 v[224:227], v253 offset:18432
    ds_read_b128 v[228:231], v253 offset:29696
    v_mfma_f32_16x16x32_bf16 v[20:23], v[196:199], v[240:243], v[20:23]
    v_cvt_pk_bf16_f32 v4, v4, v5
    v_cvt_pk_bf16_f32 v5, v6, v7
    v_mfma_f32_16x16x32_bf16 v[24:27], v[168:171], v[240:243], v[24:27]
    v_cvt_pk_bf16_f32 v6, v0, v1
    v_cvt_pk_bf16_f32 v7, v2, v3
    v_mfma_f32_16x16x32_bf16 v[28:31], v[172:175], v[240:243], v[28:31]
    s_add_u32 s47, s48, 0
    buffer_store_dwordx4 v[4:7], v251, s[16:19], s47 offen sc1
    v_mfma_f32_16x16x32_bf16 v[16:19], v[200:203], v[244:247], v[16:19]
    v_cvt_pk_bf16_f32 v12, v12, v13
    v_cvt_pk_bf16_f32 v13, v14, v15
    v_mfma_f32_16x16x32_bf16 v[20:23], v[204:207], v[244:247], v[20:23]
    v_cvt_pk_bf16_f32 v14, v8, v9
    v_cvt_pk_bf16_f32 v15, v10, v11
    v_mfma_f32_16x16x32_bf16 v[24:27], v[192:195], v[244:247], v[24:27]
    s_add_u32 s47, s48, 1024
    buffer_store_dwordx4 v[12:15], v251, s[16:19], s47 offen sc1
    v_mfma_f32_16x16x32_bf16 v[28:31], v[196:199], v[244:247], v[28:31]
    s_waitcnt lgkmcnt(2)
    v_mfma_f32_16x16x32_bf16 v[64:67], v[176:179], v[216:219], v[64:67]
    ds_read_b128 v[232:235], v250 offset:21504
    ds_read_b128 v[236:239], v250 offset:32768
    v_mfma_f32_16x16x32_bf16 v[68:71], v[180:183], v[216:219], v[68:71]
    v_mfma_f32_16x16x32_bf16 v[72:75], v[208:211], v[216:219], v[72:75]
    v_mfma_f32_16x16x32_bf16 v[76:79], v[212:215], v[216:219], v[76:79]
    v_mfma_f32_16x16x32_bf16 v[64:67], v[184:187], v[220:223], v[64:67]
    v_mfma_f32_16x16x32_bf16 v[68:71], v[188:191], v[220:223], v[68:71]
    v_mfma_f32_16x16x32_bf16 v[72:75], v[176:179], v[220:223], v[72:75]
    v_mfma_f32_16x16x32_bf16 v[76:79], v[180:183], v[220:223], v[76:79]
    s_waitcnt lgkmcnt(2)
    v_mfma_f32_16x16x32_bf16 v[32:35], v[192:195], v[224:227], v[32:35]
    ds_read_b128 v[240:243], v253 offset:19456
    ds_read_b128 v[244:247], v253 offset:30720
    v_mfma_f32_16x16x32_bf16 v[36:39], v[196:199], v[224:227], v[36:39]
    v_cvt_pk_bf16_f32 v20, v20, v21
    v_cvt_pk_bf16_f32 v21, v22, v23
    v_mfma_f32_16x16x32_bf16 v[40:43], v[168:171], v[224:227], v[40:43]
    v_cvt_pk_bf16_f32 v22, v16, v17
    v_cvt_pk_bf16_f32 v23, v18, v19
    v_mfma_f32_16x16x32_bf16 v[44:47], v[172:175], v[224:227], v[44:47]
    s_add_u32 s47, s48, 1052672
    buffer_store_dwordx4 v[20:23], v251, s[16:19], s47 offen sc1
    v_mfma_f32_16x16x32_bf16 v[32:35], v[200:203], v[228:231], v[32:35]
    v_cvt_pk_bf16_f32 v28, v28, v29
    v_cvt_pk_bf16_f32 v29, v30, v31
    v_mfma_f32_16x16x32_bf16 v[36:39], v[204:207], v[228:231], v[36:39]
    v_cvt_pk_bf16_f32 v30, v24, v25
    v_cvt_pk_bf16_f32 v31, v26, v27
    v_mfma_f32_16x16x32_bf16 v[40:43], v[192:195], v[228:231], v[40:43]
    s_add_u32 s47, s48, 1053696
    buffer_store_dwordx4 v[28:31], v251, s[16:19], s47 offen sc1
    v_mfma_f32_16x16x32_bf16 v[44:47], v[196:199], v[228:231], v[44:47]
    s_waitcnt lgkmcnt(2)
    v_mfma_f32_16x16x32_bf16 v[80:83], v[176:179], v[232:235], v[80:83]
    ds_read_b128 v[216:219], v250 offset:22528
    ds_read_b128 v[220:223], v250 offset:33792
    v_mfma_f32_16x16x32_bf16 v[84:87], v[180:183], v[232:235], v[84:87]
    v_mfma_f32_16x16x32_bf16 v[88:91], v[208:211], v[232:235], v[88:91]
    v_mfma_f32_16x16x32_bf16 v[92:95], v[212:215], v[232:235], v[92:95]
    v_mfma_f32_16x16x32_bf16 v[80:83], v[184:187], v[236:239], v[80:83]
    v_mfma_f32_16x16x32_bf16 v[84:87], v[188:191], v[236:239], v[84:87]
    v_mfma_f32_16x16x32_bf16 v[88:91], v[176:179], v[236:239], v[88:91]
    v_mfma_f32_16x16x32_bf16 v[92:95], v[180:183], v[236:239], v[92:95]
    s_waitcnt lgkmcnt(2)
    v_mfma_f32_16x16x32_bf16 v[48:51], v[192:195], v[240:243], v[48:51]
    ds_read_b128 v[224:227], v253 offset:20480
    ds_read_b128 v[228:231], v253 offset:31744
    v_mfma_f32_16x16x32_bf16 v[52:55], v[196:199], v[240:243], v[52:55]
    v_cvt_pk_bf16_f32 v36, v36, v37
    v_cvt_pk_bf16_f32 v37, v38, v39
    v_mfma_f32_16x16x32_bf16 v[56:59], v[168:171], v[240:243], v[56:59]
    v_cvt_pk_bf16_f32 v38, v32, v33
    v_cvt_pk_bf16_f32 v39, v34, v35
    v_mfma_f32_16x16x32_bf16 v[60:63], v[172:175], v[240:243], v[60:63]
    s_add_u32 s47, s48, 2105344
    buffer_store_dwordx4 v[36:39], v251, s[16:19], s47 offen sc1
    v_mfma_f32_16x16x32_bf16 v[48:51], v[200:203], v[244:247], v[48:51]
    v_cvt_pk_bf16_f32 v44, v44, v45
    v_cvt_pk_bf16_f32 v45, v46, v47
    v_mfma_f32_16x16x32_bf16 v[52:55], v[204:207], v[244:247], v[52:55]
    v_cvt_pk_bf16_f32 v46, v40, v41
    v_cvt_pk_bf16_f32 v47, v42, v43
    v_mfma_f32_16x16x32_bf16 v[56:59], v[192:195], v[244:247], v[56:59]
    s_add_u32 s47, s48, 2106368
    buffer_store_dwordx4 v[44:47], v251, s[16:19], s47 offen sc1
    v_mfma_f32_16x16x32_bf16 v[60:63], v[196:199], v[244:247], v[60:63]
    s_waitcnt lgkmcnt(2)
    v_mfma_f32_16x16x32_bf16 v[96:99], v[176:179], v[216:219], v[96:99]
    ds_read_b128 v[232:235], v250 offset:23552
    ds_read_b128 v[236:239], v250 offset:34816
    v_mfma_f32_16x16x32_bf16 v[100:103], v[180:183], v[216:219], v[100:103]
    v_mfma_f32_16x16x32_bf16 v[104:107], v[208:211], v[216:219], v[104:107]
    v_mfma_f32_16x16x32_bf16 v[108:111], v[212:215], v[216:219], v[108:111]
    v_mfma_f32_16x16x32_bf16 v[96:99], v[184:187], v[220:223], v[96:99]
    v_mfma_f32_16x16x32_bf16 v[100:103], v[188:191], v[220:223], v[100:103]
    v_mfma_f32_16x16x32_bf16 v[104:107], v[176:179], v[220:223], v[104:107]
    v_mfma_f32_16x16x32_bf16 v[108:111], v[180:183], v[220:223], v[108:111]
    s_waitcnt lgkmcnt(2)
    v_mfma_f32_16x16x32_bf16 v[64:67], v[192:195], v[224:227], v[64:67]
    ds_read_b128 v[240:243], v253 offset:21504
    ds_read_b128 v[244:247], v253 offset:32768
    v_mfma_f32_16x16x32_bf16 v[68:71], v[196:199], v[224:227], v[68:71]
    v_cvt_pk_bf16_f32 v52, v52, v53
    v_cvt_pk_bf16_f32 v53, v54, v55
    v_mfma_f32_16x16x32_bf16 v[72:75], v[168:171], v[224:227], v[72:75]
    v_cvt_pk_bf16_f32 v54, v48, v49
    v_cvt_pk_bf16_f32 v55, v50, v51
    v_mfma_f32_16x16x32_bf16 v[76:79], v[172:175], v[224:227], v[76:79]
    s_add_u32 s47, s48, 3158016
    buffer_store_dwordx4 v[52:55], v251, s[16:19], s47 offen sc1
    v_mfma_f32_16x16x32_bf16 v[64:67], v[200:203], v[228:231], v[64:67]
    v_cvt_pk_bf16_f32 v60, v60, v61
    v_cvt_pk_bf16_f32 v61, v62, v63
    v_mfma_f32_16x16x32_bf16 v[68:71], v[204:207], v[228:231], v[68:71]
    v_cvt_pk_bf16_f32 v62, v56, v57
    v_cvt_pk_bf16_f32 v63, v58, v59
    v_mfma_f32_16x16x32_bf16 v[72:75], v[192:195], v[228:231], v[72:75]
    s_add_u32 s47, s48, 3159040
    buffer_store_dwordx4 v[60:63], v251, s[16:19], s47 offen sc1
    v_mfma_f32_16x16x32_bf16 v[76:79], v[196:199], v[228:231], v[76:79]
    s_waitcnt lgkmcnt(2)
    v_mfma_f32_16x16x32_bf16 v[112:115], v[176:179], v[232:235], v[112:115]
    ds_read_b128 v[216:219], v250 offset:24576
    ds_read_b128 v[220:223], v250 offset:35840
    v_mfma_f32_16x16x32_bf16 v[116:119], v[180:183], v[232:235], v[116:119]
    v_mfma_f32_16x16x32_bf16 v[120:123], v[208:211], v[232:235], v[120:123]
    v_mfma_f32_16x16x32_bf16 v[124:127], v[212:215], v[232:235], v[124:127]
    v_mfma_f32_16x16x32_bf16 v[112:115], v[184:187], v[236:239], v[112:115]
    v_mfma_f32_16x16x32_bf16 v[116:119], v[188:191], v[236:239], v[116:119]
    v_mfma_f32_16x16x32_bf16 v[120:123], v[176:179], v[236:239], v[120:123]
    v_mfma_f32_16x16x32_bf16 v[124:127], v[180:183], v[236:239], v[124:127]
    s_waitcnt lgkmcnt(2)
    v_mfma_f32_16x16x32_bf16 v[80:83], v[192:195], v[240:243], v[80:83]
    ds_read_b128 v[224:227], v253 offset:22528
    ds_read_b128 v[228:231], v253 offset:33792
    v_mfma_f32_16x16x32_bf16 v[84:87], v[196:199], v[240:243], v[84:87]
    v_cvt_pk_bf16_f32 v68, v68, v69
    v_cvt_pk_bf16_f32 v69, v70, v71
    v_mfma_f32_16x16x32_bf16 v[88:91], v[168:171], v[240:243], v[88:91]
    v_cvt_pk_bf16_f32 v70, v64, v65
    v_cvt_pk_bf16_f32 v71, v66, v67
    v_mfma_f32_16x16x32_bf16 v[92:95], v[172:175], v[240:243], v[92:95]
    s_add_u32 s47, s48, 4210688
    buffer_store_dwordx4 v[68:71], v251, s[16:19], s47 offen sc1
    v_mfma_f32_16x16x32_bf16 v[80:83], v[200:203], v[244:247], v[80:83]
    v_cvt_pk_bf16_f32 v76, v76, v77
    v_cvt_pk_bf16_f32 v77, v78, v79
    v_mfma_f32_16x16x32_bf16 v[84:87], v[204:207], v[244:247], v[84:87]
    v_cvt_pk_bf16_f32 v78, v72, v73
    v_cvt_pk_bf16_f32 v79, v74, v75
    v_mfma_f32_16x16x32_bf16 v[88:91], v[192:195], v[244:247], v[88:91]
    s_add_u32 s47, s48, 4211712
    buffer_store_dwordx4 v[76:79], v251, s[16:19], s47 offen sc1
    v_mfma_f32_16x16x32_bf16 v[92:95], v[196:199], v[244:247], v[92:95]
    s_waitcnt lgkmcnt(2)
    v_mfma_f32_16x16x32_bf16 v[128:131], v[176:179], v[216:219], v[128:131]
    ds_read_b128 v[232:235], v250 offset:25600
    ds_read_b128 v[236:239], v250 offset:36864
    v_mfma_f32_16x16x32_bf16 v[132:135], v[180:183], v[216:219], v[132:135]
    v_mfma_f32_16x16x32_bf16 v[136:139], v[208:211], v[216:219], v[136:139]
    v_mfma_f32_16x16x32_bf16 v[140:143], v[212:215], v[216:219], v[140:143]
    v_mfma_f32_16x16x32_bf16 v[128:131], v[184:187], v[220:223], v[128:131]
    v_mfma_f32_16x16x32_bf16 v[132:135], v[188:191], v[220:223], v[132:135]
    v_mfma_f32_16x16x32_bf16 v[136:139], v[176:179], v[220:223], v[136:139]
    v_mfma_f32_16x16x32_bf16 v[140:143], v[180:183], v[220:223], v[140:143]
    s_waitcnt lgkmcnt(2)
    v_mfma_f32_16x16x32_bf16 v[96:99], v[192:195], v[224:227], v[96:99]
    ds_read_b128 v[240:243], v253 offset:23552
    ds_read_b128 v[244:247], v253 offset:34816
    v_mfma_f32_16x16x32_bf16 v[100:103], v[196:199], v[224:227], v[100:103]
    v_cvt_pk_bf16_f32 v84, v84, v85
    v_cvt_pk_bf16_f32 v85, v86, v87
    v_mfma_f32_16x16x32_bf16 v[104:107], v[168:171], v[224:227], v[104:107]
    v_cvt_pk_bf16_f32 v86, v80, v81
    v_cvt_pk_bf16_f32 v87, v82, v83
    v_mfma_f32_16x16x32_bf16 v[108:111], v[172:175], v[224:227], v[108:111]
    s_add_u32 s47, s48, 5263360
    buffer_store_dwordx4 v[84:87], v251, s[16:19], s47 offen sc1
    v_mfma_f32_16x16x32_bf16 v[96:99], v[200:203], v[228:231], v[96:99]
    v_cvt_pk_bf16_f32 v92, v92, v93
    v_cvt_pk_bf16_f32 v93, v94, v95
    v_mfma_f32_16x16x32_bf16 v[100:103], v[204:207], v[228:231], v[100:103]
    v_cvt_pk_bf16_f32 v94, v88, v89
    v_cvt_pk_bf16_f32 v95, v90, v91
    v_mfma_f32_16x16x32_bf16 v[104:107], v[192:195], v[228:231], v[104:107]
    s_add_u32 s47, s48, 5264384
    buffer_store_dwordx4 v[92:95], v251, s[16:19], s47 offen sc1
    v_mfma_f32_16x16x32_bf16 v[108:111], v[196:199], v[228:231], v[108:111]
    s_waitcnt lgkmcnt(2)
    v_mfma_f32_16x16x32_bf16 v[144:147], v[176:179], v[232:235], v[144:147]
    ds_read_b128 v[216:219], v250 offset:26624
    ds_read_b128 v[220:223], v250 offset:37888
    v_mfma_f32_16x16x32_bf16 v[148:151], v[180:183], v[232:235], v[148:151]
    v_mfma_f32_16x16x32_bf16 v[152:155], v[208:211], v[232:235], v[152:155]
    v_mfma_f32_16x16x32_bf16 v[156:159], v[212:215], v[232:235], v[156:159]
    v_mfma_f32_16x16x32_bf16 v[144:147], v[184:187], v[236:239], v[144:147]
    v_mfma_f32_16x16x32_bf16 v[148:151], v[188:191], v[236:239], v[148:151]
    v_mfma_f32_16x16x32_bf16 v[152:155], v[176:179], v[236:239], v[152:155]
    v_mfma_f32_16x16x32_bf16 v[156:159], v[180:183], v[236:239], v[156:159]
    s_waitcnt lgkmcnt(2)
    v_mfma_f32_16x16x32_bf16 v[112:115], v[192:195], v[240:243], v[112:115]
    ds_read_b128 v[224:227], v253 offset:24576
    ds_read_b128 v[228:231], v253 offset:35840
    v_mfma_f32_16x16x32_bf16 v[116:119], v[196:199], v[240:243], v[116:119]
    v_cvt_pk_bf16_f32 v100, v100, v101
    v_cvt_pk_bf16_f32 v101, v102, v103
    v_mfma_f32_16x16x32_bf16 v[120:123], v[168:171], v[240:243], v[120:123]
    v_cvt_pk_bf16_f32 v102, v96, v97
    v_cvt_pk_bf16_f32 v103, v98, v99
    v_mfma_f32_16x16x32_bf16 v[124:127], v[172:175], v[240:243], v[124:127]
    s_add_u32 s47, s48, 6316032
    buffer_store_dwordx4 v[100:103], v251, s[16:19], s47 offen sc1
    v_mfma_f32_16x16x32_bf16 v[112:115], v[200:203], v[244:247], v[112:115]
    v_cvt_pk_bf16_f32 v108, v108, v109
    v_cvt_pk_bf16_f32 v109, v110, v111
    v_mfma_f32_16x16x32_bf16 v[116:119], v[204:207], v[244:247], v[116:119]
    v_cvt_pk_bf16_f32 v110, v104, v105
    v_cvt_pk_bf16_f32 v111, v106, v107
    v_mfma_f32_16x16x32_bf16 v[120:123], v[192:195], v[244:247], v[120:123]
    s_add_u32 s47, s48, 6317056
    buffer_store_dwordx4 v[108:111], v251, s[16:19], s47 offen sc1
    v_mfma_f32_16x16x32_bf16 v[124:127], v[196:199], v[244:247], v[124:127]
    s_waitcnt lgkmcnt(2)
    v_mfma_f32_16x16x32_bf16 v[160:163], v[176:179], v[216:219], v[160:163]
    ds_read_b128 v[232:235], v253 offset:25600
    ds_read_b128 v[236:239], v253 offset:36864
    v_mfma_f32_16x16x32_bf16 v[164:167], v[208:211], v[216:219], v[164:167]
    v_mfma_f32_16x16x32_bf16 v[160:163], v[184:187], v[220:223], v[160:163]
    v_mfma_f32_16x16x32_bf16 v[164:167], v[176:179], v[220:223], v[164:167]
    s_waitcnt lgkmcnt(2)
    v_mfma_f32_16x16x32_bf16 v[128:131], v[192:195], v[224:227], v[128:131]
    ds_read_b128 v[240:243], v253 offset:26624
    ds_read_b128 v[244:247], v253 offset:37888
    v_mfma_f32_16x16x32_bf16 v[132:135], v[196:199], v[224:227], v[132:135]
    v_cvt_pk_bf16_f32 v116, v116, v117
    v_cvt_pk_bf16_f32 v117, v118, v119
    v_mfma_f32_16x16x32_bf16 v[136:139], v[168:171], v[224:227], v[136:139]
    v_cvt_pk_bf16_f32 v118, v112, v113
    v_cvt_pk_bf16_f32 v119, v114, v115
    v_mfma_f32_16x16x32_bf16 v[140:143], v[172:175], v[224:227], v[140:143]
    s_add_u32 s47, s48, 7368704
    buffer_store_dwordx4 v[116:119], v251, s[16:19], s47 offen sc1
    v_mfma_f32_16x16x32_bf16 v[128:131], v[200:203], v[228:231], v[128:131]
    v_cvt_pk_bf16_f32 v124, v124, v125
    v_cvt_pk_bf16_f32 v125, v126, v127
    v_mfma_f32_16x16x32_bf16 v[132:135], v[204:207], v[228:231], v[132:135]
    v_cvt_pk_bf16_f32 v126, v120, v121
    v_cvt_pk_bf16_f32 v127, v122, v123
    v_mfma_f32_16x16x32_bf16 v[136:139], v[192:195], v[228:231], v[136:139]
    s_add_u32 s47, s48, 7369728
    buffer_store_dwordx4 v[124:127], v251, s[16:19], s47 offen sc1
    v_mfma_f32_16x16x32_bf16 v[140:143], v[196:199], v[228:231], v[140:143]
    s_waitcnt lgkmcnt(2)
    v_mfma_f32_16x16x32_bf16 v[144:147], v[192:195], v[232:235], v[144:147]
    v_mfma_f32_16x16x32_bf16 v[148:151], v[196:199], v[232:235], v[148:151]
    v_mfma_f32_16x16x32_bf16 v[152:155], v[168:171], v[232:235], v[152:155]
    v_mfma_f32_16x16x32_bf16 v[156:159], v[172:175], v[232:235], v[156:159]
    v_mfma_f32_16x16x32_bf16 v[144:147], v[200:203], v[236:239], v[144:147]
    v_mfma_f32_16x16x32_bf16 v[148:151], v[204:207], v[236:239], v[148:151]
    v_mfma_f32_16x16x32_bf16 v[152:155], v[192:195], v[236:239], v[152:155]
    v_mfma_f32_16x16x32_bf16 v[156:159], v[196:199], v[236:239], v[156:159]
    s_waitcnt lgkmcnt(0)
    v_mfma_f32_16x16x32_bf16 v[160:163], v[192:195], v[240:243], v[160:163]
    v_mfma_f32_16x16x32_bf16 v[164:167], v[168:171], v[240:243], v[164:167]
    v_cvt_pk_bf16_f32 v132, v132, v133
    v_cvt_pk_bf16_f32 v133, v134, v135
    v_mfma_f32_16x16x32_bf16 v[160:163], v[200:203], v[244:247], v[160:163]
    v_cvt_pk_bf16_f32 v134, v128, v129
    v_cvt_pk_bf16_f32 v135, v130, v131
    v_mfma_f32_16x16x32_bf16 v[164:167], v[192:195], v[244:247], v[164:167]
    s_add_u32 s47, s48, 8421376
    buffer_store_dwordx4 v[132:135], v251, s[16:19], s47 offen sc1
    s_nop 7
    v_cvt_pk_bf16_f32 v140, v140, v141
    v_cvt_pk_bf16_f32 v141, v142, v143
    v_cvt_pk_bf16_f32 v142, v136, v137
    v_cvt_pk_bf16_f32 v143, v138, v139
    s_add_u32 s47, s48, 8422400
    buffer_store_dwordx4 v[140:143], v251, s[16:19], s47 offen sc1
    v_cvt_pk_bf16_f32 v148, v148, v149
    v_cvt_pk_bf16_f32 v149, v150, v151
    v_cvt_pk_bf16_f32 v150, v144, v145
    v_cvt_pk_bf16_f32 v151, v146, v147
    s_add_u32 s47, s48, 9474048
    buffer_store_dwordx4 v[148:151], v251, s[16:19], s47 offen sc1
    v_cvt_pk_bf16_f32 v156, v156, v157
    v_cvt_pk_bf16_f32 v157, v158, v159
    v_cvt_pk_bf16_f32 v158, v152, v153
    v_cvt_pk_bf16_f32 v159, v154, v155
    s_add_u32 s47, s48, 9475072
    buffer_store_dwordx4 v[156:159], v251, s[16:19], s47 offen sc1
    v_cvt_pk_bf16_f32 v160, v160, v161
    v_cvt_pk_bf16_f32 v161, v162, v163
    s_add_u32 s47, s49, 0
    buffer_store_dwordx2 v[160:161], v252, s[16:19], s47 offen sc1
    v_cvt_pk_bf16_f32 v164, v164, v165
    v_cvt_pk_bf16_f32 v165, v166, v167
    s_add_u32 s47, s49, 1024
    buffer_store_dwordx2 v[164:165], v252, s[16:19], s47 offen sc1
L_epi_done:
    s_endpgm
L_k3_helper:
    s_mul_i32 s40, s11, 16384
    s_mul_i32 s20, s14, 16777216
    s_add_u32 s40, s40, s20
    s_mul_i32 s41, s11, 21504
    s_mul_i32 s20, s13, 22020096
    s_add_u32 s41, s41, s20
    s_add_u32 s41, s41, 67108864
    s_lshl_b32 s42, s15, 12
    s_mul_i32 s43, s15, 5632
    s_lshr_b32 s20, s15, 1
    s_lshl_b32 s21, s20, 9
    s_sub_u32 s21, s43, s21
    v_lshlrev_b32 v1, 4, v0
    v_add_u32 v2, s21, v1
    s_add_u32 s22, s21, 4096
    v_add_u32 v5, s22, v1
    s_mov_b32 s44, s41
    s_bitcmp1_b32 s15, 0
    s_cbranch_scc0 L_six_even
    s_mul_i32 s22, s20, 10752
    s_add_u32 s22, s22, 9216
    v_lshrrev_b32 v5, 2, v0
    v_lshlrev_b32 v5, 6, v5
    v_and_b32 v3, 3, v0
    v_xor_b32 v3, 3, v3
    v_lshl_add_u32 v5, v3, 4, v5
    v_add_u32 v5, s22, v5
    s_mul_i32 s44, s11, 21504
    s_xor_b32 s22, s13, 1
    s_mul_i32 s22, s22, 22020096
    s_add_u32 s44, s44, s22
    s_add_u32 s44, s44, 67108864
L_six_even:
    s_mov_b32 s50, -1
    s_mov_b32 s51, 0
    v_add_u32 v1, s42, v1
    s_add_u32 s43, s43, 16384
    s_cmp_ge_u32 s2, 8
    s_cbranch_scc1 L_nozero
    s_cmp_lg_u32 s15, 0
    s_cbranch_scc1 L_nozero
    s_mul_i32 s20, s2, 8448
    s_add_u32 s20, s20, 147849216
    v_mov_b32 v3, 0
    v_lshlrev_b32 v4, 2, v0
    buffer_store_dword v3, v4, s[16:19], s20 offen
L_nozero:
    s_cmp_ge_u32 s2, 224
    s_cbranch_scc1 L_nofill
    s_cmp_lg_u32 s15, 1
    s_cbranch_scc1 L_nofill
    s_lshl_b32 s20, s2, 10
    s_add_u32 s20, s20, 146800640
    v_mov_b32 v8, -1
    v_mov_b32 v9, -1
    v_mov_b32 v10, -1
    v_mov_b32 v11, -1
    v_lshlrev_b32 v4, 4, v0
    buffer_store_dwordx4 v[8:11], v4, s[16:19], s20 offen
L_nofill:
    s_add_u32 m0, s42, 0
    s_nop 0
    buffer_load_dwordx4 v1, s[16:19], s40 offen offset:0 lds
    buffer_load_dwordx4 v1, s[16:19], s40 offen offset:1024 lds
    buffer_load_dwordx4 v1, s[16:19], s40 offen offset:2048 lds
    buffer_load_dwordx4 v1, s[16:19], s40 offen offset:3072 lds
    s_add_u32 s40, s40, 524288
    s_add_u32 m0, s43, 0
    s_nop 0
    buffer_load_dwordx4 v2, s[16:19], s41 offen offset:0 lds
    buffer_load_dwordx4 v2, s[16:19], s41 offen offset:1024 lds
    buffer_load_dwordx4 v2, s[16:19], s41 offen offset:2048 lds
    buffer_load_dwordx4 v2, s[16:19], s41 offen offset:3072 lds
    s_add_u32 m0, s43, 4096
    s_add_u32 s49, s41, 4096
    buffer_load_dwordx4 v2, s[16:19], s49 offen lds
    s_mov_b64 exec, s[50:51]
    buffer_load_dwordx4 v5, s[16:19], s44 offen offset:1024 lds
    s_mov_b64 exec, -1
    s_add_u32 s41, s41, 688128
    s_add_u32 s44, s44, 688128
    s_add_u32 m0, s42, 38912
    s_nop 0
    buffer_load_dwordx4 v1, s[16:19], s40 offen offset:0 lds
    buffer_load_dwordx4 v1, s[16:19], s40 offen offset:1024 lds
    buffer_load_dwordx4 v1, s[16:19], s40 offen offset:2048 lds
    buffer_load_dwordx4 v1, s[16:19], s40 offen offset:3072 lds
    s_add_u32 s40, s40, 524288
    s_add_u32 m0, s43, 38912
    s_nop 0
    buffer_load_dwordx4 v2, s[16:19], s41 offen offset:0 lds
    buffer_load_dwordx4 v2, s[16:19], s41 offen offset:1024 lds
    buffer_load_dwordx4 v2, s[16:19], s41 offen offset:2048 lds
    buffer_load_dwordx4 v2, s[16:19], s41 offen offset:3072 lds
    s_add_u32 m0, s43, 43008
    s_add_u32 s49, s41, 4096
    buffer_load_dwordx4 v2, s[16:19], s49 offen lds
    s_mov_b64 exec, s[50:51]
    buffer_load_dwordx4 v5, s[16:19], s44 offen offset:1024 lds
    s_mov_b64 exec, -1
    s_add_u32 s41, s41, 688128
    s_add_u32 s44, s44, 688128
    s_add_u32 m0, s42, 77824
    s_nop 0
    buffer_load_dwordx4 v1, s[16:19], s40 offen offset:0 lds
    buffer_load_dwordx4 v1, s[16:19], s40 offen offset:1024 lds
    buffer_load_dwordx4 v1, s[16:19], s40 offen offset:2048 lds
    buffer_load_dwordx4 v1, s[16:19], s40 offen offset:3072 lds
    s_add_u32 s40, s40, 524288
    s_add_u32 m0, s43, 77824
    s_nop 0
    buffer_load_dwordx4 v2, s[16:19], s41 offen offset:0 lds
    buffer_load_dwordx4 v2, s[16:19], s41 offen offset:1024 lds
    buffer_load_dwordx4 v2, s[16:19], s41 offen offset:2048 lds
    buffer_load_dwordx4 v2, s[16:19], s41 offen offset:3072 lds
    s_add_u32 m0, s43, 81920
    s_add_u32 s49, s41, 4096
    buffer_load_dwordx4 v2, s[16:19], s49 offen lds
    s_mov_b64 exec, s[50:51]
    buffer_load_dwordx4 v5, s[16:19], s44 offen offset:1024 lds
    s_mov_b64 exec, -1
    s_add_u32 s41, s41, 688128
    s_add_u32 s44, s44, 688128
    s_waitcnt vmcnt(20)
    s_barrier
    s_mov_b32 s46, 7
L_h_loop:
    s_waitcnt vmcnt(10)
    s_barrier
    s_add_u32 m0, s42, 116736
    s_nop 0
    buffer_load_dwordx4 v1, s[16:19], s40 offen offset:0 lds
    buffer_load_dwordx4 v1, s[16:19], s40 offen offset:1024 lds
    buffer_load_dwordx4 v1, s[16:19], s40 offen offset:2048 lds
    buffer_load_dwordx4 v1, s[16:19], s40 offen offset:3072 lds
    s_add_u32 s40, s40, 524288
    s_add_u32 m0, s43, 116736
    s_nop 0
    buffer_load_dwordx4 v2, s[16:19], s41 offen offset:0 lds
    buffer_load_dwordx4 v2, s[16:19], s41 offen offset:1024 lds
    buffer_load_dwordx4 v2, s[16:19], s41 offen offset:2048 lds
    buffer_load_dwordx4 v2, s[16:19], s41 offen offset:3072 lds
    s_add_u32 m0, s43, 120832
    s_add_u32 s49, s41, 4096
    buffer_load_dwordx4 v2, s[16:19], s49 offen lds
    s_mov_b64 exec, s[50:51]
    buffer_load_dwordx4 v5, s[16:19], s44 offen offset:1024 lds
    s_mov_b64 exec, -1
    s_add_u32 s41, s41, 688128
    s_add_u32 s44, s44, 688128
    s_waitcnt vmcnt(10)
    s_barrier
    s_add_u32 m0, s42, 0
    s_nop 0
    buffer_load_dwordx4 v1, s[16:19], s40 offen offset:0 lds
    buffer_load_dwordx4 v1, s[16:19], s40 offen offset:1024 lds
    buffer_load_dwordx4 v1, s[16:19], s40 offen offset:2048 lds
    buffer_load_dwordx4 v1, s[16:19], s40 offen offset:3072 lds
    s_add_u32 s40, s40, 524288
    s_add_u32 m0, s43, 0
    s_nop 0
    buffer_load_dwordx4 v2, s[16:19], s41 offen offset:0 lds
    buffer_load_dwordx4 v2, s[16:19], s41 offen offset:1024 lds
    buffer_load_dwordx4 v2, s[16:19], s41 offen offset:2048 lds
    buffer_load_dwordx4 v2, s[16:19], s41 offen offset:3072 lds
    s_add_u32 m0, s43, 4096
    s_add_u32 s49, s41, 4096
    buffer_load_dwordx4 v2, s[16:19], s49 offen lds
    s_mov_b64 exec, s[50:51]
    buffer_load_dwordx4 v5, s[16:19], s44 offen offset:1024 lds
    s_mov_b64 exec, -1
    s_add_u32 s41, s41, 688128
    s_add_u32 s44, s44, 688128
    s_waitcnt vmcnt(10)
    s_barrier
    s_add_u32 m0, s42, 38912
    s_nop 0
    buffer_load_dwordx4 v1, s[16:19], s40 offen offset:0 lds
    buffer_load_dwordx4 v1, s[16:19], s40 offen offset:1024 lds
    buffer_load_dwordx4 v1, s[16:19], s40 offen offset:2048 lds
    buffer_load_dwordx4 v1, s[16:19], s40 offen offset:3072 lds
    s_add_u32 s40, s40, 524288
    s_add_u32 m0, s43, 38912
    s_nop 0
    buffer_load_dwordx4 v2, s[16:19], s41 offen offset:0 lds
    buffer_load_dwordx4 v2, s[16:19], s41 offen offset:1024 lds
    buffer_load_dwordx4 v2, s[16:19], s41 offen offset:2048 lds
    buffer_load_dwordx4 v2, s[16:19], s41 offen offset:3072 lds
    s_add_u32 m0, s43, 43008
    s_add_u32 s49, s41, 4096
    buffer_load_dwordx4 v2, s[16:19], s49 offen lds
    s_mov_b64 exec, s[50:51]
    buffer_load_dwordx4 v5, s[16:19], s44 offen offset:1024 lds
    s_mov_b64 exec, -1
    s_add_u32 s41, s41, 688128
    s_add_u32 s44, s44, 688128
    s_waitcnt vmcnt(10)
    s_barrier
    s_add_u32 m0, s42, 77824
    s_nop 0
    buffer_load_dwordx4 v1, s[16:19], s40 offen offset:0 lds
    buffer_load_dwordx4 v1, s[16:19], s40 offen offset:1024 lds
    buffer_load_dwordx4 v1, s[16:19], s40 offen offset:2048 lds
    buffer_load_dwordx4 v1, s[16:19], s40 offen offset:3072 lds
    s_add_u32 s40, s40, 524288
    s_add_u32 m0, s43, 77824
    s_nop 0
    buffer_load_dwordx4 v2, s[16:19], s41 offen offset:0 lds
    buffer_load_dwordx4 v2, s[16:19], s41 offen offset:1024 lds
    buffer_load_dwordx4 v2, s[16:19], s41 offen offset:2048 lds
    buffer_load_dwordx4 v2, s[16:19], s41 offen offset:3072 lds
    s_add_u32 m0, s43, 81920
    s_add_u32 s49, s41, 4096
    buffer_load_dwordx4 v2, s[16:19], s49 offen lds
    s_mov_b64 exec, s[50:51]
    buffer_load_dwordx4 v5, s[16:19], s44 offen offset:1024 lds
    s_mov_b64 exec, -1
    s_add_u32 s41, s41, 688128
    s_add_u32 s44, s44, 688128
    s_sub_u32 s46, s46, 1
    s_cmp_lg_u32 s46, 0
    s_cbranch_scc1 L_h_loop
    s_waitcnt vmcnt(10)
    s_barrier
    s_add_u32 m0, s42, 116736
    s_nop 0
    buffer_load_dwordx4 v1, s[16:19], s40 offen offset:0 lds
    buffer_load_dwordx4 v1, s[16:19], s40 offen offset:1024 lds
    buffer_load_dwordx4 v1, s[16:19], s40 offen offset:2048 lds
    buffer_load_dwordx4 v1, s[16:19], s40 offen offset:3072 lds
    s_add_u32 s40, s40, 524288
    s_add_u32 m0, s43, 116736
    s_nop 0
    buffer_load_dwordx4 v2, s[16:19], s41 offen offset:0 lds
    buffer_load_dwordx4 v2, s[16:19], s41 offen offset:1024 lds
    buffer_load_dwordx4 v2, s[16:19], s41 offen offset:2048 lds
    buffer_load_dwordx4 v2, s[16:19], s41 offen offset:3072 lds
    s_add_u32 m0, s43, 120832
    s_add_u32 s49, s41, 4096
    buffer_load_dwordx4 v2, s[16:19], s49 offen lds
    s_mov_b64 exec, s[50:51]
    buffer_load_dwordx4 v5, s[16:19], s44 offen offset:1024 lds
    s_mov_b64 exec, -1
    s_add_u32 s41, s41, 688128
    s_add_u32 s44, s44, 688128
    s_waitcnt vmcnt(10)
    s_barrier
    s_waitcnt vmcnt(0)
    s_barrier
    s_endpgm
L_k3_end:
    s_endpgm
.globl final_kernel
.p2align 8
.type final_kernel,@function
final_kernel:
    s_cmp_ge_u32 s2, 224
    s_cbranch_scc1 L_k45_end
    s_load_dwordx2 s[8:9], s[0:1], 48
    s_load_dwordx4 s[4:7], s[0:1], 16
    s_load_dwordx2 s[28:29], s[0:1], 32
    v_lshrrev_b32 v204, 6, v0
    v_and_b32 v200, 63, v0
    v_readfirstlane_b32 s10, v204
    v_lshlrev_b32 v214, 2, v0
    v_and_b32 v201, 15, v200
    v_lshrrev_b32 v202, 4, v200
    s_and_b32 s13, s2, 3
    s_lshr_b32 s12, s2, 2
    s_cmp_ge_u32 s12, 28
    s_cselect_b32 s11, 1, 0
    s_mul_i32 s15, s11, 28
    s_sub_u32 s12, s12, s15
    s_mul_i32 s14, s12, 6
    s_add_u32 s14, s14, s10
    s_mov_b32 s24, 8192
    v_mul_u32_u24 v203, s24, v202
    v_lshl_add_u32 v203, v201, 4, v203
    s_mul_i32 s24, s11, 11579392
    s_mul_i32 s25, s14, 65792
    s_add_u32 s24, s24, s25
    s_lshl_b32 s25, s13, 8
    s_add_u32 s24, s24, s25
    s_add_u32 s24, s24, 117440512
    s_mov_b32 s30, 0x05040100
    s_mov_b32 s31, 0x07060302
    s_waitcnt lgkmcnt(0)
    s_mov_b32 s16, s8
    s_and_b32 s17, s9, 0xffff
    s_mov_b32 s18, 268435456
    s_mov_b32 s19, 0x00020000
    s_cmp_ge_u32 s10, 6
    s_cbranch_scc1 L_k45_gb
    s_add_u32 s25, s24, 0
    buffer_load_dwordx4 v[0:3], v203, s[16:19], s25 offen
    s_add_u32 s25, s24, 1024
    buffer_load_dwordx4 v[4:7], v203, s[16:19], s25 offen
    s_add_u32 s25, s24, 2048
    buffer_load_dwordx4 v[8:11], v203, s[16:19], s25 offen
    s_add_u32 s25, s24, 3072
    buffer_load_dwordx4 v[12:15], v203, s[16:19], s25 offen
    s_add_u32 s25, s24, 4096
    buffer_load_dwordx4 v[16:19], v203, s[16:19], s25 offen
    s_add_u32 s25, s24, 5120
    buffer_load_dwordx4 v[20:23], v203, s[16:19], s25 offen
    s_add_u32 s25, s24, 6144
    buffer_load_dwordx4 v[24:27], v203, s[16:19], s25 offen
    s_add_u32 s25, s24, 7168
    buffer_load_dwordx4 v[28:31], v203, s[16:19], s25 offen
    s_add_u32 s25, s24, 32768
    buffer_load_dwordx4 v[32:35], v203, s[16:19], s25 offen
    s_add_u32 s25, s24, 33792
    buffer_load_dwordx4 v[36:39], v203, s[16:19], s25 offen
    s_add_u32 s25, s24, 34816
    buffer_load_dwordx4 v[40:43], v203, s[16:19], s25 offen
    s_add_u32 s25, s24, 35840
    buffer_load_dwordx4 v[44:47], v203, s[16:19], s25 offen
    s_add_u32 s25, s24, 36864
    buffer_load_dwordx4 v[48:51], v203, s[16:19], s25 offen
    s_add_u32 s25, s24, 37888
    buffer_load_dwordx4 v[52:55], v203, s[16:19], s25 offen
    s_add_u32 s25, s24, 38912
    buffer_load_dwordx4 v[56:59], v203, s[16:19], s25 offen
    s_add_u32 s25, s24, 39936
    buffer_load_dwordx4 v[60:63], v203, s[16:19], s25 offen
    s_lshr_b32 s27, s10, 1
    s_and_b32 s33, s10, 1
    s_lshl_b32 s27, s27, 4
    v_add_u32 v204, s27, v201
    s_lshl_b32 s33, s33, 5
    s_add_u32 s33, s33, 1
    v_lshlrev_b32 v205, 3, v202
    v_add_u32 v205, s33, v205
    v_mul_u32_u24 v88, v205, v204
    v_add_u32 v89, 32, v88
    v_add_u32 v205, 2, v205
    v_mul_u32_u24 v90, v205, v204
    v_add_u32 v91, 32, v90
    v_add_u32 v205, 2, v205
    v_mul_u32_u24 v92, v205, v204
    v_add_u32 v93, 32, v92
    v_add_u32 v205, 2, v205
    v_mul_u32_u24 v94, v205, v204
    v_add_u32 v95, 32, v94
    v_and_b32 v88, 127, v88
    v_cvt_f32_u32 v88, v88
    v_mul_f32 v88, 0x3c000000, v88
    v_cos_f32 v88, v88
    v_and_b32 v89, 127, v89
    v_cvt_f32_u32 v89, v89
    v_mul_f32 v89, 0x3c000000, v89
    v_cos_f32 v89, v89
    v_and_b32 v90, 127, v90
    v_cvt_f32_u32 v90, v90
    v_mul_f32 v90, 0x3c000000, v90
    v_cos_f32 v90, v90
    v_and_b32 v91, 127, v91
    v_cvt_f32_u32 v91, v91
    v_mul_f32 v91, 0x3c000000, v91
    v_cos_f32 v91, v91
    v_and_b32 v92, 127, v92
    v_cvt_f32_u32 v92, v92
    v_mul_f32 v92, 0x3c000000, v92
    v_cos_f32 v92, v92
    v_and_b32 v93, 127, v93
    v_cvt_f32_u32 v93, v93
    v_mul_f32 v93, 0x3c000000, v93
    v_cos_f32 v93, v93
    v_and_b32 v94, 127, v94
    v_cvt_f32_u32 v94, v94
    v_mul_f32 v94, 0x3c000000, v94
    v_cos_f32 v94, v94
    v_and_b32 v95, 127, v95
    v_cvt_f32_u32 v95, v95
    v_mul_f32 v95, 0x3c000000, v95
    v_cos_f32 v95, v95
    v_mul_f32 v88, 0x3d000000, v88
    v_mul_f32 v89, 0x3d000000, v89
    v_mul_f32 v90, 0x3d000000, v90
    v_mul_f32 v91, 0x3d000000, v91
    v_mul_f32 v92, 0x3d000000, v92
    v_mul_f32 v93, 0x3d000000, v93
    v_mul_f32 v94, 0x3d000000, v94
    v_mul_f32 v95, 0x3d000000, v95
    v_cvt_pk_bf16_f32 v104, v88, v89
    v_cvt_pk_bf16_f32 v105, v90, v91
    v_cvt_pk_bf16_f32 v106, v92, v93
    v_cvt_pk_bf16_f32 v107, v94, v95
    s_lshl_b32 s26, s10, 10
    v_lshlrev_b32 v207, 4, v200
    v_add_u32 v207, s26, v207
    ds_write_b128 v207, v[104:107] offset:0
L_k45_gb:
    s_mov_b32 s20, s4
    s_and_b32 s21, s5, 0xffff
    s_mov_b32 s22, 1024
    s_mov_b32 s23, 0x00020000
    s_mov_b32 s36, s6
    s_and_b32 s37, s7, 0xffff
    s_mov_b32 s38, 1024
    s_mov_b32 s39, 0x00020000
    v_lshlrev_b32 v210, 4, v201
    s_lshl_b32 s25, s13, 8
    buffer_load_dwordx4 v[232:235], v210, s[20:23], s25 offen
    buffer_load_dwordx4 v[236:239], v210, s[36:39], s25 offen
    s_waitcnt lgkmcnt(0)
    s_barrier
    s_cmp_ge_u32 s10, 6
    s_cbranch_scc1 L_k45_red2
    v_lshlrev_b32 v207, 4, v200
    ds_read_b128 v[64:67], v207 offset:0
    ds_read_b128 v[68:71], v207 offset:1024
    ds_read_b128 v[72:75], v207 offset:2048
    ds_read_b128 v[76:79], v207 offset:3072
    ds_read_b128 v[80:83], v207 offset:4096
    ds_read_b128 v[84:87], v207 offset:5120
    s_cmp_ge_u32 s14, 167
    s_cbranch_scc1 L_k45_zero
    s_waitcnt lgkmcnt(0)
    s_cmp_lg_u32 s14, 166
    s_cbranch_scc1 L_k45_full
    v_cmp_gt_i32 vcc, 17, v201
    s_nop 1
    v_cndmask_b32 v64, 0, v64, vcc
    v_cndmask_b32 v65, 0, v65, vcc
    v_cndmask_b32 v66, 0, v66, vcc
    v_cndmask_b32 v67, 0, v67, vcc
    v_cndmask_b32 v68, 0, v68, vcc
    v_cndmask_b32 v69, 0, v69, vcc
    v_cndmask_b32 v70, 0, v70, vcc
    v_cndmask_b32 v71, 0, v71, vcc
    v_cmp_gt_i32 vcc, 1, v201
    s_nop 1
    v_cndmask_b32 v72, 0, v72, vcc
    v_cndmask_b32 v73, 0, v73, vcc
    v_cndmask_b32 v74, 0, v74, vcc
    v_cndmask_b32 v75, 0, v75, vcc
    v_cndmask_b32 v76, 0, v76, vcc
    v_cndmask_b32 v77, 0, v77, vcc
    v_cndmask_b32 v78, 0, v78, vcc
    v_cndmask_b32 v79, 0, v79, vcc
    v_cmp_gt_i32 vcc, 0, v201
    s_nop 1
    v_cndmask_b32 v80, 0, v80, vcc
    v_cndmask_b32 v81, 0, v81, vcc
    v_cndmask_b32 v82, 0, v82, vcc
    v_cndmask_b32 v83, 0, v83, vcc
    v_cndmask_b32 v84, 0, v84, vcc
    v_cndmask_b32 v85, 0, v85, vcc
    v_cndmask_b32 v86, 0, v86, vcc
    v_cndmask_b32 v87, 0, v87, vcc
L_k45_full:
    s_waitcnt vmcnt(2)
    v_perm_b32 v88, v4, v0, s30
    v_perm_b32 v89, v12, v8, s30
    v_perm_b32 v90, v20, v16, s30
    v_perm_b32 v91, v28, v24, s30
    v_perm_b32 v92, v4, v0, s31
    v_perm_b32 v93, v12, v8, s31
    v_perm_b32 v94, v20, v16, s31
    v_perm_b32 v95, v28, v24, s31
    v_perm_b32 v96, v36, v32, s30
    v_perm_b32 v97, v44, v40, s30
    v_perm_b32 v98, v52, v48, s30
    v_perm_b32 v99, v60, v56, s30
    v_perm_b32 v100, v36, v32, s31
    v_perm_b32 v101, v44, v40, s31
    v_perm_b32 v102, v52, v48, s31
    v_perm_b32 v103, v60, v56, s31
    v_mfma_f32_16x16x32_bf16 v[104:107], v[64:67], v[88:91], 0
    v_mfma_f32_16x16x32_bf16 v[108:111], v[64:67], v[92:95], 0
    v_mfma_f32_16x16x32_bf16 v[136:139], v[72:75], v[88:91], 0
    v_mfma_f32_16x16x32_bf16 v[140:143], v[72:75], v[92:95], 0
    v_mfma_f32_16x16x32_bf16 v[168:171], v[80:83], v[88:91], 0
    v_mfma_f32_16x16x32_bf16 v[172:175], v[80:83], v[92:95], 0
    v_mfma_f32_16x16x32_bf16 v[104:107], v[68:71], v[96:99], v[104:107]
    v_mfma_f32_16x16x32_bf16 v[108:111], v[68:71], v[100:103], v[108:111]
    v_mfma_f32_16x16x32_bf16 v[136:139], v[76:79], v[96:99], v[136:139]
    v_mfma_f32_16x16x32_bf16 v[140:143], v[76:79], v[100:103], v[140:143]
    v_mfma_f32_16x16x32_bf16 v[168:171], v[84:87], v[96:99], v[168:171]
    v_mfma_f32_16x16x32_bf16 v[172:175], v[84:87], v[100:103], v[172:175]
    v_perm_b32 v88, v5, v1, s30
    v_perm_b32 v89, v13, v9, s30
    v_perm_b32 v90, v21, v17, s30
    v_perm_b32 v91, v29, v25, s30
    v_perm_b32 v92, v5, v1, s31
    v_perm_b32 v93, v13, v9, s31
    v_perm_b32 v94, v21, v17, s31
    v_perm_b32 v95, v29, v25, s31
    v_perm_b32 v96, v37, v33, s30
    v_perm_b32 v97, v45, v41, s30
    v_perm_b32 v98, v53, v49, s30
    v_perm_b32 v99, v61, v57, s30
    v_perm_b32 v100, v37, v33, s31
    v_perm_b32 v101, v45, v41, s31
    v_perm_b32 v102, v53, v49, s31
    v_perm_b32 v103, v61, v57, s31
    v_mfma_f32_16x16x32_bf16 v[112:115], v[64:67], v[88:91], 0
    v_mfma_f32_16x16x32_bf16 v[116:119], v[64:67], v[92:95], 0
    v_mfma_f32_16x16x32_bf16 v[144:147], v[72:75], v[88:91], 0
    v_mfma_f32_16x16x32_bf16 v[148:151], v[72:75], v[92:95], 0
    v_mfma_f32_16x16x32_bf16 v[176:179], v[80:83], v[88:91], 0
    v_mfma_f32_16x16x32_bf16 v[180:183], v[80:83], v[92:95], 0
    v_mfma_f32_16x16x32_bf16 v[112:115], v[68:71], v[96:99], v[112:115]
    v_mfma_f32_16x16x32_bf16 v[116:119], v[68:71], v[100:103], v[116:119]
    v_mfma_f32_16x16x32_bf16 v[144:147], v[76:79], v[96:99], v[144:147]
    v_mfma_f32_16x16x32_bf16 v[148:151], v[76:79], v[100:103], v[148:151]
    v_mfma_f32_16x16x32_bf16 v[176:179], v[84:87], v[96:99], v[176:179]
    v_mfma_f32_16x16x32_bf16 v[180:183], v[84:87], v[100:103], v[180:183]
    v_perm_b32 v88, v6, v2, s30
    v_perm_b32 v89, v14, v10, s30
    v_perm_b32 v90, v22, v18, s30
    v_perm_b32 v91, v30, v26, s30
    v_perm_b32 v92, v6, v2, s31
    v_perm_b32 v93, v14, v10, s31
    v_perm_b32 v94, v22, v18, s31
    v_perm_b32 v95, v30, v26, s31
    v_perm_b32 v96, v38, v34, s30
    v_perm_b32 v97, v46, v42, s30
    v_perm_b32 v98, v54, v50, s30
    v_perm_b32 v99, v62, v58, s30
    v_perm_b32 v100, v38, v34, s31
    v_perm_b32 v101, v46, v42, s31
    v_perm_b32 v102, v54, v50, s31
    v_perm_b32 v103, v62, v58, s31
    v_mfma_f32_16x16x32_bf16 v[120:123], v[64:67], v[88:91], 0
    v_mfma_f32_16x16x32_bf16 v[124:127], v[64:67], v[92:95], 0
    v_mfma_f32_16x16x32_bf16 v[152:155], v[72:75], v[88:91], 0
    v_mfma_f32_16x16x32_bf16 v[156:159], v[72:75], v[92:95], 0
    v_mfma_f32_16x16x32_bf16 v[184:187], v[80:83], v[88:91], 0
    v_mfma_f32_16x16x32_bf16 v[188:191], v[80:83], v[92:95], 0
    v_mfma_f32_16x16x32_bf16 v[120:123], v[68:71], v[96:99], v[120:123]
    v_mfma_f32_16x16x32_bf16 v[124:127], v[68:71], v[100:103], v[124:127]
    v_mfma_f32_16x16x32_bf16 v[152:155], v[76:79], v[96:99], v[152:155]
    v_mfma_f32_16x16x32_bf16 v[156:159], v[76:79], v[100:103], v[156:159]
    v_mfma_f32_16x16x32_bf16 v[184:187], v[84:87], v[96:99], v[184:187]
    v_mfma_f32_16x16x32_bf16 v[188:191], v[84:87], v[100:103], v[188:191]
    v_perm_b32 v88, v7, v3, s30
    v_perm_b32 v89, v15, v11, s30
    v_perm_b32 v90, v23, v19, s30
    v_perm_b32 v91, v31, v27, s30
    v_perm_b32 v92, v7, v3, s31
    v_perm_b32 v93, v15, v11, s31
    v_perm_b32 v94, v23, v19, s31
    v_perm_b32 v95, v31, v27, s31
    v_perm_b32 v96, v39, v35, s30
    v_perm_b32 v97, v47, v43, s30
    v_perm_b32 v98, v55, v51, s30
    v_perm_b32 v99, v63, v59, s30
    v_perm_b32 v100, v39, v35, s31
    v_perm_b32 v101, v47, v43, s31
    v_perm_b32 v102, v55, v51, s31
    v_perm_b32 v103, v63, v59, s31
    v_mfma_f32_16x16x32_bf16 v[128:131], v[64:67], v[88:91], 0
    v_mfma_f32_16x16x32_bf16 v[132:135], v[64:67], v[92:95], 0
    v_mfma_f32_16x16x32_bf16 v[160:163], v[72:75], v[88:91], 0
    v_mfma_f32_16x16x32_bf16 v[164:167], v[72:75], v[92:95], 0
    v_mfma_f32_16x16x32_bf16 v[192:195], v[80:83], v[88:91], 0
    v_mfma_f32_16x16x32_bf16 v[196:199], v[80:83], v[92:95], 0
    v_mfma_f32_16x16x32_bf16 v[128:131], v[68:71], v[96:99], v[128:131]
    v_mfma_f32_16x16x32_bf16 v[132:135], v[68:71], v[100:103], v[132:135]
    v_mfma_f32_16x16x32_bf16 v[160:163], v[76:79], v[96:99], v[160:163]
    v_mfma_f32_16x16x32_bf16 v[164:167], v[76:79], v[100:103], v[164:167]
    v_mfma_f32_16x16x32_bf16 v[192:195], v[84:87], v[96:99], v[192:195]
    v_mfma_f32_16x16x32_bf16 v[196:199], v[84:87], v[100:103], v[196:199]
    s_nop 7
    v_mul_f32 v224, v104, v104
    v_mov_b32 v216, v104
    v_fmac_f32 v224, v105, v105
    v_add_f32 v216, v216, v105
    v_fmac_f32 v224, v106, v106
    v_add_f32 v216, v216, v106
    v_fmac_f32 v224, v107, v107
    v_add_f32 v216, v216, v107
    v_fmac_f32 v224, v136, v136
    v_add_f32 v216, v216, v136
    v_fmac_f32 v224, v137, v137
    v_add_f32 v216, v216, v137
    v_fmac_f32 v224, v138, v138
    v_add_f32 v216, v216, v138
    v_fmac_f32 v224, v139, v139
    v_add_f32 v216, v216, v139
    v_fmac_f32 v224, v168, v168
    v_add_f32 v216, v216, v168
    v_fmac_f32 v224, v169, v169
    v_add_f32 v216, v216, v169
    v_fmac_f32 v224, v170, v170
    v_add_f32 v216, v216, v170
    v_fmac_f32 v224, v171, v171
    v_add_f32 v216, v216, v171
    v_mul_f32 v225, v108, v108
    v_mov_b32 v217, v108
    v_fmac_f32 v225, v109, v109
    v_add_f32 v217, v217, v109
    v_fmac_f32 v225, v110, v110
    v_add_f32 v217, v217, v110
    v_fmac_f32 v225, v111, v111
    v_add_f32 v217, v217, v111
    v_fmac_f32 v225, v140, v140
    v_add_f32 v217, v217, v140
    v_fmac_f32 v225, v141, v141
    v_add_f32 v217, v217, v141
    v_fmac_f32 v225, v142, v142
    v_add_f32 v217, v217, v142
    v_fmac_f32 v225, v143, v143
    v_add_f32 v217, v217, v143
    v_fmac_f32 v225, v172, v172
    v_add_f32 v217, v217, v172
    v_fmac_f32 v225, v173, v173
    v_add_f32 v217, v217, v173
    v_fmac_f32 v225, v174, v174
    v_add_f32 v217, v217, v174
    v_fmac_f32 v225, v175, v175
    v_add_f32 v217, v217, v175
    v_mul_f32 v226, v112, v112
    v_mov_b32 v218, v112
    v_fmac_f32 v226, v113, v113
    v_add_f32 v218, v218, v113
    v_fmac_f32 v226, v114, v114
    v_add_f32 v218, v218, v114
    v_fmac_f32 v226, v115, v115
    v_add_f32 v218, v218, v115
    v_fmac_f32 v226, v144, v144
    v_add_f32 v218, v218, v144
    v_fmac_f32 v226, v145, v145
    v_add_f32 v218, v218, v145
    v_fmac_f32 v226, v146, v146
    v_add_f32 v218, v218, v146
    v_fmac_f32 v226, v147, v147
    v_add_f32 v218, v218, v147
    v_fmac_f32 v226, v176, v176
    v_add_f32 v218, v218, v176
    v_fmac_f32 v226, v177, v177
    v_add_f32 v218, v218, v177
    v_fmac_f32 v226, v178, v178
    v_add_f32 v218, v218, v178
    v_fmac_f32 v226, v179, v179
    v_add_f32 v218, v218, v179
    v_mul_f32 v227, v116, v116
    v_mov_b32 v219, v116
    v_fmac_f32 v227, v117, v117
    v_add_f32 v219, v219, v117
    v_fmac_f32 v227, v118, v118
    v_add_f32 v219, v219, v118
    v_fmac_f32 v227, v119, v119
    v_add_f32 v219, v219, v119
    v_fmac_f32 v227, v148, v148
    v_add_f32 v219, v219, v148
    v_fmac_f32 v227, v149, v149
    v_add_f32 v219, v219, v149
    v_fmac_f32 v227, v150, v150
    v_add_f32 v219, v219, v150
    v_fmac_f32 v227, v151, v151
    v_add_f32 v219, v219, v151
    v_fmac_f32 v227, v180, v180
    v_add_f32 v219, v219, v180
    v_fmac_f32 v227, v181, v181
    v_add_f32 v219, v219, v181
    v_fmac_f32 v227, v182, v182
    v_add_f32 v219, v219, v182
    v_fmac_f32 v227, v183, v183
    v_add_f32 v219, v219, v183
    v_mul_f32 v228, v120, v120
    v_mov_b32 v220, v120
    v_fmac_f32 v228, v121, v121
    v_add_f32 v220, v220, v121
    v_fmac_f32 v228, v122, v122
    v_add_f32 v220, v220, v122
    v_fmac_f32 v228, v123, v123
    v_add_f32 v220, v220, v123
    v_fmac_f32 v228, v152, v152
    v_add_f32 v220, v220, v152
    v_fmac_f32 v228, v153, v153
    v_add_f32 v220, v220, v153
    v_fmac_f32 v228, v154, v154
    v_add_f32 v220, v220, v154
    v_fmac_f32 v228, v155, v155
    v_add_f32 v220, v220, v155
    v_fmac_f32 v228, v184, v184
    v_add_f32 v220, v220, v184
    v_fmac_f32 v228, v185, v185
    v_add_f32 v220, v220, v185
    v_fmac_f32 v228, v186, v186
    v_add_f32 v220, v220, v186
    v_fmac_f32 v228, v187, v187
    v_add_f32 v220, v220, v187
    v_mul_f32 v229, v124, v124
    v_mov_b32 v221, v124
    v_fmac_f32 v229, v125, v125
    v_add_f32 v221, v221, v125
    v_fmac_f32 v229, v126, v126
    v_add_f32 v221, v221, v126
    v_fmac_f32 v229, v127, v127
    v_add_f32 v221, v221, v127
    v_fmac_f32 v229, v156, v156
    v_add_f32 v221, v221, v156
    v_fmac_f32 v229, v157, v157
    v_add_f32 v221, v221, v157
    v_fmac_f32 v229, v158, v158
    v_add_f32 v221, v221, v158
    v_fmac_f32 v229, v159, v159
    v_add_f32 v221, v221, v159
    v_fmac_f32 v229, v188, v188
    v_add_f32 v221, v221, v188
    v_fmac_f32 v229, v189, v189
    v_add_f32 v221, v221, v189
    v_fmac_f32 v229, v190, v190
    v_add_f32 v221, v221, v190
    v_fmac_f32 v229, v191, v191
    v_add_f32 v221, v221, v191
    v_mul_f32 v230, v128, v128
    v_mov_b32 v222, v128
    v_fmac_f32 v230, v129, v129
    v_add_f32 v222, v222, v129
    v_fmac_f32 v230, v130, v130
    v_add_f32 v222, v222, v130
    v_fmac_f32 v230, v131, v131
    v_add_f32 v222, v222, v131
    v_fmac_f32 v230, v160, v160
    v_add_f32 v222, v222, v160
    v_fmac_f32 v230, v161, v161
    v_add_f32 v222, v222, v161
    v_fmac_f32 v230, v162, v162
    v_add_f32 v222, v222, v162
    v_fmac_f32 v230, v163, v163
    v_add_f32 v222, v222, v163
    v_fmac_f32 v230, v192, v192
    v_add_f32 v222, v222, v192
    v_fmac_f32 v230, v193, v193
    v_add_f32 v222, v222, v193
    v_fmac_f32 v230, v194, v194
    v_add_f32 v222, v222, v194
    v_fmac_f32 v230, v195, v195
    v_add_f32 v222, v222, v195
    v_mul_f32 v231, v132, v132
    v_mov_b32 v223, v132
    v_fmac_f32 v231, v133, v133
    v_add_f32 v223, v223, v133
    v_fmac_f32 v231, v134, v134
    v_add_f32 v223, v223, v134
    v_fmac_f32 v231, v135, v135
    v_add_f32 v223, v223, v135
    v_fmac_f32 v231, v164, v164
    v_add_f32 v223, v223, v164
    v_fmac_f32 v231, v165, v165
    v_add_f32 v223, v223, v165
    v_fmac_f32 v231, v166, v166
    v_add_f32 v223, v223, v166
    v_fmac_f32 v231, v167, v167
    v_add_f32 v223, v223, v167
    v_fmac_f32 v231, v196, v196
    v_add_f32 v223, v223, v196
    v_fmac_f32 v231, v197, v197
    v_add_f32 v223, v223, v197
    v_fmac_f32 v231, v198, v198
    v_add_f32 v223, v223, v198
    v_fmac_f32 v231, v199, v199
    v_add_f32 v223, v223, v199
    s_branch L_k45_red
L_k45_zero:
    s_waitcnt vmcnt(0) lgkmcnt(0)
    v_mov_b32 v216, 0
    v_mov_b32 v224, 0
    v_mov_b32 v217, 0
    v_mov_b32 v225, 0
    v_mov_b32 v218, 0
    v_mov_b32 v226, 0
    v_mov_b32 v219, 0
    v_mov_b32 v227, 0
    v_mov_b32 v220, 0
    v_mov_b32 v228, 0
    v_mov_b32 v221, 0
    v_mov_b32 v229, 0
    v_mov_b32 v222, 0
    v_mov_b32 v230, 0
    v_mov_b32 v223, 0
    v_mov_b32 v231, 0
L_k45_red:
    s_lshl_b32 s25, s10, 12
    v_lshlrev_b32 v204, 10, v202
    v_lshl_add_u32 v204, v201, 5, v204
    v_add_u32 v204, s25, v204
    ds_write_b128 v204, v[216:219] offset:8192
    ds_write_b128 v204, v[220:223] offset:8208
    ds_write_b128 v204, v[224:227] offset:8704
    ds_write_b128 v204, v[228:231] offset:8720
    s_lshl_b32 s25, s10, 13
    v_lshlrev_b32 v205, 4, v200
    v_add_u32 v205, s25, v205
    ds_write_b96 v205, v[168:170] offset:33792
    ds_write_b96 v205, v[172:174] offset:34816
    ds_write_b96 v205, v[176:178] offset:35840
    ds_write_b96 v205, v[180:182] offset:36864
    ds_write_b96 v205, v[184:186] offset:37888
    ds_write_b96 v205, v[188:190] offset:38912
    ds_write_b96 v205, v[192:194] offset:39936
    ds_write_b96 v205, v[196:198] offset:40960
L_k45_red2:
    s_waitcnt lgkmcnt(0)
    s_barrier
    s_mul_i32 s24, s11, 112
    s_mul_i32 s25, s13, 28
    s_add_u32 s24, s24, s25
    s_lshl_b32 s26, s24, 10
    s_add_u32 s26, s26, 146800640
    s_cmp_ge_u32 s10, 6
    s_cbranch_scc1 L_k45_hread
    s_cmp_ge_u32 s10, 4
    s_cbranch_scc1 L_k45_sumdone
    ds_read_b32 v16, v214 offset:8192
    ds_read_b32 v17, v214 offset:9216
    ds_read_b32 v18, v214 offset:10240
    ds_read_b32 v19, v214 offset:11264
    ds_read_b32 v20, v214 offset:12288
    ds_read_b32 v21, v214 offset:13312
    ds_read_b32 v22, v214 offset:14336
    ds_read_b32 v23, v214 offset:15360
    ds_read_b32 v24, v214 offset:16384
    ds_read_b32 v25, v214 offset:17408
    ds_read_b32 v26, v214 offset:18432
    ds_read_b32 v27, v214 offset:19456
    ds_read_b32 v28, v214 offset:20480
    ds_read_b32 v29, v214 offset:21504
    ds_read_b32 v30, v214 offset:22528
    ds_read_b32 v31, v214 offset:23552
    ds_read_b32 v32, v214 offset:24576
    ds_read_b32 v33, v214 offset:25600
    ds_read_b32 v34, v214 offset:26624
    ds_read_b32 v35, v214 offset:27648
    ds_read_b32 v36, v214 offset:28672
    ds_read_b32 v37, v214 offset:29696
    ds_read_b32 v38, v214 offset:30720
    ds_read_b32 v39, v214 offset:31744
    s_waitcnt lgkmcnt(0)
    v_add_f32 v16, v16, v17
    v_add_f32 v18, v18, v19
    v_add_f32 v20, v20, v21
    v_add_f32 v22, v22, v23
    v_add_f32 v24, v24, v25
    v_add_f32 v26, v26, v27
    v_add_f32 v28, v28, v29
    v_add_f32 v30, v30, v31
    v_add_f32 v32, v32, v33
    v_add_f32 v34, v34, v35
    v_add_f32 v36, v36, v37
    v_add_f32 v38, v38, v39
    v_add_f32 v16, v16, v18
    v_add_f32 v20, v20, v22
    v_add_f32 v24, v24, v26
    v_add_f32 v28, v28, v30
    v_add_f32 v32, v32, v34
    v_add_f32 v36, v36, v38
    v_add_f32 v16, v16, v20
    v_add_f32 v24, v24, v28
    v_add_f32 v32, v32, v36
    v_add_f32 v16, v16, v24
    v_add_f32 v16, v16, v32
    s_lshl_b32 s24, s12, 10
    s_add_u32 s24, s24, s26
    buffer_store_dword v16, v214, s[16:19], s24 offen sc1
    s_mov_b32 s33, 16384
L_k45_poll:
    s_mov_b32 s27, s26
    buffer_load_dword v0, v214, s[16:19], s27 offen offset:0 sc1
    buffer_load_dword v1, v214, s[16:19], s27 offen offset:1024 sc1
    buffer_load_dword v2, v214, s[16:19], s27 offen offset:2048 sc1
    buffer_load_dword v3, v214, s[16:19], s27 offen offset:3072 sc1
    s_add_u32 s27, s27, 4096
    buffer_load_dword v4, v214, s[16:19], s27 offen offset:0 sc1
    buffer_load_dword v5, v214, s[16:19], s27 offen offset:1024 sc1
    buffer_load_dword v6, v214, s[16:19], s27 offen offset:2048 sc1
    buffer_load_dword v7, v214, s[16:19], s27 offen offset:3072 sc1
    s_add_u32 s27, s27, 4096
    buffer_load_dword v8, v214, s[16:19], s27 offen offset:0 sc1
    buffer_load_dword v9, v214, s[16:19], s27 offen offset:1024 sc1
    buffer_load_dword v10, v214, s[16:19], s27 offen offset:2048 sc1
    buffer_load_dword v11, v214, s[16:19], s27 offen offset:3072 sc1
    s_add_u32 s27, s27, 4096
    buffer_load_dword v12, v214, s[16:19], s27 offen offset:0 sc1
    buffer_load_dword v13, v214, s[16:19], s27 offen offset:1024 sc1
    buffer_load_dword v14, v214, s[16:19], s27 offen offset:2048 sc1
    buffer_load_dword v15, v214, s[16:19], s27 offen offset:3072 sc1
    s_add_u32 s27, s27, 4096
    buffer_load_dword v16, v214, s[16:19], s27 offen offset:0 sc1
    buffer_load_dword v17, v214, s[16:19], s27 offen offset:1024 sc1
    buffer_load_dword v18, v214, s[16:19], s27 offen offset:2048 sc1
    buffer_load_dword v19, v214, s[16:19], s27 offen offset:3072 sc1
    s_add_u32 s27, s27, 4096
    buffer_load_dword v20, v214, s[16:19], s27 offen offset:0 sc1
    buffer_load_dword v21, v214, s[16:19], s27 offen offset:1024 sc1
    buffer_load_dword v22, v214, s[16:19], s27 offen offset:2048 sc1
    buffer_load_dword v23, v214, s[16:19], s27 offen offset:3072 sc1
    s_add_u32 s27, s27, 4096
    buffer_load_dword v24, v214, s[16:19], s27 offen offset:0 sc1
    buffer_load_dword v25, v214, s[16:19], s27 offen offset:1024 sc1
    buffer_load_dword v26, v214, s[16:19], s27 offen offset:2048 sc1
    buffer_load_dword v27, v214, s[16:19], s27 offen offset:3072 sc1
    s_waitcnt vmcnt(0)
    v_max3_u32 v32, v0, v1, v2
    v_max3_u32 v32, v32, v3, v4
    v_max3_u32 v32, v32, v5, v6
    v_max3_u32 v32, v32, v7, v8
    v_max3_u32 v32, v32, v9, v10
    v_max3_u32 v32, v32, v11, v12
    v_max3_u32 v32, v32, v13, v14
    v_max3_u32 v32, v32, v15, v16
    v_max3_u32 v32, v32, v17, v18
    v_max3_u32 v32, v32, v19, v20
    v_max3_u32 v32, v32, v21, v22
    v_max3_u32 v32, v32, v23, v24
    v_max3_u32 v32, v32, v25, v26
    v_max_u32 v32, v32, v27
    v_cmp_eq_u32 vcc, -1, v32
    s_nop 3
    s_cmp_eq_u64 vcc, 0
    s_cbranch_scc1 L_k45_got
    s_sub_u32 s33, s33, 1
    s_cmp_eq_u32 s33, 0
    s_cbranch_scc1 L_k45_got
    s_sleep 2
    s_branch L_k45_poll
L_k45_got:
    v_add_f32 v0, v0, v1
    v_add_f32 v2, v2, v3
    v_add_f32 v4, v4, v5
    v_add_f32 v6, v6, v7
    v_add_f32 v8, v8, v9
    v_add_f32 v10, v10, v11
    v_add_f32 v12, v12, v13
    v_add_f32 v14, v14, v15
    v_add_f32 v16, v16, v17
    v_add_f32 v18, v18, v19
    v_add_f32 v20, v20, v21
    v_add_f32 v22, v22, v23
    v_add_f32 v24, v24, v25
    v_add_f32 v26, v26, v27
    v_add_f32 v0, v0, v2
    v_add_f32 v4, v4, v6
    v_add_f32 v8, v8, v10
    v_add_f32 v12, v12, v14
    v_add_f32 v16, v16, v18
    v_add_f32 v20, v20, v22
    v_add_f32 v24, v24, v26
    v_add_f32 v0, v0, v4
    v_add_f32 v8, v8, v12
    v_add_f32 v16, v16, v20
    v_add_f32 v0, v0, v8
    v_add_f32 v16, v16, v24
    v_add_f32 v0, v0, v16
    ds_write_b32 v214, v0 offset:32768
    s_branch L_k45_sumdone
L_k45_hread:
    s_sub_u32 s25, s10, 6
    s_mul_i32 s25, s25, 3
    s_lshl_b32 s25, s25, 13
    v_lshlrev_b32 v205, 4, v200
    v_add_u32 v205, s25, v205
    ds_read_b96 v[104:106], v205 offset:33792
    ds_read_b96 v[108:110], v205 offset:34816
    ds_read_b96 v[112:114], v205 offset:35840
    ds_read_b96 v[116:118], v205 offset:36864
    ds_read_b96 v[120:122], v205 offset:37888
    ds_read_b96 v[124:126], v205 offset:38912
    ds_read_b96 v[128:130], v205 offset:39936
    ds_read_b96 v[132:134], v205 offset:40960
    s_waitcnt lgkmcnt(0)
    ds_read_b96 v[136:138], v205 offset:41984
    ds_read_b96 v[140:142], v205 offset:43008
    ds_read_b96 v[144:146], v205 offset:44032
    ds_read_b96 v[148:150], v205 offset:45056
    ds_read_b96 v[152:154], v205 offset:46080
    ds_read_b96 v[156:158], v205 offset:47104
    ds_read_b96 v[160:162], v205 offset:48128
    ds_read_b96 v[164:166], v205 offset:49152
    s_waitcnt lgkmcnt(0)
    ds_read_b96 v[168:170], v205 offset:50176
    ds_read_b96 v[172:174], v205 offset:51200
    ds_read_b96 v[176:178], v205 offset:52224
    ds_read_b96 v[180:182], v205 offset:53248
    ds_read_b96 v[184:186], v205 offset:54272
    ds_read_b96 v[188:190], v205 offset:55296
    ds_read_b96 v[192:194], v205 offset:56320
    ds_read_b96 v[196:198], v205 offset:57344
    s_waitcnt lgkmcnt(0)
L_k45_sumdone:
    s_waitcnt lgkmcnt(0)
    s_barrier
    v_lshlrev_b32 v210, 5, v201
    ds_read_b128 v[44:47], v210 offset:32768
    ds_read_b128 v[48:51], v210 offset:32784
    ds_read_b128 v[52:55], v210 offset:33280
    ds_read_b128 v[56:59], v210 offset:33296
    s_mov_b32 s24, 0x39035177
    s_mov_b32 s25, 0x3727c5ac
    s_waitcnt vmcnt(0) lgkmcnt(0)
    v_mul_f32 v44, s24, v44
    v_mul_f32 v52, s24, v52
    v_fma_f32 v52, -v44, v44, v52
    v_max_f32 v52, 0, v52
    v_add_f32 v52, s25, v52
    v_rsq_f32 v52, v52
    v_lshlrev_b32 v216, 16, v232
    v_lshlrev_b32 v224, 16, v236
    v_mul_f32 v216, v216, v52
    v_fma_f32 v224, -v44, v216, v224
    v_mul_f32 v45, s24, v45
    v_mul_f32 v53, s24, v53
    v_fma_f32 v53, -v45, v45, v53
    v_max_f32 v53, 0, v53
    v_add_f32 v53, s25, v53
    v_rsq_f32 v53, v53
    v_and_b32 v217, 0xffff0000, v232
    v_and_b32 v225, 0xffff0000, v236
    v_mul_f32 v217, v217, v53
    v_fma_f32 v225, -v45, v217, v225
    v_mul_f32 v46, s24, v46
    v_mul_f32 v54, s24, v54
    v_fma_f32 v54, -v46, v46, v54
    v_max_f32 v54, 0, v54
    v_add_f32 v54, s25, v54
    v_rsq_f32 v54, v54
    v_lshlrev_b32 v218, 16, v233
    v_lshlrev_b32 v226, 16, v237
    v_mul_f32 v218, v218, v54
    v_fma_f32 v226, -v46, v218, v226
    v_mul_f32 v47, s24, v47
    v_mul_f32 v55, s24, v55
    v_fma_f32 v55, -v47, v47, v55
    v_max_f32 v55, 0, v55
    v_add_f32 v55, s25, v55
    v_rsq_f32 v55, v55
    v_and_b32 v219, 0xffff0000, v233
    v_and_b32 v227, 0xffff0000, v237
    v_mul_f32 v219, v219, v55
    v_fma_f32 v227, -v47, v219, v227
    v_mul_f32 v48, s24, v48
    v_mul_f32 v56, s24, v56
    v_fma_f32 v56, -v48, v48, v56
    v_max_f32 v56, 0, v56
    v_add_f32 v56, s25, v56
    v_rsq_f32 v56, v56
    v_lshlrev_b32 v220, 16, v234
    v_lshlrev_b32 v228, 16, v238
    v_mul_f32 v220, v220, v56
    v_fma_f32 v228, -v48, v220, v228
    v_mul_f32 v49, s24, v49
    v_mul_f32 v57, s24, v57
    v_fma_f32 v57, -v49, v49, v57
    v_max_f32 v57, 0, v57
    v_add_f32 v57, s25, v57
    v_rsq_f32 v57, v57
    v_and_b32 v221, 0xffff0000, v234
    v_and_b32 v229, 0xffff0000, v238
    v_mul_f32 v221, v221, v57
    v_fma_f32 v229, -v49, v221, v229
    v_mul_f32 v50, s24, v50
    v_mul_f32 v58, s24, v58
    v_fma_f32 v58, -v50, v50, v58
    v_max_f32 v58, 0, v58
    v_add_f32 v58, s25, v58
    v_rsq_f32 v58, v58
    v_lshlrev_b32 v222, 16, v235
    v_lshlrev_b32 v230, 16, v239
    v_mul_f32 v222, v222, v58
    v_fma_f32 v230, -v50, v222, v230
    v_mul_f32 v51, s24, v51
    v_mul_f32 v59, s24, v59
    v_fma_f32 v59, -v51, v51, v59
    v_max_f32 v59, 0, v59
    v_add_f32 v59, s25, v59
    v_rsq_f32 v59, v59
    v_and_b32 v223, 0xffff0000, v235
    v_and_b32 v231, 0xffff0000, v239
    v_mul_f32 v223, v223, v59
    v_fma_f32 v231, -v51, v223, v231
    s_mul_i32 s24, s11, 8176640
    s_add_u32 s28, s28, s24
    s_addc_u32 s29, s29, 0
    s_mov_b32 s32, s28
    s_and_b32 s33, s29, 0xffff
    s_mov_b32 s34, 8176640
    s_mov_b32 s35, 0x00020000
    s_lshl_b32 s25, s13, 8
    v_lshlrev_b32 v210, 12, v202
    v_lshl_add_u32 v210, v201, 4, v210
    v_add_u32 v210, s25, v210
    s_mov_b32 s26, 0xbdd2d3e8
    v_mov_b32 v211, 0xc0135761
    s_cmp_ge_u32 s10, 6
    s_cbranch_scc1 L_k45_hgelu
    s_cmp_ge_u32 s14, 167
    s_cbranch_scc1 L_k45_fin
    s_mul_i32 s24, s14, 49152
    v_fma_f32 v104, v104, v216, v224
    v_fma_f32 v108, v108, v217, v225
    v_fma_f32 v112, v112, v218, v226
    v_fma_f32 v116, v116, v219, v227
    v_fma_f32 v120, v120, v220, v228
    v_fma_f32 v124, v124, v221, v229
    v_fma_f32 v128, v128, v222, v230
    v_fma_f32 v132, v132, v223, v231
    v_mul_f32 v0, v104, v104
    v_mul_f32 v1, v108, v108
    v_mul_f32 v2, v112, v112
    v_mul_f32 v3, v116, v116
    v_mul_f32 v4, v120, v120
    v_mul_f32 v5, v124, v124
    v_mul_f32 v6, v128, v128
    v_mul_f32 v7, v132, v132
    v_fma_f32 v0, v0, s26, v211
    v_fma_f32 v1, v1, s26, v211
    v_fma_f32 v2, v2, s26, v211
    v_fma_f32 v3, v3, s26, v211
    v_fma_f32 v4, v4, s26, v211
    v_fma_f32 v5, v5, s26, v211
    v_fma_f32 v6, v6, s26, v211
    v_fma_f32 v7, v7, s26, v211
    v_mul_f32 v0, v0, v104
    v_mul_f32 v1, v1, v108
    v_mul_f32 v2, v2, v112
    v_mul_f32 v3, v3, v116
    v_mul_f32 v4, v4, v120
    v_mul_f32 v5, v5, v124
    v_mul_f32 v6, v6, v128
    v_mul_f32 v7, v7, v132
    v_exp_f32 v0, v0
    v_exp_f32 v1, v1
    v_exp_f32 v2, v2
    v_exp_f32 v3, v3
    v_exp_f32 v4, v4
    v_exp_f32 v5, v5
    v_exp_f32 v6, v6
    v_exp_f32 v7, v7
    v_add_f32 v0, 1.0, v0
    v_add_f32 v1, 1.0, v1
    v_add_f32 v2, 1.0, v2
    v_add_f32 v3, 1.0, v3
    v_add_f32 v4, 1.0, v4
    v_add_f32 v5, 1.0, v5
    v_add_f32 v6, 1.0, v6
    v_add_f32 v7, 1.0, v7
    v_rcp_f32 v0, v0
    v_rcp_f32 v1, v1
    v_rcp_f32 v2, v2
    v_rcp_f32 v3, v3
    v_rcp_f32 v4, v4
    v_rcp_f32 v5, v5
    v_rcp_f32 v6, v6
    v_rcp_f32 v7, v7
    v_mul_f32 v0, v0, v104
    v_mul_f32 v1, v1, v108
    v_mul_f32 v2, v2, v112
    v_mul_f32 v3, v3, v116
    v_mul_f32 v4, v4, v120
    v_mul_f32 v5, v5, v124
    v_mul_f32 v6, v6, v128
    v_mul_f32 v7, v7, v132
    v_cvt_pk_bf16_f32 v16, v0, v1
    v_cvt_pk_bf16_f32 v17, v2, v3
    v_cvt_pk_bf16_f32 v18, v4, v5
    v_cvt_pk_bf16_f32 v19, v6, v7
    s_add_u32 s27, s24, 0
    buffer_store_dwordx4 v[16:19], v210, s[32:35], s27 offen sc1
    v_fma_f32 v105, v105, v216, v224
    v_fma_f32 v109, v109, v217, v225
    v_fma_f32 v113, v113, v218, v226
    v_fma_f32 v117, v117, v219, v227
    v_fma_f32 v121, v121, v220, v228
    v_fma_f32 v125, v125, v221, v229
    v_fma_f32 v129, v129, v222, v230
    v_fma_f32 v133, v133, v223, v231
    v_mul_f32 v0, v105, v105
    v_mul_f32 v1, v109, v109
    v_mul_f32 v2, v113, v113
    v_mul_f32 v3, v117, v117
    v_mul_f32 v4, v121, v121
    v_mul_f32 v5, v125, v125
    v_mul_f32 v6, v129, v129
    v_mul_f32 v7, v133, v133
    v_fma_f32 v0, v0, s26, v211
    v_fma_f32 v1, v1, s26, v211
    v_fma_f32 v2, v2, s26, v211
    v_fma_f32 v3, v3, s26, v211
    v_fma_f32 v4, v4, s26, v211
    v_fma_f32 v5, v5, s26, v211
    v_fma_f32 v6, v6, s26, v211
    v_fma_f32 v7, v7, s26, v211
    v_mul_f32 v0, v0, v105
    v_mul_f32 v1, v1, v109
    v_mul_f32 v2, v2, v113
    v_mul_f32 v3, v3, v117
    v_mul_f32 v4, v4, v121
    v_mul_f32 v5, v5, v125
    v_mul_f32 v6, v6, v129
    v_mul_f32 v7, v7, v133
    v_exp_f32 v0, v0
    v_exp_f32 v1, v1
    v_exp_f32 v2, v2
    v_exp_f32 v3, v3
    v_exp_f32 v4, v4
    v_exp_f32 v5, v5
    v_exp_f32 v6, v6
    v_exp_f32 v7, v7
    v_add_f32 v0, 1.0, v0
    v_add_f32 v1, 1.0, v1
    v_add_f32 v2, 1.0, v2
    v_add_f32 v3, 1.0, v3
    v_add_f32 v4, 1.0, v4
    v_add_f32 v5, 1.0, v5
    v_add_f32 v6, 1.0, v6
    v_add_f32 v7, 1.0, v7
    v_rcp_f32 v0, v0
    v_rcp_f32 v1, v1
    v_rcp_f32 v2, v2
    v_rcp_f32 v3, v3
    v_rcp_f32 v4, v4
    v_rcp_f32 v5, v5
    v_rcp_f32 v6, v6
    v_rcp_f32 v7, v7
    v_mul_f32 v0, v0, v105
    v_mul_f32 v1, v1, v109
    v_mul_f32 v2, v2, v113
    v_mul_f32 v3, v3, v117
    v_mul_f32 v4, v4, v121
    v_mul_f32 v5, v5, v125
    v_mul_f32 v6, v6, v129
    v_mul_f32 v7, v7, v133
    v_cvt_pk_bf16_f32 v20, v0, v1
    v_cvt_pk_bf16_f32 v21, v2, v3
    v_cvt_pk_bf16_f32 v22, v4, v5
    v_cvt_pk_bf16_f32 v23, v6, v7
    s_add_u32 s27, s24, 1024
    buffer_store_dwordx4 v[20:23], v210, s[32:35], s27 offen sc1
    v_fma_f32 v106, v106, v216, v224
    v_fma_f32 v110, v110, v217, v225
    v_fma_f32 v114, v114, v218, v226
    v_fma_f32 v118, v118, v219, v227
    v_fma_f32 v122, v122, v220, v228
    v_fma_f32 v126, v126, v221, v229
    v_fma_f32 v130, v130, v222, v230
    v_fma_f32 v134, v134, v223, v231
    v_mul_f32 v0, v106, v106
    v_mul_f32 v1, v110, v110
    v_mul_f32 v2, v114, v114
    v_mul_f32 v3, v118, v118
    v_mul_f32 v4, v122, v122
    v_mul_f32 v5, v126, v126
    v_mul_f32 v6, v130, v130
    v_mul_f32 v7, v134, v134
    v_fma_f32 v0, v0, s26, v211
    v_fma_f32 v1, v1, s26, v211
    v_fma_f32 v2, v2, s26, v211
    v_fma_f32 v3, v3, s26, v211
    v_fma_f32 v4, v4, s26, v211
    v_fma_f32 v5, v5, s26, v211
    v_fma_f32 v6, v6, s26, v211
    v_fma_f32 v7, v7, s26, v211
    v_mul_f32 v0, v0, v106
    v_mul_f32 v1, v1, v110
    v_mul_f32 v2, v2, v114
    v_mul_f32 v3, v3, v118
    v_mul_f32 v4, v4, v122
    v_mul_f32 v5, v5, v126
    v_mul_f32 v6, v6, v130
    v_mul_f32 v7, v7, v134
    v_exp_f32 v0, v0
    v_exp_f32 v1, v1
    v_exp_f32 v2, v2
    v_exp_f32 v3, v3
    v_exp_f32 v4, v4
    v_exp_f32 v5, v5
    v_exp_f32 v6, v6
    v_exp_f32 v7, v7
    v_add_f32 v0, 1.0, v0
    v_add_f32 v1, 1.0, v1
    v_add_f32 v2, 1.0, v2
    v_add_f32 v3, 1.0, v3
    v_add_f32 v4, 1.0, v4
    v_add_f32 v5, 1.0, v5
    v_add_f32 v6, 1.0, v6
    v_add_f32 v7, 1.0, v7
    v_rcp_f32 v0, v0
    v_rcp_f32 v1, v1
    v_rcp_f32 v2, v2
    v_rcp_f32 v3, v3
    v_rcp_f32 v4, v4
    v_rcp_f32 v5, v5
    v_rcp_f32 v6, v6
    v_rcp_f32 v7, v7
    v_mul_f32 v0, v0, v106
    v_mul_f32 v1, v1, v110
    v_mul_f32 v2, v2, v114
    v_mul_f32 v3, v3, v118
    v_mul_f32 v4, v4, v122
    v_mul_f32 v5, v5, v126
    v_mul_f32 v6, v6, v130
    v_mul_f32 v7, v7, v134
    v_cvt_pk_bf16_f32 v24, v0, v1
    v_cvt_pk_bf16_f32 v25, v2, v3
    v_cvt_pk_bf16_f32 v26, v4, v5
    v_cvt_pk_bf16_f32 v27, v6, v7
    s_add_u32 s27, s24, 2048
    buffer_store_dwordx4 v[24:27], v210, s[32:35], s27 offen sc1
    v_fma_f32 v107, v107, v216, v224
    v_fma_f32 v111, v111, v217, v225
    v_fma_f32 v115, v115, v218, v226
    v_fma_f32 v119, v119, v219, v227
    v_fma_f32 v123, v123, v220, v228
    v_fma_f32 v127, v127, v221, v229
    v_fma_f32 v131, v131, v222, v230
    v_fma_f32 v135, v135, v223, v231
    v_mul_f32 v0, v107, v107
    v_mul_f32 v1, v111, v111
    v_mul_f32 v2, v115, v115
    v_mul_f32 v3, v119, v119
    v_mul_f32 v4, v123, v123
    v_mul_f32 v5, v127, v127
    v_mul_f32 v6, v131, v131
    v_mul_f32 v7, v135, v135
    v_fma_f32 v0, v0, s26, v211
    v_fma_f32 v1, v1, s26, v211
    v_fma_f32 v2, v2, s26, v211
    v_fma_f32 v3, v3, s26, v211
    v_fma_f32 v4, v4, s26, v211
    v_fma_f32 v5, v5, s26, v211
    v_fma_f32 v6, v6, s26, v211
    v_fma_f32 v7, v7, s26, v211
    v_mul_f32 v0, v0, v107
    v_mul_f32 v1, v1, v111
    v_mul_f32 v2, v2, v115
    v_mul_f32 v3, v3, v119
    v_mul_f32 v4, v4, v123
    v_mul_f32 v5, v5, v127
    v_mul_f32 v6, v6, v131
    v_mul_f32 v7, v7, v135
    v_exp_f32 v0, v0
    v_exp_f32 v1, v1
    v_exp_f32 v2, v2
    v_exp_f32 v3, v3
    v_exp_f32 v4, v4
    v_exp_f32 v5, v5
    v_exp_f32 v6, v6
    v_exp_f32 v7, v7
    v_add_f32 v0, 1.0, v0
    v_add_f32 v1, 1.0, v1
    v_add_f32 v2, 1.0, v2
    v_add_f32 v3, 1.0, v3
    v_add_f32 v4, 1.0, v4
    v_add_f32 v5, 1.0, v5
    v_add_f32 v6, 1.0, v6
    v_add_f32 v7, 1.0, v7
    v_rcp_f32 v0, v0
    v_rcp_f32 v1, v1
    v_rcp_f32 v2, v2
    v_rcp_f32 v3, v3
    v_rcp_f32 v4, v4
    v_rcp_f32 v5, v5
    v_rcp_f32 v6, v6
    v_rcp_f32 v7, v7
    v_mul_f32 v0, v0, v107
    v_mul_f32 v1, v1, v111
    v_mul_f32 v2, v2, v115
    v_mul_f32 v3, v3, v119
    v_mul_f32 v4, v4, v123
    v_mul_f32 v5, v5, v127
    v_mul_f32 v6, v6, v131
    v_mul_f32 v7, v7, v135
    v_cvt_pk_bf16_f32 v28, v0, v1
    v_cvt_pk_bf16_f32 v29, v2, v3
    v_cvt_pk_bf16_f32 v30, v4, v5
    v_cvt_pk_bf16_f32 v31, v6, v7
    s_add_u32 s27, s24, 3072
    buffer_store_dwordx4 v[28:31], v210, s[32:35], s27 offen sc1
    v_fma_f32 v136, v136, v216, v224
    v_fma_f32 v140, v140, v217, v225
    v_fma_f32 v144, v144, v218, v226
    v_fma_f32 v148, v148, v219, v227
    v_fma_f32 v152, v152, v220, v228
    v_fma_f32 v156, v156, v221, v229
    v_fma_f32 v160, v160, v222, v230
    v_fma_f32 v164, v164, v223, v231
    v_mul_f32 v0, v136, v136
    v_mul_f32 v1, v140, v140
    v_mul_f32 v2, v144, v144
    v_mul_f32 v3, v148, v148
    v_mul_f32 v4, v152, v152
    v_mul_f32 v5, v156, v156
    v_mul_f32 v6, v160, v160
    v_mul_f32 v7, v164, v164
    v_fma_f32 v0, v0, s26, v211
    v_fma_f32 v1, v1, s26, v211
    v_fma_f32 v2, v2, s26, v211
    v_fma_f32 v3, v3, s26, v211
    v_fma_f32 v4, v4, s26, v211
    v_fma_f32 v5, v5, s26, v211
    v_fma_f32 v6, v6, s26, v211
    v_fma_f32 v7, v7, s26, v211
    v_mul_f32 v0, v0, v136
    v_mul_f32 v1, v1, v140
    v_mul_f32 v2, v2, v144
    v_mul_f32 v3, v3, v148
    v_mul_f32 v4, v4, v152
    v_mul_f32 v5, v5, v156
    v_mul_f32 v6, v6, v160
    v_mul_f32 v7, v7, v164
    v_exp_f32 v0, v0
    v_exp_f32 v1, v1
    v_exp_f32 v2, v2
    v_exp_f32 v3, v3
    v_exp_f32 v4, v4
    v_exp_f32 v5, v5
    v_exp_f32 v6, v6
    v_exp_f32 v7, v7
    v_add_f32 v0, 1.0, v0
    v_add_f32 v1, 1.0, v1
    v_add_f32 v2, 1.0, v2
    v_add_f32 v3, 1.0, v3
    v_add_f32 v4, 1.0, v4
    v_add_f32 v5, 1.0, v5
    v_add_f32 v6, 1.0, v6
    v_add_f32 v7, 1.0, v7
    v_rcp_f32 v0, v0
    v_rcp_f32 v1, v1
    v_rcp_f32 v2, v2
    v_rcp_f32 v3, v3
    v_rcp_f32 v4, v4
    v_rcp_f32 v5, v5
    v_rcp_f32 v6, v6
    v_rcp_f32 v7, v7
    v_mul_f32 v0, v0, v136
    v_mul_f32 v1, v1, v140
    v_mul_f32 v2, v2, v144
    v_mul_f32 v3, v3, v148
    v_mul_f32 v4, v4, v152
    v_mul_f32 v5, v5, v156
    v_mul_f32 v6, v6, v160
    v_mul_f32 v7, v7, v164
    v_cvt_pk_bf16_f32 v32, v0, v1
    v_cvt_pk_bf16_f32 v33, v2, v3
    v_cvt_pk_bf16_f32 v34, v4, v5
    v_cvt_pk_bf16_f32 v35, v6, v7
    s_add_u32 s27, s24, 16384
    buffer_store_dwordx4 v[32:35], v210, s[32:35], s27 offen sc1
    v_fma_f32 v137, v137, v216, v224
    v_fma_f32 v141, v141, v217, v225
    v_fma_f32 v145, v145, v218, v226
    v_fma_f32 v149, v149, v219, v227
    v_fma_f32 v153, v153, v220, v228
    v_fma_f32 v157, v157, v221, v229
    v_fma_f32 v161, v161, v222, v230
    v_fma_f32 v165, v165, v223, v231
    v_mul_f32 v0, v137, v137
    v_mul_f32 v1, v141, v141
    v_mul_f32 v2, v145, v145
    v_mul_f32 v3, v149, v149
    v_mul_f32 v4, v153, v153
    v_mul_f32 v5, v157, v157
    v_mul_f32 v6, v161, v161
    v_mul_f32 v7, v165, v165
    v_fma_f32 v0, v0, s26, v211
    v_fma_f32 v1, v1, s26, v211
    v_fma_f32 v2, v2, s26, v211
    v_fma_f32 v3, v3, s26, v211
    v_fma_f32 v4, v4, s26, v211
    v_fma_f32 v5, v5, s26, v211
    v_fma_f32 v6, v6, s26, v211
    v_fma_f32 v7, v7, s26, v211
    v_mul_f32 v0, v0, v137
    v_mul_f32 v1, v1, v141
    v_mul_f32 v2, v2, v145
    v_mul_f32 v3, v3, v149
    v_mul_f32 v4, v4, v153
    v_mul_f32 v5, v5, v157
    v_mul_f32 v6, v6, v161
    v_mul_f32 v7, v7, v165
    v_exp_f32 v0, v0
    v_exp_f32 v1, v1
    v_exp_f32 v2, v2
    v_exp_f32 v3, v3
    v_exp_f32 v4, v4
    v_exp_f32 v5, v5
    v_exp_f32 v6, v6
    v_exp_f32 v7, v7
    v_add_f32 v0, 1.0, v0
    v_add_f32 v1, 1.0, v1
    v_add_f32 v2, 1.0, v2
    v_add_f32 v3, 1.0, v3
    v_add_f32 v4, 1.0, v4
    v_add_f32 v5, 1.0, v5
    v_add_f32 v6, 1.0, v6
    v_add_f32 v7, 1.0, v7
    v_rcp_f32 v0, v0
    v_rcp_f32 v1, v1
    v_rcp_f32 v2, v2
    v_rcp_f32 v3, v3
    v_rcp_f32 v4, v4
    v_rcp_f32 v5, v5
    v_rcp_f32 v6, v6
    v_rcp_f32 v7, v7
    v_mul_f32 v0, v0, v137
    v_mul_f32 v1, v1, v141
    v_mul_f32 v2, v2, v145
    v_mul_f32 v3, v3, v149
    v_mul_f32 v4, v4, v153
    v_mul_f32 v5, v5, v157
    v_mul_f32 v6, v6, v161
    v_mul_f32 v7, v7, v165
    v_cvt_pk_bf16_f32 v36, v0, v1
    v_cvt_pk_bf16_f32 v37, v2, v3
    v_cvt_pk_bf16_f32 v38, v4, v5
    v_cvt_pk_bf16_f32 v39, v6, v7
    s_add_u32 s27, s24, 17408
    buffer_store_dwordx4 v[36:39], v210, s[32:35], s27 offen sc1
    v_fma_f32 v138, v138, v216, v224
    v_fma_f32 v142, v142, v217, v225
    v_fma_f32 v146, v146, v218, v226
    v_fma_f32 v150, v150, v219, v227
    v_fma_f32 v154, v154, v220, v228
    v_fma_f32 v158, v158, v221, v229
    v_fma_f32 v162, v162, v222, v230
    v_fma_f32 v166, v166, v223, v231
    v_mul_f32 v0, v138, v138
    v_mul_f32 v1, v142, v142
    v_mul_f32 v2, v146, v146
    v_mul_f32 v3, v150, v150
    v_mul_f32 v4, v154, v154
    v_mul_f32 v5, v158, v158
    v_mul_f32 v6, v162, v162
    v_mul_f32 v7, v166, v166
    v_fma_f32 v0, v0, s26, v211
    v_fma_f32 v1, v1, s26, v211
    v_fma_f32 v2, v2, s26, v211
    v_fma_f32 v3, v3, s26, v211
    v_fma_f32 v4, v4, s26, v211
    v_fma_f32 v5, v5, s26, v211
    v_fma_f32 v6, v6, s26, v211
    v_fma_f32 v7, v7, s26, v211
    v_mul_f32 v0, v0, v138
    v_mul_f32 v1, v1, v142
    v_mul_f32 v2, v2, v146
    v_mul_f32 v3, v3, v150
    v_mul_f32 v4, v4, v154
    v_mul_f32 v5, v5, v158
    v_mul_f32 v6, v6, v162
    v_mul_f32 v7, v7, v166
    v_exp_f32 v0, v0
    v_exp_f32 v1, v1
    v_exp_f32 v2, v2
    v_exp_f32 v3, v3
    v_exp_f32 v4, v4
    v_exp_f32 v5, v5
    v_exp_f32 v6, v6
    v_exp_f32 v7, v7
    v_add_f32 v0, 1.0, v0
    v_add_f32 v1, 1.0, v1
    v_add_f32 v2, 1.0, v2
    v_add_f32 v3, 1.0, v3
    v_add_f32 v4, 1.0, v4
    v_add_f32 v5, 1.0, v5
    v_add_f32 v6, 1.0, v6
    v_add_f32 v7, 1.0, v7
    v_rcp_f32 v0, v0
    v_rcp_f32 v1, v1
    v_rcp_f32 v2, v2
    v_rcp_f32 v3, v3
    v_rcp_f32 v4, v4
    v_rcp_f32 v5, v5
    v_rcp_f32 v6, v6
    v_rcp_f32 v7, v7
    v_mul_f32 v0, v0, v138
    v_mul_f32 v1, v1, v142
    v_mul_f32 v2, v2, v146
    v_mul_f32 v3, v3, v150
    v_mul_f32 v4, v4, v154
    v_mul_f32 v5, v5, v158
    v_mul_f32 v6, v6, v162
    v_mul_f32 v7, v7, v166
    v_cvt_pk_bf16_f32 v40, v0, v1
    v_cvt_pk_bf16_f32 v41, v2, v3
    v_cvt_pk_bf16_f32 v42, v4, v5
    v_cvt_pk_bf16_f32 v43, v6, v7
    s_add_u32 s27, s24, 18432
    buffer_store_dwordx4 v[40:43], v210, s[32:35], s27 offen sc1
    v_fma_f32 v139, v139, v216, v224
    v_fma_f32 v143, v143, v217, v225
    v_fma_f32 v147, v147, v218, v226
    v_fma_f32 v151, v151, v219, v227
    v_fma_f32 v155, v155, v220, v228
    v_fma_f32 v159, v159, v221, v229
    v_fma_f32 v163, v163, v222, v230
    v_fma_f32 v167, v167, v223, v231
    v_mul_f32 v0, v139, v139
    v_mul_f32 v1, v143, v143
    v_mul_f32 v2, v147, v147
    v_mul_f32 v3, v151, v151
    v_mul_f32 v4, v155, v155
    v_mul_f32 v5, v159, v159
    v_mul_f32 v6, v163, v163
    v_mul_f32 v7, v167, v167
    v_fma_f32 v0, v0, s26, v211
    v_fma_f32 v1, v1, s26, v211
    v_fma_f32 v2, v2, s26, v211
    v_fma_f32 v3, v3, s26, v211
    v_fma_f32 v4, v4, s26, v211
    v_fma_f32 v5, v5, s26, v211
    v_fma_f32 v6, v6, s26, v211
    v_fma_f32 v7, v7, s26, v211
    v_mul_f32 v0, v0, v139
    v_mul_f32 v1, v1, v143
    v_mul_f32 v2, v2, v147
    v_mul_f32 v3, v3, v151
    v_mul_f32 v4, v4, v155
    v_mul_f32 v5, v5, v159
    v_mul_f32 v6, v6, v163
    v_mul_f32 v7, v7, v167
    v_exp_f32 v0, v0
    v_exp_f32 v1, v1
    v_exp_f32 v2, v2
    v_exp_f32 v3, v3
    v_exp_f32 v4, v4
    v_exp_f32 v5, v5
    v_exp_f32 v6, v6
    v_exp_f32 v7, v7
    v_add_f32 v0, 1.0, v0
    v_add_f32 v1, 1.0, v1
    v_add_f32 v2, 1.0, v2
    v_add_f32 v3, 1.0, v3
    v_add_f32 v4, 1.0, v4
    v_add_f32 v5, 1.0, v5
    v_add_f32 v6, 1.0, v6
    v_add_f32 v7, 1.0, v7
    v_rcp_f32 v0, v0
    v_rcp_f32 v1, v1
    v_rcp_f32 v2, v2
    v_rcp_f32 v3, v3
    v_rcp_f32 v4, v4
    v_rcp_f32 v5, v5
    v_rcp_f32 v6, v6
    v_rcp_f32 v7, v7
    v_mul_f32 v0, v0, v139
    v_mul_f32 v1, v1, v143
    v_mul_f32 v2, v2, v147
    v_mul_f32 v3, v3, v151
    v_mul_f32 v4, v4, v155
    v_mul_f32 v5, v5, v159
    v_mul_f32 v6, v6, v163
    v_mul_f32 v7, v7, v167
    v_cvt_pk_bf16_f32 v44, v0, v1
    v_cvt_pk_bf16_f32 v45, v2, v3
    v_cvt_pk_bf16_f32 v46, v4, v5
    v_cvt_pk_bf16_f32 v47, v6, v7
    s_add_u32 s27, s24, 19456
    buffer_store_dwordx4 v[44:47], v210, s[32:35], s27 offen sc1
    v_fma_f32 v171, v171, v216, v224
    v_fma_f32 v175, v175, v217, v225
    v_fma_f32 v179, v179, v218, v226
    v_fma_f32 v183, v183, v219, v227
    v_fma_f32 v187, v187, v220, v228
    v_fma_f32 v191, v191, v221, v229
    v_fma_f32 v195, v195, v222, v230
    v_fma_f32 v199, v199, v223, v231
    v_mul_f32 v0, v171, v171
    v_mul_f32 v1, v175, v175
    v_mul_f32 v2, v179, v179
    v_mul_f32 v3, v183, v183
    v_mul_f32 v4, v187, v187
    v_mul_f32 v5, v191, v191
    v_mul_f32 v6, v195, v195
    v_mul_f32 v7, v199, v199
    v_fma_f32 v0, v0, s26, v211
    v_fma_f32 v1, v1, s26, v211
    v_fma_f32 v2, v2, s26, v211
    v_fma_f32 v3, v3, s26, v211
    v_fma_f32 v4, v4, s26, v211
    v_fma_f32 v5, v5, s26, v211
    v_fma_f32 v6, v6, s26, v211
    v_fma_f32 v7, v7, s26, v211
    v_mul_f32 v0, v0, v171
    v_mul_f32 v1, v1, v175
    v_mul_f32 v2, v2, v179
    v_mul_f32 v3, v3, v183
    v_mul_f32 v4, v4, v187
    v_mul_f32 v5, v5, v191
    v_mul_f32 v6, v6, v195
    v_mul_f32 v7, v7, v199
    v_exp_f32 v0, v0
    v_exp_f32 v1, v1
    v_exp_f32 v2, v2
    v_exp_f32 v3, v3
    v_exp_f32 v4, v4
    v_exp_f32 v5, v5
    v_exp_f32 v6, v6
    v_exp_f32 v7, v7
    v_add_f32 v0, 1.0, v0
    v_add_f32 v1, 1.0, v1
    v_add_f32 v2, 1.0, v2
    v_add_f32 v3, 1.0, v3
    v_add_f32 v4, 1.0, v4
    v_add_f32 v5, 1.0, v5
    v_add_f32 v6, 1.0, v6
    v_add_f32 v7, 1.0, v7
    v_rcp_f32 v0, v0
    v_rcp_f32 v1, v1
    v_rcp_f32 v2, v2
    v_rcp_f32 v3, v3
    v_rcp_f32 v4, v4
    v_rcp_f32 v5, v5
    v_rcp_f32 v6, v6
    v_rcp_f32 v7, v7
    v_mul_f32 v0, v0, v171
    v_mul_f32 v1, v1, v175
    v_mul_f32 v2, v2, v179
    v_mul_f32 v3, v3, v183
    v_mul_f32 v4, v4, v187
    v_mul_f32 v5, v5, v191
    v_mul_f32 v6, v6, v195
    v_mul_f32 v7, v7, v199
    v_cvt_pk_bf16_f32 v16, v0, v1
    v_cvt_pk_bf16_f32 v17, v2, v3
    v_cvt_pk_bf16_f32 v18, v4, v5
    v_cvt_pk_bf16_f32 v19, v6, v7
    s_add_u32 s27, s24, 35840
    buffer_store_dwordx4 v[16:19], v210, s[32:35], s27 offen sc1
    s_branch L_k45_fin
L_k45_hgelu:
    s_sub_u32 s25, s10, 6
    s_mul_i32 s25, s25, 3
    s_mul_i32 s24, s12, 6
    s_add_u32 s24, s24, s25
    s_mul_i32 s24, s24, 49152
    v_fma_f32 v104, v104, v216, v224
    v_fma_f32 v108, v108, v217, v225
    v_fma_f32 v112, v112, v218, v226
    v_fma_f32 v116, v116, v219, v227
    v_fma_f32 v120, v120, v220, v228
    v_fma_f32 v124, v124, v221, v229
    v_fma_f32 v128, v128, v222, v230
    v_fma_f32 v132, v132, v223, v231
    v_mul_f32 v0, v104, v104
    v_mul_f32 v1, v108, v108
    v_mul_f32 v2, v112, v112
    v_mul_f32 v3, v116, v116
    v_mul_f32 v4, v120, v120
    v_mul_f32 v5, v124, v124
    v_mul_f32 v6, v128, v128
    v_mul_f32 v7, v132, v132
    v_fma_f32 v0, v0, s26, v211
    v_fma_f32 v1, v1, s26, v211
    v_fma_f32 v2, v2, s26, v211
    v_fma_f32 v3, v3, s26, v211
    v_fma_f32 v4, v4, s26, v211
    v_fma_f32 v5, v5, s26, v211
    v_fma_f32 v6, v6, s26, v211
    v_fma_f32 v7, v7, s26, v211
    v_mul_f32 v0, v0, v104
    v_mul_f32 v1, v1, v108
    v_mul_f32 v2, v2, v112
    v_mul_f32 v3, v3, v116
    v_mul_f32 v4, v4, v120
    v_mul_f32 v5, v5, v124
    v_mul_f32 v6, v6, v128
    v_mul_f32 v7, v7, v132
    v_exp_f32 v0, v0
    v_exp_f32 v1, v1
    v_exp_f32 v2, v2
    v_exp_f32 v3, v3
    v_exp_f32 v4, v4
    v_exp_f32 v5, v5
    v_exp_f32 v6, v6
    v_exp_f32 v7, v7
    v_add_f32 v0, 1.0, v0
    v_add_f32 v1, 1.0, v1
    v_add_f32 v2, 1.0, v2
    v_add_f32 v3, 1.0, v3
    v_add_f32 v4, 1.0, v4
    v_add_f32 v5, 1.0, v5
    v_add_f32 v6, 1.0, v6
    v_add_f32 v7, 1.0, v7
    v_rcp_f32 v0, v0
    v_rcp_f32 v1, v1
    v_rcp_f32 v2, v2
    v_rcp_f32 v3, v3
    v_rcp_f32 v4, v4
    v_rcp_f32 v5, v5
    v_rcp_f32 v6, v6
    v_rcp_f32 v7, v7
    v_mul_f32 v0, v0, v104
    v_mul_f32 v1, v1, v108
    v_mul_f32 v2, v2, v112
    v_mul_f32 v3, v3, v116
    v_mul_f32 v4, v4, v120
    v_mul_f32 v5, v5, v124
    v_mul_f32 v6, v6, v128
    v_mul_f32 v7, v7, v132
    v_cvt_pk_bf16_f32 v20, v0, v1
    v_cvt_pk_bf16_f32 v21, v2, v3
    v_cvt_pk_bf16_f32 v22, v4, v5
    v_cvt_pk_bf16_f32 v23, v6, v7
    s_add_u32 s27, s24, 32768
    buffer_store_dwordx4 v[20:23], v210, s[32:35], s27 offen sc1
    v_fma_f32 v105, v105, v216, v224
    v_fma_f32 v109, v109, v217, v225
    v_fma_f32 v113, v113, v218, v226
    v_fma_f32 v117, v117, v219, v227
    v_fma_f32 v121, v121, v220, v228
    v_fma_f32 v125, v125, v221, v229
    v_fma_f32 v129, v129, v222, v230
    v_fma_f32 v133, v133, v223, v231
    v_mul_f32 v0, v105, v105
    v_mul_f32 v1, v109, v109
    v_mul_f32 v2, v113, v113
    v_mul_f32 v3, v117, v117
    v_mul_f32 v4, v121, v121
    v_mul_f32 v5, v125, v125
    v_mul_f32 v6, v129, v129
    v_mul_f32 v7, v133, v133
    v_fma_f32 v0, v0, s26, v211
    v_fma_f32 v1, v1, s26, v211
    v_fma_f32 v2, v2, s26, v211
    v_fma_f32 v3, v3, s26, v211
    v_fma_f32 v4, v4, s26, v211
    v_fma_f32 v5, v5, s26, v211
    v_fma_f32 v6, v6, s26, v211
    v_fma_f32 v7, v7, s26, v211
    v_mul_f32 v0, v0, v105
    v_mul_f32 v1, v1, v109
    v_mul_f32 v2, v2, v113
    v_mul_f32 v3, v3, v117
    v_mul_f32 v4, v4, v121
    v_mul_f32 v5, v5, v125
    v_mul_f32 v6, v6, v129
    v_mul_f32 v7, v7, v133
    v_exp_f32 v0, v0
    v_exp_f32 v1, v1
    v_exp_f32 v2, v2
    v_exp_f32 v3, v3
    v_exp_f32 v4, v4
    v_exp_f32 v5, v5
    v_exp_f32 v6, v6
    v_exp_f32 v7, v7
    v_add_f32 v0, 1.0, v0
    v_add_f32 v1, 1.0, v1
    v_add_f32 v2, 1.0, v2
    v_add_f32 v3, 1.0, v3
    v_add_f32 v4, 1.0, v4
    v_add_f32 v5, 1.0, v5
    v_add_f32 v6, 1.0, v6
    v_add_f32 v7, 1.0, v7
    v_rcp_f32 v0, v0
    v_rcp_f32 v1, v1
    v_rcp_f32 v2, v2
    v_rcp_f32 v3, v3
    v_rcp_f32 v4, v4
    v_rcp_f32 v5, v5
    v_rcp_f32 v6, v6
    v_rcp_f32 v7, v7
    v_mul_f32 v0, v0, v105
    v_mul_f32 v1, v1, v109
    v_mul_f32 v2, v2, v113
    v_mul_f32 v3, v3, v117
    v_mul_f32 v4, v4, v121
    v_mul_f32 v5, v5, v125
    v_mul_f32 v6, v6, v129
    v_mul_f32 v7, v7, v133
    v_cvt_pk_bf16_f32 v24, v0, v1
    v_cvt_pk_bf16_f32 v25, v2, v3
    v_cvt_pk_bf16_f32 v26, v4, v5
    v_cvt_pk_bf16_f32 v27, v6, v7
    s_add_u32 s27, s24, 33792
    buffer_store_dwordx4 v[24:27], v210, s[32:35], s27 offen sc1
    v_fma_f32 v106, v106, v216, v224
    v_fma_f32 v110, v110, v217, v225
    v_fma_f32 v114, v114, v218, v226
    v_fma_f32 v118, v118, v219, v227
    v_fma_f32 v122, v122, v220, v228
    v_fma_f32 v126, v126, v221, v229
    v_fma_f32 v130, v130, v222, v230
    v_fma_f32 v134, v134, v223, v231
    v_mul_f32 v0, v106, v106
    v_mul_f32 v1, v110, v110
    v_mul_f32 v2, v114, v114
    v_mul_f32 v3, v118, v118
    v_mul_f32 v4, v122, v122
    v_mul_f32 v5, v126, v126
    v_mul_f32 v6, v130, v130
    v_mul_f32 v7, v134, v134
    v_fma_f32 v0, v0, s26, v211
    v_fma_f32 v1, v1, s26, v211
    v_fma_f32 v2, v2, s26, v211
    v_fma_f32 v3, v3, s26, v211
    v_fma_f32 v4, v4, s26, v211
    v_fma_f32 v5, v5, s26, v211
    v_fma_f32 v6, v6, s26, v211
    v_fma_f32 v7, v7, s26, v211
    v_mul_f32 v0, v0, v106
    v_mul_f32 v1, v1, v110
    v_mul_f32 v2, v2, v114
    v_mul_f32 v3, v3, v118
    v_mul_f32 v4, v4, v122
    v_mul_f32 v5, v5, v126
    v_mul_f32 v6, v6, v130
    v_mul_f32 v7, v7, v134
    v_exp_f32 v0, v0
    v_exp_f32 v1, v1
    v_exp_f32 v2, v2
    v_exp_f32 v3, v3
    v_exp_f32 v4, v4
    v_exp_f32 v5, v5
    v_exp_f32 v6, v6
    v_exp_f32 v7, v7
    v_add_f32 v0, 1.0, v0
    v_add_f32 v1, 1.0, v1
    v_add_f32 v2, 1.0, v2
    v_add_f32 v3, 1.0, v3
    v_add_f32 v4, 1.0, v4
    v_add_f32 v5, 1.0, v5
    v_add_f32 v6, 1.0, v6
    v_add_f32 v7, 1.0, v7
    v_rcp_f32 v0, v0
    v_rcp_f32 v1, v1
    v_rcp_f32 v2, v2
    v_rcp_f32 v3, v3
    v_rcp_f32 v4, v4
    v_rcp_f32 v5, v5
    v_rcp_f32 v6, v6
    v_rcp_f32 v7, v7
    v_mul_f32 v0, v0, v106
    v_mul_f32 v1, v1, v110
    v_mul_f32 v2, v2, v114
    v_mul_f32 v3, v3, v118
    v_mul_f32 v4, v4, v122
    v_mul_f32 v5, v5, v126
    v_mul_f32 v6, v6, v130
    v_mul_f32 v7, v7, v134
    v_cvt_pk_bf16_f32 v28, v0, v1
    v_cvt_pk_bf16_f32 v29, v2, v3
    v_cvt_pk_bf16_f32 v30, v4, v5
    v_cvt_pk_bf16_f32 v31, v6, v7
    s_add_u32 s27, s24, 34816
    buffer_store_dwordx4 v[28:31], v210, s[32:35], s27 offen sc1
    v_fma_f32 v136, v136, v216, v224
    v_fma_f32 v140, v140, v217, v225
    v_fma_f32 v144, v144, v218, v226
    v_fma_f32 v148, v148, v219, v227
    v_fma_f32 v152, v152, v220, v228
    v_fma_f32 v156, v156, v221, v229
    v_fma_f32 v160, v160, v222, v230
    v_fma_f32 v164, v164, v223, v231
    v_mul_f32 v0, v136, v136
    v_mul_f32 v1, v140, v140
    v_mul_f32 v2, v144, v144
    v_mul_f32 v3, v148, v148
    v_mul_f32 v4, v152, v152
    v_mul_f32 v5, v156, v156
    v_mul_f32 v6, v160, v160
    v_mul_f32 v7, v164, v164
    v_fma_f32 v0, v0, s26, v211
    v_fma_f32 v1, v1, s26, v211
    v_fma_f32 v2, v2, s26, v211
    v_fma_f32 v3, v3, s26, v211
    v_fma_f32 v4, v4, s26, v211
    v_fma_f32 v5, v5, s26, v211
    v_fma_f32 v6, v6, s26, v211
    v_fma_f32 v7, v7, s26, v211
    v_mul_f32 v0, v0, v136
    v_mul_f32 v1, v1, v140
    v_mul_f32 v2, v2, v144
    v_mul_f32 v3, v3, v148
    v_mul_f32 v4, v4, v152
    v_mul_f32 v5, v5, v156
    v_mul_f32 v6, v6, v160
    v_mul_f32 v7, v7, v164
    v_exp_f32 v0, v0
    v_exp_f32 v1, v1
    v_exp_f32 v2, v2
    v_exp_f32 v3, v3
    v_exp_f32 v4, v4
    v_exp_f32 v5, v5
    v_exp_f32 v6, v6
    v_exp_f32 v7, v7
    v_add_f32 v0, 1.0, v0
    v_add_f32 v1, 1.0, v1
    v_add_f32 v2, 1.0, v2
    v_add_f32 v3, 1.0, v3
    v_add_f32 v4, 1.0, v4
    v_add_f32 v5, 1.0, v5
    v_add_f32 v6, 1.0, v6
    v_add_f32 v7, 1.0, v7
    v_rcp_f32 v0, v0
    v_rcp_f32 v1, v1
    v_rcp_f32 v2, v2
    v_rcp_f32 v3, v3
    v_rcp_f32 v4, v4
    v_rcp_f32 v5, v5
    v_rcp_f32 v6, v6
    v_rcp_f32 v7, v7
    v_mul_f32 v0, v0, v136
    v_mul_f32 v1, v1, v140
    v_mul_f32 v2, v2, v144
    v_mul_f32 v3, v3, v148
    v_mul_f32 v4, v4, v152
    v_mul_f32 v5, v5, v156
    v_mul_f32 v6, v6, v160
    v_mul_f32 v7, v7, v164
    v_cvt_pk_bf16_f32 v32, v0, v1
    v_cvt_pk_bf16_f32 v33, v2, v3
    v_cvt_pk_bf16_f32 v34, v4, v5
    v_cvt_pk_bf16_f32 v35, v6, v7
    s_add_u32 s27, s24, 81920
    buffer_store_dwordx4 v[32:35], v210, s[32:35], s27 offen sc1
    v_fma_f32 v137, v137, v216, v224
    v_fma_f32 v141, v141, v217, v225
    v_fma_f32 v145, v145, v218, v226
    v_fma_f32 v149, v149, v219, v227
    v_fma_f32 v153, v153, v220, v228
    v_fma_f32 v157, v157, v221, v229
    v_fma_f32 v161, v161, v222, v230
    v_fma_f32 v165, v165, v223, v231
    v_mul_f32 v0, v137, v137
    v_mul_f32 v1, v141, v141
    v_mul_f32 v2, v145, v145
    v_mul_f32 v3, v149, v149
    v_mul_f32 v4, v153, v153
    v_mul_f32 v5, v157, v157
    v_mul_f32 v6, v161, v161
    v_mul_f32 v7, v165, v165
    v_fma_f32 v0, v0, s26, v211
    v_fma_f32 v1, v1, s26, v211
    v_fma_f32 v2, v2, s26, v211
    v_fma_f32 v3, v3, s26, v211
    v_fma_f32 v4, v4, s26, v211
    v_fma_f32 v5, v5, s26, v211
    v_fma_f32 v6, v6, s26, v211
    v_fma_f32 v7, v7, s26, v211
    v_mul_f32 v0, v0, v137
    v_mul_f32 v1, v1, v141
    v_mul_f32 v2, v2, v145
    v_mul_f32 v3, v3, v149
    v_mul_f32 v4, v4, v153
    v_mul_f32 v5, v5, v157
    v_mul_f32 v6, v6, v161
    v_mul_f32 v7, v7, v165
    v_exp_f32 v0, v0
    v_exp_f32 v1, v1
    v_exp_f32 v2, v2
    v_exp_f32 v3, v3
    v_exp_f32 v4, v4
    v_exp_f32 v5, v5
    v_exp_f32 v6, v6
    v_exp_f32 v7, v7
    v_add_f32 v0, 1.0, v0
    v_add_f32 v1, 1.0, v1
    v_add_f32 v2, 1.0, v2
    v_add_f32 v3, 1.0, v3
    v_add_f32 v4, 1.0, v4
    v_add_f32 v5, 1.0, v5
    v_add_f32 v6, 1.0, v6
    v_add_f32 v7, 1.0, v7
    v_rcp_f32 v0, v0
    v_rcp_f32 v1, v1
    v_rcp_f32 v2, v2
    v_rcp_f32 v3, v3
    v_rcp_f32 v4, v4
    v_rcp_f32 v5, v5
    v_rcp_f32 v6, v6
    v_rcp_f32 v7, v7
    v_mul_f32 v0, v0, v137
    v_mul_f32 v1, v1, v141
    v_mul_f32 v2, v2, v145
    v_mul_f32 v3, v3, v149
    v_mul_f32 v4, v4, v153
    v_mul_f32 v5, v5, v157
    v_mul_f32 v6, v6, v161
    v_mul_f32 v7, v7, v165
    v_cvt_pk_bf16_f32 v36, v0, v1
    v_cvt_pk_bf16_f32 v37, v2, v3
    v_cvt_pk_bf16_f32 v38, v4, v5
    v_cvt_pk_bf16_f32 v39, v6, v7
    s_add_u32 s27, s24, 82944
    buffer_store_dwordx4 v[36:39], v210, s[32:35], s27 offen sc1
    v_fma_f32 v138, v138, v216, v224
    v_fma_f32 v142, v142, v217, v225
    v_fma_f32 v146, v146, v218, v226
    v_fma_f32 v150, v150, v219, v227
    v_fma_f32 v154, v154, v220, v228
    v_fma_f32 v158, v158, v221, v229
    v_fma_f32 v162, v162, v222, v230
    v_fma_f32 v166, v166, v223, v231
    v_mul_f32 v0, v138, v138
    v_mul_f32 v1, v142, v142
    v_mul_f32 v2, v146, v146
    v_mul_f32 v3, v150, v150
    v_mul_f32 v4, v154, v154
    v_mul_f32 v5, v158, v158
    v_mul_f32 v6, v162, v162
    v_mul_f32 v7, v166, v166
    v_fma_f32 v0, v0, s26, v211
    v_fma_f32 v1, v1, s26, v211
    v_fma_f32 v2, v2, s26, v211
    v_fma_f32 v3, v3, s26, v211
    v_fma_f32 v4, v4, s26, v211
    v_fma_f32 v5, v5, s26, v211
    v_fma_f32 v6, v6, s26, v211
    v_fma_f32 v7, v7, s26, v211
    v_mul_f32 v0, v0, v138
    v_mul_f32 v1, v1, v142
    v_mul_f32 v2, v2, v146
    v_mul_f32 v3, v3, v150
    v_mul_f32 v4, v4, v154
    v_mul_f32 v5, v5, v158
    v_mul_f32 v6, v6, v162
    v_mul_f32 v7, v7, v166
    v_exp_f32 v0, v0
    v_exp_f32 v1, v1
    v_exp_f32 v2, v2
    v_exp_f32 v3, v3
    v_exp_f32 v4, v4
    v_exp_f32 v5, v5
    v_exp_f32 v6, v6
    v_exp_f32 v7, v7
    v_add_f32 v0, 1.0, v0
    v_add_f32 v1, 1.0, v1
    v_add_f32 v2, 1.0, v2
    v_add_f32 v3, 1.0, v3
    v_add_f32 v4, 1.0, v4
    v_add_f32 v5, 1.0, v5
    v_add_f32 v6, 1.0, v6
    v_add_f32 v7, 1.0, v7
    v_rcp_f32 v0, v0
    v_rcp_f32 v1, v1
    v_rcp_f32 v2, v2
    v_rcp_f32 v3, v3
    v_rcp_f32 v4, v4
    v_rcp_f32 v5, v5
    v_rcp_f32 v6, v6
    v_rcp_f32 v7, v7
    v_mul_f32 v0, v0, v138
    v_mul_f32 v1, v1, v142
    v_mul_f32 v2, v2, v146
    v_mul_f32 v3, v3, v150
    v_mul_f32 v4, v4, v154
    v_mul_f32 v5, v5, v158
    v_mul_f32 v6, v6, v162
    v_mul_f32 v7, v7, v166
    v_cvt_pk_bf16_f32 v40, v0, v1
    v_cvt_pk_bf16_f32 v41, v2, v3
    v_cvt_pk_bf16_f32 v42, v4, v5
    v_cvt_pk_bf16_f32 v43, v6, v7
    s_add_u32 s27, s24, 83968
    buffer_store_dwordx4 v[40:43], v210, s[32:35], s27 offen sc1
    v_fma_f32 v168, v168, v216, v224
    v_fma_f32 v172, v172, v217, v225
    v_fma_f32 v176, v176, v218, v226
    v_fma_f32 v180, v180, v219, v227
    v_fma_f32 v184, v184, v220, v228
    v_fma_f32 v188, v188, v221, v229
    v_fma_f32 v192, v192, v222, v230
    v_fma_f32 v196, v196, v223, v231
    v_mul_f32 v0, v168, v168
    v_mul_f32 v1, v172, v172
    v_mul_f32 v2, v176, v176
    v_mul_f32 v3, v180, v180
    v_mul_f32 v4, v184, v184
    v_mul_f32 v5, v188, v188
    v_mul_f32 v6, v192, v192
    v_mul_f32 v7, v196, v196
    v_fma_f32 v0, v0, s26, v211
    v_fma_f32 v1, v1, s26, v211
    v_fma_f32 v2, v2, s26, v211
    v_fma_f32 v3, v3, s26, v211
    v_fma_f32 v4, v4, s26, v211
    v_fma_f32 v5, v5, s26, v211
    v_fma_f32 v6, v6, s26, v211
    v_fma_f32 v7, v7, s26, v211
    v_mul_f32 v0, v0, v168
    v_mul_f32 v1, v1, v172
    v_mul_f32 v2, v2, v176
    v_mul_f32 v3, v3, v180
    v_mul_f32 v4, v4, v184
    v_mul_f32 v5, v5, v188
    v_mul_f32 v6, v6, v192
    v_mul_f32 v7, v7, v196
    v_exp_f32 v0, v0
    v_exp_f32 v1, v1
    v_exp_f32 v2, v2
    v_exp_f32 v3, v3
    v_exp_f32 v4, v4
    v_exp_f32 v5, v5
    v_exp_f32 v6, v6
    v_exp_f32 v7, v7
    v_add_f32 v0, 1.0, v0
    v_add_f32 v1, 1.0, v1
    v_add_f32 v2, 1.0, v2
    v_add_f32 v3, 1.0, v3
    v_add_f32 v4, 1.0, v4
    v_add_f32 v5, 1.0, v5
    v_add_f32 v6, 1.0, v6
    v_add_f32 v7, 1.0, v7
    v_rcp_f32 v0, v0
    v_rcp_f32 v1, v1
    v_rcp_f32 v2, v2
    v_rcp_f32 v3, v3
    v_rcp_f32 v4, v4
    v_rcp_f32 v5, v5
    v_rcp_f32 v6, v6
    v_rcp_f32 v7, v7
    v_mul_f32 v0, v0, v168
    v_mul_f32 v1, v1, v172
    v_mul_f32 v2, v2, v176
    v_mul_f32 v3, v3, v180
    v_mul_f32 v4, v4, v184
    v_mul_f32 v5, v5, v188
    v_mul_f32 v6, v6, v192
    v_mul_f32 v7, v7, v196
    v_cvt_pk_bf16_f32 v44, v0, v1
    v_cvt_pk_bf16_f32 v45, v2, v3
    v_cvt_pk_bf16_f32 v46, v4, v5
    v_cvt_pk_bf16_f32 v47, v6, v7
    s_add_u32 s27, s24, 131072
    buffer_store_dwordx4 v[44:47], v210, s[32:35], s27 offen sc1
    v_fma_f32 v169, v169, v216, v224
    v_fma_f32 v173, v173, v217, v225
    v_fma_f32 v177, v177, v218, v226
    v_fma_f32 v181, v181, v219, v227
    v_fma_f32 v185, v185, v220, v228
    v_fma_f32 v189, v189, v221, v229
    v_fma_f32 v193, v193, v222, v230
    v_fma_f32 v197, v197, v223, v231
    v_mul_f32 v0, v169, v169
    v_mul_f32 v1, v173, v173
    v_mul_f32 v2, v177, v177
    v_mul_f32 v3, v181, v181
    v_mul_f32 v4, v185, v185
    v_mul_f32 v5, v189, v189
    v_mul_f32 v6, v193, v193
    v_mul_f32 v7, v197, v197
    v_fma_f32 v0, v0, s26, v211
    v_fma_f32 v1, v1, s26, v211
    v_fma_f32 v2, v2, s26, v211
    v_fma_f32 v3, v3, s26, v211
    v_fma_f32 v4, v4, s26, v211
    v_fma_f32 v5, v5, s26, v211
    v_fma_f32 v6, v6, s26, v211
    v_fma_f32 v7, v7, s26, v211
    v_mul_f32 v0, v0, v169
    v_mul_f32 v1, v1, v173
    v_mul_f32 v2, v2, v177
    v_mul_f32 v3, v3, v181
    v_mul_f32 v4, v4, v185
    v_mul_f32 v5, v5, v189
    v_mul_f32 v6, v6, v193
    v_mul_f32 v7, v7, v197
    v_exp_f32 v0, v0
    v_exp_f32 v1, v1
    v_exp_f32 v2, v2
    v_exp_f32 v3, v3
    v_exp_f32 v4, v4
    v_exp_f32 v5, v5
    v_exp_f32 v6, v6
    v_exp_f32 v7, v7
    v_add_f32 v0, 1.0, v0
    v_add_f32 v1, 1.0, v1
    v_add_f32 v2, 1.0, v2
    v_add_f32 v3, 1.0, v3
    v_add_f32 v4, 1.0, v4
    v_add_f32 v5, 1.0, v5
    v_add_f32 v6, 1.0, v6
    v_add_f32 v7, 1.0, v7
    v_rcp_f32 v0, v0
    v_rcp_f32 v1, v1
    v_rcp_f32 v2, v2
    v_rcp_f32 v3, v3
    v_rcp_f32 v4, v4
    v_rcp_f32 v5, v5
    v_rcp_f32 v6, v6
    v_rcp_f32 v7, v7
    v_mul_f32 v0, v0, v169
    v_mul_f32 v1, v1, v173
    v_mul_f32 v2, v2, v177
    v_mul_f32 v3, v3, v181
    v_mul_f32 v4, v4, v185
    v_mul_f32 v5, v5, v189
    v_mul_f32 v6, v6, v193
    v_mul_f32 v7, v7, v197
    v_cvt_pk_bf16_f32 v16, v0, v1
    v_cvt_pk_bf16_f32 v17, v2, v3
    v_cvt_pk_bf16_f32 v18, v4, v5
    v_cvt_pk_bf16_f32 v19, v6, v7
    s_add_u32 s27, s24, 132096
    buffer_store_dwordx4 v[16:19], v210, s[32:35], s27 offen sc1
    v_fma_f32 v170, v170, v216, v224
    v_fma_f32 v174, v174, v217, v225
    v_fma_f32 v178, v178, v218, v226
    v_fma_f32 v182, v182, v219, v227
    v_fma_f32 v186, v186, v220, v228
    v_fma_f32 v190, v190, v221, v229
    v_fma_f32 v194, v194, v222, v230
    v_fma_f32 v198, v198, v223, v231
    v_mul_f32 v0, v170, v170
    v_mul_f32 v1, v174, v174
    v_mul_f32 v2, v178, v178
    v_mul_f32 v3, v182, v182
    v_mul_f32 v4, v186, v186
    v_mul_f32 v5, v190, v190
    v_mul_f32 v6, v194, v194
    v_mul_f32 v7, v198, v198
    v_fma_f32 v0, v0, s26, v211
    v_fma_f32 v1, v1, s26, v211
    v_fma_f32 v2, v2, s26, v211
    v_fma_f32 v3, v3, s26, v211
    v_fma_f32 v4, v4, s26, v211
    v_fma_f32 v5, v5, s26, v211
    v_fma_f32 v6, v6, s26, v211
    v_fma_f32 v7, v7, s26, v211
    v_mul_f32 v0, v0, v170
    v_mul_f32 v1, v1, v174
    v_mul_f32 v2, v2, v178
    v_mul_f32 v3, v3, v182
    v_mul_f32 v4, v4, v186
    v_mul_f32 v5, v5, v190
    v_mul_f32 v6, v6, v194
    v_mul_f32 v7, v7, v198
    v_exp_f32 v0, v0
    v_exp_f32 v1, v1
    v_exp_f32 v2, v2
    v_exp_f32 v3, v3
    v_exp_f32 v4, v4
    v_exp_f32 v5, v5
    v_exp_f32 v6, v6
    v_exp_f32 v7, v7
    v_add_f32 v0, 1.0, v0
    v_add_f32 v1, 1.0, v1
    v_add_f32 v2, 1.0, v2
    v_add_f32 v3, 1.0, v3
    v_add_f32 v4, 1.0, v4
    v_add_f32 v5, 1.0, v5
    v_add_f32 v6, 1.0, v6
    v_add_f32 v7, 1.0, v7
    v_rcp_f32 v0, v0
    v_rcp_f32 v1, v1
    v_rcp_f32 v2, v2
    v_rcp_f32 v3, v3
    v_rcp_f32 v4, v4
    v_rcp_f32 v5, v5
    v_rcp_f32 v6, v6
    v_rcp_f32 v7, v7
    v_mul_f32 v0, v0, v170
    v_mul_f32 v1, v1, v174
    v_mul_f32 v2, v2, v178
    v_mul_f32 v3, v3, v182
    v_mul_f32 v4, v4, v186
    v_mul_f32 v5, v5, v190
    v_mul_f32 v6, v6, v194
    v_mul_f32 v7, v7, v198
    v_cvt_pk_bf16_f32 v20, v0, v1
    v_cvt_pk_bf16_f32 v21, v2, v3
    v_cvt_pk_bf16_f32 v22, v4, v5
    v_cvt_pk_bf16_f32 v23, v6, v7
    s_add_u32 s27, s24, 133120
    buffer_store_dwordx4 v[20:23], v210, s[32:35], s27 offen sc1
L_k45_fin:
L_k45_end:
    s_endpgm
.section .rodata,"a"
.p2align 6
.amdhsa_kernel xform_kernel
  .amdhsa_next_free_vgpr 232
  .amdhsa_next_free_sgpr 96
  .amdhsa_accum_offset 232
  .amdhsa_group_segment_fixed_size 0
  .amdhsa_kernarg_size 56
  .amdhsa_user_sgpr_count 2
  .amdhsa_user_sgpr_kernarg_segment_ptr 1
  .amdhsa_system_sgpr_workgroup_id_x 1
  .amdhsa_float_denorm_mode_32 3
.end_amdhsa_kernel

.p2align 6
.amdhsa_kernel gemm_kernel
  .amdhsa_next_free_vgpr 256
  .amdhsa_next_free_sgpr 96
  .amdhsa_accum_offset 256
  .amdhsa_group_segment_fixed_size 0
  .amdhsa_kernarg_size 56
  .amdhsa_user_sgpr_count 2
  .amdhsa_user_sgpr_kernarg_segment_ptr 1
  .amdhsa_system_sgpr_workgroup_id_x 1
  .amdhsa_float_denorm_mode_32 3
.end_amdhsa_kernel

.p2align 6
.amdhsa_kernel final_kernel
  .amdhsa_next_free_vgpr 240
  .amdhsa_next_free_sgpr 96
  .amdhsa_accum_offset 240
  .amdhsa_group_segment_fixed_size 0
  .amdhsa_kernarg_size 56
  .amdhsa_user_sgpr_count 2
  .amdhsa_user_sgpr_kernarg_segment_ptr 1
  .amdhsa_system_sgpr_workgroup_id_x 1
  .amdhsa_float_denorm_mode_32 3
.end_amdhsa_kernel
```

```asm
; @launch kernel=xform_kernel grid=(256,1,1) block=(256,1,1) lds=12352
; @launch kernel=gemm_kernel grid=(256,1,1) block=(512,1,1) lds=155648
; @launch kernel=final_kernel grid=(224,1,1) block=(512,1,1) lds=82944
.amdgcn_target "amdgcn-amd-amdhsa--gfx950"
.text
.globl xform_kernel
.p2align 8
.type xform_kernel,@function
xform_kernel:
    s_cmp_ge_u32 s2, 256
    s_cbranch_scc1 L_k12_end
    s_load_dwordx4 s[4:7], s[0:1], 0
    s_load_dwordx4 s[36:39], s[0:1], 40
    v_and_b32 v208, 63, v0
    v_lshrrev_b32 v213, 6, v0
    v_and_b32 v209, 15, v208
    v_readfirstlane_b32 s10, v213
    v_lshrrev_b32 v210, 4, v208
    v_lshlrev_b32 v223, 4, v208
    v_mov_b32 v222, 0
    s_mov_b32 s30, 0x05040100
    s_mov_b32 s31, 0x07060302
    s_mov_b32 s32, 0x01000100
    s_mov_b32 s33, 0x03020302
    s_mov_b32 s40, s2
    s_add_u32 s42, s2, 256
    s_mov_b32 s41, 0
    s_mov_b32 s43, 0
    v_lshlrev_b32 v224, 14, v210
    v_lshl_add_u32 v224, v209, 4, v224
    v_lshlrev_b32 v225, 22, v210
    v_lshrrev_b32 v213, 2, v209
    v_lshl_add_u32 v225, v213, 6, v225
    v_and_b32 v213, 1, v209
    v_lshl_add_u32 v225, v213, 5, v225
    v_bfe_u32 v213, v209, 1, 1
    v_lshl_add_u32 v225, v213, 3, v225
    v_lshrrev_b32 v213, 2, v209
    s_mov_b32 s24, 688128
    v_mul_u32_u24 v226, s24, v213
    s_mov_b32 s24, 43008
    v_mad_u32_u24 v226, v210, s24, v226
    s_mov_b32 s24, 32768
    v_mul_u32_u24 v227, s24, v210
    s_waitcnt lgkmcnt(0)
    s_mov_b32 s16, s38
    s_and_b32 s17, s39, 0xffff
    s_mov_b32 s18, 268435456
    s_mov_b32 s19, 0x00020000
    s_mov_b32 s44, s36
    s_and_b32 s45, s37, 0xffff
    s_mov_b32 s46, 256
    s_mov_b32 s47, 0x00020000
    s_cmp_ge_u32 s40, 1696
    s_cbranch_scc1 L_ld_done0
    s_cmp_ge_u32 s40, 672
    s_cbranch_scc1 L_ld_w0
    s_cmp_ge_u32 s40, 336
    s_cselect_b32 s11, 1, 0
    s_mul_i32 s12, s11, 336
    s_sub_u32 s12, s40, s12
    s_and_b32 s13, s12, 7
    s_lshr_b32 s14, s12, 3
    s_lshl_b32 s14, s14, 2
    s_add_u32 s14, s14, s10
    s_mul_i32 s15, s11, 16384000
    s_add_u32 s34, s4, s15
    s_addc_u32 s35, s5, 0
    s_mov_b32 s20, s34
    s_and_b32 s21, s35, 0xffff
    s_mov_b32 s22, 16384000
    s_mov_b32 s23, 0x00020000
    s_mul_i32 s15, s14, 98304
    s_lshl_b32 s24, s13, 8
    s_add_u32 s15, s15, s24
    s_add_u32 s25, s15, 0
    buffer_load_dwordx4 v[0:3], v224, s[20:23], s25 offen
    s_add_u32 s25, s15, 2048
    buffer_load_dwordx4 v[4:7], v224, s[20:23], s25 offen
    s_add_u32 s25, s15, 4096
    buffer_load_dwordx4 v[8:11], v224, s[20:23], s25 offen
    s_add_u32 s25, s15, 6144
    buffer_load_dwordx4 v[12:15], v224, s[20:23], s25 offen
    s_add_u32 s25, s15, 8192
    buffer_load_dwordx4 v[16:19], v224, s[20:23], s25 offen
    s_add_u32 s25, s15, 10240
    buffer_load_dwordx4 v[20:23], v224, s[20:23], s25 offen
    s_add_u32 s25, s15, 12288
    buffer_load_dwordx4 v[24:27], v224, s[20:23], s25 offen
    s_add_u32 s25, s15, 14336
    buffer_load_dwordx4 v[28:31], v224, s[20:23], s25 offen
    s_add_u32 s25, s15, 65536
    buffer_load_dwordx4 v[32:35], v224, s[20:23], s25 offen
    s_add_u32 s25, s15, 67584
    buffer_load_dwordx4 v[36:39], v224, s[20:23], s25 offen
    s_add_u32 s25, s15, 69632
    buffer_load_dwordx4 v[40:43], v224, s[20:23], s25 offen
    s_add_u32 s25, s15, 71680
    buffer_load_dwordx4 v[44:47], v224, s[20:23], s25 offen
    s_add_u32 s25, s15, 73728
    buffer_load_dwordx4 v[48:51], v224, s[20:23], s25 offen
    s_add_u32 s25, s15, 75776
    buffer_load_dwordx4 v[52:55], v224, s[20:23], s25 offen
    s_add_u32 s25, s15, 77824
    buffer_load_dwordx4 v[56:59], v224, s[20:23], s25 offen
    s_add_u32 s25, s15, 79872
    buffer_load_dwordx4 v[60:63], v224, s[20:23], s25 offen
    s_branch L_ld_done0
L_ld_w0:
    s_sub_u32 s12, s40, 672
    s_and_b32 s13, s12, 3
    s_lshr_b32 s14, s12, 2
    s_lshl_b32 s14, s14, 2
    s_add_u32 s14, s14, s10
    s_mov_b32 s20, s6
    s_and_b32 s21, s7, 0xffff
    s_mov_b32 s22, 16252928
    s_mov_b32 s23, 0x00020000
    s_lshl_b32 s15, s14, 10
    s_lshl_b32 s24, s13, 8
    s_add_u32 s15, s15, s24
    s_add_u32 s25, s15, 0
    buffer_load_dwordx2 v[0:1], v225, s[20:23], s25 offen
    buffer_load_dwordx2 v[2:3], v225, s[20:23], s25 offen offset:16
    s_add_u32 s25, s15, 1048576
    buffer_load_dwordx2 v[4:5], v225, s[20:23], s25 offen
    buffer_load_dwordx2 v[6:7], v225, s[20:23], s25 offen offset:16
    s_add_u32 s25, s15, 2097152
    buffer_load_dwordx2 v[8:9], v225, s[20:23], s25 offen
    buffer_load_dwordx2 v[10:11], v225, s[20:23], s25 offen offset:16
    s_add_u32 s25, s15, 3145728
    buffer_load_dwordx2 v[12:13], v225, s[20:23], s25 offen
    buffer_load_dwordx2 v[14:15], v225, s[20:23], s25 offen offset:16
L_ld_done0:
    s_cmp_ge_u32 s2, 8
    s_cbranch_scc1 L_nopf12
    s_cmp_lg_u32 s10, 3
    s_cbranch_scc1 L_nopf12
    s_getpc_b64 s[60:61]
L_pf_k12:
    s_sub_u32 s60, s60, L_pf_k12-xform_kernel
    s_subb_u32 s61, s61, 0
    v_mbcnt_lo_u32_b32 v184, -1, 0
    v_mbcnt_hi_u32_b32 v184, -1, v184
    v_lshlrev_b32 v184, 6, v184
    v_add_u32 v185, 0, v184
    v_min_u32 v185, L_code_end-xform_kernel-4, v185
    v_mov_b32 v187, s61
    v_add_co_u32 v186, vcc, s60, v185
    s_nop 1
    v_addc_co_u32 v187, vcc, 0, v187, vcc
    global_load_dword v188, v[186:187], off
    v_add_u32 v185, 4096, v184
    v_min_u32 v185, L_code_end-xform_kernel-4, v185
    v_mov_b32 v187, s61
    v_add_co_u32 v186, vcc, s60, v185
    s_nop 1
    v_addc_co_u32 v187, vcc, 0, v187, vcc
    global_load_dword v188, v[186:187], off
    v_add_u32 v185, 8192, v184
    v_min_u32 v185, L_code_end-xform_kernel-4, v185
    v_mov_b32 v187, s61
    v_add_co_u32 v186, vcc, s60, v185
    s_nop 1
    v_addc_co_u32 v187, vcc, 0, v187, vcc
    global_load_dword v188, v[186:187], off
    v_add_u32 v185, 12288, v184
    v_min_u32 v185, L_code_end-xform_kernel-4, v185
    v_mov_b32 v187, s61
    v_add_co_u32 v186, vcc, s60, v185
    s_nop 1
    v_addc_co_u32 v187, vcc, 0, v187, vcc
    global_load_dword v188, v[186:187], off
    v_add_u32 v185, 16384, v184
    v_min_u32 v185, L_code_end-xform_kernel-4, v185
    v_mov_b32 v187, s61
    v_add_co_u32 v186, vcc, s60, v185
    s_nop 1
    v_addc_co_u32 v187, vcc, 0, v187, vcc
    global_load_dword v188, v[186:187], off
    v_add_u32 v185, 20480, v184
    v_min_u32 v185, L_code_end-xform_kernel-4, v185
    v_mov_b32 v187, s61
    v_add_co_u32 v186, vcc, s60, v185
    s_nop 1
    v_addc_co_u32 v187, vcc, 0, v187, vcc
    global_load_dword v188, v[186:187], off
    v_add_u32 v185, 24576, v184
    v_min_u32 v185, L_code_end-xform_kernel-4, v185
    v_mov_b32 v187, s61
    v_add_co_u32 v186, vcc, s60, v185
    s_nop 1
    v_addc_co_u32 v187, vcc, 0, v187, vcc
    global_load_dword v188, v[186:187], off
    v_add_u32 v185, 28672, v184
    v_min_u32 v185, L_code_end-xform_kernel-4, v185
    v_mov_b32 v187, s61
    v_add_co_u32 v186, vcc, s60, v185
    s_nop 1
    v_addc_co_u32 v187, vcc, 0, v187, vcc
    global_load_dword v188, v[186:187], off
    v_add_u32 v185, 32768, v184
    v_min_u32 v185, L_code_end-xform_kernel-4, v185
    v_mov_b32 v187, s61
    v_add_co_u32 v186, vcc, s60, v185
    s_nop 1
    v_addc_co_u32 v187, vcc, 0, v187, vcc
    global_load_dword v188, v[186:187], off
    v_add_u32 v185, 36864, v184
    v_min_u32 v185, L_code_end-xform_kernel-4, v185
    v_mov_b32 v187, s61
    v_add_co_u32 v186, vcc, s60, v185
    s_nop 1
    v_addc_co_u32 v187, vcc, 0, v187, vcc
    global_load_dword v188, v[186:187], off
L_nopf12:
    v_lshrrev_b32 v213, 2, v209
    v_lshlrev_b32 v213, 1, v213
    v_bfe_u32 v214, v209, 1, 1
    v_add_u32 v213, v213, v214
    s_lshl_b32 s24, s10, 3
    v_add_u32 v213, s24, v213
    v_lshl_add_u32 v213, v213, 1, 1
    v_and_b32 v214, 1, v209
    v_lshlrev_b32 v214, 5, v214
    v_lshlrev_b32 v215, 3, v210
    v_mad_u32_u24 v160, v213, v215, v214
    v_add_u32 v161, v160, v213
    v_add_u32 v162, v161, v213
    v_add_u32 v163, v162, v213
    v_add_u32 v164, v163, v213
    v_add_u32 v165, v164, v213
    v_add_u32 v166, v165, v213
    v_add_u32 v167, v166, v213
    v_and_b32 v160, 127, v160
    v_cvt_f32_u32 v160, v160
    v_mul_f32 v160, 0x3c000000, v160
    v_cos_f32 v160, v160
    v_and_b32 v161, 127, v161
    v_cvt_f32_u32 v161, v161
    v_mul_f32 v161, 0x3c000000, v161
    v_cos_f32 v161, v161
    v_and_b32 v162, 127, v162
    v_cvt_f32_u32 v162, v162
    v_mul_f32 v162, 0x3c000000, v162
    v_cos_f32 v162, v162
    v_and_b32 v163, 127, v163
    v_cvt_f32_u32 v163, v163
    v_mul_f32 v163, 0x3c000000, v163
    v_cos_f32 v163, v163
    v_and_b32 v164, 127, v164
    v_cvt_f32_u32 v164, v164
    v_mul_f32 v164, 0x3c000000, v164
    v_cos_f32 v164, v164
    v_and_b32 v165, 127, v165
    v_cvt_f32_u32 v165, v165
    v_mul_f32 v165, 0x3c000000, v165
    v_cos_f32 v165, v165
    v_and_b32 v166, 127, v166
    v_cvt_f32_u32 v166, v166
    v_mul_f32 v166, 0x3c000000, v166
    v_cos_f32 v166, v166
    v_and_b32 v167, 127, v167
    v_cvt_f32_u32 v167, v167
    v_mul_f32 v167, 0x3c000000, v167
    v_cos_f32 v167, v167
    v_cvt_pk_bf16_f32 v176, v160, v161
    v_cvt_pk_bf16_f32 v177, v162, v163
    v_cvt_pk_bf16_f32 v178, v164, v165
    v_cvt_pk_bf16_f32 v179, v166, v167
    s_lshl_b32 s24, s10, 11
    v_add_u32 v216, s24, v223
    ds_write_b128 v216, v[176:179] offset:0
    v_lshlrev_b32 v215, 3, v210
    v_add_u32 v215, 32, v215
    v_mad_u32_u24 v160, v213, v215, v214
    v_add_u32 v161, v160, v213
    v_add_u32 v162, v161, v213
    v_add_u32 v163, v162, v213
    v_add_u32 v164, v163, v213
    v_add_u32 v165, v164, v213
    v_add_u32 v166, v165, v213
    v_add_u32 v167, v166, v213
    v_and_b32 v160, 127, v160
    v_cvt_f32_u32 v160, v160
    v_mul_f32 v160, 0x3c000000, v160
    v_cos_f32 v160, v160
    v_and_b32 v161, 127, v161
    v_cvt_f32_u32 v161, v161
    v_mul_f32 v161, 0x3c000000, v161
    v_cos_f32 v161, v161
    v_and_b32 v162, 127, v162
    v_cvt_f32_u32 v162, v162
    v_mul_f32 v162, 0x3c000000, v162
    v_cos_f32 v162, v162
    v_and_b32 v163, 127, v163
    v_cvt_f32_u32 v163, v163
    v_mul_f32 v163, 0x3c000000, v163
    v_cos_f32 v163, v163
    v_and_b32 v164, 127, v164
    v_cvt_f32_u32 v164, v164
    v_mul_f32 v164, 0x3c000000, v164
    v_cos_f32 v164, v164
    v_and_b32 v165, 127, v165
    v_cvt_f32_u32 v165, v165
    v_mul_f32 v165, 0x3c000000, v165
    v_cos_f32 v165, v165
    v_and_b32 v166, 127, v166
    v_cvt_f32_u32 v166, v166
    v_mul_f32 v166, 0x3c000000, v166
    v_cos_f32 v166, v166
    v_and_b32 v167, 127, v167
    v_cvt_f32_u32 v167, v167
    v_mul_f32 v167, 0x3c000000, v167
    v_cos_f32 v167, v167
    v_cvt_pk_bf16_f32 v176, v160, v161
    v_cvt_pk_bf16_f32 v177, v162, v163
    v_cvt_pk_bf16_f32 v178, v164, v165
    v_cvt_pk_bf16_f32 v179, v166, v167
    s_lshl_b32 s24, s10, 11
    v_add_u32 v216, s24, v223
    ds_write_b128 v216, v[176:179] offset:1024
    v_lshlrev_b32 v215, 2, v210
    v_mad_u32_u24 v160, v213, v215, v214
    v_add_u32 v161, v160, v213
    v_add_u32 v162, v161, v213
    v_add_u32 v163, v162, v213
    v_and_b32 v160, 127, v160
    v_cvt_f32_u32 v160, v160
    v_mul_f32 v160, 0x3c000000, v160
    v_cos_f32 v160, v160
    v_and_b32 v161, 127, v161
    v_cvt_f32_u32 v161, v161
    v_mul_f32 v161, 0x3c000000, v161
    v_cos_f32 v161, v161
    v_and_b32 v162, 127, v162
    v_cvt_f32_u32 v162, v162
    v_mul_f32 v162, 0x3c000000, v162
    v_cos_f32 v162, v162
    v_and_b32 v163, 127, v163
    v_cvt_f32_u32 v163, v163
    v_mul_f32 v163, 0x3c000000, v163
    v_cos_f32 v163, v163
    v_cvt_pk_bf16_f32 v180, v160, v160
    v_lshlrev_b32 v181, 16, v180
    v_sub_f32 v181, v160, v181
    v_cvt_pk_bf16_f32 v181, v181, v181
    v_perm_b32 v176, v181, v180, s30
    v_cvt_pk_bf16_f32 v180, v161, v161
    v_lshlrev_b32 v181, 16, v180
    v_sub_f32 v181, v161, v181
    v_cvt_pk_bf16_f32 v181, v181, v181
    v_perm_b32 v177, v181, v180, s30
    v_cvt_pk_bf16_f32 v180, v162, v162
    v_lshlrev_b32 v181, 16, v180
    v_sub_f32 v181, v162, v181
    v_cvt_pk_bf16_f32 v181, v181, v181
    v_perm_b32 v178, v181, v180, s30
    v_cvt_pk_bf16_f32 v180, v163, v163
    v_lshlrev_b32 v181, 16, v180
    v_sub_f32 v181, v163, v181
    v_cvt_pk_bf16_f32 v181, v181, v181
    v_perm_b32 v179, v181, v180, s30
    s_lshl_b32 s24, s10, 10
    v_add_u32 v216, s24, v223
    ds_write_b128 v216, v[176:179] offset:8192
    s_waitcnt lgkmcnt(0)
    s_barrier
L_k12_loop:
    s_cmp_lg_u32 s10, 0
    s_cbranch_scc1 L_nofetch0
    v_mov_b32 v221, 1
    s_mov_b64 exec, 1
    buffer_atomic_add v221, v222, s[44:47], 0 offen sc0 sc1
    s_mov_b64 exec, -1
L_nofetch0:
    s_cmp_ge_u32 s42, 1696
    s_cbranch_scc1 L_ld_done1
    s_cmp_ge_u32 s42, 672
    s_cbranch_scc1 L_ld_w1
    s_cmp_ge_u32 s42, 336
    s_cselect_b32 s11, 1, 0
    s_mul_i32 s12, s11, 336
    s_sub_u32 s12, s42, s12
    s_and_b32 s13, s12, 7
    s_lshr_b32 s14, s12, 3
    s_lshl_b32 s14, s14, 2
    s_add_u32 s14, s14, s10
    s_mul_i32 s15, s11, 16384000
    s_add_u32 s34, s4, s15
    s_addc_u32 s35, s5, 0
    s_mov_b32 s20, s34
    s_and_b32 s21, s35, 0xffff
    s_mov_b32 s22, 16384000
    s_mov_b32 s23, 0x00020000
    s_mul_i32 s15, s14, 98304
    s_lshl_b32 s24, s13, 8
    s_add_u32 s15, s15, s24
    s_add_u32 s25, s15, 0
    buffer_load_dwordx4 v[64:67], v224, s[20:23], s25 offen
    s_add_u32 s25, s15, 2048
    buffer_load_dwordx4 v[68:71], v224, s[20:23], s25 offen
    s_add_u32 s25, s15, 4096
    buffer_load_dwordx4 v[72:75], v224, s[20:23], s25 offen
    s_add_u32 s25, s15, 6144
    buffer_load_dwordx4 v[76:79], v224, s[20:23], s25 offen
    s_add_u32 s25, s15, 8192
    buffer_load_dwordx4 v[80:83], v224, s[20:23], s25 offen
    s_add_u32 s25, s15, 10240
    buffer_load_dwordx4 v[84:87], v224, s[20:23], s25 offen
    s_add_u32 s25, s15, 12288
    buffer_load_dwordx4 v[88:91], v224, s[20:23], s25 offen
    s_add_u32 s25, s15, 14336
    buffer_load_dwordx4 v[92:95], v224, s[20:23], s25 offen
    s_add_u32 s25, s15, 65536
    buffer_load_dwordx4 v[96:99], v224, s[20:23], s25 offen
    s_add_u32 s25, s15, 67584
    buffer_load_dwordx4 v[100:103], v224, s[20:23], s25 offen
    s_add_u32 s25, s15, 69632
    buffer_load_dwordx4 v[104:107], v224, s[20:23], s25 offen
    s_add_u32 s25, s15, 71680
    buffer_load_dwordx4 v[108:111], v224, s[20:23], s25 offen
    s_add_u32 s25, s15, 73728
    buffer_load_dwordx4 v[112:115], v224, s[20:23], s25 offen
    s_add_u32 s25, s15, 75776
    buffer_load_dwordx4 v[116:119], v224, s[20:23], s25 offen
    s_add_u32 s25, s15, 77824
    buffer_load_dwordx4 v[120:123], v224, s[20:23], s25 offen
    s_add_u32 s25, s15, 79872
    buffer_load_dwordx4 v[124:127], v224, s[20:23], s25 offen
    s_branch L_ld_done1
L_ld_w1:
    s_sub_u32 s12, s42, 672
    s_and_b32 s13, s12, 3
    s_lshr_b32 s14, s12, 2
    s_lshl_b32 s14, s14, 2
    s_add_u32 s14, s14, s10
    s_mov_b32 s20, s6
    s_and_b32 s21, s7, 0xffff
    s_mov_b32 s22, 16252928
    s_mov_b32 s23, 0x00020000
    s_lshl_b32 s15, s14, 10
    s_lshl_b32 s24, s13, 8
    s_add_u32 s15, s15, s24
    s_add_u32 s25, s15, 0
    buffer_load_dwordx2 v[64:65], v225, s[20:23], s25 offen
    buffer_load_dwordx2 v[66:67], v225, s[20:23], s25 offen offset:16
    s_add_u32 s25, s15, 1048576
    buffer_load_dwordx2 v[68:69], v225, s[20:23], s25 offen
    buffer_load_dwordx2 v[70:71], v225, s[20:23], s25 offen offset:16
    s_add_u32 s25, s15, 2097152
    buffer_load_dwordx2 v[72:73], v225, s[20:23], s25 offen
    buffer_load_dwordx2 v[74:75], v225, s[20:23], s25 offen offset:16
    s_add_u32 s25, s15, 3145728
    buffer_load_dwordx2 v[76:77], v225, s[20:23], s25 offen
    buffer_load_dwordx2 v[78:79], v225, s[20:23], s25 offen offset:16
L_ld_done1:
    s_cmp_lg_u32 s43, 0
    s_cbranch_scc1 L_notfirst
    s_cmp_ge_u32 s42, 1696
    s_cbranch_scc1 L_w0_f
    s_cmp_ge_u32 s42, 672
    s_cbranch_scc1 L_w8_f
    s_waitcnt vmcnt(16)
    s_branch L_wd_f
L_w8_f:
    s_waitcnt vmcnt(8)
    s_branch L_wd_f
L_w0_f:
    s_waitcnt vmcnt(0)
L_wd_f:
    s_mov_b32 s43, 1
    s_branch L_wfin
L_notfirst:
    s_cmp_ge_u32 s42, 1696
    s_cbranch_scc1 L_w0_a0
    s_cmp_ge_u32 s42, 672
    s_cbranch_scc1 L_w8_a0
    s_waitcnt vmcnt(32)
    s_branch L_wd_a0
L_w8_a0:
    s_waitcnt vmcnt(24)
    s_branch L_wd_a0
L_w0_a0:
    s_waitcnt vmcnt(16)
L_wd_a0:
L_wfin:
    s_cmp_ge_u32 s40, 672
    s_cbranch_scc1 L_cw0
    s_cmp_ge_u32 s40, 336
    s_cselect_b32 s11, 1, 0
    s_mul_i32 s12, s11, 336
    s_sub_u32 s12, s40, s12
    s_and_b32 s13, s12, 7
    s_lshr_b32 s14, s12, 3
    s_lshl_b32 s14, s14, 2
    s_add_u32 s14, s14, s10
    ds_read_b128 v[128:131], v223 offset:0
    ds_read_b128 v[132:135], v223 offset:1024
    ds_read_b128 v[136:139], v223 offset:2048
    ds_read_b128 v[140:143], v223 offset:3072
    ds_read_b128 v[144:147], v223 offset:4096
    ds_read_b128 v[148:151], v223 offset:5120
    ds_read_b128 v[152:155], v223 offset:6144
    ds_read_b128 v[156:159], v223 offset:7168
    s_bfe_u32 s24, s14, 0x10003
    s_mul_i32 s24, s24, 3
    v_and_b32 v213, 3, v209
    v_xor_b32 v213, s24, v213
    v_lshl_add_u32 v212, v213, 4, v226
    s_mul_i32 s24, s11, 22020096
    s_mul_i32 s25, s13, 2752512
    s_add_u32 s24, s24, s25
    s_lshl_b32 s25, s14, 6
    s_add_u32 s24, s24, s25
    s_add_u32 s24, s24, 67108864
    v_perm_b32 v160, v4, v0, s30
    v_perm_b32 v161, v12, v8, s30
    v_perm_b32 v162, v20, v16, s30
    v_perm_b32 v163, v28, v24, s30
    v_perm_b32 v164, v4, v0, s31
    v_perm_b32 v165, v12, v8, s31
    v_perm_b32 v166, v20, v16, s31
    v_perm_b32 v167, v28, v24, s31
    v_perm_b32 v168, v36, v32, s30
    v_perm_b32 v169, v44, v40, s30
    v_perm_b32 v170, v52, v48, s30
    v_perm_b32 v171, v60, v56, s30
    v_perm_b32 v172, v36, v32, s31
    v_perm_b32 v173, v44, v40, s31
    v_perm_b32 v174, v52, v48, s31
    v_perm_b32 v175, v60, v56, s31
    s_waitcnt lgkmcnt(0)
    v_mfma_f32_16x16x32_bf16 v[176:179], v[128:131], v[160:163], 0
    v_mfma_f32_16x16x32_bf16 v[180:183], v[128:131], v[164:167], 0
    v_mfma_f32_16x16x32_bf16 v[184:187], v[136:139], v[160:163], 0
    v_mfma_f32_16x16x32_bf16 v[188:191], v[136:139], v[164:167], 0
    v_mfma_f32_16x16x32_bf16 v[192:195], v[144:147], v[160:163], 0
    v_mfma_f32_16x16x32_bf16 v[196:199], v[144:147], v[164:167], 0
    v_mfma_f32_16x16x32_bf16 v[200:203], v[152:155], v[160:163], 0
    v_mfma_f32_16x16x32_bf16 v[204:207], v[152:155], v[164:167], 0
    v_mfma_f32_16x16x32_bf16 v[176:179], v[132:135], v[168:171], v[176:179]
    v_mfma_f32_16x16x32_bf16 v[180:183], v[132:135], v[172:175], v[180:183]
    v_mfma_f32_16x16x32_bf16 v[184:187], v[140:143], v[168:171], v[184:187]
    v_mfma_f32_16x16x32_bf16 v[188:191], v[140:143], v[172:175], v[188:191]
    v_mfma_f32_16x16x32_bf16 v[192:195], v[148:151], v[168:171], v[192:195]
    v_mfma_f32_16x16x32_bf16 v[196:199], v[148:151], v[172:175], v[196:199]
    v_mfma_f32_16x16x32_bf16 v[200:203], v[156:159], v[168:171], v[200:203]
    v_mfma_f32_16x16x32_bf16 v[204:207], v[156:159], v[172:175], v[204:207]
    v_perm_b32 v160, v5, v1, s30
    v_perm_b32 v161, v13, v9, s30
    v_perm_b32 v162, v21, v17, s30
    v_perm_b32 v163, v29, v25, s30
    v_perm_b32 v164, v5, v1, s31
    v_perm_b32 v165, v13, v9, s31
    v_perm_b32 v166, v21, v17, s31
    v_perm_b32 v167, v29, v25, s31
    v_perm_b32 v168, v37, v33, s30
    v_perm_b32 v169, v45, v41, s30
    v_perm_b32 v170, v53, v49, s30
    v_perm_b32 v171, v61, v57, s30
    v_perm_b32 v172, v37, v33, s31
    v_perm_b32 v173, v45, v41, s31
    v_perm_b32 v174, v53, v49, s31
    v_perm_b32 v175, v61, v57, s31
    v_cvt_pk_bf16_f32 v0, v176, v180
    v_cvt_pk_bf16_f32 v4, v177, v181
    v_cvt_pk_bf16_f32 v8, v178, v182
    v_cvt_pk_bf16_f32 v12, v179, v183
    v_cvt_pk_bf16_f32 v16, v184, v188
    v_cvt_pk_bf16_f32 v20, v185, v189
    v_cvt_pk_bf16_f32 v24, v186, v190
    v_cvt_pk_bf16_f32 v28, v187, v191
    v_cvt_pk_bf16_f32 v32, v192, v196
    v_cvt_pk_bf16_f32 v36, v193, v197
    v_cvt_pk_bf16_f32 v40, v194, v198
    v_cvt_pk_bf16_f32 v44, v195, v199
    v_cvt_pk_bf16_f32 v48, v200, v204
    v_cvt_pk_bf16_f32 v52, v201, v205
    v_cvt_pk_bf16_f32 v56, v202, v206
    v_cvt_pk_bf16_f32 v60, v203, v207
    v_mfma_f32_16x16x32_bf16 v[176:179], v[128:131], v[160:163], 0
    v_mfma_f32_16x16x32_bf16 v[180:183], v[128:131], v[164:167], 0
    v_mfma_f32_16x16x32_bf16 v[184:187], v[136:139], v[160:163], 0
    v_mfma_f32_16x16x32_bf16 v[188:191], v[136:139], v[164:167], 0
    v_mfma_f32_16x16x32_bf16 v[192:195], v[144:147], v[160:163], 0
    v_mfma_f32_16x16x32_bf16 v[196:199], v[144:147], v[164:167], 0
    v_mfma_f32_16x16x32_bf16 v[200:203], v[152:155], v[160:163], 0
    v_mfma_f32_16x16x32_bf16 v[204:207], v[152:155], v[164:167], 0
    v_mfma_f32_16x16x32_bf16 v[176:179], v[132:135], v[168:171], v[176:179]
    v_mfma_f32_16x16x32_bf16 v[180:183], v[132:135], v[172:175], v[180:183]
    v_mfma_f32_16x16x32_bf16 v[184:187], v[140:143], v[168:171], v[184:187]
    v_mfma_f32_16x16x32_bf16 v[188:191], v[140:143], v[172:175], v[188:191]
    v_mfma_f32_16x16x32_bf16 v[192:195], v[148:151], v[168:171], v[192:195]
    v_mfma_f32_16x16x32_bf16 v[196:199], v[148:151], v[172:175], v[196:199]
    v_mfma_f32_16x16x32_bf16 v[200:203], v[156:159], v[168:171], v[200:203]
    v_mfma_f32_16x16x32_bf16 v[204:207], v[156:159], v[172:175], v[204:207]
    v_perm_b32 v160, v6, v2, s30
    v_perm_b32 v161, v14, v10, s30
    v_perm_b32 v162, v22, v18, s30
    v_perm_b32 v163, v30, v26, s30
    v_perm_b32 v164, v6, v2, s31
    v_perm_b32 v165, v14, v10, s31
    v_perm_b32 v166, v22, v18, s31
    v_perm_b32 v167, v30, v26, s31
    v_perm_b32 v168, v38, v34, s30
    v_perm_b32 v169, v46, v42, s30
    v_perm_b32 v170, v54, v50, s30
    v_perm_b32 v171, v62, v58, s30
    v_perm_b32 v172, v38, v34, s31
    v_perm_b32 v173, v46, v42, s31
    v_perm_b32 v174, v54, v50, s31
    v_perm_b32 v175, v62, v58, s31
    v_cvt_pk_bf16_f32 v1, v176, v180
    v_cvt_pk_bf16_f32 v5, v177, v181
    v_cvt_pk_bf16_f32 v9, v178, v182
    v_cvt_pk_bf16_f32 v13, v179, v183
    v_cvt_pk_bf16_f32 v17, v184, v188
    v_cvt_pk_bf16_f32 v21, v185, v189
    v_cvt_pk_bf16_f32 v25, v186, v190
    v_cvt_pk_bf16_f32 v29, v187, v191
    v_cvt_pk_bf16_f32 v33, v192, v196
    v_cvt_pk_bf16_f32 v37, v193, v197
    v_cvt_pk_bf16_f32 v41, v194, v198
    v_cvt_pk_bf16_f32 v45, v195, v199
    v_cvt_pk_bf16_f32 v49, v200, v204
    v_cvt_pk_bf16_f32 v53, v201, v205
    v_cvt_pk_bf16_f32 v57, v202, v206
    v_cvt_pk_bf16_f32 v61, v203, v207
    v_mfma_f32_16x16x32_bf16 v[176:179], v[128:131], v[160:163], 0
    v_mfma_f32_16x16x32_bf16 v[180:183], v[128:131], v[164:167], 0
    v_mfma_f32_16x16x32_bf16 v[184:187], v[136:139], v[160:163], 0
    v_mfma_f32_16x16x32_bf16 v[188:191], v[136:139], v[164:167], 0
    v_mfma_f32_16x16x32_bf16 v[192:195], v[144:147], v[160:163], 0
    v_mfma_f32_16x16x32_bf16 v[196:199], v[144:147], v[164:167], 0
    v_mfma_f32_16x16x32_bf16 v[200:203], v[152:155], v[160:163], 0
    v_mfma_f32_16x16x32_bf16 v[204:207], v[152:155], v[164:167], 0
    v_mfma_f32_16x16x32_bf16 v[176:179], v[132:135], v[168:171], v[176:179]
    v_mfma_f32_16x16x32_bf16 v[180:183], v[132:135], v[172:175], v[180:183]
    v_mfma_f32_16x16x32_bf16 v[184:187], v[140:143], v[168:171], v[184:187]
    v_mfma_f32_16x16x32_bf16 v[188:191], v[140:143], v[172:175], v[188:191]
    v_mfma_f32_16x16x32_bf16 v[192:195], v[148:151], v[168:171], v[192:195]
    v_mfma_f32_16x16x32_bf16 v[196:199], v[148:151], v[172:175], v[196:199]
    v_mfma_f32_16x16x32_bf16 v[200:203], v[156:159], v[168:171], v[200:203]
    v_mfma_f32_16x16x32_bf16 v[204:207], v[156:159], v[172:175], v[204:207]
    v_perm_b32 v160, v7, v3, s30
    v_perm_b32 v161, v15, v11, s30
    v_perm_b32 v162, v23, v19, s30
    v_perm_b32 v163, v31, v27, s30
    v_perm_b32 v164, v7, v3, s31
    v_perm_b32 v165, v15, v11, s31
    v_perm_b32 v166, v23, v19, s31
    v_perm_b32 v167, v31, v27, s31
    v_perm_b32 v168, v39, v35, s30
    v_perm_b32 v169, v47, v43, s30
    v_perm_b32 v170, v55, v51, s30
    v_perm_b32 v171, v63, v59, s30
    v_perm_b32 v172, v39, v35, s31
    v_perm_b32 v173, v47, v43, s31
    v_perm_b32 v174, v55, v51, s31
    v_perm_b32 v175, v63, v59, s31
    v_cvt_pk_bf16_f32 v2, v176, v180
    v_cvt_pk_bf16_f32 v6, v177, v181
    v_cvt_pk_bf16_f32 v10, v178, v182
    v_cvt_pk_bf16_f32 v14, v179, v183
    v_cvt_pk_bf16_f32 v18, v184, v188
    v_cvt_pk_bf16_f32 v22, v185, v189
    v_cvt_pk_bf16_f32 v26, v186, v190
    v_cvt_pk_bf16_f32 v30, v187, v191
    v_cvt_pk_bf16_f32 v34, v192, v196
    v_cvt_pk_bf16_f32 v38, v193, v197
    v_cvt_pk_bf16_f32 v42, v194, v198
    v_cvt_pk_bf16_f32 v46, v195, v199
    v_cvt_pk_bf16_f32 v50, v200, v204
    v_cvt_pk_bf16_f32 v54, v201, v205
    v_cvt_pk_bf16_f32 v58, v202, v206
    v_cvt_pk_bf16_f32 v62, v203, v207
    v_mfma_f32_16x16x32_bf16 v[176:179], v[128:131], v[160:163], 0
    v_mfma_f32_16x16x32_bf16 v[180:183], v[128:131], v[164:167], 0
    v_mfma_f32_16x16x32_bf16 v[184:187], v[136:139], v[160:163], 0
    v_mfma_f32_16x16x32_bf16 v[188:191], v[136:139], v[164:167], 0
    v_mfma_f32_16x16x32_bf16 v[192:195], v[144:147], v[160:163], 0
    v_mfma_f32_16x16x32_bf16 v[196:199], v[144:147], v[164:167], 0
    v_mfma_f32_16x16x32_bf16 v[200:203], v[152:155], v[160:163], 0
    v_mfma_f32_16x16x32_bf16 v[204:207], v[152:155], v[164:167], 0
    v_mfma_f32_16x16x32_bf16 v[176:179], v[132:135], v[168:171], v[176:179]
    v_mfma_f32_16x16x32_bf16 v[180:183], v[132:135], v[172:175], v[180:183]
    v_mfma_f32_16x16x32_bf16 v[184:187], v[140:143], v[168:171], v[184:187]
    v_mfma_f32_16x16x32_bf16 v[188:191], v[140:143], v[172:175], v[188:191]
    v_mfma_f32_16x16x32_bf16 v[192:195], v[148:151], v[168:171], v[192:195]
    v_mfma_f32_16x16x32_bf16 v[196:199], v[148:151], v[172:175], v[196:199]
    v_mfma_f32_16x16x32_bf16 v[200:203], v[156:159], v[168:171], v[200:203]
    v_mfma_f32_16x16x32_bf16 v[204:207], v[156:159], v[172:175], v[204:207]
    s_nop 1
    v_cvt_pk_bf16_f32 v3, v176, v180
    v_cvt_pk_bf16_f32 v7, v177, v181
    v_cvt_pk_bf16_f32 v11, v178, v182
    v_cvt_pk_bf16_f32 v15, v179, v183
    v_cvt_pk_bf16_f32 v19, v184, v188
    v_cvt_pk_bf16_f32 v23, v185, v189
    v_cvt_pk_bf16_f32 v27, v186, v190
    v_cvt_pk_bf16_f32 v31, v187, v191
    v_cvt_pk_bf16_f32 v35, v192, v196
    v_cvt_pk_bf16_f32 v39, v193, v197
    v_cvt_pk_bf16_f32 v43, v194, v198
    v_cvt_pk_bf16_f32 v47, v195, v199
    v_cvt_pk_bf16_f32 v51, v200, v204
    v_cvt_pk_bf16_f32 v55, v201, v205
    v_cvt_pk_bf16_f32 v59, v202, v206
    v_cvt_pk_bf16_f32 v63, v203, v207
    s_add_u32 s25, s24, 0
    buffer_store_dwordx4 v[0:3], v212, s[16:19], s25 offen sc1
    s_add_u32 s25, s24, 10752
    buffer_store_dwordx4 v[4:7], v212, s[16:19], s25 offen sc1
    s_add_u32 s25, s24, 21504
    buffer_store_dwordx4 v[8:11], v212, s[16:19], s25 offen sc1
    s_add_u32 s25, s24, 32256
    buffer_store_dwordx4 v[12:15], v212, s[16:19], s25 offen sc1
    s_add_u32 s25, s24, 172032
    buffer_store_dwordx4 v[16:19], v212, s[16:19], s25 offen sc1
    s_add_u32 s25, s24, 182784
    buffer_store_dwordx4 v[20:23], v212, s[16:19], s25 offen sc1
    s_add_u32 s25, s24, 193536
    buffer_store_dwordx4 v[24:27], v212, s[16:19], s25 offen sc1
    s_add_u32 s25, s24, 204288
    buffer_store_dwordx4 v[28:31], v212, s[16:19], s25 offen sc1
    s_add_u32 s25, s24, 344064
    buffer_store_dwordx4 v[32:35], v212, s[16:19], s25 offen sc1
    s_add_u32 s25, s24, 354816
    buffer_store_dwordx4 v[36:39], v212, s[16:19], s25 offen sc1
    s_add_u32 s25, s24, 365568
    buffer_store_dwordx4 v[40:43], v212, s[16:19], s25 offen sc1
    s_add_u32 s25, s24, 376320
    buffer_store_dwordx4 v[44:47], v212, s[16:19], s25 offen sc1
    s_add_u32 s25, s24, 516096
    buffer_store_dwordx4 v[48:51], v212, s[16:19], s25 offen sc1
    s_add_u32 s25, s24, 526848
    buffer_store_dwordx4 v[52:55], v212, s[16:19], s25 offen sc1
    s_add_u32 s25, s24, 537600
    buffer_store_dwordx4 v[56:59], v212, s[16:19], s25 offen sc1
    s_add_u32 s25, s24, 548352
    buffer_store_dwordx4 v[60:63], v212, s[16:19], s25 offen sc1
    s_branch L_next0
L_cw0:
    s_sub_u32 s12, s40, 672
    s_and_b32 s13, s12, 3
    s_lshr_b32 s14, s12, 2
    s_lshl_b32 s14, s14, 2
    s_add_u32 s14, s14, s10
    ds_read_b128 v[128:131], v223 offset:8192
    ds_read_b128 v[132:135], v223 offset:9216
    ds_read_b128 v[136:139], v223 offset:10240
    ds_read_b128 v[140:143], v223 offset:11264
    s_and_b32 s24, s14, 3
    s_bfe_u32 s25, s14, 0x10003
    s_lshl_b32 s25, s25, 2
    s_or_b32 s24, s24, s25
    s_lshl_b32 s24, s24, 1
    v_xor_b32 v213, s24, v209
    v_lshl_add_u32 v212, v213, 4, v227
    s_mul_i32 s24, s13, 16777216
    s_lshr_b32 s25, s14, 5
    s_mul_i32 s25, s25, 524288
    s_add_u32 s24, s24, s25
    s_and_b32 s25, s14, 31
    s_lshl_b32 s25, s25, 8
    s_add_u32 s24, s24, s25
    v_perm_b32 v16, v0, v0, s32
    v_perm_b32 v17, v4, v4, s32
    v_perm_b32 v18, v8, v8, s32
    v_perm_b32 v19, v12, v12, s32
    v_perm_b32 v20, v0, v0, s33
    v_perm_b32 v21, v4, v4, s33
    v_perm_b32 v22, v8, v8, s33
    v_perm_b32 v23, v12, v12, s33
    v_perm_b32 v24, v1, v1, s32
    v_perm_b32 v25, v5, v5, s32
    v_perm_b32 v26, v9, v9, s32
    v_perm_b32 v27, v13, v13, s32
    v_perm_b32 v28, v1, v1, s33
    v_perm_b32 v29, v5, v5, s33
    v_perm_b32 v30, v9, v9, s33
    v_perm_b32 v31, v13, v13, s33
    v_perm_b32 v32, v2, v2, s32
    v_perm_b32 v33, v6, v6, s32
    v_perm_b32 v34, v10, v10, s32
    v_perm_b32 v35, v14, v14, s32
    v_perm_b32 v36, v2, v2, s33
    v_perm_b32 v37, v6, v6, s33
    v_perm_b32 v38, v10, v10, s33
    v_perm_b32 v39, v14, v14, s33
    v_perm_b32 v40, v3, v3, s32
    v_perm_b32 v41, v7, v7, s32
    v_perm_b32 v42, v11, v11, s32
    v_perm_b32 v43, v15, v15, s32
    v_perm_b32 v44, v3, v3, s33
    v_perm_b32 v45, v7, v7, s33
    v_perm_b32 v46, v11, v11, s33
    v_perm_b32 v47, v15, v15, s33
    s_waitcnt lgkmcnt(0)
    v_mfma_f32_16x16x32_bf16 v[176:179], v[128:131], v[16:19], 0
    v_mfma_f32_16x16x32_bf16 v[180:183], v[128:131], v[20:23], 0
    v_mfma_f32_16x16x32_bf16 v[184:187], v[128:131], v[24:27], 0
    v_mfma_f32_16x16x32_bf16 v[188:191], v[128:131], v[28:31], 0
    v_mfma_f32_16x16x32_bf16 v[192:195], v[128:131], v[32:35], 0
    v_mfma_f32_16x16x32_bf16 v[196:199], v[128:131], v[36:39], 0
    v_mfma_f32_16x16x32_bf16 v[200:203], v[128:131], v[40:43], 0
    v_mfma_f32_16x16x32_bf16 v[204:207], v[128:131], v[44:47], 0
    s_nop 1
    v_cvt_pk_bf16_f32 v0, v176, v180
    s_nop 0
    v_cvt_pk_bf16_f32 v1, v184, v188
    s_nop 0
    v_cvt_pk_bf16_f32 v2, v192, v196
    s_nop 0
    v_cvt_pk_bf16_f32 v3, v200, v204
    v_cvt_pk_bf16_f32 v4, v177, v181
    v_cvt_pk_bf16_f32 v5, v185, v189
    v_cvt_pk_bf16_f32 v6, v193, v197
    v_cvt_pk_bf16_f32 v7, v201, v205
    v_cvt_pk_bf16_f32 v8, v178, v182
    v_cvt_pk_bf16_f32 v9, v186, v190
    v_cvt_pk_bf16_f32 v10, v194, v198
    v_cvt_pk_bf16_f32 v11, v202, v206
    v_cvt_pk_bf16_f32 v12, v179, v183
    v_cvt_pk_bf16_f32 v13, v187, v191
    v_cvt_pk_bf16_f32 v14, v195, v199
    v_cvt_pk_bf16_f32 v15, v203, v207
    s_add_u32 s25, s24, 0
    buffer_store_dwordx4 v[0:3], v212, s[16:19], s25 offen sc1
    s_add_u32 s25, s24, 8192
    buffer_store_dwordx4 v[4:7], v212, s[16:19], s25 offen sc1
    s_add_u32 s25, s24, 16384
    buffer_store_dwordx4 v[8:11], v212, s[16:19], s25 offen sc1
    s_add_u32 s25, s24, 24576
    buffer_store_dwordx4 v[12:15], v212, s[16:19], s25 offen sc1
    v_mfma_f32_16x16x32_bf16 v[176:179], v[132:135], v[16:19], 0
    v_mfma_f32_16x16x32_bf16 v[180:183], v[132:135], v[20:23], 0
    v_mfma_f32_16x16x32_bf16 v[184:187], v[132:135], v[24:27], 0
    v_mfma_f32_16x16x32_bf16 v[188:191], v[132:135], v[28:31], 0
    v_mfma_f32_16x16x32_bf16 v[192:195], v[132:135], v[32:35], 0
    v_mfma_f32_16x16x32_bf16 v[196:199], v[132:135], v[36:39], 0
    v_mfma_f32_16x16x32_bf16 v[200:203], v[132:135], v[40:43], 0
    v_mfma_f32_16x16x32_bf16 v[204:207], v[132:135], v[44:47], 0
    s_nop 1
    v_cvt_pk_bf16_f32 v48, v176, v180
    s_nop 0
    v_cvt_pk_bf16_f32 v49, v184, v188
    s_nop 0
    v_cvt_pk_bf16_f32 v50, v192, v196
    s_nop 0
    v_cvt_pk_bf16_f32 v51, v200, v204
    v_cvt_pk_bf16_f32 v52, v177, v181
    v_cvt_pk_bf16_f32 v53, v185, v189
    v_cvt_pk_bf16_f32 v54, v193, v197
    v_cvt_pk_bf16_f32 v55, v201, v205
    v_cvt_pk_bf16_f32 v56, v178, v182
    v_cvt_pk_bf16_f32 v57, v186, v190
    v_cvt_pk_bf16_f32 v58, v194, v198
    v_cvt_pk_bf16_f32 v59, v202, v206
    v_cvt_pk_bf16_f32 v60, v179, v183
    v_cvt_pk_bf16_f32 v61, v187, v191
    v_cvt_pk_bf16_f32 v62, v195, v199
    v_cvt_pk_bf16_f32 v63, v203, v207
    s_add_u32 s25, s24, 131072
    buffer_store_dwordx4 v[48:51], v212, s[16:19], s25 offen sc1
    s_add_u32 s25, s24, 139264
    buffer_store_dwordx4 v[52:55], v212, s[16:19], s25 offen sc1
    s_add_u32 s25, s24, 147456
    buffer_store_dwordx4 v[56:59], v212, s[16:19], s25 offen sc1
    s_add_u32 s25, s24, 155648
    buffer_store_dwordx4 v[60:63], v212, s[16:19], s25 offen sc1
    v_mfma_f32_16x16x32_bf16 v[176:179], v[136:139], v[16:19], 0
    v_mfma_f32_16x16x32_bf16 v[180:183], v[136:139], v[20:23], 0
    v_mfma_f32_16x16x32_bf16 v[184:187], v[136:139], v[24:27], 0
    v_mfma_f32_16x16x32_bf16 v[188:191], v[136:139], v[28:31], 0
    v_mfma_f32_16x16x32_bf16 v[192:195], v[136:139], v[32:35], 0
    v_mfma_f32_16x16x32_bf16 v[196:199], v[136:139], v[36:39], 0
    v_mfma_f32_16x16x32_bf16 v[200:203], v[136:139], v[40:43], 0
    v_mfma_f32_16x16x32_bf16 v[204:207], v[136:139], v[44:47], 0
    s_nop 1
    v_cvt_pk_bf16_f32 v0, v176, v180
    s_nop 0
    v_cvt_pk_bf16_f32 v1, v184, v188
    s_nop 0
    v_cvt_pk_bf16_f32 v2, v192, v196
    s_nop 0
    v_cvt_pk_bf16_f32 v3, v200, v204
    v_cvt_pk_bf16_f32 v4, v177, v181
    v_cvt_pk_bf16_f32 v5, v185, v189
    v_cvt_pk_bf16_f32 v6, v193, v197
    v_cvt_pk_bf16_f32 v7, v201, v205
    v_cvt_pk_bf16_f32 v8, v178, v182
    v_cvt_pk_bf16_f32 v9, v186, v190
    v_cvt_pk_bf16_f32 v10, v194, v198
    v_cvt_pk_bf16_f32 v11, v202, v206
    v_cvt_pk_bf16_f32 v12, v179, v183
    v_cvt_pk_bf16_f32 v13, v187, v191
    v_cvt_pk_bf16_f32 v14, v195, v199
    v_cvt_pk_bf16_f32 v15, v203, v207
    s_add_u32 s25, s24, 262144
    buffer_store_dwordx4 v[0:3], v212, s[16:19], s25 offen sc1
    s_add_u32 s25, s24, 270336
    buffer_store_dwordx4 v[4:7], v212, s[16:19], s25 offen sc1
    s_add_u32 s25, s24, 278528
    buffer_store_dwordx4 v[8:11], v212, s[16:19], s25 offen sc1
    s_add_u32 s25, s24, 286720
    buffer_store_dwordx4 v[12:15], v212, s[16:19], s25 offen sc1
    v_mfma_f32_16x16x32_bf16 v[176:179], v[140:143], v[16:19], 0
    v_mfma_f32_16x16x32_bf16 v[180:183], v[140:143], v[20:23], 0
    v_mfma_f32_16x16x32_bf16 v[184:187], v[140:143], v[24:27], 0
    v_mfma_f32_16x16x32_bf16 v[188:191], v[140:143], v[28:31], 0
    v_mfma_f32_16x16x32_bf16 v[192:195], v[140:143], v[32:35], 0
    v_mfma_f32_16x16x32_bf16 v[196:199], v[140:143], v[36:39], 0
    v_mfma_f32_16x16x32_bf16 v[200:203], v[140:143], v[40:43], 0
    v_mfma_f32_16x16x32_bf16 v[204:207], v[140:143], v[44:47], 0
    s_nop 1
    v_cvt_pk_bf16_f32 v48, v176, v180
    s_nop 0
    v_cvt_pk_bf16_f32 v49, v184, v188
    s_nop 0
    v_cvt_pk_bf16_f32 v50, v192, v196
    s_nop 0
    v_cvt_pk_bf16_f32 v51, v200, v204
    v_cvt_pk_bf16_f32 v52, v177, v181
    v_cvt_pk_bf16_f32 v53, v185, v189
    v_cvt_pk_bf16_f32 v54, v193, v197
    v_cvt_pk_bf16_f32 v55, v201, v205
    v_cvt_pk_bf16_f32 v56, v178, v182
    v_cvt_pk_bf16_f32 v57, v186, v190
    v_cvt_pk_bf16_f32 v58, v194, v198
    v_cvt_pk_bf16_f32 v59, v202, v206
    v_cvt_pk_bf16_f32 v60, v179, v183
    v_cvt_pk_bf16_f32 v61, v187, v191
    v_cvt_pk_bf16_f32 v62, v195, v199
    v_cvt_pk_bf16_f32 v63, v203, v207
    s_add_u32 s25, s24, 393216
    buffer_store_dwordx4 v[48:51], v212, s[16:19], s25 offen sc1
    s_add_u32 s25, s24, 401408
    buffer_store_dwordx4 v[52:55], v212, s[16:19], s25 offen sc1
    s_add_u32 s25, s24, 409600
    buffer_store_dwordx4 v[56:59], v212, s[16:19], s25 offen sc1
    s_add_u32 s25, s24, 417792
    buffer_store_dwordx4 v[60:63], v212, s[16:19], s25 offen sc1
L_next0:
    s_cmp_lg_u32 s10, 0
    s_cbranch_scc1 L_pub0
    s_cmp_ge_u32 s42, 1696
    s_cbranch_scc1 L_w0_p0
    s_cmp_ge_u32 s42, 672
    s_cbranch_scc1 L_w8_p0
    s_waitcnt vmcnt(32)
    s_branch L_wd_p0
L_w8_p0:
    s_waitcnt vmcnt(24)
    s_branch L_wd_p0
L_w0_p0:
    s_waitcnt vmcnt(16)
L_wd_p0:
    v_add_u32 v221, 512, v221
    v_mov_b32 v213, s41
    s_mov_b64 exec, 1
    ds_write_b32 v213, v221 offset:12288
    s_mov_b64 exec, -1
L_pub0:
    s_waitcnt lgkmcnt(0)
    s_barrier
    v_mov_b32 v213, s41
    ds_read_b32 v214, v213 offset:12288
    s_xor_b32 s41, s41, 4
    s_mov_b32 s40, s42
    s_waitcnt lgkmcnt(0)
    v_readfirstlane_b32 s42, v214
    s_cmp_ge_u32 s40, 1696
    s_cbranch_scc1 L_k12_end
    s_cmp_lg_u32 s10, 0
    s_cbranch_scc1 L_nofetch1
    v_mov_b32 v221, 1
    s_mov_b64 exec, 1
    buffer_atomic_add v221, v222, s[44:47], 0 offen sc0 sc1
    s_mov_b64 exec, -1
L_nofetch1:
    s_cmp_ge_u32 s42, 1696
    s_cbranch_scc1 L_ld_done2
    s_cmp_ge_u32 s42, 672
    s_cbranch_scc1 L_ld_w2
    s_cmp_ge_u32 s42, 336
    s_cselect_b32 s11, 1, 0
    s_mul_i32 s12, s11, 336
    s_sub_u32 s12, s42, s12
    s_and_b32 s13, s12, 7
    s_lshr_b32 s14, s12, 3
    s_lshl_b32 s14, s14, 2
    s_add_u32 s14, s14, s10
    s_mul_i32 s15, s11, 16384000
    s_add_u32 s34, s4, s15
    s_addc_u32 s35, s5, 0
    s_mov_b32 s20, s34
    s_and_b32 s21, s35, 0xffff
    s_mov_b32 s22, 16384000
    s_mov_b32 s23, 0x00020000
    s_mul_i32 s15, s14, 98304
    s_lshl_b32 s24, s13, 8
    s_add_u32 s15, s15, s24
    s_add_u32 s25, s15, 0
    buffer_load_dwordx4 v[0:3], v224, s[20:23], s25 offen
    s_add_u32 s25, s15, 2048
    buffer_load_dwordx4 v[4:7], v224, s[20:23], s25 offen
    s_add_u32 s25, s15, 4096
    buffer_load_dwordx4 v[8:11], v224, s[20:23], s25 offen
    s_add_u32 s25, s15, 6144
    buffer_load_dwordx4 v[12:15], v224, s[20:23], s25 offen
    s_add_u32 s25, s15, 8192
    buffer_load_dwordx4 v[16:19], v224, s[20:23], s25 offen
    s_add_u32 s25, s15, 10240
    buffer_load_dwordx4 v[20:23], v224, s[20:23], s25 offen
    s_add_u32 s25, s15, 12288
    buffer_load_dwordx4 v[24:27], v224, s[20:23], s25 offen
    s_add_u32 s25, s15, 14336
    buffer_load_dwordx4 v[28:31], v224, s[20:23], s25 offen
    s_add_u32 s25, s15, 65536
    buffer_load_dwordx4 v[32:35], v224, s[20:23], s25 offen
    s_add_u32 s25, s15, 67584
    buffer_load_dwordx4 v[36:39], v224, s[20:23], s25 offen
    s_add_u32 s25, s15, 69632
    buffer_load_dwordx4 v[40:43], v224, s[20:23], s25 offen
    s_add_u32 s25, s15, 71680
    buffer_load_dwordx4 v[44:47], v224, s[20:23], s25 offen
    s_add_u32 s25, s15, 73728
    buffer_load_dwordx4 v[48:51], v224, s[20:23], s25 offen
    s_add_u32 s25, s15, 75776
    buffer_load_dwordx4 v[52:55], v224, s[20:23], s25 offen
    s_add_u32 s25, s15, 77824
    buffer_load_dwordx4 v[56:59], v224, s[20:23], s25 offen
    s_add_u32 s25, s15, 79872
    buffer_load_dwordx4 v[60:63], v224, s[20:23], s25 offen
    s_branch L_ld_done2
L_ld_w2:
    s_sub_u32 s12, s42, 672
    s_and_b32 s13, s12, 3
    s_lshr_b32 s14, s12, 2
    s_lshl_b32 s14, s14, 2
    s_add_u32 s14, s14, s10
    s_mov_b32 s20, s6
    s_and_b32 s21, s7, 0xffff
    s_mov_b32 s22, 16252928
    s_mov_b32 s23, 0x00020000
    s_lshl_b32 s15, s14, 10
    s_lshl_b32 s24, s13, 8
    s_add_u32 s15, s15, s24
    s_add_u32 s25, s15, 0
    buffer_load_dwordx2 v[0:1], v225, s[20:23], s25 offen
    buffer_load_dwordx2 v[2:3], v225, s[20:23], s25 offen offset:16
    s_add_u32 s25, s15, 1048576
    buffer_load_dwordx2 v[4:5], v225, s[20:23], s25 offen
    buffer_load_dwordx2 v[6:7], v225, s[20:23], s25 offen offset:16
    s_add_u32 s25, s15, 2097152
    buffer_load_dwordx2 v[8:9], v225, s[20:23], s25 offen
    buffer_load_dwordx2 v[10:11], v225, s[20:23], s25 offen offset:16
    s_add_u32 s25, s15, 3145728
    buffer_load_dwordx2 v[12:13], v225, s[20:23], s25 offen
    buffer_load_dwordx2 v[14:15], v225, s[20:23], s25 offen offset:16
L_ld_done2:
    s_cmp_ge_u32 s42, 1696
    s_cbranch_scc1 L_w0_a1
    s_cmp_ge_u32 s42, 672
    s_cbranch_scc1 L_w8_a1
    s_waitcnt vmcnt(32)
    s_branch L_wd_a1
L_w8_a1:
    s_waitcnt vmcnt(24)
    s_branch L_wd_a1
L_w0_a1:
    s_waitcnt vmcnt(16)
L_wd_a1:
    s_cmp_ge_u32 s40, 672
    s_cbranch_scc1 L_cw1
    s_cmp_ge_u32 s40, 336
    s_cselect_b32 s11, 1, 0
    s_mul_i32 s12, s11, 336
    s_sub_u32 s12, s40, s12
    s_and_b32 s13, s12, 7
    s_lshr_b32 s14, s12, 3
    s_lshl_b32 s14, s14, 2
    s_add_u32 s14, s14, s10
    ds_read_b128 v[128:131], v223 offset:0
    ds_read_b128 v[132:135], v223 offset:1024
    ds_read_b128 v[136:139], v223 offset:2048
    ds_read_b128 v[140:143], v223 offset:3072
    ds_read_b128 v[144:147], v223 offset:4096
    ds_read_b128 v[148:151], v223 offset:5120
    ds_read_b128 v[152:155], v223 offset:6144
    ds_read_b128 v[156:159], v223 offset:7168
    s_bfe_u32 s24, s14, 0x10003
    s_mul_i32 s24, s24, 3
    v_and_b32 v213, 3, v209
    v_xor_b32 v213, s24, v213
    v_lshl_add_u32 v212, v213, 4, v226
    s_mul_i32 s24, s11, 22020096
    s_mul_i32 s25, s13, 2752512
    s_add_u32 s24, s24, s25
    s_lshl_b32 s25, s14, 6
    s_add_u32 s24, s24, s25
    s_add_u32 s24, s24, 67108864
    v_perm_b32 v160, v68, v64, s30
    v_perm_b32 v161, v76, v72, s30
    v_perm_b32 v162, v84, v80, s30
    v_perm_b32 v163, v92, v88, s30
    v_perm_b32 v164, v68, v64, s31
    v_perm_b32 v165, v76, v72, s31
    v_perm_b32 v166, v84, v80, s31
    v_perm_b32 v167, v92, v88, s31
    v_perm_b32 v168, v100, v96, s30
    v_perm_b32 v169, v108, v104, s30
    v_perm_b32 v170, v116, v112, s30
    v_perm_b32 v171, v124, v120, s30
    v_perm_b32 v172, v100, v96, s31
    v_perm_b32 v173, v108, v104, s31
    v_perm_b32 v174, v116, v112, s31
    v_perm_b32 v175, v124, v120, s31
    s_waitcnt lgkmcnt(0)
    v_mfma_f32_16x16x32_bf16 v[176:179], v[128:131], v[160:163], 0
    v_mfma_f32_16x16x32_bf16 v[180:183], v[128:131], v[164:167], 0
    v_mfma_f32_16x16x32_bf16 v[184:187], v[136:139], v[160:163], 0
    v_mfma_f32_16x16x32_bf16 v[188:191], v[136:139], v[164:167], 0
    v_mfma_f32_16x16x32_bf16 v[192:195], v[144:147], v[160:163], 0
    v_mfma_f32_16x16x32_bf16 v[196:199], v[144:147], v[164:167], 0
    v_mfma_f32_16x16x32_bf16 v[200:203], v[152:155], v[160:163], 0
    v_mfma_f32_16x16x32_bf16 v[204:207], v[152:155], v[164:167], 0
    v_mfma_f32_16x16x32_bf16 v[176:179], v[132:135], v[168:171], v[176:179]
    v_mfma_f32_16x16x32_bf16 v[180:183], v[132:135], v[172:175], v[180:183]
    v_mfma_f32_16x16x32_bf16 v[184:187], v[140:143], v[168:171], v[184:187]
    v_mfma_f32_16x16x32_bf16 v[188:191], v[140:143], v[172:175], v[188:191]
    v_mfma_f32_16x16x32_bf16 v[192:195], v[148:151], v[168:171], v[192:195]
    v_mfma_f32_16x16x32_bf16 v[196:199], v[148:151], v[172:175], v[196:199]
    v_mfma_f32_16x16x32_bf16 v[200:203], v[156:159], v[168:171], v[200:203]
    v_mfma_f32_16x16x32_bf16 v[204:207], v[156:159], v[172:175], v[204:207]
    v_perm_b32 v160, v69, v65, s30
    v_perm_b32 v161, v77, v73, s30
    v_perm_b32 v162, v85, v81, s30
    v_perm_b32 v163, v93, v89, s30
    v_perm_b32 v164, v69, v65, s31
    v_perm_b32 v165, v77, v73, s31
    v_perm_b32 v166, v85, v81, s31
    v_perm_b32 v167, v93, v89, s31
    v_perm_b32 v168, v101, v97, s30
    v_perm_b32 v169, v109, v105, s30
    v_perm_b32 v170, v117, v113, s30
    v_perm_b32 v171, v125, v121, s30
    v_perm_b32 v172, v101, v97, s31
    v_perm_b32 v173, v109, v105, s31
    v_perm_b32 v174, v117, v113, s31
    v_perm_b32 v175, v125, v121, s31
    v_cvt_pk_bf16_f32 v64, v176, v180
    v_cvt_pk_bf16_f32 v68, v177, v181
    v_cvt_pk_bf16_f32 v72, v178, v182
    v_cvt_pk_bf16_f32 v76, v179, v183
    v_cvt_pk_bf16_f32 v80, v184, v188
    v_cvt_pk_bf16_f32 v84, v185, v189
    v_cvt_pk_bf16_f32 v88, v186, v190
    v_cvt_pk_bf16_f32 v92, v187, v191
    v_cvt_pk_bf16_f32 v96, v192, v196
    v_cvt_pk_bf16_f32 v100, v193, v197
    v_cvt_pk_bf16_f32 v104, v194, v198
    v_cvt_pk_bf16_f32 v108, v195, v199
    v_cvt_pk_bf16_f32 v112, v200, v204
    v_cvt_pk_bf16_f32 v116, v201, v205
    v_cvt_pk_bf16_f32 v120, v202, v206
    v_cvt_pk_bf16_f32 v124, v203, v207
    v_mfma_f32_16x16x32_bf16 v[176:179], v[128:131], v[160:163], 0
    v_mfma_f32_16x16x32_bf16 v[180:183], v[128:131], v[164:167], 0
    v_mfma_f32_16x16x32_bf16 v[184:187], v[136:139], v[160:163], 0
    v_mfma_f32_16x16x32_bf16 v[188:191], v[136:139], v[164:167], 0
    v_mfma_f32_16x16x32_bf16 v[192:195], v[144:147], v[160:163], 0
    v_mfma_f32_16x16x32_bf16 v[196:199], v[144:147], v[164:167], 0
    v_mfma_f32_16x16x32_bf16 v[200:203], v[152:155], v[160:163], 0
    v_mfma_f32_16x16x32_bf16 v[204:207], v[152:155], v[164:167], 0
    v_mfma_f32_16x16x32_bf16 v[176:179], v[132:135], v[168:171], v[176:179]
    v_mfma_f32_16x16x32_bf16 v[180:183], v[132:135], v[172:175], v[180:183]
    v_mfma_f32_16x16x32_bf16 v[184:187], v[140:143], v[168:171], v[184:187]
    v_mfma_f32_16x16x32_bf16 v[188:191], v[140:143], v[172:175], v[188:191]
    v_mfma_f32_16x16x32_bf16 v[192:195], v[148:151], v[168:171], v[192:195]
    v_mfma_f32_16x16x32_bf16 v[196:199], v[148:151], v[172:175], v[196:199]
    v_mfma_f32_16x16x32_bf16 v[200:203], v[156:159], v[168:171], v[200:203]
    v_mfma_f32_16x16x32_bf16 v[204:207], v[156:159], v[172:175], v[204:207]
    v_perm_b32 v160, v70, v66, s30
    v_perm_b32 v161, v78, v74, s30
    v_perm_b32 v162, v86, v82, s30
    v_perm_b32 v163, v94, v90, s30
    v_perm_b32 v164, v70, v66, s31
    v_perm_b32 v165, v78, v74, s31
    v_perm_b32 v166, v86, v82, s31
    v_perm_b32 v167, v94, v90, s31
    v_perm_b32 v168, v102, v98, s30
    v_perm_b32 v169, v110, v106, s30
    v_perm_b32 v170, v118, v114, s30
    v_perm_b32 v171, v126, v122, s30
    v_perm_b32 v172, v102, v98, s31
    v_perm_b32 v173, v110, v106, s31
    v_perm_b32 v174, v118, v114, s31
    v_perm_b32 v175, v126, v122, s31
    v_cvt_pk_bf16_f32 v65, v176, v180
    v_cvt_pk_bf16_f32 v69, v177, v181
    v_cvt_pk_bf16_f32 v73, v178, v182
    v_cvt_pk_bf16_f32 v77, v179, v183
    v_cvt_pk_bf16_f32 v81, v184, v188
    v_cvt_pk_bf16_f32 v85, v185, v189
    v_cvt_pk_bf16_f32 v89, v186, v190
    v_cvt_pk_bf16_f32 v93, v187, v191
    v_cvt_pk_bf16_f32 v97, v192, v196
    v_cvt_pk_bf16_f32 v101, v193, v197
    v_cvt_pk_bf16_f32 v105, v194, v198
    v_cvt_pk_bf16_f32 v109, v195, v199
    v_cvt_pk_bf16_f32 v113, v200, v204
    v_cvt_pk_bf16_f32 v117, v201, v205
    v_cvt_pk_bf16_f32 v121, v202, v206
    v_cvt_pk_bf16_f32 v125, v203, v207
    v_mfma_f32_16x16x32_bf16 v[176:179], v[128:131], v[160:163], 0
    v_mfma_f32_16x16x32_bf16 v[180:183], v[128:131], v[164:167], 0
    v_mfma_f32_16x16x32_bf16 v[184:187], v[136:139], v[160:163], 0
    v_mfma_f32_16x16x32_bf16 v[188:191], v[136:139], v[164:167], 0
    v_mfma_f32_16x16x32_bf16 v[192:195], v[144:147], v[160:163], 0
    v_mfma_f32_16x16x32_bf16 v[196:199], v[144:147], v[164:167], 0
    v_mfma_f32_16x16x32_bf16 v[200:203], v[152:155], v[160:163], 0
    v_mfma_f32_16x16x32_bf16 v[204:207], v[152:155], v[164:167], 0
    v_mfma_f32_16x16x32_bf16 v[176:179], v[132:135], v[168:171], v[176:179]
    v_mfma_f32_16x16x32_bf16 v[180:183], v[132:135], v[172:175], v[180:183]
    v_mfma_f32_16x16x32_bf16 v[184:187], v[140:143], v[168:171], v[184:187]
    v_mfma_f32_16x16x32_bf16 v[188:191], v[140:143], v[172:175], v[188:191]
    v_mfma_f32_16x16x32_bf16 v[192:195], v[148:151], v[168:171], v[192:195]
    v_mfma_f32_16x16x32_bf16 v[196:199], v[148:151], v[172:175], v[196:199]
    v_mfma_f32_16x16x32_bf16 v[200:203], v[156:159], v[168:171], v[200:203]
    v_mfma_f32_16x16x32_bf16 v[204:207], v[156:159], v[172:175], v[204:207]
    v_perm_b32 v160, v71, v67, s30
    v_perm_b32 v161, v79, v75, s30
    v_perm_b32 v162, v87, v83, s30
    v_perm_b32 v163, v95, v91, s30
    v_perm_b32 v164, v71, v67, s31
    v_perm_b32 v165, v79, v75, s31
    v_perm_b32 v166, v87, v83, s31
    v_perm_b32 v167, v95, v91, s31
    v_perm_b32 v168, v103, v99, s30
    v_perm_b32 v169, v111, v107, s30
    v_perm_b32 v170, v119, v115, s30
    v_perm_b32 v171, v127, v123, s30
    v_perm_b32 v172, v103, v99, s31
    v_perm_b32 v173, v111, v107, s31
    v_perm_b32 v174, v119, v115, s31
    v_perm_b32 v175, v127, v123, s31
    v_cvt_pk_bf16_f32 v66, v176, v180
    v_cvt_pk_bf16_f32 v70, v177, v181
    v_cvt_pk_bf16_f32 v74, v178, v182
    v_cvt_pk_bf16_f32 v78, v179, v183
    v_cvt_pk_bf16_f32 v82, v184, v188
    v_cvt_pk_bf16_f32 v86, v185, v189
    v_cvt_pk_bf16_f32 v90, v186, v190
    v_cvt_pk_bf16_f32 v94, v187, v191
    v_cvt_pk_bf16_f32 v98, v192, v196
    v_cvt_pk_bf16_f32 v102, v193, v197
    v_cvt_pk_bf16_f32 v106, v194, v198
    v_cvt_pk_bf16_f32 v110, v195, v199
    v_cvt_pk_bf16_f32 v114, v200, v204
    v_cvt_pk_bf16_f32 v118, v201, v205
    v_cvt_pk_bf16_f32 v122, v202, v206
    v_cvt_pk_bf16_f32 v126, v203, v207
    v_mfma_f32_16x16x32_bf16 v[176:179], v[128:131], v[160:163], 0
    v_mfma_f32_16x16x32_bf16 v[180:183], v[128:131], v[164:167], 0
    v_mfma_f32_16x16x32_bf16 v[184:187], v[136:139], v[160:163], 0
    v_mfma_f32_16x16x32_bf16 v[188:191], v[136:139], v[164:167], 0
    v_mfma_f32_16x16x32_bf16 v[192:195], v[144:147], v[160:163], 0
    v_mfma_f32_16x16x32_bf16 v[196:199], v[144:147], v[164:167], 0
    v_mfma_f32_16x16x32_bf16 v[200:203], v[152:155], v[160:163], 0
    v_mfma_f32_16x16x32_bf16 v[204:207], v[152:155], v[164:167], 0
    v_mfma_f32_16x16x32_bf16 v[176:179], v[132:135], v[168:171], v[176:179]
    v_mfma_f32_16x16x32_bf16 v[180:183], v[132:135], v[172:175], v[180:183]
    v_mfma_f32_16x16x32_bf16 v[184:187], v[140:143], v[168:171], v[184:187]
    v_mfma_f32_16x16x32_bf16 v[188:191], v[140:143], v[172:175], v[188:191]
    v_mfma_f32_16x16x32_bf16 v[192:195], v[148:151], v[168:171], v[192:195]
    v_mfma_f32_16x16x32_bf16 v[196:199], v[148:151], v[172:175], v[196:199]
    v_mfma_f32_16x16x32_bf16 v[200:203], v[156:159], v[168:171], v[200:203]
    v_mfma_f32_16x16x32_bf16 v[204:207], v[156:159], v[172:175], v[204:207]
    s_nop 1
    v_cvt_pk_bf16_f32 v67, v176, v180
    v_cvt_pk_bf16_f32 v71, v177, v181
    v_cvt_pk_bf16_f32 v75, v178, v182
    v_cvt_pk_bf16_f32 v79, v179, v183
    v_cvt_pk_bf16_f32 v83, v184, v188
    v_cvt_pk_bf16_f32 v87, v185, v189
    v_cvt_pk_bf16_f32 v91, v186, v190
    v_cvt_pk_bf16_f32 v95, v187, v191
    v_cvt_pk_bf16_f32 v99, v192, v196
    v_cvt_pk_bf16_f32 v103, v193, v197
    v_cvt_pk_bf16_f32 v107, v194, v198
    v_cvt_pk_bf16_f32 v111, v195, v199
    v_cvt_pk_bf16_f32 v115, v200, v204
    v_cvt_pk_bf16_f32 v119, v201, v205
    v_cvt_pk_bf16_f32 v123, v202, v206
    v_cvt_pk_bf16_f32 v127, v203, v207
    s_add_u32 s25, s24, 0
    buffer_store_dwordx4 v[64:67], v212, s[16:19], s25 offen sc1
    s_add_u32 s25, s24, 10752
    buffer_store_dwordx4 v[68:71], v212, s[16:19], s25 offen sc1
    s_add_u32 s25, s24, 21504
    buffer_store_dwordx4 v[72:75], v212, s[16:19], s25 offen sc1
    s_add_u32 s25, s24, 32256
    buffer_store_dwordx4 v[76:79], v212, s[16:19], s25 offen sc1
    s_add_u32 s25, s24, 172032
    buffer_store_dwordx4 v[80:83], v212, s[16:19], s25 offen sc1
    s_add_u32 s25, s24, 182784
    buffer_store_dwordx4 v[84:87], v212, s[16:19], s25 offen sc1
    s_add_u32 s25, s24, 193536
    buffer_store_dwordx4 v[88:91], v212, s[16:19], s25 offen sc1
    s_add_u32 s25, s24, 204288
    buffer_store_dwordx4 v[92:95], v212, s[16:19], s25 offen sc1
    s_add_u32 s25, s24, 344064
    buffer_store_dwordx4 v[96:99], v212, s[16:19], s25 offen sc1
    s_add_u32 s25, s24, 354816
    buffer_store_dwordx4 v[100:103], v212, s[16:19], s25 offen sc1
    s_add_u32 s25, s24, 365568
    buffer_store_dwordx4 v[104:107], v212, s[16:19], s25 offen sc1
    s_add_u32 s25, s24, 376320
    buffer_store_dwordx4 v[108:111], v212, s[16:19], s25 offen sc1
    s_add_u32 s25, s24, 516096
    buffer_store_dwordx4 v[112:115], v212, s[16:19], s25 offen sc1
    s_add_u32 s25, s24, 526848
    buffer_store_dwordx4 v[116:119], v212, s[16:19], s25 offen sc1
    s_add_u32 s25, s24, 537600
    buffer_store_dwordx4 v[120:123], v212, s[16:19], s25 offen sc1
    s_add_u32 s25, s24, 548352
    buffer_store_dwordx4 v[124:127], v212, s[16:19], s25 offen sc1
    s_branch L_next1
L_cw1:
    s_sub_u32 s12, s40, 672
    s_and_b32 s13, s12, 3
    s_lshr_b32 s14, s12, 2
    s_lshl_b32 s14, s14, 2
    s_add_u32 s14, s14, s10
    ds_read_b128 v[128:131], v223 offset:8192
    ds_read_b128 v[132:135], v223 offset:9216
    ds_read_b128 v[136:139], v223 offset:10240
    ds_read_b128 v[140:143], v223 offset:11264
    s_and_b32 s24, s14, 3
    s_bfe_u32 s25, s14, 0x10003
    s_lshl_b32 s25, s25, 2
    s_or_b32 s24, s24, s25
    s_lshl_b32 s24, s24, 1
    v_xor_b32 v213, s24, v209
    v_lshl_add_u32 v212, v213, 4, v227
    s_mul_i32 s24, s13, 16777216
    s_lshr_b32 s25, s14, 5
    s_mul_i32 s25, s25, 524288
    s_add_u32 s24, s24, s25
    s_and_b32 s25, s14, 31
    s_lshl_b32 s25, s25, 8
    s_add_u32 s24, s24, s25
    v_perm_b32 v80, v64, v64, s32
    v_perm_b32 v81, v68, v68, s32
    v_perm_b32 v82, v72, v72, s32
    v_perm_b32 v83, v76, v76, s32
    v_perm_b32 v84, v64, v64, s33
    v_perm_b32 v85, v68, v68, s33
    v_perm_b32 v86, v72, v72, s33
    v_perm_b32 v87, v76, v76, s33
    v_perm_b32 v88, v65, v65, s32
    v_perm_b32 v89, v69, v69, s32
    v_perm_b32 v90, v73, v73, s32
    v_perm_b32 v91, v77, v77, s32
    v_perm_b32 v92, v65, v65, s33
    v_perm_b32 v93, v69, v69, s33
    v_perm_b32 v94, v73, v73, s33
    v_perm_b32 v95, v77, v77, s33
    v_perm_b32 v96, v66, v66, s32
    v_perm_b32 v97, v70, v70, s32
    v_perm_b32 v98, v74, v74, s32
    v_perm_b32 v99, v78, v78, s32
    v_perm_b32 v100, v66, v66, s33
    v_perm_b32 v101, v70, v70, s33
    v_perm_b32 v102, v74, v74, s33
    v_perm_b32 v103, v78, v78, s33
    v_perm_b32 v104, v67, v67, s32
    v_perm_b32 v105, v71, v71, s32
    v_perm_b32 v106, v75, v75, s32
    v_perm_b32 v107, v79, v79, s32
    v_perm_b32 v108, v67, v67, s33
    v_perm_b32 v109, v71, v71, s33
    v_perm_b32 v110, v75, v75, s33
    v_perm_b32 v111, v79, v79, s33
    s_waitcnt lgkmcnt(0)
    v_mfma_f32_16x16x32_bf16 v[176:179], v[128:131], v[80:83], 0
    v_mfma_f32_16x16x32_bf16 v[180:183], v[128:131], v[84:87], 0
    v_mfma_f32_16x16x32_bf16 v[184:187], v[128:131], v[88:91], 0
    v_mfma_f32_16x16x32_bf16 v[188:191], v[128:131], v[92:95], 0
    v_mfma_f32_16x16x32_bf16 v[192:195], v[128:131], v[96:99], 0
    v_mfma_f32_16x16x32_bf16 v[196:199], v[128:131], v[100:103], 0
    v_mfma_f32_16x16x32_bf16 v[200:203], v[128:131], v[104:107], 0
    v_mfma_f32_16x16x32_bf16 v[204:207], v[128:131], v[108:111], 0
    s_nop 1
    v_cvt_pk_bf16_f32 v64, v176, v180
    s_nop 0
    v_cvt_pk_bf16_f32 v65, v184, v188
    s_nop 0
    v_cvt_pk_bf16_f32 v66, v192, v196
    s_nop 0
    v_cvt_pk_bf16_f32 v67, v200, v204
    v_cvt_pk_bf16_f32 v68, v177, v181
    v_cvt_pk_bf16_f32 v69, v185, v189
    v_cvt_pk_bf16_f32 v70, v193, v197
    v_cvt_pk_bf16_f32 v71, v201, v205
    v_cvt_pk_bf16_f32 v72, v178, v182
    v_cvt_pk_bf16_f32 v73, v186, v190
    v_cvt_pk_bf16_f32 v74, v194, v198
    v_cvt_pk_bf16_f32 v75, v202, v206
    v_cvt_pk_bf16_f32 v76, v179, v183
    v_cvt_pk_bf16_f32 v77, v187, v191
    v_cvt_pk_bf16_f32 v78, v195, v199
    v_cvt_pk_bf16_f32 v79, v203, v207
    s_add_u32 s25, s24, 0
    buffer_store_dwordx4 v[64:67], v212, s[16:19], s25 offen sc1
    s_add_u32 s25, s24, 8192
    buffer_store_dwordx4 v[68:71], v212, s[16:19], s25 offen sc1
    s_add_u32 s25, s24, 16384
    buffer_store_dwordx4 v[72:75], v212, s[16:19], s25 offen sc1
    s_add_u32 s25, s24, 24576
    buffer_store_dwordx4 v[76:79], v212, s[16:19], s25 offen sc1
    v_mfma_f32_16x16x32_bf16 v[176:179], v[132:135], v[80:83], 0
    v_mfma_f32_16x16x32_bf16 v[180:183], v[132:135], v[84:87], 0
    v_mfma_f32_16x16x32_bf16 v[184:187], v[132:135], v[88:91], 0
    v_mfma_f32_16x16x32_bf16 v[188:191], v[132:135], v[92:95], 0
    v_mfma_f32_16x16x32_bf16 v[192:195], v[132:135], v[96:99], 0
    v_mfma_f32_16x16x32_bf16 v[196:199], v[132:135], v[100:103], 0
    v_mfma_f32_16x16x32_bf16 v[200:203], v[132:135], v[104:107], 0
    v_mfma_f32_16x16x32_bf16 v[204:207], v[132:135], v[108:111], 0
    s_nop 1
    v_cvt_pk_bf16_f32 v112, v176, v180
    s_nop 0
    v_cvt_pk_bf16_f32 v113, v184, v188
    s_nop 0
    v_cvt_pk_bf16_f32 v114, v192, v196
    s_nop 0
    v_cvt_pk_bf16_f32 v115, v200, v204
    v_cvt_pk_bf16_f32 v116, v177, v181
    v_cvt_pk_bf16_f32 v117, v185, v189
    v_cvt_pk_bf16_f32 v118, v193, v197
    v_cvt_pk_bf16_f32 v119, v201, v205
    v_cvt_pk_bf16_f32 v120, v178, v182
    v_cvt_pk_bf16_f32 v121, v186, v190
    v_cvt_pk_bf16_f32 v122, v194, v198
    v_cvt_pk_bf16_f32 v123, v202, v206
    v_cvt_pk_bf16_f32 v124, v179, v183
    v_cvt_pk_bf16_f32 v125, v187, v191
    v_cvt_pk_bf16_f32 v126, v195, v199
    v_cvt_pk_bf16_f32 v127, v203, v207
    s_add_u32 s25, s24, 131072
    buffer_store_dwordx4 v[112:115], v212, s[16:19], s25 offen sc1
    s_add_u32 s25, s24, 139264
    buffer_store_dwordx4 v[116:119], v212, s[16:19], s25 offen sc1
    s_add_u32 s25, s24, 147456
    buffer_store_dwordx4 v[120:123], v212, s[16:19], s25 offen sc1
    s_add_u32 s25, s24, 155648
    buffer_store_dwordx4 v[124:127], v212, s[16:19], s25 offen sc1
    v_mfma_f32_16x16x32_bf16 v[176:179], v[136:139], v[80:83], 0
    v_mfma_f32_16x16x32_bf16 v[180:183], v[136:139], v[84:87], 0
    v_mfma_f32_16x16x32_bf16 v[184:187], v[136:139], v[88:91], 0
    v_mfma_f32_16x16x32_bf16 v[188:191], v[136:139], v[92:95], 0
    v_mfma_f32_16x16x32_bf16 v[192:195], v[136:139], v[96:99], 0
    v_mfma_f32_16x16x32_bf16 v[196:199], v[136:139], v[100:103], 0
    v_mfma_f32_16x16x32_bf16 v[200:203], v[136:139], v[104:107], 0
    v_mfma_f32_16x16x32_bf16 v[204:207], v[136:139], v[108:111], 0
    s_nop 1
    v_cvt_pk_bf16_f32 v64, v176, v180
    s_nop 0
    v_cvt_pk_bf16_f32 v65, v184, v188
    s_nop 0
    v_cvt_pk_bf16_f32 v66, v192, v196
    s_nop 0
    v_cvt_pk_bf16_f32 v67, v200, v204
    v_cvt_pk_bf16_f32 v68, v177, v181
    v_cvt_pk_bf16_f32 v69, v185, v189
    v_cvt_pk_bf16_f32 v70, v193, v197
    v_cvt_pk_bf16_f32 v71, v201, v205
    v_cvt_pk_bf16_f32 v72, v178, v182
    v_cvt_pk_bf16_f32 v73, v186, v190
    v_cvt_pk_bf16_f32 v74, v194, v198
    v_cvt_pk_bf16_f32 v75, v202, v206
    v_cvt_pk_bf16_f32 v76, v179, v183
    v_cvt_pk_bf16_f32 v77, v187, v191
    v_cvt_pk_bf16_f32 v78, v195, v199
    v_cvt_pk_bf16_f32 v79, v203, v207
    s_add_u32 s25, s24, 262144
    buffer_store_dwordx4 v[64:67], v212, s[16:19], s25 offen sc1
    s_add_u32 s25, s24, 270336
    buffer_store_dwordx4 v[68:71], v212, s[16:19], s25 offen sc1
    s_add_u32 s25, s24, 278528
    buffer_store_dwordx4 v[72:75], v212, s[16:19], s25 offen sc1
    s_add_u32 s25, s24, 286720
    buffer_store_dwordx4 v[76:79], v212, s[16:19], s25 offen sc1
    v_mfma_f32_16x16x32_bf16 v[176:179], v[140:143], v[80:83], 0
    v_mfma_f32_16x16x32_bf16 v[180:183], v[140:143], v[84:87], 0
    v_mfma_f32_16x16x32_bf16 v[184:187], v[140:143], v[88:91], 0
    v_mfma_f32_16x16x32_bf16 v[188:191], v[140:143], v[92:95], 0
    v_mfma_f32_16x16x32_bf16 v[192:195], v[140:143], v[96:99], 0
    v_mfma_f32_16x16x32_bf16 v[196:199], v[140:143], v[100:103], 0
    v_mfma_f32_16x16x32_bf16 v[200:203], v[140:143], v[104:107], 0
    v_mfma_f32_16x16x32_bf16 v[204:207], v[140:143], v[108:111], 0
    s_nop 1
    v_cvt_pk_bf16_f32 v112, v176, v180
    s_nop 0
    v_cvt_pk_bf16_f32 v113, v184, v188
    s_nop 0
    v_cvt_pk_bf16_f32 v114, v192, v196
    s_nop 0
    v_cvt_pk_bf16_f32 v115, v200, v204
    v_cvt_pk_bf16_f32 v116, v177, v181
    v_cvt_pk_bf16_f32 v117, v185, v189
    v_cvt_pk_bf16_f32 v118, v193, v197
    v_cvt_pk_bf16_f32 v119, v201, v205
    v_cvt_pk_bf16_f32 v120, v178, v182
    v_cvt_pk_bf16_f32 v121, v186, v190
    v_cvt_pk_bf16_f32 v122, v194, v198
    v_cvt_pk_bf16_f32 v123, v202, v206
    v_cvt_pk_bf16_f32 v124, v179, v183
    v_cvt_pk_bf16_f32 v125, v187, v191
    v_cvt_pk_bf16_f32 v126, v195, v199
    v_cvt_pk_bf16_f32 v127, v203, v207
    s_add_u32 s25, s24, 393216
    buffer_store_dwordx4 v[112:115], v212, s[16:19], s25 offen sc1
    s_add_u32 s25, s24, 401408
    buffer_store_dwordx4 v[116:119], v212, s[16:19], s25 offen sc1
    s_add_u32 s25, s24, 409600
    buffer_store_dwordx4 v[120:123], v212, s[16:19], s25 offen sc1
    s_add_u32 s25, s24, 417792
    buffer_store_dwordx4 v[124:127], v212, s[16:19], s25 offen sc1
L_next1:
    s_cmp_lg_u32 s10, 0
    s_cbranch_scc1 L_pub1
    s_cmp_ge_u32 s42, 1696
    s_cbranch_scc1 L_w0_p1
    s_cmp_ge_u32 s42, 672
    s_cbranch_scc1 L_w8_p1
    s_waitcnt vmcnt(32)
    s_branch L_wd_p1
L_w8_p1:
    s_waitcnt vmcnt(24)
    s_branch L_wd_p1
L_w0_p1:
    s_waitcnt vmcnt(16)
L_wd_p1:
    v_add_u32 v221, 512, v221
    v_mov_b32 v213, s41
    s_mov_b64 exec, 1
    ds_write_b32 v213, v221 offset:12288
    s_mov_b64 exec, -1
L_pub1:
    s_waitcnt lgkmcnt(0)
    s_barrier
    v_mov_b32 v213, s41
    ds_read_b32 v214, v213 offset:12288
    s_xor_b32 s41, s41, 4
    s_mov_b32 s40, s42
    s_waitcnt lgkmcnt(0)
    v_readfirstlane_b32 s42, v214
    s_cmp_ge_u32 s40, 1696
    s_cbranch_scc1 L_k12_end
    s_branch L_k12_loop
L_k12_end:
    s_endpgm
.globl gemm_kernel
.p2align 8
.type gemm_kernel,@function
gemm_kernel:
    s_cmp_ge_u32 s2, 256
    s_cbranch_scc1 L_k3_end
    s_load_dwordx2 s[8:9], s[0:1], 48
    v_lshrrev_b32 v253, 6, v0
    v_and_b32 v0, 63, v0
    v_readfirstlane_b32 s10, v253
    s_and_b32 s11, s2, 7
    s_lshr_b32 s12, s2, 3
    s_lshr_b32 s13, s12, 3
    s_lshl_b32 s11, s11, 2
    s_add_u32 s11, s11, s13
    s_bfe_u32 s13, s12, 0x10002
    s_and_b32 s14, s12, 3
    s_and_b32 s15, s10, 3
    s_waitcnt lgkmcnt(0)
    s_mov_b32 s16, s8
    s_and_b32 s17, s9, 0xffff
    s_mov_b32 s18, 268435456
    s_mov_b32 s19, 0x00020000
    s_cmp_ge_u32 s10, 4
    s_cbranch_scc1 L_k3_helper
    v_lshrrev_b32 v253, 4, v0
    v_and_b32 v254, 15, v0
    v_bfe_u32 v255, v254, 3, 1
    v_mul_u32_u24 v255, 3, v255
    v_xor_b32 v255, v255, v253
    v_lshlrev_b32 v255, 4, v255
    v_lshl_add_u32 v250, v254, 6, v255
    v_lshrrev_b32 v255, 2, v254
    v_and_b32 v216, 1, v253
    v_lshl_or_b32 v216, v216, 2, v255
    v_lshl_add_u32 v255, v253, 3, v255
    v_lshlrev_b32 v255, 8, v255
    v_and_b32 v217, 3, v254
    v_lshl_add_u32 v255, v217, 3, v255
    s_lshl_b32 s20, s15, 1
    s_add_u32 s20, s20, s13
    v_xor_b32 v217, s20, v216
    v_lshl_add_u32 v248, v217, 5, v255
    s_xor_b32 s20, s20, 1
    v_xor_b32 v217, s20, v216
    v_lshl_add_u32 v249, v217, 5, v255
    s_mov_b32 s21, 65792
    v_mul_u32_u24 v251, s21, v254
    v_lshl_add_u32 v251, v253, 4, v251
    s_lshl_b32 s23, s15, 6
    v_add_u32 v251, s23, v251
    v_and_b32 v255, 7, v254
    v_mul_u32_u24 v252, s21, v255
    v_lshrrev_b32 v216, 3, v254
    v_xor_b32 v216, s13, v216
    s_mov_b32 s22, 11579392
    v_mul_lo_u32 v216, v216, s22
    v_add_u32 v252, v252, v216
    v_lshl_add_u32 v252, v253, 4, v252
    s_lshl_b32 s22, s13, 3
    s_add_u32 s22, s22, s23
    v_add_u32 v252, s22, v252
    v_cmp_gt_u32 vcc, 7, v255
    v_mov_b32 v216, 0x80000000
    s_nop 0
    v_cndmask_b32 v252, v216, v252, vcc
    s_mul_i32 s48, s11, 2048
    s_lshl_b32 s20, s14, 8
    s_add_u32 s48, s48, s20
    s_add_u32 s48, s48, 117440512
    s_add_u32 s49, s48, 10526720
    s_mul_i32 s20, s13, 11579392
    s_add_u32 s48, s48, s20
    v_mov_b32 v0, 0
    v_mov_b32 v1, 0
    v_mov_b32 v2, 0
    v_mov_b32 v3, 0
    v_mov_b32 v4, 0
    v_mov_b32 v5, 0
    v_mov_b32 v6, 0
    v_mov_b32 v7, 0
    v_mov_b32 v8, 0
    v_mov_b32 v9, 0
    v_mov_b32 v10, 0
    v_mov_b32 v11, 0
    v_mov_b32 v12, 0
    v_mov_b32 v13, 0
    v_mov_b32 v14, 0
    v_mov_b32 v15, 0
    v_mov_b32 v16, 0
    v_mov_b32 v17, 0
    v_mov_b32 v18, 0
    v_mov_b32 v19, 0
    v_mov_b32 v20, 0
    v_mov_b32 v21, 0
    v_mov_b32 v22, 0
    v_mov_b32 v23, 0
    v_mov_b32 v24, 0
    v_mov_b32 v25, 0
    v_mov_b32 v26, 0
    v_mov_b32 v27, 0
    v_mov_b32 v28, 0
    v_mov_b32 v29, 0
    v_mov_b32 v30, 0
    v_mov_b32 v31, 0
    v_mov_b32 v32, 0
    v_mov_b32 v33, 0
    v_mov_b32 v34, 0
    v_mov_b32 v35, 0
    v_mov_b32 v36, 0
    v_mov_b32 v37, 0
    v_mov_b32 v38, 0
    v_mov_b32 v39, 0
    v_mov_b32 v40, 0
    v_mov_b32 v41, 0
    v_mov_b32 v42, 0
    v_mov_b32 v43, 0
    v_mov_b32 v44, 0
    v_mov_b32 v45, 0
    v_mov_b32 v46, 0
    v_mov_b32 v47, 0
    v_mov_b32 v48, 0
    v_mov_b32 v49, 0
    v_mov_b32 v50, 0
    v_mov_b32 v51, 0
    v_mov_b32 v52, 0
    v_mov_b32 v53, 0
    v_mov_b32 v54, 0
    v_mov_b32 v55, 0
    v_mov_b32 v56, 0
    v_mov_b32 v57, 0
    v_mov_b32 v58, 0
    v_mov_b32 v59, 0
    v_mov_b32 v60, 0
    v_mov_b32 v61, 0
    v_mov_b32 v62, 0
    v_mov_b32 v63, 0
    v_mov_b32 v64, 0
    v_mov_b32 v65, 0
    v_mov_b32 v66, 0
    v_mov_b32 v67, 0
    v_mov_b32 v68, 0
    v_mov_b32 v69, 0
    v_mov_b32 v70, 0
    v_mov_b32 v71, 0
    v_mov_b32 v72, 0
    v_mov_b32 v73, 0
    v_mov_b32 v74, 0
    v_mov_b32 v75, 0
    v_mov_b32 v76, 0
    v_mov_b32 v77, 0
    v_mov_b32 v78, 0
    v_mov_b32 v79, 0
    v_mov_b32 v80, 0
    v_mov_b32 v81, 0
    v_mov_b32 v82, 0
    v_mov_b32 v83, 0
    v_mov_b32 v84, 0
    v_mov_b32 v85, 0
    v_mov_b32 v86, 0
    v_mov_b32 v87, 0
    v_mov_b32 v88, 0
    v_mov_b32 v89, 0
    v_mov_b32 v90, 0
    v_mov_b32 v91, 0
    v_mov_b32 v92, 0
    v_mov_b32 v93, 0
    v_mov_b32 v94, 0
    v_mov_b32 v95, 0
    v_mov_b32 v96, 0
    v_mov_b32 v97, 0
    v_mov_b32 v98, 0
    v_mov_b32 v99, 0
    v_mov_b32 v100, 0
    v_mov_b32 v101, 0
    v_mov_b32 v102, 0
    v_mov_b32 v103, 0
    v_mov_b32 v104, 0
    v_mov_b32 v105, 0
    v_mov_b32 v106, 0
    v_mov_b32 v107, 0
    v_mov_b32 v108, 0
    v_mov_b32 v109, 0
    v_mov_b32 v110, 0
    v_mov_b32 v111, 0
    v_mov_b32 v112, 0
    v_mov_b32 v113, 0
    v_mov_b32 v114, 0
    v_mov_b32 v115, 0
    v_mov_b32 v116, 0
    v_mov_b32 v117, 0
    v_mov_b32 v118, 0
    v_mov_b32 v119, 0
    v_mov_b32 v120, 0
    v_mov_b32 v121, 0
    v_mov_b32 v122, 0
    v_mov_b32 v123, 0
    v_mov_b32 v124, 0
    v_mov_b32 v125, 0
    v_mov_b32 v126, 0
    v_mov_b32 v127, 0
    v_mov_b32 v128, 0
    v_mov_b32 v129, 0
    v_mov_b32 v130, 0
    v_mov_b32 v131, 0
    v_mov_b32 v132, 0
    v_mov_b32 v133, 0
    v_mov_b32 v134, 0
    v_mov_b32 v135, 0
    v_mov_b32 v136, 0
    v_mov_b32 v137, 0
    v_mov_b32 v138, 0
    v_mov_b32 v139, 0
    v_mov_b32 v140, 0
    v_mov_b32 v141, 0
    v_mov_b32 v142, 0
    v_mov_b32 v143, 0
    v_mov_b32 v144, 0
    v_mov_b32 v145, 0
    v_mov_b32 v146, 0
    v_mov_b32 v147, 0
    v_mov_b32 v148, 0
    v_mov_b32 v149, 0
    v_mov_b32 v150, 0
    v_mov_b32 v151, 0
    v_mov_b32 v152, 0
    v_mov_b32 v153, 0
    v_mov_b32 v154, 0
    v_mov_b32 v155, 0
    v_mov_b32 v156, 0
    v_mov_b32 v157, 0
    v_mov_b32 v158, 0
    v_mov_b32 v159, 0
    v_mov_b32 v160, 0
    v_mov_b32 v161, 0
    v_mov_b32 v162, 0
    v_mov_b32 v163, 0
    v_mov_b32 v164, 0
    v_mov_b32 v165, 0
    v_mov_b32 v166, 0
    v_mov_b32 v167, 0
    s_barrier
    ds_read_b64_tr_b16 v[176:177], v248 offset:0
    ds_read_b64_tr_b16 v[178:179], v248 offset:1024
    ds_read_b64_tr_b16 v[180:181], v249 offset:0
    ds_read_b64_tr_b16 v[182:183], v249 offset:1024
    ds_read_b64_tr_b16 v[184:185], v248 offset:8192
    ds_read_b64_tr_b16 v[186:187], v248 offset:9216
    ds_read_b64_tr_b16 v[188:189], v249 offset:8192
    ds_read_b64_tr_b16 v[190:191], v249 offset:9216
    ds_read_b128 v[216:219], v250 offset:16384
    ds_read_b128 v[220:223], v250 offset:27648
    ds_read_b128 v[224:227], v250 offset:17408
    ds_read_b128 v[228:231], v250 offset:28672
    s_waitcnt lgkmcnt(4)
    v_xor_b32 v208, 0x80008000, v184
    v_xor_b32 v209, 0x80008000, v185
    v_xor_b32 v210, 0x80008000, v186
    v_xor_b32 v211, 0x80008000, v187
    v_xor_b32 v212, 0x80008000, v188
    v_xor_b32 v213, 0x80008000, v189
    v_xor_b32 v214, 0x80008000, v190
    v_xor_b32 v215, 0x80008000, v191
    s_mov_b32 s46, 7
L_g_loop:
    s_barrier
    s_waitcnt lgkmcnt(2)
    v_mfma_f32_16x16x32_bf16 v[0:3], v[176:179], v[216:219], v[0:3]
    ds_read_b128 v[232:235], v250 offset:18432
    ds_read_b128 v[236:239], v250 offset:29696
    v_mfma_f32_16x16x32_bf16 v[4:7], v[180:183], v[216:219], v[4:7]
    v_mfma_f32_16x16x32_bf16 v[8:11], v[208:211], v[216:219], v[8:11]
    v_mfma_f32_16x16x32_bf16 v[12:15], v[212:215], v[216:219], v[12:15]
    v_mfma_f32_16x16x32_bf16 v[0:3], v[184:187], v[220:223], v[0:3]
    v_mfma_f32_16x16x32_bf16 v[4:7], v[188:191], v[220:223], v[4:7]
    v_mfma_f32_16x16x32_bf16 v[8:11], v[176:179], v[220:223], v[8:11]
    v_mfma_f32_16x16x32_bf16 v[12:15], v[180:183], v[220:223], v[12:15]
    s_waitcnt lgkmcnt(2)
    v_mfma_f32_16x16x32_bf16 v[16:19], v[176:179], v[224:227], v[16:19]
    ds_read_b128 v[240:243], v250 offset:19456
    ds_read_b128 v[244:247], v250 offset:30720
    v_mfma_f32_16x16x32_bf16 v[20:23], v[180:183], v[224:227], v[20:23]
    v_mfma_f32_16x16x32_bf16 v[24:27], v[208:211], v[224:227], v[24:27]
    v_mfma_f32_16x16x32_bf16 v[28:31], v[212:215], v[224:227], v[28:31]
    v_mfma_f32_16x16x32_bf16 v[16:19], v[184:187], v[228:231], v[16:19]
    v_mfma_f32_16x16x32_bf16 v[20:23], v[188:191], v[228:231], v[20:23]
    v_mfma_f32_16x16x32_bf16 v[24:27], v[176:179], v[228:231], v[24:27]
    v_mfma_f32_16x16x32_bf16 v[28:31], v[180:183], v[228:231], v[28:31]
    s_waitcnt lgkmcnt(2)
    v_mfma_f32_16x16x32_bf16 v[32:35], v[176:179], v[232:235], v[32:35]
    ds_read_b128 v[216:219], v250 offset:20480
    ds_read_b128 v[220:223], v250 offset:31744
    v_mfma_f32_16x16x32_bf16 v[36:39], v[180:183], v[232:235], v[36:39]
    v_mfma_f32_16x16x32_bf16 v[40:43], v[208:211], v[232:235], v[40:43]
    v_mfma_f32_16x16x32_bf16 v[44:47], v[212:215], v[232:235], v[44:47]
    v_mfma_f32_16x16x32_bf16 v[32:35], v[184:187], v[236:239], v[32:35]
    v_mfma_f32_16x16x32_bf16 v[36:39], v[188:191], v[236:239], v[36:39]
    v_mfma_f32_16x16x32_bf16 v[40:43], v[176:179], v[236:239], v[40:43]
    v_mfma_f32_16x16x32_bf16 v[44:47], v[180:183], v[236:239], v[44:47]
    s_waitcnt lgkmcnt(2)
    v_mfma_f32_16x16x32_bf16 v[48:51], v[176:179], v[240:243], v[48:51]
    ds_read_b128 v[224:227], v250 offset:21504
    ds_read_b128 v[228:231], v250 offset:32768
    v_mfma_f32_16x16x32_bf16 v[52:55], v[180:183], v[240:243], v[52:55]
    v_mfma_f32_16x16x32_bf16 v[56:59], v[208:211], v[240:243], v[56:59]
    v_mfma_f32_16x16x32_bf16 v[60:63], v[212:215], v[240:243], v[60:63]
    v_mfma_f32_16x16x32_bf16 v[48:51], v[184:187], v[244:247], v[48:51]
    v_mfma_f32_16x16x32_bf16 v[52:55], v[188:191], v[244:247], v[52:55]
    v_mfma_f32_16x16x32_bf16 v[56:59], v[176:179], v[244:247], v[56:59]
    v_mfma_f32_16x16x32_bf16 v[60:63], v[180:183], v[244:247], v[60:63]
    s_waitcnt lgkmcnt(2)
    v_mfma_f32_16x16x32_bf16 v[64:67], v[176:179], v[216:219], v[64:67]
    ds_read_b128 v[232:235], v250 offset:22528
    ds_read_b128 v[236:239], v250 offset:33792
    v_mfma_f32_16x16x32_bf16 v[68:71], v[180:183], v[216:219], v[68:71]
    v_mfma_f32_16x16x32_bf16 v[72:75], v[208:211], v[216:219], v[72:75]
    v_mfma_f32_16x16x32_bf16 v[76:79], v[212:215], v[216:219], v[76:79]
    v_mfma_f32_16x16x32_bf16 v[64:67], v[184:187], v[220:223], v[64:67]
    v_mfma_f32_16x16x32_bf16 v[68:71], v[188:191], v[220:223], v[68:71]
    v_mfma_f32_16x16x32_bf16 v[72:75], v[176:179], v[220:223], v[72:75]
    v_mfma_f32_16x16x32_bf16 v[76:79], v[180:183], v[220:223], v[76:79]
    s_waitcnt lgkmcnt(2)
    v_mfma_f32_16x16x32_bf16 v[80:83], v[176:179], v[224:227], v[80:83]
    ds_read_b128 v[240:243], v250 offset:23552
    ds_read_b128 v[244:247], v250 offset:34816
    v_mfma_f32_16x16x32_bf16 v[84:87], v[180:183], v[224:227], v[84:87]
    v_mfma_f32_16x16x32_bf16 v[88:91], v[208:211], v[224:227], v[88:91]
    v_mfma_f32_16x16x32_bf16 v[92:95], v[212:215], v[224:227], v[92:95]
    v_mfma_f32_16x16x32_bf16 v[80:83], v[184:187], v[228:231], v[80:83]
    v_add_u32 v248, 0x9800, v248
    v_add_u32 v249, 0x9800, v249
    v_mfma_f32_16x16x32_bf16 v[84:87], v[188:191], v[228:231], v[84:87]
    v_mfma_f32_16x16x32_bf16 v[88:91], v[176:179], v[228:231], v[88:91]
    v_mfma_f32_16x16x32_bf16 v[92:95], v[180:183], v[228:231], v[92:95]
    s_waitcnt lgkmcnt(2)
    v_mfma_f32_16x16x32_bf16 v[96:99], v[176:179], v[232:235], v[96:99]
    ds_read_b128 v[216:219], v250 offset:24576
    ds_read_b128 v[220:223], v250 offset:35840
    v_mfma_f32_16x16x32_bf16 v[100:103], v[180:183], v[232:235], v[100:103]
    v_mfma_f32_16x16x32_bf16 v[104:107], v[208:211], v[232:235], v[104:107]
    v_mfma_f32_16x16x32_bf16 v[108:111], v[212:215], v[232:235], v[108:111]
    ds_read_b64_tr_b16 v[192:193], v248 offset:0
    ds_read_b64_tr_b16 v[194:195], v248 offset:1024
    ds_read_b64_tr_b16 v[196:197], v249 offset:0
    ds_read_b64_tr_b16 v[198:199], v249 offset:1024
    v_mfma_f32_16x16x32_bf16 v[96:99], v[184:187], v[236:239], v[96:99]
    v_mfma_f32_16x16x32_bf16 v[100:103], v[188:191], v[236:239], v[100:103]
    v_mfma_f32_16x16x32_bf16 v[104:107], v[176:179], v[236:239], v[104:107]
    v_mfma_f32_16x16x32_bf16 v[108:111], v[180:183], v[236:239], v[108:111]
    s_waitcnt lgkmcnt(6)
    v_mfma_f32_16x16x32_bf16 v[112:115], v[176:179], v[240:243], v[112:115]
    ds_read_b128 v[224:227], v250 offset:25600
    ds_read_b128 v[228:231], v250 offset:36864
    v_mfma_f32_16x16x32_bf16 v[116:119], v[180:183], v[240:243], v[116:119]
    v_mfma_f32_16x16x32_bf16 v[120:123], v[208:211], v[240:243], v[120:123]
    v_mfma_f32_16x16x32_bf16 v[124:127], v[212:215], v[240:243], v[124:127]
    ds_read_b64_tr_b16 v[200:201], v248 offset:8192
    ds_read_b64_tr_b16 v[202:203], v248 offset:9216
    ds_read_b64_tr_b16 v[204:205], v249 offset:8192
    ds_read_b64_tr_b16 v[206:207], v249 offset:9216
    v_mfma_f32_16x16x32_bf16 v[112:115], v[184:187], v[244:247], v[112:115]
    v_mfma_f32_16x16x32_bf16 v[116:119], v[188:191], v[244:247], v[116:119]
    v_mfma_f32_16x16x32_bf16 v[120:123], v[176:179], v[244:247], v[120:123]
    v_mfma_f32_16x16x32_bf16 v[124:127], v[180:183], v[244:247], v[124:127]
    s_waitcnt lgkmcnt(10)
    v_mfma_f32_16x16x32_bf16 v[128:131], v[176:179], v[216:219], v[128:131]
    ds_read_b128 v[232:235], v250 offset:26624
    ds_read_b128 v[236:239], v250 offset:37888
    v_mfma_f32_16x16x32_bf16 v[132:135], v[180:183], v[216:219], v[132:135]
    v_mfma_f32_16x16x32_bf16 v[136:139], v[208:211], v[216:219], v[136:139]
    v_mfma_f32_16x16x32_bf16 v[140:143], v[212:215], v[216:219], v[140:143]
    v_mfma_f32_16x16x32_bf16 v[128:131], v[184:187], v[220:223], v[128:131]
    v_mfma_f32_16x16x32_bf16 v[132:135], v[188:191], v[220:223], v[132:135]
    v_mfma_f32_16x16x32_bf16 v[136:139], v[176:179], v[220:223], v[136:139]
    v_mfma_f32_16x16x32_bf16 v[140:143], v[180:183], v[220:223], v[140:143]
    s_waitcnt lgkmcnt(6)
    v_mfma_f32_16x16x32_bf16 v[144:147], v[176:179], v[224:227], v[144:147]
    v_add_u32 v250, 0x9800, v250
    ds_read_b128 v[240:243], v250 offset:16384
    ds_read_b128 v[244:247], v250 offset:27648
    v_mfma_f32_16x16x32_bf16 v[148:151], v[180:183], v[224:227], v[148:151]
    v_mfma_f32_16x16x32_bf16 v[152:155], v[208:211], v[224:227], v[152:155]
    v_mfma_f32_16x16x32_bf16 v[156:159], v[212:215], v[224:227], v[156:159]
    v_mfma_f32_16x16x32_bf16 v[144:147], v[184:187], v[228:231], v[144:147]
    s_waitcnt lgkmcnt(4)
    v_xor_b32 v212, 0x80008000, v204
    v_xor_b32 v213, 0x80008000, v205
    v_mfma_f32_16x16x32_bf16 v[148:151], v[188:191], v[228:231], v[148:151]
    v_xor_b32 v214, 0x80008000, v206
    v_xor_b32 v215, 0x80008000, v207
    v_mfma_f32_16x16x32_bf16 v[152:155], v[176:179], v[228:231], v[152:155]
    v_mfma_f32_16x16x32_bf16 v[156:159], v[180:183], v[228:231], v[156:159]
    s_waitcnt lgkmcnt(2)
    v_mfma_f32_16x16x32_bf16 v[160:163], v[176:179], v[232:235], v[160:163]
    ds_read_b128 v[216:219], v250 offset:17408
    ds_read_b128 v[220:223], v250 offset:28672
    v_mfma_f32_16x16x32_bf16 v[164:167], v[208:211], v[232:235], v[164:167]
    v_xor_b32 v208, 0x80008000, v200
    v_xor_b32 v209, 0x80008000, v201
    v_mfma_f32_16x16x32_bf16 v[160:163], v[184:187], v[236:239], v[160:163]
    v_xor_b32 v210, 0x80008000, v202
    v_xor_b32 v211, 0x80008000, v203
    v_mfma_f32_16x16x32_bf16 v[164:167], v[176:179], v[236:239], v[164:167]
    s_barrier
    s_waitcnt lgkmcnt(2)
    v_mfma_f32_16x16x32_bf16 v[0:3], v[192:195], v[240:243], v[0:3]
    ds_read_b128 v[224:227], v250 offset:18432
    ds_read_b128 v[228:231], v250 offset:29696
    v_mfma_f32_16x16x32_bf16 v[4:7], v[196:199], v[240:243], v[4:7]
    v_mfma_f32_16x16x32_bf16 v[8:11], v[208:211], v[240:243], v[8:11]
    v_mfma_f32_16x16x32_bf16 v[12:15], v[212:215], v[240:243], v[12:15]
    v_mfma_f32_16x16x32_bf16 v[0:3], v[200:203], v[244:247], v[0:3]
    v_mfma_f32_16x16x32_bf16 v[4:7], v[204:207], v[244:247], v[4:7]
    v_mfma_f32_16x16x32_bf16 v[8:11], v[192:195], v[244:247], v[8:11]
    v_mfma_f32_16x16x32_bf16 v[12:15], v[196:199], v[244:247], v[12:15]
    s_waitcnt lgkmcnt(2)
    v_mfma_f32_16x16x32_bf16 v[16:19], v[192:195], v[216:219], v[16:19]
    ds_read_b128 v[232:235], v250 offset:19456
    ds_read_b128 v[236:239], v250 offset:30720
    v_mfma_f32_16x16x32_bf16 v[20:23], v[196:199], v[216:219], v[20:23]
    v_mfma_f32_16x16x32_bf16 v[24:27], v[208:211], v[216:219], v[24:27]
    v_mfma_f32_16x16x32_bf16 v[28:31], v[212:215], v[216:219], v[28:31]
    v_mfma_f32_16x16x32_bf16 v[16:19], v[200:203], v[220:223], v[16:19]
    v_mfma_f32_16x16x32_bf16 v[20:23], v[204:207], v[220:223], v[20:23]
    v_mfma_f32_16x16x32_bf16 v[24:27], v[192:195], v[220:223], v[24:27]
    v_mfma_f32_16x16x32_bf16 v[28:31], v[196:199], v[220:223], v[28:31]
    s_waitcnt lgkmcnt(2)
    v_mfma_f32_16x16x32_bf16 v[32:35], v[192:195], v[224:227], v[32:35]
    ds_read_b128 v[240:243], v250 offset:20480
    ds_read_b128 v[244:247], v250 offset:31744
    v_mfma_f32_16x16x32_bf16 v[36:39], v[196:199], v[224:227], v[36:39]
    v_mfma_f32_16x16x32_bf16 v[40:43], v[208:211], v[224:227], v[40:43]
    v_mfma_f32_16x16x32_bf16 v[44:47], v[212:215], v[224:227], v[44:47]
    v_mfma_f32_16x16x32_bf16 v[32:35], v[200:203], v[228:231], v[32:35]
    v_mfma_f32_16x16x32_bf16 v[36:39], v[204:207], v[228:231], v[36:39]
    v_mfma_f32_16x16x32_bf16 v[40:43], v[192:195], v[228:231], v[40:43]
    v_mfma_f32_16x16x32_bf16 v[44:47], v[196:199], v[228:231], v[44:47]
    s_waitcnt lgkmcnt(2)
    v_mfma_f32_16x16x32_bf16 v[48:51], v[192:195], v[232:235], v[48:51]
    ds_read_b128 v[216:219], v250 offset:21504
    ds_read_b128 v[220:223], v250 offset:32768
    v_mfma_f32_16x16x32_bf16 v[52:55], v[196:199], v[232:235], v[52:55]
    v_mfma_f32_16x16x32_bf16 v[56:59], v[208:211], v[232:235], v[56:59]
    v_mfma_f32_16x16x32_bf16 v[60:63], v[212:215], v[232:235], v[60:63]
    v_mfma_f32_16x16x32_bf16 v[48:51], v[200:203], v[236:239], v[48:51]
    v_mfma_f32_16x16x32_bf16 v[52:55], v[204:207], v[236:239], v[52:55]
    v_mfma_f32_16x16x32_bf16 v[56:59], v[192:195], v[236:239], v[56:59]
    v_mfma_f32_16x16x32_bf16 v[60:63], v[196:199], v[236:239], v[60:63]
    s_waitcnt lgkmcnt(2)
    v_mfma_f32_16x16x32_bf16 v[64:67], v[192:195], v[240:243], v[64:67]
    ds_read_b128 v[224:227], v250 offset:22528
    ds_read_b128 v[228:231], v250 offset:33792
    v_mfma_f32_16x16x32_bf16 v[68:71], v[196:199], v[240:243], v[68:71]
    v_mfma_f32_16x16x32_bf16 v[72:75], v[208:211], v[240:243], v[72:75]
    v_mfma_f32_16x16x32_bf16 v[76:79], v[212:215], v[240:243], v[76:79]
    v_mfma_f32_16x16x32_bf16 v[64:67], v[200:203], v[244:247], v[64:67]
    v_mfma_f32_16x16x32_bf16 v[68:71], v[204:207], v[244:247], v[68:71]
    v_mfma_f32_16x16x32_bf16 v[72:75], v[192:195], v[244:247], v[72:75]
    v_mfma_f32_16x16x32_bf16 v[76:79], v[196:199], v[244:247], v[76:79]
    s_waitcnt lgkmcnt(2)
    v_mfma_f32_16x16x32_bf16 v[80:83], v[192:195], v[216:219], v[80:83]
    ds_read_b128 v[232:235], v250 offset:23552
    ds_read_b128 v[236:239], v250 offset:34816
    v_mfma_f32_16x16x32_bf16 v[84:87], v[196:199], v[216:219], v[84:87]
    v_mfma_f32_16x16x32_bf16 v[88:91], v[208:211], v[216:219], v[88:91]
    v_mfma_f32_16x16x32_bf16 v[92:95], v[212:215], v[216:219], v[92:95]
    v_mfma_f32_16x16x32_bf16 v[80:83], v[200:203], v[220:223], v[80:83]
    v_add_u32 v248, 0x9800, v248
    v_add_u32 v249, 0x9800, v249
    v_mfma_f32_16x16x32_bf16 v[84:87], v[204:207], v[220:223], v[84:87]
    v_mfma_f32_16x16x32_bf16 v[88:91], v[192:195], v[220:223], v[88:91]
    v_mfma_f32_16x16x32_bf16 v[92:95], v[196:199], v[220:223], v[92:95]
    s_waitcnt lgkmcnt(2)
    v_mfma_f32_16x16x32_bf16 v[96:99], v[192:195], v[224:227], v[96:99]
    ds_read_b128 v[240:243], v250 offset:24576
    ds_read_b128 v[244:247], v250 offset:35840
    v_mfma_f32_16x16x32_bf16 v[100:103], v[196:199], v[224:227], v[100:103]
    v_mfma_f32_16x16x32_bf16 v[104:107], v[208:211], v[224:227], v[104:107]
    v_mfma_f32_16x16x32_bf16 v[108:111], v[212:215], v[224:227], v[108:111]
    ds_read_b64_tr_b16 v[176:177], v248 offset:0
    ds_read_b64_tr_b16 v[178:179], v248 offset:1024
    ds_read_b64_tr_b16 v[180:181], v249 offset:0
    ds_read_b64_tr_b16 v[182:183], v249 offset:1024
    v_mfma_f32_16x16x32_bf16 v[96:99], v[200:203], v[228:231], v[96:99]
    v_mfma_f32_16x16x32_bf16 v[100:103], v[204:207], v[228:231], v[100:103]
    v_mfma_f32_16x16x32_bf16 v[104:107], v[192:195], v[228:231], v[104:107]
    v_mfma_f32_16x16x32_bf16 v[108:111], v[196:199], v[228:231], v[108:111]
    s_waitcnt lgkmcnt(6)
    v_mfma_f32_16x16x32_bf16 v[112:115], v[192:195], v[232:235], v[112:115]
    ds_read_b128 v[216:219], v250 offset:25600
    ds_read_b128 v[220:223], v250 offset:36864
    v_mfma_f32_16x16x32_bf16 v[116:119], v[196:199], v[232:235], v[116:119]
    v_mfma_f32_16x16x32_bf16 v[120:123], v[208:211], v[232:235], v[120:123]
    v_mfma_f32_16x16x32_bf16 v[124:127], v[212:215], v[232:235], v[124:127]
    ds_read_b64_tr_b16 v[184:185], v248 offset:8192
    ds_read_b64_tr_b16 v[186:187], v248 offset:9216
    ds_read_b64_tr_b16 v[188:189], v249 offset:8192
    ds_read_b64_tr_b16 v[190:191], v249 offset:9216
    v_mfma_f32_16x16x32_bf16 v[112:115], v[200:203], v[236:239], v[112:115]
    v_mfma_f32_16x16x32_bf16 v[116:119], v[204:207], v[236:239], v[116:119]
    v_mfma_f32_16x16x32_bf16 v[120:123], v[192:195], v[236:239], v[120:123]
    v_mfma_f32_16x16x32_bf16 v[124:127], v[196:199], v[236:239], v[124:127]
    s_waitcnt lgkmcnt(10)
    v_mfma_f32_16x16x32_bf16 v[128:131], v[192:195], v[240:243], v[128:131]
    ds_read_b128 v[224:227], v250 offset:26624
    ds_read_b128 v[228:231], v250 offset:37888
    v_mfma_f32_16x16x32_bf16 v[132:135], v[196:199], v[240:243], v[132:135]
    v_mfma_f32_16x16x32_bf16 v[136:139], v[208:211], v[240:243], v[136:139]
    v_mfma_f32_16x16x32_bf16 v[140:143], v[212:215], v[240:243], v[140:143]
    v_mfma_f32_16x16x32_bf16 v[128:131], v[200:203], v[244:247], v[128:131]
    v_mfma_f32_16x16x32_bf16 v[132:135], v[204:207], v[244:247], v[132:135]
    v_mfma_f32_16x16x32_bf16 v[136:139], v[192:195], v[244:247], v[136:139]
    v_mfma_f32_16x16x32_bf16 v[140:143], v[196:199], v[244:247], v[140:143]
    s_waitcnt lgkmcnt(6)
    v_mfma_f32_16x16x32_bf16 v[144:147], v[192:195], v[216:219], v[144:147]
    v_add_u32 v250, 0x9800, v250
    ds_read_b128 v[232:235], v250 offset:16384
    ds_read_b128 v[236:239], v250 offset:27648
    v_mfma_f32_16x16x32_bf16 v[148:151], v[196:199], v[216:219], v[148:151]
    v_mfma_f32_16x16x32_bf16 v[152:155], v[208:211], v[216:219], v[152:155]
    v_mfma_f32_16x16x32_bf16 v[156:159], v[212:215], v[216:219], v[156:159]
    v_mfma_f32_16x16x32_bf16 v[144:147], v[200:203], v[220:223], v[144:147]
    s_waitcnt lgkmcnt(4)
    v_xor_b32 v212, 0x80008000, v188
    v_xor_b32 v213, 0x80008000, v189
    v_mfma_f32_16x16x32_bf16 v[148:151], v[204:207], v[220:223], v[148:151]
    v_xor_b32 v214, 0x80008000, v190
    v_xor_b32 v215, 0x80008000, v191
    v_mfma_f32_16x16x32_bf16 v[152:155], v[192:195], v[220:223], v[152:155]
    v_mfma_f32_16x16x32_bf16 v[156:159], v[196:199], v[220:223], v[156:159]
    s_waitcnt lgkmcnt(2)
    v_mfma_f32_16x16x32_bf16 v[160:163], v[192:195], v[224:227], v[160:163]
    ds_read_b128 v[240:243], v250 offset:17408
    ds_read_b128 v[244:247], v250 offset:28672
    v_mfma_f32_16x16x32_bf16 v[164:167], v[208:211], v[224:227], v[164:167]
    v_xor_b32 v208, 0x80008000, v184
    v_xor_b32 v209, 0x80008000, v185
    v_mfma_f32_16x16x32_bf16 v[160:163], v[200:203], v[228:231], v[160:163]
    v_xor_b32 v210, 0x80008000, v186
    v_xor_b32 v211, 0x80008000, v187
    v_mfma_f32_16x16x32_bf16 v[164:167], v[192:195], v[228:231], v[164:167]
    s_barrier
    s_waitcnt lgkmcnt(2)
    v_mfma_f32_16x16x32_bf16 v[0:3], v[176:179], v[232:235], v[0:3]
    ds_read_b128 v[216:219], v250 offset:18432
    ds_read_b128 v[220:223], v250 offset:29696
    v_mfma_f32_16x16x32_bf16 v[4:7], v[180:183], v[232:235], v[4:7]
    v_mfma_f32_16x16x32_bf16 v[8:11], v[208:211], v[232:235], v[8:11]
    v_mfma_f32_16x16x32_bf16 v[12:15], v[212:215], v[232:235], v[12:15]
    v_mfma_f32_16x16x32_bf16 v[0:3], v[184:187], v[236:239], v[0:3]
    v_mfma_f32_16x16x32_bf16 v[4:7], v[188:191], v[236:239], v[4:7]
    v_mfma_f32_16x16x32_bf16 v[8:11], v[176:179], v[236:239], v[8:11]
    v_mfma_f32_16x16x32_bf16 v[12:15], v[180:183], v[236:239], v[12:15]
    s_waitcnt lgkmcnt(2)
    v_mfma_f32_16x16x32_bf16 v[16:19], v[176:179], v[240:243], v[16:19]
    ds_read_b128 v[224:227], v250 offset:19456
    ds_read_b128 v[228:231], v250 offset:30720
    v_mfma_f32_16x16x32_bf16 v[20:23], v[180:183], v[240:243], v[20:23]
    v_mfma_f32_16x16x32_bf16 v[24:27], v[208:211], v[240:243], v[24:27]
    v_mfma_f32_16x16x32_bf16 v[28:31], v[212:215], v[240:243], v[28:31]
    v_mfma_f32_16x16x32_bf16 v[16:19], v[184:187], v[244:247], v[16:19]
    v_mfma_f32_16x16x32_bf16 v[20:23], v[188:191], v[244:247], v[20:23]
    v_mfma_f32_16x16x32_bf16 v[24:27], v[176:179], v[244:247], v[24:27]
    v_mfma_f32_16x16x32_bf16 v[28:31], v[180:183], v[244:247], v[28:31]
    s_waitcnt lgkmcnt(2)
    v_mfma_f32_16x16x32_bf16 v[32:35], v[176:179], v[216:219], v[32:35]
    ds_read_b128 v[232:235], v250 offset:20480
    ds_read_b128 v[236:239], v250 offset:31744
    v_mfma_f32_16x16x32_bf16 v[36:39], v[180:183], v[216:219], v[36:39]
    v_mfma_f32_16x16x32_bf16 v[40:43], v[208:211], v[216:219], v[40:43]
    v_mfma_f32_16x16x32_bf16 v[44:47], v[212:215], v[216:219], v[44:47]
    v_mfma_f32_16x16x32_bf16 v[32:35], v[184:187], v[220:223], v[32:35]
    v_mfma_f32_16x16x32_bf16 v[36:39], v[188:191], v[220:223], v[36:39]
    v_mfma_f32_16x16x32_bf16 v[40:43], v[176:179], v[220:223], v[40:43]
    v_mfma_f32_16x16x32_bf16 v[44:47], v[180:183], v[220:223], v[44:47]
    s_waitcnt lgkmcnt(2)
    v_mfma_f32_16x16x32_bf16 v[48:51], v[176:179], v[224:227], v[48:51]
    ds_read_b128 v[240:243], v250 offset:21504
    ds_read_b128 v[244:247], v250 offset:32768
    v_mfma_f32_16x16x32_bf16 v[52:55], v[180:183], v[224:227], v[52:55]
    v_mfma_f32_16x16x32_bf16 v[56:59], v[208:211], v[224:227], v[56:59]
    v_mfma_f32_16x16x32_bf16 v[60:63], v[212:215], v[224:227], v[60:63]
    v_mfma_f32_16x16x32_bf16 v[48:51], v[184:187], v[228:231], v[48:51]
    v_mfma_f32_16x16x32_bf16 v[52:55], v[188:191], v[228:231], v[52:55]
    v_mfma_f32_16x16x32_bf16 v[56:59], v[176:179], v[228:231], v[56:59]
    v_mfma_f32_16x16x32_bf16 v[60:63], v[180:183], v[228:231], v[60:63]
    s_waitcnt lgkmcnt(2)
    v_mfma_f32_16x16x32_bf16 v[64:67], v[176:179], v[232:235], v[64:67]
    ds_read_b128 v[216:219], v250 offset:22528
    ds_read_b128 v[220:223], v250 offset:33792
    v_mfma_f32_16x16x32_bf16 v[68:71], v[180:183], v[232:235], v[68:71]
    v_mfma_f32_16x16x32_bf16 v[72:75], v[208:211], v[232:235], v[72:75]
    v_mfma_f32_16x16x32_bf16 v[76:79], v[212:215], v[232:235], v[76:79]
    v_mfma_f32_16x16x32_bf16 v[64:67], v[184:187], v[236:239], v[64:67]
    v_mfma_f32_16x16x32_bf16 v[68:71], v[188:191], v[236:239], v[68:71]
    v_mfma_f32_16x16x32_bf16 v[72:75], v[176:179], v[236:239], v[72:75]
    v_mfma_f32_16x16x32_bf16 v[76:79], v[180:183], v[236:239], v[76:79]
    s_waitcnt lgkmcnt(2)
    v_mfma_f32_16x16x32_bf16 v[80:83], v[176:179], v[240:243], v[80:83]
    ds_read_b128 v[224:227], v250 offset:23552
    ds_read_b128 v[228:231], v250 offset:34816
    v_mfma_f32_16x16x32_bf16 v[84:87], v[180:183], v[240:243], v[84:87]
    v_mfma_f32_16x16x32_bf16 v[88:91], v[208:211], v[240:243], v[88:91]
    v_mfma_f32_16x16x32_bf16 v[92:95], v[212:215], v[240:243], v[92:95]
    v_mfma_f32_16x16x32_bf16 v[80:83], v[184:187], v[244:247], v[80:83]
    v_add_u32 v248, 0x9800, v248
    v_add_u32 v249, 0x9800, v249
    v_mfma_f32_16x16x32_bf16 v[84:87], v[188:191], v[244:247], v[84:87]
    v_mfma_f32_16x16x32_bf16 v[88:91], v[176:179], v[244:247], v[88:91]
    v_mfma_f32_16x16x32_bf16 v[92:95], v[180:183], v[244:247], v[92:95]
    s_waitcnt lgkmcnt(2)
    v_mfma_f32_16x16x32_bf16 v[96:99], v[176:179], v[216:219], v[96:99]
    ds_read_b128 v[232:235], v250 offset:24576
    ds_read_b128 v[236:239], v250 offset:35840
    v_mfma_f32_16x16x32_bf16 v[100:103], v[180:183], v[216:219], v[100:103]
    v_mfma_f32_16x16x32_bf16 v[104:107], v[208:211], v[216:219], v[104:107]
    v_mfma_f32_16x16x32_bf16 v[108:111], v[212:215], v[216:219], v[108:111]
    ds_read_b64_tr_b16 v[192:193], v248 offset:0
    ds_read_b64_tr_b16 v[194:195], v248 offset:1024
    ds_read_b64_tr_b16 v[196:197], v249 offset:0
    ds_read_b64_tr_b16 v[198:199], v249 offset:1024
    v_mfma_f32_16x16x32_bf16 v[96:99], v[184:187], v[220:223], v[96:99]
    v_mfma_f32_16x16x32_bf16 v[100:103], v[188:191], v[220:223], v[100:103]
    v_mfma_f32_16x16x32_bf16 v[104:107], v[176:179], v[220:223], v[104:107]
    v_mfma_f32_16x16x32_bf16 v[108:111], v[180:183], v[220:223], v[108:111]
    s_waitcnt lgkmcnt(6)
    v_mfma_f32_16x16x32_bf16 v[112:115], v[176:179], v[224:227], v[112:115]
    ds_read_b128 v[240:243], v250 offset:25600
    ds_read_b128 v[244:247], v250 offset:36864
    v_mfma_f32_16x16x32_bf16 v[116:119], v[180:183], v[224:227], v[116:119]
    v_mfma_f32_16x16x32_bf16 v[120:123], v[208:211], v[224:227], v[120:123]
    v_mfma_f32_16x16x32_bf16 v[124:127], v[212:215], v[224:227], v[124:127]
    ds_read_b64_tr_b16 v[200:201], v248 offset:8192
    ds_read_b64_tr_b16 v[202:203], v248 offset:9216
    ds_read_b64_tr_b16 v[204:205], v249 offset:8192
    ds_read_b64_tr_b16 v[206:207], v249 offset:9216
    v_mfma_f32_16x16x32_bf16 v[112:115], v[184:187], v[228:231], v[112:115]
    v_mfma_f32_16x16x32_bf16 v[116:119], v[188:191], v[228:231], v[116:119]
    v_mfma_f32_16x16x32_bf16 v[120:123], v[176:179], v[228:231], v[120:123]
    v_mfma_f32_16x16x32_bf16 v[124:127], v[180:183], v[228:231], v[124:127]
    s_waitcnt lgkmcnt(10)
    v_mfma_f32_16x16x32_bf16 v[128:131], v[176:179], v[232:235], v[128:131]
    ds_read_b128 v[216:219], v250 offset:26624
    ds_read_b128 v[220:223], v250 offset:37888
    v_mfma_f32_16x16x32_bf16 v[132:135], v[180:183], v[232:235], v[132:135]
    v_mfma_f32_16x16x32_bf16 v[136:139], v[208:211], v[232:235], v[136:139]
    v_mfma_f32_16x16x32_bf16 v[140:143], v[212:215], v[232:235], v[140:143]
    v_mfma_f32_16x16x32_bf16 v[128:131], v[184:187], v[236:239], v[128:131]
    v_mfma_f32_16x16x32_bf16 v[132:135], v[188:191], v[236:239], v[132:135]
    v_mfma_f32_16x16x32_bf16 v[136:139], v[176:179], v[236:239], v[136:139]
    v_mfma_f32_16x16x32_bf16 v[140:143], v[180:183], v[236:239], v[140:143]
    s_waitcnt lgkmcnt(6)
    v_mfma_f32_16x16x32_bf16 v[144:147], v[176:179], v[240:243], v[144:147]
    v_add_u32 v250, 0x9800, v250
    ds_read_b128 v[224:227], v250 offset:16384
    ds_read_b128 v[228:231], v250 offset:27648
    v_mfma_f32_16x16x32_bf16 v[148:151], v[180:183], v[240:243], v[148:151]
    v_mfma_f32_16x16x32_bf16 v[152:155], v[208:211], v[240:243], v[152:155]
    v_mfma_f32_16x16x32_bf16 v[156:159], v[212:215], v[240:243], v[156:159]
    v_mfma_f32_16x16x32_bf16 v[144:147], v[184:187], v[244:247], v[144:147]
    s_waitcnt lgkmcnt(4)
    v_xor_b32 v212, 0x80008000, v204
    v_xor_b32 v213, 0x80008000, v205
    v_mfma_f32_16x16x32_bf16 v[148:151], v[188:191], v[244:247], v[148:151]
    v_xor_b32 v214, 0x80008000, v206
    v_xor_b32 v215, 0x80008000, v207
    v_mfma_f32_16x16x32_bf16 v[152:155], v[176:179], v[244:247], v[152:155]
    v_mfma_f32_16x16x32_bf16 v[156:159], v[180:183], v[244:247], v[156:159]
    s_waitcnt lgkmcnt(2)
    v_mfma_f32_16x16x32_bf16 v[160:163], v[176:179], v[216:219], v[160:163]
    ds_read_b128 v[232:235], v250 offset:17408
    ds_read_b128 v[236:239], v250 offset:28672
    v_mfma_f32_16x16x32_bf16 v[164:167], v[208:211], v[216:219], v[164:167]
    v_xor_b32 v208, 0x80008000, v200
    v_xor_b32 v209, 0x80008000, v201
    v_mfma_f32_16x16x32_bf16 v[160:163], v[184:187], v[220:223], v[160:163]
    v_xor_b32 v210, 0x80008000, v202
    v_xor_b32 v211, 0x80008000, v203
    v_mfma_f32_16x16x32_bf16 v[164:167], v[176:179], v[220:223], v[164:167]
    s_barrier
    s_waitcnt lgkmcnt(2)
    v_mfma_f32_16x16x32_bf16 v[0:3], v[192:195], v[224:227], v[0:3]
    ds_read_b128 v[240:243], v250 offset:18432
    ds_read_b128 v[244:247], v250 offset:29696
    v_mfma_f32_16x16x32_bf16 v[4:7], v[196:199], v[224:227], v[4:7]
    v_mfma_f32_16x16x32_bf16 v[8:11], v[208:211], v[224:227], v[8:11]
    v_mfma_f32_16x16x32_bf16 v[12:15], v[212:215], v[224:227], v[12:15]
    v_mfma_f32_16x16x32_bf16 v[0:3], v[200:203], v[228:231], v[0:3]
    v_mfma_f32_16x16x32_bf16 v[4:7], v[204:207], v[228:231], v[4:7]
    v_mfma_f32_16x16x32_bf16 v[8:11], v[192:195], v[228:231], v[8:11]
    v_mfma_f32_16x16x32_bf16 v[12:15], v[196:199], v[228:231], v[12:15]
    s_waitcnt lgkmcnt(2)
    v_mfma_f32_16x16x32_bf16 v[16:19], v[192:195], v[232:235], v[16:19]
    ds_read_b128 v[216:219], v250 offset:19456
    ds_read_b128 v[220:223], v250 offset:30720
    v_mfma_f32_16x16x32_bf16 v[20:23], v[196:199], v[232:235], v[20:23]
    v_mfma_f32_16x16x32_bf16 v[24:27], v[208:211], v[232:235], v[24:27]
    v_mfma_f32_16x16x32_bf16 v[28:31], v[212:215], v[232:235], v[28:31]
    v_mfma_f32_16x16x32_bf16 v[16:19], v[200:203], v[236:239], v[16:19]
    v_mfma_f32_16x16x32_bf16 v[20:23], v[204:207], v[236:239], v[20:23]
    v_mfma_f32_16x16x32_bf16 v[24:27], v[192:195], v[236:239], v[24:27]
    v_mfma_f32_16x16x32_bf16 v[28:31], v[196:199], v[236:239], v[28:31]
    s_waitcnt lgkmcnt(2)
    v_mfma_f32_16x16x32_bf16 v[32:35], v[192:195], v[240:243], v[32:35]
    ds_read_b128 v[224:227], v250 offset:20480
    ds_read_b128 v[228:231], v250 offset:31744
    v_mfma_f32_16x16x32_bf16 v[36:39], v[196:199], v[240:243], v[36:39]
    v_mfma_f32_16x16x32_bf16 v[40:43], v[208:211], v[240:243], v[40:43]
    v_mfma_f32_16x16x32_bf16 v[44:47], v[212:215], v[240:243], v[44:47]
    v_mfma_f32_16x16x32_bf16 v[32:35], v[200:203], v[244:247], v[32:35]
    v_mfma_f32_16x16x32_bf16 v[36:39], v[204:207], v[244:247], v[36:39]
    v_mfma_f32_16x16x32_bf16 v[40:43], v[192:195], v[244:247], v[40:43]
    v_mfma_f32_16x16x32_bf16 v[44:47], v[196:199], v[244:247], v[44:47]
    s_waitcnt lgkmcnt(2)
    v_mfma_f32_16x16x32_bf16 v[48:51], v[192:195], v[216:219], v[48:51]
    ds_read_b128 v[232:235], v250 offset:21504
    ds_read_b128 v[236:239], v250 offset:32768
    v_mfma_f32_16x16x32_bf16 v[52:55], v[196:199], v[216:219], v[52:55]
    v_mfma_f32_16x16x32_bf16 v[56:59], v[208:211], v[216:219], v[56:59]
    v_mfma_f32_16x16x32_bf16 v[60:63], v[212:215], v[216:219], v[60:63]
    v_mfma_f32_16x16x32_bf16 v[48:51], v[200:203], v[220:223], v[48:51]
    v_mfma_f32_16x16x32_bf16 v[52:55], v[204:207], v[220:223], v[52:55]
    v_mfma_f32_16x16x32_bf16 v[56:59], v[192:195], v[220:223], v[56:59]
    v_mfma_f32_16x16x32_bf16 v[60:63], v[196:199], v[220:223], v[60:63]
    s_waitcnt lgkmcnt(2)
    v_mfma_f32_16x16x32_bf16 v[64:67], v[192:195], v[224:227], v[64:67]
    ds_read_b128 v[240:243], v250 offset:22528
    ds_read_b128 v[244:247], v250 offset:33792
    v_mfma_f32_16x16x32_bf16 v[68:71], v[196:199], v[224:227], v[68:71]
    v_mfma_f32_16x16x32_bf16 v[72:75], v[208:211], v[224:227], v[72:75]
    v_mfma_f32_16x16x32_bf16 v[76:79], v[212:215], v[224:227], v[76:79]
    v_mfma_f32_16x16x32_bf16 v[64:67], v[200:203], v[228:231], v[64:67]
    v_mfma_f32_16x16x32_bf16 v[68:71], v[204:207], v[228:231], v[68:71]
    v_mfma_f32_16x16x32_bf16 v[72:75], v[192:195], v[228:231], v[72:75]
    v_mfma_f32_16x16x32_bf16 v[76:79], v[196:199], v[228:231], v[76:79]
    s_waitcnt lgkmcnt(2)
    v_mfma_f32_16x16x32_bf16 v[80:83], v[192:195], v[232:235], v[80:83]
    ds_read_b128 v[216:219], v250 offset:23552
    ds_read_b128 v[220:223], v250 offset:34816
    v_mfma_f32_16x16x32_bf16 v[84:87], v[196:199], v[232:235], v[84:87]
    v_mfma_f32_16x16x32_bf16 v[88:91], v[208:211], v[232:235], v[88:91]
    v_mfma_f32_16x16x32_bf16 v[92:95], v[212:215], v[232:235], v[92:95]
    v_mfma_f32_16x16x32_bf16 v[80:83], v[200:203], v[236:239], v[80:83]
    v_add_u32 v248, 0xfffe3800, v248
    v_add_u32 v249, 0xfffe3800, v249
    v_mfma_f32_16x16x32_bf16 v[84:87], v[204:207], v[236:239], v[84:87]
    v_mfma_f32_16x16x32_bf16 v[88:91], v[192:195], v[236:239], v[88:91]
    v_mfma_f32_16x16x32_bf16 v[92:95], v[196:199], v[236:239], v[92:95]
    s_waitcnt lgkmcnt(2)
    v_mfma_f32_16x16x32_bf16 v[96:99], v[192:195], v[240:243], v[96:99]
    ds_read_b128 v[224:227], v250 offset:24576
    ds_read_b128 v[228:231], v250 offset:35840
    v_mfma_f32_16x16x32_bf16 v[100:103], v[196:199], v[240:243], v[100:103]
    v_mfma_f32_16x16x32_bf16 v[104:107], v[208:211], v[240:243], v[104:107]
    v_mfma_f32_16x16x32_bf16 v[108:111], v[212:215], v[240:243], v[108:111]
    ds_read_b64_tr_b16 v[176:177], v248 offset:0
    ds_read_b64_tr_b16 v[178:179], v248 offset:1024
    ds_read_b64_tr_b16 v[180:181], v249 offset:0
    ds_read_b64_tr_b16 v[182:183], v249 offset:1024
    v_mfma_f32_16x16x32_bf16 v[96:99], v[200:203], v[244:247], v[96:99]
    v_mfma_f32_16x16x32_bf16 v[100:103], v[204:207], v[244:247], v[100:103]
    v_mfma_f32_16x16x32_bf16 v[104:107], v[192:195], v[244:247], v[104:107]
    v_mfma_f32_16x16x32_bf16 v[108:111], v[196:199], v[244:247], v[108:111]
    s_waitcnt lgkmcnt(6)
    v_mfma_f32_16x16x32_bf16 v[112:115], v[192:195], v[216:219], v[112:115]
    ds_read_b128 v[232:235], v250 offset:25600
    ds_read_b128 v[236:239], v250 offset:36864
    v_mfma_f32_16x16x32_bf16 v[116:119], v[196:199], v[216:219], v[116:119]
    v_mfma_f32_16x16x32_bf16 v[120:123], v[208:211], v[216:219], v[120:123]
    v_mfma_f32_16x16x32_bf16 v[124:127], v[212:215], v[216:219], v[124:127]
    ds_read_b64_tr_b16 v[184:185], v248 offset:8192
    ds_read_b64_tr_b16 v[186:187], v248 offset:9216
    ds_read_b64_tr_b16 v[188:189], v249 offset:8192
    ds_read_b64_tr_b16 v[190:191], v249 offset:9216
    v_mfma_f32_16x16x32_bf16 v[112:115], v[200:203], v[220:223], v[112:115]
    v_mfma_f32_16x16x32_bf16 v[116:119], v[204:207], v[220:223], v[116:119]
    v_mfma_f32_16x16x32_bf16 v[120:123], v[192:195], v[220:223], v[120:123]
    v_mfma_f32_16x16x32_bf16 v[124:127], v[196:199], v[220:223], v[124:127]
    s_waitcnt lgkmcnt(10)
    v_mfma_f32_16x16x32_bf16 v[128:131], v[192:195], v[224:227], v[128:131]
    ds_read_b128 v[240:243], v250 offset:26624
    ds_read_b128 v[244:247], v250 offset:37888
    v_mfma_f32_16x16x32_bf16 v[132:135], v[196:199], v[224:227], v[132:135]
    v_mfma_f32_16x16x32_bf16 v[136:139], v[208:211], v[224:227], v[136:139]
    v_mfma_f32_16x16x32_bf16 v[140:143], v[212:215], v[224:227], v[140:143]
    v_mfma_f32_16x16x32_bf16 v[128:131], v[200:203], v[228:231], v[128:131]
    v_mfma_f32_16x16x32_bf16 v[132:135], v[204:207], v[228:231], v[132:135]
    v_mfma_f32_16x16x32_bf16 v[136:139], v[192:195], v[228:231], v[136:139]
    v_mfma_f32_16x16x32_bf16 v[140:143], v[196:199], v[228:231], v[140:143]
    s_waitcnt lgkmcnt(6)
    v_mfma_f32_16x16x32_bf16 v[144:147], v[192:195], v[232:235], v[144:147]
    v_add_u32 v250, 0xfffe3800, v250
    ds_read_b128 v[216:219], v250 offset:16384
    ds_read_b128 v[220:223], v250 offset:27648
    v_mfma_f32_16x16x32_bf16 v[148:151], v[196:199], v[232:235], v[148:151]
    v_mfma_f32_16x16x32_bf16 v[152:155], v[208:211], v[232:235], v[152:155]
    v_mfma_f32_16x16x32_bf16 v[156:159], v[212:215], v[232:235], v[156:159]
    v_mfma_f32_16x16x32_bf16 v[144:147], v[200:203], v[236:239], v[144:147]
    s_waitcnt lgkmcnt(4)
    v_xor_b32 v212, 0x80008000, v188
    v_xor_b32 v213, 0x80008000, v189
    v_mfma_f32_16x16x32_bf16 v[148:151], v[204:207], v[236:239], v[148:151]
    v_xor_b32 v214, 0x80008000, v190
    v_xor_b32 v215, 0x80008000, v191
    v_mfma_f32_16x16x32_bf16 v[152:155], v[192:195], v[236:239], v[152:155]
    v_mfma_f32_16x16x32_bf16 v[156:159], v[196:199], v[236:239], v[156:159]
    s_waitcnt lgkmcnt(2)
    v_mfma_f32_16x16x32_bf16 v[160:163], v[192:195], v[240:243], v[160:163]
    ds_read_b128 v[224:227], v250 offset:17408
    ds_read_b128 v[228:231], v250 offset:28672
    v_mfma_f32_16x16x32_bf16 v[164:167], v[208:211], v[240:243], v[164:167]
    v_xor_b32 v208, 0x80008000, v184
    v_xor_b32 v209, 0x80008000, v185
    v_mfma_f32_16x16x32_bf16 v[160:163], v[200:203], v[244:247], v[160:163]
    v_xor_b32 v210, 0x80008000, v186
    v_xor_b32 v211, 0x80008000, v187
    v_mfma_f32_16x16x32_bf16 v[164:167], v[192:195], v[244:247], v[164:167]
    s_sub_u32 s46, s46, 1
    s_cmp_lg_u32 s46, 0
    s_cbranch_scc1 L_g_loop
    s_barrier
    s_waitcnt lgkmcnt(2)
    v_mfma_f32_16x16x32_bf16 v[0:3], v[176:179], v[216:219], v[0:3]
    ds_read_b128 v[232:235], v250 offset:18432
    ds_read_b128 v[236:239], v250 offset:29696
    v_mfma_f32_16x16x32_bf16 v[4:7], v[180:183], v[216:219], v[4:7]
    v_mfma_f32_16x16x32_bf16 v[8:11], v[208:211], v[216:219], v[8:11]
    v_mfma_f32_16x16x32_bf16 v[12:15], v[212:215], v[216:219], v[12:15]
    v_mfma_f32_16x16x32_bf16 v[0:3], v[184:187], v[220:223], v[0:3]
    v_mfma_f32_16x16x32_bf16 v[4:7], v[188:191], v[220:223], v[4:7]
    v_mfma_f32_16x16x32_bf16 v[8:11], v[176:179], v[220:223], v[8:11]
    v_mfma_f32_16x16x32_bf16 v[12:15], v[180:183], v[220:223], v[12:15]
    s_waitcnt lgkmcnt(2)
    v_mfma_f32_16x16x32_bf16 v[16:19], v[176:179], v[224:227], v[16:19]
    ds_read_b128 v[240:243], v250 offset:19456
    ds_read_b128 v[244:247], v250 offset:30720
    v_mfma_f32_16x16x32_bf16 v[20:23], v[180:183], v[224:227], v[20:23]
    v_mfma_f32_16x16x32_bf16 v[24:27], v[208:211], v[224:227], v[24:27]
    v_mfma_f32_16x16x32_bf16 v[28:31], v[212:215], v[224:227], v[28:31]
    v_mfma_f32_16x16x32_bf16 v[16:19], v[184:187], v[228:231], v[16:19]
    v_mfma_f32_16x16x32_bf16 v[20:23], v[188:191], v[228:231], v[20:23]
    v_mfma_f32_16x16x32_bf16 v[24:27], v[176:179], v[228:231], v[24:27]
    v_mfma_f32_16x16x32_bf16 v[28:31], v[180:183], v[228:231], v[28:31]
    s_waitcnt lgkmcnt(2)
    v_mfma_f32_16x16x32_bf16 v[32:35], v[176:179], v[232:235], v[32:35]
    ds_read_b128 v[216:219], v250 offset:20480
    ds_read_b128 v[220:223], v250 offset:31744
    v_mfma_f32_16x16x32_bf16 v[36:39], v[180:183], v[232:235], v[36:39]
    v_mfma_f32_16x16x32_bf16 v[40:43], v[208:211], v[232:235], v[40:43]
    v_mfma_f32_16x16x32_bf16 v[44:47], v[212:215], v[232:235], v[44:47]
    v_mfma_f32_16x16x32_bf16 v[32:35], v[184:187], v[236:239], v[32:35]
    v_mfma_f32_16x16x32_bf16 v[36:39], v[188:191], v[236:239], v[36:39]
    v_mfma_f32_16x16x32_bf16 v[40:43], v[176:179], v[236:239], v[40:43]
    v_mfma_f32_16x16x32_bf16 v[44:47], v[180:183], v[236:239], v[44:47]
    s_waitcnt lgkmcnt(2)
    v_mfma_f32_16x16x32_bf16 v[48:51], v[176:179], v[240:243], v[48:51]
    ds_read_b128 v[224:227], v250 offset:21504
    ds_read_b128 v[228:231], v250 offset:32768
    v_mfma_f32_16x16x32_bf16 v[52:55], v[180:183], v[240:243], v[52:55]
    v_mfma_f32_16x16x32_bf16 v[56:59], v[208:211], v[240:243], v[56:59]
    v_mfma_f32_16x16x32_bf16 v[60:63], v[212:215], v[240:243], v[60:63]
    v_mfma_f32_16x16x32_bf16 v[48:51], v[184:187], v[244:247], v[48:51]
    v_mfma_f32_16x16x32_bf16 v[52:55], v[188:191], v[244:247], v[52:55]
    v_mfma_f32_16x16x32_bf16 v[56:59], v[176:179], v[244:247], v[56:59]
    v_mfma_f32_16x16x32_bf16 v[60:63], v[180:183], v[244:247], v[60:63]
    s_waitcnt lgkmcnt(2)
    v_mfma_f32_16x16x32_bf16 v[64:67], v[176:179], v[216:219], v[64:67]
    ds_read_b128 v[232:235], v250 offset:22528
    ds_read_b128 v[236:239], v250 offset:33792
    v_mfma_f32_16x16x32_bf16 v[68:71], v[180:183], v[216:219], v[68:71]
    v_mfma_f32_16x16x32_bf16 v[72:75], v[208:211], v[216:219], v[72:75]
    v_mfma_f32_16x16x32_bf16 v[76:79], v[212:215], v[216:219], v[76:79]
    v_mfma_f32_16x16x32_bf16 v[64:67], v[184:187], v[220:223], v[64:67]
    v_mfma_f32_16x16x32_bf16 v[68:71], v[188:191], v[220:223], v[68:71]
    v_mfma_f32_16x16x32_bf16 v[72:75], v[176:179], v[220:223], v[72:75]
    v_mfma_f32_16x16x32_bf16 v[76:79], v[180:183], v[220:223], v[76:79]
    s_waitcnt lgkmcnt(2)
    v_mfma_f32_16x16x32_bf16 v[80:83], v[176:179], v[224:227], v[80:83]
    ds_read_b128 v[240:243], v250 offset:23552
    ds_read_b128 v[244:247], v250 offset:34816
    v_mfma_f32_16x16x32_bf16 v[84:87], v[180:183], v[224:227], v[84:87]
    v_mfma_f32_16x16x32_bf16 v[88:91], v[208:211], v[224:227], v[88:91]
    v_mfma_f32_16x16x32_bf16 v[92:95], v[212:215], v[224:227], v[92:95]
    v_mfma_f32_16x16x32_bf16 v[80:83], v[184:187], v[228:231], v[80:83]
    v_add_u32 v248, 0x9800, v248
    v_add_u32 v249, 0x9800, v249
    v_mfma_f32_16x16x32_bf16 v[84:87], v[188:191], v[228:231], v[84:87]
    v_mfma_f32_16x16x32_bf16 v[88:91], v[176:179], v[228:231], v[88:91]
    v_mfma_f32_16x16x32_bf16 v[92:95], v[180:183], v[228:231], v[92:95]
    s_waitcnt lgkmcnt(2)
    v_mfma_f32_16x16x32_bf16 v[96:99], v[176:179], v[232:235], v[96:99]
    ds_read_b128 v[216:219], v250 offset:24576
    ds_read_b128 v[220:223], v250 offset:35840
    v_mfma_f32_16x16x32_bf16 v[100:103], v[180:183], v[232:235], v[100:103]
    v_mfma_f32_16x16x32_bf16 v[104:107], v[208:211], v[232:235], v[104:107]
    v_mfma_f32_16x16x32_bf16 v[108:111], v[212:215], v[232:235], v[108:111]
    ds_read_b64_tr_b16 v[192:193], v248 offset:0
    ds_read_b64_tr_b16 v[194:195], v248 offset:1024
    ds_read_b64_tr_b16 v[196:197], v249 offset:0
    ds_read_b64_tr_b16 v[198:199], v249 offset:1024
    v_mfma_f32_16x16x32_bf16 v[96:99], v[184:187], v[236:239], v[96:99]
    v_mfma_f32_16x16x32_bf16 v[100:103], v[188:191], v[236:239], v[100:103]
    v_mfma_f32_16x16x32_bf16 v[104:107], v[176:179], v[236:239], v[104:107]
    v_mfma_f32_16x16x32_bf16 v[108:111], v[180:183], v[236:239], v[108:111]
    s_waitcnt lgkmcnt(6)
    v_mfma_f32_16x16x32_bf16 v[112:115], v[176:179], v[240:243], v[112:115]
    ds_read_b128 v[224:227], v250 offset:25600
    ds_read_b128 v[228:231], v250 offset:36864
    v_mfma_f32_16x16x32_bf16 v[116:119], v[180:183], v[240:243], v[116:119]
    v_mfma_f32_16x16x32_bf16 v[120:123], v[208:211], v[240:243], v[120:123]
    v_mfma_f32_16x16x32_bf16 v[124:127], v[212:215], v[240:243], v[124:127]
    ds_read_b64_tr_b16 v[200:201], v248 offset:8192
    ds_read_b64_tr_b16 v[202:203], v248 offset:9216
    ds_read_b64_tr_b16 v[204:205], v249 offset:8192
    ds_read_b64_tr_b16 v[206:207], v249 offset:9216
    v_mfma_f32_16x16x32_bf16 v[112:115], v[184:187], v[244:247], v[112:115]
    v_mfma_f32_16x16x32_bf16 v[116:119], v[188:191], v[244:247], v[116:119]
    v_mfma_f32_16x16x32_bf16 v[120:123], v[176:179], v[244:247], v[120:123]
    v_mfma_f32_16x16x32_bf16 v[124:127], v[180:183], v[244:247], v[124:127]
    s_waitcnt lgkmcnt(10)
    v_mfma_f32_16x16x32_bf16 v[128:131], v[176:179], v[216:219], v[128:131]
    ds_read_b128 v[232:235], v250 offset:26624
    ds_read_b128 v[236:239], v250 offset:37888
    v_mfma_f32_16x16x32_bf16 v[132:135], v[180:183], v[216:219], v[132:135]
    v_mfma_f32_16x16x32_bf16 v[136:139], v[208:211], v[216:219], v[136:139]
    v_mfma_f32_16x16x32_bf16 v[140:143], v[212:215], v[216:219], v[140:143]
    v_mfma_f32_16x16x32_bf16 v[128:131], v[184:187], v[220:223], v[128:131]
    v_mfma_f32_16x16x32_bf16 v[132:135], v[188:191], v[220:223], v[132:135]
    v_mfma_f32_16x16x32_bf16 v[136:139], v[176:179], v[220:223], v[136:139]
    v_mfma_f32_16x16x32_bf16 v[140:143], v[180:183], v[220:223], v[140:143]
    s_waitcnt lgkmcnt(6)
    v_mfma_f32_16x16x32_bf16 v[144:147], v[176:179], v[224:227], v[144:147]
    v_add_u32 v250, 0x9800, v250
    ds_read_b128 v[240:243], v250 offset:16384
    ds_read_b128 v[244:247], v250 offset:27648
    v_mfma_f32_16x16x32_bf16 v[148:151], v[180:183], v[224:227], v[148:151]
    v_mfma_f32_16x16x32_bf16 v[152:155], v[208:211], v[224:227], v[152:155]
    v_mfma_f32_16x16x32_bf16 v[156:159], v[212:215], v[224:227], v[156:159]
    v_mfma_f32_16x16x32_bf16 v[144:147], v[184:187], v[228:231], v[144:147]
    s_waitcnt lgkmcnt(4)
    v_xor_b32 v212, 0x80008000, v204
    v_xor_b32 v213, 0x80008000, v205
    v_mfma_f32_16x16x32_bf16 v[148:151], v[188:191], v[228:231], v[148:151]
    v_xor_b32 v214, 0x80008000, v206
    v_xor_b32 v215, 0x80008000, v207
    v_mfma_f32_16x16x32_bf16 v[152:155], v[176:179], v[228:231], v[152:155]
    v_mfma_f32_16x16x32_bf16 v[156:159], v[180:183], v[228:231], v[156:159]
    s_waitcnt lgkmcnt(2)
    v_mfma_f32_16x16x32_bf16 v[160:163], v[176:179], v[232:235], v[160:163]
    ds_read_b128 v[216:219], v250 offset:17408
    ds_read_b128 v[220:223], v250 offset:28672
    v_mfma_f32_16x16x32_bf16 v[164:167], v[208:211], v[232:235], v[164:167]
    v_xor_b32 v208, 0x80008000, v200
    v_xor_b32 v209, 0x80008000, v201
    v_mfma_f32_16x16x32_bf16 v[160:163], v[184:187], v[236:239], v[160:163]
    v_xor_b32 v210, 0x80008000, v202
    v_xor_b32 v211, 0x80008000, v203
    v_mfma_f32_16x16x32_bf16 v[164:167], v[176:179], v[236:239], v[164:167]
    s_barrier
    s_waitcnt lgkmcnt(2)
    v_mfma_f32_16x16x32_bf16 v[0:3], v[192:195], v[240:243], v[0:3]
    ds_read_b128 v[224:227], v250 offset:18432
    ds_read_b128 v[228:231], v250 offset:29696
    v_mfma_f32_16x16x32_bf16 v[4:7], v[196:199], v[240:243], v[4:7]
    v_mfma_f32_16x16x32_bf16 v[8:11], v[208:211], v[240:243], v[8:11]
    v_mfma_f32_16x16x32_bf16 v[12:15], v[212:215], v[240:243], v[12:15]
    v_mfma_f32_16x16x32_bf16 v[0:3], v[200:203], v[244:247], v[0:3]
    v_mfma_f32_16x16x32_bf16 v[4:7], v[204:207], v[244:247], v[4:7]
    v_mfma_f32_16x16x32_bf16 v[8:11], v[192:195], v[244:247], v[8:11]
    v_mfma_f32_16x16x32_bf16 v[12:15], v[196:199], v[244:247], v[12:15]
    s_waitcnt lgkmcnt(2)
    v_mfma_f32_16x16x32_bf16 v[16:19], v[192:195], v[216:219], v[16:19]
    ds_read_b128 v[232:235], v250 offset:19456
    ds_read_b128 v[236:239], v250 offset:30720
    v_mfma_f32_16x16x32_bf16 v[20:23], v[196:199], v[216:219], v[20:23]
    v_mfma_f32_16x16x32_bf16 v[24:27], v[208:211], v[216:219], v[24:27]
    v_mfma_f32_16x16x32_bf16 v[28:31], v[212:215], v[216:219], v[28:31]
    v_mfma_f32_16x16x32_bf16 v[16:19], v[200:203], v[220:223], v[16:19]
    v_mfma_f32_16x16x32_bf16 v[20:23], v[204:207], v[220:223], v[20:23]
    v_mfma_f32_16x16x32_bf16 v[24:27], v[192:195], v[220:223], v[24:27]
    v_mfma_f32_16x16x32_bf16 v[28:31], v[196:199], v[220:223], v[28:31]
    s_waitcnt lgkmcnt(2)
    v_mfma_f32_16x16x32_bf16 v[32:35], v[192:195], v[224:227], v[32:35]
    ds_read_b128 v[240:243], v250 offset:20480
    ds_read_b128 v[244:247], v250 offset:31744
    v_mfma_f32_16x16x32_bf16 v[36:39], v[196:199], v[224:227], v[36:39]
    v_mfma_f32_16x16x32_bf16 v[40:43], v[208:211], v[224:227], v[40:43]
    v_mfma_f32_16x16x32_bf16 v[44:47], v[212:215], v[224:227], v[44:47]
    v_mfma_f32_16x16x32_bf16 v[32:35], v[200:203], v[228:231], v[32:35]
    v_mfma_f32_16x16x32_bf16 v[36:39], v[204:207], v[228:231], v[36:39]
    v_mfma_f32_16x16x32_bf16 v[40:43], v[192:195], v[228:231], v[40:43]
    v_mfma_f32_16x16x32_bf16 v[44:47], v[196:199], v[228:231], v[44:47]
    s_waitcnt lgkmcnt(2)
    v_mfma_f32_16x16x32_bf16 v[48:51], v[192:195], v[232:235], v[48:51]
    ds_read_b128 v[216:219], v250 offset:21504
    ds_read_b128 v[220:223], v250 offset:32768
    v_mfma_f32_16x16x32_bf16 v[52:55], v[196:199], v[232:235], v[52:55]
    v_mfma_f32_16x16x32_bf16 v[56:59], v[208:211], v[232:235], v[56:59]
    v_mfma_f32_16x16x32_bf16 v[60:63], v[212:215], v[232:235], v[60:63]
    v_mfma_f32_16x16x32_bf16 v[48:51], v[200:203], v[236:239], v[48:51]
    v_mfma_f32_16x16x32_bf16 v[52:55], v[204:207], v[236:239], v[52:55]
    v_mfma_f32_16x16x32_bf16 v[56:59], v[192:195], v[236:239], v[56:59]
    v_mfma_f32_16x16x32_bf16 v[60:63], v[196:199], v[236:239], v[60:63]
    s_waitcnt lgkmcnt(2)
    v_mfma_f32_16x16x32_bf16 v[64:67], v[192:195], v[240:243], v[64:67]
    ds_read_b128 v[224:227], v250 offset:22528
    ds_read_b128 v[228:231], v250 offset:33792
    v_mfma_f32_16x16x32_bf16 v[68:71], v[196:199], v[240:243], v[68:71]
    v_mfma_f32_16x16x32_bf16 v[72:75], v[208:211], v[240:243], v[72:75]
    v_mfma_f32_16x16x32_bf16 v[76:79], v[212:215], v[240:243], v[76:79]
    v_mfma_f32_16x16x32_bf16 v[64:67], v[200:203], v[244:247], v[64:67]
    v_mfma_f32_16x16x32_bf16 v[68:71], v[204:207], v[244:247], v[68:71]
    v_mfma_f32_16x16x32_bf16 v[72:75], v[192:195], v[244:247], v[72:75]
    v_mfma_f32_16x16x32_bf16 v[76:79], v[196:199], v[244:247], v[76:79]
    s_waitcnt lgkmcnt(2)
    v_mfma_f32_16x16x32_bf16 v[80:83], v[192:195], v[216:219], v[80:83]
    ds_read_b128 v[232:235], v250 offset:23552
    ds_read_b128 v[236:239], v250 offset:34816
    v_mfma_f32_16x16x32_bf16 v[84:87], v[196:199], v[216:219], v[84:87]
    v_mfma_f32_16x16x32_bf16 v[88:91], v[208:211], v[216:219], v[88:91]
    v_mfma_f32_16x16x32_bf16 v[92:95], v[212:215], v[216:219], v[92:95]
    v_mfma_f32_16x16x32_bf16 v[80:83], v[200:203], v[220:223], v[80:83]
    v_add_u32 v248, 0x9800, v248
    v_add_u32 v249, 0x9800, v249
    v_mfma_f32_16x16x32_bf16 v[84:87], v[204:207], v[220:223], v[84:87]
    v_mfma_f32_16x16x32_bf16 v[88:91], v[192:195], v[220:223], v[88:91]
    v_mfma_f32_16x16x32_bf16 v[92:95], v[196:199], v[220:223], v[92:95]
    s_waitcnt lgkmcnt(2)
    v_mfma_f32_16x16x32_bf16 v[96:99], v[192:195], v[224:227], v[96:99]
    ds_read_b128 v[240:243], v250 offset:24576
    ds_read_b128 v[244:247], v250 offset:35840
    v_mfma_f32_16x16x32_bf16 v[100:103], v[196:199], v[224:227], v[100:103]
    v_mfma_f32_16x16x32_bf16 v[104:107], v[208:211], v[224:227], v[104:107]
    v_mfma_f32_16x16x32_bf16 v[108:111], v[212:215], v[224:227], v[108:111]
    ds_read_b64_tr_b16 v[176:177], v248 offset:0
    ds_read_b64_tr_b16 v[178:179], v248 offset:1024
    ds_read_b64_tr_b16 v[180:181], v249 offset:0
    ds_read_b64_tr_b16 v[182:183], v249 offset:1024
    v_mfma_f32_16x16x32_bf16 v[96:99], v[200:203], v[228:231], v[96:99]
    v_mfma_f32_16x16x32_bf16 v[100:103], v[204:207], v[228:231], v[100:103]
    v_mfma_f32_16x16x32_bf16 v[104:107], v[192:195], v[228:231], v[104:107]
    v_mfma_f32_16x16x32_bf16 v[108:111], v[196:199], v[228:231], v[108:111]
    s_waitcnt lgkmcnt(6)
    v_mfma_f32_16x16x32_bf16 v[112:115], v[192:195], v[232:235], v[112:115]
    ds_read_b128 v[216:219], v250 offset:25600
    ds_read_b128 v[220:223], v250 offset:36864
    v_mfma_f32_16x16x32_bf16 v[116:119], v[196:199], v[232:235], v[116:119]
    v_mfma_f32_16x16x32_bf16 v[120:123], v[208:211], v[232:235], v[120:123]
    v_mfma_f32_16x16x32_bf16 v[124:127], v[212:215], v[232:235], v[124:127]
    ds_read_b64_tr_b16 v[184:185], v248 offset:8192
    ds_read_b64_tr_b16 v[186:187], v248 offset:9216
    ds_read_b64_tr_b16 v[188:189], v249 offset:8192
    ds_read_b64_tr_b16 v[190:191], v249 offset:9216
    v_mfma_f32_16x16x32_bf16 v[112:115], v[200:203], v[236:239], v[112:115]
    v_mfma_f32_16x16x32_bf16 v[116:119], v[204:207], v[236:239], v[116:119]
    v_mfma_f32_16x16x32_bf16 v[120:123], v[192:195], v[236:239], v[120:123]
    v_mfma_f32_16x16x32_bf16 v[124:127], v[196:199], v[236:239], v[124:127]
    s_waitcnt lgkmcnt(10)
    v_mfma_f32_16x16x32_bf16 v[128:131], v[192:195], v[240:243], v[128:131]
    ds_read_b128 v[224:227], v250 offset:26624
    ds_read_b128 v[228:231], v250 offset:37888
    v_mfma_f32_16x16x32_bf16 v[132:135], v[196:199], v[240:243], v[132:135]
    v_mfma_f32_16x16x32_bf16 v[136:139], v[208:211], v[240:243], v[136:139]
    v_mfma_f32_16x16x32_bf16 v[140:143], v[212:215], v[240:243], v[140:143]
    v_mfma_f32_16x16x32_bf16 v[128:131], v[200:203], v[244:247], v[128:131]
    v_mfma_f32_16x16x32_bf16 v[132:135], v[204:207], v[244:247], v[132:135]
    v_mfma_f32_16x16x32_bf16 v[136:139], v[192:195], v[244:247], v[136:139]
    v_mfma_f32_16x16x32_bf16 v[140:143], v[196:199], v[244:247], v[140:143]
    s_waitcnt lgkmcnt(6)
    v_mfma_f32_16x16x32_bf16 v[144:147], v[192:195], v[216:219], v[144:147]
    v_add_u32 v250, 0x9800, v250
    ds_read_b128 v[232:235], v250 offset:16384
    ds_read_b128 v[236:239], v250 offset:27648
    v_mfma_f32_16x16x32_bf16 v[148:151], v[196:199], v[216:219], v[148:151]
    v_mfma_f32_16x16x32_bf16 v[152:155], v[208:211], v[216:219], v[152:155]
    v_mfma_f32_16x16x32_bf16 v[156:159], v[212:215], v[216:219], v[156:159]
    v_mfma_f32_16x16x32_bf16 v[144:147], v[200:203], v[220:223], v[144:147]
    s_waitcnt lgkmcnt(4)
    v_xor_b32 v212, 0x80008000, v188
    v_xor_b32 v213, 0x80008000, v189
    v_mfma_f32_16x16x32_bf16 v[148:151], v[204:207], v[220:223], v[148:151]
    v_xor_b32 v214, 0x80008000, v190
    v_xor_b32 v215, 0x80008000, v191
    v_mfma_f32_16x16x32_bf16 v[152:155], v[192:195], v[220:223], v[152:155]
    v_mfma_f32_16x16x32_bf16 v[156:159], v[196:199], v[220:223], v[156:159]
    s_waitcnt lgkmcnt(2)
    v_mfma_f32_16x16x32_bf16 v[160:163], v[192:195], v[224:227], v[160:163]
    ds_read_b128 v[240:243], v250 offset:17408
    ds_read_b128 v[244:247], v250 offset:28672
    v_mfma_f32_16x16x32_bf16 v[164:167], v[208:211], v[224:227], v[164:167]
    v_xor_b32 v208, 0x80008000, v184
    v_xor_b32 v209, 0x80008000, v185
    v_mfma_f32_16x16x32_bf16 v[160:163], v[200:203], v[228:231], v[160:163]
    v_xor_b32 v210, 0x80008000, v186
    v_xor_b32 v211, 0x80008000, v187
    v_mfma_f32_16x16x32_bf16 v[164:167], v[192:195], v[228:231], v[164:167]
    s_barrier
    s_cmp_lg_u32 s13, 0
    s_cbranch_scc1 L_epi_b1
    v_add_u32 v248, 0x9800, v248
    v_add_u32 v249, 0x9800, v249
    v_add_u32 v253, 38912, v250
    ds_read_b64_tr_b16 v[192:193], v248 offset:0
    ds_read_b64_tr_b16 v[194:195], v248 offset:1024
    ds_read_b64_tr_b16 v[196:197], v249 offset:0
    ds_read_b64_tr_b16 v[198:199], v249 offset:1024
    ds_read_b64_tr_b16 v[200:201], v248 offset:8192
    ds_read_b64_tr_b16 v[202:203], v248 offset:9216
    ds_read_b64_tr_b16 v[204:205], v249 offset:8192
    ds_read_b64_tr_b16 v[206:207], v249 offset:9216
    s_waitcnt lgkmcnt(10)
    v_mfma_f32_16x16x32_bf16 v[0:3], v[176:179], v[232:235], v[0:3]
    ds_read_b128 v[216:219], v250 offset:18432
    ds_read_b128 v[220:223], v250 offset:29696
    v_mfma_f32_16x16x32_bf16 v[4:7], v[180:183], v[232:235], v[4:7]
    v_mfma_f32_16x16x32_bf16 v[8:11], v[208:211], v[232:235], v[8:11]
    v_mfma_f32_16x16x32_bf16 v[12:15], v[212:215], v[232:235], v[12:15]
    v_mfma_f32_16x16x32_bf16 v[0:3], v[184:187], v[236:239], v[0:3]
    v_mfma_f32_16x16x32_bf16 v[4:7], v[188:191], v[236:239], v[4:7]
    v_mfma_f32_16x16x32_bf16 v[8:11], v[176:179], v[236:239], v[8:11]
    v_mfma_f32_16x16x32_bf16 v[12:15], v[180:183], v[236:239], v[12:15]
    s_waitcnt lgkmcnt(10)
    v_mfma_f32_16x16x32_bf16 v[16:19], v[176:179], v[240:243], v[16:19]
    ds_read_b128 v[224:227], v253 offset:16384
    ds_read_b128 v[228:231], v253 offset:27648
    v_mfma_f32_16x16x32_bf16 v[20:23], v[180:183], v[240:243], v[20:23]
    v_mfma_f32_16x16x32_bf16 v[24:27], v[208:211], v[240:243], v[24:27]
    v_mfma_f32_16x16x32_bf16 v[28:31], v[212:215], v[240:243], v[28:31]
    v_mfma_f32_16x16x32_bf16 v[16:19], v[184:187], v[244:247], v[16:19]
    v_mfma_f32_16x16x32_bf16 v[20:23], v[188:191], v[244:247], v[20:23]
    v_mfma_f32_16x16x32_bf16 v[24:27], v[176:179], v[244:247], v[24:27]
    v_mfma_f32_16x16x32_bf16 v[28:31], v[180:183], v[244:247], v[28:31]
    s_waitcnt lgkmcnt(2)
    v_mfma_f32_16x16x32_bf16 v[32:35], v[176:179], v[216:219], v[32:35]
    ds_read_b128 v[232:235], v250 offset:19456
    ds_read_b128 v[236:239], v250 offset:30720
    v_mfma_f32_16x16x32_bf16 v[36:39], v[180:183], v[216:219], v[36:39]
    v_mfma_f32_16x16x32_bf16 v[40:43], v[208:211], v[216:219], v[40:43]
    v_mfma_f32_16x16x32_bf16 v[44:47], v[212:215], v[216:219], v[44:47]
    v_mfma_f32_16x16x32_bf16 v[32:35], v[184:187], v[220:223], v[32:35]
    v_mfma_f32_16x16x32_bf16 v[36:39], v[188:191], v[220:223], v[36:39]
    v_mfma_f32_16x16x32_bf16 v[40:43], v[176:179], v[220:223], v[40:43]
    v_mfma_f32_16x16x32_bf16 v[44:47], v[180:183], v[220:223], v[44:47]
    v_xor_b32 v168, 0x80008000, v200
    v_xor_b32 v169, 0x80008000, v201
    v_xor_b32 v170, 0x80008000, v202
    v_xor_b32 v171, 0x80008000, v203
    v_xor_b32 v172, 0x80008000, v204
    v_xor_b32 v173, 0x80008000, v205
    v_xor_b32 v174, 0x80008000, v206
    v_xor_b32 v175, 0x80008000, v207
    s_waitcnt lgkmcnt(2)
    v_mfma_f32_16x16x32_bf16 v[0:3], v[192:195], v[224:227], v[0:3]
    ds_read_b128 v[240:243], v253 offset:17408
    ds_read_b128 v[244:247], v253 offset:28672
    v_mfma_f32_16x16x32_bf16 v[4:7], v[196:199], v[224:227], v[4:7]
    v_mfma_f32_16x16x32_bf16 v[8:11], v[168:171], v[224:227], v[8:11]
    v_mfma_f32_16x16x32_bf16 v[12:15], v[172:175], v[224:227], v[12:15]
    v_mfma_f32_16x16x32_bf16 v[0:3], v[200:203], v[228:231], v[0:3]
    v_mfma_f32_16x16x32_bf16 v[4:7], v[204:207], v[228:231], v[4:7]
    v_mfma_f32_16x16x32_bf16 v[8:11], v[192:195], v[228:231], v[8:11]
    v_mfma_f32_16x16x32_bf16 v[12:15], v[196:199], v[228:231], v[12:15]
    s_waitcnt lgkmcnt(2)
    v_mfma_f32_16x16x32_bf16 v[48:51], v[176:179], v[232:235], v[48:51]
    ds_read_b128 v[216:219], v250 offset:20480
    ds_read_b128 v[220:223], v250 offset:31744
    v_mfma_f32_16x16x32_bf16 v[52:55], v[180:183], v[232:235], v[52:55]
    v_mfma_f32_16x16x32_bf16 v[56:59], v[208:211], v[232:235], v[56:59]
    v_mfma_f32_16x16x32_bf16 v[60:63], v[212:215], v[232:235], v[60:63]
    v_mfma_f32_16x16x32_bf16 v[48:51], v[184:187], v[236:239], v[48:51]
    v_mfma_f32_16x16x32_bf16 v[52:55], v[188:191], v[236:239], v[52:55]
    v_mfma_f32_16x16x32_bf16 v[56:59], v[176:179], v[236:239], v[56:59]
    v_mfma_f32_16x16x32_bf16 v[60:63], v[180:183], v[236:239], v[60:63]
    s_waitcnt lgkmcnt(2)
    v_mfma_f32_16x16x32_bf16 v[16:19], v[192:195], v[240:243], v[16:19]
    ds_read_b128 v[224:227], v253 offset:18432
    ds_read_b128 v[228:231], v253 offset:29696
    v_mfma_f32_16x16x32_bf16 v[20:23], v[196:199], v[240:243], v[20:23]
    v_cvt_pk_bf16_f32 v0, v0, v1
    v_cvt_pk_bf16_f32 v1, v2, v3
    v_mfma_f32_16x16x32_bf16 v[24:27], v[168:171], v[240:243], v[24:27]
    v_cvt_pk_bf16_f32 v2, v4, v5
    v_cvt_pk_bf16_f32 v3, v6, v7
    v_mfma_f32_16x16x32_bf16 v[28:31], v[172:175], v[240:243], v[28:31]
    s_add_u32 s47, s48, 0
    buffer_store_dwordx4 v[0:3], v251, s[16:19], s47 offen sc1
    v_mfma_f32_16x16x32_bf16 v[16:19], v[200:203], v[244:247], v[16:19]
    v_cvt_pk_bf16_f32 v8, v8, v9
    v_cvt_pk_bf16_f32 v9, v10, v11
    v_mfma_f32_16x16x32_bf16 v[20:23], v[204:207], v[244:247], v[20:23]
    v_cvt_pk_bf16_f32 v10, v12, v13
    v_cvt_pk_bf16_f32 v11, v14, v15
    v_mfma_f32_16x16x32_bf16 v[24:27], v[192:195], v[244:247], v[24:27]
    s_add_u32 s47, s48, 1024
    buffer_store_dwordx4 v[8:11], v251, s[16:19], s47 offen sc1
    v_mfma_f32_16x16x32_bf16 v[28:31], v[196:199], v[244:247], v[28:31]
    s_waitcnt lgkmcnt(2)
    v_mfma_f32_16x16x32_bf16 v[64:67], v[176:179], v[216:219], v[64:67]
    ds_read_b128 v[232:235], v250 offset:21504
    ds_read_b128 v[236:239], v250 offset:32768
    v_mfma_f32_16x16x32_bf16 v[68:71], v[180:183], v[216:219], v[68:71]
    v_mfma_f32_16x16x32_bf16 v[72:75], v[208:211], v[216:219], v[72:75]
    v_mfma_f32_16x16x32_bf16 v[76:79], v[212:215], v[216:219], v[76:79]
    v_mfma_f32_16x16x32_bf16 v[64:67], v[184:187], v[220:223], v[64:67]
    v_mfma_f32_16x16x32_bf16 v[68:71], v[188:191], v[220:223], v[68:71]
    v_mfma_f32_16x16x32_bf16 v[72:75], v[176:179], v[220:223], v[72:75]
    v_mfma_f32_16x16x32_bf16 v[76:79], v[180:183], v[220:223], v[76:79]
    s_waitcnt lgkmcnt(2)
    v_mfma_f32_16x16x32_bf16 v[32:35], v[192:195], v[224:227], v[32:35]
    ds_read_b128 v[240:243], v253 offset:19456
    ds_read_b128 v[244:247], v253 offset:30720
    v_mfma_f32_16x16x32_bf16 v[36:39], v[196:199], v[224:227], v[36:39]
    v_cvt_pk_bf16_f32 v16, v16, v17
    v_cvt_pk_bf16_f32 v17, v18, v19
    v_mfma_f32_16x16x32_bf16 v[40:43], v[168:171], v[224:227], v[40:43]
    v_cvt_pk_bf16_f32 v18, v20, v21
    v_cvt_pk_bf16_f32 v19, v22, v23
    v_mfma_f32_16x16x32_bf16 v[44:47], v[172:175], v[224:227], v[44:47]
    s_add_u32 s47, s48, 1052672
    buffer_store_dwordx4 v[16:19], v251, s[16:19], s47 offen sc1
    v_mfma_f32_16x16x32_bf16 v[32:35], v[200:203], v[228:231], v[32:35]
    v_cvt_pk_bf16_f32 v24, v24, v25
    v_cvt_pk_bf16_f32 v25, v26, v27
    v_mfma_f32_16x16x32_bf16 v[36:39], v[204:207], v[228:231], v[36:39]
    v_cvt_pk_bf16_f32 v26, v28, v29
    v_cvt_pk_bf16_f32 v27, v30, v31
    v_mfma_f32_16x16x32_bf16 v[40:43], v[192:195], v[228:231], v[40:43]
    s_add_u32 s47, s48, 1053696
    buffer_store_dwordx4 v[24:27], v251, s[16:19], s47 offen sc1
    v_mfma_f32_16x16x32_bf16 v[44:47], v[196:199], v[228:231], v[44:47]
    s_waitcnt lgkmcnt(2)
    v_mfma_f32_16x16x32_bf16 v[80:83], v[176:179], v[232:235], v[80:83]
    ds_read_b128 v[216:219], v250 offset:22528
    ds_read_b128 v[220:223], v250 offset:33792
    v_mfma_f32_16x16x32_bf16 v[84:87], v[180:183], v[232:235], v[84:87]
    v_mfma_f32_16x16x32_bf16 v[88:91], v[208:211], v[232:235], v[88:91]
    v_mfma_f32_16x16x32_bf16 v[92:95], v[212:215], v[232:235], v[92:95]
    v_mfma_f32_16x16x32_bf16 v[80:83], v[184:187], v[236:239], v[80:83]
    v_mfma_f32_16x16x32_bf16 v[84:87], v[188:191], v[236:239], v[84:87]
    v_mfma_f32_16x16x32_bf16 v[88:91], v[176:179], v[236:239], v[88:91]
    v_mfma_f32_16x16x32_bf16 v[92:95], v[180:183], v[236:239], v[92:95]
    s_waitcnt lgkmcnt(2)
    v_mfma_f32_16x16x32_bf16 v[48:51], v[192:195], v[240:243], v[48:51]
    ds_read_b128 v[224:227], v253 offset:20480
    ds_read_b128 v[228:231], v253 offset:31744
    v_mfma_f32_16x16x32_bf16 v[52:55], v[196:199], v[240:243], v[52:55]
    v_cvt_pk_bf16_f32 v32, v32, v33
    v_cvt_pk_bf16_f32 v33, v34, v35
    v_mfma_f32_16x16x32_bf16 v[56:59], v[168:171], v[240:243], v[56:59]
    v_cvt_pk_bf16_f32 v34, v36, v37
    v_cvt_pk_bf16_f32 v35, v38, v39
    v_mfma_f32_16x16x32_bf16 v[60:63], v[172:175], v[240:243], v[60:63]
    s_add_u32 s47, s48, 2105344
    buffer_store_dwordx4 v[32:35], v251, s[16:19], s47 offen sc1
    v_mfma_f32_16x16x32_bf16 v[48:51], v[200:203], v[244:247], v[48:51]
    v_cvt_pk_bf16_f32 v40, v40, v41
    v_cvt_pk_bf16_f32 v41, v42, v43
    v_mfma_f32_16x16x32_bf16 v[52:55], v[204:207], v[244:247], v[52:55]
    v_cvt_pk_bf16_f32 v42, v44, v45
    v_cvt_pk_bf16_f32 v43, v46, v47
    v_mfma_f32_16x16x32_bf16 v[56:59], v[192:195], v[244:247], v[56:59]
    s_add_u32 s47, s48, 2106368
    buffer_store_dwordx4 v[40:43], v251, s[16:19], s47 offen sc1
    v_mfma_f32_16x16x32_bf16 v[60:63], v[196:199], v[244:247], v[60:63]
    s_waitcnt lgkmcnt(2)
    v_mfma_f32_16x16x32_bf16 v[96:99], v[176:179], v[216:219], v[96:99]
    ds_read_b128 v[232:235], v250 offset:23552
    ds_read_b128 v[236:239], v250 offset:34816
    v_mfma_f32_16x16x32_bf16 v[100:103], v[180:183], v[216:219], v[100:103]
    v_mfma_f32_16x16x32_bf16 v[104:107], v[208:211], v[216:219], v[104:107]
    v_mfma_f32_16x16x32_bf16 v[108:111], v[212:215], v[216:219], v[108:111]
    v_mfma_f32_16x16x32_bf16 v[96:99], v[184:187], v[220:223], v[96:99]
    v_mfma_f32_16x16x32_bf16 v[100:103], v[188:191], v[220:223], v[100:103]
    v_mfma_f32_16x16x32_bf16 v[104:107], v[176:179], v[220:223], v[104:107]
    v_mfma_f32_16x16x32_bf16 v[108:111], v[180:183], v[220:223], v[108:111]
    s_waitcnt lgkmcnt(2)
    v_mfma_f32_16x16x32_bf16 v[64:67], v[192:195], v[224:227], v[64:67]
    ds_read_b128 v[240:243], v253 offset:21504
    ds_read_b128 v[244:247], v253 offset:32768
    v_mfma_f32_16x16x32_bf16 v[68:71], v[196:199], v[224:227], v[68:71]
    v_cvt_pk_bf16_f32 v48, v48, v49
    v_cvt_pk_bf16_f32 v49, v50, v51
    v_mfma_f32_16x16x32_bf16 v[72:75], v[168:171], v[224:227], v[72:75]
    v_cvt_pk_bf16_f32 v50, v52, v53
    v_cvt_pk_bf16_f32 v51, v54, v55
    v_mfma_f32_16x16x32_bf16 v[76:79], v[172:175], v[224:227], v[76:79]
    s_add_u32 s47, s48, 3158016
    buffer_store_dwordx4 v[48:51], v251, s[16:19], s47 offen sc1
    v_mfma_f32_16x16x32_bf16 v[64:67], v[200:203], v[228:231], v[64:67]
    v_cvt_pk_bf16_f32 v56, v56, v57
    v_cvt_pk_bf16_f32 v57, v58, v59
    v_mfma_f32_16x16x32_bf16 v[68:71], v[204:207], v[228:231], v[68:71]
    v_cvt_pk_bf16_f32 v58, v60, v61
    v_cvt_pk_bf16_f32 v59, v62, v63
    v_mfma_f32_16x16x32_bf16 v[72:75], v[192:195], v[228:231], v[72:75]
    s_add_u32 s47, s48, 3159040
    buffer_store_dwordx4 v[56:59], v251, s[16:19], s47 offen sc1
    v_mfma_f32_16x16x32_bf16 v[76:79], v[196:199], v[228:231], v[76:79]
    s_waitcnt lgkmcnt(2)
    v_mfma_f32_16x16x32_bf16 v[112:115], v[176:179], v[232:235], v[112:115]
    ds_read_b128 v[216:219], v250 offset:24576
    ds_read_b128 v[220:223], v250 offset:35840
    v_mfma_f32_16x16x32_bf16 v[116:119], v[180:183], v[232:235], v[116:119]
    v_mfma_f32_16x16x32_bf16 v[120:123], v[208:211], v[232:235], v[120:123]
    v_mfma_f32_16x16x32_bf16 v[124:127], v[212:215], v[232:235], v[124:127]
    v_mfma_f32_16x16x32_bf16 v[112:115], v[184:187], v[236:239], v[112:115]
    v_mfma_f32_16x16x32_bf16 v[116:119], v[188:191], v[236:239], v[116:119]
    v_mfma_f32_16x16x32_bf16 v[120:123], v[176:179], v[236:239], v[120:123]
    v_mfma_f32_16x16x32_bf16 v[124:127], v[180:183], v[236:239], v[124:127]
    s_waitcnt lgkmcnt(2)
    v_mfma_f32_16x16x32_bf16 v[80:83], v[192:195], v[240:243], v[80:83]
    ds_read_b128 v[224:227], v253 offset:22528
    ds_read_b128 v[228:231], v253 offset:33792
    v_mfma_f32_16x16x32_bf16 v[84:87], v[196:199], v[240:243], v[84:87]
    v_cvt_pk_bf16_f32 v64, v64, v65
    v_cvt_pk_bf16_f32 v65, v66, v67
    v_mfma_f32_16x16x32_bf16 v[88:91], v[168:171], v[240:243], v[88:91]
    v_cvt_pk_bf16_f32 v66, v68, v69
    v_cvt_pk_bf16_f32 v67, v70, v71
    v_mfma_f32_16x16x32_bf16 v[92:95], v[172:175], v[240:243], v[92:95]
    s_add_u32 s47, s48, 4210688
    buffer_store_dwordx4 v[64:67], v251, s[16:19], s47 offen sc1
    v_mfma_f32_16x16x32_bf16 v[80:83], v[200:203], v[244:247], v[80:83]
    v_cvt_pk_bf16_f32 v72, v72, v73
    v_cvt_pk_bf16_f32 v73, v74, v75
    v_mfma_f32_16x16x32_bf16 v[84:87], v[204:207], v[244:247], v[84:87]
    v_cvt_pk_bf16_f32 v74, v76, v77
    v_cvt_pk_bf16_f32 v75, v78, v79
    v_mfma_f32_16x16x32_bf16 v[88:91], v[192:195], v[244:247], v[88:91]
    s_add_u32 s47, s48, 4211712
    buffer_store_dwordx4 v[72:75], v251, s[16:19], s47 offen sc1
    v_mfma_f32_16x16x32_bf16 v[92:95], v[196:199], v[244:247], v[92:95]
    s_waitcnt lgkmcnt(2)
    v_mfma_f32_16x16x32_bf16 v[128:131], v[176:179], v[216:219], v[128:131]
    ds_read_b128 v[232:235], v250 offset:25600
    ds_read_b128 v[236:239], v250 offset:36864
    v_mfma_f32_16x16x32_bf16 v[132:135], v[180:183], v[216:219], v[132:135]
    v_mfma_f32_16x16x32_bf16 v[136:139], v[208:211], v[216:219], v[136:139]
    v_mfma_f32_16x16x32_bf16 v[140:143], v[212:215], v[216:219], v[140:143]
    v_mfma_f32_16x16x32_bf16 v[128:131], v[184:187], v[220:223], v[128:131]
    v_mfma_f32_16x16x32_bf16 v[132:135], v[188:191], v[220:223], v[132:135]
    v_mfma_f32_16x16x32_bf16 v[136:139], v[176:179], v[220:223], v[136:139]
    v_mfma_f32_16x16x32_bf16 v[140:143], v[180:183], v[220:223], v[140:143]
    s_waitcnt lgkmcnt(2)
    v_mfma_f32_16x16x32_bf16 v[96:99], v[192:195], v[224:227], v[96:99]
    ds_read_b128 v[240:243], v253 offset:23552
    ds_read_b128 v[244:247], v253 offset:34816
    v_mfma_f32_16x16x32_bf16 v[100:103], v[196:199], v[224:227], v[100:103]
    v_cvt_pk_bf16_f32 v80, v80, v81
    v_cvt_pk_bf16_f32 v81, v82, v83
    v_mfma_f32_16x16x32_bf16 v[104:107], v[168:171], v[224:227], v[104:107]
    v_cvt_pk_bf16_f32 v82, v84, v85
    v_cvt_pk_bf16_f32 v83, v86, v87
    v_mfma_f32_16x16x32_bf16 v[108:111], v[172:175], v[224:227], v[108:111]
    s_add_u32 s47, s48, 5263360
    buffer_store_dwordx4 v[80:83], v251, s[16:19], s47 offen sc1
    v_mfma_f32_16x16x32_bf16 v[96:99], v[200:203], v[228:231], v[96:99]
    v_cvt_pk_bf16_f32 v88, v88, v89
    v_cvt_pk_bf16_f32 v89, v90, v91
    v_mfma_f32_16x16x32_bf16 v[100:103], v[204:207], v[228:231], v[100:103]
    v_cvt_pk_bf16_f32 v90, v92, v93
    v_cvt_pk_bf16_f32 v91, v94, v95
    v_mfma_f32_16x16x32_bf16 v[104:107], v[192:195], v[228:231], v[104:107]
    s_add_u32 s47, s48, 5264384
    buffer_store_dwordx4 v[88:91], v251, s[16:19], s47 offen sc1
    v_mfma_f32_16x16x32_bf16 v[108:111], v[196:199], v[228:231], v[108:111]
    s_waitcnt lgkmcnt(2)
    v_mfma_f32_16x16x32_bf16 v[144:147], v[176:179], v[232:235], v[144:147]
    ds_read_b128 v[216:219], v250 offset:26624
    ds_read_b128 v[220:223], v250 offset:37888
    v_mfma_f32_16x16x32_bf16 v[148:151], v[180:183], v[232:235], v[148:151]
    v_mfma_f32_16x16x32_bf16 v[152:155], v[208:211], v[232:235], v[152:155]
    v_mfma_f32_16x16x32_bf16 v[156:159], v[212:215], v[232:235], v[156:159]
    v_mfma_f32_16x16x32_bf16 v[144:147], v[184:187], v[236:239], v[144:147]
    v_mfma_f32_16x16x32_bf16 v[148:151], v[188:191], v[236:239], v[148:151]
    v_mfma_f32_16x16x32_bf16 v[152:155], v[176:179], v[236:239], v[152:155]
    v_mfma_f32_16x16x32_bf16 v[156:159], v[180:183], v[236:239], v[156:159]
    s_waitcnt lgkmcnt(2)
    v_mfma_f32_16x16x32_bf16 v[112:115], v[192:195], v[240:243], v[112:115]
    ds_read_b128 v[224:227], v253 offset:24576
    ds_read_b128 v[228:231], v253 offset:35840
    v_mfma_f32_16x16x32_bf16 v[116:119], v[196:199], v[240:243], v[116:119]
    v_cvt_pk_bf16_f32 v96, v96, v97
    v_cvt_pk_bf16_f32 v97, v98, v99
    v_mfma_f32_16x16x32_bf16 v[120:123], v[168:171], v[240:243], v[120:123]
    v_cvt_pk_bf16_f32 v98, v100, v101
    v_cvt_pk_bf16_f32 v99, v102, v103
    v_mfma_f32_16x16x32_bf16 v[124:127], v[172:175], v[240:243], v[124:127]
    s_add_u32 s47, s48, 6316032
    buffer_store_dwordx4 v[96:99], v251, s[16:19], s47 offen sc1
    v_mfma_f32_16x16x32_bf16 v[112:115], v[200:203], v[244:247], v[112:115]
    v_cvt_pk_bf16_f32 v104, v104, v105
    v_cvt_pk_bf16_f32 v105, v106, v107
    v_mfma_f32_16x16x32_bf16 v[116:119], v[204:207], v[244:247], v[116:119]
    v_cvt_pk_bf16_f32 v106, v108, v109
    v_cvt_pk_bf16_f32 v107, v110, v111
    v_mfma_f32_16x16x32_bf16 v[120:123], v[192:195], v[244:247], v[120:123]
    s_add_u32 s47, s48, 6317056
    buffer_store_dwordx4 v[104:107], v251, s[16:19], s47 offen sc1
    v_mfma_f32_16x16x32_bf16 v[124:127], v[196:199], v[244:247], v[124:127]
    s_waitcnt lgkmcnt(2)
    v_mfma_f32_16x16x32_bf16 v[160:163], v[176:179], v[216:219], v[160:163]
    ds_read_b128 v[232:235], v253 offset:25600
    ds_read_b128 v[236:239], v253 offset:36864
    v_mfma_f32_16x16x32_bf16 v[164:167], v[208:211], v[216:219], v[164:167]
    v_mfma_f32_16x16x32_bf16 v[160:163], v[184:187], v[220:223], v[160:163]
    v_mfma_f32_16x16x32_bf16 v[164:167], v[176:179], v[220:223], v[164:167]
    s_waitcnt lgkmcnt(2)
    v_mfma_f32_16x16x32_bf16 v[128:131], v[192:195], v[224:227], v[128:131]
    ds_read_b128 v[240:243], v253 offset:26624
    ds_read_b128 v[244:247], v253 offset:37888
    v_mfma_f32_16x16x32_bf16 v[132:135], v[196:199], v[224:227], v[132:135]
    v_cvt_pk_bf16_f32 v112, v112, v113
    v_cvt_pk_bf16_f32 v113, v114, v115
    v_mfma_f32_16x16x32_bf16 v[136:139], v[168:171], v[224:227], v[136:139]
    v_cvt_pk_bf16_f32 v114, v116, v117
    v_cvt_pk_bf16_f32 v115, v118, v119
    v_mfma_f32_16x16x32_bf16 v[140:143], v[172:175], v[224:227], v[140:143]
    s_add_u32 s47, s48, 7368704
    buffer_store_dwordx4 v[112:115], v251, s[16:19], s47 offen sc1
    v_mfma_f32_16x16x32_bf16 v[128:131], v[200:203], v[228:231], v[128:131]
    v_cvt_pk_bf16_f32 v120, v120, v121
    v_cvt_pk_bf16_f32 v121, v122, v123
    v_mfma_f32_16x16x32_bf16 v[132:135], v[204:207], v[228:231], v[132:135]
    v_cvt_pk_bf16_f32 v122, v124, v125
    v_cvt_pk_bf16_f32 v123, v126, v127
    v_mfma_f32_16x16x32_bf16 v[136:139], v[192:195], v[228:231], v[136:139]
    s_add_u32 s47, s48, 7369728
    buffer_store_dwordx4 v[120:123], v251, s[16:19], s47 offen sc1
    v_mfma_f32_16x16x32_bf16 v[140:143], v[196:199], v[228:231], v[140:143]
    s_waitcnt lgkmcnt(2)
    v_mfma_f32_16x16x32_bf16 v[144:147], v[192:195], v[232:235], v[144:147]
    v_mfma_f32_16x16x32_bf16 v[148:151], v[196:199], v[232:235], v[148:151]
    v_mfma_f32_16x16x32_bf16 v[152:155], v[168:171], v[232:235], v[152:155]
    v_mfma_f32_16x16x32_bf16 v[156:159], v[172:175], v[232:235], v[156:159]
    v_mfma_f32_16x16x32_bf16 v[144:147], v[200:203], v[236:239], v[144:147]
    v_mfma_f32_16x16x32_bf16 v[148:151], v[204:207], v[236:239], v[148:151]
    v_mfma_f32_16x16x32_bf16 v[152:155], v[192:195], v[236:239], v[152:155]
    v_mfma_f32_16x16x32_bf16 v[156:159], v[196:199], v[236:239], v[156:159]
    s_waitcnt lgkmcnt(0)
    v_mfma_f32_16x16x32_bf16 v[160:163], v[192:195], v[240:243], v[160:163]
    v_mfma_f32_16x16x32_bf16 v[164:167], v[168:171], v[240:243], v[164:167]
    v_cvt_pk_bf16_f32 v128, v128, v129
    v_cvt_pk_bf16_f32 v129, v130, v131
    v_mfma_f32_16x16x32_bf16 v[160:163], v[200:203], v[244:247], v[160:163]
    v_cvt_pk_bf16_f32 v130, v132, v133
    v_cvt_pk_bf16_f32 v131, v134, v135
    v_mfma_f32_16x16x32_bf16 v[164:167], v[192:195], v[244:247], v[164:167]
    s_add_u32 s47, s48, 8421376
    buffer_store_dwordx4 v[128:131], v251, s[16:19], s47 offen sc1
    s_nop 7
    v_cvt_pk_bf16_f32 v136, v136, v137
    v_cvt_pk_bf16_f32 v137, v138, v139
    v_cvt_pk_bf16_f32 v138, v140, v141
    v_cvt_pk_bf16_f32 v139, v142, v143
    s_add_u32 s47, s48, 8422400
    buffer_store_dwordx4 v[136:139], v251, s[16:19], s47 offen sc1
    v_cvt_pk_bf16_f32 v144, v144, v145
    v_cvt_pk_bf16_f32 v145, v146, v147
    v_cvt_pk_bf16_f32 v146, v148, v149
    v_cvt_pk_bf16_f32 v147, v150, v151
    s_add_u32 s47, s48, 9474048
    buffer_store_dwordx4 v[144:147], v251, s[16:19], s47 offen sc1
    v_cvt_pk_bf16_f32 v152, v152, v153
    v_cvt_pk_bf16_f32 v153, v154, v155
    v_cvt_pk_bf16_f32 v154, v156, v157
    v_cvt_pk_bf16_f32 v155, v158, v159
    s_add_u32 s47, s48, 9475072
    buffer_store_dwordx4 v[152:155], v251, s[16:19], s47 offen sc1
    v_cvt_pk_bf16_f32 v160, v160, v161
    v_cvt_pk_bf16_f32 v161, v162, v163
    s_add_u32 s47, s49, 0
    buffer_store_dwordx2 v[160:161], v252, s[16:19], s47 offen sc1
    v_cvt_pk_bf16_f32 v164, v164, v165
    v_cvt_pk_bf16_f32 v165, v166, v167
    s_add_u32 s47, s49, 1024
    buffer_store_dwordx2 v[164:165], v252, s[16:19], s47 offen sc1
    s_branch L_epi_done
L_epi_b1:
    v_add_u32 v248, 0x9800, v248
    v_add_u32 v249, 0x9800, v249
    v_add_u32 v253, 38912, v250
    ds_read_b64_tr_b16 v[192:193], v248 offset:0
    ds_read_b64_tr_b16 v[194:195], v248 offset:1024
    ds_read_b64_tr_b16 v[196:197], v249 offset:0
    ds_read_b64_tr_b16 v[198:199], v249 offset:1024
    ds_read_b64_tr_b16 v[200:201], v248 offset:8192
    ds_read_b64_tr_b16 v[202:203], v248 offset:9216
    ds_read_b64_tr_b16 v[204:205], v249 offset:8192
    ds_read_b64_tr_b16 v[206:207], v249 offset:9216
    s_waitcnt lgkmcnt(10)
    v_mfma_f32_16x16x32_bf16 v[0:3], v[176:179], v[232:235], v[0:3]
    ds_read_b128 v[216:219], v250 offset:18432
    ds_read_b128 v[220:223], v250 offset:29696
    v_mfma_f32_16x16x32_bf16 v[4:7], v[180:183], v[232:235], v[4:7]
    v_mfma_f32_16x16x32_bf16 v[8:11], v[208:211], v[232:235], v[8:11]
    v_mfma_f32_16x16x32_bf16 v[12:15], v[212:215], v[232:235], v[12:15]
    v_mfma_f32_16x16x32_bf16 v[0:3], v[184:187], v[236:239], v[0:3]
    v_mfma_f32_16x16x32_bf16 v[4:7], v[188:191], v[236:239], v[4:7]
    v_mfma_f32_16x16x32_bf16 v[8:11], v[176:179], v[236:239], v[8:11]
    v_mfma_f32_16x16x32_bf16 v[12:15], v[180:183], v[236:239], v[12:15]
    s_waitcnt lgkmcnt(10)
    v_mfma_f32_16x16x32_bf16 v[16:19], v[176:179], v[240:243], v[16:19]
    ds_read_b128 v[224:227], v253 offset:16384
    ds_read_b128 v[228:231], v253 offset:27648
    v_mfma_f32_16x16x32_bf16 v[20:23], v[180:183], v[240:243], v[20:23]
    v_mfma_f32_16x16x32_bf16 v[24:27], v[208:211], v[240:243], v[24:27]
    v_mfma_f32_16x16x32_bf16 v[28:31], v[212:215], v[240:243], v[28:31]
    v_mfma_f32_16x16x32_bf16 v[16:19], v[184:187], v[244:247], v[16:19]
    v_mfma_f32_16x16x32_bf16 v[20:23], v[188:191], v[244:247], v[20:23]
    v_mfma_f32_16x16x32_bf16 v[24:27], v[176:179], v[244:247], v[24:27]
    v_mfma_f32_16x16x32_bf16 v[28:31], v[180:183], v[244:247], v[28:31]
    s_waitcnt lgkmcnt(2)
    v_mfma_f32_16x16x32_bf16 v[32:35], v[176:179], v[216:219], v[32:35]
    ds_read_b128 v[232:235], v250 offset:19456
    ds_read_b128 v[236:239], v250 offset:30720
    v_mfma_f32_16x16x32_bf16 v[36:39], v[180:183], v[216:219], v[36:39]
    v_mfma_f32_16x16x32_bf16 v[40:43], v[208:211], v[216:219], v[40:43]
    v_mfma_f32_16x16x32_bf16 v[44:47], v[212:215], v[216:219], v[44:47]
    v_mfma_f32_16x16x32_bf16 v[32:35], v[184:187], v[220:223], v[32:35]
    v_mfma_f32_16x16x32_bf16 v[36:39], v[188:191], v[220:223], v[36:39]
    v_mfma_f32_16x16x32_bf16 v[40:43], v[176:179], v[220:223], v[40:43]
    v_mfma_f32_16x16x32_bf16 v[44:47], v[180:183], v[220:223], v[44:47]
    v_xor_b32 v168, 0x80008000, v200
    v_xor_b32 v169, 0x80008000, v201
    v_xor_b32 v170, 0x80008000, v202
    v_xor_b32 v171, 0x80008000, v203
    v_xor_b32 v172, 0x80008000, v204
    v_xor_b32 v173, 0x80008000, v205
    v_xor_b32 v174, 0x80008000, v206
    v_xor_b32 v175, 0x80008000, v207
    s_waitcnt lgkmcnt(2)
    v_mfma_f32_16x16x32_bf16 v[0:3], v[192:195], v[224:227], v[0:3]
    ds_read_b128 v[240:243], v253 offset:17408
    ds_read_b128 v[244:247], v253 offset:28672
    v_mfma_f32_16x16x32_bf16 v[4:7], v[196:199], v[224:227], v[4:7]
    v_mfma_f32_16x16x32_bf16 v[8:11], v[168:171], v[224:227], v[8:11]
    v_mfma_f32_16x16x32_bf16 v[12:15], v[172:175], v[224:227], v[12:15]
    v_mfma_f32_16x16x32_bf16 v[0:3], v[200:203], v[228:231], v[0:3]
    v_mfma_f32_16x16x32_bf16 v[4:7], v[204:207], v[228:231], v[4:7]
    v_mfma_f32_16x16x32_bf16 v[8:11], v[192:195], v[228:231], v[8:11]
    v_mfma_f32_16x16x32_bf16 v[12:15], v[196:199], v[228:231], v[12:15]
    s_waitcnt lgkmcnt(2)
    v_mfma_f32_16x16x32_bf16 v[48:51], v[176:179], v[232:235], v[48:51]
    ds_read_b128 v[216:219], v250 offset:20480
    ds_read_b128 v[220:223], v250 offset:31744
    v_mfma_f32_16x16x32_bf16 v[52:55], v[180:183], v[232:235], v[52:55]
    v_mfma_f32_16x16x32_bf16 v[56:59], v[208:211], v[232:235], v[56:59]
    v_mfma_f32_16x16x32_bf16 v[60:63], v[212:215], v[232:235], v[60:63]
    v_mfma_f32_16x16x32_bf16 v[48:51], v[184:187], v[236:239], v[48:51]
    v_mfma_f32_16x16x32_bf16 v[52:55], v[188:191], v[236:239], v[52:55]
    v_mfma_f32_16x16x32_bf16 v[56:59], v[176:179], v[236:239], v[56:59]
    v_mfma_f32_16x16x32_bf16 v[60:63], v[180:183], v[236:239], v[60:63]
    s_waitcnt lgkmcnt(2)
    v_mfma_f32_16x16x32_bf16 v[16:19], v[192:195], v[240:243], v[16:19]
    ds_read_b128 v[224:227], v253 offset:18432
    ds_read_b128 v[228:231], v253 offset:29696
    v_mfma_f32_16x16x32_bf16 v[20:23], v[196:199], v[240:243], v[20:23]
    v_cvt_pk_bf16_f32 v4, v4, v5
    v_cvt_pk_bf16_f32 v5, v6, v7
    v_mfma_f32_16x16x32_bf16 v[24:27], v[168:171], v[240:243], v[24:27]
    v_cvt_pk_bf16_f32 v6, v0, v1
    v_cvt_pk_bf16_f32 v7, v2, v3
    v_mfma_f32_16x16x32_bf16 v[28:31], v[172:175], v[240:243], v[28:31]
    s_add_u32 s47, s48, 0
    buffer_store_dwordx4 v[4:7], v251, s[16:19], s47 offen sc1
    v_mfma_f32_16x16x32_bf16 v[16:19], v[200:203], v[244:247], v[16:19]
    v_cvt_pk_bf16_f32 v12, v12, v13
    v_cvt_pk_bf16_f32 v13, v14, v15
    v_mfma_f32_16x16x32_bf16 v[20:23], v[204:207], v[244:247], v[20:23]
    v_cvt_pk_bf16_f32 v14, v8, v9
    v_cvt_pk_bf16_f32 v15, v10, v11
    v_mfma_f32_16x16x32_bf16 v[24:27], v[192:195], v[244:247], v[24:27]
    s_add_u32 s47, s48, 1024
    buffer_store_dwordx4 v[12:15], v251, s[16:19], s47 offen sc1
    v_mfma_f32_16x16x32_bf16 v[28:31], v[196:199], v[244:247], v[28:31]
    s_waitcnt lgkmcnt(2)
    v_mfma_f32_16x16x32_bf16 v[64:67], v[176:179], v[216:219], v[64:67]
    ds_read_b128 v[232:235], v250 offset:21504
    ds_read_b128 v[236:239], v250 offset:32768
    v_mfma_f32_16x16x32_bf16 v[68:71], v[180:183], v[216:219], v[68:71]
    v_mfma_f32_16x16x32_bf16 v[72:75], v[208:211], v[216:219], v[72:75]
    v_mfma_f32_16x16x32_bf16 v[76:79], v[212:215], v[216:219], v[76:79]
    v_mfma_f32_16x16x32_bf16 v[64:67], v[184:187], v[220:223], v[64:67]
    v_mfma_f32_16x16x32_bf16 v[68:71], v[188:191], v[220:223], v[68:71]
    v_mfma_f32_16x16x32_bf16 v[72:75], v[176:179], v[220:223], v[72:75]
    v_mfma_f32_16x16x32_bf16 v[76:79], v[180:183], v[220:223], v[76:79]
    s_waitcnt lgkmcnt(2)
    v_mfma_f32_16x16x32_bf16 v[32:35], v[192:195], v[224:227], v[32:35]
    ds_read_b128 v[240:243], v253 offset:19456
    ds_read_b128 v[244:247], v253 offset:30720
    v_mfma_f32_16x16x32_bf16 v[36:39], v[196:199], v[224:227], v[36:39]
    v_cvt_pk_bf16_f32 v20, v20, v21
    v_cvt_pk_bf16_f32 v21, v22, v23
    v_mfma_f32_16x16x32_bf16 v[40:43], v[168:171], v[224:227], v[40:43]
    v_cvt_pk_bf16_f32 v22, v16, v17
    v_cvt_pk_bf16_f32 v23, v18, v19
    v_mfma_f32_16x16x32_bf16 v[44:47], v[172:175], v[224:227], v[44:47]
    s_add_u32 s47, s48, 1052672
    buffer_store_dwordx4 v[20:23], v251, s[16:19], s47 offen sc1
    v_mfma_f32_16x16x32_bf16 v[32:35], v[200:203], v[228:231], v[32:35]
    v_cvt_pk_bf16_f32 v28, v28, v29
    v_cvt_pk_bf16_f32 v29, v30, v31
    v_mfma_f32_16x16x32_bf16 v[36:39], v[204:207], v[228:231], v[36:39]
    v_cvt_pk_bf16_f32 v30, v24, v25
    v_cvt_pk_bf16_f32 v31, v26, v27
    v_mfma_f32_16x16x32_bf16 v[40:43], v[192:195], v[228:231], v[40:43]
    s_add_u32 s47, s48, 1053696
    buffer_store_dwordx4 v[28:31], v251, s[16:19], s47 offen sc1
    v_mfma_f32_16x16x32_bf16 v[44:47], v[196:199], v[228:231], v[44:47]
    s_waitcnt lgkmcnt(2)
    v_mfma_f32_16x16x32_bf16 v[80:83], v[176:179], v[232:235], v[80:83]
    ds_read_b128 v[216:219], v250 offset:22528
    ds_read_b128 v[220:223], v250 offset:33792
    v_mfma_f32_16x16x32_bf16 v[84:87], v[180:183], v[232:235], v[84:87]
    v_mfma_f32_16x16x32_bf16 v[88:91], v[208:211], v[232:235], v[88:91]
    v_mfma_f32_16x16x32_bf16 v[92:95], v[212:215], v[232:235], v[92:95]
    v_mfma_f32_16x16x32_bf16 v[80:83], v[184:187], v[236:239], v[80:83]
    v_mfma_f32_16x16x32_bf16 v[84:87], v[188:191], v[236:239], v[84:87]
    v_mfma_f32_16x16x32_bf16 v[88:91], v[176:179], v[236:239], v[88:91]
    v_mfma_f32_16x16x32_bf16 v[92:95], v[180:183], v[236:239], v[92:95]
    s_waitcnt lgkmcnt(2)
    v_mfma_f32_16x16x32_bf16 v[48:51], v[192:195], v[240:243], v[48:51]
    ds_read_b128 v[224:227], v253 offset:20480
    ds_read_b128 v[228:231], v253 offset:31744
    v_mfma_f32_16x16x32_bf16 v[52:55], v[196:199], v[240:243], v[52:55]
    v_cvt_pk_bf16_f32 v36, v36, v37
    v_cvt_pk_bf16_f32 v37, v38, v39
    v_mfma_f32_16x16x32_bf16 v[56:59], v[168:171], v[240:243], v[56:59]
    v_cvt_pk_bf16_f32 v38, v32, v33
    v_cvt_pk_bf16_f32 v39, v34, v35
    v_mfma_f32_16x16x32_bf16 v[60:63], v[172:175], v[240:243], v[60:63]
    s_add_u32 s47, s48, 2105344
    buffer_store_dwordx4 v[36:39], v251, s[16:19], s47 offen sc1
    v_mfma_f32_16x16x32_bf16 v[48:51], v[200:203], v[244:247], v[48:51]
    v_cvt_pk_bf16_f32 v44, v44, v45
    v_cvt_pk_bf16_f32 v45, v46, v47
    v_mfma_f32_16x16x32_bf16 v[52:55], v[204:207], v[244:247], v[52:55]
    v_cvt_pk_bf16_f32 v46, v40, v41
    v_cvt_pk_bf16_f32 v47, v42, v43
    v_mfma_f32_16x16x32_bf16 v[56:59], v[192:195], v[244:247], v[56:59]
    s_add_u32 s47, s48, 2106368
    buffer_store_dwordx4 v[44:47], v251, s[16:19], s47 offen sc1
    v_mfma_f32_16x16x32_bf16 v[60:63], v[196:199], v[244:247], v[60:63]
    s_waitcnt lgkmcnt(2)
    v_mfma_f32_16x16x32_bf16 v[96:99], v[176:179], v[216:219], v[96:99]
    ds_read_b128 v[232:235], v250 offset:23552
    ds_read_b128 v[236:239], v250 offset:34816
    v_mfma_f32_16x16x32_bf16 v[100:103], v[180:183], v[216:219], v[100:103]
    v_mfma_f32_16x16x32_bf16 v[104:107], v[208:211], v[216:219], v[104:107]
    v_mfma_f32_16x16x32_bf16 v[108:111], v[212:215], v[216:219], v[108:111]
    v_mfma_f32_16x16x32_bf16 v[96:99], v[184:187], v[220:223], v[96:99]
    v_mfma_f32_16x16x32_bf16 v[100:103], v[188:191], v[220:223], v[100:103]
    v_mfma_f32_16x16x32_bf16 v[104:107], v[176:179], v[220:223], v[104:107]
    v_mfma_f32_16x16x32_bf16 v[108:111], v[180:183], v[220:223], v[108:111]
    s_waitcnt lgkmcnt(2)
    v_mfma_f32_16x16x32_bf16 v[64:67], v[192:195], v[224:227], v[64:67]
    ds_read_b128 v[240:243], v253 offset:21504
    ds_read_b128 v[244:247], v253 offset:32768
    v_mfma_f32_16x16x32_bf16 v[68:71], v[196:199], v[224:227], v[68:71]
    v_cvt_pk_bf16_f32 v52, v52, v53
    v_cvt_pk_bf16_f32 v53, v54, v55
    v_mfma_f32_16x16x32_bf16 v[72:75], v[168:171], v[224:227], v[72:75]
    v_cvt_pk_bf16_f32 v54, v48, v49
    v_cvt_pk_bf16_f32 v55, v50, v51
    v_mfma_f32_16x16x32_bf16 v[76:79], v[172:175], v[224:227], v[76:79]
    s_add_u32 s47, s48, 3158016
    buffer_store_dwordx4 v[52:55], v251, s[16:19], s47 offen sc1
    v_mfma_f32_16x16x32_bf16 v[64:67], v[200:203], v[228:231], v[64:67]
    v_cvt_pk_bf16_f32 v60, v60, v61
    v_cvt_pk_bf16_f32 v61, v62, v63
    v_mfma_f32_16x16x32_bf16 v[68:71], v[204:207], v[228:231], v[68:71]
    v_cvt_pk_bf16_f32 v62, v56, v57
    v_cvt_pk_bf16_f32 v63, v58, v59
    v_mfma_f32_16x16x32_bf16 v[72:75], v[192:195], v[228:231], v[72:75]
    s_add_u32 s47, s48, 3159040
    buffer_store_dwordx4 v[60:63], v251, s[16:19], s47 offen sc1
    v_mfma_f32_16x16x32_bf16 v[76:79], v[196:199], v[228:231], v[76:79]
    s_waitcnt lgkmcnt(2)
    v_mfma_f32_16x16x32_bf16 v[112:115], v[176:179], v[232:235], v[112:115]
    ds_read_b128 v[216:219], v250 offset:24576
    ds_read_b128 v[220:223], v250 offset:35840
    v_mfma_f32_16x16x32_bf16 v[116:119], v[180:183], v[232:235], v[116:119]
    v_mfma_f32_16x16x32_bf16 v[120:123], v[208:211], v[232:235], v[120:123]
    v_mfma_f32_16x16x32_bf16 v[124:127], v[212:215], v[232:235], v[124:127]
    v_mfma_f32_16x16x32_bf16 v[112:115], v[184:187], v[236:239], v[112:115]
    v_mfma_f32_16x16x32_bf16 v[116:119], v[188:191], v[236:239], v[116:119]
    v_mfma_f32_16x16x32_bf16 v[120:123], v[176:179], v[236:239], v[120:123]
    v_mfma_f32_16x16x32_bf16 v[124:127], v[180:183], v[236:239], v[124:127]
    s_waitcnt lgkmcnt(2)
    v_mfma_f32_16x16x32_bf16 v[80:83], v[192:195], v[240:243], v[80:83]
    ds_read_b128 v[224:227], v253 offset:22528
    ds_read_b128 v[228:231], v253 offset:33792
    v_mfma_f32_16x16x32_bf16 v[84:87], v[196:199], v[240:243], v[84:87]
    v_cvt_pk_bf16_f32 v68, v68, v69
    v_cvt_pk_bf16_f32 v69, v70, v71
    v_mfma_f32_16x16x32_bf16 v[88:91], v[168:171], v[240:243], v[88:91]
    v_cvt_pk_bf16_f32 v70, v64, v65
    v_cvt_pk_bf16_f32 v71, v66, v67
    v_mfma_f32_16x16x32_bf16 v[92:95], v[172:175], v[240:243], v[92:95]
    s_add_u32 s47, s48, 4210688
    buffer_store_dwordx4 v[68:71], v251, s[16:19], s47 offen sc1
    v_mfma_f32_16x16x32_bf16 v[80:83], v[200:203], v[244:247], v[80:83]
    v_cvt_pk_bf16_f32 v76, v76, v77
    v_cvt_pk_bf16_f32 v77, v78, v79
    v_mfma_f32_16x16x32_bf16 v[84:87], v[204:207], v[244:247], v[84:87]
    v_cvt_pk_bf16_f32 v78, v72, v73
    v_cvt_pk_bf16_f32 v79, v74, v75
    v_mfma_f32_16x16x32_bf16 v[88:91], v[192:195], v[244:247], v[88:91]
    s_add_u32 s47, s48, 4211712
    buffer_store_dwordx4 v[76:79], v251, s[16:19], s47 offen sc1
    v_mfma_f32_16x16x32_bf16 v[92:95], v[196:199], v[244:247], v[92:95]
    s_waitcnt lgkmcnt(2)
    v_mfma_f32_16x16x32_bf16 v[128:131], v[176:179], v[216:219], v[128:131]
    ds_read_b128 v[232:235], v250 offset:25600
    ds_read_b128 v[236:239], v250 offset:36864
    v_mfma_f32_16x16x32_bf16 v[132:135], v[180:183], v[216:219], v[132:135]
    v_mfma_f32_16x16x32_bf16 v[136:139], v[208:211], v[216:219], v[136:139]
    v_mfma_f32_16x16x32_bf16 v[140:143], v[212:215], v[216:219], v[140:143]
    v_mfma_f32_16x16x32_bf16 v[128:131], v[184:187], v[220:223], v[128:131]
    v_mfma_f32_16x16x32_bf16 v[132:135], v[188:191], v[220:223], v[132:135]
    v_mfma_f32_16x16x32_bf16 v[136:139], v[176:179], v[220:223], v[136:139]
    v_mfma_f32_16x16x32_bf16 v[140:143], v[180:183], v[220:223], v[140:143]
    s_waitcnt lgkmcnt(2)
    v_mfma_f32_16x16x32_bf16 v[96:99], v[192:195], v[224:227], v[96:99]
    ds_read_b128 v[240:243], v253 offset:23552
    ds_read_b128 v[244:247], v253 offset:34816
    v_mfma_f32_16x16x32_bf16 v[100:103], v[196:199], v[224:227], v[100:103]
    v_cvt_pk_bf16_f32 v84, v84, v85
    v_cvt_pk_bf16_f32 v85, v86, v87
    v_mfma_f32_16x16x32_bf16 v[104:107], v[168:171], v[224:227], v[104:107]
    v_cvt_pk_bf16_f32 v86, v80, v81
    v_cvt_pk_bf16_f32 v87, v82, v83
    v_mfma_f32_16x16x32_bf16 v[108:111], v[172:175], v[224:227], v[108:111]
    s_add_u32 s47, s48, 5263360
    buffer_store_dwordx4 v[84:87], v251, s[16:19], s47 offen sc1
    v_mfma_f32_16x16x32_bf16 v[96:99], v[200:203], v[228:231], v[96:99]
    v_cvt_pk_bf16_f32 v92, v92, v93
    v_cvt_pk_bf16_f32 v93, v94, v95
    v_mfma_f32_16x16x32_bf16 v[100:103], v[204:207], v[228:231], v[100:103]
    v_cvt_pk_bf16_f32 v94, v88, v89
    v_cvt_pk_bf16_f32 v95, v90, v91
    v_mfma_f32_16x16x32_bf16 v[104:107], v[192:195], v[228:231], v[104:107]
    s_add_u32 s47, s48, 5264384
    buffer_store_dwordx4 v[92:95], v251, s[16:19], s47 offen sc1
    v_mfma_f32_16x16x32_bf16 v[108:111], v[196:199], v[228:231], v[108:111]
    s_waitcnt lgkmcnt(2)
    v_mfma_f32_16x16x32_bf16 v[144:147], v[176:179], v[232:235], v[144:147]
    ds_read_b128 v[216:219], v250 offset:26624
    ds_read_b128 v[220:223], v250 offset:37888
    v_mfma_f32_16x16x32_bf16 v[148:151], v[180:183], v[232:235], v[148:151]
    v_mfma_f32_16x16x32_bf16 v[152:155], v[208:211], v[232:235], v[152:155]
    v_mfma_f32_16x16x32_bf16 v[156:159], v[212:215], v[232:235], v[156:159]
    v_mfma_f32_16x16x32_bf16 v[144:147], v[184:187], v[236:239], v[144:147]
    v_mfma_f32_16x16x32_bf16 v[148:151], v[188:191], v[236:239], v[148:151]
    v_mfma_f32_16x16x32_bf16 v[152:155], v[176:179], v[236:239], v[152:155]
    v_mfma_f32_16x16x32_bf16 v[156:159], v[180:183], v[236:239], v[156:159]
    s_waitcnt lgkmcnt(2)
    v_mfma_f32_16x16x32_bf16 v[112:115], v[192:195], v[240:243], v[112:115]
    ds_read_b128 v[224:227], v253 offset:24576
    ds_read_b128 v[228:231], v253 offset:35840
    v_mfma_f32_16x16x32_bf16 v[116:119], v[196:199], v[240:243], v[116:119]
    v_cvt_pk_bf16_f32 v100, v100, v101
    v_cvt_pk_bf16_f32 v101, v102, v103
    v_mfma_f32_16x16x32_bf16 v[120:123], v[168:171], v[240:243], v[120:123]
    v_cvt_pk_bf16_f32 v102, v96, v97
    v_cvt_pk_bf16_f32 v103, v98, v99
    v_mfma_f32_16x16x32_bf16 v[124:127], v[172:175], v[240:243], v[124:127]
    s_add_u32 s47, s48, 6316032
    buffer_store_dwordx4 v[100:103], v251, s[16:19], s47 offen sc1
    v_mfma_f32_16x16x32_bf16 v[112:115], v[200:203], v[244:247], v[112:115]
    v_cvt_pk_bf16_f32 v108, v108, v109
    v_cvt_pk_bf16_f32 v109, v110, v111
    v_mfma_f32_16x16x32_bf16 v[116:119], v[204:207], v[244:247], v[116:119]
    v_cvt_pk_bf16_f32 v110, v104, v105
    v_cvt_pk_bf16_f32 v111, v106, v107
    v_mfma_f32_16x16x32_bf16 v[120:123], v[192:195], v[244:247], v[120:123]
    s_add_u32 s47, s48, 6317056
    buffer_store_dwordx4 v[108:111], v251, s[16:19], s47 offen sc1
    v_mfma_f32_16x16x32_bf16 v[124:127], v[196:199], v[244:247], v[124:127]
    s_waitcnt lgkmcnt(2)
    v_mfma_f32_16x16x32_bf16 v[160:163], v[176:179], v[216:219], v[160:163]
    ds_read_b128 v[232:235], v253 offset:25600
    ds_read_b128 v[236:239], v253 offset:36864
    v_mfma_f32_16x16x32_bf16 v[164:167], v[208:211], v[216:219], v[164:167]
    v_mfma_f32_16x16x32_bf16 v[160:163], v[184:187], v[220:223], v[160:163]
    v_mfma_f32_16x16x32_bf16 v[164:167], v[176:179], v[220:223], v[164:167]
    s_waitcnt lgkmcnt(2)
    v_mfma_f32_16x16x32_bf16 v[128:131], v[192:195], v[224:227], v[128:131]
    ds_read_b128 v[240:243], v253 offset:26624
    ds_read_b128 v[244:247], v253 offset:37888
    v_mfma_f32_16x16x32_bf16 v[132:135], v[196:199], v[224:227], v[132:135]
    v_cvt_pk_bf16_f32 v116, v116, v117
    v_cvt_pk_bf16_f32 v117, v118, v119
    v_mfma_f32_16x16x32_bf16 v[136:139], v[168:171], v[224:227], v[136:139]
    v_cvt_pk_bf16_f32 v118, v112, v113
    v_cvt_pk_bf16_f32 v119, v114, v115
    v_mfma_f32_16x16x32_bf16 v[140:143], v[172:175], v[224:227], v[140:143]
    s_add_u32 s47, s48, 7368704
    buffer_store_dwordx4 v[116:119], v251, s[16:19], s47 offen sc1
    v_mfma_f32_16x16x32_bf16 v[128:131], v[200:203], v[228:231], v[128:131]
    v_cvt_pk_bf16_f32 v124, v124, v125
    v_cvt_pk_bf16_f32 v125, v126, v127
    v_mfma_f32_16x16x32_bf16 v[132:135], v[204:207], v[228:231], v[132:135]
    v_cvt_pk_bf16_f32 v126, v120, v121
    v_cvt_pk_bf16_f32 v127, v122, v123
    v_mfma_f32_16x16x32_bf16 v[136:139], v[192:195], v[228:231], v[136:139]
    s_add_u32 s47, s48, 7369728
    buffer_store_dwordx4 v[124:127], v251, s[16:19], s47 offen sc1
    v_mfma_f32_16x16x32_bf16 v[140:143], v[196:199], v[228:231], v[140:143]
    s_waitcnt lgkmcnt(2)
    v_mfma_f32_16x16x32_bf16 v[144:147], v[192:195], v[232:235], v[144:147]
    v_mfma_f32_16x16x32_bf16 v[148:151], v[196:199], v[232:235], v[148:151]
    v_mfma_f32_16x16x32_bf16 v[152:155], v[168:171], v[232:235], v[152:155]
    v_mfma_f32_16x16x32_bf16 v[156:159], v[172:175], v[232:235], v[156:159]
    v_mfma_f32_16x16x32_bf16 v[144:147], v[200:203], v[236:239], v[144:147]
    v_mfma_f32_16x16x32_bf16 v[148:151], v[204:207], v[236:239], v[148:151]
    v_mfma_f32_16x16x32_bf16 v[152:155], v[192:195], v[236:239], v[152:155]
    v_mfma_f32_16x16x32_bf16 v[156:159], v[196:199], v[236:239], v[156:159]
    s_waitcnt lgkmcnt(0)
    v_mfma_f32_16x16x32_bf16 v[160:163], v[192:195], v[240:243], v[160:163]
    v_mfma_f32_16x16x32_bf16 v[164:167], v[168:171], v[240:243], v[164:167]
    v_cvt_pk_bf16_f32 v132, v132, v133
    v_cvt_pk_bf16_f32 v133, v134, v135
    v_mfma_f32_16x16x32_bf16 v[160:163], v[200:203], v[244:247], v[160:163]
    v_cvt_pk_bf16_f32 v134, v128, v129
    v_cvt_pk_bf16_f32 v135, v130, v131
    v_mfma_f32_16x16x32_bf16 v[164:167], v[192:195], v[244:247], v[164:167]
    s_add_u32 s47, s48, 8421376
    buffer_store_dwordx4 v[132:135], v251, s[16:19], s47 offen sc1
    s_nop 7
    v_cvt_pk_bf16_f32 v140, v140, v141
    v_cvt_pk_bf16_f32 v141, v142, v143
    v_cvt_pk_bf16_f32 v142, v136, v137
    v_cvt_pk_bf16_f32 v143, v138, v139
    s_add_u32 s47, s48, 8422400
    buffer_store_dwordx4 v[140:143], v251, s[16:19], s47 offen sc1
    v_cvt_pk_bf16_f32 v148, v148, v149
    v_cvt_pk_bf16_f32 v149, v150, v151
    v_cvt_pk_bf16_f32 v150, v144, v145
    v_cvt_pk_bf16_f32 v151, v146, v147
    s_add_u32 s47, s48, 9474048
    buffer_store_dwordx4 v[148:151], v251, s[16:19], s47 offen sc1
    v_cvt_pk_bf16_f32 v156, v156, v157
    v_cvt_pk_bf16_f32 v157, v158, v159
    v_cvt_pk_bf16_f32 v158, v152, v153
    v_cvt_pk_bf16_f32 v159, v154, v155
    s_add_u32 s47, s48, 9475072
    buffer_store_dwordx4 v[156:159], v251, s[16:19], s47 offen sc1
    v_cvt_pk_bf16_f32 v160, v160, v161
    v_cvt_pk_bf16_f32 v161, v162, v163
    s_add_u32 s47, s49, 0
    buffer_store_dwordx2 v[160:161], v252, s[16:19], s47 offen sc1
    v_cvt_pk_bf16_f32 v164, v164, v165
    v_cvt_pk_bf16_f32 v165, v166, v167
    s_add_u32 s47, s49, 1024
    buffer_store_dwordx2 v[164:165], v252, s[16:19], s47 offen sc1
L_epi_done:
    s_endpgm
L_k3_helper:
    s_mul_i32 s40, s11, 16384
    s_mul_i32 s20, s14, 16777216
    s_add_u32 s40, s40, s20
    s_mul_i32 s41, s11, 21504
    s_mul_i32 s20, s13, 22020096
    s_add_u32 s41, s41, s20
    s_add_u32 s41, s41, 67108864
    s_lshl_b32 s42, s15, 12
    s_mul_i32 s43, s15, 5632
    s_lshr_b32 s20, s15, 1
    s_lshl_b32 s21, s20, 9
    s_sub_u32 s21, s43, s21
    v_lshlrev_b32 v1, 4, v0
    v_add_u32 v2, s21, v1
    s_add_u32 s22, s21, 4096
    v_add_u32 v5, s22, v1
    s_mov_b32 s44, s41
    s_bitcmp1_b32 s15, 0
    s_cbranch_scc0 L_six_even
    s_mul_i32 s22, s20, 10752
    s_add_u32 s22, s22, 9216
    v_lshrrev_b32 v5, 2, v0
    v_lshlrev_b32 v5, 6, v5
    v_and_b32 v3, 3, v0
    v_xor_b32 v3, 3, v3
    v_lshl_add_u32 v5, v3, 4, v5
    v_add_u32 v5, s22, v5
    s_mul_i32 s44, s11, 21504
    s_xor_b32 s22, s13, 1
    s_mul_i32 s22, s22, 22020096
    s_add_u32 s44, s44, s22
    s_add_u32 s44, s44, 67108864
L_six_even:
    s_mov_b32 s50, -1
    s_mov_b32 s51, 0
    v_add_u32 v1, s42, v1
    s_add_u32 s43, s43, 16384
    s_cmp_ge_u32 s2, 8
    s_cbranch_scc1 L_nozero
    s_cmp_lg_u32 s15, 0
    s_cbranch_scc1 L_nozero
    s_mul_i32 s20, s2, 8448
    s_add_u32 s20, s20, 147849216
    v_mov_b32 v3, 0
    v_lshlrev_b32 v4, 2, v0
    buffer_store_dword v3, v4, s[16:19], s20 offen
L_nozero:
    s_cmp_ge_u32 s2, 224
    s_cbranch_scc1 L_nofill
    s_cmp_lg_u32 s15, 1
    s_cbranch_scc1 L_nofill
    s_lshl_b32 s20, s2, 10
    s_add_u32 s20, s20, 146800640
    v_mov_b32 v8, -1
    v_mov_b32 v9, -1
    v_mov_b32 v10, -1
    v_mov_b32 v11, -1
    v_lshlrev_b32 v4, 4, v0
    buffer_store_dwordx4 v[8:11], v4, s[16:19], s20 offen
L_nofill:
    s_cmp_ge_u32 s2, 8
    s_cbranch_scc1 L_nopf3
    s_cmp_lg_u32 s15, 3
    s_cbranch_scc1 L_nopf3
    s_getpc_b64 s[60:61]
L_pf_k3:
    s_sub_u32 s60, s60, L_pf_k3-gemm_kernel
    s_subb_u32 s61, s61, 0
    v_mbcnt_lo_u32_b32 v12, -1, 0
    v_mbcnt_hi_u32_b32 v12, -1, v12
    v_lshlrev_b32 v12, 6, v12
    v_add_u32 v13, 0, v12
    v_min_u32 v13, final_kernel-gemm_kernel-4, v13
    v_mov_b32 v15, s61
    v_add_co_u32 v14, vcc, s60, v13
    s_nop 1
    v_addc_co_u32 v15, vcc, 0, v15, vcc
    global_load_dword v16, v[14:15], off
    v_add_u32 v13, 4096, v12
    v_min_u32 v13, final_kernel-gemm_kernel-4, v13
    v_mov_b32 v15, s61
    v_add_co_u32 v14, vcc, s60, v13
    s_nop 1
    v_addc_co_u32 v15, vcc, 0, v15, vcc
    global_load_dword v16, v[14:15], off
    v_add_u32 v13, 8192, v12
    v_min_u32 v13, final_kernel-gemm_kernel-4, v13
    v_mov_b32 v15, s61
    v_add_co_u32 v14, vcc, s60, v13
    s_nop 1
    v_addc_co_u32 v15, vcc, 0, v15, vcc
    global_load_dword v16, v[14:15], off
    v_add_u32 v13, 12288, v12
    v_min_u32 v13, final_kernel-gemm_kernel-4, v13
    v_mov_b32 v15, s61
    v_add_co_u32 v14, vcc, s60, v13
    s_nop 1
    v_addc_co_u32 v15, vcc, 0, v15, vcc
    global_load_dword v16, v[14:15], off
L_nopf3:
    s_add_u32 m0, s42, 0
    s_nop 0
    buffer_load_dwordx4 v1, s[16:19], s40 offen offset:0 lds
    buffer_load_dwordx4 v1, s[16:19], s40 offen offset:1024 lds
    buffer_load_dwordx4 v1, s[16:19], s40 offen offset:2048 lds
    buffer_load_dwordx4 v1, s[16:19], s40 offen offset:3072 lds
    s_add_u32 s40, s40, 524288
    s_add_u32 m0, s43, 0
    s_nop 0
    buffer_load_dwordx4 v2, s[16:19], s41 offen offset:0 lds
    buffer_load_dwordx4 v2, s[16:19], s41 offen offset:1024 lds
    buffer_load_dwordx4 v2, s[16:19], s41 offen offset:2048 lds
    buffer_load_dwordx4 v2, s[16:19], s41 offen offset:3072 lds
    s_add_u32 m0, s43, 4096
    s_add_u32 s49, s41, 4096
    buffer_load_dwordx4 v2, s[16:19], s49 offen lds
    s_mov_b64 exec, s[50:51]
    buffer_load_dwordx4 v5, s[16:19], s44 offen offset:1024 lds
    s_mov_b64 exec, -1
    s_add_u32 s41, s41, 688128
    s_add_u32 s44, s44, 688128
    s_add_u32 m0, s42, 38912
    s_nop 0
    buffer_load_dwordx4 v1, s[16:19], s40 offen offset:0 lds
    buffer_load_dwordx4 v1, s[16:19], s40 offen offset:1024 lds
    buffer_load_dwordx4 v1, s[16:19], s40 offen offset:2048 lds
    buffer_load_dwordx4 v1, s[16:19], s40 offen offset:3072 lds
    s_add_u32 s40, s40, 524288
    s_add_u32 m0, s43, 38912
    s_nop 0
    buffer_load_dwordx4 v2, s[16:19], s41 offen offset:0 lds
    buffer_load_dwordx4 v2, s[16:19], s41 offen offset:1024 lds
    buffer_load_dwordx4 v2, s[16:19], s41 offen offset:2048 lds
    buffer_load_dwordx4 v2, s[16:19], s41 offen offset:3072 lds
    s_add_u32 m0, s43, 43008
    s_add_u32 s49, s41, 4096
    buffer_load_dwordx4 v2, s[16:19], s49 offen lds
    s_mov_b64 exec, s[50:51]
    buffer_load_dwordx4 v5, s[16:19], s44 offen offset:1024 lds
    s_mov_b64 exec, -1
    s_add_u32 s41, s41, 688128
    s_add_u32 s44, s44, 688128
    s_add_u32 m0, s42, 77824
    s_nop 0
    buffer_load_dwordx4 v1, s[16:19], s40 offen offset:0 lds
    buffer_load_dwordx4 v1, s[16:19], s40 offen offset:1024 lds
    buffer_load_dwordx4 v1, s[16:19], s40 offen offset:2048 lds
    buffer_load_dwordx4 v1, s[16:19], s40 offen offset:3072 lds
    s_add_u32 s40, s40, 524288
    s_add_u32 m0, s43, 77824
    s_nop 0
    buffer_load_dwordx4 v2, s[16:19], s41 offen offset:0 lds
    buffer_load_dwordx4 v2, s[16:19], s41 offen offset:1024 lds
    buffer_load_dwordx4 v2, s[16:19], s41 offen offset:2048 lds
    buffer_load_dwordx4 v2, s[16:19], s41 offen offset:3072 lds
    s_add_u32 m0, s43, 81920
    s_add_u32 s49, s41, 4096
    buffer_load_dwordx4 v2, s[16:19], s49 offen lds
    s_mov_b64 exec, s[50:51]
    buffer_load_dwordx4 v5, s[16:19], s44 offen offset:1024 lds
    s_mov_b64 exec, -1
    s_add_u32 s41, s41, 688128
    s_add_u32 s44, s44, 688128
    s_waitcnt vmcnt(20)
    s_barrier
    s_mov_b32 s46, 7
L_h_loop:
    s_waitcnt vmcnt(10)
    s_barrier
    s_add_u32 m0, s42, 116736
    s_nop 0
    buffer_load_dwordx4 v1, s[16:19], s40 offen offset:0 lds
    buffer_load_dwordx4 v1, s[16:19], s40 offen offset:1024 lds
    buffer_load_dwordx4 v1, s[16:19], s40 offen offset:2048 lds
    buffer_load_dwordx4 v1, s[16:19], s40 offen offset:3072 lds
    s_add_u32 s40, s40, 524288
    s_add_u32 m0, s43, 116736
    s_nop 0
    buffer_load_dwordx4 v2, s[16:19], s41 offen offset:0 lds
    buffer_load_dwordx4 v2, s[16:19], s41 offen offset:1024 lds
    buffer_load_dwordx4 v2, s[16:19], s41 offen offset:2048 lds
    buffer_load_dwordx4 v2, s[16:19], s41 offen offset:3072 lds
    s_add_u32 m0, s43, 120832
    s_add_u32 s49, s41, 4096
    buffer_load_dwordx4 v2, s[16:19], s49 offen lds
    s_mov_b64 exec, s[50:51]
    buffer_load_dwordx4 v5, s[16:19], s44 offen offset:1024 lds
    s_mov_b64 exec, -1
    s_add_u32 s41, s41, 688128
    s_add_u32 s44, s44, 688128
    s_waitcnt vmcnt(10)
    s_barrier
    s_add_u32 m0, s42, 0
    s_nop 0
    buffer_load_dwordx4 v1, s[16:19], s40 offen offset:0 lds
    buffer_load_dwordx4 v1, s[16:19], s40 offen offset:1024 lds
    buffer_load_dwordx4 v1, s[16:19], s40 offen offset:2048 lds
    buffer_load_dwordx4 v1, s[16:19], s40 offen offset:3072 lds
    s_add_u32 s40, s40, 524288
    s_add_u32 m0, s43, 0
    s_nop 0
    buffer_load_dwordx4 v2, s[16:19], s41 offen offset:0 lds
    buffer_load_dwordx4 v2, s[16:19], s41 offen offset:1024 lds
    buffer_load_dwordx4 v2, s[16:19], s41 offen offset:2048 lds
    buffer_load_dwordx4 v2, s[16:19], s41 offen offset:3072 lds
    s_add_u32 m0, s43, 4096
    s_add_u32 s49, s41, 4096
    buffer_load_dwordx4 v2, s[16:19], s49 offen lds
    s_mov_b64 exec, s[50:51]
    buffer_load_dwordx4 v5, s[16:19], s44 offen offset:1024 lds
    s_mov_b64 exec, -1
    s_add_u32 s41, s41, 688128
    s_add_u32 s44, s44, 688128
    s_waitcnt vmcnt(10)
    s_barrier
    s_add_u32 m0, s42, 38912
    s_nop 0
    buffer_load_dwordx4 v1, s[16:19], s40 offen offset:0 lds
    buffer_load_dwordx4 v1, s[16:19], s40 offen offset:1024 lds
    buffer_load_dwordx4 v1, s[16:19], s40 offen offset:2048 lds
    buffer_load_dwordx4 v1, s[16:19], s40 offen offset:3072 lds
    s_add_u32 s40, s40, 524288
    s_add_u32 m0, s43, 38912
    s_nop 0
    buffer_load_dwordx4 v2, s[16:19], s41 offen offset:0 lds
    buffer_load_dwordx4 v2, s[16:19], s41 offen offset:1024 lds
    buffer_load_dwordx4 v2, s[16:19], s41 offen offset:2048 lds
    buffer_load_dwordx4 v2, s[16:19], s41 offen offset:3072 lds
    s_add_u32 m0, s43, 43008
    s_add_u32 s49, s41, 4096
    buffer_load_dwordx4 v2, s[16:19], s49 offen lds
    s_mov_b64 exec, s[50:51]
    buffer_load_dwordx4 v5, s[16:19], s44 offen offset:1024 lds
    s_mov_b64 exec, -1
    s_add_u32 s41, s41, 688128
    s_add_u32 s44, s44, 688128
    s_waitcnt vmcnt(10)
    s_barrier
    s_add_u32 m0, s42, 77824
    s_nop 0
    buffer_load_dwordx4 v1, s[16:19], s40 offen offset:0 lds
    buffer_load_dwordx4 v1, s[16:19], s40 offen offset:1024 lds
    buffer_load_dwordx4 v1, s[16:19], s40 offen offset:2048 lds
    buffer_load_dwordx4 v1, s[16:19], s40 offen offset:3072 lds
    s_add_u32 s40, s40, 524288
    s_add_u32 m0, s43, 77824
    s_nop 0
    buffer_load_dwordx4 v2, s[16:19], s41 offen offset:0 lds
    buffer_load_dwordx4 v2, s[16:19], s41 offen offset:1024 lds
    buffer_load_dwordx4 v2, s[16:19], s41 offen offset:2048 lds
    buffer_load_dwordx4 v2, s[16:19], s41 offen offset:3072 lds
    s_add_u32 m0, s43, 81920
    s_add_u32 s49, s41, 4096
    buffer_load_dwordx4 v2, s[16:19], s49 offen lds
    s_mov_b64 exec, s[50:51]
    buffer_load_dwordx4 v5, s[16:19], s44 offen offset:1024 lds
    s_mov_b64 exec, -1
    s_add_u32 s41, s41, 688128
    s_add_u32 s44, s44, 688128
    s_sub_u32 s46, s46, 1
    s_cmp_lg_u32 s46, 0
    s_cbranch_scc1 L_h_loop
    s_waitcnt vmcnt(10)
    s_barrier
    s_add_u32 m0, s42, 116736
    s_nop 0
    buffer_load_dwordx4 v1, s[16:19], s40 offen offset:0 lds
    buffer_load_dwordx4 v1, s[16:19], s40 offen offset:1024 lds
    buffer_load_dwordx4 v1, s[16:19], s40 offen offset:2048 lds
    buffer_load_dwordx4 v1, s[16:19], s40 offen offset:3072 lds
    s_add_u32 s40, s40, 524288
    s_add_u32 m0, s43, 116736
    s_nop 0
    buffer_load_dwordx4 v2, s[16:19], s41 offen offset:0 lds
    buffer_load_dwordx4 v2, s[16:19], s41 offen offset:1024 lds
    buffer_load_dwordx4 v2, s[16:19], s41 offen offset:2048 lds
    buffer_load_dwordx4 v2, s[16:19], s41 offen offset:3072 lds
    s_add_u32 m0, s43, 120832
    s_add_u32 s49, s41, 4096
    buffer_load_dwordx4 v2, s[16:19], s49 offen lds
    s_mov_b64 exec, s[50:51]
    buffer_load_dwordx4 v5, s[16:19], s44 offen offset:1024 lds
    s_mov_b64 exec, -1
    s_add_u32 s41, s41, 688128
    s_add_u32 s44, s44, 688128
    s_waitcnt vmcnt(10)
    s_barrier
    s_waitcnt vmcnt(0)
    s_barrier
    s_endpgm
L_k3_end:
    s_endpgm
.globl final_kernel
.p2align 8
.type final_kernel,@function
final_kernel:
    s_cmp_ge_u32 s2, 224
    s_cbranch_scc1 L_k45_end
    s_load_dwordx2 s[8:9], s[0:1], 48
    s_load_dwordx4 s[4:7], s[0:1], 16
    s_load_dwordx2 s[28:29], s[0:1], 32
    v_lshrrev_b32 v204, 6, v0
    v_and_b32 v200, 63, v0
    v_readfirstlane_b32 s10, v204
    v_lshlrev_b32 v214, 2, v0
    v_and_b32 v201, 15, v200
    v_lshrrev_b32 v202, 4, v200
    s_and_b32 s13, s2, 3
    s_lshr_b32 s12, s2, 2
    s_cmp_ge_u32 s12, 28
    s_cselect_b32 s11, 1, 0
    s_mul_i32 s15, s11, 28
    s_sub_u32 s12, s12, s15
    s_mul_i32 s14, s12, 6
    s_add_u32 s14, s14, s10
    s_mov_b32 s24, 8192
    v_mul_u32_u24 v203, s24, v202
    v_lshl_add_u32 v203, v201, 4, v203
    s_mul_i32 s24, s11, 11579392
    s_mul_i32 s25, s14, 65792
    s_add_u32 s24, s24, s25
    s_lshl_b32 s25, s13, 8
    s_add_u32 s24, s24, s25
    s_add_u32 s24, s24, 117440512
    s_mov_b32 s30, 0x05040100
    s_mov_b32 s31, 0x07060302
    s_waitcnt lgkmcnt(0)
    s_mov_b32 s16, s8
    s_and_b32 s17, s9, 0xffff
    s_mov_b32 s18, 268435456
    s_mov_b32 s19, 0x00020000
    s_cmp_ge_u32 s10, 6
    s_cbranch_scc1 L_k45_gb
    s_add_u32 s25, s24, 0
    buffer_load_dwordx4 v[0:3], v203, s[16:19], s25 offen
    s_add_u32 s25, s24, 1024
    buffer_load_dwordx4 v[4:7], v203, s[16:19], s25 offen
    s_add_u32 s25, s24, 2048
    buffer_load_dwordx4 v[8:11], v203, s[16:19], s25 offen
    s_add_u32 s25, s24, 3072
    buffer_load_dwordx4 v[12:15], v203, s[16:19], s25 offen
    s_add_u32 s25, s24, 4096
    buffer_load_dwordx4 v[16:19], v203, s[16:19], s25 offen
    s_add_u32 s25, s24, 5120
    buffer_load_dwordx4 v[20:23], v203, s[16:19], s25 offen
    s_add_u32 s25, s24, 6144
    buffer_load_dwordx4 v[24:27], v203, s[16:19], s25 offen
    s_add_u32 s25, s24, 7168
    buffer_load_dwordx4 v[28:31], v203, s[16:19], s25 offen
    s_add_u32 s25, s24, 32768
    buffer_load_dwordx4 v[32:35], v203, s[16:19], s25 offen
    s_add_u32 s25, s24, 33792
    buffer_load_dwordx4 v[36:39], v203, s[16:19], s25 offen
    s_add_u32 s25, s24, 34816
    buffer_load_dwordx4 v[40:43], v203, s[16:19], s25 offen
    s_add_u32 s25, s24, 35840
    buffer_load_dwordx4 v[44:47], v203, s[16:19], s25 offen
    s_add_u32 s25, s24, 36864
    buffer_load_dwordx4 v[48:51], v203, s[16:19], s25 offen
    s_add_u32 s25, s24, 37888
    buffer_load_dwordx4 v[52:55], v203, s[16:19], s25 offen
    s_add_u32 s25, s24, 38912
    buffer_load_dwordx4 v[56:59], v203, s[16:19], s25 offen
    s_add_u32 s25, s24, 39936
    buffer_load_dwordx4 v[60:63], v203, s[16:19], s25 offen
    s_lshr_b32 s27, s10, 1
    s_and_b32 s33, s10, 1
    s_lshl_b32 s27, s27, 4
    v_add_u32 v204, s27, v201
    s_lshl_b32 s33, s33, 5
    s_add_u32 s33, s33, 1
    v_lshlrev_b32 v205, 3, v202
    v_add_u32 v205, s33, v205
    v_mul_u32_u24 v88, v205, v204
    v_add_u32 v89, 32, v88
    v_add_u32 v205, 2, v205
    v_mul_u32_u24 v90, v205, v204
    v_add_u32 v91, 32, v90
    v_add_u32 v205, 2, v205
    v_mul_u32_u24 v92, v205, v204
    v_add_u32 v93, 32, v92
    v_add_u32 v205, 2, v205
    v_mul_u32_u24 v94, v205, v204
    v_add_u32 v95, 32, v94
    v_and_b32 v88, 127, v88
    v_cvt_f32_u32 v88, v88
    v_mul_f32 v88, 0x3c000000, v88
    v_cos_f32 v88, v88
    v_and_b32 v89, 127, v89
    v_cvt_f32_u32 v89, v89
    v_mul_f32 v89, 0x3c000000, v89
    v_cos_f32 v89, v89
    v_and_b32 v90, 127, v90
    v_cvt_f32_u32 v90, v90
    v_mul_f32 v90, 0x3c000000, v90
    v_cos_f32 v90, v90
    v_and_b32 v91, 127, v91
    v_cvt_f32_u32 v91, v91
    v_mul_f32 v91, 0x3c000000, v91
    v_cos_f32 v91, v91
    v_and_b32 v92, 127, v92
    v_cvt_f32_u32 v92, v92
    v_mul_f32 v92, 0x3c000000, v92
    v_cos_f32 v92, v92
    v_and_b32 v93, 127, v93
    v_cvt_f32_u32 v93, v93
    v_mul_f32 v93, 0x3c000000, v93
    v_cos_f32 v93, v93
    v_and_b32 v94, 127, v94
    v_cvt_f32_u32 v94, v94
    v_mul_f32 v94, 0x3c000000, v94
    v_cos_f32 v94, v94
    v_and_b32 v95, 127, v95
    v_cvt_f32_u32 v95, v95
    v_mul_f32 v95, 0x3c000000, v95
    v_cos_f32 v95, v95
    v_mul_f32 v88, 0x3d000000, v88
    v_mul_f32 v89, 0x3d000000, v89
    v_mul_f32 v90, 0x3d000000, v90
    v_mul_f32 v91, 0x3d000000, v91
    v_mul_f32 v92, 0x3d000000, v92
    v_mul_f32 v93, 0x3d000000, v93
    v_mul_f32 v94, 0x3d000000, v94
    v_mul_f32 v95, 0x3d000000, v95
    v_cvt_pk_bf16_f32 v104, v88, v89
    v_cvt_pk_bf16_f32 v105, v90, v91
    v_cvt_pk_bf16_f32 v106, v92, v93
    v_cvt_pk_bf16_f32 v107, v94, v95
    s_lshl_b32 s26, s10, 10
    v_lshlrev_b32 v207, 4, v200
    v_add_u32 v207, s26, v207
    ds_write_b128 v207, v[104:107] offset:0
L_k45_gb:
    s_cmp_ge_u32 s2, 8
    s_cbranch_scc1 L_nopf45
    s_cmp_lg_u32 s10, 7
    s_cbranch_scc1 L_nopf45
    s_getpc_b64 s[60:61]
L_pf_k45:
    s_sub_u32 s60, s60, L_pf_k45-final_kernel
    s_subb_u32 s61, s61, 0
    v_mbcnt_lo_u32_b32 v112, -1, 0
    v_mbcnt_hi_u32_b32 v112, -1, v112
    v_lshlrev_b32 v112, 6, v112
    v_add_u32 v113, 0, v112
    v_min_u32 v113, L_code_end-final_kernel-4, v113
    v_mov_b32 v115, s61
    v_add_co_u32 v114, vcc, s60, v113
    s_nop 1
    v_addc_co_u32 v115, vcc, 0, v115, vcc
    global_load_dword v116, v[114:115], off
    v_add_u32 v113, 4096, v112
    v_min_u32 v113, L_code_end-final_kernel-4, v113
    v_mov_b32 v115, s61
    v_add_co_u32 v114, vcc, s60, v113
    s_nop 1
    v_addc_co_u32 v115, vcc, 0, v115, vcc
    global_load_dword v116, v[114:115], off
    v_add_u32 v113, 8192, v112
    v_min_u32 v113, L_code_end-final_kernel-4, v113
    v_mov_b32 v115, s61
    v_add_co_u32 v114, vcc, s60, v113
    s_nop 1
    v_addc_co_u32 v115, vcc, 0, v115, vcc
    global_load_dword v116, v[114:115], off
L_nopf45:
    s_mov_b32 s20, s4
    s_and_b32 s21, s5, 0xffff
    s_mov_b32 s22, 1024
    s_mov_b32 s23, 0x00020000
    s_mov_b32 s36, s6
    s_and_b32 s37, s7, 0xffff
    s_mov_b32 s38, 1024
    s_mov_b32 s39, 0x00020000
    v_lshlrev_b32 v210, 4, v201
    s_lshl_b32 s25, s13, 8
    buffer_load_dwordx4 v[232:235], v210, s[20:23], s25 offen
    buffer_load_dwordx4 v[236:239], v210, s[36:39], s25 offen
    s_waitcnt lgkmcnt(0)
    s_barrier
    s_cmp_ge_u32 s10, 6
    s_cbranch_scc1 L_k45_red2
    v_lshlrev_b32 v207, 4, v200
    ds_read_b128 v[64:67], v207 offset:0
    ds_read_b128 v[68:71], v207 offset:1024
    ds_read_b128 v[72:75], v207 offset:2048
    ds_read_b128 v[76:79], v207 offset:3072
    ds_read_b128 v[80:83], v207 offset:4096
    ds_read_b128 v[84:87], v207 offset:5120
    s_cmp_ge_u32 s14, 167
    s_cbranch_scc1 L_k45_zero
    s_waitcnt lgkmcnt(0)
    s_cmp_lg_u32 s14, 166
    s_cbranch_scc1 L_k45_full
    v_cmp_gt_i32 vcc, 17, v201
    s_nop 1
    v_cndmask_b32 v64, 0, v64, vcc
    v_cndmask_b32 v65, 0, v65, vcc
    v_cndmask_b32 v66, 0, v66, vcc
    v_cndmask_b32 v67, 0, v67, vcc
    v_cndmask_b32 v68, 0, v68, vcc
    v_cndmask_b32 v69, 0, v69, vcc
    v_cndmask_b32 v70, 0, v70, vcc
    v_cndmask_b32 v71, 0, v71, vcc
    v_cmp_gt_i32 vcc, 1, v201
    s_nop 1
    v_cndmask_b32 v72, 0, v72, vcc
    v_cndmask_b32 v73, 0, v73, vcc
    v_cndmask_b32 v74, 0, v74, vcc
    v_cndmask_b32 v75, 0, v75, vcc
    v_cndmask_b32 v76, 0, v76, vcc
    v_cndmask_b32 v77, 0, v77, vcc
    v_cndmask_b32 v78, 0, v78, vcc
    v_cndmask_b32 v79, 0, v79, vcc
    v_cmp_gt_i32 vcc, 0, v201
    s_nop 1
    v_cndmask_b32 v80, 0, v80, vcc
    v_cndmask_b32 v81, 0, v81, vcc
    v_cndmask_b32 v82, 0, v82, vcc
    v_cndmask_b32 v83, 0, v83, vcc
    v_cndmask_b32 v84, 0, v84, vcc
    v_cndmask_b32 v85, 0, v85, vcc
    v_cndmask_b32 v86, 0, v86, vcc
    v_cndmask_b32 v87, 0, v87, vcc
L_k45_full:
    s_waitcnt vmcnt(2)
    v_perm_b32 v88, v4, v0, s30
    v_perm_b32 v89, v12, v8, s30
    v_perm_b32 v90, v20, v16, s30
    v_perm_b32 v91, v28, v24, s30
    v_perm_b32 v92, v4, v0, s31
    v_perm_b32 v93, v12, v8, s31
    v_perm_b32 v94, v20, v16, s31
    v_perm_b32 v95, v28, v24, s31
    v_perm_b32 v96, v36, v32, s30
    v_perm_b32 v97, v44, v40, s30
    v_perm_b32 v98, v52, v48, s30
    v_perm_b32 v99, v60, v56, s30
    v_perm_b32 v100, v36, v32, s31
    v_perm_b32 v101, v44, v40, s31
    v_perm_b32 v102, v52, v48, s31
    v_perm_b32 v103, v60, v56, s31
    v_mfma_f32_16x16x32_bf16 v[104:107], v[64:67], v[88:91], 0
    v_mfma_f32_16x16x32_bf16 v[108:111], v[64:67], v[92:95], 0
    v_mfma_f32_16x16x32_bf16 v[136:139], v[72:75], v[88:91], 0
    v_mfma_f32_16x16x32_bf16 v[140:143], v[72:75], v[92:95], 0
    v_mfma_f32_16x16x32_bf16 v[168:171], v[80:83], v[88:91], 0
    v_mfma_f32_16x16x32_bf16 v[172:175], v[80:83], v[92:95], 0
    v_mfma_f32_16x16x32_bf16 v[104:107], v[68:71], v[96:99], v[104:107]
    v_mfma_f32_16x16x32_bf16 v[108:111], v[68:71], v[100:103], v[108:111]
    v_mfma_f32_16x16x32_bf16 v[136:139], v[76:79], v[96:99], v[136:139]
    v_mfma_f32_16x16x32_bf16 v[140:143], v[76:79], v[100:103], v[140:143]
    v_mfma_f32_16x16x32_bf16 v[168:171], v[84:87], v[96:99], v[168:171]
    v_mfma_f32_16x16x32_bf16 v[172:175], v[84:87], v[100:103], v[172:175]
    v_perm_b32 v88, v5, v1, s30
    v_perm_b32 v89, v13, v9, s30
    v_perm_b32 v90, v21, v17, s30
    v_perm_b32 v91, v29, v25, s30
    v_perm_b32 v92, v5, v1, s31
    v_perm_b32 v93, v13, v9, s31
    v_perm_b32 v94, v21, v17, s31
    v_perm_b32 v95, v29, v25, s31
    v_perm_b32 v96, v37, v33, s30
    v_perm_b32 v97, v45, v41, s30
    v_perm_b32 v98, v53, v49, s30
    v_perm_b32 v99, v61, v57, s30
    v_perm_b32 v100, v37, v33, s31
    v_perm_b32 v101, v45, v41, s31
    v_perm_b32 v102, v53, v49, s31
    v_perm_b32 v103, v61, v57, s31
    v_mfma_f32_16x16x32_bf16 v[112:115], v[64:67], v[88:91], 0
    v_mfma_f32_16x16x32_bf16 v[116:119], v[64:67], v[92:95], 0
    v_mfma_f32_16x16x32_bf16 v[144:147], v[72:75], v[88:91], 0
    v_mfma_f32_16x16x32_bf16 v[148:151], v[72:75], v[92:95], 0
    v_mfma_f32_16x16x32_bf16 v[176:179], v[80:83], v[88:91], 0
    v_mfma_f32_16x16x32_bf16 v[180:183], v[80:83], v[92:95], 0
    v_mfma_f32_16x16x32_bf16 v[112:115], v[68:71], v[96:99], v[112:115]
    v_mfma_f32_16x16x32_bf16 v[116:119], v[68:71], v[100:103], v[116:119]
    v_mfma_f32_16x16x32_bf16 v[144:147], v[76:79], v[96:99], v[144:147]
    v_mfma_f32_16x16x32_bf16 v[148:151], v[76:79], v[100:103], v[148:151]
    v_mfma_f32_16x16x32_bf16 v[176:179], v[84:87], v[96:99], v[176:179]
    v_mfma_f32_16x16x32_bf16 v[180:183], v[84:87], v[100:103], v[180:183]
    v_perm_b32 v88, v6, v2, s30
    v_perm_b32 v89, v14, v10, s30
    v_perm_b32 v90, v22, v18, s30
    v_perm_b32 v91, v30, v26, s30
    v_perm_b32 v92, v6, v2, s31
    v_perm_b32 v93, v14, v10, s31
    v_perm_b32 v94, v22, v18, s31
    v_perm_b32 v95, v30, v26, s31
    v_perm_b32 v96, v38, v34, s30
    v_perm_b32 v97, v46, v42, s30
    v_perm_b32 v98, v54, v50, s30
    v_perm_b32 v99, v62, v58, s30
    v_perm_b32 v100, v38, v34, s31
    v_perm_b32 v101, v46, v42, s31
    v_perm_b32 v102, v54, v50, s31
    v_perm_b32 v103, v62, v58, s31
    v_mfma_f32_16x16x32_bf16 v[120:123], v[64:67], v[88:91], 0
    v_mfma_f32_16x16x32_bf16 v[124:127], v[64:67], v[92:95], 0
    v_mfma_f32_16x16x32_bf16 v[152:155], v[72:75], v[88:91], 0
    v_mfma_f32_16x16x32_bf16 v[156:159], v[72:75], v[92:95], 0
    v_mfma_f32_16x16x32_bf16 v[184:187], v[80:83], v[88:91], 0
    v_mfma_f32_16x16x32_bf16 v[188:191], v[80:83], v[92:95], 0
    v_mfma_f32_16x16x32_bf16 v[120:123], v[68:71], v[96:99], v[120:123]
    v_mfma_f32_16x16x32_bf16 v[124:127], v[68:71], v[100:103], v[124:127]
    v_mfma_f32_16x16x32_bf16 v[152:155], v[76:79], v[96:99], v[152:155]
    v_mfma_f32_16x16x32_bf16 v[156:159], v[76:79], v[100:103], v[156:159]
    v_mfma_f32_16x16x32_bf16 v[184:187], v[84:87], v[96:99], v[184:187]
    v_mfma_f32_16x16x32_bf16 v[188:191], v[84:87], v[100:103], v[188:191]
    v_perm_b32 v88, v7, v3, s30
    v_perm_b32 v89, v15, v11, s30
    v_perm_b32 v90, v23, v19, s30
    v_perm_b32 v91, v31, v27, s30
    v_perm_b32 v92, v7, v3, s31
    v_perm_b32 v93, v15, v11, s31
    v_perm_b32 v94, v23, v19, s31
    v_perm_b32 v95, v31, v27, s31
    v_perm_b32 v96, v39, v35, s30
    v_perm_b32 v97, v47, v43, s30
    v_perm_b32 v98, v55, v51, s30
    v_perm_b32 v99, v63, v59, s30
    v_perm_b32 v100, v39, v35, s31
    v_perm_b32 v101, v47, v43, s31
    v_perm_b32 v102, v55, v51, s31
    v_perm_b32 v103, v63, v59, s31
    v_mfma_f32_16x16x32_bf16 v[128:131], v[64:67], v[88:91], 0
    v_mfma_f32_16x16x32_bf16 v[132:135], v[64:67], v[92:95], 0
    v_mfma_f32_16x16x32_bf16 v[160:163], v[72:75], v[88:91], 0
    v_mfma_f32_16x16x32_bf16 v[164:167], v[72:75], v[92:95], 0
    v_mfma_f32_16x16x32_bf16 v[192:195], v[80:83], v[88:91], 0
    v_mfma_f32_16x16x32_bf16 v[196:199], v[80:83], v[92:95], 0
    v_mfma_f32_16x16x32_bf16 v[128:131], v[68:71], v[96:99], v[128:131]
    v_mfma_f32_16x16x32_bf16 v[132:135], v[68:71], v[100:103], v[132:135]
    v_mfma_f32_16x16x32_bf16 v[160:163], v[76:79], v[96:99], v[160:163]
    v_mfma_f32_16x16x32_bf16 v[164:167], v[76:79], v[100:103], v[164:167]
    v_mfma_f32_16x16x32_bf16 v[192:195], v[84:87], v[96:99], v[192:195]
    v_mfma_f32_16x16x32_bf16 v[196:199], v[84:87], v[100:103], v[196:199]
    s_nop 7
    v_mul_f32 v224, v104, v104
    v_mov_b32 v216, v104
    v_fmac_f32 v224, v105, v105
    v_add_f32 v216, v216, v105
    v_fmac_f32 v224, v106, v106
    v_add_f32 v216, v216, v106
    v_fmac_f32 v224, v107, v107
    v_add_f32 v216, v216, v107
    v_fmac_f32 v224, v136, v136
    v_add_f32 v216, v216, v136
    v_fmac_f32 v224, v137, v137
    v_add_f32 v216, v216, v137
    v_fmac_f32 v224, v138, v138
    v_add_f32 v216, v216, v138
    v_fmac_f32 v224, v139, v139
    v_add_f32 v216, v216, v139
    v_fmac_f32 v224, v168, v168
    v_add_f32 v216, v216, v168
    v_fmac_f32 v224, v169, v169
    v_add_f32 v216, v216, v169
    v_fmac_f32 v224, v170, v170
    v_add_f32 v216, v216, v170
    v_fmac_f32 v224, v171, v171
    v_add_f32 v216, v216, v171
    v_mul_f32 v225, v108, v108
    v_mov_b32 v217, v108
    v_fmac_f32 v225, v109, v109
    v_add_f32 v217, v217, v109
    v_fmac_f32 v225, v110, v110
    v_add_f32 v217, v217, v110
    v_fmac_f32 v225, v111, v111
    v_add_f32 v217, v217, v111
    v_fmac_f32 v225, v140, v140
    v_add_f32 v217, v217, v140
    v_fmac_f32 v225, v141, v141
    v_add_f32 v217, v217, v141
    v_fmac_f32 v225, v142, v142
    v_add_f32 v217, v217, v142
    v_fmac_f32 v225, v143, v143
    v_add_f32 v217, v217, v143
    v_fmac_f32 v225, v172, v172
    v_add_f32 v217, v217, v172
    v_fmac_f32 v225, v173, v173
    v_add_f32 v217, v217, v173
    v_fmac_f32 v225, v174, v174
    v_add_f32 v217, v217, v174
    v_fmac_f32 v225, v175, v175
    v_add_f32 v217, v217, v175
    v_mul_f32 v226, v112, v112
    v_mov_b32 v218, v112
    v_fmac_f32 v226, v113, v113
    v_add_f32 v218, v218, v113
    v_fmac_f32 v226, v114, v114
    v_add_f32 v218, v218, v114
    v_fmac_f32 v226, v115, v115
    v_add_f32 v218, v218, v115
    v_fmac_f32 v226, v144, v144
    v_add_f32 v218, v218, v144
    v_fmac_f32 v226, v145, v145
    v_add_f32 v218, v218, v145
    v_fmac_f32 v226, v146, v146
    v_add_f32 v218, v218, v146
    v_fmac_f32 v226, v147, v147
    v_add_f32 v218, v218, v147
    v_fmac_f32 v226, v176, v176
    v_add_f32 v218, v218, v176
    v_fmac_f32 v226, v177, v177
    v_add_f32 v218, v218, v177
    v_fmac_f32 v226, v178, v178
    v_add_f32 v218, v218, v178
    v_fmac_f32 v226, v179, v179
    v_add_f32 v218, v218, v179
    v_mul_f32 v227, v116, v116
    v_mov_b32 v219, v116
    v_fmac_f32 v227, v117, v117
    v_add_f32 v219, v219, v117
    v_fmac_f32 v227, v118, v118
    v_add_f32 v219, v219, v118
    v_fmac_f32 v227, v119, v119
    v_add_f32 v219, v219, v119
    v_fmac_f32 v227, v148, v148
    v_add_f32 v219, v219, v148
    v_fmac_f32 v227, v149, v149
    v_add_f32 v219, v219, v149
    v_fmac_f32 v227, v150, v150
    v_add_f32 v219, v219, v150
    v_fmac_f32 v227, v151, v151
    v_add_f32 v219, v219, v151
    v_fmac_f32 v227, v180, v180
    v_add_f32 v219, v219, v180
    v_fmac_f32 v227, v181, v181
    v_add_f32 v219, v219, v181
    v_fmac_f32 v227, v182, v182
    v_add_f32 v219, v219, v182
    v_fmac_f32 v227, v183, v183
    v_add_f32 v219, v219, v183
    v_mul_f32 v228, v120, v120
    v_mov_b32 v220, v120
    v_fmac_f32 v228, v121, v121
    v_add_f32 v220, v220, v121
    v_fmac_f32 v228, v122, v122
    v_add_f32 v220, v220, v122
    v_fmac_f32 v228, v123, v123
    v_add_f32 v220, v220, v123
    v_fmac_f32 v228, v152, v152
    v_add_f32 v220, v220, v152
    v_fmac_f32 v228, v153, v153
    v_add_f32 v220, v220, v153
    v_fmac_f32 v228, v154, v154
    v_add_f32 v220, v220, v154
    v_fmac_f32 v228, v155, v155
    v_add_f32 v220, v220, v155
    v_fmac_f32 v228, v184, v184
    v_add_f32 v220, v220, v184
    v_fmac_f32 v228, v185, v185
    v_add_f32 v220, v220, v185
    v_fmac_f32 v228, v186, v186
    v_add_f32 v220, v220, v186
    v_fmac_f32 v228, v187, v187
    v_add_f32 v220, v220, v187
    v_mul_f32 v229, v124, v124
    v_mov_b32 v221, v124
    v_fmac_f32 v229, v125, v125
    v_add_f32 v221, v221, v125
    v_fmac_f32 v229, v126, v126
    v_add_f32 v221, v221, v126
    v_fmac_f32 v229, v127, v127
    v_add_f32 v221, v221, v127
    v_fmac_f32 v229, v156, v156
    v_add_f32 v221, v221, v156
    v_fmac_f32 v229, v157, v157
    v_add_f32 v221, v221, v157
    v_fmac_f32 v229, v158, v158
    v_add_f32 v221, v221, v158
    v_fmac_f32 v229, v159, v159
    v_add_f32 v221, v221, v159
    v_fmac_f32 v229, v188, v188
    v_add_f32 v221, v221, v188
    v_fmac_f32 v229, v189, v189
    v_add_f32 v221, v221, v189
    v_fmac_f32 v229, v190, v190
    v_add_f32 v221, v221, v190
    v_fmac_f32 v229, v191, v191
    v_add_f32 v221, v221, v191
    v_mul_f32 v230, v128, v128
    v_mov_b32 v222, v128
    v_fmac_f32 v230, v129, v129
    v_add_f32 v222, v222, v129
    v_fmac_f32 v230, v130, v130
    v_add_f32 v222, v222, v130
    v_fmac_f32 v230, v131, v131
    v_add_f32 v222, v222, v131
    v_fmac_f32 v230, v160, v160
    v_add_f32 v222, v222, v160
    v_fmac_f32 v230, v161, v161
    v_add_f32 v222, v222, v161
    v_fmac_f32 v230, v162, v162
    v_add_f32 v222, v222, v162
    v_fmac_f32 v230, v163, v163
    v_add_f32 v222, v222, v163
    v_fmac_f32 v230, v192, v192
    v_add_f32 v222, v222, v192
    v_fmac_f32 v230, v193, v193
    v_add_f32 v222, v222, v193
    v_fmac_f32 v230, v194, v194
    v_add_f32 v222, v222, v194
    v_fmac_f32 v230, v195, v195
    v_add_f32 v222, v222, v195
    v_mul_f32 v231, v132, v132
    v_mov_b32 v223, v132
    v_fmac_f32 v231, v133, v133
    v_add_f32 v223, v223, v133
    v_fmac_f32 v231, v134, v134
    v_add_f32 v223, v223, v134
    v_fmac_f32 v231, v135, v135
    v_add_f32 v223, v223, v135
    v_fmac_f32 v231, v164, v164
    v_add_f32 v223, v223, v164
    v_fmac_f32 v231, v165, v165
    v_add_f32 v223, v223, v165
    v_fmac_f32 v231, v166, v166
    v_add_f32 v223, v223, v166
    v_fmac_f32 v231, v167, v167
    v_add_f32 v223, v223, v167
    v_fmac_f32 v231, v196, v196
    v_add_f32 v223, v223, v196
    v_fmac_f32 v231, v197, v197
    v_add_f32 v223, v223, v197
    v_fmac_f32 v231, v198, v198
    v_add_f32 v223, v223, v198
    v_fmac_f32 v231, v199, v199
    v_add_f32 v223, v223, v199
    s_branch L_k45_red
L_k45_zero:
    s_waitcnt vmcnt(0) lgkmcnt(0)
    v_mov_b32 v216, 0
    v_mov_b32 v224, 0
    v_mov_b32 v217, 0
    v_mov_b32 v225, 0
    v_mov_b32 v218, 0
    v_mov_b32 v226, 0
    v_mov_b32 v219, 0
    v_mov_b32 v227, 0
    v_mov_b32 v220, 0
    v_mov_b32 v228, 0
    v_mov_b32 v221, 0
    v_mov_b32 v229, 0
    v_mov_b32 v222, 0
    v_mov_b32 v230, 0
    v_mov_b32 v223, 0
    v_mov_b32 v231, 0
L_k45_red:
    s_lshl_b32 s25, s10, 12
    v_lshlrev_b32 v204, 10, v202
    v_lshl_add_u32 v204, v201, 5, v204
    v_add_u32 v204, s25, v204
    ds_write_b128 v204, v[216:219] offset:8192
    ds_write_b128 v204, v[220:223] offset:8208
    ds_write_b128 v204, v[224:227] offset:8704
    ds_write_b128 v204, v[228:231] offset:8720
    s_lshl_b32 s25, s10, 13
    v_lshlrev_b32 v205, 4, v200
    v_add_u32 v205, s25, v205
    ds_write_b96 v205, v[168:170] offset:33792
    ds_write_b96 v205, v[172:174] offset:34816
    ds_write_b96 v205, v[176:178] offset:35840
    ds_write_b96 v205, v[180:182] offset:36864
    ds_write_b96 v205, v[184:186] offset:37888
    ds_write_b96 v205, v[188:190] offset:38912
    ds_write_b96 v205, v[192:194] offset:39936
    ds_write_b96 v205, v[196:198] offset:40960
L_k45_red2:
    s_waitcnt lgkmcnt(0)
    s_barrier
    s_mul_i32 s24, s11, 112
    s_mul_i32 s25, s13, 28
    s_add_u32 s24, s24, s25
    s_lshl_b32 s26, s24, 10
    s_add_u32 s26, s26, 146800640
    s_cmp_ge_u32 s10, 6
    s_cbranch_scc1 L_k45_hread
    s_cmp_ge_u32 s10, 4
    s_cbranch_scc1 L_k45_sumdone
    ds_read_b32 v16, v214 offset:8192
    ds_read_b32 v17, v214 offset:9216
    ds_read_b32 v18, v214 offset:10240
    ds_read_b32 v19, v214 offset:11264
    ds_read_b32 v20, v214 offset:12288
    ds_read_b32 v21, v214 offset:13312
    ds_read_b32 v22, v214 offset:14336
    ds_read_b32 v23, v214 offset:15360
    ds_read_b32 v24, v214 offset:16384
    ds_read_b32 v25, v214 offset:17408
    ds_read_b32 v26, v214 offset:18432
    ds_read_b32 v27, v214 offset:19456
    ds_read_b32 v28, v214 offset:20480
    ds_read_b32 v29, v214 offset:21504
    ds_read_b32 v30, v214 offset:22528
    ds_read_b32 v31, v214 offset:23552
    ds_read_b32 v32, v214 offset:24576
    ds_read_b32 v33, v214 offset:25600
    ds_read_b32 v34, v214 offset:26624
    ds_read_b32 v35, v214 offset:27648
    ds_read_b32 v36, v214 offset:28672
    ds_read_b32 v37, v214 offset:29696
    ds_read_b32 v38, v214 offset:30720
    ds_read_b32 v39, v214 offset:31744
    s_waitcnt lgkmcnt(0)
    v_add_f32 v16, v16, v17
    v_add_f32 v18, v18, v19
    v_add_f32 v20, v20, v21
    v_add_f32 v22, v22, v23
    v_add_f32 v24, v24, v25
    v_add_f32 v26, v26, v27
    v_add_f32 v28, v28, v29
    v_add_f32 v30, v30, v31
    v_add_f32 v32, v32, v33
    v_add_f32 v34, v34, v35
    v_add_f32 v36, v36, v37
    v_add_f32 v38, v38, v39
    v_add_f32 v16, v16, v18
    v_add_f32 v20, v20, v22
    v_add_f32 v24, v24, v26
    v_add_f32 v28, v28, v30
    v_add_f32 v32, v32, v34
    v_add_f32 v36, v36, v38
    v_add_f32 v16, v16, v20
    v_add_f32 v24, v24, v28
    v_add_f32 v32, v32, v36
    v_add_f32 v16, v16, v24
    v_add_f32 v16, v16, v32
    s_lshl_b32 s24, s12, 10
    s_add_u32 s24, s24, s26
    buffer_store_dword v16, v214, s[16:19], s24 offen sc1
    s_mov_b32 s33, 16384
L_k45_poll:
    s_mov_b32 s27, s26
    buffer_load_dword v0, v214, s[16:19], s27 offen offset:0 sc1
    buffer_load_dword v1, v214, s[16:19], s27 offen offset:1024 sc1
    buffer_load_dword v2, v214, s[16:19], s27 offen offset:2048 sc1
    buffer_load_dword v3, v214, s[16:19], s27 offen offset:3072 sc1
    s_add_u32 s27, s27, 4096
    buffer_load_dword v4, v214, s[16:19], s27 offen offset:0 sc1
    buffer_load_dword v5, v214, s[16:19], s27 offen offset:1024 sc1
    buffer_load_dword v6, v214, s[16:19], s27 offen offset:2048 sc1
    buffer_load_dword v7, v214, s[16:19], s27 offen offset:3072 sc1
    s_add_u32 s27, s27, 4096
    buffer_load_dword v8, v214, s[16:19], s27 offen offset:0 sc1
    buffer_load_dword v9, v214, s[16:19], s27 offen offset:1024 sc1
    buffer_load_dword v10, v214, s[16:19], s27 offen offset:2048 sc1
    buffer_load_dword v11, v214, s[16:19], s27 offen offset:3072 sc1
    s_add_u32 s27, s27, 4096
    buffer_load_dword v12, v214, s[16:19], s27 offen offset:0 sc1
    buffer_load_dword v13, v214, s[16:19], s27 offen offset:1024 sc1
    buffer_load_dword v14, v214, s[16:19], s27 offen offset:2048 sc1
    buffer_load_dword v15, v214, s[16:19], s27 offen offset:3072 sc1
    s_add_u32 s27, s27, 4096
    buffer_load_dword v16, v214, s[16:19], s27 offen offset:0 sc1
    buffer_load_dword v17, v214, s[16:19], s27 offen offset:1024 sc1
    buffer_load_dword v18, v214, s[16:19], s27 offen offset:2048 sc1
    buffer_load_dword v19, v214, s[16:19], s27 offen offset:3072 sc1
    s_add_u32 s27, s27, 4096
    buffer_load_dword v20, v214, s[16:19], s27 offen offset:0 sc1
    buffer_load_dword v21, v214, s[16:19], s27 offen offset:1024 sc1
    buffer_load_dword v22, v214, s[16:19], s27 offen offset:2048 sc1
    buffer_load_dword v23, v214, s[16:19], s27 offen offset:3072 sc1
    s_add_u32 s27, s27, 4096
    buffer_load_dword v24, v214, s[16:19], s27 offen offset:0 sc1
    buffer_load_dword v25, v214, s[16:19], s27 offen offset:1024 sc1
    buffer_load_dword v26, v214, s[16:19], s27 offen offset:2048 sc1
    buffer_load_dword v27, v214, s[16:19], s27 offen offset:3072 sc1
    s_waitcnt vmcnt(0)
    v_max3_u32 v32, v0, v1, v2
    v_max3_u32 v32, v32, v3, v4
    v_max3_u32 v32, v32, v5, v6
    v_max3_u32 v32, v32, v7, v8
    v_max3_u32 v32, v32, v9, v10
    v_max3_u32 v32, v32, v11, v12
    v_max3_u32 v32, v32, v13, v14
    v_max3_u32 v32, v32, v15, v16
    v_max3_u32 v32, v32, v17, v18
    v_max3_u32 v32, v32, v19, v20
    v_max3_u32 v32, v32, v21, v22
    v_max3_u32 v32, v32, v23, v24
    v_max3_u32 v32, v32, v25, v26
    v_max_u32 v32, v32, v27
    v_cmp_eq_u32 vcc, -1, v32
    s_nop 3
    s_cmp_eq_u64 vcc, 0
    s_cbranch_scc1 L_k45_got
    s_sub_u32 s33, s33, 1
    s_cmp_eq_u32 s33, 0
    s_cbranch_scc1 L_k45_got
    s_sleep 2
    s_branch L_k45_poll
L_k45_got:
    v_add_f32 v0, v0, v1
    v_add_f32 v2, v2, v3
    v_add_f32 v4, v4, v5
    v_add_f32 v6, v6, v7
    v_add_f32 v8, v8, v9
    v_add_f32 v10, v10, v11
    v_add_f32 v12, v12, v13
    v_add_f32 v14, v14, v15
    v_add_f32 v16, v16, v17
    v_add_f32 v18, v18, v19
    v_add_f32 v20, v20, v21
    v_add_f32 v22, v22, v23
    v_add_f32 v24, v24, v25
    v_add_f32 v26, v26, v27
    v_add_f32 v0, v0, v2
    v_add_f32 v4, v4, v6
    v_add_f32 v8, v8, v10
    v_add_f32 v12, v12, v14
    v_add_f32 v16, v16, v18
    v_add_f32 v20, v20, v22
    v_add_f32 v24, v24, v26
    v_add_f32 v0, v0, v4
    v_add_f32 v8, v8, v12
    v_add_f32 v16, v16, v20
    v_add_f32 v0, v0, v8
    v_add_f32 v16, v16, v24
    v_add_f32 v0, v0, v16
    ds_write_b32 v214, v0 offset:32768
    s_branch L_k45_sumdone
L_k45_hread:
    s_waitcnt vmcnt(0)
    s_sub_u32 s25, s10, 6
    s_mul_i32 s25, s25, 3
    s_lshl_b32 s25, s25, 13
    v_lshlrev_b32 v205, 4, v200
    v_add_u32 v205, s25, v205
    ds_read_b96 v[104:106], v205 offset:33792
    ds_read_b96 v[108:110], v205 offset:34816
    ds_read_b96 v[112:114], v205 offset:35840
    ds_read_b96 v[116:118], v205 offset:36864
    ds_read_b96 v[120:122], v205 offset:37888
    ds_read_b96 v[124:126], v205 offset:38912
    ds_read_b96 v[128:130], v205 offset:39936
    ds_read_b96 v[132:134], v205 offset:40960
    s_waitcnt lgkmcnt(0)
    ds_read_b96 v[136:138], v205 offset:41984
    ds_read_b96 v[140:142], v205 offset:43008
    ds_read_b96 v[144:146], v205 offset:44032
    ds_read_b96 v[148:150], v205 offset:45056
    ds_read_b96 v[152:154], v205 offset:46080
    ds_read_b96 v[156:158], v205 offset:47104
    ds_read_b96 v[160:162], v205 offset:48128
    ds_read_b96 v[164:166], v205 offset:49152
    s_waitcnt lgkmcnt(0)
    ds_read_b96 v[168:170], v205 offset:50176
    ds_read_b96 v[172:174], v205 offset:51200
    ds_read_b96 v[176:178], v205 offset:52224
    ds_read_b96 v[180:182], v205 offset:53248
    ds_read_b96 v[184:186], v205 offset:54272
    ds_read_b96 v[188:190], v205 offset:55296
    ds_read_b96 v[192:194], v205 offset:56320
    ds_read_b96 v[196:198], v205 offset:57344
    s_waitcnt lgkmcnt(0)
L_k45_sumdone:
    s_waitcnt lgkmcnt(0)
    s_barrier
    v_lshlrev_b32 v210, 5, v201
    ds_read_b128 v[44:47], v210 offset:32768
    ds_read_b128 v[48:51], v210 offset:32784
    ds_read_b128 v[52:55], v210 offset:33280
    ds_read_b128 v[56:59], v210 offset:33296
    s_mov_b32 s24, 0x39035177
    s_mov_b32 s25, 0x3727c5ac
    s_waitcnt vmcnt(0) lgkmcnt(0)
    v_mul_f32 v44, s24, v44
    v_mul_f32 v52, s24, v52
    v_fma_f32 v52, -v44, v44, v52
    v_max_f32 v52, 0, v52
    v_add_f32 v52, s25, v52
    v_rsq_f32 v52, v52
    v_lshlrev_b32 v216, 16, v232
    v_lshlrev_b32 v224, 16, v236
    v_mul_f32 v216, v216, v52
    v_fma_f32 v224, -v44, v216, v224
    v_mul_f32 v45, s24, v45
    v_mul_f32 v53, s24, v53
    v_fma_f32 v53, -v45, v45, v53
    v_max_f32 v53, 0, v53
    v_add_f32 v53, s25, v53
    v_rsq_f32 v53, v53
    v_and_b32 v217, 0xffff0000, v232
    v_and_b32 v225, 0xffff0000, v236
    v_mul_f32 v217, v217, v53
    v_fma_f32 v225, -v45, v217, v225
    v_mul_f32 v46, s24, v46
    v_mul_f32 v54, s24, v54
    v_fma_f32 v54, -v46, v46, v54
    v_max_f32 v54, 0, v54
    v_add_f32 v54, s25, v54
    v_rsq_f32 v54, v54
    v_lshlrev_b32 v218, 16, v233
    v_lshlrev_b32 v226, 16, v237
    v_mul_f32 v218, v218, v54
    v_fma_f32 v226, -v46, v218, v226
    v_mul_f32 v47, s24, v47
    v_mul_f32 v55, s24, v55
    v_fma_f32 v55, -v47, v47, v55
    v_max_f32 v55, 0, v55
    v_add_f32 v55, s25, v55
    v_rsq_f32 v55, v55
    v_and_b32 v219, 0xffff0000, v233
    v_and_b32 v227, 0xffff0000, v237
    v_mul_f32 v219, v219, v55
    v_fma_f32 v227, -v47, v219, v227
    v_mul_f32 v48, s24, v48
    v_mul_f32 v56, s24, v56
    v_fma_f32 v56, -v48, v48, v56
    v_max_f32 v56, 0, v56
    v_add_f32 v56, s25, v56
    v_rsq_f32 v56, v56
    v_lshlrev_b32 v220, 16, v234
    v_lshlrev_b32 v228, 16, v238
    v_mul_f32 v220, v220, v56
    v_fma_f32 v228, -v48, v220, v228
    v_mul_f32 v49, s24, v49
    v_mul_f32 v57, s24, v57
    v_fma_f32 v57, -v49, v49, v57
    v_max_f32 v57, 0, v57
    v_add_f32 v57, s25, v57
    v_rsq_f32 v57, v57
    v_and_b32 v221, 0xffff0000, v234
    v_and_b32 v229, 0xffff0000, v238
    v_mul_f32 v221, v221, v57
    v_fma_f32 v229, -v49, v221, v229
    v_mul_f32 v50, s24, v50
    v_mul_f32 v58, s24, v58
    v_fma_f32 v58, -v50, v50, v58
    v_max_f32 v58, 0, v58
    v_add_f32 v58, s25, v58
    v_rsq_f32 v58, v58
    v_lshlrev_b32 v222, 16, v235
    v_lshlrev_b32 v230, 16, v239
    v_mul_f32 v222, v222, v58
    v_fma_f32 v230, -v50, v222, v230
    v_mul_f32 v51, s24, v51
    v_mul_f32 v59, s24, v59
    v_fma_f32 v59, -v51, v51, v59
    v_max_f32 v59, 0, v59
    v_add_f32 v59, s25, v59
    v_rsq_f32 v59, v59
    v_and_b32 v223, 0xffff0000, v235
    v_and_b32 v231, 0xffff0000, v239
    v_mul_f32 v223, v223, v59
    v_fma_f32 v231, -v51, v223, v231
    s_mul_i32 s24, s11, 8176640
    s_add_u32 s28, s28, s24
    s_addc_u32 s29, s29, 0
    s_mov_b32 s32, s28
    s_and_b32 s33, s29, 0xffff
    s_mov_b32 s34, 8176640
    s_mov_b32 s35, 0x00020000
    s_lshl_b32 s25, s13, 8
    v_lshlrev_b32 v210, 12, v202
    v_lshl_add_u32 v210, v201, 4, v210
    v_add_u32 v210, s25, v210
    s_mov_b32 s26, 0xbdd2d3e8
    v_mov_b32 v211, 0xc0135761
    s_cmp_ge_u32 s10, 6
    s_cbranch_scc1 L_k45_hgelu
    s_cmp_ge_u32 s14, 167
    s_cbranch_scc1 L_k45_fin
    s_mul_i32 s24, s14, 49152
    v_fma_f32 v104, v104, v216, v224
    v_fma_f32 v108, v108, v217, v225
    v_fma_f32 v112, v112, v218, v226
    v_fma_f32 v116, v116, v219, v227
    v_fma_f32 v120, v120, v220, v228
    v_fma_f32 v124, v124, v221, v229
    v_fma_f32 v128, v128, v222, v230
    v_fma_f32 v132, v132, v223, v231
    v_mul_f32 v0, v104, v104
    v_mul_f32 v1, v108, v108
    v_mul_f32 v2, v112, v112
    v_mul_f32 v3, v116, v116
    v_mul_f32 v4, v120, v120
    v_mul_f32 v5, v124, v124
    v_mul_f32 v6, v128, v128
    v_mul_f32 v7, v132, v132
    v_fma_f32 v0, v0, s26, v211
    v_fma_f32 v1, v1, s26, v211
    v_fma_f32 v2, v2, s26, v211
    v_fma_f32 v3, v3, s26, v211
    v_fma_f32 v4, v4, s26, v211
    v_fma_f32 v5, v5, s26, v211
    v_fma_f32 v6, v6, s26, v211
    v_fma_f32 v7, v7, s26, v211
    v_mul_f32 v0, v0, v104
    v_mul_f32 v1, v1, v108
    v_mul_f32 v2, v2, v112
    v_mul_f32 v3, v3, v116
    v_mul_f32 v4, v4, v120
    v_mul_f32 v5, v5, v124
    v_mul_f32 v6, v6, v128
    v_mul_f32 v7, v7, v132
    v_exp_f32 v0, v0
    v_exp_f32 v1, v1
    v_exp_f32 v2, v2
    v_exp_f32 v3, v3
    v_exp_f32 v4, v4
    v_exp_f32 v5, v5
    v_exp_f32 v6, v6
    v_exp_f32 v7, v7
    v_add_f32 v0, 1.0, v0
    v_add_f32 v1, 1.0, v1
    v_add_f32 v2, 1.0, v2
    v_add_f32 v3, 1.0, v3
    v_add_f32 v4, 1.0, v4
    v_add_f32 v5, 1.0, v5
    v_add_f32 v6, 1.0, v6
    v_add_f32 v7, 1.0, v7
    v_rcp_f32 v0, v0
    v_rcp_f32 v1, v1
    v_rcp_f32 v2, v2
    v_rcp_f32 v3, v3
    v_rcp_f32 v4, v4
    v_rcp_f32 v5, v5
    v_rcp_f32 v6, v6
    v_rcp_f32 v7, v7
    v_mul_f32 v0, v0, v104
    v_mul_f32 v1, v1, v108
    v_mul_f32 v2, v2, v112
    v_mul_f32 v3, v3, v116
    v_mul_f32 v4, v4, v120
    v_mul_f32 v5, v5, v124
    v_mul_f32 v6, v6, v128
    v_mul_f32 v7, v7, v132
    v_cvt_pk_bf16_f32 v16, v0, v1
    v_cvt_pk_bf16_f32 v17, v2, v3
    v_cvt_pk_bf16_f32 v18, v4, v5
    v_cvt_pk_bf16_f32 v19, v6, v7
    s_add_u32 s27, s24, 0
    buffer_store_dwordx4 v[16:19], v210, s[32:35], s27 offen sc1
    v_fma_f32 v105, v105, v216, v224
    v_fma_f32 v109, v109, v217, v225
    v_fma_f32 v113, v113, v218, v226
    v_fma_f32 v117, v117, v219, v227
    v_fma_f32 v121, v121, v220, v228
    v_fma_f32 v125, v125, v221, v229
    v_fma_f32 v129, v129, v222, v230
    v_fma_f32 v133, v133, v223, v231
    v_mul_f32 v0, v105, v105
    v_mul_f32 v1, v109, v109
    v_mul_f32 v2, v113, v113
    v_mul_f32 v3, v117, v117
    v_mul_f32 v4, v121, v121
    v_mul_f32 v5, v125, v125
    v_mul_f32 v6, v129, v129
    v_mul_f32 v7, v133, v133
    v_fma_f32 v0, v0, s26, v211
    v_fma_f32 v1, v1, s26, v211
    v_fma_f32 v2, v2, s26, v211
    v_fma_f32 v3, v3, s26, v211
    v_fma_f32 v4, v4, s26, v211
    v_fma_f32 v5, v5, s26, v211
    v_fma_f32 v6, v6, s26, v211
    v_fma_f32 v7, v7, s26, v211
    v_mul_f32 v0, v0, v105
    v_mul_f32 v1, v1, v109
    v_mul_f32 v2, v2, v113
    v_mul_f32 v3, v3, v117
    v_mul_f32 v4, v4, v121
    v_mul_f32 v5, v5, v125
    v_mul_f32 v6, v6, v129
    v_mul_f32 v7, v7, v133
    v_exp_f32 v0, v0
    v_exp_f32 v1, v1
    v_exp_f32 v2, v2
    v_exp_f32 v3, v3
    v_exp_f32 v4, v4
    v_exp_f32 v5, v5
    v_exp_f32 v6, v6
    v_exp_f32 v7, v7
    v_add_f32 v0, 1.0, v0
    v_add_f32 v1, 1.0, v1
    v_add_f32 v2, 1.0, v2
    v_add_f32 v3, 1.0, v3
    v_add_f32 v4, 1.0, v4
    v_add_f32 v5, 1.0, v5
    v_add_f32 v6, 1.0, v6
    v_add_f32 v7, 1.0, v7
    v_rcp_f32 v0, v0
    v_rcp_f32 v1, v1
    v_rcp_f32 v2, v2
    v_rcp_f32 v3, v3
    v_rcp_f32 v4, v4
    v_rcp_f32 v5, v5
    v_rcp_f32 v6, v6
    v_rcp_f32 v7, v7
    v_mul_f32 v0, v0, v105
    v_mul_f32 v1, v1, v109
    v_mul_f32 v2, v2, v113
    v_mul_f32 v3, v3, v117
    v_mul_f32 v4, v4, v121
    v_mul_f32 v5, v5, v125
    v_mul_f32 v6, v6, v129
    v_mul_f32 v7, v7, v133
    v_cvt_pk_bf16_f32 v20, v0, v1
    v_cvt_pk_bf16_f32 v21, v2, v3
    v_cvt_pk_bf16_f32 v22, v4, v5
    v_cvt_pk_bf16_f32 v23, v6, v7
    s_add_u32 s27, s24, 1024
    buffer_store_dwordx4 v[20:23], v210, s[32:35], s27 offen sc1
    v_fma_f32 v106, v106, v216, v224
    v_fma_f32 v110, v110, v217, v225
    v_fma_f32 v114, v114, v218, v226
    v_fma_f32 v118, v118, v219, v227
    v_fma_f32 v122, v122, v220, v228
    v_fma_f32 v126, v126, v221, v229
    v_fma_f32 v130, v130, v222, v230
    v_fma_f32 v134, v134, v223, v231
    v_mul_f32 v0, v106, v106
    v_mul_f32 v1, v110, v110
    v_mul_f32 v2, v114, v114
    v_mul_f32 v3, v118, v118
    v_mul_f32 v4, v122, v122
    v_mul_f32 v5, v126, v126
    v_mul_f32 v6, v130, v130
    v_mul_f32 v7, v134, v134
    v_fma_f32 v0, v0, s26, v211
    v_fma_f32 v1, v1, s26, v211
    v_fma_f32 v2, v2, s26, v211
    v_fma_f32 v3, v3, s26, v211
    v_fma_f32 v4, v4, s26, v211
    v_fma_f32 v5, v5, s26, v211
    v_fma_f32 v6, v6, s26, v211
    v_fma_f32 v7, v7, s26, v211
    v_mul_f32 v0, v0, v106
    v_mul_f32 v1, v1, v110
    v_mul_f32 v2, v2, v114
    v_mul_f32 v3, v3, v118
    v_mul_f32 v4, v4, v122
    v_mul_f32 v5, v5, v126
    v_mul_f32 v6, v6, v130
    v_mul_f32 v7, v7, v134
    v_exp_f32 v0, v0
    v_exp_f32 v1, v1
    v_exp_f32 v2, v2
    v_exp_f32 v3, v3
    v_exp_f32 v4, v4
    v_exp_f32 v5, v5
    v_exp_f32 v6, v6
    v_exp_f32 v7, v7
    v_add_f32 v0, 1.0, v0
    v_add_f32 v1, 1.0, v1
    v_add_f32 v2, 1.0, v2
    v_add_f32 v3, 1.0, v3
    v_add_f32 v4, 1.0, v4
    v_add_f32 v5, 1.0, v5
    v_add_f32 v6, 1.0, v6
    v_add_f32 v7, 1.0, v7
    v_rcp_f32 v0, v0
    v_rcp_f32 v1, v1
    v_rcp_f32 v2, v2
    v_rcp_f32 v3, v3
    v_rcp_f32 v4, v4
    v_rcp_f32 v5, v5
    v_rcp_f32 v6, v6
    v_rcp_f32 v7, v7
    v_mul_f32 v0, v0, v106
    v_mul_f32 v1, v1, v110
    v_mul_f32 v2, v2, v114
    v_mul_f32 v3, v3, v118
    v_mul_f32 v4, v4, v122
    v_mul_f32 v5, v5, v126
    v_mul_f32 v6, v6, v130
    v_mul_f32 v7, v7, v134
    v_cvt_pk_bf16_f32 v24, v0, v1
    v_cvt_pk_bf16_f32 v25, v2, v3
    v_cvt_pk_bf16_f32 v26, v4, v5
    v_cvt_pk_bf16_f32 v27, v6, v7
    s_add_u32 s27, s24, 2048
    buffer_store_dwordx4 v[24:27], v210, s[32:35], s27 offen sc1
    v_fma_f32 v107, v107, v216, v224
    v_fma_f32 v111, v111, v217, v225
    v_fma_f32 v115, v115, v218, v226
    v_fma_f32 v119, v119, v219, v227
    v_fma_f32 v123, v123, v220, v228
    v_fma_f32 v127, v127, v221, v229
    v_fma_f32 v131, v131, v222, v230
    v_fma_f32 v135, v135, v223, v231
    v_mul_f32 v0, v107, v107
    v_mul_f32 v1, v111, v111
    v_mul_f32 v2, v115, v115
    v_mul_f32 v3, v119, v119
    v_mul_f32 v4, v123, v123
    v_mul_f32 v5, v127, v127
    v_mul_f32 v6, v131, v131
    v_mul_f32 v7, v135, v135
    v_fma_f32 v0, v0, s26, v211
    v_fma_f32 v1, v1, s26, v211
    v_fma_f32 v2, v2, s26, v211
    v_fma_f32 v3, v3, s26, v211
    v_fma_f32 v4, v4, s26, v211
    v_fma_f32 v5, v5, s26, v211
    v_fma_f32 v6, v6, s26, v211
    v_fma_f32 v7, v7, s26, v211
    v_mul_f32 v0, v0, v107
    v_mul_f32 v1, v1, v111
    v_mul_f32 v2, v2, v115
    v_mul_f32 v3, v3, v119
    v_mul_f32 v4, v4, v123
    v_mul_f32 v5, v5, v127
    v_mul_f32 v6, v6, v131
    v_mul_f32 v7, v7, v135
    v_exp_f32 v0, v0
    v_exp_f32 v1, v1
    v_exp_f32 v2, v2
    v_exp_f32 v3, v3
    v_exp_f32 v4, v4
    v_exp_f32 v5, v5
    v_exp_f32 v6, v6
    v_exp_f32 v7, v7
    v_add_f32 v0, 1.0, v0
    v_add_f32 v1, 1.0, v1
    v_add_f32 v2, 1.0, v2
    v_add_f32 v3, 1.0, v3
    v_add_f32 v4, 1.0, v4
    v_add_f32 v5, 1.0, v5
    v_add_f32 v6, 1.0, v6
    v_add_f32 v7, 1.0, v7
    v_rcp_f32 v0, v0
    v_rcp_f32 v1, v1
    v_rcp_f32 v2, v2
    v_rcp_f32 v3, v3
    v_rcp_f32 v4, v4
    v_rcp_f32 v5, v5
    v_rcp_f32 v6, v6
    v_rcp_f32 v7, v7
    v_mul_f32 v0, v0, v107
    v_mul_f32 v1, v1, v111
    v_mul_f32 v2, v2, v115
    v_mul_f32 v3, v3, v119
    v_mul_f32 v4, v4, v123
    v_mul_f32 v5, v5, v127
    v_mul_f32 v6, v6, v131
    v_mul_f32 v7, v7, v135
    v_cvt_pk_bf16_f32 v28, v0, v1
    v_cvt_pk_bf16_f32 v29, v2, v3
    v_cvt_pk_bf16_f32 v30, v4, v5
    v_cvt_pk_bf16_f32 v31, v6, v7
    s_add_u32 s27, s24, 3072
    buffer_store_dwordx4 v[28:31], v210, s[32:35], s27 offen sc1
    v_fma_f32 v136, v136, v216, v224
    v_fma_f32 v140, v140, v217, v225
    v_fma_f32 v144, v144, v218, v226
    v_fma_f32 v148, v148, v219, v227
    v_fma_f32 v152, v152, v220, v228
    v_fma_f32 v156, v156, v221, v229
    v_fma_f32 v160, v160, v222, v230
    v_fma_f32 v164, v164, v223, v231
    v_mul_f32 v0, v136, v136
    v_mul_f32 v1, v140, v140
    v_mul_f32 v2, v144, v144
    v_mul_f32 v3, v148, v148
    v_mul_f32 v4, v152, v152
    v_mul_f32 v5, v156, v156
    v_mul_f32 v6, v160, v160
    v_mul_f32 v7, v164, v164
    v_fma_f32 v0, v0, s26, v211
    v_fma_f32 v1, v1, s26, v211
    v_fma_f32 v2, v2, s26, v211
    v_fma_f32 v3, v3, s26, v211
    v_fma_f32 v4, v4, s26, v211
    v_fma_f32 v5, v5, s26, v211
    v_fma_f32 v6, v6, s26, v211
    v_fma_f32 v7, v7, s26, v211
    v_mul_f32 v0, v0, v136
    v_mul_f32 v1, v1, v140
    v_mul_f32 v2, v2, v144
    v_mul_f32 v3, v3, v148
    v_mul_f32 v4, v4, v152
    v_mul_f32 v5, v5, v156
    v_mul_f32 v6, v6, v160
    v_mul_f32 v7, v7, v164
    v_exp_f32 v0, v0
    v_exp_f32 v1, v1
    v_exp_f32 v2, v2
    v_exp_f32 v3, v3
    v_exp_f32 v4, v4
    v_exp_f32 v5, v5
    v_exp_f32 v6, v6
    v_exp_f32 v7, v7
    v_add_f32 v0, 1.0, v0
    v_add_f32 v1, 1.0, v1
    v_add_f32 v2, 1.0, v2
    v_add_f32 v3, 1.0, v3
    v_add_f32 v4, 1.0, v4
    v_add_f32 v5, 1.0, v5
    v_add_f32 v6, 1.0, v6
    v_add_f32 v7, 1.0, v7
    v_rcp_f32 v0, v0
    v_rcp_f32 v1, v1
    v_rcp_f32 v2, v2
    v_rcp_f32 v3, v3
    v_rcp_f32 v4, v4
    v_rcp_f32 v5, v5
    v_rcp_f32 v6, v6
    v_rcp_f32 v7, v7
    v_mul_f32 v0, v0, v136
    v_mul_f32 v1, v1, v140
    v_mul_f32 v2, v2, v144
    v_mul_f32 v3, v3, v148
    v_mul_f32 v4, v4, v152
    v_mul_f32 v5, v5, v156
    v_mul_f32 v6, v6, v160
    v_mul_f32 v7, v7, v164
    v_cvt_pk_bf16_f32 v32, v0, v1
    v_cvt_pk_bf16_f32 v33, v2, v3
    v_cvt_pk_bf16_f32 v34, v4, v5
    v_cvt_pk_bf16_f32 v35, v6, v7
    s_add_u32 s27, s24, 16384
    buffer_store_dwordx4 v[32:35], v210, s[32:35], s27 offen sc1
    v_fma_f32 v137, v137, v216, v224
    v_fma_f32 v141, v141, v217, v225
    v_fma_f32 v145, v145, v218, v226
    v_fma_f32 v149, v149, v219, v227
    v_fma_f32 v153, v153, v220, v228
    v_fma_f32 v157, v157, v221, v229
    v_fma_f32 v161, v161, v222, v230
    v_fma_f32 v165, v165, v223, v231
    v_mul_f32 v0, v137, v137
    v_mul_f32 v1, v141, v141
    v_mul_f32 v2, v145, v145
    v_mul_f32 v3, v149, v149
    v_mul_f32 v4, v153, v153
    v_mul_f32 v5, v157, v157
    v_mul_f32 v6, v161, v161
    v_mul_f32 v7, v165, v165
    v_fma_f32 v0, v0, s26, v211
    v_fma_f32 v1, v1, s26, v211
    v_fma_f32 v2, v2, s26, v211
    v_fma_f32 v3, v3, s26, v211
    v_fma_f32 v4, v4, s26, v211
    v_fma_f32 v5, v5, s26, v211
    v_fma_f32 v6, v6, s26, v211
    v_fma_f32 v7, v7, s26, v211
    v_mul_f32 v0, v0, v137
    v_mul_f32 v1, v1, v141
    v_mul_f32 v2, v2, v145
    v_mul_f32 v3, v3, v149
    v_mul_f32 v4, v4, v153
    v_mul_f32 v5, v5, v157
    v_mul_f32 v6, v6, v161
    v_mul_f32 v7, v7, v165
    v_exp_f32 v0, v0
    v_exp_f32 v1, v1
    v_exp_f32 v2, v2
    v_exp_f32 v3, v3
    v_exp_f32 v4, v4
    v_exp_f32 v5, v5
    v_exp_f32 v6, v6
    v_exp_f32 v7, v7
    v_add_f32 v0, 1.0, v0
    v_add_f32 v1, 1.0, v1
    v_add_f32 v2, 1.0, v2
    v_add_f32 v3, 1.0, v3
    v_add_f32 v4, 1.0, v4
    v_add_f32 v5, 1.0, v5
    v_add_f32 v6, 1.0, v6
    v_add_f32 v7, 1.0, v7
    v_rcp_f32 v0, v0
    v_rcp_f32 v1, v1
    v_rcp_f32 v2, v2
    v_rcp_f32 v3, v3
    v_rcp_f32 v4, v4
    v_rcp_f32 v5, v5
    v_rcp_f32 v6, v6
    v_rcp_f32 v7, v7
    v_mul_f32 v0, v0, v137
    v_mul_f32 v1, v1, v141
    v_mul_f32 v2, v2, v145
    v_mul_f32 v3, v3, v149
    v_mul_f32 v4, v4, v153
    v_mul_f32 v5, v5, v157
    v_mul_f32 v6, v6, v161
    v_mul_f32 v7, v7, v165
    v_cvt_pk_bf16_f32 v36, v0, v1
    v_cvt_pk_bf16_f32 v37, v2, v3
    v_cvt_pk_bf16_f32 v38, v4, v5
    v_cvt_pk_bf16_f32 v39, v6, v7
    s_add_u32 s27, s24, 17408
    buffer_store_dwordx4 v[36:39], v210, s[32:35], s27 offen sc1
    v_fma_f32 v138, v138, v216, v224
    v_fma_f32 v142, v142, v217, v225
    v_fma_f32 v146, v146, v218, v226
    v_fma_f32 v150, v150, v219, v227
    v_fma_f32 v154, v154, v220, v228
    v_fma_f32 v158, v158, v221, v229
    v_fma_f32 v162, v162, v222, v230
    v_fma_f32 v166, v166, v223, v231
    v_mul_f32 v0, v138, v138
    v_mul_f32 v1, v142, v142
    v_mul_f32 v2, v146, v146
    v_mul_f32 v3, v150, v150
    v_mul_f32 v4, v154, v154
    v_mul_f32 v5, v158, v158
    v_mul_f32 v6, v162, v162
    v_mul_f32 v7, v166, v166
    v_fma_f32 v0, v0, s26, v211
    v_fma_f32 v1, v1, s26, v211
    v_fma_f32 v2, v2, s26, v211
    v_fma_f32 v3, v3, s26, v211
    v_fma_f32 v4, v4, s26, v211
    v_fma_f32 v5, v5, s26, v211
    v_fma_f32 v6, v6, s26, v211
    v_fma_f32 v7, v7, s26, v211
    v_mul_f32 v0, v0, v138
    v_mul_f32 v1, v1, v142
    v_mul_f32 v2, v2, v146
    v_mul_f32 v3, v3, v150
    v_mul_f32 v4, v4, v154
    v_mul_f32 v5, v5, v158
    v_mul_f32 v6, v6, v162
    v_mul_f32 v7, v7, v166
    v_exp_f32 v0, v0
    v_exp_f32 v1, v1
    v_exp_f32 v2, v2
    v_exp_f32 v3, v3
    v_exp_f32 v4, v4
    v_exp_f32 v5, v5
    v_exp_f32 v6, v6
    v_exp_f32 v7, v7
    v_add_f32 v0, 1.0, v0
    v_add_f32 v1, 1.0, v1
    v_add_f32 v2, 1.0, v2
    v_add_f32 v3, 1.0, v3
    v_add_f32 v4, 1.0, v4
    v_add_f32 v5, 1.0, v5
    v_add_f32 v6, 1.0, v6
    v_add_f32 v7, 1.0, v7
    v_rcp_f32 v0, v0
    v_rcp_f32 v1, v1
    v_rcp_f32 v2, v2
    v_rcp_f32 v3, v3
    v_rcp_f32 v4, v4
    v_rcp_f32 v5, v5
    v_rcp_f32 v6, v6
    v_rcp_f32 v7, v7
    v_mul_f32 v0, v0, v138
    v_mul_f32 v1, v1, v142
    v_mul_f32 v2, v2, v146
    v_mul_f32 v3, v3, v150
    v_mul_f32 v4, v4, v154
    v_mul_f32 v5, v5, v158
    v_mul_f32 v6, v6, v162
    v_mul_f32 v7, v7, v166
    v_cvt_pk_bf16_f32 v40, v0, v1
    v_cvt_pk_bf16_f32 v41, v2, v3
    v_cvt_pk_bf16_f32 v42, v4, v5
    v_cvt_pk_bf16_f32 v43, v6, v7
    s_add_u32 s27, s24, 18432
    buffer_store_dwordx4 v[40:43], v210, s[32:35], s27 offen sc1
    v_fma_f32 v139, v139, v216, v224
    v_fma_f32 v143, v143, v217, v225
    v_fma_f32 v147, v147, v218, v226
    v_fma_f32 v151, v151, v219, v227
    v_fma_f32 v155, v155, v220, v228
    v_fma_f32 v159, v159, v221, v229
    v_fma_f32 v163, v163, v222, v230
    v_fma_f32 v167, v167, v223, v231
    v_mul_f32 v0, v139, v139
    v_mul_f32 v1, v143, v143
    v_mul_f32 v2, v147, v147
    v_mul_f32 v3, v151, v151
    v_mul_f32 v4, v155, v155
    v_mul_f32 v5, v159, v159
    v_mul_f32 v6, v163, v163
    v_mul_f32 v7, v167, v167
    v_fma_f32 v0, v0, s26, v211
    v_fma_f32 v1, v1, s26, v211
    v_fma_f32 v2, v2, s26, v211
    v_fma_f32 v3, v3, s26, v211
    v_fma_f32 v4, v4, s26, v211
    v_fma_f32 v5, v5, s26, v211
    v_fma_f32 v6, v6, s26, v211
    v_fma_f32 v7, v7, s26, v211
    v_mul_f32 v0, v0, v139
    v_mul_f32 v1, v1, v143
    v_mul_f32 v2, v2, v147
    v_mul_f32 v3, v3, v151
    v_mul_f32 v4, v4, v155
    v_mul_f32 v5, v5, v159
    v_mul_f32 v6, v6, v163
    v_mul_f32 v7, v7, v167
    v_exp_f32 v0, v0
    v_exp_f32 v1, v1
    v_exp_f32 v2, v2
    v_exp_f32 v3, v3
    v_exp_f32 v4, v4
    v_exp_f32 v5, v5
    v_exp_f32 v6, v6
    v_exp_f32 v7, v7
    v_add_f32 v0, 1.0, v0
    v_add_f32 v1, 1.0, v1
    v_add_f32 v2, 1.0, v2
    v_add_f32 v3, 1.0, v3
    v_add_f32 v4, 1.0, v4
    v_add_f32 v5, 1.0, v5
    v_add_f32 v6, 1.0, v6
    v_add_f32 v7, 1.0, v7
    v_rcp_f32 v0, v0
    v_rcp_f32 v1, v1
    v_rcp_f32 v2, v2
    v_rcp_f32 v3, v3
    v_rcp_f32 v4, v4
    v_rcp_f32 v5, v5
    v_rcp_f32 v6, v6
    v_rcp_f32 v7, v7
    v_mul_f32 v0, v0, v139
    v_mul_f32 v1, v1, v143
    v_mul_f32 v2, v2, v147
    v_mul_f32 v3, v3, v151
    v_mul_f32 v4, v4, v155
    v_mul_f32 v5, v5, v159
    v_mul_f32 v6, v6, v163
    v_mul_f32 v7, v7, v167
    v_cvt_pk_bf16_f32 v44, v0, v1
    v_cvt_pk_bf16_f32 v45, v2, v3
    v_cvt_pk_bf16_f32 v46, v4, v5
    v_cvt_pk_bf16_f32 v47, v6, v7
    s_add_u32 s27, s24, 19456
    buffer_store_dwordx4 v[44:47], v210, s[32:35], s27 offen sc1
    v_fma_f32 v171, v171, v216, v224
    v_fma_f32 v175, v175, v217, v225
    v_fma_f32 v179, v179, v218, v226
    v_fma_f32 v183, v183, v219, v227
    v_fma_f32 v187, v187, v220, v228
    v_fma_f32 v191, v191, v221, v229
    v_fma_f32 v195, v195, v222, v230
    v_fma_f32 v199, v199, v223, v231
    v_mul_f32 v0, v171, v171
    v_mul_f32 v1, v175, v175
    v_mul_f32 v2, v179, v179
    v_mul_f32 v3, v183, v183
    v_mul_f32 v4, v187, v187
    v_mul_f32 v5, v191, v191
    v_mul_f32 v6, v195, v195
    v_mul_f32 v7, v199, v199
    v_fma_f32 v0, v0, s26, v211
    v_fma_f32 v1, v1, s26, v211
    v_fma_f32 v2, v2, s26, v211
    v_fma_f32 v3, v3, s26, v211
    v_fma_f32 v4, v4, s26, v211
    v_fma_f32 v5, v5, s26, v211
    v_fma_f32 v6, v6, s26, v211
    v_fma_f32 v7, v7, s26, v211
    v_mul_f32 v0, v0, v171
    v_mul_f32 v1, v1, v175
    v_mul_f32 v2, v2, v179
    v_mul_f32 v3, v3, v183
    v_mul_f32 v4, v4, v187
    v_mul_f32 v5, v5, v191
    v_mul_f32 v6, v6, v195
    v_mul_f32 v7, v7, v199
    v_exp_f32 v0, v0
    v_exp_f32 v1, v1
    v_exp_f32 v2, v2
    v_exp_f32 v3, v3
    v_exp_f32 v4, v4
    v_exp_f32 v5, v5
    v_exp_f32 v6, v6
    v_exp_f32 v7, v7
    v_add_f32 v0, 1.0, v0
    v_add_f32 v1, 1.0, v1
    v_add_f32 v2, 1.0, v2
    v_add_f32 v3, 1.0, v3
    v_add_f32 v4, 1.0, v4
    v_add_f32 v5, 1.0, v5
    v_add_f32 v6, 1.0, v6
    v_add_f32 v7, 1.0, v7
    v_rcp_f32 v0, v0
    v_rcp_f32 v1, v1
    v_rcp_f32 v2, v2
    v_rcp_f32 v3, v3
    v_rcp_f32 v4, v4
    v_rcp_f32 v5, v5
    v_rcp_f32 v6, v6
    v_rcp_f32 v7, v7
    v_mul_f32 v0, v0, v171
    v_mul_f32 v1, v1, v175
    v_mul_f32 v2, v2, v179
    v_mul_f32 v3, v3, v183
    v_mul_f32 v4, v4, v187
    v_mul_f32 v5, v5, v191
    v_mul_f32 v6, v6, v195
    v_mul_f32 v7, v7, v199
    v_cvt_pk_bf16_f32 v16, v0, v1
    v_cvt_pk_bf16_f32 v17, v2, v3
    v_cvt_pk_bf16_f32 v18, v4, v5
    v_cvt_pk_bf16_f32 v19, v6, v7
    s_add_u32 s27, s24, 35840
    buffer_store_dwordx4 v[16:19], v210, s[32:35], s27 offen sc1
    s_branch L_k45_fin
L_k45_hgelu:
    s_sub_u32 s25, s10, 6
    s_mul_i32 s25, s25, 3
    s_mul_i32 s24, s12, 6
    s_add_u32 s24, s24, s25
    s_mul_i32 s24, s24, 49152
    v_fma_f32 v104, v104, v216, v224
    v_fma_f32 v108, v108, v217, v225
    v_fma_f32 v112, v112, v218, v226
    v_fma_f32 v116, v116, v219, v227
    v_fma_f32 v120, v120, v220, v228
    v_fma_f32 v124, v124, v221, v229
    v_fma_f32 v128, v128, v222, v230
    v_fma_f32 v132, v132, v223, v231
    v_mul_f32 v0, v104, v104
    v_mul_f32 v1, v108, v108
    v_mul_f32 v2, v112, v112
    v_mul_f32 v3, v116, v116
    v_mul_f32 v4, v120, v120
    v_mul_f32 v5, v124, v124
    v_mul_f32 v6, v128, v128
    v_mul_f32 v7, v132, v132
    v_fma_f32 v0, v0, s26, v211
    v_fma_f32 v1, v1, s26, v211
    v_fma_f32 v2, v2, s26, v211
    v_fma_f32 v3, v3, s26, v211
    v_fma_f32 v4, v4, s26, v211
    v_fma_f32 v5, v5, s26, v211
    v_fma_f32 v6, v6, s26, v211
    v_fma_f32 v7, v7, s26, v211
    v_mul_f32 v0, v0, v104
    v_mul_f32 v1, v1, v108
    v_mul_f32 v2, v2, v112
    v_mul_f32 v3, v3, v116
    v_mul_f32 v4, v4, v120
    v_mul_f32 v5, v5, v124
    v_mul_f32 v6, v6, v128
    v_mul_f32 v7, v7, v132
    v_exp_f32 v0, v0
    v_exp_f32 v1, v1
    v_exp_f32 v2, v2
    v_exp_f32 v3, v3
    v_exp_f32 v4, v4
    v_exp_f32 v5, v5
    v_exp_f32 v6, v6
    v_exp_f32 v7, v7
    v_add_f32 v0, 1.0, v0
    v_add_f32 v1, 1.0, v1
    v_add_f32 v2, 1.0, v2
    v_add_f32 v3, 1.0, v3
    v_add_f32 v4, 1.0, v4
    v_add_f32 v5, 1.0, v5
    v_add_f32 v6, 1.0, v6
    v_add_f32 v7, 1.0, v7
    v_rcp_f32 v0, v0
    v_rcp_f32 v1, v1
    v_rcp_f32 v2, v2
    v_rcp_f32 v3, v3
    v_rcp_f32 v4, v4
    v_rcp_f32 v5, v5
    v_rcp_f32 v6, v6
    v_rcp_f32 v7, v7
    v_mul_f32 v0, v0, v104
    v_mul_f32 v1, v1, v108
    v_mul_f32 v2, v2, v112
    v_mul_f32 v3, v3, v116
    v_mul_f32 v4, v4, v120
    v_mul_f32 v5, v5, v124
    v_mul_f32 v6, v6, v128
    v_mul_f32 v7, v7, v132
    v_cvt_pk_bf16_f32 v20, v0, v1
    v_cvt_pk_bf16_f32 v21, v2, v3
    v_cvt_pk_bf16_f32 v22, v4, v5
    v_cvt_pk_bf16_f32 v23, v6, v7
    s_add_u32 s27, s24, 32768
    buffer_store_dwordx4 v[20:23], v210, s[32:35], s27 offen sc1
    v_fma_f32 v105, v105, v216, v224
    v_fma_f32 v109, v109, v217, v225
    v_fma_f32 v113, v113, v218, v226
    v_fma_f32 v117, v117, v219, v227
    v_fma_f32 v121, v121, v220, v228
    v_fma_f32 v125, v125, v221, v229
    v_fma_f32 v129, v129, v222, v230
    v_fma_f32 v133, v133, v223, v231
    v_mul_f32 v0, v105, v105
    v_mul_f32 v1, v109, v109
    v_mul_f32 v2, v113, v113
    v_mul_f32 v3, v117, v117
    v_mul_f32 v4, v121, v121
    v_mul_f32 v5, v125, v125
    v_mul_f32 v6, v129, v129
    v_mul_f32 v7, v133, v133
    v_fma_f32 v0, v0, s26, v211
    v_fma_f32 v1, v1, s26, v211
    v_fma_f32 v2, v2, s26, v211
    v_fma_f32 v3, v3, s26, v211
    v_fma_f32 v4, v4, s26, v211
    v_fma_f32 v5, v5, s26, v211
    v_fma_f32 v6, v6, s26, v211
    v_fma_f32 v7, v7, s26, v211
    v_mul_f32 v0, v0, v105
    v_mul_f32 v1, v1, v109
    v_mul_f32 v2, v2, v113
    v_mul_f32 v3, v3, v117
    v_mul_f32 v4, v4, v121
    v_mul_f32 v5, v5, v125
    v_mul_f32 v6, v6, v129
    v_mul_f32 v7, v7, v133
    v_exp_f32 v0, v0
    v_exp_f32 v1, v1
    v_exp_f32 v2, v2
    v_exp_f32 v3, v3
    v_exp_f32 v4, v4
    v_exp_f32 v5, v5
    v_exp_f32 v6, v6
    v_exp_f32 v7, v7
    v_add_f32 v0, 1.0, v0
    v_add_f32 v1, 1.0, v1
    v_add_f32 v2, 1.0, v2
    v_add_f32 v3, 1.0, v3
    v_add_f32 v4, 1.0, v4
    v_add_f32 v5, 1.0, v5
    v_add_f32 v6, 1.0, v6
    v_add_f32 v7, 1.0, v7
    v_rcp_f32 v0, v0
    v_rcp_f32 v1, v1
    v_rcp_f32 v2, v2
    v_rcp_f32 v3, v3
    v_rcp_f32 v4, v4
    v_rcp_f32 v5, v5
    v_rcp_f32 v6, v6
    v_rcp_f32 v7, v7
    v_mul_f32 v0, v0, v105
    v_mul_f32 v1, v1, v109
    v_mul_f32 v2, v2, v113
    v_mul_f32 v3, v3, v117
    v_mul_f32 v4, v4, v121
    v_mul_f32 v5, v5, v125
    v_mul_f32 v6, v6, v129
    v_mul_f32 v7, v7, v133
    v_cvt_pk_bf16_f32 v24, v0, v1
    v_cvt_pk_bf16_f32 v25, v2, v3
    v_cvt_pk_bf16_f32 v26, v4, v5
    v_cvt_pk_bf16_f32 v27, v6, v7
    s_add_u32 s27, s24, 33792
    buffer_store_dwordx4 v[24:27], v210, s[32:35], s27 offen sc1
    v_fma_f32 v106, v106, v216, v224
    v_fma_f32 v110, v110, v217, v225
    v_fma_f32 v114, v114, v218, v226
    v_fma_f32 v118, v118, v219, v227
    v_fma_f32 v122, v122, v220, v228
    v_fma_f32 v126, v126, v221, v229
    v_fma_f32 v130, v130, v222, v230
    v_fma_f32 v134, v134, v223, v231
    v_mul_f32 v0, v106, v106
    v_mul_f32 v1, v110, v110
    v_mul_f32 v2, v114, v114
    v_mul_f32 v3, v118, v118
    v_mul_f32 v4, v122, v122
    v_mul_f32 v5, v126, v126
    v_mul_f32 v6, v130, v130
    v_mul_f32 v7, v134, v134
    v_fma_f32 v0, v0, s26, v211
    v_fma_f32 v1, v1, s26, v211
    v_fma_f32 v2, v2, s26, v211
    v_fma_f32 v3, v3, s26, v211
    v_fma_f32 v4, v4, s26, v211
    v_fma_f32 v5, v5, s26, v211
    v_fma_f32 v6, v6, s26, v211
    v_fma_f32 v7, v7, s26, v211
    v_mul_f32 v0, v0, v106
    v_mul_f32 v1, v1, v110
    v_mul_f32 v2, v2, v114
    v_mul_f32 v3, v3, v118
    v_mul_f32 v4, v4, v122
    v_mul_f32 v5, v5, v126
    v_mul_f32 v6, v6, v130
    v_mul_f32 v7, v7, v134
    v_exp_f32 v0, v0
    v_exp_f32 v1, v1
    v_exp_f32 v2, v2
    v_exp_f32 v3, v3
    v_exp_f32 v4, v4
    v_exp_f32 v5, v5
    v_exp_f32 v6, v6
    v_exp_f32 v7, v7
    v_add_f32 v0, 1.0, v0
    v_add_f32 v1, 1.0, v1
    v_add_f32 v2, 1.0, v2
    v_add_f32 v3, 1.0, v3
    v_add_f32 v4, 1.0, v4
    v_add_f32 v5, 1.0, v5
    v_add_f32 v6, 1.0, v6
    v_add_f32 v7, 1.0, v7
    v_rcp_f32 v0, v0
    v_rcp_f32 v1, v1
    v_rcp_f32 v2, v2
    v_rcp_f32 v3, v3
    v_rcp_f32 v4, v4
    v_rcp_f32 v5, v5
    v_rcp_f32 v6, v6
    v_rcp_f32 v7, v7
    v_mul_f32 v0, v0, v106
    v_mul_f32 v1, v1, v110
    v_mul_f32 v2, v2, v114
    v_mul_f32 v3, v3, v118
    v_mul_f32 v4, v4, v122
    v_mul_f32 v5, v5, v126
    v_mul_f32 v6, v6, v130
    v_mul_f32 v7, v7, v134
    v_cvt_pk_bf16_f32 v28, v0, v1
    v_cvt_pk_bf16_f32 v29, v2, v3
    v_cvt_pk_bf16_f32 v30, v4, v5
    v_cvt_pk_bf16_f32 v31, v6, v7
    s_add_u32 s27, s24, 34816
    buffer_store_dwordx4 v[28:31], v210, s[32:35], s27 offen sc1
    v_fma_f32 v136, v136, v216, v224
    v_fma_f32 v140, v140, v217, v225
    v_fma_f32 v144, v144, v218, v226
    v_fma_f32 v148, v148, v219, v227
    v_fma_f32 v152, v152, v220, v228
    v_fma_f32 v156, v156, v221, v229
    v_fma_f32 v160, v160, v222, v230
    v_fma_f32 v164, v164, v223, v231
    v_mul_f32 v0, v136, v136
    v_mul_f32 v1, v140, v140
    v_mul_f32 v2, v144, v144
    v_mul_f32 v3, v148, v148
    v_mul_f32 v4, v152, v152
    v_mul_f32 v5, v156, v156
    v_mul_f32 v6, v160, v160
    v_mul_f32 v7, v164, v164
    v_fma_f32 v0, v0, s26, v211
    v_fma_f32 v1, v1, s26, v211
    v_fma_f32 v2, v2, s26, v211
    v_fma_f32 v3, v3, s26, v211
    v_fma_f32 v4, v4, s26, v211
    v_fma_f32 v5, v5, s26, v211
    v_fma_f32 v6, v6, s26, v211
    v_fma_f32 v7, v7, s26, v211
    v_mul_f32 v0, v0, v136
    v_mul_f32 v1, v1, v140
    v_mul_f32 v2, v2, v144
    v_mul_f32 v3, v3, v148
    v_mul_f32 v4, v4, v152
    v_mul_f32 v5, v5, v156
    v_mul_f32 v6, v6, v160
    v_mul_f32 v7, v7, v164
    v_exp_f32 v0, v0
    v_exp_f32 v1, v1
    v_exp_f32 v2, v2
    v_exp_f32 v3, v3
    v_exp_f32 v4, v4
    v_exp_f32 v5, v5
    v_exp_f32 v6, v6
    v_exp_f32 v7, v7
    v_add_f32 v0, 1.0, v0
    v_add_f32 v1, 1.0, v1
    v_add_f32 v2, 1.0, v2
    v_add_f32 v3, 1.0, v3
    v_add_f32 v4, 1.0, v4
    v_add_f32 v5, 1.0, v5
    v_add_f32 v6, 1.0, v6
    v_add_f32 v7, 1.0, v7
    v_rcp_f32 v0, v0
    v_rcp_f32 v1, v1
    v_rcp_f32 v2, v2
    v_rcp_f32 v3, v3
    v_rcp_f32 v4, v4
    v_rcp_f32 v5, v5
    v_rcp_f32 v6, v6
    v_rcp_f32 v7, v7
    v_mul_f32 v0, v0, v136
    v_mul_f32 v1, v1, v140
    v_mul_f32 v2, v2, v144
    v_mul_f32 v3, v3, v148
    v_mul_f32 v4, v4, v152
    v_mul_f32 v5, v5, v156
    v_mul_f32 v6, v6, v160
    v_mul_f32 v7, v7, v164
    v_cvt_pk_bf16_f32 v32, v0, v1
    v_cvt_pk_bf16_f32 v33, v2, v3
    v_cvt_pk_bf16_f32 v34, v4, v5
    v_cvt_pk_bf16_f32 v35, v6, v7
    s_add_u32 s27, s24, 81920
    buffer_store_dwordx4 v[32:35], v210, s[32:35], s27 offen sc1
    v_fma_f32 v137, v137, v216, v224
    v_fma_f32 v141, v141, v217, v225
    v_fma_f32 v145, v145, v218, v226
    v_fma_f32 v149, v149, v219, v227
    v_fma_f32 v153, v153, v220, v228
    v_fma_f32 v157, v157, v221, v229
    v_fma_f32 v161, v161, v222, v230
    v_fma_f32 v165, v165, v223, v231
    v_mul_f32 v0, v137, v137
    v_mul_f32 v1, v141, v141
    v_mul_f32 v2, v145, v145
    v_mul_f32 v3, v149, v149
    v_mul_f32 v4, v153, v153
    v_mul_f32 v5, v157, v157
    v_mul_f32 v6, v161, v161
    v_mul_f32 v7, v165, v165
    v_fma_f32 v0, v0, s26, v211
    v_fma_f32 v1, v1, s26, v211
    v_fma_f32 v2, v2, s26, v211
    v_fma_f32 v3, v3, s26, v211
    v_fma_f32 v4, v4, s26, v211
    v_fma_f32 v5, v5, s26, v211
    v_fma_f32 v6, v6, s26, v211
    v_fma_f32 v7, v7, s26, v211
    v_mul_f32 v0, v0, v137
    v_mul_f32 v1, v1, v141
    v_mul_f32 v2, v2, v145
    v_mul_f32 v3, v3, v149
    v_mul_f32 v4, v4, v153
    v_mul_f32 v5, v5, v157
    v_mul_f32 v6, v6, v161
    v_mul_f32 v7, v7, v165
    v_exp_f32 v0, v0
    v_exp_f32 v1, v1
    v_exp_f32 v2, v2
    v_exp_f32 v3, v3
    v_exp_f32 v4, v4
    v_exp_f32 v5, v5
    v_exp_f32 v6, v6
    v_exp_f32 v7, v7
    v_add_f32 v0, 1.0, v0
    v_add_f32 v1, 1.0, v1
    v_add_f32 v2, 1.0, v2
    v_add_f32 v3, 1.0, v3
    v_add_f32 v4, 1.0, v4
    v_add_f32 v5, 1.0, v5
    v_add_f32 v6, 1.0, v6
    v_add_f32 v7, 1.0, v7
    v_rcp_f32 v0, v0
    v_rcp_f32 v1, v1
    v_rcp_f32 v2, v2
    v_rcp_f32 v3, v3
    v_rcp_f32 v4, v4
    v_rcp_f32 v5, v5
    v_rcp_f32 v6, v6
    v_rcp_f32 v7, v7
    v_mul_f32 v0, v0, v137
    v_mul_f32 v1, v1, v141
    v_mul_f32 v2, v2, v145
    v_mul_f32 v3, v3, v149
    v_mul_f32 v4, v4, v153
    v_mul_f32 v5, v5, v157
    v_mul_f32 v6, v6, v161
    v_mul_f32 v7, v7, v165
    v_cvt_pk_bf16_f32 v36, v0, v1
    v_cvt_pk_bf16_f32 v37, v2, v3
    v_cvt_pk_bf16_f32 v38, v4, v5
    v_cvt_pk_bf16_f32 v39, v6, v7
    s_add_u32 s27, s24, 82944
    buffer_store_dwordx4 v[36:39], v210, s[32:35], s27 offen sc1
    v_fma_f32 v138, v138, v216, v224
    v_fma_f32 v142, v142, v217, v225
    v_fma_f32 v146, v146, v218, v226
    v_fma_f32 v150, v150, v219, v227
    v_fma_f32 v154, v154, v220, v228
    v_fma_f32 v158, v158, v221, v229
    v_fma_f32 v162, v162, v222, v230
    v_fma_f32 v166, v166, v223, v231
    v_mul_f32 v0, v138, v138
    v_mul_f32 v1, v142, v142
    v_mul_f32 v2, v146, v146
    v_mul_f32 v3, v150, v150
    v_mul_f32 v4, v154, v154
    v_mul_f32 v5, v158, v158
    v_mul_f32 v6, v162, v162
    v_mul_f32 v7, v166, v166
    v_fma_f32 v0, v0, s26, v211
    v_fma_f32 v1, v1, s26, v211
    v_fma_f32 v2, v2, s26, v211
    v_fma_f32 v3, v3, s26, v211
    v_fma_f32 v4, v4, s26, v211
    v_fma_f32 v5, v5, s26, v211
    v_fma_f32 v6, v6, s26, v211
    v_fma_f32 v7, v7, s26, v211
    v_mul_f32 v0, v0, v138
    v_mul_f32 v1, v1, v142
    v_mul_f32 v2, v2, v146
    v_mul_f32 v3, v3, v150
    v_mul_f32 v4, v4, v154
    v_mul_f32 v5, v5, v158
    v_mul_f32 v6, v6, v162
    v_mul_f32 v7, v7, v166
    v_exp_f32 v0, v0
    v_exp_f32 v1, v1
    v_exp_f32 v2, v2
    v_exp_f32 v3, v3
    v_exp_f32 v4, v4
    v_exp_f32 v5, v5
    v_exp_f32 v6, v6
    v_exp_f32 v7, v7
    v_add_f32 v0, 1.0, v0
    v_add_f32 v1, 1.0, v1
    v_add_f32 v2, 1.0, v2
    v_add_f32 v3, 1.0, v3
    v_add_f32 v4, 1.0, v4
    v_add_f32 v5, 1.0, v5
    v_add_f32 v6, 1.0, v6
    v_add_f32 v7, 1.0, v7
    v_rcp_f32 v0, v0
    v_rcp_f32 v1, v1
    v_rcp_f32 v2, v2
    v_rcp_f32 v3, v3
    v_rcp_f32 v4, v4
    v_rcp_f32 v5, v5
    v_rcp_f32 v6, v6
    v_rcp_f32 v7, v7
    v_mul_f32 v0, v0, v138
    v_mul_f32 v1, v1, v142
    v_mul_f32 v2, v2, v146
    v_mul_f32 v3, v3, v150
    v_mul_f32 v4, v4, v154
    v_mul_f32 v5, v5, v158
    v_mul_f32 v6, v6, v162
    v_mul_f32 v7, v7, v166
    v_cvt_pk_bf16_f32 v40, v0, v1
    v_cvt_pk_bf16_f32 v41, v2, v3
    v_cvt_pk_bf16_f32 v42, v4, v5
    v_cvt_pk_bf16_f32 v43, v6, v7
    s_add_u32 s27, s24, 83968
    buffer_store_dwordx4 v[40:43], v210, s[32:35], s27 offen sc1
    v_fma_f32 v168, v168, v216, v224
    v_fma_f32 v172, v172, v217, v225
    v_fma_f32 v176, v176, v218, v226
    v_fma_f32 v180, v180, v219, v227
    v_fma_f32 v184, v184, v220, v228
    v_fma_f32 v188, v188, v221, v229
    v_fma_f32 v192, v192, v222, v230
    v_fma_f32 v196, v196, v223, v231
    v_mul_f32 v0, v168, v168
    v_mul_f32 v1, v172, v172
    v_mul_f32 v2, v176, v176
    v_mul_f32 v3, v180, v180
    v_mul_f32 v4, v184, v184
    v_mul_f32 v5, v188, v188
    v_mul_f32 v6, v192, v192
    v_mul_f32 v7, v196, v196
    v_fma_f32 v0, v0, s26, v211
    v_fma_f32 v1, v1, s26, v211
    v_fma_f32 v2, v2, s26, v211
    v_fma_f32 v3, v3, s26, v211
    v_fma_f32 v4, v4, s26, v211
    v_fma_f32 v5, v5, s26, v211
    v_fma_f32 v6, v6, s26, v211
    v_fma_f32 v7, v7, s26, v211
    v_mul_f32 v0, v0, v168
    v_mul_f32 v1, v1, v172
    v_mul_f32 v2, v2, v176
    v_mul_f32 v3, v3, v180
    v_mul_f32 v4, v4, v184
    v_mul_f32 v5, v5, v188
    v_mul_f32 v6, v6, v192
    v_mul_f32 v7, v7, v196
    v_exp_f32 v0, v0
    v_exp_f32 v1, v1
    v_exp_f32 v2, v2
    v_exp_f32 v3, v3
    v_exp_f32 v4, v4
    v_exp_f32 v5, v5
    v_exp_f32 v6, v6
    v_exp_f32 v7, v7
    v_add_f32 v0, 1.0, v0
    v_add_f32 v1, 1.0, v1
    v_add_f32 v2, 1.0, v2
    v_add_f32 v3, 1.0, v3
    v_add_f32 v4, 1.0, v4
    v_add_f32 v5, 1.0, v5
    v_add_f32 v6, 1.0, v6
    v_add_f32 v7, 1.0, v7
    v_rcp_f32 v0, v0
    v_rcp_f32 v1, v1
    v_rcp_f32 v2, v2
    v_rcp_f32 v3, v3
    v_rcp_f32 v4, v4
    v_rcp_f32 v5, v5
    v_rcp_f32 v6, v6
    v_rcp_f32 v7, v7
    v_mul_f32 v0, v0, v168
    v_mul_f32 v1, v1, v172
    v_mul_f32 v2, v2, v176
    v_mul_f32 v3, v3, v180
    v_mul_f32 v4, v4, v184
    v_mul_f32 v5, v5, v188
    v_mul_f32 v6, v6, v192
    v_mul_f32 v7, v7, v196
    v_cvt_pk_bf16_f32 v44, v0, v1
    v_cvt_pk_bf16_f32 v45, v2, v3
    v_cvt_pk_bf16_f32 v46, v4, v5
    v_cvt_pk_bf16_f32 v47, v6, v7
    s_add_u32 s27, s24, 131072
    buffer_store_dwordx4 v[44:47], v210, s[32:35], s27 offen sc1
    v_fma_f32 v169, v169, v216, v224
    v_fma_f32 v173, v173, v217, v225
    v_fma_f32 v177, v177, v218, v226
    v_fma_f32 v181, v181, v219, v227
    v_fma_f32 v185, v185, v220, v228
    v_fma_f32 v189, v189, v221, v229
    v_fma_f32 v193, v193, v222, v230
    v_fma_f32 v197, v197, v223, v231
    v_mul_f32 v0, v169, v169
    v_mul_f32 v1, v173, v173
    v_mul_f32 v2, v177, v177
    v_mul_f32 v3, v181, v181
    v_mul_f32 v4, v185, v185
    v_mul_f32 v5, v189, v189
    v_mul_f32 v6, v193, v193
    v_mul_f32 v7, v197, v197
    v_fma_f32 v0, v0, s26, v211
    v_fma_f32 v1, v1, s26, v211
    v_fma_f32 v2, v2, s26, v211
    v_fma_f32 v3, v3, s26, v211
    v_fma_f32 v4, v4, s26, v211
    v_fma_f32 v5, v5, s26, v211
    v_fma_f32 v6, v6, s26, v211
    v_fma_f32 v7, v7, s26, v211
    v_mul_f32 v0, v0, v169
    v_mul_f32 v1, v1, v173
    v_mul_f32 v2, v2, v177
    v_mul_f32 v3, v3, v181
    v_mul_f32 v4, v4, v185
    v_mul_f32 v5, v5, v189
    v_mul_f32 v6, v6, v193
    v_mul_f32 v7, v7, v197
    v_exp_f32 v0, v0
    v_exp_f32 v1, v1
    v_exp_f32 v2, v2
    v_exp_f32 v3, v3
    v_exp_f32 v4, v4
    v_exp_f32 v5, v5
    v_exp_f32 v6, v6
    v_exp_f32 v7, v7
    v_add_f32 v0, 1.0, v0
    v_add_f32 v1, 1.0, v1
    v_add_f32 v2, 1.0, v2
    v_add_f32 v3, 1.0, v3
    v_add_f32 v4, 1.0, v4
    v_add_f32 v5, 1.0, v5
    v_add_f32 v6, 1.0, v6
    v_add_f32 v7, 1.0, v7
    v_rcp_f32 v0, v0
    v_rcp_f32 v1, v1
    v_rcp_f32 v2, v2
    v_rcp_f32 v3, v3
    v_rcp_f32 v4, v4
    v_rcp_f32 v5, v5
    v_rcp_f32 v6, v6
    v_rcp_f32 v7, v7
    v_mul_f32 v0, v0, v169
    v_mul_f32 v1, v1, v173
    v_mul_f32 v2, v2, v177
    v_mul_f32 v3, v3, v181
    v_mul_f32 v4, v4, v185
    v_mul_f32 v5, v5, v189
    v_mul_f32 v6, v6, v193
    v_mul_f32 v7, v7, v197
    v_cvt_pk_bf16_f32 v16, v0, v1
    v_cvt_pk_bf16_f32 v17, v2, v3
    v_cvt_pk_bf16_f32 v18, v4, v5
    v_cvt_pk_bf16_f32 v19, v6, v7
    s_add_u32 s27, s24, 132096
    buffer_store_dwordx4 v[16:19], v210, s[32:35], s27 offen sc1
    v_fma_f32 v170, v170, v216, v224
    v_fma_f32 v174, v174, v217, v225
    v_fma_f32 v178, v178, v218, v226
    v_fma_f32 v182, v182, v219, v227
    v_fma_f32 v186, v186, v220, v228
    v_fma_f32 v190, v190, v221, v229
    v_fma_f32 v194, v194, v222, v230
    v_fma_f32 v198, v198, v223, v231
    v_mul_f32 v0, v170, v170
    v_mul_f32 v1, v174, v174
    v_mul_f32 v2, v178, v178
    v_mul_f32 v3, v182, v182
    v_mul_f32 v4, v186, v186
    v_mul_f32 v5, v190, v190
    v_mul_f32 v6, v194, v194
    v_mul_f32 v7, v198, v198
    v_fma_f32 v0, v0, s26, v211
    v_fma_f32 v1, v1, s26, v211
    v_fma_f32 v2, v2, s26, v211
    v_fma_f32 v3, v3, s26, v211
    v_fma_f32 v4, v4, s26, v211
    v_fma_f32 v5, v5, s26, v211
    v_fma_f32 v6, v6, s26, v211
    v_fma_f32 v7, v7, s26, v211
    v_mul_f32 v0, v0, v170
    v_mul_f32 v1, v1, v174
    v_mul_f32 v2, v2, v178
    v_mul_f32 v3, v3, v182
    v_mul_f32 v4, v4, v186
    v_mul_f32 v5, v5, v190
    v_mul_f32 v6, v6, v194
    v_mul_f32 v7, v7, v198
    v_exp_f32 v0, v0
    v_exp_f32 v1, v1
    v_exp_f32 v2, v2
    v_exp_f32 v3, v3
    v_exp_f32 v4, v4
    v_exp_f32 v5, v5
    v_exp_f32 v6, v6
    v_exp_f32 v7, v7
    v_add_f32 v0, 1.0, v0
    v_add_f32 v1, 1.0, v1
    v_add_f32 v2, 1.0, v2
    v_add_f32 v3, 1.0, v3
    v_add_f32 v4, 1.0, v4
    v_add_f32 v5, 1.0, v5
    v_add_f32 v6, 1.0, v6
    v_add_f32 v7, 1.0, v7
    v_rcp_f32 v0, v0
    v_rcp_f32 v1, v1
    v_rcp_f32 v2, v2
    v_rcp_f32 v3, v3
    v_rcp_f32 v4, v4
    v_rcp_f32 v5, v5
    v_rcp_f32 v6, v6
    v_rcp_f32 v7, v7
    v_mul_f32 v0, v0, v170
    v_mul_f32 v1, v1, v174
    v_mul_f32 v2, v2, v178
    v_mul_f32 v3, v3, v182
    v_mul_f32 v4, v4, v186
    v_mul_f32 v5, v5, v190
    v_mul_f32 v6, v6, v194
    v_mul_f32 v7, v7, v198
    v_cvt_pk_bf16_f32 v20, v0, v1
    v_cvt_pk_bf16_f32 v21, v2, v3
    v_cvt_pk_bf16_f32 v22, v4, v5
    v_cvt_pk_bf16_f32 v23, v6, v7
    s_add_u32 s27, s24, 133120
    buffer_store_dwordx4 v[20:23], v210, s[32:35], s27 offen sc1
L_k45_fin:
L_k45_end:
    s_endpgm
L_code_end:
    s_endpgm
.section .rodata,"a"
.p2align 6
.amdhsa_kernel xform_kernel
  .amdhsa_next_free_vgpr 232
  .amdhsa_next_free_sgpr 96
  .amdhsa_accum_offset 232
  .amdhsa_group_segment_fixed_size 0
  .amdhsa_kernarg_size 56
  .amdhsa_user_sgpr_count 2
  .amdhsa_user_sgpr_kernarg_segment_ptr 1
  .amdhsa_system_sgpr_workgroup_id_x 1
  .amdhsa_float_denorm_mode_32 3
.end_amdhsa_kernel

.p2align 6
.amdhsa_kernel gemm_kernel
  .amdhsa_next_free_vgpr 256
  .amdhsa_next_free_sgpr 96
  .amdhsa_accum_offset 256
  .amdhsa_group_segment_fixed_size 0
  .amdhsa_kernarg_size 56
  .amdhsa_user_sgpr_count 2
  .amdhsa_user_sgpr_kernarg_segment_ptr 1
  .amdhsa_system_sgpr_workgroup_id_x 1
  .amdhsa_float_denorm_mode_32 3
.end_amdhsa_kernel

.p2align 6
.amdhsa_kernel final_kernel
  .amdhsa_next_free_vgpr 240
  .amdhsa_next_free_sgpr 96
  .amdhsa_accum_offset 240
  .amdhsa_group_segment_fixed_size 0
  .amdhsa_kernarg_size 56
  .amdhsa_user_sgpr_count 2
  .amdhsa_user_sgpr_kernarg_segment_ptr 1
  .amdhsa_system_sgpr_workgroup_id_x 1
  .amdhsa_float_denorm_mode_32 3
.end_amdhsa_kernel
```

```asm
; @launch kernel=xform_kernel grid=(256,1,1) block=(256,1,1) lds=12352
; @launch kernel=gemm_kernel grid=(256,1,1) block=(512,1,1) lds=155648
; @launch kernel=final_kernel grid=(224,1,1) block=(512,1,1) lds=82944
.amdgcn_target "amdgcn-amd-amdhsa--gfx950"
.text
.globl xform_kernel
.p2align 8
.type xform_kernel,@function
xform_kernel:
    s_cmp_ge_u32 s2, 256
    s_cbranch_scc1 L_k12_end
    s_load_dwordx4 s[4:7], s[0:1], 0
    s_load_dwordx4 s[36:39], s[0:1], 40
    v_lshrrev_b32 v213, 6, v0
    s_cmp_ge_u32 s2, 8
    s_cbranch_scc1 L_nopf12
    v_readfirstlane_b32 s10, v213
    s_nop 3
    s_cmp_lg_u32 s10, 3
    s_cbranch_scc1 L_nopf12
    s_getpc_b64 s[60:61]
L_pf_k12:
    s_sub_u32 s60, s60, L_pf_k12-xform_kernel
    s_subb_u32 s61, s61, 0
    v_mbcnt_lo_u32_b32 v184, -1, 0
    v_mbcnt_hi_u32_b32 v184, -1, v184
    v_lshlrev_b32 v184, 6, v184
    v_add_u32 v185, 0, v184
    v_min_u32 v185, L_code_end-xform_kernel-4, v185
    v_mov_b32 v187, s61
    v_add_co_u32 v186, vcc, s60, v185
    s_nop 1
    v_addc_co_u32 v187, vcc, 0, v187, vcc
    global_load_dword v188, v[186:187], off
    v_add_u32 v185, 4096, v184
    v_min_u32 v185, L_code_end-xform_kernel-4, v185
    v_mov_b32 v187, s61
    v_add_co_u32 v186, vcc, s60, v185
    s_nop 1
    v_addc_co_u32 v187, vcc, 0, v187, vcc
    global_load_dword v188, v[186:187], off
    v_add_u32 v185, 8192, v184
    v_min_u32 v185, L_code_end-xform_kernel-4, v185
    v_mov_b32 v187, s61
    v_add_co_u32 v186, vcc, s60, v185
    s_nop 1
    v_addc_co_u32 v187, vcc, 0, v187, vcc
    global_load_dword v188, v[186:187], off
    v_add_u32 v185, 12288, v184
    v_min_u32 v185, L_code_end-xform_kernel-4, v185
    v_mov_b32 v187, s61
    v_add_co_u32 v186, vcc, s60, v185
    s_nop 1
    v_addc_co_u32 v187, vcc, 0, v187, vcc
    global_load_dword v188, v[186:187], off
    v_add_u32 v185, 16384, v184
    v_min_u32 v185, L_code_end-xform_kernel-4, v185
    v_mov_b32 v187, s61
    v_add_co_u32 v186, vcc, s60, v185
    s_nop 1
    v_addc_co_u32 v187, vcc, 0, v187, vcc
    global_load_dword v188, v[186:187], off
    v_add_u32 v185, 20480, v184
    v_min_u32 v185, L_code_end-xform_kernel-4, v185
    v_mov_b32 v187, s61
    v_add_co_u32 v186, vcc, s60, v185
    s_nop 1
    v_addc_co_u32 v187, vcc, 0, v187, vcc
    global_load_dword v188, v[186:187], off
    v_add_u32 v185, 24576, v184
    v_min_u32 v185, L_code_end-xform_kernel-4, v185
    v_mov_b32 v187, s61
    v_add_co_u32 v186, vcc, s60, v185
    s_nop 1
    v_addc_co_u32 v187, vcc, 0, v187, vcc
    global_load_dword v188, v[186:187], off
    v_add_u32 v185, 28672, v184
    v_min_u32 v185, L_code_end-xform_kernel-4, v185
    v_mov_b32 v187, s61
    v_add_co_u32 v186, vcc, s60, v185
    s_nop 1
    v_addc_co_u32 v187, vcc, 0, v187, vcc
    global_load_dword v188, v[186:187], off
    v_add_u32 v185, 32768, v184
    v_min_u32 v185, L_code_end-xform_kernel-4, v185
    v_mov_b32 v187, s61
    v_add_co_u32 v186, vcc, s60, v185
    s_nop 1
    v_addc_co_u32 v187, vcc, 0, v187, vcc
    global_load_dword v188, v[186:187], off
    v_add_u32 v185, 36864, v184
    v_min_u32 v185, L_code_end-xform_kernel-4, v185
    v_mov_b32 v187, s61
    v_add_co_u32 v186, vcc, s60, v185
    s_nop 1
    v_addc_co_u32 v187, vcc, 0, v187, vcc
    global_load_dword v188, v[186:187], off
L_nopf12:
    v_and_b32 v208, 63, v0
    v_lshrrev_b32 v213, 6, v0
    v_and_b32 v209, 15, v208
    v_readfirstlane_b32 s10, v213
    v_lshrrev_b32 v210, 4, v208
    v_lshlrev_b32 v223, 4, v208
    v_mov_b32 v222, 0
    s_mov_b32 s30, 0x05040100
    s_mov_b32 s31, 0x07060302
    s_mov_b32 s32, 0x01000100
    s_mov_b32 s33, 0x03020302
    s_mov_b32 s40, s2
    s_add_u32 s42, s2, 256
    s_mov_b32 s41, 0
    s_mov_b32 s43, 0
    v_lshlrev_b32 v224, 14, v210
    v_lshl_add_u32 v224, v209, 4, v224
    v_lshlrev_b32 v225, 22, v210
    v_lshrrev_b32 v213, 2, v209
    v_lshl_add_u32 v225, v213, 6, v225
    v_and_b32 v213, 1, v209
    v_lshl_add_u32 v225, v213, 5, v225
    v_bfe_u32 v213, v209, 1, 1
    v_lshl_add_u32 v225, v213, 3, v225
    v_lshrrev_b32 v213, 2, v209
    s_mov_b32 s24, 688128
    v_mul_u32_u24 v226, s24, v213
    s_mov_b32 s24, 43008
    v_mad_u32_u24 v226, v210, s24, v226
    s_mov_b32 s24, 32768
    v_mul_u32_u24 v227, s24, v210
    s_waitcnt lgkmcnt(0)
    s_mov_b32 s16, s38
    s_and_b32 s17, s39, 0xffff
    s_mov_b32 s18, 268435456
    s_mov_b32 s19, 0x00020000
    s_mov_b32 s44, s36
    s_and_b32 s45, s37, 0xffff
    s_mov_b32 s46, 256
    s_mov_b32 s47, 0x00020000
    s_cmp_ge_u32 s40, 1696
    s_cbranch_scc1 L_ld_done0
    s_cmp_ge_u32 s40, 672
    s_cbranch_scc1 L_ld_w0
    s_cmp_ge_u32 s40, 336
    s_cselect_b32 s11, 1, 0
    s_mul_i32 s12, s11, 336
    s_sub_u32 s12, s40, s12
    s_and_b32 s13, s12, 7
    s_lshr_b32 s14, s12, 3
    s_lshl_b32 s14, s14, 2
    s_add_u32 s14, s14, s10
    s_mul_i32 s15, s11, 16384000
    s_add_u32 s34, s4, s15
    s_addc_u32 s35, s5, 0
    s_mov_b32 s20, s34
    s_and_b32 s21, s35, 0xffff
    s_mov_b32 s22, 16384000
    s_mov_b32 s23, 0x00020000
    s_mul_i32 s15, s14, 98304
    s_lshl_b32 s24, s13, 8
    s_add_u32 s15, s15, s24
    s_add_u32 s25, s15, 0
    buffer_load_dwordx4 v[0:3], v224, s[20:23], s25 offen
    s_add_u32 s25, s15, 2048
    buffer_load_dwordx4 v[4:7], v224, s[20:23], s25 offen
    s_add_u32 s25, s15, 4096
    buffer_load_dwordx4 v[8:11], v224, s[20:23], s25 offen
    s_add_u32 s25, s15, 6144
    buffer_load_dwordx4 v[12:15], v224, s[20:23], s25 offen
    s_add_u32 s25, s15, 8192
    buffer_load_dwordx4 v[16:19], v224, s[20:23], s25 offen
    s_add_u32 s25, s15, 10240
    buffer_load_dwordx4 v[20:23], v224, s[20:23], s25 offen
    s_add_u32 s25, s15, 12288
    buffer_load_dwordx4 v[24:27], v224, s[20:23], s25 offen
    s_add_u32 s25, s15, 14336
    buffer_load_dwordx4 v[28:31], v224, s[20:23], s25 offen
    s_add_u32 s25, s15, 65536
    buffer_load_dwordx4 v[32:35], v224, s[20:23], s25 offen
    s_add_u32 s25, s15, 67584
    buffer_load_dwordx4 v[36:39], v224, s[20:23], s25 offen
    s_add_u32 s25, s15, 69632
    buffer_load_dwordx4 v[40:43], v224, s[20:23], s25 offen
    s_add_u32 s25, s15, 71680
    buffer_load_dwordx4 v[44:47], v224, s[20:23], s25 offen
    s_add_u32 s25, s15, 73728
    buffer_load_dwordx4 v[48:51], v224, s[20:23], s25 offen
    s_add_u32 s25, s15, 75776
    buffer_load_dwordx4 v[52:55], v224, s[20:23], s25 offen
    s_add_u32 s25, s15, 77824
    buffer_load_dwordx4 v[56:59], v224, s[20:23], s25 offen
    s_add_u32 s25, s15, 79872
    buffer_load_dwordx4 v[60:63], v224, s[20:23], s25 offen
    s_branch L_ld_done0
L_ld_w0:
    s_sub_u32 s12, s40, 672
    s_and_b32 s13, s12, 3
    s_lshr_b32 s14, s12, 2
    s_lshl_b32 s14, s14, 2
    s_add_u32 s14, s14, s10
    s_mov_b32 s20, s6
    s_and_b32 s21, s7, 0xffff
    s_mov_b32 s22, 16252928
    s_mov_b32 s23, 0x00020000
    s_lshl_b32 s15, s14, 10
    s_lshl_b32 s24, s13, 8
    s_add_u32 s15, s15, s24
    s_add_u32 s25, s15, 0
    buffer_load_dwordx2 v[0:1], v225, s[20:23], s25 offen
    buffer_load_dwordx2 v[2:3], v225, s[20:23], s25 offen offset:16
    s_add_u32 s25, s15, 1048576
    buffer_load_dwordx2 v[4:5], v225, s[20:23], s25 offen
    buffer_load_dwordx2 v[6:7], v225, s[20:23], s25 offen offset:16
    s_add_u32 s25, s15, 2097152
    buffer_load_dwordx2 v[8:9], v225, s[20:23], s25 offen
    buffer_load_dwordx2 v[10:11], v225, s[20:23], s25 offen offset:16
    s_add_u32 s25, s15, 3145728
    buffer_load_dwordx2 v[12:13], v225, s[20:23], s25 offen
    buffer_load_dwordx2 v[14:15], v225, s[20:23], s25 offen offset:16
L_ld_done0:
    v_lshrrev_b32 v213, 2, v209
    v_lshlrev_b32 v213, 1, v213
    v_bfe_u32 v214, v209, 1, 1
    v_add_u32 v213, v213, v214
    s_lshl_b32 s24, s10, 3
    v_add_u32 v213, s24, v213
    v_lshl_add_u32 v213, v213, 1, 1
    v_and_b32 v214, 1, v209
    v_lshlrev_b32 v214, 5, v214
    v_lshlrev_b32 v215, 3, v210
    v_mad_u32_u24 v160, v213, v215, v214
    v_add_u32 v161, v160, v213
    v_add_u32 v162, v161, v213
    v_add_u32 v163, v162, v213
    v_add_u32 v164, v163, v213
    v_add_u32 v165, v164, v213
    v_add_u32 v166, v165, v213
    v_add_u32 v167, v166, v213
    v_and_b32 v160, 127, v160
    v_cvt_f32_u32 v160, v160
    v_mul_f32 v160, 0x3c000000, v160
    v_cos_f32 v160, v160
    v_and_b32 v161, 127, v161
    v_cvt_f32_u32 v161, v161
    v_mul_f32 v161, 0x3c000000, v161
    v_cos_f32 v161, v161
    v_and_b32 v162, 127, v162
    v_cvt_f32_u32 v162, v162
    v_mul_f32 v162, 0x3c000000, v162
    v_cos_f32 v162, v162
    v_and_b32 v163, 127, v163
    v_cvt_f32_u32 v163, v163
    v_mul_f32 v163, 0x3c000000, v163
    v_cos_f32 v163, v163
    v_and_b32 v164, 127, v164
    v_cvt_f32_u32 v164, v164
    v_mul_f32 v164, 0x3c000000, v164
    v_cos_f32 v164, v164
    v_and_b32 v165, 127, v165
    v_cvt_f32_u32 v165, v165
    v_mul_f32 v165, 0x3c000000, v165
    v_cos_f32 v165, v165
    v_and_b32 v166, 127, v166
    v_cvt_f32_u32 v166, v166
    v_mul_f32 v166, 0x3c000000, v166
    v_cos_f32 v166, v166
    v_and_b32 v167, 127, v167
    v_cvt_f32_u32 v167, v167
    v_mul_f32 v167, 0x3c000000, v167
    v_cos_f32 v167, v167
    v_cvt_pk_bf16_f32 v176, v160, v161
    v_cvt_pk_bf16_f32 v177, v162, v163
    v_cvt_pk_bf16_f32 v178, v164, v165
    v_cvt_pk_bf16_f32 v179, v166, v167
    s_lshl_b32 s24, s10, 11
    v_add_u32 v216, s24, v223
    ds_write_b128 v216, v[176:179] offset:0
    v_lshlrev_b32 v215, 3, v210
    v_add_u32 v215, 32, v215
    v_mad_u32_u24 v160, v213, v215, v214
    v_add_u32 v161, v160, v213
    v_add_u32 v162, v161, v213
    v_add_u32 v163, v162, v213
    v_add_u32 v164, v163, v213
    v_add_u32 v165, v164, v213
    v_add_u32 v166, v165, v213
    v_add_u32 v167, v166, v213
    v_and_b32 v160, 127, v160
    v_cvt_f32_u32 v160, v160
    v_mul_f32 v160, 0x3c000000, v160
    v_cos_f32 v160, v160
    v_and_b32 v161, 127, v161
    v_cvt_f32_u32 v161, v161
    v_mul_f32 v161, 0x3c000000, v161
    v_cos_f32 v161, v161
    v_and_b32 v162, 127, v162
    v_cvt_f32_u32 v162, v162
    v_mul_f32 v162, 0x3c000000, v162
    v_cos_f32 v162, v162
    v_and_b32 v163, 127, v163
    v_cvt_f32_u32 v163, v163
    v_mul_f32 v163, 0x3c000000, v163
    v_cos_f32 v163, v163
    v_and_b32 v164, 127, v164
    v_cvt_f32_u32 v164, v164
    v_mul_f32 v164, 0x3c000000, v164
    v_cos_f32 v164, v164
    v_and_b32 v165, 127, v165
    v_cvt_f32_u32 v165, v165
    v_mul_f32 v165, 0x3c000000, v165
    v_cos_f32 v165, v165
    v_and_b32 v166, 127, v166
    v_cvt_f32_u32 v166, v166
    v_mul_f32 v166, 0x3c000000, v166
    v_cos_f32 v166, v166
    v_and_b32 v167, 127, v167
    v_cvt_f32_u32 v167, v167
    v_mul_f32 v167, 0x3c000000, v167
    v_cos_f32 v167, v167
    v_cvt_pk_bf16_f32 v176, v160, v161
    v_cvt_pk_bf16_f32 v177, v162, v163
    v_cvt_pk_bf16_f32 v178, v164, v165
    v_cvt_pk_bf16_f32 v179, v166, v167
    s_lshl_b32 s24, s10, 11
    v_add_u32 v216, s24, v223
    ds_write_b128 v216, v[176:179] offset:1024
    v_lshlrev_b32 v215, 2, v210
    v_mad_u32_u24 v160, v213, v215, v214
    v_add_u32 v161, v160, v213
    v_add_u32 v162, v161, v213
    v_add_u32 v163, v162, v213
    v_and_b32 v160, 127, v160
    v_cvt_f32_u32 v160, v160
    v_mul_f32 v160, 0x3c000000, v160
    v_cos_f32 v160, v160
    v_and_b32 v161, 127, v161
    v_cvt_f32_u32 v161, v161
    v_mul_f32 v161, 0x3c000000, v161
    v_cos_f32 v161, v161
    v_and_b32 v162, 127, v162
    v_cvt_f32_u32 v162, v162
    v_mul_f32 v162, 0x3c000000, v162
    v_cos_f32 v162, v162
    v_and_b32 v163, 127, v163
    v_cvt_f32_u32 v163, v163
    v_mul_f32 v163, 0x3c000000, v163
    v_cos_f32 v163, v163
    v_cvt_pk_bf16_f32 v180, v160, v160
    v_lshlrev_b32 v181, 16, v180
    v_sub_f32 v181, v160, v181
    v_cvt_pk_bf16_f32 v181, v181, v181
    v_perm_b32 v176, v181, v180, s30
    v_cvt_pk_bf16_f32 v180, v161, v161
    v_lshlrev_b32 v181, 16, v180
    v_sub_f32 v181, v161, v181
    v_cvt_pk_bf16_f32 v181, v181, v181
    v_perm_b32 v177, v181, v180, s30
    v_cvt_pk_bf16_f32 v180, v162, v162
    v_lshlrev_b32 v181, 16, v180
    v_sub_f32 v181, v162, v181
    v_cvt_pk_bf16_f32 v181, v181, v181
    v_perm_b32 v178, v181, v180, s30
    v_cvt_pk_bf16_f32 v180, v163, v163
    v_lshlrev_b32 v181, 16, v180
    v_sub_f32 v181, v163, v181
    v_cvt_pk_bf16_f32 v181, v181, v181
    v_perm_b32 v179, v181, v180, s30
    s_lshl_b32 s24, s10, 10
    v_add_u32 v216, s24, v223
    ds_write_b128 v216, v[176:179] offset:8192
    s_waitcnt lgkmcnt(0)
    s_barrier
L_k12_loop:
    s_cmp_lg_u32 s10, 0
    s_cbranch_scc1 L_nofetch0
    v_mov_b32 v221, 1
    s_mov_b64 exec, 1
    buffer_atomic_add v221, v222, s[44:47], 0 offen sc0 sc1
    s_mov_b64 exec, -1
L_nofetch0:
    s_cmp_ge_u32 s42, 1696
    s_cbranch_scc1 L_ld_done1
    s_cmp_ge_u32 s42, 672
    s_cbranch_scc1 L_ld_w1
    s_cmp_ge_u32 s42, 336
    s_cselect_b32 s11, 1, 0
    s_mul_i32 s12, s11, 336
    s_sub_u32 s12, s42, s12
    s_and_b32 s13, s12, 7
    s_lshr_b32 s14, s12, 3
    s_lshl_b32 s14, s14, 2
    s_add_u32 s14, s14, s10
    s_mul_i32 s15, s11, 16384000
    s_add_u32 s34, s4, s15
    s_addc_u32 s35, s5, 0
    s_mov_b32 s20, s34
    s_and_b32 s21, s35, 0xffff
    s_mov_b32 s22, 16384000
    s_mov_b32 s23, 0x00020000
    s_mul_i32 s15, s14, 98304
    s_lshl_b32 s24, s13, 8
    s_add_u32 s15, s15, s24
    s_add_u32 s25, s15, 0
    buffer_load_dwordx4 v[64:67], v224, s[20:23], s25 offen
    s_add_u32 s25, s15, 2048
    buffer_load_dwordx4 v[68:71], v224, s[20:23], s25 offen
    s_add_u32 s25, s15, 4096
    buffer_load_dwordx4 v[72:75], v224, s[20:23], s25 offen
    s_add_u32 s25, s15, 6144
    buffer_load_dwordx4 v[76:79], v224, s[20:23], s25 offen
    s_add_u32 s25, s15, 8192
    buffer_load_dwordx4 v[80:83], v224, s[20:23], s25 offen
    s_add_u32 s25, s15, 10240
    buffer_load_dwordx4 v[84:87], v224, s[20:23], s25 offen
    s_add_u32 s25, s15, 12288
    buffer_load_dwordx4 v[88:91], v224, s[20:23], s25 offen
    s_add_u32 s25, s15, 14336
    buffer_load_dwordx4 v[92:95], v224, s[20:23], s25 offen
    s_add_u32 s25, s15, 65536
    buffer_load_dwordx4 v[96:99], v224, s[20:23], s25 offen
    s_add_u32 s25, s15, 67584
    buffer_load_dwordx4 v[100:103], v224, s[20:23], s25 offen
    s_add_u32 s25, s15, 69632
    buffer_load_dwordx4 v[104:107], v224, s[20:23], s25 offen
    s_add_u32 s25, s15, 71680
    buffer_load_dwordx4 v[108:111], v224, s[20:23], s25 offen
    s_add_u32 s25, s15, 73728
    buffer_load_dwordx4 v[112:115], v224, s[20:23], s25 offen
    s_add_u32 s25, s15, 75776
    buffer_load_dwordx4 v[116:119], v224, s[20:23], s25 offen
    s_add_u32 s25, s15, 77824
    buffer_load_dwordx4 v[120:123], v224, s[20:23], s25 offen
    s_add_u32 s25, s15, 79872
    buffer_load_dwordx4 v[124:127], v224, s[20:23], s25 offen
    s_branch L_ld_done1
L_ld_w1:
    s_sub_u32 s12, s42, 672
    s_and_b32 s13, s12, 3
    s_lshr_b32 s14, s12, 2
    s_lshl_b32 s14, s14, 2
    s_add_u32 s14, s14, s10
    s_mov_b32 s20, s6
    s_and_b32 s21, s7, 0xffff
    s_mov_b32 s22, 16252928
    s_mov_b32 s23, 0x00020000
    s_lshl_b32 s15, s14, 10
    s_lshl_b32 s24, s13, 8
    s_add_u32 s15, s15, s24
    s_add_u32 s25, s15, 0
    buffer_load_dwordx2 v[64:65], v225, s[20:23], s25 offen
    buffer_load_dwordx2 v[66:67], v225, s[20:23], s25 offen offset:16
    s_add_u32 s25, s15, 1048576
    buffer_load_dwordx2 v[68:69], v225, s[20:23], s25 offen
    buffer_load_dwordx2 v[70:71], v225, s[20:23], s25 offen offset:16
    s_add_u32 s25, s15, 2097152
    buffer_load_dwordx2 v[72:73], v225, s[20:23], s25 offen
    buffer_load_dwordx2 v[74:75], v225, s[20:23], s25 offen offset:16
    s_add_u32 s25, s15, 3145728
    buffer_load_dwordx2 v[76:77], v225, s[20:23], s25 offen
    buffer_load_dwordx2 v[78:79], v225, s[20:23], s25 offen offset:16
L_ld_done1:
    s_cmp_lg_u32 s43, 0
    s_cbranch_scc1 L_notfirst
    s_cmp_ge_u32 s42, 1696
    s_cbranch_scc1 L_w0_f
    s_cmp_ge_u32 s42, 672
    s_cbranch_scc1 L_w8_f
    s_waitcnt vmcnt(16)
    s_branch L_wd_f
L_w8_f:
    s_waitcnt vmcnt(8)
    s_branch L_wd_f
L_w0_f:
    s_waitcnt vmcnt(0)
L_wd_f:
    s_mov_b32 s43, 1
    s_branch L_wfin
L_notfirst:
    s_cmp_ge_u32 s42, 1696
    s_cbranch_scc1 L_w0_a0
    s_cmp_ge_u32 s42, 672
    s_cbranch_scc1 L_w8_a0
    s_waitcnt vmcnt(32)
    s_branch L_wd_a0
L_w8_a0:
    s_waitcnt vmcnt(24)
    s_branch L_wd_a0
L_w0_a0:
    s_waitcnt vmcnt(16)
L_wd_a0:
L_wfin:
    s_cmp_ge_u32 s40, 672
    s_cbranch_scc1 L_cw0
    s_cmp_ge_u32 s40, 336
    s_cselect_b32 s11, 1, 0
    s_mul_i32 s12, s11, 336
    s_sub_u32 s12, s40, s12
    s_and_b32 s13, s12, 7
    s_lshr_b32 s14, s12, 3
    s_lshl_b32 s14, s14, 2
    s_add_u32 s14, s14, s10
    ds_read_b128 v[128:131], v223 offset:0
    ds_read_b128 v[132:135], v223 offset:1024
    ds_read_b128 v[136:139], v223 offset:2048
    ds_read_b128 v[140:143], v223 offset:3072
    ds_read_b128 v[144:147], v223 offset:4096
    ds_read_b128 v[148:151], v223 offset:5120
    ds_read_b128 v[152:155], v223 offset:6144
    ds_read_b128 v[156:159], v223 offset:7168
    s_bfe_u32 s24, s14, 0x10003
    s_mul_i32 s24, s24, 3
    v_and_b32 v213, 3, v209
    v_xor_b32 v213, s24, v213
    v_lshl_add_u32 v212, v213, 4, v226
    s_mul_i32 s24, s11, 22020096
    s_mul_i32 s25, s13, 2752512
    s_add_u32 s24, s24, s25
    s_lshl_b32 s25, s14, 6
    s_add_u32 s24, s24, s25
    s_add_u32 s24, s24, 67108864
    v_perm_b32 v160, v4, v0, s30
    v_perm_b32 v161, v12, v8, s30
    v_perm_b32 v162, v20, v16, s30
    v_perm_b32 v163, v28, v24, s30
    v_perm_b32 v164, v4, v0, s31
    v_perm_b32 v165, v12, v8, s31
    v_perm_b32 v166, v20, v16, s31
    v_perm_b32 v167, v28, v24, s31
    v_perm_b32 v168, v36, v32, s30
    v_perm_b32 v169, v44, v40, s30
    v_perm_b32 v170, v52, v48, s30
    v_perm_b32 v171, v60, v56, s30
    v_perm_b32 v172, v36, v32, s31
    v_perm_b32 v173, v44, v40, s31
    v_perm_b32 v174, v52, v48, s31
    v_perm_b32 v175, v60, v56, s31
    s_waitcnt lgkmcnt(0)
    v_mfma_f32_16x16x32_bf16 v[176:179], v[128:131], v[160:163], 0
    v_mfma_f32_16x16x32_bf16 v[180:183], v[128:131], v[164:167], 0
    v_mfma_f32_16x16x32_bf16 v[184:187], v[136:139], v[160:163], 0
    v_mfma_f32_16x16x32_bf16 v[188:191], v[136:139], v[164:167], 0
    v_mfma_f32_16x16x32_bf16 v[192:195], v[144:147], v[160:163], 0
    v_mfma_f32_16x16x32_bf16 v[196:199], v[144:147], v[164:167], 0
    v_mfma_f32_16x16x32_bf16 v[200:203], v[152:155], v[160:163], 0
    v_mfma_f32_16x16x32_bf16 v[204:207], v[152:155], v[164:167], 0
    v_mfma_f32_16x16x32_bf16 v[176:179], v[132:135], v[168:171], v[176:179]
    v_mfma_f32_16x16x32_bf16 v[180:183], v[132:135], v[172:175], v[180:183]
    v_mfma_f32_16x16x32_bf16 v[184:187], v[140:143], v[168:171], v[184:187]
    v_mfma_f32_16x16x32_bf16 v[188:191], v[140:143], v[172:175], v[188:191]
    v_mfma_f32_16x16x32_bf16 v[192:195], v[148:151], v[168:171], v[192:195]
    v_mfma_f32_16x16x32_bf16 v[196:199], v[148:151], v[172:175], v[196:199]
    v_mfma_f32_16x16x32_bf16 v[200:203], v[156:159], v[168:171], v[200:203]
    v_mfma_f32_16x16x32_bf16 v[204:207], v[156:159], v[172:175], v[204:207]
    v_perm_b32 v160, v5, v1, s30
    v_perm_b32 v161, v13, v9, s30
    v_perm_b32 v162, v21, v17, s30
    v_perm_b32 v163, v29, v25, s30
    v_perm_b32 v164, v5, v1, s31
    v_perm_b32 v165, v13, v9, s31
    v_perm_b32 v166, v21, v17, s31
    v_perm_b32 v167, v29, v25, s31
    v_perm_b32 v168, v37, v33, s30
    v_perm_b32 v169, v45, v41, s30
    v_perm_b32 v170, v53, v49, s30
    v_perm_b32 v171, v61, v57, s30
    v_perm_b32 v172, v37, v33, s31
    v_perm_b32 v173, v45, v41, s31
    v_perm_b32 v174, v53, v49, s31
    v_perm_b32 v175, v61, v57, s31
    v_cvt_pk_bf16_f32 v0, v176, v180
    v_cvt_pk_bf16_f32 v4, v177, v181
    v_cvt_pk_bf16_f32 v8, v178, v182
    v_cvt_pk_bf16_f32 v12, v179, v183
    v_cvt_pk_bf16_f32 v16, v184, v188
    v_cvt_pk_bf16_f32 v20, v185, v189
    v_cvt_pk_bf16_f32 v24, v186, v190
    v_cvt_pk_bf16_f32 v28, v187, v191
    v_cvt_pk_bf16_f32 v32, v192, v196
    v_cvt_pk_bf16_f32 v36, v193, v197
    v_cvt_pk_bf16_f32 v40, v194, v198
    v_cvt_pk_bf16_f32 v44, v195, v199
    v_cvt_pk_bf16_f32 v48, v200, v204
    v_cvt_pk_bf16_f32 v52, v201, v205
    v_cvt_pk_bf16_f32 v56, v202, v206
    v_cvt_pk_bf16_f32 v60, v203, v207
    v_mfma_f32_16x16x32_bf16 v[176:179], v[128:131], v[160:163], 0
    v_mfma_f32_16x16x32_bf16 v[180:183], v[128:131], v[164:167], 0
    v_mfma_f32_16x16x32_bf16 v[184:187], v[136:139], v[160:163], 0
    v_mfma_f32_16x16x32_bf16 v[188:191], v[136:139], v[164:167], 0
    v_mfma_f32_16x16x32_bf16 v[192:195], v[144:147], v[160:163], 0
    v_mfma_f32_16x16x32_bf16 v[196:199], v[144:147], v[164:167], 0
    v_mfma_f32_16x16x32_bf16 v[200:203], v[152:155], v[160:163], 0
    v_mfma_f32_16x16x32_bf16 v[204:207], v[152:155], v[164:167], 0
    v_mfma_f32_16x16x32_bf16 v[176:179], v[132:135], v[168:171], v[176:179]
    v_mfma_f32_16x16x32_bf16 v[180:183], v[132:135], v[172:175], v[180:183]
    v_mfma_f32_16x16x32_bf16 v[184:187], v[140:143], v[168:171], v[184:187]
    v_mfma_f32_16x16x32_bf16 v[188:191], v[140:143], v[172:175], v[188:191]
    v_mfma_f32_16x16x32_bf16 v[192:195], v[148:151], v[168:171], v[192:195]
    v_mfma_f32_16x16x32_bf16 v[196:199], v[148:151], v[172:175], v[196:199]
    v_mfma_f32_16x16x32_bf16 v[200:203], v[156:159], v[168:171], v[200:203]
    v_mfma_f32_16x16x32_bf16 v[204:207], v[156:159], v[172:175], v[204:207]
    v_perm_b32 v160, v6, v2, s30
    v_perm_b32 v161, v14, v10, s30
    v_perm_b32 v162, v22, v18, s30
    v_perm_b32 v163, v30, v26, s30
    v_perm_b32 v164, v6, v2, s31
    v_perm_b32 v165, v14, v10, s31
    v_perm_b32 v166, v22, v18, s31
    v_perm_b32 v167, v30, v26, s31
    v_perm_b32 v168, v38, v34, s30
    v_perm_b32 v169, v46, v42, s30
    v_perm_b32 v170, v54, v50, s30
    v_perm_b32 v171, v62, v58, s30
    v_perm_b32 v172, v38, v34, s31
    v_perm_b32 v173, v46, v42, s31
    v_perm_b32 v174, v54, v50, s31
    v_perm_b32 v175, v62, v58, s31
    v_cvt_pk_bf16_f32 v1, v176, v180
    v_cvt_pk_bf16_f32 v5, v177, v181
    v_cvt_pk_bf16_f32 v9, v178, v182
    v_cvt_pk_bf16_f32 v13, v179, v183
    v_cvt_pk_bf16_f32 v17, v184, v188
    v_cvt_pk_bf16_f32 v21, v185, v189
    v_cvt_pk_bf16_f32 v25, v186, v190
    v_cvt_pk_bf16_f32 v29, v187, v191
    v_cvt_pk_bf16_f32 v33, v192, v196
    v_cvt_pk_bf16_f32 v37, v193, v197
    v_cvt_pk_bf16_f32 v41, v194, v198
    v_cvt_pk_bf16_f32 v45, v195, v199
    v_cvt_pk_bf16_f32 v49, v200, v204
    v_cvt_pk_bf16_f32 v53, v201, v205
    v_cvt_pk_bf16_f32 v57, v202, v206
    v_cvt_pk_bf16_f32 v61, v203, v207
    v_mfma_f32_16x16x32_bf16 v[176:179], v[128:131], v[160:163], 0
    v_mfma_f32_16x16x32_bf16 v[180:183], v[128:131], v[164:167], 0
    v_mfma_f32_16x16x32_bf16 v[184:187], v[136:139], v[160:163], 0
    v_mfma_f32_16x16x32_bf16 v[188:191], v[136:139], v[164:167], 0
    v_mfma_f32_16x16x32_bf16 v[192:195], v[144:147], v[160:163], 0
    v_mfma_f32_16x16x32_bf16 v[196:199], v[144:147], v[164:167], 0
    v_mfma_f32_16x16x32_bf16 v[200:203], v[152:155], v[160:163], 0
    v_mfma_f32_16x16x32_bf16 v[204:207], v[152:155], v[164:167], 0
    v_mfma_f32_16x16x32_bf16 v[176:179], v[132:135], v[168:171], v[176:179]
    v_mfma_f32_16x16x32_bf16 v[180:183], v[132:135], v[172:175], v[180:183]
    v_mfma_f32_16x16x32_bf16 v[184:187], v[140:143], v[168:171], v[184:187]
    v_mfma_f32_16x16x32_bf16 v[188:191], v[140:143], v[172:175], v[188:191]
    v_mfma_f32_16x16x32_bf16 v[192:195], v[148:151], v[168:171], v[192:195]
    v_mfma_f32_16x16x32_bf16 v[196:199], v[148:151], v[172:175], v[196:199]
    v_mfma_f32_16x16x32_bf16 v[200:203], v[156:159], v[168:171], v[200:203]
    v_mfma_f32_16x16x32_bf16 v[204:207], v[156:159], v[172:175], v[204:207]
    v_perm_b32 v160, v7, v3, s30
    v_perm_b32 v161, v15, v11, s30
    v_perm_b32 v162, v23, v19, s30
    v_perm_b32 v163, v31, v27, s30
    v_perm_b32 v164, v7, v3, s31
    v_perm_b32 v165, v15, v11, s31
    v_perm_b32 v166, v23, v19, s31
    v_perm_b32 v167, v31, v27, s31
    v_perm_b32 v168, v39, v35, s30
    v_perm_b32 v169, v47, v43, s30
    v_perm_b32 v170, v55, v51, s30
    v_perm_b32 v171, v63, v59, s30
    v_perm_b32 v172, v39, v35, s31
    v_perm_b32 v173, v47, v43, s31
    v_perm_b32 v174, v55, v51, s31
    v_perm_b32 v175, v63, v59, s31
    v_cvt_pk_bf16_f32 v2, v176, v180
    v_cvt_pk_bf16_f32 v6, v177, v181
    v_cvt_pk_bf16_f32 v10, v178, v182
    v_cvt_pk_bf16_f32 v14, v179, v183
    v_cvt_pk_bf16_f32 v18, v184, v188
    v_cvt_pk_bf16_f32 v22, v185, v189
    v_cvt_pk_bf16_f32 v26, v186, v190
    v_cvt_pk_bf16_f32 v30, v187, v191
    v_cvt_pk_bf16_f32 v34, v192, v196
    v_cvt_pk_bf16_f32 v38, v193, v197
    v_cvt_pk_bf16_f32 v42, v194, v198
    v_cvt_pk_bf16_f32 v46, v195, v199
    v_cvt_pk_bf16_f32 v50, v200, v204
    v_cvt_pk_bf16_f32 v54, v201, v205
    v_cvt_pk_bf16_f32 v58, v202, v206
    v_cvt_pk_bf16_f32 v62, v203, v207
    v_mfma_f32_16x16x32_bf16 v[176:179], v[128:131], v[160:163], 0
    v_mfma_f32_16x16x32_bf16 v[180:183], v[128:131], v[164:167], 0
    v_mfma_f32_16x16x32_bf16 v[184:187], v[136:139], v[160:163], 0
    v_mfma_f32_16x16x32_bf16 v[188:191], v[136:139], v[164:167], 0
    v_mfma_f32_16x16x32_bf16 v[192:195], v[144:147], v[160:163], 0
    v_mfma_f32_16x16x32_bf16 v[196:199], v[144:147], v[164:167], 0
    v_mfma_f32_16x16x32_bf16 v[200:203], v[152:155], v[160:163], 0
    v_mfma_f32_16x16x32_bf16 v[204:207], v[152:155], v[164:167], 0
    v_mfma_f32_16x16x32_bf16 v[176:179], v[132:135], v[168:171], v[176:179]
    v_mfma_f32_16x16x32_bf16 v[180:183], v[132:135], v[172:175], v[180:183]
    v_mfma_f32_16x16x32_bf16 v[184:187], v[140:143], v[168:171], v[184:187]
    v_mfma_f32_16x16x32_bf16 v[188:191], v[140:143], v[172:175], v[188:191]
    v_mfma_f32_16x16x32_bf16 v[192:195], v[148:151], v[168:171], v[192:195]
    v_mfma_f32_16x16x32_bf16 v[196:199], v[148:151], v[172:175], v[196:199]
    v_mfma_f32_16x16x32_bf16 v[200:203], v[156:159], v[168:171], v[200:203]
    v_mfma_f32_16x16x32_bf16 v[204:207], v[156:159], v[172:175], v[204:207]
    s_nop 1
    v_cvt_pk_bf16_f32 v3, v176, v180
    v_cvt_pk_bf16_f32 v7, v177, v181
    v_cvt_pk_bf16_f32 v11, v178, v182
    v_cvt_pk_bf16_f32 v15, v179, v183
    v_cvt_pk_bf16_f32 v19, v184, v188
    v_cvt_pk_bf16_f32 v23, v185, v189
    v_cvt_pk_bf16_f32 v27, v186, v190
    v_cvt_pk_bf16_f32 v31, v187, v191
    v_cvt_pk_bf16_f32 v35, v192, v196
    v_cvt_pk_bf16_f32 v39, v193, v197
    v_cvt_pk_bf16_f32 v43, v194, v198
    v_cvt_pk_bf16_f32 v47, v195, v199
    v_cvt_pk_bf16_f32 v51, v200, v204
    v_cvt_pk_bf16_f32 v55, v201, v205
    v_cvt_pk_bf16_f32 v59, v202, v206
    v_cvt_pk_bf16_f32 v63, v203, v207
    s_add_u32 s25, s24, 0
    buffer_store_dwordx4 v[0:3], v212, s[16:19], s25 offen sc1
    s_add_u32 s25, s24, 10752
    buffer_store_dwordx4 v[4:7], v212, s[16:19], s25 offen sc1
    s_add_u32 s25, s24, 21504
    buffer_store_dwordx4 v[8:11], v212, s[16:19], s25 offen sc1
    s_add_u32 s25, s24, 32256
    buffer_store_dwordx4 v[12:15], v212, s[16:19], s25 offen sc1
    s_add_u32 s25, s24, 172032
    buffer_store_dwordx4 v[16:19], v212, s[16:19], s25 offen sc1
    s_add_u32 s25, s24, 182784
    buffer_store_dwordx4 v[20:23], v212, s[16:19], s25 offen sc1
    s_add_u32 s25, s24, 193536
    buffer_store_dwordx4 v[24:27], v212, s[16:19], s25 offen sc1
    s_add_u32 s25, s24, 204288
    buffer_store_dwordx4 v[28:31], v212, s[16:19], s25 offen sc1
    s_add_u32 s25, s24, 344064
    buffer_store_dwordx4 v[32:35], v212, s[16:19], s25 offen sc1
    s_add_u32 s25, s24, 354816
    buffer_store_dwordx4 v[36:39], v212, s[16:19], s25 offen sc1
    s_add_u32 s25, s24, 365568
    buffer_store_dwordx4 v[40:43], v212, s[16:19], s25 offen sc1
    s_add_u32 s25, s24, 376320
    buffer_store_dwordx4 v[44:47], v212, s[16:19], s25 offen sc1
    s_add_u32 s25, s24, 516096
    buffer_store_dwordx4 v[48:51], v212, s[16:19], s25 offen sc1
    s_add_u32 s25, s24, 526848
    buffer_store_dwordx4 v[52:55], v212, s[16:19], s25 offen sc1
    s_add_u32 s25, s24, 537600
    buffer_store_dwordx4 v[56:59], v212, s[16:19], s25 offen sc1
    s_add_u32 s25, s24, 548352
    buffer_store_dwordx4 v[60:63], v212, s[16:19], s25 offen sc1
    s_branch L_next0
L_cw0:
    s_sub_u32 s12, s40, 672
    s_and_b32 s13, s12, 3
    s_lshr_b32 s14, s12, 2
    s_lshl_b32 s14, s14, 2
    s_add_u32 s14, s14, s10
    ds_read_b128 v[128:131], v223 offset:8192
    ds_read_b128 v[132:135], v223 offset:9216
    ds_read_b128 v[136:139], v223 offset:10240
    ds_read_b128 v[140:143], v223 offset:11264
    s_and_b32 s24, s14, 3
    s_bfe_u32 s25, s14, 0x10003
    s_lshl_b32 s25, s25, 2
    s_or_b32 s24, s24, s25
    s_lshl_b32 s24, s24, 1
    v_xor_b32 v213, s24, v209
    v_lshl_add_u32 v212, v213, 4, v227
    s_mul_i32 s24, s13, 16777216
    s_lshr_b32 s25, s14, 5
    s_mul_i32 s25, s25, 524288
    s_add_u32 s24, s24, s25
    s_and_b32 s25, s14, 31
    s_lshl_b32 s25, s25, 8
    s_add_u32 s24, s24, s25
    v_perm_b32 v16, v0, v0, s32
    v_perm_b32 v17, v4, v4, s32
    v_perm_b32 v18, v8, v8, s32
    v_perm_b32 v19, v12, v12, s32
    v_perm_b32 v20, v0, v0, s33
    v_perm_b32 v21, v4, v4, s33
    v_perm_b32 v22, v8, v8, s33
    v_perm_b32 v23, v12, v12, s33
    v_perm_b32 v24, v1, v1, s32
    v_perm_b32 v25, v5, v5, s32
    v_perm_b32 v26, v9, v9, s32
    v_perm_b32 v27, v13, v13, s32
    v_perm_b32 v28, v1, v1, s33
    v_perm_b32 v29, v5, v5, s33
    v_perm_b32 v30, v9, v9, s33
    v_perm_b32 v31, v13, v13, s33
    v_perm_b32 v32, v2, v2, s32
    v_perm_b32 v33, v6, v6, s32
    v_perm_b32 v34, v10, v10, s32
    v_perm_b32 v35, v14, v14, s32
    v_perm_b32 v36, v2, v2, s33
    v_perm_b32 v37, v6, v6, s33
    v_perm_b32 v38, v10, v10, s33
    v_perm_b32 v39, v14, v14, s33
    v_perm_b32 v40, v3, v3, s32
    v_perm_b32 v41, v7, v7, s32
    v_perm_b32 v42, v11, v11, s32
    v_perm_b32 v43, v15, v15, s32
    v_perm_b32 v44, v3, v3, s33
    v_perm_b32 v45, v7, v7, s33
    v_perm_b32 v46, v11, v11, s33
    v_perm_b32 v47, v15, v15, s33
    s_waitcnt lgkmcnt(0)
    v_mfma_f32_16x16x32_bf16 v[176:179], v[128:131], v[16:19], 0
    v_mfma_f32_16x16x32_bf16 v[180:183], v[128:131], v[20:23], 0
    v_mfma_f32_16x16x32_bf16 v[184:187], v[128:131], v[24:27], 0
    v_mfma_f32_16x16x32_bf16 v[188:191], v[128:131], v[28:31], 0
    v_mfma_f32_16x16x32_bf16 v[192:195], v[128:131], v[32:35], 0
    v_mfma_f32_16x16x32_bf16 v[196:199], v[128:131], v[36:39], 0
    v_mfma_f32_16x16x32_bf16 v[200:203], v[128:131], v[40:43], 0
    v_mfma_f32_16x16x32_bf16 v[204:207], v[128:131], v[44:47], 0
    s_nop 1
    v_cvt_pk_bf16_f32 v0, v176, v180
    s_nop 0
    v_cvt_pk_bf16_f32 v1, v184, v188
    s_nop 0
    v_cvt_pk_bf16_f32 v2, v192, v196
    s_nop 0
    v_cvt_pk_bf16_f32 v3, v200, v204
    v_cvt_pk_bf16_f32 v4, v177, v181
    v_cvt_pk_bf16_f32 v5, v185, v189
    v_cvt_pk_bf16_f32 v6, v193, v197
    v_cvt_pk_bf16_f32 v7, v201, v205
    v_cvt_pk_bf16_f32 v8, v178, v182
    v_cvt_pk_bf16_f32 v9, v186, v190
    v_cvt_pk_bf16_f32 v10, v194, v198
    v_cvt_pk_bf16_f32 v11, v202, v206
    v_cvt_pk_bf16_f32 v12, v179, v183
    v_cvt_pk_bf16_f32 v13, v187, v191
    v_cvt_pk_bf16_f32 v14, v195, v199
    v_cvt_pk_bf16_f32 v15, v203, v207
    s_add_u32 s25, s24, 0
    buffer_store_dwordx4 v[0:3], v212, s[16:19], s25 offen sc1
    s_add_u32 s25, s24, 8192
    buffer_store_dwordx4 v[4:7], v212, s[16:19], s25 offen sc1
    s_add_u32 s25, s24, 16384
    buffer_store_dwordx4 v[8:11], v212, s[16:19], s25 offen sc1
    s_add_u32 s25, s24, 24576
    buffer_store_dwordx4 v[12:15], v212, s[16:19], s25 offen sc1
    v_mfma_f32_16x16x32_bf16 v[176:179], v[132:135], v[16:19], 0
    v_mfma_f32_16x16x32_bf16 v[180:183], v[132:135], v[20:23], 0
    v_mfma_f32_16x16x32_bf16 v[184:187], v[132:135], v[24:27], 0
    v_mfma_f32_16x16x32_bf16 v[188:191], v[132:135], v[28:31], 0
    v_mfma_f32_16x16x32_bf16 v[192:195], v[132:135], v[32:35], 0
    v_mfma_f32_16x16x32_bf16 v[196:199], v[132:135], v[36:39], 0
    v_mfma_f32_16x16x32_bf16 v[200:203], v[132:135], v[40:43], 0
    v_mfma_f32_16x16x32_bf16 v[204:207], v[132:135], v[44:47], 0
    s_nop 1
    v_cvt_pk_bf16_f32 v48, v176, v180
    s_nop 0
    v_cvt_pk_bf16_f32 v49, v184, v188
    s_nop 0
    v_cvt_pk_bf16_f32 v50, v192, v196
    s_nop 0
    v_cvt_pk_bf16_f32 v51, v200, v204
    v_cvt_pk_bf16_f32 v52, v177, v181
    v_cvt_pk_bf16_f32 v53, v185, v189
    v_cvt_pk_bf16_f32 v54, v193, v197
    v_cvt_pk_bf16_f32 v55, v201, v205
    v_cvt_pk_bf16_f32 v56, v178, v182
    v_cvt_pk_bf16_f32 v57, v186, v190
    v_cvt_pk_bf16_f32 v58, v194, v198
    v_cvt_pk_bf16_f32 v59, v202, v206
    v_cvt_pk_bf16_f32 v60, v179, v183
    v_cvt_pk_bf16_f32 v61, v187, v191
    v_cvt_pk_bf16_f32 v62, v195, v199
    v_cvt_pk_bf16_f32 v63, v203, v207
    s_add_u32 s25, s24, 131072
    buffer_store_dwordx4 v[48:51], v212, s[16:19], s25 offen sc1
    s_add_u32 s25, s24, 139264
    buffer_store_dwordx4 v[52:55], v212, s[16:19], s25 offen sc1
    s_add_u32 s25, s24, 147456
    buffer_store_dwordx4 v[56:59], v212, s[16:19], s25 offen sc1
    s_add_u32 s25, s24, 155648
    buffer_store_dwordx4 v[60:63], v212, s[16:19], s25 offen sc1
    v_mfma_f32_16x16x32_bf16 v[176:179], v[136:139], v[16:19], 0
    v_mfma_f32_16x16x32_bf16 v[180:183], v[136:139], v[20:23], 0
    v_mfma_f32_16x16x32_bf16 v[184:187], v[136:139], v[24:27], 0
    v_mfma_f32_16x16x32_bf16 v[188:191], v[136:139], v[28:31], 0
    v_mfma_f32_16x16x32_bf16 v[192:195], v[136:139], v[32:35], 0
    v_mfma_f32_16x16x32_bf16 v[196:199], v[136:139], v[36:39], 0
    v_mfma_f32_16x16x32_bf16 v[200:203], v[136:139], v[40:43], 0
    v_mfma_f32_16x16x32_bf16 v[204:207], v[136:139], v[44:47], 0
    s_nop 1
    v_cvt_pk_bf16_f32 v0, v176, v180
    s_nop 0
    v_cvt_pk_bf16_f32 v1, v184, v188
    s_nop 0
    v_cvt_pk_bf16_f32 v2, v192, v196
    s_nop 0
    v_cvt_pk_bf16_f32 v3, v200, v204
    v_cvt_pk_bf16_f32 v4, v177, v181
    v_cvt_pk_bf16_f32 v5, v185, v189
    v_cvt_pk_bf16_f32 v6, v193, v197
    v_cvt_pk_bf16_f32 v7, v201, v205
    v_cvt_pk_bf16_f32 v8, v178, v182
    v_cvt_pk_bf16_f32 v9, v186, v190
    v_cvt_pk_bf16_f32 v10, v194, v198
    v_cvt_pk_bf16_f32 v11, v202, v206
    v_cvt_pk_bf16_f32 v12, v179, v183
    v_cvt_pk_bf16_f32 v13, v187, v191
    v_cvt_pk_bf16_f32 v14, v195, v199
    v_cvt_pk_bf16_f32 v15, v203, v207
    s_add_u32 s25, s24, 262144
    buffer_store_dwordx4 v[0:3], v212, s[16:19], s25 offen sc1
    s_add_u32 s25, s24, 270336
    buffer_store_dwordx4 v[4:7], v212, s[16:19], s25 offen sc1
    s_add_u32 s25, s24, 278528
    buffer_store_dwordx4 v[8:11], v212, s[16:19], s25 offen sc1
    s_add_u32 s25, s24, 286720
    buffer_store_dwordx4 v[12:15], v212, s[16:19], s25 offen sc1
    v_mfma_f32_16x16x32_bf16 v[176:179], v[140:143], v[16:19], 0
    v_mfma_f32_16x16x32_bf16 v[180:183], v[140:143], v[20:23], 0
    v_mfma_f32_16x16x32_bf16 v[184:187], v[140:143], v[24:27], 0
    v_mfma_f32_16x16x32_bf16 v[188:191], v[140:143], v[28:31], 0
    v_mfma_f32_16x16x32_bf16 v[192:195], v[140:143], v[32:35], 0
    v_mfma_f32_16x16x32_bf16 v[196:199], v[140:143], v[36:39], 0
    v_mfma_f32_16x16x32_bf16 v[200:203], v[140:143], v[40:43], 0
    v_mfma_f32_16x16x32_bf16 v[204:207], v[140:143], v[44:47], 0
    s_nop 1
    v_cvt_pk_bf16_f32 v48, v176, v180
    s_nop 0
    v_cvt_pk_bf16_f32 v49, v184, v188
    s_nop 0
    v_cvt_pk_bf16_f32 v50, v192, v196
    s_nop 0
    v_cvt_pk_bf16_f32 v51, v200, v204
    v_cvt_pk_bf16_f32 v52, v177, v181
    v_cvt_pk_bf16_f32 v53, v185, v189
    v_cvt_pk_bf16_f32 v54, v193, v197
    v_cvt_pk_bf16_f32 v55, v201, v205
    v_cvt_pk_bf16_f32 v56, v178, v182
    v_cvt_pk_bf16_f32 v57, v186, v190
    v_cvt_pk_bf16_f32 v58, v194, v198
    v_cvt_pk_bf16_f32 v59, v202, v206
    v_cvt_pk_bf16_f32 v60, v179, v183
    v_cvt_pk_bf16_f32 v61, v187, v191
    v_cvt_pk_bf16_f32 v62, v195, v199
    v_cvt_pk_bf16_f32 v63, v203, v207
    s_add_u32 s25, s24, 393216
    buffer_store_dwordx4 v[48:51], v212, s[16:19], s25 offen sc1
    s_add_u32 s25, s24, 401408
    buffer_store_dwordx4 v[52:55], v212, s[16:19], s25 offen sc1
    s_add_u32 s25, s24, 409600
    buffer_store_dwordx4 v[56:59], v212, s[16:19], s25 offen sc1
    s_add_u32 s25, s24, 417792
    buffer_store_dwordx4 v[60:63], v212, s[16:19], s25 offen sc1
L_next0:
    s_cmp_lg_u32 s10, 0
    s_cbranch_scc1 L_pub0
    s_cmp_ge_u32 s42, 1696
    s_cbranch_scc1 L_w0_p0
    s_cmp_ge_u32 s42, 672
    s_cbranch_scc1 L_w8_p0
    s_waitcnt vmcnt(32)
    s_branch L_wd_p0
L_w8_p0:
    s_waitcnt vmcnt(24)
    s_branch L_wd_p0
L_w0_p0:
    s_waitcnt vmcnt(16)
L_wd_p0:
    v_add_u32 v221, 512, v221
    v_mov_b32 v213, s41
    s_mov_b64 exec, 1
    ds_write_b32 v213, v221 offset:12288
    s_mov_b64 exec, -1
L_pub0:
    s_waitcnt lgkmcnt(0)
    s_barrier
    v_mov_b32 v213, s41
    ds_read_b32 v214, v213 offset:12288
    s_xor_b32 s41, s41, 4
    s_mov_b32 s40, s42
    s_waitcnt lgkmcnt(0)
    v_readfirstlane_b32 s42, v214
    s_cmp_ge_u32 s40, 1696
    s_cbranch_scc1 L_k12_fin
    s_cmp_lg_u32 s10, 0
    s_cbranch_scc1 L_nofetch1
    v_mov_b32 v221, 1
    s_mov_b64 exec, 1
    buffer_atomic_add v221, v222, s[44:47], 0 offen sc0 sc1
    s_mov_b64 exec, -1
L_nofetch1:
    s_cmp_ge_u32 s42, 1696
    s_cbranch_scc1 L_ld_done2
    s_cmp_ge_u32 s42, 672
    s_cbranch_scc1 L_ld_w2
    s_cmp_ge_u32 s42, 336
    s_cselect_b32 s11, 1, 0
    s_mul_i32 s12, s11, 336
    s_sub_u32 s12, s42, s12
    s_and_b32 s13, s12, 7
    s_lshr_b32 s14, s12, 3
    s_lshl_b32 s14, s14, 2
    s_add_u32 s14, s14, s10
    s_mul_i32 s15, s11, 16384000
    s_add_u32 s34, s4, s15
    s_addc_u32 s35, s5, 0
    s_mov_b32 s20, s34
    s_and_b32 s21, s35, 0xffff
    s_mov_b32 s22, 16384000
    s_mov_b32 s23, 0x00020000
    s_mul_i32 s15, s14, 98304
    s_lshl_b32 s24, s13, 8
    s_add_u32 s15, s15, s24
    s_add_u32 s25, s15, 0
    buffer_load_dwordx4 v[0:3], v224, s[20:23], s25 offen
    s_add_u32 s25, s15, 2048
    buffer_load_dwordx4 v[4:7], v224, s[20:23], s25 offen
    s_add_u32 s25, s15, 4096
    buffer_load_dwordx4 v[8:11], v224, s[20:23], s25 offen
    s_add_u32 s25, s15, 6144
    buffer_load_dwordx4 v[12:15], v224, s[20:23], s25 offen
    s_add_u32 s25, s15, 8192
    buffer_load_dwordx4 v[16:19], v224, s[20:23], s25 offen
    s_add_u32 s25, s15, 10240
    buffer_load_dwordx4 v[20:23], v224, s[20:23], s25 offen
    s_add_u32 s25, s15, 12288
    buffer_load_dwordx4 v[24:27], v224, s[20:23], s25 offen
    s_add_u32 s25, s15, 14336
    buffer_load_dwordx4 v[28:31], v224, s[20:23], s25 offen
    s_add_u32 s25, s15, 65536
    buffer_load_dwordx4 v[32:35], v224, s[20:23], s25 offen
    s_add_u32 s25, s15, 67584
    buffer_load_dwordx4 v[36:39], v224, s[20:23], s25 offen
    s_add_u32 s25, s15, 69632
    buffer_load_dwordx4 v[40:43], v224, s[20:23], s25 offen
    s_add_u32 s25, s15, 71680
    buffer_load_dwordx4 v[44:47], v224, s[20:23], s25 offen
    s_add_u32 s25, s15, 73728
    buffer_load_dwordx4 v[48:51], v224, s[20:23], s25 offen
    s_add_u32 s25, s15, 75776
    buffer_load_dwordx4 v[52:55], v224, s[20:23], s25 offen
    s_add_u32 s25, s15, 77824
    buffer_load_dwordx4 v[56:59], v224, s[20:23], s25 offen
    s_add_u32 s25, s15, 79872
    buffer_load_dwordx4 v[60:63], v224, s[20:23], s25 offen
    s_branch L_ld_done2
L_ld_w2:
    s_sub_u32 s12, s42, 672
    s_and_b32 s13, s12, 3
    s_lshr_b32 s14, s12, 2
    s_lshl_b32 s14, s14, 2
    s_add_u32 s14, s14, s10
    s_mov_b32 s20, s6
    s_and_b32 s21, s7, 0xffff
    s_mov_b32 s22, 16252928
    s_mov_b32 s23, 0x00020000
    s_lshl_b32 s15, s14, 10
    s_lshl_b32 s24, s13, 8
    s_add_u32 s15, s15, s24
    s_add_u32 s25, s15, 0
    buffer_load_dwordx2 v[0:1], v225, s[20:23], s25 offen
    buffer_load_dwordx2 v[2:3], v225, s[20:23], s25 offen offset:16
    s_add_u32 s25, s15, 1048576
    buffer_load_dwordx2 v[4:5], v225, s[20:23], s25 offen
    buffer_load_dwordx2 v[6:7], v225, s[20:23], s25 offen offset:16
    s_add_u32 s25, s15, 2097152
    buffer_load_dwordx2 v[8:9], v225, s[20:23], s25 offen
    buffer_load_dwordx2 v[10:11], v225, s[20:23], s25 offen offset:16
    s_add_u32 s25, s15, 3145728
    buffer_load_dwordx2 v[12:13], v225, s[20:23], s25 offen
    buffer_load_dwordx2 v[14:15], v225, s[20:23], s25 offen offset:16
L_ld_done2:
    s_cmp_ge_u32 s42, 1696
    s_cbranch_scc1 L_w0_a1
    s_cmp_ge_u32 s42, 672
    s_cbranch_scc1 L_w8_a1
    s_waitcnt vmcnt(32)
    s_branch L_wd_a1
L_w8_a1:
    s_waitcnt vmcnt(24)
    s_branch L_wd_a1
L_w0_a1:
    s_waitcnt vmcnt(16)
L_wd_a1:
    s_cmp_ge_u32 s40, 672
    s_cbranch_scc1 L_cw1
    s_cmp_ge_u32 s40, 336
    s_cselect_b32 s11, 1, 0
    s_mul_i32 s12, s11, 336
    s_sub_u32 s12, s40, s12
    s_and_b32 s13, s12, 7
    s_lshr_b32 s14, s12, 3
    s_lshl_b32 s14, s14, 2
    s_add_u32 s14, s14, s10
    ds_read_b128 v[128:131], v223 offset:0
    ds_read_b128 v[132:135], v223 offset:1024
    ds_read_b128 v[136:139], v223 offset:2048
    ds_read_b128 v[140:143], v223 offset:3072
    ds_read_b128 v[144:147], v223 offset:4096
    ds_read_b128 v[148:151], v223 offset:5120
    ds_read_b128 v[152:155], v223 offset:6144
    ds_read_b128 v[156:159], v223 offset:7168
    s_bfe_u32 s24, s14, 0x10003
    s_mul_i32 s24, s24, 3
    v_and_b32 v213, 3, v209
    v_xor_b32 v213, s24, v213
    v_lshl_add_u32 v212, v213, 4, v226
    s_mul_i32 s24, s11, 22020096
    s_mul_i32 s25, s13, 2752512
    s_add_u32 s24, s24, s25
    s_lshl_b32 s25, s14, 6
    s_add_u32 s24, s24, s25
    s_add_u32 s24, s24, 67108864
    v_perm_b32 v160, v68, v64, s30
    v_perm_b32 v161, v76, v72, s30
    v_perm_b32 v162, v84, v80, s30
    v_perm_b32 v163, v92, v88, s30
    v_perm_b32 v164, v68, v64, s31
    v_perm_b32 v165, v76, v72, s31
    v_perm_b32 v166, v84, v80, s31
    v_perm_b32 v167, v92, v88, s31
    v_perm_b32 v168, v100, v96, s30
    v_perm_b32 v169, v108, v104, s30
    v_perm_b32 v170, v116, v112, s30
    v_perm_b32 v171, v124, v120, s30
    v_perm_b32 v172, v100, v96, s31
    v_perm_b32 v173, v108, v104, s31
    v_perm_b32 v174, v116, v112, s31
    v_perm_b32 v175, v124, v120, s31
    s_waitcnt lgkmcnt(0)
    v_mfma_f32_16x16x32_bf16 v[176:179], v[128:131], v[160:163], 0
    v_mfma_f32_16x16x32_bf16 v[180:183], v[128:131], v[164:167], 0
    v_mfma_f32_16x16x32_bf16 v[184:187], v[136:139], v[160:163], 0
    v_mfma_f32_16x16x32_bf16 v[188:191], v[136:139], v[164:167], 0
    v_mfma_f32_16x16x32_bf16 v[192:195], v[144:147], v[160:163], 0
    v_mfma_f32_16x16x32_bf16 v[196:199], v[144:147], v[164:167], 0
    v_mfma_f32_16x16x32_bf16 v[200:203], v[152:155], v[160:163], 0
    v_mfma_f32_16x16x32_bf16 v[204:207], v[152:155], v[164:167], 0
    v_mfma_f32_16x16x32_bf16 v[176:179], v[132:135], v[168:171], v[176:179]
    v_mfma_f32_16x16x32_bf16 v[180:183], v[132:135], v[172:175], v[180:183]
    v_mfma_f32_16x16x32_bf16 v[184:187], v[140:143], v[168:171], v[184:187]
    v_mfma_f32_16x16x32_bf16 v[188:191], v[140:143], v[172:175], v[188:191]
    v_mfma_f32_16x16x32_bf16 v[192:195], v[148:151], v[168:171], v[192:195]
    v_mfma_f32_16x16x32_bf16 v[196:199], v[148:151], v[172:175], v[196:199]
    v_mfma_f32_16x16x32_bf16 v[200:203], v[156:159], v[168:171], v[200:203]
    v_mfma_f32_16x16x32_bf16 v[204:207], v[156:159], v[172:175], v[204:207]
    v_perm_b32 v160, v69, v65, s30
    v_perm_b32 v161, v77, v73, s30
    v_perm_b32 v162, v85, v81, s30
    v_perm_b32 v163, v93, v89, s30
    v_perm_b32 v164, v69, v65, s31
    v_perm_b32 v165, v77, v73, s31
    v_perm_b32 v166, v85, v81, s31
    v_perm_b32 v167, v93, v89, s31
    v_perm_b32 v168, v101, v97, s30
    v_perm_b32 v169, v109, v105, s30
    v_perm_b32 v170, v117, v113, s30
    v_perm_b32 v171, v125, v121, s30
    v_perm_b32 v172, v101, v97, s31
    v_perm_b32 v173, v109, v105, s31
    v_perm_b32 v174, v117, v113, s31
    v_perm_b32 v175, v125, v121, s31
    v_cvt_pk_bf16_f32 v64, v176, v180
    v_cvt_pk_bf16_f32 v68, v177, v181
    v_cvt_pk_bf16_f32 v72, v178, v182
    v_cvt_pk_bf16_f32 v76, v179, v183
    v_cvt_pk_bf16_f32 v80, v184, v188
    v_cvt_pk_bf16_f32 v84, v185, v189
    v_cvt_pk_bf16_f32 v88, v186, v190
    v_cvt_pk_bf16_f32 v92, v187, v191
    v_cvt_pk_bf16_f32 v96, v192, v196
    v_cvt_pk_bf16_f32 v100, v193, v197
    v_cvt_pk_bf16_f32 v104, v194, v198
    v_cvt_pk_bf16_f32 v108, v195, v199
    v_cvt_pk_bf16_f32 v112, v200, v204
    v_cvt_pk_bf16_f32 v116, v201, v205
    v_cvt_pk_bf16_f32 v120, v202, v206
    v_cvt_pk_bf16_f32 v124, v203, v207
    v_mfma_f32_16x16x32_bf16 v[176:179], v[128:131], v[160:163], 0
    v_mfma_f32_16x16x32_bf16 v[180:183], v[128:131], v[164:167], 0
    v_mfma_f32_16x16x32_bf16 v[184:187], v[136:139], v[160:163], 0
    v_mfma_f32_16x16x32_bf16 v[188:191], v[136:139], v[164:167], 0
    v_mfma_f32_16x16x32_bf16 v[192:195], v[144:147], v[160:163], 0
    v_mfma_f32_16x16x32_bf16 v[196:199], v[144:147], v[164:167], 0
    v_mfma_f32_16x16x32_bf16 v[200:203], v[152:155], v[160:163], 0
    v_mfma_f32_16x16x32_bf16 v[204:207], v[152:155], v[164:167], 0
    v_mfma_f32_16x16x32_bf16 v[176:179], v[132:135], v[168:171], v[176:179]
    v_mfma_f32_16x16x32_bf16 v[180:183], v[132:135], v[172:175], v[180:183]
    v_mfma_f32_16x16x32_bf16 v[184:187], v[140:143], v[168:171], v[184:187]
    v_mfma_f32_16x16x32_bf16 v[188:191], v[140:143], v[172:175], v[188:191]
    v_mfma_f32_16x16x32_bf16 v[192:195], v[148:151], v[168:171], v[192:195]
    v_mfma_f32_16x16x32_bf16 v[196:199], v[148:151], v[172:175], v[196:199]
    v_mfma_f32_16x16x32_bf16 v[200:203], v[156:159], v[168:171], v[200:203]
    v_mfma_f32_16x16x32_bf16 v[204:207], v[156:159], v[172:175], v[204:207]
    v_perm_b32 v160, v70, v66, s30
    v_perm_b32 v161, v78, v74, s30
    v_perm_b32 v162, v86, v82, s30
    v_perm_b32 v163, v94, v90, s30
    v_perm_b32 v164, v70, v66, s31
    v_perm_b32 v165, v78, v74, s31
    v_perm_b32 v166, v86, v82, s31
    v_perm_b32 v167, v94, v90, s31
    v_perm_b32 v168, v102, v98, s30
    v_perm_b32 v169, v110, v106, s30
    v_perm_b32 v170, v118, v114, s30
    v_perm_b32 v171, v126, v122, s30
    v_perm_b32 v172, v102, v98, s31
    v_perm_b32 v173, v110, v106, s31
    v_perm_b32 v174, v118, v114, s31
    v_perm_b32 v175, v126, v122, s31
    v_cvt_pk_bf16_f32 v65, v176, v180
    v_cvt_pk_bf16_f32 v69, v177, v181
    v_cvt_pk_bf16_f32 v73, v178, v182
    v_cvt_pk_bf16_f32 v77, v179, v183
    v_cvt_pk_bf16_f32 v81, v184, v188
    v_cvt_pk_bf16_f32 v85, v185, v189
    v_cvt_pk_bf16_f32 v89, v186, v190
    v_cvt_pk_bf16_f32 v93, v187, v191
    v_cvt_pk_bf16_f32 v97, v192, v196
    v_cvt_pk_bf16_f32 v101, v193, v197
    v_cvt_pk_bf16_f32 v105, v194, v198
    v_cvt_pk_bf16_f32 v109, v195, v199
    v_cvt_pk_bf16_f32 v113, v200, v204
    v_cvt_pk_bf16_f32 v117, v201, v205
    v_cvt_pk_bf16_f32 v121, v202, v206
    v_cvt_pk_bf16_f32 v125, v203, v207
    v_mfma_f32_16x16x32_bf16 v[176:179], v[128:131], v[160:163], 0
    v_mfma_f32_16x16x32_bf16 v[180:183], v[128:131], v[164:167], 0
    v_mfma_f32_16x16x32_bf16 v[184:187], v[136:139], v[160:163], 0
    v_mfma_f32_16x16x32_bf16 v[188:191], v[136:139], v[164:167], 0
    v_mfma_f32_16x16x32_bf16 v[192:195], v[144:147], v[160:163], 0
    v_mfma_f32_16x16x32_bf16 v[196:199], v[144:147], v[164:167], 0
    v_mfma_f32_16x16x32_bf16 v[200:203], v[152:155], v[160:163], 0
    v_mfma_f32_16x16x32_bf16 v[204:207], v[152:155], v[164:167], 0
    v_mfma_f32_16x16x32_bf16 v[176:179], v[132:135], v[168:171], v[176:179]
    v_mfma_f32_16x16x32_bf16 v[180:183], v[132:135], v[172:175], v[180:183]
    v_mfma_f32_16x16x32_bf16 v[184:187], v[140:143], v[168:171], v[184:187]
    v_mfma_f32_16x16x32_bf16 v[188:191], v[140:143], v[172:175], v[188:191]
    v_mfma_f32_16x16x32_bf16 v[192:195], v[148:151], v[168:171], v[192:195]
    v_mfma_f32_16x16x32_bf16 v[196:199], v[148:151], v[172:175], v[196:199]
    v_mfma_f32_16x16x32_bf16 v[200:203], v[156:159], v[168:171], v[200:203]
    v_mfma_f32_16x16x32_bf16 v[204:207], v[156:159], v[172:175], v[204:207]
    v_perm_b32 v160, v71, v67, s30
    v_perm_b32 v161, v79, v75, s30
    v_perm_b32 v162, v87, v83, s30
    v_perm_b32 v163, v95, v91, s30
    v_perm_b32 v164, v71, v67, s31
    v_perm_b32 v165, v79, v75, s31
    v_perm_b32 v166, v87, v83, s31
    v_perm_b32 v167, v95, v91, s31
    v_perm_b32 v168, v103, v99, s30
    v_perm_b32 v169, v111, v107, s30
    v_perm_b32 v170, v119, v115, s30
    v_perm_b32 v171, v127, v123, s30
    v_perm_b32 v172, v103, v99, s31
    v_perm_b32 v173, v111, v107, s31
    v_perm_b32 v174, v119, v115, s31
    v_perm_b32 v175, v127, v123, s31
    v_cvt_pk_bf16_f32 v66, v176, v180
    v_cvt_pk_bf16_f32 v70, v177, v181
    v_cvt_pk_bf16_f32 v74, v178, v182
    v_cvt_pk_bf16_f32 v78, v179, v183
    v_cvt_pk_bf16_f32 v82, v184, v188
    v_cvt_pk_bf16_f32 v86, v185, v189
    v_cvt_pk_bf16_f32 v90, v186, v190
    v_cvt_pk_bf16_f32 v94, v187, v191
    v_cvt_pk_bf16_f32 v98, v192, v196
    v_cvt_pk_bf16_f32 v102, v193, v197
    v_cvt_pk_bf16_f32 v106, v194, v198
    v_cvt_pk_bf16_f32 v110, v195, v199
    v_cvt_pk_bf16_f32 v114, v200, v204
    v_cvt_pk_bf16_f32 v118, v201, v205
    v_cvt_pk_bf16_f32 v122, v202, v206
    v_cvt_pk_bf16_f32 v126, v203, v207
    v_mfma_f32_16x16x32_bf16 v[176:179], v[128:131], v[160:163], 0
    v_mfma_f32_16x16x32_bf16 v[180:183], v[128:131], v[164:167], 0
    v_mfma_f32_16x16x32_bf16 v[184:187], v[136:139], v[160:163], 0
    v_mfma_f32_16x16x32_bf16 v[188:191], v[136:139], v[164:167], 0
    v_mfma_f32_16x16x32_bf16 v[192:195], v[144:147], v[160:163], 0
    v_mfma_f32_16x16x32_bf16 v[196:199], v[144:147], v[164:167], 0
    v_mfma_f32_16x16x32_bf16 v[200:203], v[152:155], v[160:163], 0
    v_mfma_f32_16x16x32_bf16 v[204:207], v[152:155], v[164:167], 0
    v_mfma_f32_16x16x32_bf16 v[176:179], v[132:135], v[168:171], v[176:179]
    v_mfma_f32_16x16x32_bf16 v[180:183], v[132:135], v[172:175], v[180:183]
    v_mfma_f32_16x16x32_bf16 v[184:187], v[140:143], v[168:171], v[184:187]
    v_mfma_f32_16x16x32_bf16 v[188:191], v[140:143], v[172:175], v[188:191]
    v_mfma_f32_16x16x32_bf16 v[192:195], v[148:151], v[168:171], v[192:195]
    v_mfma_f32_16x16x32_bf16 v[196:199], v[148:151], v[172:175], v[196:199]
    v_mfma_f32_16x16x32_bf16 v[200:203], v[156:159], v[168:171], v[200:203]
    v_mfma_f32_16x16x32_bf16 v[204:207], v[156:159], v[172:175], v[204:207]
    s_nop 1
    v_cvt_pk_bf16_f32 v67, v176, v180
    v_cvt_pk_bf16_f32 v71, v177, v181
    v_cvt_pk_bf16_f32 v75, v178, v182
    v_cvt_pk_bf16_f32 v79, v179, v183
    v_cvt_pk_bf16_f32 v83, v184, v188
    v_cvt_pk_bf16_f32 v87, v185, v189
    v_cvt_pk_bf16_f32 v91, v186, v190
    v_cvt_pk_bf16_f32 v95, v187, v191
    v_cvt_pk_bf16_f32 v99, v192, v196
    v_cvt_pk_bf16_f32 v103, v193, v197
    v_cvt_pk_bf16_f32 v107, v194, v198
    v_cvt_pk_bf16_f32 v111, v195, v199
    v_cvt_pk_bf16_f32 v115, v200, v204
    v_cvt_pk_bf16_f32 v119, v201, v205
    v_cvt_pk_bf16_f32 v123, v202, v206
    v_cvt_pk_bf16_f32 v127, v203, v207
    s_add_u32 s25, s24, 0
    buffer_store_dwordx4 v[64:67], v212, s[16:19], s25 offen sc1
    s_add_u32 s25, s24, 10752
    buffer_store_dwordx4 v[68:71], v212, s[16:19], s25 offen sc1
    s_add_u32 s25, s24, 21504
    buffer_store_dwordx4 v[72:75], v212, s[16:19], s25 offen sc1
    s_add_u32 s25, s24, 32256
    buffer_store_dwordx4 v[76:79], v212, s[16:19], s25 offen sc1
    s_add_u32 s25, s24, 172032
    buffer_store_dwordx4 v[80:83], v212, s[16:19], s25 offen sc1
    s_add_u32 s25, s24, 182784
    buffer_store_dwordx4 v[84:87], v212, s[16:19], s25 offen sc1
    s_add_u32 s25, s24, 193536
    buffer_store_dwordx4 v[88:91], v212, s[16:19], s25 offen sc1
    s_add_u32 s25, s24, 204288
    buffer_store_dwordx4 v[92:95], v212, s[16:19], s25 offen sc1
    s_add_u32 s25, s24, 344064
    buffer_store_dwordx4 v[96:99], v212, s[16:19], s25 offen sc1
    s_add_u32 s25, s24, 354816
    buffer_store_dwordx4 v[100:103], v212, s[16:19], s25 offen sc1
    s_add_u32 s25, s24, 365568
    buffer_store_dwordx4 v[104:107], v212, s[16:19], s25 offen sc1
    s_add_u32 s25, s24, 376320
    buffer_store_dwordx4 v[108:111], v212, s[16:19], s25 offen sc1
    s_add_u32 s25, s24, 516096
    buffer_store_dwordx4 v[112:115], v212, s[16:19], s25 offen sc1
    s_add_u32 s25, s24, 526848
    buffer_store_dwordx4 v[116:119], v212, s[16:19], s25 offen sc1
    s_add_u32 s25, s24, 537600
    buffer_store_dwordx4 v[120:123], v212, s[16:19], s25 offen sc1
    s_add_u32 s25, s24, 548352
    buffer_store_dwordx4 v[124:127], v212, s[16:19], s25 offen sc1
    s_branch L_next1
L_cw1:
    s_sub_u32 s12, s40, 672
    s_and_b32 s13, s12, 3
    s_lshr_b32 s14, s12, 2
    s_lshl_b32 s14, s14, 2
    s_add_u32 s14, s14, s10
    ds_read_b128 v[128:131], v223 offset:8192
    ds_read_b128 v[132:135], v223 offset:9216
    ds_read_b128 v[136:139], v223 offset:10240
    ds_read_b128 v[140:143], v223 offset:11264
    s_and_b32 s24, s14, 3
    s_bfe_u32 s25, s14, 0x10003
    s_lshl_b32 s25, s25, 2
    s_or_b32 s24, s24, s25
    s_lshl_b32 s24, s24, 1
    v_xor_b32 v213, s24, v209
    v_lshl_add_u32 v212, v213, 4, v227
    s_mul_i32 s24, s13, 16777216
    s_lshr_b32 s25, s14, 5
    s_mul_i32 s25, s25, 524288
    s_add_u32 s24, s24, s25
    s_and_b32 s25, s14, 31
    s_lshl_b32 s25, s25, 8
    s_add_u32 s24, s24, s25
    v_perm_b32 v80, v64, v64, s32
    v_perm_b32 v81, v68, v68, s32
    v_perm_b32 v82, v72, v72, s32
    v_perm_b32 v83, v76, v76, s32
    v_perm_b32 v84, v64, v64, s33
    v_perm_b32 v85, v68, v68, s33
    v_perm_b32 v86, v72, v72, s33
    v_perm_b32 v87, v76, v76, s33
    v_perm_b32 v88, v65, v65, s32
    v_perm_b32 v89, v69, v69, s32
    v_perm_b32 v90, v73, v73, s32
    v_perm_b32 v91, v77, v77, s32
    v_perm_b32 v92, v65, v65, s33
    v_perm_b32 v93, v69, v69, s33
    v_perm_b32 v94, v73, v73, s33
    v_perm_b32 v95, v77, v77, s33
    v_perm_b32 v96, v66, v66, s32
    v_perm_b32 v97, v70, v70, s32
    v_perm_b32 v98, v74, v74, s32
    v_perm_b32 v99, v78, v78, s32
    v_perm_b32 v100, v66, v66, s33
    v_perm_b32 v101, v70, v70, s33
    v_perm_b32 v102, v74, v74, s33
    v_perm_b32 v103, v78, v78, s33
    v_perm_b32 v104, v67, v67, s32
    v_perm_b32 v105, v71, v71, s32
    v_perm_b32 v106, v75, v75, s32
    v_perm_b32 v107, v79, v79, s32
    v_perm_b32 v108, v67, v67, s33
    v_perm_b32 v109, v71, v71, s33
    v_perm_b32 v110, v75, v75, s33
    v_perm_b32 v111, v79, v79, s33
    s_waitcnt lgkmcnt(0)
    v_mfma_f32_16x16x32_bf16 v[176:179], v[128:131], v[80:83], 0
    v_mfma_f32_16x16x32_bf16 v[180:183], v[128:131], v[84:87], 0
    v_mfma_f32_16x16x32_bf16 v[184:187], v[128:131], v[88:91], 0
    v_mfma_f32_16x16x32_bf16 v[188:191], v[128:131], v[92:95], 0
    v_mfma_f32_16x16x32_bf16 v[192:195], v[128:131], v[96:99], 0
    v_mfma_f32_16x16x32_bf16 v[196:199], v[128:131], v[100:103], 0
    v_mfma_f32_16x16x32_bf16 v[200:203], v[128:131], v[104:107], 0
    v_mfma_f32_16x16x32_bf16 v[204:207], v[128:131], v[108:111], 0
    s_nop 1
    v_cvt_pk_bf16_f32 v64, v176, v180
    s_nop 0
    v_cvt_pk_bf16_f32 v65, v184, v188
    s_nop 0
    v_cvt_pk_bf16_f32 v66, v192, v196
    s_nop 0
    v_cvt_pk_bf16_f32 v67, v200, v204
    v_cvt_pk_bf16_f32 v68, v177, v181
    v_cvt_pk_bf16_f32 v69, v185, v189
    v_cvt_pk_bf16_f32 v70, v193, v197
    v_cvt_pk_bf16_f32 v71, v201, v205
    v_cvt_pk_bf16_f32 v72, v178, v182
    v_cvt_pk_bf16_f32 v73, v186, v190
    v_cvt_pk_bf16_f32 v74, v194, v198
    v_cvt_pk_bf16_f32 v75, v202, v206
    v_cvt_pk_bf16_f32 v76, v179, v183
    v_cvt_pk_bf16_f32 v77, v187, v191
    v_cvt_pk_bf16_f32 v78, v195, v199
    v_cvt_pk_bf16_f32 v79, v203, v207
    s_add_u32 s25, s24, 0
    buffer_store_dwordx4 v[64:67], v212, s[16:19], s25 offen sc1
    s_add_u32 s25, s24, 8192
    buffer_store_dwordx4 v[68:71], v212, s[16:19], s25 offen sc1
    s_add_u32 s25, s24, 16384
    buffer_store_dwordx4 v[72:75], v212, s[16:19], s25 offen sc1
    s_add_u32 s25, s24, 24576
    buffer_store_dwordx4 v[76:79], v212, s[16:19], s25 offen sc1
    v_mfma_f32_16x16x32_bf16 v[176:179], v[132:135], v[80:83], 0
    v_mfma_f32_16x16x32_bf16 v[180:183], v[132:135], v[84:87], 0
    v_mfma_f32_16x16x32_bf16 v[184:187], v[132:135], v[88:91], 0
    v_mfma_f32_16x16x32_bf16 v[188:191], v[132:135], v[92:95], 0
    v_mfma_f32_16x16x32_bf16 v[192:195], v[132:135], v[96:99], 0
    v_mfma_f32_16x16x32_bf16 v[196:199], v[132:135], v[100:103], 0
    v_mfma_f32_16x16x32_bf16 v[200:203], v[132:135], v[104:107], 0
    v_mfma_f32_16x16x32_bf16 v[204:207], v[132:135], v[108:111], 0
    s_nop 1
    v_cvt_pk_bf16_f32 v112, v176, v180
    s_nop 0
    v_cvt_pk_bf16_f32 v113, v184, v188
    s_nop 0
    v_cvt_pk_bf16_f32 v114, v192, v196
    s_nop 0
    v_cvt_pk_bf16_f32 v115, v200, v204
    v_cvt_pk_bf16_f32 v116, v177, v181
    v_cvt_pk_bf16_f32 v117, v185, v189
    v_cvt_pk_bf16_f32 v118, v193, v197
    v_cvt_pk_bf16_f32 v119, v201, v205
    v_cvt_pk_bf16_f32 v120, v178, v182
    v_cvt_pk_bf16_f32 v121, v186, v190
    v_cvt_pk_bf16_f32 v122, v194, v198
    v_cvt_pk_bf16_f32 v123, v202, v206
    v_cvt_pk_bf16_f32 v124, v179, v183
    v_cvt_pk_bf16_f32 v125, v187, v191
    v_cvt_pk_bf16_f32 v126, v195, v199
    v_cvt_pk_bf16_f32 v127, v203, v207
    s_add_u32 s25, s24, 131072
    buffer_store_dwordx4 v[112:115], v212, s[16:19], s25 offen sc1
    s_add_u32 s25, s24, 139264
    buffer_store_dwordx4 v[116:119], v212, s[16:19], s25 offen sc1
    s_add_u32 s25, s24, 147456
    buffer_store_dwordx4 v[120:123], v212, s[16:19], s25 offen sc1
    s_add_u32 s25, s24, 155648
    buffer_store_dwordx4 v[124:127], v212, s[16:19], s25 offen sc1
    v_mfma_f32_16x16x32_bf16 v[176:179], v[136:139], v[80:83], 0
    v_mfma_f32_16x16x32_bf16 v[180:183], v[136:139], v[84:87], 0
    v_mfma_f32_16x16x32_bf16 v[184:187], v[136:139], v[88:91], 0
    v_mfma_f32_16x16x32_bf16 v[188:191], v[136:139], v[92:95], 0
    v_mfma_f32_16x16x32_bf16 v[192:195], v[136:139], v[96:99], 0
    v_mfma_f32_16x16x32_bf16 v[196:199], v[136:139], v[100:103], 0
    v_mfma_f32_16x16x32_bf16 v[200:203], v[136:139], v[104:107], 0
    v_mfma_f32_16x16x32_bf16 v[204:207], v[136:139], v[108:111], 0
    s_nop 1
    v_cvt_pk_bf16_f32 v64, v176, v180
    s_nop 0
    v_cvt_pk_bf16_f32 v65, v184, v188
    s_nop 0
    v_cvt_pk_bf16_f32 v66, v192, v196
    s_nop 0
    v_cvt_pk_bf16_f32 v67, v200, v204
    v_cvt_pk_bf16_f32 v68, v177, v181
    v_cvt_pk_bf16_f32 v69, v185, v189
    v_cvt_pk_bf16_f32 v70, v193, v197
    v_cvt_pk_bf16_f32 v71, v201, v205
    v_cvt_pk_bf16_f32 v72, v178, v182
    v_cvt_pk_bf16_f32 v73, v186, v190
    v_cvt_pk_bf16_f32 v74, v194, v198
    v_cvt_pk_bf16_f32 v75, v202, v206
    v_cvt_pk_bf16_f32 v76, v179, v183
    v_cvt_pk_bf16_f32 v77, v187, v191
    v_cvt_pk_bf16_f32 v78, v195, v199
    v_cvt_pk_bf16_f32 v79, v203, v207
    s_add_u32 s25, s24, 262144
    buffer_store_dwordx4 v[64:67], v212, s[16:19], s25 offen sc1
    s_add_u32 s25, s24, 270336
    buffer_store_dwordx4 v[68:71], v212, s[16:19], s25 offen sc1
    s_add_u32 s25, s24, 278528
    buffer_store_dwordx4 v[72:75], v212, s[16:19], s25 offen sc1
    s_add_u32 s25, s24, 286720
    buffer_store_dwordx4 v[76:79], v212, s[16:19], s25 offen sc1
    v_mfma_f32_16x16x32_bf16 v[176:179], v[140:143], v[80:83], 0
    v_mfma_f32_16x16x32_bf16 v[180:183], v[140:143], v[84:87], 0
    v_mfma_f32_16x16x32_bf16 v[184:187], v[140:143], v[88:91], 0
    v_mfma_f32_16x16x32_bf16 v[188:191], v[140:143], v[92:95], 0
    v_mfma_f32_16x16x32_bf16 v[192:195], v[140:143], v[96:99], 0
    v_mfma_f32_16x16x32_bf16 v[196:199], v[140:143], v[100:103], 0
    v_mfma_f32_16x16x32_bf16 v[200:203], v[140:143], v[104:107], 0
    v_mfma_f32_16x16x32_bf16 v[204:207], v[140:143], v[108:111], 0
    s_nop 1
    v_cvt_pk_bf16_f32 v112, v176, v180
    s_nop 0
    v_cvt_pk_bf16_f32 v113, v184, v188
    s_nop 0
    v_cvt_pk_bf16_f32 v114, v192, v196
    s_nop 0
    v_cvt_pk_bf16_f32 v115, v200, v204
    v_cvt_pk_bf16_f32 v116, v177, v181
    v_cvt_pk_bf16_f32 v117, v185, v189
    v_cvt_pk_bf16_f32 v118, v193, v197
    v_cvt_pk_bf16_f32 v119, v201, v205
    v_cvt_pk_bf16_f32 v120, v178, v182
    v_cvt_pk_bf16_f32 v121, v186, v190
    v_cvt_pk_bf16_f32 v122, v194, v198
    v_cvt_pk_bf16_f32 v123, v202, v206
    v_cvt_pk_bf16_f32 v124, v179, v183
    v_cvt_pk_bf16_f32 v125, v187, v191
    v_cvt_pk_bf16_f32 v126, v195, v199
    v_cvt_pk_bf16_f32 v127, v203, v207
    s_add_u32 s25, s24, 393216
    buffer_store_dwordx4 v[112:115], v212, s[16:19], s25 offen sc1
    s_add_u32 s25, s24, 401408
    buffer_store_dwordx4 v[116:119], v212, s[16:19], s25 offen sc1
    s_add_u32 s25, s24, 409600
    buffer_store_dwordx4 v[120:123], v212, s[16:19], s25 offen sc1
    s_add_u32 s25, s24, 417792
    buffer_store_dwordx4 v[124:127], v212, s[16:19], s25 offen sc1
L_next1:
    s_cmp_lg_u32 s10, 0
    s_cbranch_scc1 L_pub1
    s_cmp_ge_u32 s42, 1696
    s_cbranch_scc1 L_w0_p1
    s_cmp_ge_u32 s42, 672
    s_cbranch_scc1 L_w8_p1
    s_waitcnt vmcnt(32)
    s_branch L_wd_p1
L_w8_p1:
    s_waitcnt vmcnt(24)
    s_branch L_wd_p1
L_w0_p1:
    s_waitcnt vmcnt(16)
L_wd_p1:
    v_add_u32 v221, 512, v221
    v_mov_b32 v213, s41
    s_mov_b64 exec, 1
    ds_write_b32 v213, v221 offset:12288
    s_mov_b64 exec, -1
L_pub1:
    s_waitcnt lgkmcnt(0)
    s_barrier
    v_mov_b32 v213, s41
    ds_read_b32 v214, v213 offset:12288
    s_xor_b32 s41, s41, 4
    s_mov_b32 s40, s42
    s_waitcnt lgkmcnt(0)
    v_readfirstlane_b32 s42, v214
    s_cmp_ge_u32 s40, 1696
    s_cbranch_scc1 L_k12_fin
    s_branch L_k12_loop
L_k12_fin:
L_k12_end:
    s_endpgm
.globl gemm_kernel
.p2align 8
.type gemm_kernel,@function
gemm_kernel:
    s_cmp_ge_u32 s2, 256
    s_cbranch_scc1 L_k3_end
    s_load_dwordx2 s[8:9], s[0:1], 48
    v_lshrrev_b32 v253, 6, v0
    v_and_b32 v0, 63, v0
    v_readfirstlane_b32 s10, v253
    s_cmp_ge_u32 s2, 8
    s_cbranch_scc1 L_nopf3
    s_nop 1
    s_cmp_lg_u32 s10, 7
    s_cbranch_scc1 L_nopf3
    s_getpc_b64 s[60:61]
L_pf_k3:
    s_sub_u32 s60, s60, L_pf_k3-gemm_kernel
    s_subb_u32 s61, s61, 0
    v_mbcnt_lo_u32_b32 v12, -1, 0
    v_mbcnt_hi_u32_b32 v12, -1, v12
    v_lshlrev_b32 v12, 6, v12
    v_add_u32 v13, 0, v12
    v_min_u32 v13, final_kernel-gemm_kernel-4, v13
    v_mov_b32 v15, s61
    v_add_co_u32 v14, vcc, s60, v13
    s_nop 1
    v_addc_co_u32 v15, vcc, 0, v15, vcc
    global_load_dword v16, v[14:15], off
    v_add_u32 v13, 4096, v12
    v_min_u32 v13, final_kernel-gemm_kernel-4, v13
    v_mov_b32 v15, s61
    v_add_co_u32 v14, vcc, s60, v13
    s_nop 1
    v_addc_co_u32 v15, vcc, 0, v15, vcc
    global_load_dword v16, v[14:15], off
    v_add_u32 v13, 8192, v12
    v_min_u32 v13, final_kernel-gemm_kernel-4, v13
    v_mov_b32 v15, s61
    v_add_co_u32 v14, vcc, s60, v13
    s_nop 1
    v_addc_co_u32 v15, vcc, 0, v15, vcc
    global_load_dword v16, v[14:15], off
    v_add_u32 v13, 12288, v12
    v_min_u32 v13, final_kernel-gemm_kernel-4, v13
    v_mov_b32 v15, s61
    v_add_co_u32 v14, vcc, s60, v13
    s_nop 1
    v_addc_co_u32 v15, vcc, 0, v15, vcc
    global_load_dword v16, v[14:15], off
L_nopf3:
    s_and_b32 s11, s2, 7
    s_lshr_b32 s12, s2, 3
    s_lshr_b32 s13, s12, 3
    s_lshl_b32 s11, s11, 2
    s_add_u32 s11, s11, s13
    s_bfe_u32 s13, s12, 0x10002
    s_and_b32 s14, s12, 3
    s_and_b32 s15, s10, 3
    s_waitcnt lgkmcnt(0)
    s_mov_b32 s16, s8
    s_and_b32 s17, s9, 0xffff
    s_mov_b32 s18, 268435456
    s_mov_b32 s19, 0x00020000
    s_cmp_ge_u32 s10, 4
    s_cbranch_scc1 L_k3_helper
    v_lshrrev_b32 v253, 4, v0
    v_and_b32 v254, 15, v0
    v_bfe_u32 v255, v254, 3, 1
    v_mul_u32_u24 v255, 3, v255
    v_xor_b32 v255, v255, v253
    v_lshlrev_b32 v255, 4, v255
    v_lshl_add_u32 v250, v254, 6, v255
    v_lshrrev_b32 v255, 2, v254
    v_and_b32 v216, 1, v253
    v_lshl_or_b32 v216, v216, 2, v255
    v_lshl_add_u32 v255, v253, 3, v255
    v_lshlrev_b32 v255, 8, v255
    v_and_b32 v217, 3, v254
    v_lshl_add_u32 v255, v217, 3, v255
    s_lshl_b32 s20, s15, 1
    s_add_u32 s20, s20, s13
    v_xor_b32 v217, s20, v216
    v_lshl_add_u32 v248, v217, 5, v255
    s_xor_b32 s20, s20, 1
    v_xor_b32 v217, s20, v216
    v_lshl_add_u32 v249, v217, 5, v255
    s_mov_b32 s21, 65792
    v_mul_u32_u24 v251, s21, v254
    v_lshl_add_u32 v251, v253, 4, v251
    s_lshl_b32 s23, s15, 6
    v_add_u32 v251, s23, v251
    v_and_b32 v255, 7, v254
    v_mul_u32_u24 v252, s21, v255
    v_lshrrev_b32 v216, 3, v254
    v_xor_b32 v216, s13, v216
    s_mov_b32 s22, 11579392
    v_mul_lo_u32 v216, v216, s22
    v_add_u32 v252, v252, v216
    v_lshl_add_u32 v252, v253, 4, v252
    s_lshl_b32 s22, s13, 3
    s_add_u32 s22, s22, s23
    v_add_u32 v252, s22, v252
    v_cmp_gt_u32 vcc, 7, v255
    v_mov_b32 v216, 0x80000000
    s_nop 0
    v_cndmask_b32 v252, v216, v252, vcc
    s_mul_i32 s48, s11, 2048
    s_lshl_b32 s20, s14, 8
    s_add_u32 s48, s48, s20
    s_add_u32 s48, s48, 117440512
    s_add_u32 s49, s48, 10526720
    s_mul_i32 s20, s13, 11579392
    s_add_u32 s48, s48, s20
    v_mov_b32 v0, 0
    v_mov_b32 v1, 0
    v_mov_b32 v2, 0
    v_mov_b32 v3, 0
    v_mov_b32 v4, 0
    v_mov_b32 v5, 0
    v_mov_b32 v6, 0
    v_mov_b32 v7, 0
    v_mov_b32 v8, 0
    v_mov_b32 v9, 0
    v_mov_b32 v10, 0
    v_mov_b32 v11, 0
    v_mov_b32 v12, 0
    v_mov_b32 v13, 0
    v_mov_b32 v14, 0
    v_mov_b32 v15, 0
    v_mov_b32 v16, 0
    v_mov_b32 v17, 0
    v_mov_b32 v18, 0
    v_mov_b32 v19, 0
    v_mov_b32 v20, 0
    v_mov_b32 v21, 0
    v_mov_b32 v22, 0
    v_mov_b32 v23, 0
    v_mov_b32 v24, 0
    v_mov_b32 v25, 0
    v_mov_b32 v26, 0
    v_mov_b32 v27, 0
    v_mov_b32 v28, 0
    v_mov_b32 v29, 0
    v_mov_b32 v30, 0
    v_mov_b32 v31, 0
    v_mov_b32 v32, 0
    v_mov_b32 v33, 0
    v_mov_b32 v34, 0
    v_mov_b32 v35, 0
    v_mov_b32 v36, 0
    v_mov_b32 v37, 0
    v_mov_b32 v38, 0
    v_mov_b32 v39, 0
    v_mov_b32 v40, 0
    v_mov_b32 v41, 0
    v_mov_b32 v42, 0
    v_mov_b32 v43, 0
    v_mov_b32 v44, 0
    v_mov_b32 v45, 0
    v_mov_b32 v46, 0
    v_mov_b32 v47, 0
    v_mov_b32 v48, 0
    v_mov_b32 v49, 0
    v_mov_b32 v50, 0
    v_mov_b32 v51, 0
    v_mov_b32 v52, 0
    v_mov_b32 v53, 0
    v_mov_b32 v54, 0
    v_mov_b32 v55, 0
    v_mov_b32 v56, 0
    v_mov_b32 v57, 0
    v_mov_b32 v58, 0
    v_mov_b32 v59, 0
    v_mov_b32 v60, 0
    v_mov_b32 v61, 0
    v_mov_b32 v62, 0
    v_mov_b32 v63, 0
    v_mov_b32 v64, 0
    v_mov_b32 v65, 0
    v_mov_b32 v66, 0
    v_mov_b32 v67, 0
    v_mov_b32 v68, 0
    v_mov_b32 v69, 0
    v_mov_b32 v70, 0
    v_mov_b32 v71, 0
    v_mov_b32 v72, 0
    v_mov_b32 v73, 0
    v_mov_b32 v74, 0
    v_mov_b32 v75, 0
    v_mov_b32 v76, 0
    v_mov_b32 v77, 0
    v_mov_b32 v78, 0
    v_mov_b32 v79, 0
    v_mov_b32 v80, 0
    v_mov_b32 v81, 0
    v_mov_b32 v82, 0
    v_mov_b32 v83, 0
    v_mov_b32 v84, 0
    v_mov_b32 v85, 0
    v_mov_b32 v86, 0
    v_mov_b32 v87, 0
    v_mov_b32 v88, 0
    v_mov_b32 v89, 0
    v_mov_b32 v90, 0
    v_mov_b32 v91, 0
    v_mov_b32 v92, 0
    v_mov_b32 v93, 0
    v_mov_b32 v94, 0
    v_mov_b32 v95, 0
    v_mov_b32 v96, 0
    v_mov_b32 v97, 0
    v_mov_b32 v98, 0
    v_mov_b32 v99, 0
    v_mov_b32 v100, 0
    v_mov_b32 v101, 0
    v_mov_b32 v102, 0
    v_mov_b32 v103, 0
    v_mov_b32 v104, 0
    v_mov_b32 v105, 0
    v_mov_b32 v106, 0
    v_mov_b32 v107, 0
    v_mov_b32 v108, 0
    v_mov_b32 v109, 0
    v_mov_b32 v110, 0
    v_mov_b32 v111, 0
    v_mov_b32 v112, 0
    v_mov_b32 v113, 0
    v_mov_b32 v114, 0
    v_mov_b32 v115, 0
    v_mov_b32 v116, 0
    v_mov_b32 v117, 0
    v_mov_b32 v118, 0
    v_mov_b32 v119, 0
    v_mov_b32 v120, 0
    v_mov_b32 v121, 0
    v_mov_b32 v122, 0
    v_mov_b32 v123, 0
    v_mov_b32 v124, 0
    v_mov_b32 v125, 0
    v_mov_b32 v126, 0
    v_mov_b32 v127, 0
    v_mov_b32 v128, 0
    v_mov_b32 v129, 0
    v_mov_b32 v130, 0
    v_mov_b32 v131, 0
    v_mov_b32 v132, 0
    v_mov_b32 v133, 0
    v_mov_b32 v134, 0
    v_mov_b32 v135, 0
    v_mov_b32 v136, 0
    v_mov_b32 v137, 0
    v_mov_b32 v138, 0
    v_mov_b32 v139, 0
    v_mov_b32 v140, 0
    v_mov_b32 v141, 0
    v_mov_b32 v142, 0
    v_mov_b32 v143, 0
    v_mov_b32 v144, 0
    v_mov_b32 v145, 0
    v_mov_b32 v146, 0
    v_mov_b32 v147, 0
    v_mov_b32 v148, 0
    v_mov_b32 v149, 0
    v_mov_b32 v150, 0
    v_mov_b32 v151, 0
    v_mov_b32 v152, 0
    v_mov_b32 v153, 0
    v_mov_b32 v154, 0
    v_mov_b32 v155, 0
    v_mov_b32 v156, 0
    v_mov_b32 v157, 0
    v_mov_b32 v158, 0
    v_mov_b32 v159, 0
    v_mov_b32 v160, 0
    v_mov_b32 v161, 0
    v_mov_b32 v162, 0
    v_mov_b32 v163, 0
    v_mov_b32 v164, 0
    v_mov_b32 v165, 0
    v_mov_b32 v166, 0
    v_mov_b32 v167, 0
    s_barrier
    ds_read_b64_tr_b16 v[176:177], v248 offset:0
    ds_read_b64_tr_b16 v[178:179], v248 offset:1024
    ds_read_b64_tr_b16 v[180:181], v249 offset:0
    ds_read_b64_tr_b16 v[182:183], v249 offset:1024
    ds_read_b64_tr_b16 v[184:185], v248 offset:8192
    ds_read_b64_tr_b16 v[186:187], v248 offset:9216
    ds_read_b64_tr_b16 v[188:189], v249 offset:8192
    ds_read_b64_tr_b16 v[190:191], v249 offset:9216
    ds_read_b128 v[216:219], v250 offset:16384
    ds_read_b128 v[220:223], v250 offset:27648
    ds_read_b128 v[224:227], v250 offset:17408
    ds_read_b128 v[228:231], v250 offset:28672
    s_waitcnt lgkmcnt(4)
    v_xor_b32 v208, 0x80008000, v184
    v_xor_b32 v209, 0x80008000, v185
    v_xor_b32 v210, 0x80008000, v186
    v_xor_b32 v211, 0x80008000, v187
    v_xor_b32 v212, 0x80008000, v188
    v_xor_b32 v213, 0x80008000, v189
    v_xor_b32 v214, 0x80008000, v190
    v_xor_b32 v215, 0x80008000, v191
    s_mov_b32 s46, 7
L_g_loop:
    s_barrier
    s_waitcnt lgkmcnt(2)
    v_mfma_f32_16x16x32_bf16 v[0:3], v[176:179], v[216:219], v[0:3]
    ds_read_b128 v[232:235], v250 offset:18432
    ds_read_b128 v[236:239], v250 offset:29696
    v_mfma_f32_16x16x32_bf16 v[4:7], v[180:183], v[216:219], v[4:7]
    v_mfma_f32_16x16x32_bf16 v[8:11], v[208:211], v[216:219], v[8:11]
    v_mfma_f32_16x16x32_bf16 v[12:15], v[212:215], v[216:219], v[12:15]
    v_mfma_f32_16x16x32_bf16 v[0:3], v[184:187], v[220:223], v[0:3]
    v_mfma_f32_16x16x32_bf16 v[4:7], v[188:191], v[220:223], v[4:7]
    v_mfma_f32_16x16x32_bf16 v[8:11], v[176:179], v[220:223], v[8:11]
    v_mfma_f32_16x16x32_bf16 v[12:15], v[180:183], v[220:223], v[12:15]
    s_waitcnt lgkmcnt(2)
    v_mfma_f32_16x16x32_bf16 v[16:19], v[176:179], v[224:227], v[16:19]
    ds_read_b128 v[240:243], v250 offset:19456
    ds_read_b128 v[244:247], v250 offset:30720
    v_mfma_f32_16x16x32_bf16 v[20:23], v[180:183], v[224:227], v[20:23]
    v_mfma_f32_16x16x32_bf16 v[24:27], v[208:211], v[224:227], v[24:27]
    v_mfma_f32_16x16x32_bf16 v[28:31], v[212:215], v[224:227], v[28:31]
    v_mfma_f32_16x16x32_bf16 v[16:19], v[184:187], v[228:231], v[16:19]
    v_mfma_f32_16x16x32_bf16 v[20:23], v[188:191], v[228:231], v[20:23]
    v_mfma_f32_16x16x32_bf16 v[24:27], v[176:179], v[228:231], v[24:27]
    v_mfma_f32_16x16x32_bf16 v[28:31], v[180:183], v[228:231], v[28:31]
    s_waitcnt lgkmcnt(2)
    v_mfma_f32_16x16x32_bf16 v[32:35], v[176:179], v[232:235], v[32:35]
    ds_read_b128 v[216:219], v250 offset:20480
    ds_read_b128 v[220:223], v250 offset:31744
    v_mfma_f32_16x16x32_bf16 v[36:39], v[180:183], v[232:235], v[36:39]
    v_mfma_f32_16x16x32_bf16 v[40:43], v[208:211], v[232:235], v[40:43]
    v_mfma_f32_16x16x32_bf16 v[44:47], v[212:215], v[232:235], v[44:47]
    v_mfma_f32_16x16x32_bf16 v[32:35], v[184:187], v[236:239], v[32:35]
    v_mfma_f32_16x16x32_bf16 v[36:39], v[188:191], v[236:239], v[36:39]
    v_mfma_f32_16x16x32_bf16 v[40:43], v[176:179], v[236:239], v[40:43]
    v_mfma_f32_16x16x32_bf16 v[44:47], v[180:183], v[236:239], v[44:47]
    s_waitcnt lgkmcnt(2)
    v_mfma_f32_16x16x32_bf16 v[48:51], v[176:179], v[240:243], v[48:51]
    ds_read_b128 v[224:227], v250 offset:21504
    ds_read_b128 v[228:231], v250 offset:32768
    v_mfma_f32_16x16x32_bf16 v[52:55], v[180:183], v[240:243], v[52:55]
    v_mfma_f32_16x16x32_bf16 v[56:59], v[208:211], v[240:243], v[56:59]
    v_mfma_f32_16x16x32_bf16 v[60:63], v[212:215], v[240:243], v[60:63]
    v_mfma_f32_16x16x32_bf16 v[48:51], v[184:187], v[244:247], v[48:51]
    v_mfma_f32_16x16x32_bf16 v[52:55], v[188:191], v[244:247], v[52:55]
    v_mfma_f32_16x16x32_bf16 v[56:59], v[176:179], v[244:247], v[56:59]
    v_mfma_f32_16x16x32_bf16 v[60:63], v[180:183], v[244:247], v[60:63]
    s_waitcnt lgkmcnt(2)
    v_mfma_f32_16x16x32_bf16 v[64:67], v[176:179], v[216:219], v[64:67]
    ds_read_b128 v[232:235], v250 offset:22528
    ds_read_b128 v[236:239], v250 offset:33792
    v_mfma_f32_16x16x32_bf16 v[68:71], v[180:183], v[216:219], v[68:71]
    v_mfma_f32_16x16x32_bf16 v[72:75], v[208:211], v[216:219], v[72:75]
    v_mfma_f32_16x16x32_bf16 v[76:79], v[212:215], v[216:219], v[76:79]
    v_mfma_f32_16x16x32_bf16 v[64:67], v[184:187], v[220:223], v[64:67]
    v_mfma_f32_16x16x32_bf16 v[68:71], v[188:191], v[220:223], v[68:71]
    v_mfma_f32_16x16x32_bf16 v[72:75], v[176:179], v[220:223], v[72:75]
    v_mfma_f32_16x16x32_bf16 v[76:79], v[180:183], v[220:223], v[76:79]
    s_waitcnt lgkmcnt(2)
    v_mfma_f32_16x16x32_bf16 v[80:83], v[176:179], v[224:227], v[80:83]
    ds_read_b128 v[240:243], v250 offset:23552
    ds_read_b128 v[244:247], v250 offset:34816
    v_mfma_f32_16x16x32_bf16 v[84:87], v[180:183], v[224:227], v[84:87]
    v_mfma_f32_16x16x32_bf16 v[88:91], v[208:211], v[224:227], v[88:91]
    v_mfma_f32_16x16x32_bf16 v[92:95], v[212:215], v[224:227], v[92:95]
    v_mfma_f32_16x16x32_bf16 v[80:83], v[184:187], v[228:231], v[80:83]
    v_add_u32 v248, 0x9800, v248
    v_add_u32 v249, 0x9800, v249
    v_mfma_f32_16x16x32_bf16 v[84:87], v[188:191], v[228:231], v[84:87]
    v_mfma_f32_16x16x32_bf16 v[88:91], v[176:179], v[228:231], v[88:91]
    v_mfma_f32_16x16x32_bf16 v[92:95], v[180:183], v[228:231], v[92:95]
    s_waitcnt lgkmcnt(2)
    v_mfma_f32_16x16x32_bf16 v[96:99], v[176:179], v[232:235], v[96:99]
    ds_read_b128 v[216:219], v250 offset:24576
    ds_read_b128 v[220:223], v250 offset:35840
    v_mfma_f32_16x16x32_bf16 v[100:103], v[180:183], v[232:235], v[100:103]
    v_mfma_f32_16x16x32_bf16 v[104:107], v[208:211], v[232:235], v[104:107]
    v_mfma_f32_16x16x32_bf16 v[108:111], v[212:215], v[232:235], v[108:111]
    ds_read_b64_tr_b16 v[192:193], v248 offset:0
    ds_read_b64_tr_b16 v[194:195], v248 offset:1024
    ds_read_b64_tr_b16 v[196:197], v249 offset:0
    ds_read_b64_tr_b16 v[198:199], v249 offset:1024
    v_mfma_f32_16x16x32_bf16 v[96:99], v[184:187], v[236:239], v[96:99]
    v_mfma_f32_16x16x32_bf16 v[100:103], v[188:191], v[236:239], v[100:103]
    v_mfma_f32_16x16x32_bf16 v[104:107], v[176:179], v[236:239], v[104:107]
    v_mfma_f32_16x16x32_bf16 v[108:111], v[180:183], v[236:239], v[108:111]
    s_waitcnt lgkmcnt(6)
    v_mfma_f32_16x16x32_bf16 v[112:115], v[176:179], v[240:243], v[112:115]
    ds_read_b128 v[224:227], v250 offset:25600
    ds_read_b128 v[228:231], v250 offset:36864
    v_mfma_f32_16x16x32_bf16 v[116:119], v[180:183], v[240:243], v[116:119]
    v_mfma_f32_16x16x32_bf16 v[120:123], v[208:211], v[240:243], v[120:123]
    v_mfma_f32_16x16x32_bf16 v[124:127], v[212:215], v[240:243], v[124:127]
    ds_read_b64_tr_b16 v[200:201], v248 offset:8192
    ds_read_b64_tr_b16 v[202:203], v248 offset:9216
    ds_read_b64_tr_b16 v[204:205], v249 offset:8192
    ds_read_b64_tr_b16 v[206:207], v249 offset:9216
    v_mfma_f32_16x16x32_bf16 v[112:115], v[184:187], v[244:247], v[112:115]
    v_mfma_f32_16x16x32_bf16 v[116:119], v[188:191], v[244:247], v[116:119]
    v_mfma_f32_16x16x32_bf16 v[120:123], v[176:179], v[244:247], v[120:123]
    v_mfma_f32_16x16x32_bf16 v[124:127], v[180:183], v[244:247], v[124:127]
    s_waitcnt lgkmcnt(10)
    v_mfma_f32_16x16x32_bf16 v[128:131], v[176:179], v[216:219], v[128:131]
    ds_read_b128 v[232:235], v250 offset:26624
    ds_read_b128 v[236:239], v250 offset:37888
    v_mfma_f32_16x16x32_bf16 v[132:135], v[180:183], v[216:219], v[132:135]
    v_mfma_f32_16x16x32_bf16 v[136:139], v[208:211], v[216:219], v[136:139]
    v_mfma_f32_16x16x32_bf16 v[140:143], v[212:215], v[216:219], v[140:143]
    v_mfma_f32_16x16x32_bf16 v[128:131], v[184:187], v[220:223], v[128:131]
    v_mfma_f32_16x16x32_bf16 v[132:135], v[188:191], v[220:223], v[132:135]
    v_mfma_f32_16x16x32_bf16 v[136:139], v[176:179], v[220:223], v[136:139]
    v_mfma_f32_16x16x32_bf16 v[140:143], v[180:183], v[220:223], v[140:143]
    s_waitcnt lgkmcnt(6)
    v_mfma_f32_16x16x32_bf16 v[144:147], v[176:179], v[224:227], v[144:147]
    v_add_u32 v250, 0x9800, v250
    ds_read_b128 v[240:243], v250 offset:16384
    ds_read_b128 v[244:247], v250 offset:27648
    v_mfma_f32_16x16x32_bf16 v[148:151], v[180:183], v[224:227], v[148:151]
    v_mfma_f32_16x16x32_bf16 v[152:155], v[208:211], v[224:227], v[152:155]
    v_mfma_f32_16x16x32_bf16 v[156:159], v[212:215], v[224:227], v[156:159]
    v_mfma_f32_16x16x32_bf16 v[144:147], v[184:187], v[228:231], v[144:147]
    s_waitcnt lgkmcnt(4)
    v_xor_b32 v212, 0x80008000, v204
    v_xor_b32 v213, 0x80008000, v205
    v_mfma_f32_16x16x32_bf16 v[148:151], v[188:191], v[228:231], v[148:151]
    v_xor_b32 v214, 0x80008000, v206
    v_xor_b32 v215, 0x80008000, v207
    v_mfma_f32_16x16x32_bf16 v[152:155], v[176:179], v[228:231], v[152:155]
    v_mfma_f32_16x16x32_bf16 v[156:159], v[180:183], v[228:231], v[156:159]
    s_waitcnt lgkmcnt(2)
    v_mfma_f32_16x16x32_bf16 v[160:163], v[176:179], v[232:235], v[160:163]
    ds_read_b128 v[216:219], v250 offset:17408
    ds_read_b128 v[220:223], v250 offset:28672
    v_mfma_f32_16x16x32_bf16 v[164:167], v[208:211], v[232:235], v[164:167]
    v_xor_b32 v208, 0x80008000, v200
    v_xor_b32 v209, 0x80008000, v201
    v_mfma_f32_16x16x32_bf16 v[160:163], v[184:187], v[236:239], v[160:163]
    v_xor_b32 v210, 0x80008000, v202
    v_xor_b32 v211, 0x80008000, v203
    v_mfma_f32_16x16x32_bf16 v[164:167], v[176:179], v[236:239], v[164:167]
    s_barrier
    s_waitcnt lgkmcnt(2)
    v_mfma_f32_16x16x32_bf16 v[0:3], v[192:195], v[240:243], v[0:3]
    ds_read_b128 v[224:227], v250 offset:18432
    ds_read_b128 v[228:231], v250 offset:29696
    v_mfma_f32_16x16x32_bf16 v[4:7], v[196:199], v[240:243], v[4:7]
    v_mfma_f32_16x16x32_bf16 v[8:11], v[208:211], v[240:243], v[8:11]
    v_mfma_f32_16x16x32_bf16 v[12:15], v[212:215], v[240:243], v[12:15]
    v_mfma_f32_16x16x32_bf16 v[0:3], v[200:203], v[244:247], v[0:3]
    v_mfma_f32_16x16x32_bf16 v[4:7], v[204:207], v[244:247], v[4:7]
    v_mfma_f32_16x16x32_bf16 v[8:11], v[192:195], v[244:247], v[8:11]
    v_mfma_f32_16x16x32_bf16 v[12:15], v[196:199], v[244:247], v[12:15]
    s_waitcnt lgkmcnt(2)
    v_mfma_f32_16x16x32_bf16 v[16:19], v[192:195], v[216:219], v[16:19]
    ds_read_b128 v[232:235], v250 offset:19456
    ds_read_b128 v[236:239], v250 offset:30720
    v_mfma_f32_16x16x32_bf16 v[20:23], v[196:199], v[216:219], v[20:23]
    v_mfma_f32_16x16x32_bf16 v[24:27], v[208:211], v[216:219], v[24:27]
    v_mfma_f32_16x16x32_bf16 v[28:31], v[212:215], v[216:219], v[28:31]
    v_mfma_f32_16x16x32_bf16 v[16:19], v[200:203], v[220:223], v[16:19]
    v_mfma_f32_16x16x32_bf16 v[20:23], v[204:207], v[220:223], v[20:23]
    v_mfma_f32_16x16x32_bf16 v[24:27], v[192:195], v[220:223], v[24:27]
    v_mfma_f32_16x16x32_bf16 v[28:31], v[196:199], v[220:223], v[28:31]
    s_waitcnt lgkmcnt(2)
    v_mfma_f32_16x16x32_bf16 v[32:35], v[192:195], v[224:227], v[32:35]
    ds_read_b128 v[240:243], v250 offset:20480
    ds_read_b128 v[244:247], v250 offset:31744
    v_mfma_f32_16x16x32_bf16 v[36:39], v[196:199], v[224:227], v[36:39]
    v_mfma_f32_16x16x32_bf16 v[40:43], v[208:211], v[224:227], v[40:43]
    v_mfma_f32_16x16x32_bf16 v[44:47], v[212:215], v[224:227], v[44:47]
    v_mfma_f32_16x16x32_bf16 v[32:35], v[200:203], v[228:231], v[32:35]
    v_mfma_f32_16x16x32_bf16 v[36:39], v[204:207], v[228:231], v[36:39]
    v_mfma_f32_16x16x32_bf16 v[40:43], v[192:195], v[228:231], v[40:43]
    v_mfma_f32_16x16x32_bf16 v[44:47], v[196:199], v[228:231], v[44:47]
    s_waitcnt lgkmcnt(2)
    v_mfma_f32_16x16x32_bf16 v[48:51], v[192:195], v[232:235], v[48:51]
    ds_read_b128 v[216:219], v250 offset:21504
    ds_read_b128 v[220:223], v250 offset:32768
    v_mfma_f32_16x16x32_bf16 v[52:55], v[196:199], v[232:235], v[52:55]
    v_mfma_f32_16x16x32_bf16 v[56:59], v[208:211], v[232:235], v[56:59]
    v_mfma_f32_16x16x32_bf16 v[60:63], v[212:215], v[232:235], v[60:63]
    v_mfma_f32_16x16x32_bf16 v[48:51], v[200:203], v[236:239], v[48:51]
    v_mfma_f32_16x16x32_bf16 v[52:55], v[204:207], v[236:239], v[52:55]
    v_mfma_f32_16x16x32_bf16 v[56:59], v[192:195], v[236:239], v[56:59]
    v_mfma_f32_16x16x32_bf16 v[60:63], v[196:199], v[236:239], v[60:63]
    s_waitcnt lgkmcnt(2)
    v_mfma_f32_16x16x32_bf16 v[64:67], v[192:195], v[240:243], v[64:67]
    ds_read_b128 v[224:227], v250 offset:22528
    ds_read_b128 v[228:231], v250 offset:33792
    v_mfma_f32_16x16x32_bf16 v[68:71], v[196:199], v[240:243], v[68:71]
    v_mfma_f32_16x16x32_bf16 v[72:75], v[208:211], v[240:243], v[72:75]
    v_mfma_f32_16x16x32_bf16 v[76:79], v[212:215], v[240:243], v[76:79]
    v_mfma_f32_16x16x32_bf16 v[64:67], v[200:203], v[244:247], v[64:67]
    v_mfma_f32_16x16x32_bf16 v[68:71], v[204:207], v[244:247], v[68:71]
    v_mfma_f32_16x16x32_bf16 v[72:75], v[192:195], v[244:247], v[72:75]
    v_mfma_f32_16x16x32_bf16 v[76:79], v[196:199], v[244:247], v[76:79]
    s_waitcnt lgkmcnt(2)
    v_mfma_f32_16x16x32_bf16 v[80:83], v[192:195], v[216:219], v[80:83]
    ds_read_b128 v[232:235], v250 offset:23552
    ds_read_b128 v[236:239], v250 offset:34816
    v_mfma_f32_16x16x32_bf16 v[84:87], v[196:199], v[216:219], v[84:87]
    v_mfma_f32_16x16x32_bf16 v[88:91], v[208:211], v[216:219], v[88:91]
    v_mfma_f32_16x16x32_bf16 v[92:95], v[212:215], v[216:219], v[92:95]
    v_mfma_f32_16x16x32_bf16 v[80:83], v[200:203], v[220:223], v[80:83]
    v_add_u32 v248, 0x9800, v248
    v_add_u32 v249, 0x9800, v249
    v_mfma_f32_16x16x32_bf16 v[84:87], v[204:207], v[220:223], v[84:87]
    v_mfma_f32_16x16x32_bf16 v[88:91], v[192:195], v[220:223], v[88:91]
    v_mfma_f32_16x16x32_bf16 v[92:95], v[196:199], v[220:223], v[92:95]
    s_waitcnt lgkmcnt(2)
    v_mfma_f32_16x16x32_bf16 v[96:99], v[192:195], v[224:227], v[96:99]
    ds_read_b128 v[240:243], v250 offset:24576
    ds_read_b128 v[244:247], v250 offset:35840
    v_mfma_f32_16x16x32_bf16 v[100:103], v[196:199], v[224:227], v[100:103]
    v_mfma_f32_16x16x32_bf16 v[104:107], v[208:211], v[224:227], v[104:107]
    v_mfma_f32_16x16x32_bf16 v[108:111], v[212:215], v[224:227], v[108:111]
    ds_read_b64_tr_b16 v[176:177], v248 offset:0
    ds_read_b64_tr_b16 v[178:179], v248 offset:1024
    ds_read_b64_tr_b16 v[180:181], v249 offset:0
    ds_read_b64_tr_b16 v[182:183], v249 offset:1024
    v_mfma_f32_16x16x32_bf16 v[96:99], v[200:203], v[228:231], v[96:99]
    v_mfma_f32_16x16x32_bf16 v[100:103], v[204:207], v[228:231], v[100:103]
    v_mfma_f32_16x16x32_bf16 v[104:107], v[192:195], v[228:231], v[104:107]
    v_mfma_f32_16x16x32_bf16 v[108:111], v[196:199], v[228:231], v[108:111]
    s_waitcnt lgkmcnt(6)
    v_mfma_f32_16x16x32_bf16 v[112:115], v[192:195], v[232:235], v[112:115]
    ds_read_b128 v[216:219], v250 offset:25600
    ds_read_b128 v[220:223], v250 offset:36864
    v_mfma_f32_16x16x32_bf16 v[116:119], v[196:199], v[232:235], v[116:119]
    v_mfma_f32_16x16x32_bf16 v[120:123], v[208:211], v[232:235], v[120:123]
    v_mfma_f32_16x16x32_bf16 v[124:127], v[212:215], v[232:235], v[124:127]
    ds_read_b64_tr_b16 v[184:185], v248 offset:8192
    ds_read_b64_tr_b16 v[186:187], v248 offset:9216
    ds_read_b64_tr_b16 v[188:189], v249 offset:8192
    ds_read_b64_tr_b16 v[190:191], v249 offset:9216
    v_mfma_f32_16x16x32_bf16 v[112:115], v[200:203], v[236:239], v[112:115]
    v_mfma_f32_16x16x32_bf16 v[116:119], v[204:207], v[236:239], v[116:119]
    v_mfma_f32_16x16x32_bf16 v[120:123], v[192:195], v[236:239], v[120:123]
    v_mfma_f32_16x16x32_bf16 v[124:127], v[196:199], v[236:239], v[124:127]
    s_waitcnt lgkmcnt(10)
    v_mfma_f32_16x16x32_bf16 v[128:131], v[192:195], v[240:243], v[128:131]
    ds_read_b128 v[224:227], v250 offset:26624
    ds_read_b128 v[228:231], v250 offset:37888
    v_mfma_f32_16x16x32_bf16 v[132:135], v[196:199], v[240:243], v[132:135]
    v_mfma_f32_16x16x32_bf16 v[136:139], v[208:211], v[240:243], v[136:139]
    v_mfma_f32_16x16x32_bf16 v[140:143], v[212:215], v[240:243], v[140:143]
    v_mfma_f32_16x16x32_bf16 v[128:131], v[200:203], v[244:247], v[128:131]
    v_mfma_f32_16x16x32_bf16 v[132:135], v[204:207], v[244:247], v[132:135]
    v_mfma_f32_16x16x32_bf16 v[136:139], v[192:195], v[244:247], v[136:139]
    v_mfma_f32_16x16x32_bf16 v[140:143], v[196:199], v[244:247], v[140:143]
    s_waitcnt lgkmcnt(6)
    v_mfma_f32_16x16x32_bf16 v[144:147], v[192:195], v[216:219], v[144:147]
    v_add_u32 v250, 0x9800, v250
    ds_read_b128 v[232:235], v250 offset:16384
    ds_read_b128 v[236:239], v250 offset:27648
    v_mfma_f32_16x16x32_bf16 v[148:151], v[196:199], v[216:219], v[148:151]
    v_mfma_f32_16x16x32_bf16 v[152:155], v[208:211], v[216:219], v[152:155]
    v_mfma_f32_16x16x32_bf16 v[156:159], v[212:215], v[216:219], v[156:159]
    v_mfma_f32_16x16x32_bf16 v[144:147], v[200:203], v[220:223], v[144:147]
    s_waitcnt lgkmcnt(4)
    v_xor_b32 v212, 0x80008000, v188
    v_xor_b32 v213, 0x80008000, v189
    v_mfma_f32_16x16x32_bf16 v[148:151], v[204:207], v[220:223], v[148:151]
    v_xor_b32 v214, 0x80008000, v190
    v_xor_b32 v215, 0x80008000, v191
    v_mfma_f32_16x16x32_bf16 v[152:155], v[192:195], v[220:223], v[152:155]
    v_mfma_f32_16x16x32_bf16 v[156:159], v[196:199], v[220:223], v[156:159]
    s_waitcnt lgkmcnt(2)
    v_mfma_f32_16x16x32_bf16 v[160:163], v[192:195], v[224:227], v[160:163]
    ds_read_b128 v[240:243], v250 offset:17408
    ds_read_b128 v[244:247], v250 offset:28672
    v_mfma_f32_16x16x32_bf16 v[164:167], v[208:211], v[224:227], v[164:167]
    v_xor_b32 v208, 0x80008000, v184
    v_xor_b32 v209, 0x80008000, v185
    v_mfma_f32_16x16x32_bf16 v[160:163], v[200:203], v[228:231], v[160:163]
    v_xor_b32 v210, 0x80008000, v186
    v_xor_b32 v211, 0x80008000, v187
    v_mfma_f32_16x16x32_bf16 v[164:167], v[192:195], v[228:231], v[164:167]
    s_barrier
    s_waitcnt lgkmcnt(2)
    v_mfma_f32_16x16x32_bf16 v[0:3], v[176:179], v[232:235], v[0:3]
    ds_read_b128 v[216:219], v250 offset:18432
    ds_read_b128 v[220:223], v250 offset:29696
    v_mfma_f32_16x16x32_bf16 v[4:7], v[180:183], v[232:235], v[4:7]
    v_mfma_f32_16x16x32_bf16 v[8:11], v[208:211], v[232:235], v[8:11]
    v_mfma_f32_16x16x32_bf16 v[12:15], v[212:215], v[232:235], v[12:15]
    v_mfma_f32_16x16x32_bf16 v[0:3], v[184:187], v[236:239], v[0:3]
    v_mfma_f32_16x16x32_bf16 v[4:7], v[188:191], v[236:239], v[4:7]
    v_mfma_f32_16x16x32_bf16 v[8:11], v[176:179], v[236:239], v[8:11]
    v_mfma_f32_16x16x32_bf16 v[12:15], v[180:183], v[236:239], v[12:15]
    s_waitcnt lgkmcnt(2)
    v_mfma_f32_16x16x32_bf16 v[16:19], v[176:179], v[240:243], v[16:19]
    ds_read_b128 v[224:227], v250 offset:19456
    ds_read_b128 v[228:231], v250 offset:30720
    v_mfma_f32_16x16x32_bf16 v[20:23], v[180:183], v[240:243], v[20:23]
    v_mfma_f32_16x16x32_bf16 v[24:27], v[208:211], v[240:243], v[24:27]
    v_mfma_f32_16x16x32_bf16 v[28:31], v[212:215], v[240:243], v[28:31]
    v_mfma_f32_16x16x32_bf16 v[16:19], v[184:187], v[244:247], v[16:19]
    v_mfma_f32_16x16x32_bf16 v[20:23], v[188:191], v[244:247], v[20:23]
    v_mfma_f32_16x16x32_bf16 v[24:27], v[176:179], v[244:247], v[24:27]
    v_mfma_f32_16x16x32_bf16 v[28:31], v[180:183], v[244:247], v[28:31]
    s_waitcnt lgkmcnt(2)
    v_mfma_f32_16x16x32_bf16 v[32:35], v[176:179], v[216:219], v[32:35]
    ds_read_b128 v[232:235], v250 offset:20480
    ds_read_b128 v[236:239], v250 offset:31744
    v_mfma_f32_16x16x32_bf16 v[36:39], v[180:183], v[216:219], v[36:39]
    v_mfma_f32_16x16x32_bf16 v[40:43], v[208:211], v[216:219], v[40:43]
    v_mfma_f32_16x16x32_bf16 v[44:47], v[212:215], v[216:219], v[44:47]
    v_mfma_f32_16x16x32_bf16 v[32:35], v[184:187], v[220:223], v[32:35]
    v_mfma_f32_16x16x32_bf16 v[36:39], v[188:191], v[220:223], v[36:39]
    v_mfma_f32_16x16x32_bf16 v[40:43], v[176:179], v[220:223], v[40:43]
    v_mfma_f32_16x16x32_bf16 v[44:47], v[180:183], v[220:223], v[44:47]
    s_waitcnt lgkmcnt(2)
    v_mfma_f32_16x16x32_bf16 v[48:51], v[176:179], v[224:227], v[48:51]
    ds_read_b128 v[240:243], v250 offset:21504
    ds_read_b128 v[244:247], v250 offset:32768
    v_mfma_f32_16x16x32_bf16 v[52:55], v[180:183], v[224:227], v[52:55]
    v_mfma_f32_16x16x32_bf16 v[56:59], v[208:211], v[224:227], v[56:59]
    v_mfma_f32_16x16x32_bf16 v[60:63], v[212:215], v[224:227], v[60:63]
    v_mfma_f32_16x16x32_bf16 v[48:51], v[184:187], v[228:231], v[48:51]
    v_mfma_f32_16x16x32_bf16 v[52:55], v[188:191], v[228:231], v[52:55]
    v_mfma_f32_16x16x32_bf16 v[56:59], v[176:179], v[228:231], v[56:59]
    v_mfma_f32_16x16x32_bf16 v[60:63], v[180:183], v[228:231], v[60:63]
    s_waitcnt lgkmcnt(2)
    v_mfma_f32_16x16x32_bf16 v[64:67], v[176:179], v[232:235], v[64:67]
    ds_read_b128 v[216:219], v250 offset:22528
    ds_read_b128 v[220:223], v250 offset:33792
    v_mfma_f32_16x16x32_bf16 v[68:71], v[180:183], v[232:235], v[68:71]
    v_mfma_f32_16x16x32_bf16 v[72:75], v[208:211], v[232:235], v[72:75]
    v_mfma_f32_16x16x32_bf16 v[76:79], v[212:215], v[232:235], v[76:79]
    v_mfma_f32_16x16x32_bf16 v[64:67], v[184:187], v[236:239], v[64:67]
    v_mfma_f32_16x16x32_bf16 v[68:71], v[188:191], v[236:239], v[68:71]
    v_mfma_f32_16x16x32_bf16 v[72:75], v[176:179], v[236:239], v[72:75]
    v_mfma_f32_16x16x32_bf16 v[76:79], v[180:183], v[236:239], v[76:79]
    s_waitcnt lgkmcnt(2)
    v_mfma_f32_16x16x32_bf16 v[80:83], v[176:179], v[240:243], v[80:83]
    ds_read_b128 v[224:227], v250 offset:23552
    ds_read_b128 v[228:231], v250 offset:34816
    v_mfma_f32_16x16x32_bf16 v[84:87], v[180:183], v[240:243], v[84:87]
    v_mfma_f32_16x16x32_bf16 v[88:91], v[208:211], v[240:243], v[88:91]
    v_mfma_f32_16x16x32_bf16 v[92:95], v[212:215], v[240:243], v[92:95]
    v_mfma_f32_16x16x32_bf16 v[80:83], v[184:187], v[244:247], v[80:83]
    v_add_u32 v248, 0x9800, v248
    v_add_u32 v249, 0x9800, v249
    v_mfma_f32_16x16x32_bf16 v[84:87], v[188:191], v[244:247], v[84:87]
    v_mfma_f32_16x16x32_bf16 v[88:91], v[176:179], v[244:247], v[88:91]
    v_mfma_f32_16x16x32_bf16 v[92:95], v[180:183], v[244:247], v[92:95]
    s_waitcnt lgkmcnt(2)
    v_mfma_f32_16x16x32_bf16 v[96:99], v[176:179], v[216:219], v[96:99]
    ds_read_b128 v[232:235], v250 offset:24576
    ds_read_b128 v[236:239], v250 offset:35840
    v_mfma_f32_16x16x32_bf16 v[100:103], v[180:183], v[216:219], v[100:103]
    v_mfma_f32_16x16x32_bf16 v[104:107], v[208:211], v[216:219], v[104:107]
    v_mfma_f32_16x16x32_bf16 v[108:111], v[212:215], v[216:219], v[108:111]
    ds_read_b64_tr_b16 v[192:193], v248 offset:0
    ds_read_b64_tr_b16 v[194:195], v248 offset:1024
    ds_read_b64_tr_b16 v[196:197], v249 offset:0
    ds_read_b64_tr_b16 v[198:199], v249 offset:1024
    v_mfma_f32_16x16x32_bf16 v[96:99], v[184:187], v[220:223], v[96:99]
    v_mfma_f32_16x16x32_bf16 v[100:103], v[188:191], v[220:223], v[100:103]
    v_mfma_f32_16x16x32_bf16 v[104:107], v[176:179], v[220:223], v[104:107]
    v_mfma_f32_16x16x32_bf16 v[108:111], v[180:183], v[220:223], v[108:111]
    s_waitcnt lgkmcnt(6)
    v_mfma_f32_16x16x32_bf16 v[112:115], v[176:179], v[224:227], v[112:115]
    ds_read_b128 v[240:243], v250 offset:25600
    ds_read_b128 v[244:247], v250 offset:36864
    v_mfma_f32_16x16x32_bf16 v[116:119], v[180:183], v[224:227], v[116:119]
    v_mfma_f32_16x16x32_bf16 v[120:123], v[208:211], v[224:227], v[120:123]
    v_mfma_f32_16x16x32_bf16 v[124:127], v[212:215], v[224:227], v[124:127]
    ds_read_b64_tr_b16 v[200:201], v248 offset:8192
    ds_read_b64_tr_b16 v[202:203], v248 offset:9216
    ds_read_b64_tr_b16 v[204:205], v249 offset:8192
    ds_read_b64_tr_b16 v[206:207], v249 offset:9216
    v_mfma_f32_16x16x32_bf16 v[112:115], v[184:187], v[228:231], v[112:115]
    v_mfma_f32_16x16x32_bf16 v[116:119], v[188:191], v[228:231], v[116:119]
    v_mfma_f32_16x16x32_bf16 v[120:123], v[176:179], v[228:231], v[120:123]
    v_mfma_f32_16x16x32_bf16 v[124:127], v[180:183], v[228:231], v[124:127]
    s_waitcnt lgkmcnt(10)
    v_mfma_f32_16x16x32_bf16 v[128:131], v[176:179], v[232:235], v[128:131]
    ds_read_b128 v[216:219], v250 offset:26624
    ds_read_b128 v[220:223], v250 offset:37888
    v_mfma_f32_16x16x32_bf16 v[132:135], v[180:183], v[232:235], v[132:135]
    v_mfma_f32_16x16x32_bf16 v[136:139], v[208:211], v[232:235], v[136:139]
    v_mfma_f32_16x16x32_bf16 v[140:143], v[212:215], v[232:235], v[140:143]
    v_mfma_f32_16x16x32_bf16 v[128:131], v[184:187], v[236:239], v[128:131]
    v_mfma_f32_16x16x32_bf16 v[132:135], v[188:191], v[236:239], v[132:135]
    v_mfma_f32_16x16x32_bf16 v[136:139], v[176:179], v[236:239], v[136:139]
    v_mfma_f32_16x16x32_bf16 v[140:143], v[180:183], v[236:239], v[140:143]
    s_waitcnt lgkmcnt(6)
    v_mfma_f32_16x16x32_bf16 v[144:147], v[176:179], v[240:243], v[144:147]
    v_add_u32 v250, 0x9800, v250
    ds_read_b128 v[224:227], v250 offset:16384
    ds_read_b128 v[228:231], v250 offset:27648
    v_mfma_f32_16x16x32_bf16 v[148:151], v[180:183], v[240:243], v[148:151]
    v_mfma_f32_16x16x32_bf16 v[152:155], v[208:211], v[240:243], v[152:155]
    v_mfma_f32_16x16x32_bf16 v[156:159], v[212:215], v[240:243], v[156:159]
    v_mfma_f32_16x16x32_bf16 v[144:147], v[184:187], v[244:247], v[144:147]
    s_waitcnt lgkmcnt(4)
    v_xor_b32 v212, 0x80008000, v204
    v_xor_b32 v213, 0x80008000, v205
    v_mfma_f32_16x16x32_bf16 v[148:151], v[188:191], v[244:247], v[148:151]
    v_xor_b32 v214, 0x80008000, v206
    v_xor_b32 v215, 0x80008000, v207
    v_mfma_f32_16x16x32_bf16 v[152:155], v[176:179], v[244:247], v[152:155]
    v_mfma_f32_16x16x32_bf16 v[156:159], v[180:183], v[244:247], v[156:159]
    s_waitcnt lgkmcnt(2)
    v_mfma_f32_16x16x32_bf16 v[160:163], v[176:179], v[216:219], v[160:163]
    ds_read_b128 v[232:235], v250 offset:17408
    ds_read_b128 v[236:239], v250 offset:28672
    v_mfma_f32_16x16x32_bf16 v[164:167], v[208:211], v[216:219], v[164:167]
    v_xor_b32 v208, 0x80008000, v200
    v_xor_b32 v209, 0x80008000, v201
    v_mfma_f32_16x16x32_bf16 v[160:163], v[184:187], v[220:223], v[160:163]
    v_xor_b32 v210, 0x80008000, v202
    v_xor_b32 v211, 0x80008000, v203
    v_mfma_f32_16x16x32_bf16 v[164:167], v[176:179], v[220:223], v[164:167]
    s_barrier
    s_waitcnt lgkmcnt(2)
    v_mfma_f32_16x16x32_bf16 v[0:3], v[192:195], v[224:227], v[0:3]
    ds_read_b128 v[240:243], v250 offset:18432
    ds_read_b128 v[244:247], v250 offset:29696
    v_mfma_f32_16x16x32_bf16 v[4:7], v[196:199], v[224:227], v[4:7]
    v_mfma_f32_16x16x32_bf16 v[8:11], v[208:211], v[224:227], v[8:11]
    v_mfma_f32_16x16x32_bf16 v[12:15], v[212:215], v[224:227], v[12:15]
    v_mfma_f32_16x16x32_bf16 v[0:3], v[200:203], v[228:231], v[0:3]
    v_mfma_f32_16x16x32_bf16 v[4:7], v[204:207], v[228:231], v[4:7]
    v_mfma_f32_16x16x32_bf16 v[8:11], v[192:195], v[228:231], v[8:11]
    v_mfma_f32_16x16x32_bf16 v[12:15], v[196:199], v[228:231], v[12:15]
    s_waitcnt lgkmcnt(2)
    v_mfma_f32_16x16x32_bf16 v[16:19], v[192:195], v[232:235], v[16:19]
    ds_read_b128 v[216:219], v250 offset:19456
    ds_read_b128 v[220:223], v250 offset:30720
    v_mfma_f32_16x16x32_bf16 v[20:23], v[196:199], v[232:235], v[20:23]
    v_mfma_f32_16x16x32_bf16 v[24:27], v[208:211], v[232:235], v[24:27]
    v_mfma_f32_16x16x32_bf16 v[28:31], v[212:215], v[232:235], v[28:31]
    v_mfma_f32_16x16x32_bf16 v[16:19], v[200:203], v[236:239], v[16:19]
    v_mfma_f32_16x16x32_bf16 v[20:23], v[204:207], v[236:239], v[20:23]
    v_mfma_f32_16x16x32_bf16 v[24:27], v[192:195], v[236:239], v[24:27]
    v_mfma_f32_16x16x32_bf16 v[28:31], v[196:199], v[236:239], v[28:31]
    s_waitcnt lgkmcnt(2)
    v_mfma_f32_16x16x32_bf16 v[32:35], v[192:195], v[240:243], v[32:35]
    ds_read_b128 v[224:227], v250 offset:20480
    ds_read_b128 v[228:231], v250 offset:31744
    v_mfma_f32_16x16x32_bf16 v[36:39], v[196:199], v[240:243], v[36:39]
    v_mfma_f32_16x16x32_bf16 v[40:43], v[208:211], v[240:243], v[40:43]
    v_mfma_f32_16x16x32_bf16 v[44:47], v[212:215], v[240:243], v[44:47]
    v_mfma_f32_16x16x32_bf16 v[32:35], v[200:203], v[244:247], v[32:35]
    v_mfma_f32_16x16x32_bf16 v[36:39], v[204:207], v[244:247], v[36:39]
    v_mfma_f32_16x16x32_bf16 v[40:43], v[192:195], v[244:247], v[40:43]
    v_mfma_f32_16x16x32_bf16 v[44:47], v[196:199], v[244:247], v[44:47]
    s_waitcnt lgkmcnt(2)
    v_mfma_f32_16x16x32_bf16 v[48:51], v[192:195], v[216:219], v[48:51]
    ds_read_b128 v[232:235], v250 offset:21504
    ds_read_b128 v[236:239], v250 offset:32768
    v_mfma_f32_16x16x32_bf16 v[52:55], v[196:199], v[216:219], v[52:55]
    v_mfma_f32_16x16x32_bf16 v[56:59], v[208:211], v[216:219], v[56:59]
    v_mfma_f32_16x16x32_bf16 v[60:63], v[212:215], v[216:219], v[60:63]
    v_mfma_f32_16x16x32_bf16 v[48:51], v[200:203], v[220:223], v[48:51]
    v_mfma_f32_16x16x32_bf16 v[52:55], v[204:207], v[220:223], v[52:55]
    v_mfma_f32_16x16x32_bf16 v[56:59], v[192:195], v[220:223], v[56:59]
    v_mfma_f32_16x16x32_bf16 v[60:63], v[196:199], v[220:223], v[60:63]
    s_waitcnt lgkmcnt(2)
    v_mfma_f32_16x16x32_bf16 v[64:67], v[192:195], v[224:227], v[64:67]
    ds_read_b128 v[240:243], v250 offset:22528
    ds_read_b128 v[244:247], v250 offset:33792
    v_mfma_f32_16x16x32_bf16 v[68:71], v[196:199], v[224:227], v[68:71]
    v_mfma_f32_16x16x32_bf16 v[72:75], v[208:211], v[224:227], v[72:75]
    v_mfma_f32_16x16x32_bf16 v[76:79], v[212:215], v[224:227], v[76:79]
    v_mfma_f32_16x16x32_bf16 v[64:67], v[200:203], v[228:231], v[64:67]
    v_mfma_f32_16x16x32_bf16 v[68:71], v[204:207], v[228:231], v[68:71]
    v_mfma_f32_16x16x32_bf16 v[72:75], v[192:195], v[228:231], v[72:75]
    v_mfma_f32_16x16x32_bf16 v[76:79], v[196:199], v[228:231], v[76:79]
    s_waitcnt lgkmcnt(2)
    v_mfma_f32_16x16x32_bf16 v[80:83], v[192:195], v[232:235], v[80:83]
    ds_read_b128 v[216:219], v250 offset:23552
    ds_read_b128 v[220:223], v250 offset:34816
    v_mfma_f32_16x16x32_bf16 v[84:87], v[196:199], v[232:235], v[84:87]
    v_mfma_f32_16x16x32_bf16 v[88:91], v[208:211], v[232:235], v[88:91]
    v_mfma_f32_16x16x32_bf16 v[92:95], v[212:215], v[232:235], v[92:95]
    v_mfma_f32_16x16x32_bf16 v[80:83], v[200:203], v[236:239], v[80:83]
    v_add_u32 v248, 0xfffe3800, v248
    v_add_u32 v249, 0xfffe3800, v249
    v_mfma_f32_16x16x32_bf16 v[84:87], v[204:207], v[236:239], v[84:87]
    v_mfma_f32_16x16x32_bf16 v[88:91], v[192:195], v[236:239], v[88:91]
    v_mfma_f32_16x16x32_bf16 v[92:95], v[196:199], v[236:239], v[92:95]
    s_waitcnt lgkmcnt(2)
    v_mfma_f32_16x16x32_bf16 v[96:99], v[192:195], v[240:243], v[96:99]
    ds_read_b128 v[224:227], v250 offset:24576
    ds_read_b128 v[228:231], v250 offset:35840
    v_mfma_f32_16x16x32_bf16 v[100:103], v[196:199], v[240:243], v[100:103]
    v_mfma_f32_16x16x32_bf16 v[104:107], v[208:211], v[240:243], v[104:107]
    v_mfma_f32_16x16x32_bf16 v[108:111], v[212:215], v[240:243], v[108:111]
    ds_read_b64_tr_b16 v[176:177], v248 offset:0
    ds_read_b64_tr_b16 v[178:179], v248 offset:1024
    ds_read_b64_tr_b16 v[180:181], v249 offset:0
    ds_read_b64_tr_b16 v[182:183], v249 offset:1024
    v_mfma_f32_16x16x32_bf16 v[96:99], v[200:203], v[244:247], v[96:99]
    v_mfma_f32_16x16x32_bf16 v[100:103], v[204:207], v[244:247], v[100:103]
    v_mfma_f32_16x16x32_bf16 v[104:107], v[192:195], v[244:247], v[104:107]
    v_mfma_f32_16x16x32_bf16 v[108:111], v[196:199], v[244:247], v[108:111]
    s_waitcnt lgkmcnt(6)
    v_mfma_f32_16x16x32_bf16 v[112:115], v[192:195], v[216:219], v[112:115]
    ds_read_b128 v[232:235], v250 offset:25600
    ds_read_b128 v[236:239], v250 offset:36864
    v_mfma_f32_16x16x32_bf16 v[116:119], v[196:199], v[216:219], v[116:119]
    v_mfma_f32_16x16x32_bf16 v[120:123], v[208:211], v[216:219], v[120:123]
    v_mfma_f32_16x16x32_bf16 v[124:127], v[212:215], v[216:219], v[124:127]
    ds_read_b64_tr_b16 v[184:185], v248 offset:8192
    ds_read_b64_tr_b16 v[186:187], v248 offset:9216
    ds_read_b64_tr_b16 v[188:189], v249 offset:8192
    ds_read_b64_tr_b16 v[190:191], v249 offset:9216
    v_mfma_f32_16x16x32_bf16 v[112:115], v[200:203], v[220:223], v[112:115]
    v_mfma_f32_16x16x32_bf16 v[116:119], v[204:207], v[220:223], v[116:119]
    v_mfma_f32_16x16x32_bf16 v[120:123], v[192:195], v[220:223], v[120:123]
    v_mfma_f32_16x16x32_bf16 v[124:127], v[196:199], v[220:223], v[124:127]
    s_waitcnt lgkmcnt(10)
    v_mfma_f32_16x16x32_bf16 v[128:131], v[192:195], v[224:227], v[128:131]
    ds_read_b128 v[240:243], v250 offset:26624
    ds_read_b128 v[244:247], v250 offset:37888
    v_mfma_f32_16x16x32_bf16 v[132:135], v[196:199], v[224:227], v[132:135]
    v_mfma_f32_16x16x32_bf16 v[136:139], v[208:211], v[224:227], v[136:139]
    v_mfma_f32_16x16x32_bf16 v[140:143], v[212:215], v[224:227], v[140:143]
    v_mfma_f32_16x16x32_bf16 v[128:131], v[200:203], v[228:231], v[128:131]
    v_mfma_f32_16x16x32_bf16 v[132:135], v[204:207], v[228:231], v[132:135]
    v_mfma_f32_16x16x32_bf16 v[136:139], v[192:195], v[228:231], v[136:139]
    v_mfma_f32_16x16x32_bf16 v[140:143], v[196:199], v[228:231], v[140:143]
    s_waitcnt lgkmcnt(6)
    v_mfma_f32_16x16x32_bf16 v[144:147], v[192:195], v[232:235], v[144:147]
    v_add_u32 v250, 0xfffe3800, v250
    ds_read_b128 v[216:219], v250 offset:16384
    ds_read_b128 v[220:223], v250 offset:27648
    v_mfma_f32_16x16x32_bf16 v[148:151], v[196:199], v[232:235], v[148:151]
    v_mfma_f32_16x16x32_bf16 v[152:155], v[208:211], v[232:235], v[152:155]
    v_mfma_f32_16x16x32_bf16 v[156:159], v[212:215], v[232:235], v[156:159]
    v_mfma_f32_16x16x32_bf16 v[144:147], v[200:203], v[236:239], v[144:147]
    s_waitcnt lgkmcnt(4)
    v_xor_b32 v212, 0x80008000, v188
    v_xor_b32 v213, 0x80008000, v189
    v_mfma_f32_16x16x32_bf16 v[148:151], v[204:207], v[236:239], v[148:151]
    v_xor_b32 v214, 0x80008000, v190
    v_xor_b32 v215, 0x80008000, v191
    v_mfma_f32_16x16x32_bf16 v[152:155], v[192:195], v[236:239], v[152:155]
    v_mfma_f32_16x16x32_bf16 v[156:159], v[196:199], v[236:239], v[156:159]
    s_waitcnt lgkmcnt(2)
    v_mfma_f32_16x16x32_bf16 v[160:163], v[192:195], v[240:243], v[160:163]
    ds_read_b128 v[224:227], v250 offset:17408
    ds_read_b128 v[228:231], v250 offset:28672
    v_mfma_f32_16x16x32_bf16 v[164:167], v[208:211], v[240:243], v[164:167]
    v_xor_b32 v208, 0x80008000, v184
    v_xor_b32 v209, 0x80008000, v185
    v_mfma_f32_16x16x32_bf16 v[160:163], v[200:203], v[244:247], v[160:163]
    v_xor_b32 v210, 0x80008000, v186
    v_xor_b32 v211, 0x80008000, v187
    v_mfma_f32_16x16x32_bf16 v[164:167], v[192:195], v[244:247], v[164:167]
    s_sub_u32 s46, s46, 1
    s_cmp_lg_u32 s46, 0
    s_cbranch_scc1 L_g_loop
    s_barrier
    s_waitcnt lgkmcnt(2)
    v_mfma_f32_16x16x32_bf16 v[0:3], v[176:179], v[216:219], v[0:3]
    ds_read_b128 v[232:235], v250 offset:18432
    ds_read_b128 v[236:239], v250 offset:29696
    v_mfma_f32_16x16x32_bf16 v[4:7], v[180:183], v[216:219], v[4:7]
    v_mfma_f32_16x16x32_bf16 v[8:11], v[208:211], v[216:219], v[8:11]
    v_mfma_f32_16x16x32_bf16 v[12:15], v[212:215], v[216:219], v[12:15]
    v_mfma_f32_16x16x32_bf16 v[0:3], v[184:187], v[220:223], v[0:3]
    v_mfma_f32_16x16x32_bf16 v[4:7], v[188:191], v[220:223], v[4:7]
    v_mfma_f32_16x16x32_bf16 v[8:11], v[176:179], v[220:223], v[8:11]
    v_mfma_f32_16x16x32_bf16 v[12:15], v[180:183], v[220:223], v[12:15]
    s_waitcnt lgkmcnt(2)
    v_mfma_f32_16x16x32_bf16 v[16:19], v[176:179], v[224:227], v[16:19]
    ds_read_b128 v[240:243], v250 offset:19456
    ds_read_b128 v[244:247], v250 offset:30720
    v_mfma_f32_16x16x32_bf16 v[20:23], v[180:183], v[224:227], v[20:23]
    v_mfma_f32_16x16x32_bf16 v[24:27], v[208:211], v[224:227], v[24:27]
    v_mfma_f32_16x16x32_bf16 v[28:31], v[212:215], v[224:227], v[28:31]
    v_mfma_f32_16x16x32_bf16 v[16:19], v[184:187], v[228:231], v[16:19]
    v_mfma_f32_16x16x32_bf16 v[20:23], v[188:191], v[228:231], v[20:23]
    v_mfma_f32_16x16x32_bf16 v[24:27], v[176:179], v[228:231], v[24:27]
    v_mfma_f32_16x16x32_bf16 v[28:31], v[180:183], v[228:231], v[28:31]
    s_waitcnt lgkmcnt(2)
    v_mfma_f32_16x16x32_bf16 v[32:35], v[176:179], v[232:235], v[32:35]
    ds_read_b128 v[216:219], v250 offset:20480
    ds_read_b128 v[220:223], v250 offset:31744
    v_mfma_f32_16x16x32_bf16 v[36:39], v[180:183], v[232:235], v[36:39]
    v_mfma_f32_16x16x32_bf16 v[40:43], v[208:211], v[232:235], v[40:43]
    v_mfma_f32_16x16x32_bf16 v[44:47], v[212:215], v[232:235], v[44:47]
    v_mfma_f32_16x16x32_bf16 v[32:35], v[184:187], v[236:239], v[32:35]
    v_mfma_f32_16x16x32_bf16 v[36:39], v[188:191], v[236:239], v[36:39]
    v_mfma_f32_16x16x32_bf16 v[40:43], v[176:179], v[236:239], v[40:43]
    v_mfma_f32_16x16x32_bf16 v[44:47], v[180:183], v[236:239], v[44:47]
    s_waitcnt lgkmcnt(2)
    v_mfma_f32_16x16x32_bf16 v[48:51], v[176:179], v[240:243], v[48:51]
    ds_read_b128 v[224:227], v250 offset:21504
    ds_read_b128 v[228:231], v250 offset:32768
    v_mfma_f32_16x16x32_bf16 v[52:55], v[180:183], v[240:243], v[52:55]
    v_mfma_f32_16x16x32_bf16 v[56:59], v[208:211], v[240:243], v[56:59]
    v_mfma_f32_16x16x32_bf16 v[60:63], v[212:215], v[240:243], v[60:63]
    v_mfma_f32_16x16x32_bf16 v[48:51], v[184:187], v[244:247], v[48:51]
    v_mfma_f32_16x16x32_bf16 v[52:55], v[188:191], v[244:247], v[52:55]
    v_mfma_f32_16x16x32_bf16 v[56:59], v[176:179], v[244:247], v[56:59]
    v_mfma_f32_16x16x32_bf16 v[60:63], v[180:183], v[244:247], v[60:63]
    s_waitcnt lgkmcnt(2)
    v_mfma_f32_16x16x32_bf16 v[64:67], v[176:179], v[216:219], v[64:67]
    ds_read_b128 v[232:235], v250 offset:22528
    ds_read_b128 v[236:239], v250 offset:33792
    v_mfma_f32_16x16x32_bf16 v[68:71], v[180:183], v[216:219], v[68:71]
    v_mfma_f32_16x16x32_bf16 v[72:75], v[208:211], v[216:219], v[72:75]
    v_mfma_f32_16x16x32_bf16 v[76:79], v[212:215], v[216:219], v[76:79]
    v_mfma_f32_16x16x32_bf16 v[64:67], v[184:187], v[220:223], v[64:67]
    v_mfma_f32_16x16x32_bf16 v[68:71], v[188:191], v[220:223], v[68:71]
    v_mfma_f32_16x16x32_bf16 v[72:75], v[176:179], v[220:223], v[72:75]
    v_mfma_f32_16x16x32_bf16 v[76:79], v[180:183], v[220:223], v[76:79]
    s_waitcnt lgkmcnt(2)
    v_mfma_f32_16x16x32_bf16 v[80:83], v[176:179], v[224:227], v[80:83]
    ds_read_b128 v[240:243], v250 offset:23552
    ds_read_b128 v[244:247], v250 offset:34816
    v_mfma_f32_16x16x32_bf16 v[84:87], v[180:183], v[224:227], v[84:87]
    v_mfma_f32_16x16x32_bf16 v[88:91], v[208:211], v[224:227], v[88:91]
    v_mfma_f32_16x16x32_bf16 v[92:95], v[212:215], v[224:227], v[92:95]
    v_mfma_f32_16x16x32_bf16 v[80:83], v[184:187], v[228:231], v[80:83]
    v_add_u32 v248, 0x9800, v248
    v_add_u32 v249, 0x9800, v249
    v_mfma_f32_16x16x32_bf16 v[84:87], v[188:191], v[228:231], v[84:87]
    v_mfma_f32_16x16x32_bf16 v[88:91], v[176:179], v[228:231], v[88:91]
    v_mfma_f32_16x16x32_bf16 v[92:95], v[180:183], v[228:231], v[92:95]
    s_waitcnt lgkmcnt(2)
    v_mfma_f32_16x16x32_bf16 v[96:99], v[176:179], v[232:235], v[96:99]
    ds_read_b128 v[216:219], v250 offset:24576
    ds_read_b128 v[220:223], v250 offset:35840
    v_mfma_f32_16x16x32_bf16 v[100:103], v[180:183], v[232:235], v[100:103]
    v_mfma_f32_16x16x32_bf16 v[104:107], v[208:211], v[232:235], v[104:107]
    v_mfma_f32_16x16x32_bf16 v[108:111], v[212:215], v[232:235], v[108:111]
    ds_read_b64_tr_b16 v[192:193], v248 offset:0
    ds_read_b64_tr_b16 v[194:195], v248 offset:1024
    ds_read_b64_tr_b16 v[196:197], v249 offset:0
    ds_read_b64_tr_b16 v[198:199], v249 offset:1024
    v_mfma_f32_16x16x32_bf16 v[96:99], v[184:187], v[236:239], v[96:99]
    v_mfma_f32_16x16x32_bf16 v[100:103], v[188:191], v[236:239], v[100:103]
    v_mfma_f32_16x16x32_bf16 v[104:107], v[176:179], v[236:239], v[104:107]
    v_mfma_f32_16x16x32_bf16 v[108:111], v[180:183], v[236:239], v[108:111]
    s_waitcnt lgkmcnt(6)
    v_mfma_f32_16x16x32_bf16 v[112:115], v[176:179], v[240:243], v[112:115]
    ds_read_b128 v[224:227], v250 offset:25600
    ds_read_b128 v[228:231], v250 offset:36864
    v_mfma_f32_16x16x32_bf16 v[116:119], v[180:183], v[240:243], v[116:119]
    v_mfma_f32_16x16x32_bf16 v[120:123], v[208:211], v[240:243], v[120:123]
    v_mfma_f32_16x16x32_bf16 v[124:127], v[212:215], v[240:243], v[124:127]
    ds_read_b64_tr_b16 v[200:201], v248 offset:8192
    ds_read_b64_tr_b16 v[202:203], v248 offset:9216
    ds_read_b64_tr_b16 v[204:205], v249 offset:8192
    ds_read_b64_tr_b16 v[206:207], v249 offset:9216
    v_mfma_f32_16x16x32_bf16 v[112:115], v[184:187], v[244:247], v[112:115]
    v_mfma_f32_16x16x32_bf16 v[116:119], v[188:191], v[244:247], v[116:119]
    v_mfma_f32_16x16x32_bf16 v[120:123], v[176:179], v[244:247], v[120:123]
    v_mfma_f32_16x16x32_bf16 v[124:127], v[180:183], v[244:247], v[124:127]
    s_waitcnt lgkmcnt(10)
    v_mfma_f32_16x16x32_bf16 v[128:131], v[176:179], v[216:219], v[128:131]
    ds_read_b128 v[232:235], v250 offset:26624
    ds_read_b128 v[236:239], v250 offset:37888
    v_mfma_f32_16x16x32_bf16 v[132:135], v[180:183], v[216:219], v[132:135]
    v_mfma_f32_16x16x32_bf16 v[136:139], v[208:211], v[216:219], v[136:139]
    v_mfma_f32_16x16x32_bf16 v[140:143], v[212:215], v[216:219], v[140:143]
    v_mfma_f32_16x16x32_bf16 v[128:131], v[184:187], v[220:223], v[128:131]
    v_mfma_f32_16x16x32_bf16 v[132:135], v[188:191], v[220:223], v[132:135]
    v_mfma_f32_16x16x32_bf16 v[136:139], v[176:179], v[220:223], v[136:139]
    v_mfma_f32_16x16x32_bf16 v[140:143], v[180:183], v[220:223], v[140:143]
    s_waitcnt lgkmcnt(6)
    v_mfma_f32_16x16x32_bf16 v[144:147], v[176:179], v[224:227], v[144:147]
    v_add_u32 v250, 0x9800, v250
    ds_read_b128 v[240:243], v250 offset:16384
    ds_read_b128 v[244:247], v250 offset:27648
    v_mfma_f32_16x16x32_bf16 v[148:151], v[180:183], v[224:227], v[148:151]
    v_mfma_f32_16x16x32_bf16 v[152:155], v[208:211], v[224:227], v[152:155]
    v_mfma_f32_16x16x32_bf16 v[156:159], v[212:215], v[224:227], v[156:159]
    v_mfma_f32_16x16x32_bf16 v[144:147], v[184:187], v[228:231], v[144:147]
    s_waitcnt lgkmcnt(4)
    v_xor_b32 v212, 0x80008000, v204
    v_xor_b32 v213, 0x80008000, v205
    v_mfma_f32_16x16x32_bf16 v[148:151], v[188:191], v[228:231], v[148:151]
    v_xor_b32 v214, 0x80008000, v206
    v_xor_b32 v215, 0x80008000, v207
    v_mfma_f32_16x16x32_bf16 v[152:155], v[176:179], v[228:231], v[152:155]
    v_mfma_f32_16x16x32_bf16 v[156:159], v[180:183], v[228:231], v[156:159]
    s_waitcnt lgkmcnt(2)
    v_mfma_f32_16x16x32_bf16 v[160:163], v[176:179], v[232:235], v[160:163]
    ds_read_b128 v[216:219], v250 offset:17408
    ds_read_b128 v[220:223], v250 offset:28672
    v_mfma_f32_16x16x32_bf16 v[164:167], v[208:211], v[232:235], v[164:167]
    v_xor_b32 v208, 0x80008000, v200
    v_xor_b32 v209, 0x80008000, v201
    v_mfma_f32_16x16x32_bf16 v[160:163], v[184:187], v[236:239], v[160:163]
    v_xor_b32 v210, 0x80008000, v202
    v_xor_b32 v211, 0x80008000, v203
    v_mfma_f32_16x16x32_bf16 v[164:167], v[176:179], v[236:239], v[164:167]
    s_barrier
    s_waitcnt lgkmcnt(2)
    v_mfma_f32_16x16x32_bf16 v[0:3], v[192:195], v[240:243], v[0:3]
    ds_read_b128 v[224:227], v250 offset:18432
    ds_read_b128 v[228:231], v250 offset:29696
    v_mfma_f32_16x16x32_bf16 v[4:7], v[196:199], v[240:243], v[4:7]
    v_mfma_f32_16x16x32_bf16 v[8:11], v[208:211], v[240:243], v[8:11]
    v_mfma_f32_16x16x32_bf16 v[12:15], v[212:215], v[240:243], v[12:15]
    v_mfma_f32_16x16x32_bf16 v[0:3], v[200:203], v[244:247], v[0:3]
    v_mfma_f32_16x16x32_bf16 v[4:7], v[204:207], v[244:247], v[4:7]
    v_mfma_f32_16x16x32_bf16 v[8:11], v[192:195], v[244:247], v[8:11]
    v_mfma_f32_16x16x32_bf16 v[12:15], v[196:199], v[244:247], v[12:15]
    s_waitcnt lgkmcnt(2)
    v_mfma_f32_16x16x32_bf16 v[16:19], v[192:195], v[216:219], v[16:19]
    ds_read_b128 v[232:235], v250 offset:19456
    ds_read_b128 v[236:239], v250 offset:30720
    v_mfma_f32_16x16x32_bf16 v[20:23], v[196:199], v[216:219], v[20:23]
    v_mfma_f32_16x16x32_bf16 v[24:27], v[208:211], v[216:219], v[24:27]
    v_mfma_f32_16x16x32_bf16 v[28:31], v[212:215], v[216:219], v[28:31]
    v_mfma_f32_16x16x32_bf16 v[16:19], v[200:203], v[220:223], v[16:19]
    v_mfma_f32_16x16x32_bf16 v[20:23], v[204:207], v[220:223], v[20:23]
    v_mfma_f32_16x16x32_bf16 v[24:27], v[192:195], v[220:223], v[24:27]
    v_mfma_f32_16x16x32_bf16 v[28:31], v[196:199], v[220:223], v[28:31]
    s_waitcnt lgkmcnt(2)
    v_mfma_f32_16x16x32_bf16 v[32:35], v[192:195], v[224:227], v[32:35]
    ds_read_b128 v[240:243], v250 offset:20480
    ds_read_b128 v[244:247], v250 offset:31744
    v_mfma_f32_16x16x32_bf16 v[36:39], v[196:199], v[224:227], v[36:39]
    v_mfma_f32_16x16x32_bf16 v[40:43], v[208:211], v[224:227], v[40:43]
    v_mfma_f32_16x16x32_bf16 v[44:47], v[212:215], v[224:227], v[44:47]
    v_mfma_f32_16x16x32_bf16 v[32:35], v[200:203], v[228:231], v[32:35]
    v_mfma_f32_16x16x32_bf16 v[36:39], v[204:207], v[228:231], v[36:39]
    v_mfma_f32_16x16x32_bf16 v[40:43], v[192:195], v[228:231], v[40:43]
    v_mfma_f32_16x16x32_bf16 v[44:47], v[196:199], v[228:231], v[44:47]
    s_waitcnt lgkmcnt(2)
    v_mfma_f32_16x16x32_bf16 v[48:51], v[192:195], v[232:235], v[48:51]
    ds_read_b128 v[216:219], v250 offset:21504
    ds_read_b128 v[220:223], v250 offset:32768
    v_mfma_f32_16x16x32_bf16 v[52:55], v[196:199], v[232:235], v[52:55]
    v_mfma_f32_16x16x32_bf16 v[56:59], v[208:211], v[232:235], v[56:59]
    v_mfma_f32_16x16x32_bf16 v[60:63], v[212:215], v[232:235], v[60:63]
    v_mfma_f32_16x16x32_bf16 v[48:51], v[200:203], v[236:239], v[48:51]
    v_mfma_f32_16x16x32_bf16 v[52:55], v[204:207], v[236:239], v[52:55]
    v_mfma_f32_16x16x32_bf16 v[56:59], v[192:195], v[236:239], v[56:59]
    v_mfma_f32_16x16x32_bf16 v[60:63], v[196:199], v[236:239], v[60:63]
    s_waitcnt lgkmcnt(2)
    v_mfma_f32_16x16x32_bf16 v[64:67], v[192:195], v[240:243], v[64:67]
    ds_read_b128 v[224:227], v250 offset:22528
    ds_read_b128 v[228:231], v250 offset:33792
    v_mfma_f32_16x16x32_bf16 v[68:71], v[196:199], v[240:243], v[68:71]
    v_mfma_f32_16x16x32_bf16 v[72:75], v[208:211], v[240:243], v[72:75]
    v_mfma_f32_16x16x32_bf16 v[76:79], v[212:215], v[240:243], v[76:79]
    v_mfma_f32_16x16x32_bf16 v[64:67], v[200:203], v[244:247], v[64:67]
    v_mfma_f32_16x16x32_bf16 v[68:71], v[204:207], v[244:247], v[68:71]
    v_mfma_f32_16x16x32_bf16 v[72:75], v[192:195], v[244:247], v[72:75]
    v_mfma_f32_16x16x32_bf16 v[76:79], v[196:199], v[244:247], v[76:79]
    s_waitcnt lgkmcnt(2)
    v_mfma_f32_16x16x32_bf16 v[80:83], v[192:195], v[216:219], v[80:83]
    ds_read_b128 v[232:235], v250 offset:23552
    ds_read_b128 v[236:239], v250 offset:34816
    v_mfma_f32_16x16x32_bf16 v[84:87], v[196:199], v[216:219], v[84:87]
    v_mfma_f32_16x16x32_bf16 v[88:91], v[208:211], v[216:219], v[88:91]
    v_mfma_f32_16x16x32_bf16 v[92:95], v[212:215], v[216:219], v[92:95]
    v_mfma_f32_16x16x32_bf16 v[80:83], v[200:203], v[220:223], v[80:83]
    v_add_u32 v248, 0x9800, v248
    v_add_u32 v249, 0x9800, v249
    v_mfma_f32_16x16x32_bf16 v[84:87], v[204:207], v[220:223], v[84:87]
    v_mfma_f32_16x16x32_bf16 v[88:91], v[192:195], v[220:223], v[88:91]
    v_mfma_f32_16x16x32_bf16 v[92:95], v[196:199], v[220:223], v[92:95]
    s_waitcnt lgkmcnt(2)
    v_mfma_f32_16x16x32_bf16 v[96:99], v[192:195], v[224:227], v[96:99]
    ds_read_b128 v[240:243], v250 offset:24576
    ds_read_b128 v[244:247], v250 offset:35840
    v_mfma_f32_16x16x32_bf16 v[100:103], v[196:199], v[224:227], v[100:103]
    v_mfma_f32_16x16x32_bf16 v[104:107], v[208:211], v[224:227], v[104:107]
    v_mfma_f32_16x16x32_bf16 v[108:111], v[212:215], v[224:227], v[108:111]
    ds_read_b64_tr_b16 v[176:177], v248 offset:0
    ds_read_b64_tr_b16 v[178:179], v248 offset:1024
    ds_read_b64_tr_b16 v[180:181], v249 offset:0
    ds_read_b64_tr_b16 v[182:183], v249 offset:1024
    v_mfma_f32_16x16x32_bf16 v[96:99], v[200:203], v[228:231], v[96:99]
    v_mfma_f32_16x16x32_bf16 v[100:103], v[204:207], v[228:231], v[100:103]
    v_mfma_f32_16x16x32_bf16 v[104:107], v[192:195], v[228:231], v[104:107]
    v_mfma_f32_16x16x32_bf16 v[108:111], v[196:199], v[228:231], v[108:111]
    s_waitcnt lgkmcnt(6)
    v_mfma_f32_16x16x32_bf16 v[112:115], v[192:195], v[232:235], v[112:115]
    ds_read_b128 v[216:219], v250 offset:25600
    ds_read_b128 v[220:223], v250 offset:36864
    v_mfma_f32_16x16x32_bf16 v[116:119], v[196:199], v[232:235], v[116:119]
    v_mfma_f32_16x16x32_bf16 v[120:123], v[208:211], v[232:235], v[120:123]
    v_mfma_f32_16x16x32_bf16 v[124:127], v[212:215], v[232:235], v[124:127]
    ds_read_b64_tr_b16 v[184:185], v248 offset:8192
    ds_read_b64_tr_b16 v[186:187], v248 offset:9216
    ds_read_b64_tr_b16 v[188:189], v249 offset:8192
    ds_read_b64_tr_b16 v[190:191], v249 offset:9216
    v_mfma_f32_16x16x32_bf16 v[112:115], v[200:203], v[236:239], v[112:115]
    v_mfma_f32_16x16x32_bf16 v[116:119], v[204:207], v[236:239], v[116:119]
    v_mfma_f32_16x16x32_bf16 v[120:123], v[192:195], v[236:239], v[120:123]
    v_mfma_f32_16x16x32_bf16 v[124:127], v[196:199], v[236:239], v[124:127]
    s_waitcnt lgkmcnt(10)
    v_mfma_f32_16x16x32_bf16 v[128:131], v[192:195], v[240:243], v[128:131]
    ds_read_b128 v[224:227], v250 offset:26624
    ds_read_b128 v[228:231], v250 offset:37888
    v_mfma_f32_16x16x32_bf16 v[132:135], v[196:199], v[240:243], v[132:135]
    v_mfma_f32_16x16x32_bf16 v[136:139], v[208:211], v[240:243], v[136:139]
    v_mfma_f32_16x16x32_bf16 v[140:143], v[212:215], v[240:243], v[140:143]
    v_mfma_f32_16x16x32_bf16 v[128:131], v[200:203], v[244:247], v[128:131]
    v_mfma_f32_16x16x32_bf16 v[132:135], v[204:207], v[244:247], v[132:135]
    v_mfma_f32_16x16x32_bf16 v[136:139], v[192:195], v[244:247], v[136:139]
    v_mfma_f32_16x16x32_bf16 v[140:143], v[196:199], v[244:247], v[140:143]
    s_waitcnt lgkmcnt(6)
    v_mfma_f32_16x16x32_bf16 v[144:147], v[192:195], v[216:219], v[144:147]
    v_add_u32 v250, 0x9800, v250
    ds_read_b128 v[232:235], v250 offset:16384
    ds_read_b128 v[236:239], v250 offset:27648
    v_mfma_f32_16x16x32_bf16 v[148:151], v[196:199], v[216:219], v[148:151]
    v_mfma_f32_16x16x32_bf16 v[152:155], v[208:211], v[216:219], v[152:155]
    v_mfma_f32_16x16x32_bf16 v[156:159], v[212:215], v[216:219], v[156:159]
    v_mfma_f32_16x16x32_bf16 v[144:147], v[200:203], v[220:223], v[144:147]
    s_waitcnt lgkmcnt(4)
    v_xor_b32 v212, 0x80008000, v188
    v_xor_b32 v213, 0x80008000, v189
    v_mfma_f32_16x16x32_bf16 v[148:151], v[204:207], v[220:223], v[148:151]
    v_xor_b32 v214, 0x80008000, v190
    v_xor_b32 v215, 0x80008000, v191
    v_mfma_f32_16x16x32_bf16 v[152:155], v[192:195], v[220:223], v[152:155]
    v_mfma_f32_16x16x32_bf16 v[156:159], v[196:199], v[220:223], v[156:159]
    s_waitcnt lgkmcnt(2)
    v_mfma_f32_16x16x32_bf16 v[160:163], v[192:195], v[224:227], v[160:163]
    ds_read_b128 v[240:243], v250 offset:17408
    ds_read_b128 v[244:247], v250 offset:28672
    v_mfma_f32_16x16x32_bf16 v[164:167], v[208:211], v[224:227], v[164:167]
    v_xor_b32 v208, 0x80008000, v184
    v_xor_b32 v209, 0x80008000, v185
    v_mfma_f32_16x16x32_bf16 v[160:163], v[200:203], v[228:231], v[160:163]
    v_xor_b32 v210, 0x80008000, v186
    v_xor_b32 v211, 0x80008000, v187
    v_mfma_f32_16x16x32_bf16 v[164:167], v[192:195], v[228:231], v[164:167]
    s_barrier
    s_cmp_lg_u32 s13, 0
    s_cbranch_scc1 L_epi_b1
    v_add_u32 v248, 0x9800, v248
    v_add_u32 v249, 0x9800, v249
    v_add_u32 v253, 38912, v250
    ds_read_b64_tr_b16 v[192:193], v248 offset:0
    ds_read_b64_tr_b16 v[194:195], v248 offset:1024
    ds_read_b64_tr_b16 v[196:197], v249 offset:0
    ds_read_b64_tr_b16 v[198:199], v249 offset:1024
    ds_read_b64_tr_b16 v[200:201], v248 offset:8192
    ds_read_b64_tr_b16 v[202:203], v248 offset:9216
    ds_read_b64_tr_b16 v[204:205], v249 offset:8192
    ds_read_b64_tr_b16 v[206:207], v249 offset:9216
    s_waitcnt lgkmcnt(10)
    v_mfma_f32_16x16x32_bf16 v[0:3], v[176:179], v[232:235], v[0:3]
    ds_read_b128 v[216:219], v250 offset:18432
    ds_read_b128 v[220:223], v250 offset:29696
    v_mfma_f32_16x16x32_bf16 v[4:7], v[180:183], v[232:235], v[4:7]
    v_mfma_f32_16x16x32_bf16 v[8:11], v[208:211], v[232:235], v[8:11]
    v_mfma_f32_16x16x32_bf16 v[12:15], v[212:215], v[232:235], v[12:15]
    v_mfma_f32_16x16x32_bf16 v[0:3], v[184:187], v[236:239], v[0:3]
    v_mfma_f32_16x16x32_bf16 v[4:7], v[188:191], v[236:239], v[4:7]
    v_mfma_f32_16x16x32_bf16 v[8:11], v[176:179], v[236:239], v[8:11]
    v_mfma_f32_16x16x32_bf16 v[12:15], v[180:183], v[236:239], v[12:15]
    s_waitcnt lgkmcnt(10)
    v_mfma_f32_16x16x32_bf16 v[16:19], v[176:179], v[240:243], v[16:19]
    ds_read_b128 v[224:227], v253 offset:16384
    ds_read_b128 v[228:231], v253 offset:27648
    v_mfma_f32_16x16x32_bf16 v[20:23], v[180:183], v[240:243], v[20:23]
    v_mfma_f32_16x16x32_bf16 v[24:27], v[208:211], v[240:243], v[24:27]
    v_mfma_f32_16x16x32_bf16 v[28:31], v[212:215], v[240:243], v[28:31]
    v_mfma_f32_16x16x32_bf16 v[16:19], v[184:187], v[244:247], v[16:19]
    v_mfma_f32_16x16x32_bf16 v[20:23], v[188:191], v[244:247], v[20:23]
    v_mfma_f32_16x16x32_bf16 v[24:27], v[176:179], v[244:247], v[24:27]
    v_mfma_f32_16x16x32_bf16 v[28:31], v[180:183], v[244:247], v[28:31]
    s_waitcnt lgkmcnt(2)
    v_mfma_f32_16x16x32_bf16 v[32:35], v[176:179], v[216:219], v[32:35]
    ds_read_b128 v[232:235], v250 offset:19456
    ds_read_b128 v[236:239], v250 offset:30720
    v_mfma_f32_16x16x32_bf16 v[36:39], v[180:183], v[216:219], v[36:39]
    v_mfma_f32_16x16x32_bf16 v[40:43], v[208:211], v[216:219], v[40:43]
    v_mfma_f32_16x16x32_bf16 v[44:47], v[212:215], v[216:219], v[44:47]
    v_mfma_f32_16x16x32_bf16 v[32:35], v[184:187], v[220:223], v[32:35]
    v_mfma_f32_16x16x32_bf16 v[36:39], v[188:191], v[220:223], v[36:39]
    v_mfma_f32_16x16x32_bf16 v[40:43], v[176:179], v[220:223], v[40:43]
    v_mfma_f32_16x16x32_bf16 v[44:47], v[180:183], v[220:223], v[44:47]
    v_xor_b32 v168, 0x80008000, v200
    v_xor_b32 v169, 0x80008000, v201
    v_xor_b32 v170, 0x80008000, v202
    v_xor_b32 v171, 0x80008000, v203
    v_xor_b32 v172, 0x80008000, v204
    v_xor_b32 v173, 0x80008000, v205
    v_xor_b32 v174, 0x80008000, v206
    v_xor_b32 v175, 0x80008000, v207
    s_waitcnt lgkmcnt(2)
    v_mfma_f32_16x16x32_bf16 v[0:3], v[192:195], v[224:227], v[0:3]
    ds_read_b128 v[240:243], v253 offset:17408
    ds_read_b128 v[244:247], v253 offset:28672
    v_mfma_f32_16x16x32_bf16 v[4:7], v[196:199], v[224:227], v[4:7]
    v_mfma_f32_16x16x32_bf16 v[8:11], v[168:171], v[224:227], v[8:11]
    v_mfma_f32_16x16x32_bf16 v[12:15], v[172:175], v[224:227], v[12:15]
    v_mfma_f32_16x16x32_bf16 v[0:3], v[200:203], v[228:231], v[0:3]
    v_mfma_f32_16x16x32_bf16 v[4:7], v[204:207], v[228:231], v[4:7]
    v_mfma_f32_16x16x32_bf16 v[8:11], v[192:195], v[228:231], v[8:11]
    v_mfma_f32_16x16x32_bf16 v[12:15], v[196:199], v[228:231], v[12:15]
    s_waitcnt lgkmcnt(2)
    v_mfma_f32_16x16x32_bf16 v[48:51], v[176:179], v[232:235], v[48:51]
    ds_read_b128 v[216:219], v250 offset:20480
    ds_read_b128 v[220:223], v250 offset:31744
    v_mfma_f32_16x16x32_bf16 v[52:55], v[180:183], v[232:235], v[52:55]
    v_mfma_f32_16x16x32_bf16 v[56:59], v[208:211], v[232:235], v[56:59]
    v_mfma_f32_16x16x32_bf16 v[60:63], v[212:215], v[232:235], v[60:63]
    v_mfma_f32_16x16x32_bf16 v[48:51], v[184:187], v[236:239], v[48:51]
    v_mfma_f32_16x16x32_bf16 v[52:55], v[188:191], v[236:239], v[52:55]
    v_mfma_f32_16x16x32_bf16 v[56:59], v[176:179], v[236:239], v[56:59]
    v_mfma_f32_16x16x32_bf16 v[60:63], v[180:183], v[236:239], v[60:63]
    s_waitcnt lgkmcnt(2)
    v_mfma_f32_16x16x32_bf16 v[16:19], v[192:195], v[240:243], v[16:19]
    ds_read_b128 v[224:227], v253 offset:18432
    ds_read_b128 v[228:231], v253 offset:29696
    v_mfma_f32_16x16x32_bf16 v[20:23], v[196:199], v[240:243], v[20:23]
    v_cvt_pk_bf16_f32 v0, v0, v1
    v_cvt_pk_bf16_f32 v1, v2, v3
    v_mfma_f32_16x16x32_bf16 v[24:27], v[168:171], v[240:243], v[24:27]
    v_cvt_pk_bf16_f32 v2, v4, v5
    v_cvt_pk_bf16_f32 v3, v6, v7
    v_mfma_f32_16x16x32_bf16 v[28:31], v[172:175], v[240:243], v[28:31]
    s_add_u32 s47, s48, 0
    buffer_store_dwordx4 v[0:3], v251, s[16:19], s47 offen sc1
    v_mfma_f32_16x16x32_bf16 v[16:19], v[200:203], v[244:247], v[16:19]
    v_cvt_pk_bf16_f32 v8, v8, v9
    v_cvt_pk_bf16_f32 v9, v10, v11
    v_mfma_f32_16x16x32_bf16 v[20:23], v[204:207], v[244:247], v[20:23]
    v_cvt_pk_bf16_f32 v10, v12, v13
    v_cvt_pk_bf16_f32 v11, v14, v15
    v_mfma_f32_16x16x32_bf16 v[24:27], v[192:195], v[244:247], v[24:27]
    s_add_u32 s47, s48, 1024
    buffer_store_dwordx4 v[8:11], v251, s[16:19], s47 offen sc1
    v_mfma_f32_16x16x32_bf16 v[28:31], v[196:199], v[244:247], v[28:31]
    s_waitcnt lgkmcnt(2)
    v_mfma_f32_16x16x32_bf16 v[64:67], v[176:179], v[216:219], v[64:67]
    ds_read_b128 v[232:235], v250 offset:21504
    ds_read_b128 v[236:239], v250 offset:32768
    v_mfma_f32_16x16x32_bf16 v[68:71], v[180:183], v[216:219], v[68:71]
    v_mfma_f32_16x16x32_bf16 v[72:75], v[208:211], v[216:219], v[72:75]
    v_mfma_f32_16x16x32_bf16 v[76:79], v[212:215], v[216:219], v[76:79]
    v_mfma_f32_16x16x32_bf16 v[64:67], v[184:187], v[220:223], v[64:67]
    v_mfma_f32_16x16x32_bf16 v[68:71], v[188:191], v[220:223], v[68:71]
    v_mfma_f32_16x16x32_bf16 v[72:75], v[176:179], v[220:223], v[72:75]
    v_mfma_f32_16x16x32_bf16 v[76:79], v[180:183], v[220:223], v[76:79]
    s_waitcnt lgkmcnt(2)
    v_mfma_f32_16x16x32_bf16 v[32:35], v[192:195], v[224:227], v[32:35]
    ds_read_b128 v[240:243], v253 offset:19456
    ds_read_b128 v[244:247], v253 offset:30720
    v_mfma_f32_16x16x32_bf16 v[36:39], v[196:199], v[224:227], v[36:39]
    v_cvt_pk_bf16_f32 v16, v16, v17
    v_cvt_pk_bf16_f32 v17, v18, v19
    v_mfma_f32_16x16x32_bf16 v[40:43], v[168:171], v[224:227], v[40:43]
    v_cvt_pk_bf16_f32 v18, v20, v21
    v_cvt_pk_bf16_f32 v19, v22, v23
    v_mfma_f32_16x16x32_bf16 v[44:47], v[172:175], v[224:227], v[44:47]
    s_add_u32 s47, s48, 1052672
    buffer_store_dwordx4 v[16:19], v251, s[16:19], s47 offen sc1
    v_mfma_f32_16x16x32_bf16 v[32:35], v[200:203], v[228:231], v[32:35]
    v_cvt_pk_bf16_f32 v24, v24, v25
    v_cvt_pk_bf16_f32 v25, v26, v27
    v_mfma_f32_16x16x32_bf16 v[36:39], v[204:207], v[228:231], v[36:39]
    v_cvt_pk_bf16_f32 v26, v28, v29
    v_cvt_pk_bf16_f32 v27, v30, v31
    v_mfma_f32_16x16x32_bf16 v[40:43], v[192:195], v[228:231], v[40:43]
    s_add_u32 s47, s48, 1053696
    buffer_store_dwordx4 v[24:27], v251, s[16:19], s47 offen sc1
    v_mfma_f32_16x16x32_bf16 v[44:47], v[196:199], v[228:231], v[44:47]
    s_waitcnt lgkmcnt(2)
    v_mfma_f32_16x16x32_bf16 v[80:83], v[176:179], v[232:235], v[80:83]
    ds_read_b128 v[216:219], v250 offset:22528
    ds_read_b128 v[220:223], v250 offset:33792
    v_mfma_f32_16x16x32_bf16 v[84:87], v[180:183], v[232:235], v[84:87]
    v_mfma_f32_16x16x32_bf16 v[88:91], v[208:211], v[232:235], v[88:91]
    v_mfma_f32_16x16x32_bf16 v[92:95], v[212:215], v[232:235], v[92:95]
    v_mfma_f32_16x16x32_bf16 v[80:83], v[184:187], v[236:239], v[80:83]
    v_mfma_f32_16x16x32_bf16 v[84:87], v[188:191], v[236:239], v[84:87]
    v_mfma_f32_16x16x32_bf16 v[88:91], v[176:179], v[236:239], v[88:91]
    v_mfma_f32_16x16x32_bf16 v[92:95], v[180:183], v[236:239], v[92:95]
    s_waitcnt lgkmcnt(2)
    v_mfma_f32_16x16x32_bf16 v[48:51], v[192:195], v[240:243], v[48:51]
    ds_read_b128 v[224:227], v253 offset:20480
    ds_read_b128 v[228:231], v253 offset:31744
    v_mfma_f32_16x16x32_bf16 v[52:55], v[196:199], v[240:243], v[52:55]
    v_cvt_pk_bf16_f32 v32, v32, v33
    v_cvt_pk_bf16_f32 v33, v34, v35
    v_mfma_f32_16x16x32_bf16 v[56:59], v[168:171], v[240:243], v[56:59]
    v_cvt_pk_bf16_f32 v34, v36, v37
    v_cvt_pk_bf16_f32 v35, v38, v39
    v_mfma_f32_16x16x32_bf16 v[60:63], v[172:175], v[240:243], v[60:63]
    s_add_u32 s47, s48, 2105344
    buffer_store_dwordx4 v[32:35], v251, s[16:19], s47 offen sc1
    v_mfma_f32_16x16x32_bf16 v[48:51], v[200:203], v[244:247], v[48:51]
    v_cvt_pk_bf16_f32 v40, v40, v41
    v_cvt_pk_bf16_f32 v41, v42, v43
    v_mfma_f32_16x16x32_bf16 v[52:55], v[204:207], v[244:247], v[52:55]
    v_cvt_pk_bf16_f32 v42, v44, v45
    v_cvt_pk_bf16_f32 v43, v46, v47
    v_mfma_f32_16x16x32_bf16 v[56:59], v[192:195], v[244:247], v[56:59]
    s_add_u32 s47, s48, 2106368
    buffer_store_dwordx4 v[40:43], v251, s[16:19], s47 offen sc1
    v_mfma_f32_16x16x32_bf16 v[60:63], v[196:199], v[244:247], v[60:63]
    s_waitcnt lgkmcnt(2)
    v_mfma_f32_16x16x32_bf16 v[96:99], v[176:179], v[216:219], v[96:99]
    ds_read_b128 v[232:235], v250 offset:23552
    ds_read_b128 v[236:239], v250 offset:34816
    v_mfma_f32_16x16x32_bf16 v[100:103], v[180:183], v[216:219], v[100:103]
    v_mfma_f32_16x16x32_bf16 v[104:107], v[208:211], v[216:219], v[104:107]
    v_mfma_f32_16x16x32_bf16 v[108:111], v[212:215], v[216:219], v[108:111]
    v_mfma_f32_16x16x32_bf16 v[96:99], v[184:187], v[220:223], v[96:99]
    v_mfma_f32_16x16x32_bf16 v[100:103], v[188:191], v[220:223], v[100:103]
    v_mfma_f32_16x16x32_bf16 v[104:107], v[176:179], v[220:223], v[104:107]
    v_mfma_f32_16x16x32_bf16 v[108:111], v[180:183], v[220:223], v[108:111]
    s_waitcnt lgkmcnt(2)
    v_mfma_f32_16x16x32_bf16 v[64:67], v[192:195], v[224:227], v[64:67]
    ds_read_b128 v[240:243], v253 offset:21504
    ds_read_b128 v[244:247], v253 offset:32768
    v_mfma_f32_16x16x32_bf16 v[68:71], v[196:199], v[224:227], v[68:71]
    v_cvt_pk_bf16_f32 v48, v48, v49
    v_cvt_pk_bf16_f32 v49, v50, v51
    v_mfma_f32_16x16x32_bf16 v[72:75], v[168:171], v[224:227], v[72:75]
    v_cvt_pk_bf16_f32 v50, v52, v53
    v_cvt_pk_bf16_f32 v51, v54, v55
    v_mfma_f32_16x16x32_bf16 v[76:79], v[172:175], v[224:227], v[76:79]
    s_add_u32 s47, s48, 3158016
    buffer_store_dwordx4 v[48:51], v251, s[16:19], s47 offen sc1
    v_mfma_f32_16x16x32_bf16 v[64:67], v[200:203], v[228:231], v[64:67]
    v_cvt_pk_bf16_f32 v56, v56, v57
    v_cvt_pk_bf16_f32 v57, v58, v59
    v_mfma_f32_16x16x32_bf16 v[68:71], v[204:207], v[228:231], v[68:71]
    v_cvt_pk_bf16_f32 v58, v60, v61
    v_cvt_pk_bf16_f32 v59, v62, v63
    v_mfma_f32_16x16x32_bf16 v[72:75], v[192:195], v[228:231], v[72:75]
    s_add_u32 s47, s48, 3159040
    buffer_store_dwordx4 v[56:59], v251, s[16:19], s47 offen sc1
    v_mfma_f32_16x16x32_bf16 v[76:79], v[196:199], v[228:231], v[76:79]
    s_waitcnt lgkmcnt(2)
    v_mfma_f32_16x16x32_bf16 v[112:115], v[176:179], v[232:235], v[112:115]
    ds_read_b128 v[216:219], v250 offset:24576
    ds_read_b128 v[220:223], v250 offset:35840
    v_mfma_f32_16x16x32_bf16 v[116:119], v[180:183], v[232:235], v[116:119]
    v_mfma_f32_16x16x32_bf16 v[120:123], v[208:211], v[232:235], v[120:123]
    v_mfma_f32_16x16x32_bf16 v[124:127], v[212:215], v[232:235], v[124:127]
    v_mfma_f32_16x16x32_bf16 v[112:115], v[184:187], v[236:239], v[112:115]
    v_mfma_f32_16x16x32_bf16 v[116:119], v[188:191], v[236:239], v[116:119]
    v_mfma_f32_16x16x32_bf16 v[120:123], v[176:179], v[236:239], v[120:123]
    v_mfma_f32_16x16x32_bf16 v[124:127], v[180:183], v[236:239], v[124:127]
    s_waitcnt lgkmcnt(2)
    v_mfma_f32_16x16x32_bf16 v[80:83], v[192:195], v[240:243], v[80:83]
    ds_read_b128 v[224:227], v253 offset:22528
    ds_read_b128 v[228:231], v253 offset:33792
    v_mfma_f32_16x16x32_bf16 v[84:87], v[196:199], v[240:243], v[84:87]
    v_cvt_pk_bf16_f32 v64, v64, v65
    v_cvt_pk_bf16_f32 v65, v66, v67
    v_mfma_f32_16x16x32_bf16 v[88:91], v[168:171], v[240:243], v[88:91]
    v_cvt_pk_bf16_f32 v66, v68, v69
    v_cvt_pk_bf16_f32 v67, v70, v71
    v_mfma_f32_16x16x32_bf16 v[92:95], v[172:175], v[240:243], v[92:95]
    s_add_u32 s47, s48, 4210688
    buffer_store_dwordx4 v[64:67], v251, s[16:19], s47 offen sc1
    v_mfma_f32_16x16x32_bf16 v[80:83], v[200:203], v[244:247], v[80:83]
    v_cvt_pk_bf16_f32 v72, v72, v73
    v_cvt_pk_bf16_f32 v73, v74, v75
    v_mfma_f32_16x16x32_bf16 v[84:87], v[204:207], v[244:247], v[84:87]
    v_cvt_pk_bf16_f32 v74, v76, v77
    v_cvt_pk_bf16_f32 v75, v78, v79
    v_mfma_f32_16x16x32_bf16 v[88:91], v[192:195], v[244:247], v[88:91]
    s_add_u32 s47, s48, 4211712
    buffer_store_dwordx4 v[72:75], v251, s[16:19], s47 offen sc1
    v_mfma_f32_16x16x32_bf16 v[92:95], v[196:199], v[244:247], v[92:95]
    s_waitcnt lgkmcnt(2)
    v_mfma_f32_16x16x32_bf16 v[128:131], v[176:179], v[216:219], v[128:131]
    ds_read_b128 v[232:235], v250 offset:25600
    ds_read_b128 v[236:239], v250 offset:36864
    v_mfma_f32_16x16x32_bf16 v[132:135], v[180:183], v[216:219], v[132:135]
    v_mfma_f32_16x16x32_bf16 v[136:139], v[208:211], v[216:219], v[136:139]
    v_mfma_f32_16x16x32_bf16 v[140:143], v[212:215], v[216:219], v[140:143]
    v_mfma_f32_16x16x32_bf16 v[128:131], v[184:187], v[220:223], v[128:131]
    v_mfma_f32_16x16x32_bf16 v[132:135], v[188:191], v[220:223], v[132:135]
    v_mfma_f32_16x16x32_bf16 v[136:139], v[176:179], v[220:223], v[136:139]
    v_mfma_f32_16x16x32_bf16 v[140:143], v[180:183], v[220:223], v[140:143]
    s_waitcnt lgkmcnt(2)
    v_mfma_f32_16x16x32_bf16 v[96:99], v[192:195], v[224:227], v[96:99]
    ds_read_b128 v[240:243], v253 offset:23552
    ds_read_b128 v[244:247], v253 offset:34816
    v_mfma_f32_16x16x32_bf16 v[100:103], v[196:199], v[224:227], v[100:103]
    v_cvt_pk_bf16_f32 v80, v80, v81
    v_cvt_pk_bf16_f32 v81, v82, v83
    v_mfma_f32_16x16x32_bf16 v[104:107], v[168:171], v[224:227], v[104:107]
    v_cvt_pk_bf16_f32 v82, v84, v85
    v_cvt_pk_bf16_f32 v83, v86, v87
    v_mfma_f32_16x16x32_bf16 v[108:111], v[172:175], v[224:227], v[108:111]
    s_add_u32 s47, s48, 5263360
    buffer_store_dwordx4 v[80:83], v251, s[16:19], s47 offen sc1
    v_mfma_f32_16x16x32_bf16 v[96:99], v[200:203], v[228:231], v[96:99]
    v_cvt_pk_bf16_f32 v88, v88, v89
    v_cvt_pk_bf16_f32 v89, v90, v91
    v_mfma_f32_16x16x32_bf16 v[100:103], v[204:207], v[228:231], v[100:103]
    v_cvt_pk_bf16_f32 v90, v92, v93
    v_cvt_pk_bf16_f32 v91, v94, v95
    v_mfma_f32_16x16x32_bf16 v[104:107], v[192:195], v[228:231], v[104:107]
    s_add_u32 s47, s48, 5264384
    buffer_store_dwordx4 v[88:91], v251, s[16:19], s47 offen sc1
    v_mfma_f32_16x16x32_bf16 v[108:111], v[196:199], v[228:231], v[108:111]
    s_waitcnt lgkmcnt(2)
    v_mfma_f32_16x16x32_bf16 v[144:147], v[176:179], v[232:235], v[144:147]
    ds_read_b128 v[216:219], v250 offset:26624
    ds_read_b128 v[220:223], v250 offset:37888
    v_mfma_f32_16x16x32_bf16 v[148:151], v[180:183], v[232:235], v[148:151]
    v_mfma_f32_16x16x32_bf16 v[152:155], v[208:211], v[232:235], v[152:155]
    v_mfma_f32_16x16x32_bf16 v[156:159], v[212:215], v[232:235], v[156:159]
    v_mfma_f32_16x16x32_bf16 v[144:147], v[184:187], v[236:239], v[144:147]
    v_mfma_f32_16x16x32_bf16 v[148:151], v[188:191], v[236:239], v[148:151]
    v_mfma_f32_16x16x32_bf16 v[152:155], v[176:179], v[236:239], v[152:155]
    v_mfma_f32_16x16x32_bf16 v[156:159], v[180:183], v[236:239], v[156:159]
    s_waitcnt lgkmcnt(2)
    v_mfma_f32_16x16x32_bf16 v[112:115], v[192:195], v[240:243], v[112:115]
    ds_read_b128 v[224:227], v253 offset:24576
    ds_read_b128 v[228:231], v253 offset:35840
    v_mfma_f32_16x16x32_bf16 v[116:119], v[196:199], v[240:243], v[116:119]
    v_cvt_pk_bf16_f32 v96, v96, v97
    v_cvt_pk_bf16_f32 v97, v98, v99
    v_mfma_f32_16x16x32_bf16 v[120:123], v[168:171], v[240:243], v[120:123]
    v_cvt_pk_bf16_f32 v98, v100, v101
    v_cvt_pk_bf16_f32 v99, v102, v103
    v_mfma_f32_16x16x32_bf16 v[124:127], v[172:175], v[240:243], v[124:127]
    s_add_u32 s47, s48, 6316032
    buffer_store_dwordx4 v[96:99], v251, s[16:19], s47 offen sc1
    v_mfma_f32_16x16x32_bf16 v[112:115], v[200:203], v[244:247], v[112:115]
    v_cvt_pk_bf16_f32 v104, v104, v105
    v_cvt_pk_bf16_f32 v105, v106, v107
    v_mfma_f32_16x16x32_bf16 v[116:119], v[204:207], v[244:247], v[116:119]
    v_cvt_pk_bf16_f32 v106, v108, v109
    v_cvt_pk_bf16_f32 v107, v110, v111
    v_mfma_f32_16x16x32_bf16 v[120:123], v[192:195], v[244:247], v[120:123]
    s_add_u32 s47, s48, 6317056
    buffer_store_dwordx4 v[104:107], v251, s[16:19], s47 offen sc1
    v_mfma_f32_16x16x32_bf16 v[124:127], v[196:199], v[244:247], v[124:127]
    s_waitcnt lgkmcnt(2)
    v_mfma_f32_16x16x32_bf16 v[160:163], v[176:179], v[216:219], v[160:163]
    ds_read_b128 v[232:235], v253 offset:25600
    ds_read_b128 v[236:239], v253 offset:36864
    v_mfma_f32_16x16x32_bf16 v[164:167], v[208:211], v[216:219], v[164:167]
    v_mfma_f32_16x16x32_bf16 v[160:163], v[184:187], v[220:223], v[160:163]
    v_mfma_f32_16x16x32_bf16 v[164:167], v[176:179], v[220:223], v[164:167]
    s_waitcnt lgkmcnt(2)
    v_mfma_f32_16x16x32_bf16 v[128:131], v[192:195], v[224:227], v[128:131]
    ds_read_b128 v[240:243], v253 offset:26624
    ds_read_b128 v[244:247], v253 offset:37888
    v_mfma_f32_16x16x32_bf16 v[132:135], v[196:199], v[224:227], v[132:135]
    v_cvt_pk_bf16_f32 v112, v112, v113
    v_cvt_pk_bf16_f32 v113, v114, v115
    v_mfma_f32_16x16x32_bf16 v[136:139], v[168:171], v[224:227], v[136:139]
    v_cvt_pk_bf16_f32 v114, v116, v117
    v_cvt_pk_bf16_f32 v115, v118, v119
    v_mfma_f32_16x16x32_bf16 v[140:143], v[172:175], v[224:227], v[140:143]
    s_add_u32 s47, s48, 7368704
    buffer_store_dwordx4 v[112:115], v251, s[16:19], s47 offen sc1
    v_mfma_f32_16x16x32_bf16 v[128:131], v[200:203], v[228:231], v[128:131]
    v_cvt_pk_bf16_f32 v120, v120, v121
    v_cvt_pk_bf16_f32 v121, v122, v123
    v_mfma_f32_16x16x32_bf16 v[132:135], v[204:207], v[228:231], v[132:135]
    v_cvt_pk_bf16_f32 v122, v124, v125
    v_cvt_pk_bf16_f32 v123, v126, v127
    v_mfma_f32_16x16x32_bf16 v[136:139], v[192:195], v[228:231], v[136:139]
    s_add_u32 s47, s48, 7369728
    buffer_store_dwordx4 v[120:123], v251, s[16:19], s47 offen sc1
    v_mfma_f32_16x16x32_bf16 v[140:143], v[196:199], v[228:231], v[140:143]
    s_waitcnt lgkmcnt(2)
    v_mfma_f32_16x16x32_bf16 v[144:147], v[192:195], v[232:235], v[144:147]
    v_mfma_f32_16x16x32_bf16 v[148:151], v[196:199], v[232:235], v[148:151]
    v_mfma_f32_16x16x32_bf16 v[152:155], v[168:171], v[232:235], v[152:155]
    v_mfma_f32_16x16x32_bf16 v[156:159], v[172:175], v[232:235], v[156:159]
    v_mfma_f32_16x16x32_bf16 v[144:147], v[200:203], v[236:239], v[144:147]
    v_mfma_f32_16x16x32_bf16 v[148:151], v[204:207], v[236:239], v[148:151]
    v_mfma_f32_16x16x32_bf16 v[152:155], v[192:195], v[236:239], v[152:155]
    v_mfma_f32_16x16x32_bf16 v[156:159], v[196:199], v[236:239], v[156:159]
    s_waitcnt lgkmcnt(0)
    v_mfma_f32_16x16x32_bf16 v[160:163], v[192:195], v[240:243], v[160:163]
    v_mfma_f32_16x16x32_bf16 v[164:167], v[168:171], v[240:243], v[164:167]
    v_cvt_pk_bf16_f32 v128, v128, v129
    v_cvt_pk_bf16_f32 v129, v130, v131
    v_mfma_f32_16x16x32_bf16 v[160:163], v[200:203], v[244:247], v[160:163]
    v_cvt_pk_bf16_f32 v130, v132, v133
    v_cvt_pk_bf16_f32 v131, v134, v135
    v_mfma_f32_16x16x32_bf16 v[164:167], v[192:195], v[244:247], v[164:167]
    s_add_u32 s47, s48, 8421376
    buffer_store_dwordx4 v[128:131], v251, s[16:19], s47 offen sc1
    s_nop 7
    v_cvt_pk_bf16_f32 v136, v136, v137
    v_cvt_pk_bf16_f32 v137, v138, v139
    v_cvt_pk_bf16_f32 v138, v140, v141
    v_cvt_pk_bf16_f32 v139, v142, v143
    s_add_u32 s47, s48, 8422400
    buffer_store_dwordx4 v[136:139], v251, s[16:19], s47 offen sc1
    v_cvt_pk_bf16_f32 v144, v144, v145
    v_cvt_pk_bf16_f32 v145, v146, v147
    v_cvt_pk_bf16_f32 v146, v148, v149
    v_cvt_pk_bf16_f32 v147, v150, v151
    s_add_u32 s47, s48, 9474048
    buffer_store_dwordx4 v[144:147], v251, s[16:19], s47 offen sc1
    v_cvt_pk_bf16_f32 v152, v152, v153
    v_cvt_pk_bf16_f32 v153, v154, v155
    v_cvt_pk_bf16_f32 v154, v156, v157
    v_cvt_pk_bf16_f32 v155, v158, v159
    s_add_u32 s47, s48, 9475072
    buffer_store_dwordx4 v[152:155], v251, s[16:19], s47 offen sc1
    v_cvt_pk_bf16_f32 v160, v160, v161
    v_cvt_pk_bf16_f32 v161, v162, v163
    s_add_u32 s47, s49, 0
    buffer_store_dwordx2 v[160:161], v252, s[16:19], s47 offen sc1
    v_cvt_pk_bf16_f32 v164, v164, v165
    v_cvt_pk_bf16_f32 v165, v166, v167
    s_add_u32 s47, s49, 1024
    buffer_store_dwordx2 v[164:165], v252, s[16:19], s47 offen sc1
    s_branch L_epi_done
L_epi_b1:
    v_add_u32 v248, 0x9800, v248
    v_add_u32 v249, 0x9800, v249
    v_add_u32 v253, 38912, v250
    ds_read_b64_tr_b16 v[192:193], v248 offset:0
    ds_read_b64_tr_b16 v[194:195], v248 offset:1024
    ds_read_b64_tr_b16 v[196:197], v249 offset:0
    ds_read_b64_tr_b16 v[198:199], v249 offset:1024
    ds_read_b64_tr_b16 v[200:201], v248 offset:8192
    ds_read_b64_tr_b16 v[202:203], v248 offset:9216
    ds_read_b64_tr_b16 v[204:205], v249 offset:8192
    ds_read_b64_tr_b16 v[206:207], v249 offset:9216
    s_waitcnt lgkmcnt(10)
    v_mfma_f32_16x16x32_bf16 v[0:3], v[176:179], v[232:235], v[0:3]
    ds_read_b128 v[216:219], v250 offset:18432
    ds_read_b128 v[220:223], v250 offset:29696
    v_mfma_f32_16x16x32_bf16 v[4:7], v[180:183], v[232:235], v[4:7]
    v_mfma_f32_16x16x32_bf16 v[8:11], v[208:211], v[232:235], v[8:11]
    v_mfma_f32_16x16x32_bf16 v[12:15], v[212:215], v[232:235], v[12:15]
    v_mfma_f32_16x16x32_bf16 v[0:3], v[184:187], v[236:239], v[0:3]
    v_mfma_f32_16x16x32_bf16 v[4:7], v[188:191], v[236:239], v[4:7]
    v_mfma_f32_16x16x32_bf16 v[8:11], v[176:179], v[236:239], v[8:11]
    v_mfma_f32_16x16x32_bf16 v[12:15], v[180:183], v[236:239], v[12:15]
    s_waitcnt lgkmcnt(10)
    v_mfma_f32_16x16x32_bf16 v[16:19], v[176:179], v[240:243], v[16:19]
    ds_read_b128 v[224:227], v253 offset:16384
    ds_read_b128 v[228:231], v253 offset:27648
    v_mfma_f32_16x16x32_bf16 v[20:23], v[180:183], v[240:243], v[20:23]
    v_mfma_f32_16x16x32_bf16 v[24:27], v[208:211], v[240:243], v[24:27]
    v_mfma_f32_16x16x32_bf16 v[28:31], v[212:215], v[240:243], v[28:31]
    v_mfma_f32_16x16x32_bf16 v[16:19], v[184:187], v[244:247], v[16:19]
    v_mfma_f32_16x16x32_bf16 v[20:23], v[188:191], v[244:247], v[20:23]
    v_mfma_f32_16x16x32_bf16 v[24:27], v[176:179], v[244:247], v[24:27]
    v_mfma_f32_16x16x32_bf16 v[28:31], v[180:183], v[244:247], v[28:31]
    s_waitcnt lgkmcnt(2)
    v_mfma_f32_16x16x32_bf16 v[32:35], v[176:179], v[216:219], v[32:35]
    ds_read_b128 v[232:235], v250 offset:19456
    ds_read_b128 v[236:239], v250 offset:30720
    v_mfma_f32_16x16x32_bf16 v[36:39], v[180:183], v[216:219], v[36:39]
    v_mfma_f32_16x16x32_bf16 v[40:43], v[208:211], v[216:219], v[40:43]
    v_mfma_f32_16x16x32_bf16 v[44:47], v[212:215], v[216:219], v[44:47]
    v_mfma_f32_16x16x32_bf16 v[32:35], v[184:187], v[220:223], v[32:35]
    v_mfma_f32_16x16x32_bf16 v[36:39], v[188:191], v[220:223], v[36:39]
    v_mfma_f32_16x16x32_bf16 v[40:43], v[176:179], v[220:223], v[40:43]
    v_mfma_f32_16x16x32_bf16 v[44:47], v[180:183], v[220:223], v[44:47]
    v_xor_b32 v168, 0x80008000, v200
    v_xor_b32 v169, 0x80008000, v201
    v_xor_b32 v170, 0x80008000, v202
    v_xor_b32 v171, 0x80008000, v203
    v_xor_b32 v172, 0x80008000, v204
    v_xor_b32 v173, 0x80008000, v205
    v_xor_b32 v174, 0x80008000, v206
    v_xor_b32 v175, 0x80008000, v207
    s_waitcnt lgkmcnt(2)
    v_mfma_f32_16x16x32_bf16 v[0:3], v[192:195], v[224:227], v[0:3]
    ds_read_b128 v[240:243], v253 offset:17408
    ds_read_b128 v[244:247], v253 offset:28672
    v_mfma_f32_16x16x32_bf16 v[4:7], v[196:199], v[224:227], v[4:7]
    v_mfma_f32_16x16x32_bf16 v[8:11], v[168:171], v[224:227], v[8:11]
    v_mfma_f32_16x16x32_bf16 v[12:15], v[172:175], v[224:227], v[12:15]
    v_mfma_f32_16x16x32_bf16 v[0:3], v[200:203], v[228:231], v[0:3]
    v_mfma_f32_16x16x32_bf16 v[4:7], v[204:207], v[228:231], v[4:7]
    v_mfma_f32_16x16x32_bf16 v[8:11], v[192:195], v[228:231], v[8:11]
    v_mfma_f32_16x16x32_bf16 v[12:15], v[196:199], v[228:231], v[12:15]
    s_waitcnt lgkmcnt(2)
    v_mfma_f32_16x16x32_bf16 v[48:51], v[176:179], v[232:235], v[48:51]
    ds_read_b128 v[216:219], v250 offset:20480
    ds_read_b128 v[220:223], v250 offset:31744
    v_mfma_f32_16x16x32_bf16 v[52:55], v[180:183], v[232:235], v[52:55]
    v_mfma_f32_16x16x32_bf16 v[56:59], v[208:211], v[232:235], v[56:59]
    v_mfma_f32_16x16x32_bf16 v[60:63], v[212:215], v[232:235], v[60:63]
    v_mfma_f32_16x16x32_bf16 v[48:51], v[184:187], v[236:239], v[48:51]
    v_mfma_f32_16x16x32_bf16 v[52:55], v[188:191], v[236:239], v[52:55]
    v_mfma_f32_16x16x32_bf16 v[56:59], v[176:179], v[236:239], v[56:59]
    v_mfma_f32_16x16x32_bf16 v[60:63], v[180:183], v[236:239], v[60:63]
    s_waitcnt lgkmcnt(2)
    v_mfma_f32_16x16x32_bf16 v[16:19], v[192:195], v[240:243], v[16:19]
    ds_read_b128 v[224:227], v253 offset:18432
    ds_read_b128 v[228:231], v253 offset:29696
    v_mfma_f32_16x16x32_bf16 v[20:23], v[196:199], v[240:243], v[20:23]
    v_cvt_pk_bf16_f32 v4, v4, v5
    v_cvt_pk_bf16_f32 v5, v6, v7
    v_mfma_f32_16x16x32_bf16 v[24:27], v[168:171], v[240:243], v[24:27]
    v_cvt_pk_bf16_f32 v6, v0, v1
    v_cvt_pk_bf16_f32 v7, v2, v3
    v_mfma_f32_16x16x32_bf16 v[28:31], v[172:175], v[240:243], v[28:31]
    s_add_u32 s47, s48, 0
    buffer_store_dwordx4 v[4:7], v251, s[16:19], s47 offen sc1
    v_mfma_f32_16x16x32_bf16 v[16:19], v[200:203], v[244:247], v[16:19]
    v_cvt_pk_bf16_f32 v12, v12, v13
    v_cvt_pk_bf16_f32 v13, v14, v15
    v_mfma_f32_16x16x32_bf16 v[20:23], v[204:207], v[244:247], v[20:23]
    v_cvt_pk_bf16_f32 v14, v8, v9
    v_cvt_pk_bf16_f32 v15, v10, v11
    v_mfma_f32_16x16x32_bf16 v[24:27], v[192:195], v[244:247], v[24:27]
    s_add_u32 s47, s48, 1024
    buffer_store_dwordx4 v[12:15], v251, s[16:19], s47 offen sc1
    v_mfma_f32_16x16x32_bf16 v[28:31], v[196:199], v[244:247], v[28:31]
    s_waitcnt lgkmcnt(2)
    v_mfma_f32_16x16x32_bf16 v[64:67], v[176:179], v[216:219], v[64:67]
    ds_read_b128 v[232:235], v250 offset:21504
    ds_read_b128 v[236:239], v250 offset:32768
    v_mfma_f32_16x16x32_bf16 v[68:71], v[180:183], v[216:219], v[68:71]
    v_mfma_f32_16x16x32_bf16 v[72:75], v[208:211], v[216:219], v[72:75]
    v_mfma_f32_16x16x32_bf16 v[76:79], v[212:215], v[216:219], v[76:79]
    v_mfma_f32_16x16x32_bf16 v[64:67], v[184:187], v[220:223], v[64:67]
    v_mfma_f32_16x16x32_bf16 v[68:71], v[188:191], v[220:223], v[68:71]
    v_mfma_f32_16x16x32_bf16 v[72:75], v[176:179], v[220:223], v[72:75]
    v_mfma_f32_16x16x32_bf16 v[76:79], v[180:183], v[220:223], v[76:79]
    s_waitcnt lgkmcnt(2)
    v_mfma_f32_16x16x32_bf16 v[32:35], v[192:195], v[224:227], v[32:35]
    ds_read_b128 v[240:243], v253 offset:19456
    ds_read_b128 v[244:247], v253 offset:30720
    v_mfma_f32_16x16x32_bf16 v[36:39], v[196:199], v[224:227], v[36:39]
    v_cvt_pk_bf16_f32 v20, v20, v21
    v_cvt_pk_bf16_f32 v21, v22, v23
    v_mfma_f32_16x16x32_bf16 v[40:43], v[168:171], v[224:227], v[40:43]
    v_cvt_pk_bf16_f32 v22, v16, v17
    v_cvt_pk_bf16_f32 v23, v18, v19
    v_mfma_f32_16x16x32_bf16 v[44:47], v[172:175], v[224:227], v[44:47]
    s_add_u32 s47, s48, 1052672
    buffer_store_dwordx4 v[20:23], v251, s[16:19], s47 offen sc1
    v_mfma_f32_16x16x32_bf16 v[32:35], v[200:203], v[228:231], v[32:35]
    v_cvt_pk_bf16_f32 v28, v28, v29
    v_cvt_pk_bf16_f32 v29, v30, v31
    v_mfma_f32_16x16x32_bf16 v[36:39], v[204:207], v[228:231], v[36:39]
    v_cvt_pk_bf16_f32 v30, v24, v25
    v_cvt_pk_bf16_f32 v31, v26, v27
    v_mfma_f32_16x16x32_bf16 v[40:43], v[192:195], v[228:231], v[40:43]
    s_add_u32 s47, s48, 1053696
    buffer_store_dwordx4 v[28:31], v251, s[16:19], s47 offen sc1
    v_mfma_f32_16x16x32_bf16 v[44:47], v[196:199], v[228:231], v[44:47]
    s_waitcnt lgkmcnt(2)
    v_mfma_f32_16x16x32_bf16 v[80:83], v[176:179], v[232:235], v[80:83]
    ds_read_b128 v[216:219], v250 offset:22528
    ds_read_b128 v[220:223], v250 offset:33792
    v_mfma_f32_16x16x32_bf16 v[84:87], v[180:183], v[232:235], v[84:87]
    v_mfma_f32_16x16x32_bf16 v[88:91], v[208:211], v[232:235], v[88:91]
    v_mfma_f32_16x16x32_bf16 v[92:95], v[212:215], v[232:235], v[92:95]
    v_mfma_f32_16x16x32_bf16 v[80:83], v[184:187], v[236:239], v[80:83]
    v_mfma_f32_16x16x32_bf16 v[84:87], v[188:191], v[236:239], v[84:87]
    v_mfma_f32_16x16x32_bf16 v[88:91], v[176:179], v[236:239], v[88:91]
    v_mfma_f32_16x16x32_bf16 v[92:95], v[180:183], v[236:239], v[92:95]
    s_waitcnt lgkmcnt(2)
    v_mfma_f32_16x16x32_bf16 v[48:51], v[192:195], v[240:243], v[48:51]
    ds_read_b128 v[224:227], v253 offset:20480
    ds_read_b128 v[228:231], v253 offset:31744
    v_mfma_f32_16x16x32_bf16 v[52:55], v[196:199], v[240:243], v[52:55]
    v_cvt_pk_bf16_f32 v36, v36, v37
    v_cvt_pk_bf16_f32 v37, v38, v39
    v_mfma_f32_16x16x32_bf16 v[56:59], v[168:171], v[240:243], v[56:59]
    v_cvt_pk_bf16_f32 v38, v32, v33
    v_cvt_pk_bf16_f32 v39, v34, v35
    v_mfma_f32_16x16x32_bf16 v[60:63], v[172:175], v[240:243], v[60:63]
    s_add_u32 s47, s48, 2105344
    buffer_store_dwordx4 v[36:39], v251, s[16:19], s47 offen sc1
    v_mfma_f32_16x16x32_bf16 v[48:51], v[200:203], v[244:247], v[48:51]
    v_cvt_pk_bf16_f32 v44, v44, v45
    v_cvt_pk_bf16_f32 v45, v46, v47
    v_mfma_f32_16x16x32_bf16 v[52:55], v[204:207], v[244:247], v[52:55]
    v_cvt_pk_bf16_f32 v46, v40, v41
    v_cvt_pk_bf16_f32 v47, v42, v43
    v_mfma_f32_16x16x32_bf16 v[56:59], v[192:195], v[244:247], v[56:59]
    s_add_u32 s47, s48, 2106368
    buffer_store_dwordx4 v[44:47], v251, s[16:19], s47 offen sc1
    v_mfma_f32_16x16x32_bf16 v[60:63], v[196:199], v[244:247], v[60:63]
    s_waitcnt lgkmcnt(2)
    v_mfma_f32_16x16x32_bf16 v[96:99], v[176:179], v[216:219], v[96:99]
    ds_read_b128 v[232:235], v250 offset:23552
    ds_read_b128 v[236:239], v250 offset:34816
    v_mfma_f32_16x16x32_bf16 v[100:103], v[180:183], v[216:219], v[100:103]
    v_mfma_f32_16x16x32_bf16 v[104:107], v[208:211], v[216:219], v[104:107]
    v_mfma_f32_16x16x32_bf16 v[108:111], v[212:215], v[216:219], v[108:111]
    v_mfma_f32_16x16x32_bf16 v[96:99], v[184:187], v[220:223], v[96:99]
    v_mfma_f32_16x16x32_bf16 v[100:103], v[188:191], v[220:223], v[100:103]
    v_mfma_f32_16x16x32_bf16 v[104:107], v[176:179], v[220:223], v[104:107]
    v_mfma_f32_16x16x32_bf16 v[108:111], v[180:183], v[220:223], v[108:111]
    s_waitcnt lgkmcnt(2)
    v_mfma_f32_16x16x32_bf16 v[64:67], v[192:195], v[224:227], v[64:67]
    ds_read_b128 v[240:243], v253 offset:21504
    ds_read_b128 v[244:247], v253 offset:32768
    v_mfma_f32_16x16x32_bf16 v[68:71], v[196:199], v[224:227], v[68:71]
    v_cvt_pk_bf16_f32 v52, v52, v53
    v_cvt_pk_bf16_f32 v53, v54, v55
    v_mfma_f32_16x16x32_bf16 v[72:75], v[168:171], v[224:227], v[72:75]
    v_cvt_pk_bf16_f32 v54, v48, v49
    v_cvt_pk_bf16_f32 v55, v50, v51
    v_mfma_f32_16x16x32_bf16 v[76:79], v[172:175], v[224:227], v[76:79]
    s_add_u32 s47, s48, 3158016
    buffer_store_dwordx4 v[52:55], v251, s[16:19], s47 offen sc1
    v_mfma_f32_16x16x32_bf16 v[64:67], v[200:203], v[228:231], v[64:67]
    v_cvt_pk_bf16_f32 v60, v60, v61
    v_cvt_pk_bf16_f32 v61, v62, v63
    v_mfma_f32_16x16x32_bf16 v[68:71], v[204:207], v[228:231], v[68:71]
    v_cvt_pk_bf16_f32 v62, v56, v57
    v_cvt_pk_bf16_f32 v63, v58, v59
    v_mfma_f32_16x16x32_bf16 v[72:75], v[192:195], v[228:231], v[72:75]
    s_add_u32 s47, s48, 3159040
    buffer_store_dwordx4 v[60:63], v251, s[16:19], s47 offen sc1
    v_mfma_f32_16x16x32_bf16 v[76:79], v[196:199], v[228:231], v[76:79]
    s_waitcnt lgkmcnt(2)
    v_mfma_f32_16x16x32_bf16 v[112:115], v[176:179], v[232:235], v[112:115]
    ds_read_b128 v[216:219], v250 offset:24576
    ds_read_b128 v[220:223], v250 offset:35840
    v_mfma_f32_16x16x32_bf16 v[116:119], v[180:183], v[232:235], v[116:119]
    v_mfma_f32_16x16x32_bf16 v[120:123], v[208:211], v[232:235], v[120:123]
    v_mfma_f32_16x16x32_bf16 v[124:127], v[212:215], v[232:235], v[124:127]
    v_mfma_f32_16x16x32_bf16 v[112:115], v[184:187], v[236:239], v[112:115]
    v_mfma_f32_16x16x32_bf16 v[116:119], v[188:191], v[236:239], v[116:119]
    v_mfma_f32_16x16x32_bf16 v[120:123], v[176:179], v[236:239], v[120:123]
    v_mfma_f32_16x16x32_bf16 v[124:127], v[180:183], v[236:239], v[124:127]
    s_waitcnt lgkmcnt(2)
    v_mfma_f32_16x16x32_bf16 v[80:83], v[192:195], v[240:243], v[80:83]
    ds_read_b128 v[224:227], v253 offset:22528
    ds_read_b128 v[228:231], v253 offset:33792
    v_mfma_f32_16x16x32_bf16 v[84:87], v[196:199], v[240:243], v[84:87]
    v_cvt_pk_bf16_f32 v68, v68, v69
    v_cvt_pk_bf16_f32 v69, v70, v71
    v_mfma_f32_16x16x32_bf16 v[88:91], v[168:171], v[240:243], v[88:91]
    v_cvt_pk_bf16_f32 v70, v64, v65
    v_cvt_pk_bf16_f32 v71, v66, v67
    v_mfma_f32_16x16x32_bf16 v[92:95], v[172:175], v[240:243], v[92:95]
    s_add_u32 s47, s48, 4210688
    buffer_store_dwordx4 v[68:71], v251, s[16:19], s47 offen sc1
    v_mfma_f32_16x16x32_bf16 v[80:83], v[200:203], v[244:247], v[80:83]
    v_cvt_pk_bf16_f32 v76, v76, v77
    v_cvt_pk_bf16_f32 v77, v78, v79
    v_mfma_f32_16x16x32_bf16 v[84:87], v[204:207], v[244:247], v[84:87]
    v_cvt_pk_bf16_f32 v78, v72, v73
    v_cvt_pk_bf16_f32 v79, v74, v75
    v_mfma_f32_16x16x32_bf16 v[88:91], v[192:195], v[244:247], v[88:91]
    s_add_u32 s47, s48, 4211712
    buffer_store_dwordx4 v[76:79], v251, s[16:19], s47 offen sc1
    v_mfma_f32_16x16x32_bf16 v[92:95], v[196:199], v[244:247], v[92:95]
    s_waitcnt lgkmcnt(2)
    v_mfma_f32_16x16x32_bf16 v[128:131], v[176:179], v[216:219], v[128:131]
    ds_read_b128 v[232:235], v250 offset:25600
    ds_read_b128 v[236:239], v250 offset:36864
    v_mfma_f32_16x16x32_bf16 v[132:135], v[180:183], v[216:219], v[132:135]
    v_mfma_f32_16x16x32_bf16 v[136:139], v[208:211], v[216:219], v[136:139]
    v_mfma_f32_16x16x32_bf16 v[140:143], v[212:215], v[216:219], v[140:143]
    v_mfma_f32_16x16x32_bf16 v[128:131], v[184:187], v[220:223], v[128:131]
    v_mfma_f32_16x16x32_bf16 v[132:135], v[188:191], v[220:223], v[132:135]
    v_mfma_f32_16x16x32_bf16 v[136:139], v[176:179], v[220:223], v[136:139]
    v_mfma_f32_16x16x32_bf16 v[140:143], v[180:183], v[220:223], v[140:143]
    s_waitcnt lgkmcnt(2)
    v_mfma_f32_16x16x32_bf16 v[96:99], v[192:195], v[224:227], v[96:99]
    ds_read_b128 v[240:243], v253 offset:23552
    ds_read_b128 v[244:247], v253 offset:34816
    v_mfma_f32_16x16x32_bf16 v[100:103], v[196:199], v[224:227], v[100:103]
    v_cvt_pk_bf16_f32 v84, v84, v85
    v_cvt_pk_bf16_f32 v85, v86, v87
    v_mfma_f32_16x16x32_bf16 v[104:107], v[168:171], v[224:227], v[104:107]
    v_cvt_pk_bf16_f32 v86, v80, v81
    v_cvt_pk_bf16_f32 v87, v82, v83
    v_mfma_f32_16x16x32_bf16 v[108:111], v[172:175], v[224:227], v[108:111]
    s_add_u32 s47, s48, 5263360
    buffer_store_dwordx4 v[84:87], v251, s[16:19], s47 offen sc1
    v_mfma_f32_16x16x32_bf16 v[96:99], v[200:203], v[228:231], v[96:99]
    v_cvt_pk_bf16_f32 v92, v92, v93
    v_cvt_pk_bf16_f32 v93, v94, v95
    v_mfma_f32_16x16x32_bf16 v[100:103], v[204:207], v[228:231], v[100:103]
    v_cvt_pk_bf16_f32 v94, v88, v89
    v_cvt_pk_bf16_f32 v95, v90, v91
    v_mfma_f32_16x16x32_bf16 v[104:107], v[192:195], v[228:231], v[104:107]
    s_add_u32 s47, s48, 5264384
    buffer_store_dwordx4 v[92:95], v251, s[16:19], s47 offen sc1
    v_mfma_f32_16x16x32_bf16 v[108:111], v[196:199], v[228:231], v[108:111]
    s_waitcnt lgkmcnt(2)
    v_mfma_f32_16x16x32_bf16 v[144:147], v[176:179], v[232:235], v[144:147]
    ds_read_b128 v[216:219], v250 offset:26624
    ds_read_b128 v[220:223], v250 offset:37888
    v_mfma_f32_16x16x32_bf16 v[148:151], v[180:183], v[232:235], v[148:151]
    v_mfma_f32_16x16x32_bf16 v[152:155], v[208:211], v[232:235], v[152:155]
    v_mfma_f32_16x16x32_bf16 v[156:159], v[212:215], v[232:235], v[156:159]
    v_mfma_f32_16x16x32_bf16 v[144:147], v[184:187], v[236:239], v[144:147]
    v_mfma_f32_16x16x32_bf16 v[148:151], v[188:191], v[236:239], v[148:151]
    v_mfma_f32_16x16x32_bf16 v[152:155], v[176:179], v[236:239], v[152:155]
    v_mfma_f32_16x16x32_bf16 v[156:159], v[180:183], v[236:239], v[156:159]
    s_waitcnt lgkmcnt(2)
    v_mfma_f32_16x16x32_bf16 v[112:115], v[192:195], v[240:243], v[112:115]
    ds_read_b128 v[224:227], v253 offset:24576
    ds_read_b128 v[228:231], v253 offset:35840
    v_mfma_f32_16x16x32_bf16 v[116:119], v[196:199], v[240:243], v[116:119]
    v_cvt_pk_bf16_f32 v100, v100, v101
    v_cvt_pk_bf16_f32 v101, v102, v103
    v_mfma_f32_16x16x32_bf16 v[120:123], v[168:171], v[240:243], v[120:123]
    v_cvt_pk_bf16_f32 v102, v96, v97
    v_cvt_pk_bf16_f32 v103, v98, v99
    v_mfma_f32_16x16x32_bf16 v[124:127], v[172:175], v[240:243], v[124:127]
    s_add_u32 s47, s48, 6316032
    buffer_store_dwordx4 v[100:103], v251, s[16:19], s47 offen sc1
    v_mfma_f32_16x16x32_bf16 v[112:115], v[200:203], v[244:247], v[112:115]
    v_cvt_pk_bf16_f32 v108, v108, v109
    v_cvt_pk_bf16_f32 v109, v110, v111
    v_mfma_f32_16x16x32_bf16 v[116:119], v[204:207], v[244:247], v[116:119]
    v_cvt_pk_bf16_f32 v110, v104, v105
    v_cvt_pk_bf16_f32 v111, v106, v107
    v_mfma_f32_16x16x32_bf16 v[120:123], v[192:195], v[244:247], v[120:123]
    s_add_u32 s47, s48, 6317056
    buffer_store_dwordx4 v[108:111], v251, s[16:19], s47 offen sc1
    v_mfma_f32_16x16x32_bf16 v[124:127], v[196:199], v[244:247], v[124:127]
    s_waitcnt lgkmcnt(2)
    v_mfma_f32_16x16x32_bf16 v[160:163], v[176:179], v[216:219], v[160:163]
    ds_read_b128 v[232:235], v253 offset:25600
    ds_read_b128 v[236:239], v253 offset:36864
    v_mfma_f32_16x16x32_bf16 v[164:167], v[208:211], v[216:219], v[164:167]
    v_mfma_f32_16x16x32_bf16 v[160:163], v[184:187], v[220:223], v[160:163]
    v_mfma_f32_16x16x32_bf16 v[164:167], v[176:179], v[220:223], v[164:167]
    s_waitcnt lgkmcnt(2)
    v_mfma_f32_16x16x32_bf16 v[128:131], v[192:195], v[224:227], v[128:131]
    ds_read_b128 v[240:243], v253 offset:26624
    ds_read_b128 v[244:247], v253 offset:37888
    v_mfma_f32_16x16x32_bf16 v[132:135], v[196:199], v[224:227], v[132:135]
    v_cvt_pk_bf16_f32 v116, v116, v117
    v_cvt_pk_bf16_f32 v117, v118, v119
    v_mfma_f32_16x16x32_bf16 v[136:139], v[168:171], v[224:227], v[136:139]
    v_cvt_pk_bf16_f32 v118, v112, v113
    v_cvt_pk_bf16_f32 v119, v114, v115
    v_mfma_f32_16x16x32_bf16 v[140:143], v[172:175], v[224:227], v[140:143]
    s_add_u32 s47, s48, 7368704
    buffer_store_dwordx4 v[116:119], v251, s[16:19], s47 offen sc1
    v_mfma_f32_16x16x32_bf16 v[128:131], v[200:203], v[228:231], v[128:131]
    v_cvt_pk_bf16_f32 v124, v124, v125
    v_cvt_pk_bf16_f32 v125, v126, v127
    v_mfma_f32_16x16x32_bf16 v[132:135], v[204:207], v[228:231], v[132:135]
    v_cvt_pk_bf16_f32 v126, v120, v121
    v_cvt_pk_bf16_f32 v127, v122, v123
    v_mfma_f32_16x16x32_bf16 v[136:139], v[192:195], v[228:231], v[136:139]
    s_add_u32 s47, s48, 7369728
    buffer_store_dwordx4 v[124:127], v251, s[16:19], s47 offen sc1
    v_mfma_f32_16x16x32_bf16 v[140:143], v[196:199], v[228:231], v[140:143]
    s_waitcnt lgkmcnt(2)
    v_mfma_f32_16x16x32_bf16 v[144:147], v[192:195], v[232:235], v[144:147]
    v_mfma_f32_16x16x32_bf16 v[148:151], v[196:199], v[232:235], v[148:151]
    v_mfma_f32_16x16x32_bf16 v[152:155], v[168:171], v[232:235], v[152:155]
    v_mfma_f32_16x16x32_bf16 v[156:159], v[172:175], v[232:235], v[156:159]
    v_mfma_f32_16x16x32_bf16 v[144:147], v[200:203], v[236:239], v[144:147]
    v_mfma_f32_16x16x32_bf16 v[148:151], v[204:207], v[236:239], v[148:151]
    v_mfma_f32_16x16x32_bf16 v[152:155], v[192:195], v[236:239], v[152:155]
    v_mfma_f32_16x16x32_bf16 v[156:159], v[196:199], v[236:239], v[156:159]
    s_waitcnt lgkmcnt(0)
    v_mfma_f32_16x16x32_bf16 v[160:163], v[192:195], v[240:243], v[160:163]
    v_mfma_f32_16x16x32_bf16 v[164:167], v[168:171], v[240:243], v[164:167]
    v_cvt_pk_bf16_f32 v132, v132, v133
    v_cvt_pk_bf16_f32 v133, v134, v135
    v_mfma_f32_16x16x32_bf16 v[160:163], v[200:203], v[244:247], v[160:163]
    v_cvt_pk_bf16_f32 v134, v128, v129
    v_cvt_pk_bf16_f32 v135, v130, v131
    v_mfma_f32_16x16x32_bf16 v[164:167], v[192:195], v[244:247], v[164:167]
    s_add_u32 s47, s48, 8421376
    buffer_store_dwordx4 v[132:135], v251, s[16:19], s47 offen sc1
    s_nop 7
    v_cvt_pk_bf16_f32 v140, v140, v141
    v_cvt_pk_bf16_f32 v141, v142, v143
    v_cvt_pk_bf16_f32 v142, v136, v137
    v_cvt_pk_bf16_f32 v143, v138, v139
    s_add_u32 s47, s48, 8422400
    buffer_store_dwordx4 v[140:143], v251, s[16:19], s47 offen sc1
    v_cvt_pk_bf16_f32 v148, v148, v149
    v_cvt_pk_bf16_f32 v149, v150, v151
    v_cvt_pk_bf16_f32 v150, v144, v145
    v_cvt_pk_bf16_f32 v151, v146, v147
    s_add_u32 s47, s48, 9474048
    buffer_store_dwordx4 v[148:151], v251, s[16:19], s47 offen sc1
    v_cvt_pk_bf16_f32 v156, v156, v157
    v_cvt_pk_bf16_f32 v157, v158, v159
    v_cvt_pk_bf16_f32 v158, v152, v153
    v_cvt_pk_bf16_f32 v159, v154, v155
    s_add_u32 s47, s48, 9475072
    buffer_store_dwordx4 v[156:159], v251, s[16:19], s47 offen sc1
    v_cvt_pk_bf16_f32 v160, v160, v161
    v_cvt_pk_bf16_f32 v161, v162, v163
    s_add_u32 s47, s49, 0
    buffer_store_dwordx2 v[160:161], v252, s[16:19], s47 offen sc1
    v_cvt_pk_bf16_f32 v164, v164, v165
    v_cvt_pk_bf16_f32 v165, v166, v167
    s_add_u32 s47, s49, 1024
    buffer_store_dwordx2 v[164:165], v252, s[16:19], s47 offen sc1
L_epi_done:
    s_endpgm
L_k3_helper:
    s_mul_i32 s40, s11, 16384
    s_mul_i32 s20, s14, 16777216
    s_add_u32 s40, s40, s20
    s_mul_i32 s41, s11, 21504
    s_mul_i32 s20, s13, 22020096
    s_add_u32 s41, s41, s20
    s_add_u32 s41, s41, 67108864
    s_lshl_b32 s42, s15, 12
    s_mul_i32 s43, s15, 5632
    s_lshr_b32 s20, s15, 1
    s_lshl_b32 s21, s20, 9
    s_sub_u32 s21, s43, s21
    v_lshlrev_b32 v1, 4, v0
    v_add_u32 v2, s21, v1
    s_add_u32 s22, s21, 4096
    v_add_u32 v5, s22, v1
    s_mov_b32 s44, s41
    s_bitcmp1_b32 s15, 0
    s_cbranch_scc0 L_six_even
    s_mul_i32 s22, s20, 10752
    s_add_u32 s22, s22, 9216
    v_lshrrev_b32 v5, 2, v0
    v_lshlrev_b32 v5, 6, v5
    v_and_b32 v3, 3, v0
    v_xor_b32 v3, 3, v3
    v_lshl_add_u32 v5, v3, 4, v5
    v_add_u32 v5, s22, v5
    s_mul_i32 s44, s11, 21504
    s_xor_b32 s22, s13, 1
    s_mul_i32 s22, s22, 22020096
    s_add_u32 s44, s44, s22
    s_add_u32 s44, s44, 67108864
L_six_even:
    s_mov_b32 s50, -1
    s_mov_b32 s51, 0
    v_add_u32 v1, s42, v1
    s_add_u32 s43, s43, 16384
    s_cmp_ge_u32 s2, 8
    s_cbranch_scc1 L_nozero
    s_cmp_lg_u32 s15, 0
    s_cbranch_scc1 L_nozero
    s_mul_i32 s20, s2, 8448
    s_add_u32 s20, s20, 147849216
    v_mov_b32 v3, 0
    v_lshlrev_b32 v4, 2, v0
    buffer_store_dword v3, v4, s[16:19], s20 offen
L_nozero:
    s_cmp_ge_u32 s2, 224
    s_cbranch_scc1 L_nofill
    s_cmp_lg_u32 s15, 1
    s_cbranch_scc1 L_nofill
    s_lshl_b32 s20, s2, 10
    s_add_u32 s20, s20, 146800640
    v_mov_b32 v8, -1
    v_mov_b32 v9, -1
    v_mov_b32 v10, -1
    v_mov_b32 v11, -1
    v_lshlrev_b32 v4, 4, v0
    buffer_store_dwordx4 v[8:11], v4, s[16:19], s20 offen
L_nofill:
    s_add_u32 m0, s42, 0
    s_nop 0
    buffer_load_dwordx4 v1, s[16:19], s40 offen offset:0 lds
    buffer_load_dwordx4 v1, s[16:19], s40 offen offset:1024 lds
    buffer_load_dwordx4 v1, s[16:19], s40 offen offset:2048 lds
    buffer_load_dwordx4 v1, s[16:19], s40 offen offset:3072 lds
    s_add_u32 s40, s40, 524288
    s_add_u32 m0, s43, 0
    s_nop 0
    buffer_load_dwordx4 v2, s[16:19], s41 offen offset:0 lds
    buffer_load_dwordx4 v2, s[16:19], s41 offen offset:1024 lds
    buffer_load_dwordx4 v2, s[16:19], s41 offen offset:2048 lds
    buffer_load_dwordx4 v2, s[16:19], s41 offen offset:3072 lds
    s_add_u32 m0, s43, 4096
    s_add_u32 s49, s41, 4096
    buffer_load_dwordx4 v2, s[16:19], s49 offen lds
    s_mov_b64 exec, s[50:51]
    buffer_load_dwordx4 v5, s[16:19], s44 offen offset:1024 lds
    s_mov_b64 exec, -1
    s_add_u32 s41, s41, 688128
    s_add_u32 s44, s44, 688128
    s_add_u32 m0, s42, 38912
    s_nop 0
    buffer_load_dwordx4 v1, s[16:19], s40 offen offset:0 lds
    buffer_load_dwordx4 v1, s[16:19], s40 offen offset:1024 lds
    buffer_load_dwordx4 v1, s[16:19], s40 offen offset:2048 lds
    buffer_load_dwordx4 v1, s[16:19], s40 offen offset:3072 lds
    s_add_u32 s40, s40, 524288
    s_add_u32 m0, s43, 38912
    s_nop 0
    buffer_load_dwordx4 v2, s[16:19], s41 offen offset:0 lds
    buffer_load_dwordx4 v2, s[16:19], s41 offen offset:1024 lds
    buffer_load_dwordx4 v2, s[16:19], s41 offen offset:2048 lds
    buffer_load_dwordx4 v2, s[16:19], s41 offen offset:3072 lds
    s_add_u32 m0, s43, 43008
    s_add_u32 s49, s41, 4096
    buffer_load_dwordx4 v2, s[16:19], s49 offen lds
    s_mov_b64 exec, s[50:51]
    buffer_load_dwordx4 v5, s[16:19], s44 offen offset:1024 lds
    s_mov_b64 exec, -1
    s_add_u32 s41, s41, 688128
    s_add_u32 s44, s44, 688128
    s_add_u32 m0, s42, 77824
    s_nop 0
    buffer_load_dwordx4 v1, s[16:19], s40 offen offset:0 lds
    buffer_load_dwordx4 v1, s[16:19], s40 offen offset:1024 lds
    buffer_load_dwordx4 v1, s[16:19], s40 offen offset:2048 lds
    buffer_load_dwordx4 v1, s[16:19], s40 offen offset:3072 lds
    s_add_u32 s40, s40, 524288
    s_add_u32 m0, s43, 77824
    s_nop 0
    buffer_load_dwordx4 v2, s[16:19], s41 offen offset:0 lds
    buffer_load_dwordx4 v2, s[16:19], s41 offen offset:1024 lds
    buffer_load_dwordx4 v2, s[16:19], s41 offen offset:2048 lds
    buffer_load_dwordx4 v2, s[16:19], s41 offen offset:3072 lds
    s_add_u32 m0, s43, 81920
    s_add_u32 s49, s41, 4096
    buffer_load_dwordx4 v2, s[16:19], s49 offen lds
    s_mov_b64 exec, s[50:51]
    buffer_load_dwordx4 v5, s[16:19], s44 offen offset:1024 lds
    s_mov_b64 exec, -1
    s_add_u32 s41, s41, 688128
    s_add_u32 s44, s44, 688128
    s_waitcnt vmcnt(20)
    s_barrier
    s_mov_b32 s46, 7
L_h_loop:
    s_waitcnt vmcnt(10)
    s_barrier
    s_add_u32 m0, s42, 116736
    s_nop 0
    buffer_load_dwordx4 v1, s[16:19], s40 offen offset:0 lds
    buffer_load_dwordx4 v1, s[16:19], s40 offen offset:1024 lds
    buffer_load_dwordx4 v1, s[16:19], s40 offen offset:2048 lds
    buffer_load_dwordx4 v1, s[16:19], s40 offen offset:3072 lds
    s_add_u32 s40, s40, 524288
    s_add_u32 m0, s43, 116736
    s_nop 0
    buffer_load_dwordx4 v2, s[16:19], s41 offen offset:0 lds
    buffer_load_dwordx4 v2, s[16:19], s41 offen offset:1024 lds
    buffer_load_dwordx4 v2, s[16:19], s41 offen offset:2048 lds
    buffer_load_dwordx4 v2, s[16:19], s41 offen offset:3072 lds
    s_add_u32 m0, s43, 120832
    s_add_u32 s49, s41, 4096
    buffer_load_dwordx4 v2, s[16:19], s49 offen lds
    s_mov_b64 exec, s[50:51]
    buffer_load_dwordx4 v5, s[16:19], s44 offen offset:1024 lds
    s_mov_b64 exec, -1
    s_add_u32 s41, s41, 688128
    s_add_u32 s44, s44, 688128
    s_waitcnt vmcnt(10)
    s_barrier
    s_add_u32 m0, s42, 0
    s_nop 0
    buffer_load_dwordx4 v1, s[16:19], s40 offen offset:0 lds
    buffer_load_dwordx4 v1, s[16:19], s40 offen offset:1024 lds
    buffer_load_dwordx4 v1, s[16:19], s40 offen offset:2048 lds
    buffer_load_dwordx4 v1, s[16:19], s40 offen offset:3072 lds
    s_add_u32 s40, s40, 524288
    s_add_u32 m0, s43, 0
    s_nop 0
    buffer_load_dwordx4 v2, s[16:19], s41 offen offset:0 lds
    buffer_load_dwordx4 v2, s[16:19], s41 offen offset:1024 lds
    buffer_load_dwordx4 v2, s[16:19], s41 offen offset:2048 lds
    buffer_load_dwordx4 v2, s[16:19], s41 offen offset:3072 lds
    s_add_u32 m0, s43, 4096
    s_add_u32 s49, s41, 4096
    buffer_load_dwordx4 v2, s[16:19], s49 offen lds
    s_mov_b64 exec, s[50:51]
    buffer_load_dwordx4 v5, s[16:19], s44 offen offset:1024 lds
    s_mov_b64 exec, -1
    s_add_u32 s41, s41, 688128
    s_add_u32 s44, s44, 688128
    s_waitcnt vmcnt(10)
    s_barrier
    s_add_u32 m0, s42, 38912
    s_nop 0
    buffer_load_dwordx4 v1, s[16:19], s40 offen offset:0 lds
    buffer_load_dwordx4 v1, s[16:19], s40 offen offset:1024 lds
    buffer_load_dwordx4 v1, s[16:19], s40 offen offset:2048 lds
    buffer_load_dwordx4 v1, s[16:19], s40 offen offset:3072 lds
    s_add_u32 s40, s40, 524288
    s_add_u32 m0, s43, 38912
    s_nop 0
    buffer_load_dwordx4 v2, s[16:19], s41 offen offset:0 lds
    buffer_load_dwordx4 v2, s[16:19], s41 offen offset:1024 lds
    buffer_load_dwordx4 v2, s[16:19], s41 offen offset:2048 lds
    buffer_load_dwordx4 v2, s[16:19], s41 offen offset:3072 lds
    s_add_u32 m0, s43, 43008
    s_add_u32 s49, s41, 4096
    buffer_load_dwordx4 v2, s[16:19], s49 offen lds
    s_mov_b64 exec, s[50:51]
    buffer_load_dwordx4 v5, s[16:19], s44 offen offset:1024 lds
    s_mov_b64 exec, -1
    s_add_u32 s41, s41, 688128
    s_add_u32 s44, s44, 688128
    s_waitcnt vmcnt(10)
    s_barrier
    s_add_u32 m0, s42, 77824
    s_nop 0
    buffer_load_dwordx4 v1, s[16:19], s40 offen offset:0 lds
    buffer_load_dwordx4 v1, s[16:19], s40 offen offset:1024 lds
    buffer_load_dwordx4 v1, s[16:19], s40 offen offset:2048 lds
    buffer_load_dwordx4 v1, s[16:19], s40 offen offset:3072 lds
    s_add_u32 s40, s40, 524288
    s_add_u32 m0, s43, 77824
    s_nop 0
    buffer_load_dwordx4 v2, s[16:19], s41 offen offset:0 lds
    buffer_load_dwordx4 v2, s[16:19], s41 offen offset:1024 lds
    buffer_load_dwordx4 v2, s[16:19], s41 offen offset:2048 lds
    buffer_load_dwordx4 v2, s[16:19], s41 offen offset:3072 lds
    s_add_u32 m0, s43, 81920
    s_add_u32 s49, s41, 4096
    buffer_load_dwordx4 v2, s[16:19], s49 offen lds
    s_mov_b64 exec, s[50:51]
    buffer_load_dwordx4 v5, s[16:19], s44 offen offset:1024 lds
    s_mov_b64 exec, -1
    s_add_u32 s41, s41, 688128
    s_add_u32 s44, s44, 688128
    s_sub_u32 s46, s46, 1
    s_cmp_lg_u32 s46, 0
    s_cbranch_scc1 L_h_loop
    s_waitcnt vmcnt(10)
    s_barrier
    s_add_u32 m0, s42, 116736
    s_nop 0
    buffer_load_dwordx4 v1, s[16:19], s40 offen offset:0 lds
    buffer_load_dwordx4 v1, s[16:19], s40 offen offset:1024 lds
    buffer_load_dwordx4 v1, s[16:19], s40 offen offset:2048 lds
    buffer_load_dwordx4 v1, s[16:19], s40 offen offset:3072 lds
    s_add_u32 s40, s40, 524288
    s_add_u32 m0, s43, 116736
    s_nop 0
    buffer_load_dwordx4 v2, s[16:19], s41 offen offset:0 lds
    buffer_load_dwordx4 v2, s[16:19], s41 offen offset:1024 lds
    buffer_load_dwordx4 v2, s[16:19], s41 offen offset:2048 lds
    buffer_load_dwordx4 v2, s[16:19], s41 offen offset:3072 lds
    s_add_u32 m0, s43, 120832
    s_add_u32 s49, s41, 4096
    buffer_load_dwordx4 v2, s[16:19], s49 offen lds
    s_mov_b64 exec, s[50:51]
    buffer_load_dwordx4 v5, s[16:19], s44 offen offset:1024 lds
    s_mov_b64 exec, -1
    s_add_u32 s41, s41, 688128
    s_add_u32 s44, s44, 688128
    s_waitcnt vmcnt(10)
    s_barrier
    s_waitcnt vmcnt(0)
    s_barrier
    s_endpgm
L_k3_end:
    s_endpgm
.globl final_kernel
.p2align 8
.type final_kernel,@function
final_kernel:
    s_cmp_ge_u32 s2, 224
    s_cbranch_scc1 L_k45_end
    s_load_dwordx2 s[8:9], s[0:1], 48
    s_load_dwordx4 s[4:7], s[0:1], 16
    s_load_dwordx2 s[28:29], s[0:1], 32
    v_lshrrev_b32 v204, 6, v0
    v_and_b32 v200, 63, v0
    v_readfirstlane_b32 s10, v204
    s_cmp_ge_u32 s2, 8
    s_cbranch_scc1 L_nopf45
    s_nop 1
    s_cmp_lg_u32 s10, 7
    s_cbranch_scc1 L_nopf45
    s_getpc_b64 s[60:61]
L_pf_k45:
    s_sub_u32 s60, s60, L_pf_k45-final_kernel
    s_subb_u32 s61, s61, 0
    v_mbcnt_lo_u32_b32 v112, -1, 0
    v_mbcnt_hi_u32_b32 v112, -1, v112
    v_lshlrev_b32 v112, 6, v112
    v_add_u32 v113, 0, v112
    v_min_u32 v113, L_code_end-final_kernel-4, v113
    v_mov_b32 v115, s61
    v_add_co_u32 v114, vcc, s60, v113
    s_nop 1
    v_addc_co_u32 v115, vcc, 0, v115, vcc
    global_load_dword v116, v[114:115], off
    v_add_u32 v113, 4096, v112
    v_min_u32 v113, L_code_end-final_kernel-4, v113
    v_mov_b32 v115, s61
    v_add_co_u32 v114, vcc, s60, v113
    s_nop 1
    v_addc_co_u32 v115, vcc, 0, v115, vcc
    global_load_dword v116, v[114:115], off
    v_add_u32 v113, 8192, v112
    v_min_u32 v113, L_code_end-final_kernel-4, v113
    v_mov_b32 v115, s61
    v_add_co_u32 v114, vcc, s60, v113
    s_nop 1
    v_addc_co_u32 v115, vcc, 0, v115, vcc
    global_load_dword v116, v[114:115], off
L_nopf45:
    v_lshlrev_b32 v214, 2, v0
    v_and_b32 v201, 15, v200
    v_lshrrev_b32 v202, 4, v200
    s_and_b32 s13, s2, 3
    s_lshr_b32 s12, s2, 2
    s_cmp_ge_u32 s12, 28
    s_cselect_b32 s11, 1, 0
    s_mul_i32 s15, s11, 28
    s_sub_u32 s12, s12, s15
    s_mul_i32 s14, s12, 6
    s_add_u32 s14, s14, s10
    s_mov_b32 s24, 8192
    v_mul_u32_u24 v203, s24, v202
    v_lshl_add_u32 v203, v201, 4, v203
    s_mul_i32 s24, s11, 11579392
    s_mul_i32 s25, s14, 65792
    s_add_u32 s24, s24, s25
    s_lshl_b32 s25, s13, 8
    s_add_u32 s24, s24, s25
    s_add_u32 s24, s24, 117440512
    s_mov_b32 s30, 0x05040100
    s_mov_b32 s31, 0x07060302
    s_waitcnt lgkmcnt(0)
    s_mov_b32 s16, s8
    s_and_b32 s17, s9, 0xffff
    s_mov_b32 s18, 268435456
    s_mov_b32 s19, 0x00020000
    s_cmp_ge_u32 s10, 6
    s_cbranch_scc1 L_k45_gb
    s_add_u32 s25, s24, 0
    buffer_load_dwordx4 v[0:3], v203, s[16:19], s25 offen
    s_add_u32 s25, s24, 1024
    buffer_load_dwordx4 v[4:7], v203, s[16:19], s25 offen
    s_add_u32 s25, s24, 2048
    buffer_load_dwordx4 v[8:11], v203, s[16:19], s25 offen
    s_add_u32 s25, s24, 3072
    buffer_load_dwordx4 v[12:15], v203, s[16:19], s25 offen
    s_add_u32 s25, s24, 4096
    buffer_load_dwordx4 v[16:19], v203, s[16:19], s25 offen
    s_add_u32 s25, s24, 5120
    buffer_load_dwordx4 v[20:23], v203, s[16:19], s25 offen
    s_add_u32 s25, s24, 6144
    buffer_load_dwordx4 v[24:27], v203, s[16:19], s25 offen
    s_add_u32 s25, s24, 7168
    buffer_load_dwordx4 v[28:31], v203, s[16:19], s25 offen
    s_add_u32 s25, s24, 32768
    buffer_load_dwordx4 v[32:35], v203, s[16:19], s25 offen
    s_add_u32 s25, s24, 33792
    buffer_load_dwordx4 v[36:39], v203, s[16:19], s25 offen
    s_add_u32 s25, s24, 34816
    buffer_load_dwordx4 v[40:43], v203, s[16:19], s25 offen
    s_add_u32 s25, s24, 35840
    buffer_load_dwordx4 v[44:47], v203, s[16:19], s25 offen
    s_add_u32 s25, s24, 36864
    buffer_load_dwordx4 v[48:51], v203, s[16:19], s25 offen
    s_add_u32 s25, s24, 37888
    buffer_load_dwordx4 v[52:55], v203, s[16:19], s25 offen
    s_add_u32 s25, s24, 38912
    buffer_load_dwordx4 v[56:59], v203, s[16:19], s25 offen
    s_add_u32 s25, s24, 39936
    buffer_load_dwordx4 v[60:63], v203, s[16:19], s25 offen
    s_lshr_b32 s27, s10, 1
    s_and_b32 s33, s10, 1
    s_lshl_b32 s27, s27, 4
    v_add_u32 v204, s27, v201
    s_lshl_b32 s33, s33, 5
    s_add_u32 s33, s33, 1
    v_lshlrev_b32 v205, 3, v202
    v_add_u32 v205, s33, v205
    v_mul_u32_u24 v88, v205, v204
    v_add_u32 v89, 32, v88
    v_add_u32 v205, 2, v205
    v_mul_u32_u24 v90, v205, v204
    v_add_u32 v91, 32, v90
    v_add_u32 v205, 2, v205
    v_mul_u32_u24 v92, v205, v204
    v_add_u32 v93, 32, v92
    v_add_u32 v205, 2, v205
    v_mul_u32_u24 v94, v205, v204
    v_add_u32 v95, 32, v94
    v_and_b32 v88, 127, v88
    v_cvt_f32_u32 v88, v88
    v_mul_f32 v88, 0x3c000000, v88
    v_cos_f32 v88, v88
    v_and_b32 v89, 127, v89
    v_cvt_f32_u32 v89, v89
    v_mul_f32 v89, 0x3c000000, v89
    v_cos_f32 v89, v89
    v_and_b32 v90, 127, v90
    v_cvt_f32_u32 v90, v90
    v_mul_f32 v90, 0x3c000000, v90
    v_cos_f32 v90, v90
    v_and_b32 v91, 127, v91
    v_cvt_f32_u32 v91, v91
    v_mul_f32 v91, 0x3c000000, v91
    v_cos_f32 v91, v91
    v_and_b32 v92, 127, v92
    v_cvt_f32_u32 v92, v92
    v_mul_f32 v92, 0x3c000000, v92
    v_cos_f32 v92, v92
    v_and_b32 v93, 127, v93
    v_cvt_f32_u32 v93, v93
    v_mul_f32 v93, 0x3c000000, v93
    v_cos_f32 v93, v93
    v_and_b32 v94, 127, v94
    v_cvt_f32_u32 v94, v94
    v_mul_f32 v94, 0x3c000000, v94
    v_cos_f32 v94, v94
    v_and_b32 v95, 127, v95
    v_cvt_f32_u32 v95, v95
    v_mul_f32 v95, 0x3c000000, v95
    v_cos_f32 v95, v95
    v_mul_f32 v88, 0x3d000000, v88
    v_mul_f32 v89, 0x3d000000, v89
    v_mul_f32 v90, 0x3d000000, v90
    v_mul_f32 v91, 0x3d000000, v91
    v_mul_f32 v92, 0x3d000000, v92
    v_mul_f32 v93, 0x3d000000, v93
    v_mul_f32 v94, 0x3d000000, v94
    v_mul_f32 v95, 0x3d000000, v95
    v_cvt_pk_bf16_f32 v104, v88, v89
    v_cvt_pk_bf16_f32 v105, v90, v91
    v_cvt_pk_bf16_f32 v106, v92, v93
    v_cvt_pk_bf16_f32 v107, v94, v95
    s_lshl_b32 s26, s10, 10
    v_lshlrev_b32 v207, 4, v200
    v_add_u32 v207, s26, v207
    ds_write_b128 v207, v[104:107] offset:0
L_k45_gb:
    s_mov_b32 s20, s4
    s_and_b32 s21, s5, 0xffff
    s_mov_b32 s22, 1024
    s_mov_b32 s23, 0x00020000
    s_mov_b32 s36, s6
    s_and_b32 s37, s7, 0xffff
    s_mov_b32 s38, 1024
    s_mov_b32 s39, 0x00020000
    v_lshlrev_b32 v210, 4, v201
    s_lshl_b32 s25, s13, 8
    buffer_load_dwordx4 v[232:235], v210, s[20:23], s25 offen
    buffer_load_dwordx4 v[236:239], v210, s[36:39], s25 offen
    s_waitcnt lgkmcnt(0)
    s_barrier
    s_cmp_ge_u32 s10, 6
    s_cbranch_scc1 L_k45_red2
    v_lshlrev_b32 v207, 4, v200
    ds_read_b128 v[64:67], v207 offset:0
    ds_read_b128 v[68:71], v207 offset:1024
    ds_read_b128 v[72:75], v207 offset:2048
    ds_read_b128 v[76:79], v207 offset:3072
    ds_read_b128 v[80:83], v207 offset:4096
    ds_read_b128 v[84:87], v207 offset:5120
    s_cmp_ge_u32 s14, 167
    s_cbranch_scc1 L_k45_zero
    s_waitcnt lgkmcnt(0)
    s_cmp_lg_u32 s14, 166
    s_cbranch_scc1 L_k45_full
    v_cmp_gt_i32 vcc, 17, v201
    s_nop 1
    v_cndmask_b32 v64, 0, v64, vcc
    v_cndmask_b32 v65, 0, v65, vcc
    v_cndmask_b32 v66, 0, v66, vcc
    v_cndmask_b32 v67, 0, v67, vcc
    v_cndmask_b32 v68, 0, v68, vcc
    v_cndmask_b32 v69, 0, v69, vcc
    v_cndmask_b32 v70, 0, v70, vcc
    v_cndmask_b32 v71, 0, v71, vcc
    v_cmp_gt_i32 vcc, 1, v201
    s_nop 1
    v_cndmask_b32 v72, 0, v72, vcc
    v_cndmask_b32 v73, 0, v73, vcc
    v_cndmask_b32 v74, 0, v74, vcc
    v_cndmask_b32 v75, 0, v75, vcc
    v_cndmask_b32 v76, 0, v76, vcc
    v_cndmask_b32 v77, 0, v77, vcc
    v_cndmask_b32 v78, 0, v78, vcc
    v_cndmask_b32 v79, 0, v79, vcc
    v_cmp_gt_i32 vcc, 0, v201
    s_nop 1
    v_cndmask_b32 v80, 0, v80, vcc
    v_cndmask_b32 v81, 0, v81, vcc
    v_cndmask_b32 v82, 0, v82, vcc
    v_cndmask_b32 v83, 0, v83, vcc
    v_cndmask_b32 v84, 0, v84, vcc
    v_cndmask_b32 v85, 0, v85, vcc
    v_cndmask_b32 v86, 0, v86, vcc
    v_cndmask_b32 v87, 0, v87, vcc
L_k45_full:
    s_waitcnt vmcnt(2)
    v_perm_b32 v88, v4, v0, s30
    v_perm_b32 v89, v12, v8, s30
    v_perm_b32 v90, v20, v16, s30
    v_perm_b32 v91, v28, v24, s30
    v_perm_b32 v92, v4, v0, s31
    v_perm_b32 v93, v12, v8, s31
    v_perm_b32 v94, v20, v16, s31
    v_perm_b32 v95, v28, v24, s31
    v_perm_b32 v96, v36, v32, s30
    v_perm_b32 v97, v44, v40, s30
    v_perm_b32 v98, v52, v48, s30
    v_perm_b32 v99, v60, v56, s30
    v_perm_b32 v100, v36, v32, s31
    v_perm_b32 v101, v44, v40, s31
    v_perm_b32 v102, v52, v48, s31
    v_perm_b32 v103, v60, v56, s31
    v_mfma_f32_16x16x32_bf16 v[104:107], v[64:67], v[88:91], 0
    v_mfma_f32_16x16x32_bf16 v[108:111], v[64:67], v[92:95], 0
    v_mfma_f32_16x16x32_bf16 v[136:139], v[72:75], v[88:91], 0
    v_mfma_f32_16x16x32_bf16 v[140:143], v[72:75], v[92:95], 0
    v_mfma_f32_16x16x32_bf16 v[168:171], v[80:83], v[88:91], 0
    v_mfma_f32_16x16x32_bf16 v[172:175], v[80:83], v[92:95], 0
    v_mfma_f32_16x16x32_bf16 v[104:107], v[68:71], v[96:99], v[104:107]
    v_mfma_f32_16x16x32_bf16 v[108:111], v[68:71], v[100:103], v[108:111]
    v_mfma_f32_16x16x32_bf16 v[136:139], v[76:79], v[96:99], v[136:139]
    v_mfma_f32_16x16x32_bf16 v[140:143], v[76:79], v[100:103], v[140:143]
    v_mfma_f32_16x16x32_bf16 v[168:171], v[84:87], v[96:99], v[168:171]
    v_mfma_f32_16x16x32_bf16 v[172:175], v[84:87], v[100:103], v[172:175]
    v_perm_b32 v88, v5, v1, s30
    v_perm_b32 v89, v13, v9, s30
    v_perm_b32 v90, v21, v17, s30
    v_perm_b32 v91, v29, v25, s30
    v_perm_b32 v92, v5, v1, s31
    v_perm_b32 v93, v13, v9, s31
    v_perm_b32 v94, v21, v17, s31
    v_perm_b32 v95, v29, v25, s31
    v_perm_b32 v96, v37, v33, s30
    v_perm_b32 v97, v45, v41, s30
    v_perm_b32 v98, v53, v49, s30
    v_perm_b32 v99, v61, v57, s30
    v_perm_b32 v100, v37, v33, s31
    v_perm_b32 v101, v45, v41, s31
    v_perm_b32 v102, v53, v49, s31
    v_perm_b32 v103, v61, v57, s31
    v_mfma_f32_16x16x32_bf16 v[112:115], v[64:67], v[88:91], 0
    v_mfma_f32_16x16x32_bf16 v[116:119], v[64:67], v[92:95], 0
    v_mfma_f32_16x16x32_bf16 v[144:147], v[72:75], v[88:91], 0
    v_mfma_f32_16x16x32_bf16 v[148:151], v[72:75], v[92:95], 0
    v_mfma_f32_16x16x32_bf16 v[176:179], v[80:83], v[88:91], 0
    v_mfma_f32_16x16x32_bf16 v[180:183], v[80:83], v[92:95], 0
    v_mfma_f32_16x16x32_bf16 v[112:115], v[68:71], v[96:99], v[112:115]
    v_mfma_f32_16x16x32_bf16 v[116:119], v[68:71], v[100:103], v[116:119]
    v_mfma_f32_16x16x32_bf16 v[144:147], v[76:79], v[96:99], v[144:147]
    v_mfma_f32_16x16x32_bf16 v[148:151], v[76:79], v[100:103], v[148:151]
    v_mfma_f32_16x16x32_bf16 v[176:179], v[84:87], v[96:99], v[176:179]
    v_mfma_f32_16x16x32_bf16 v[180:183], v[84:87], v[100:103], v[180:183]
    v_perm_b32 v88, v6, v2, s30
    v_perm_b32 v89, v14, v10, s30
    v_perm_b32 v90, v22, v18, s30
    v_perm_b32 v91, v30, v26, s30
    v_perm_b32 v92, v6, v2, s31
    v_perm_b32 v93, v14, v10, s31
    v_perm_b32 v94, v22, v18, s31
    v_perm_b32 v95, v30, v26, s31
    v_perm_b32 v96, v38, v34, s30
    v_perm_b32 v97, v46, v42, s30
    v_perm_b32 v98, v54, v50, s30
    v_perm_b32 v99, v62, v58, s30
    v_perm_b32 v100, v38, v34, s31
    v_perm_b32 v101, v46, v42, s31
    v_perm_b32 v102, v54, v50, s31
    v_perm_b32 v103, v62, v58, s31
    v_mfma_f32_16x16x32_bf16 v[120:123], v[64:67], v[88:91], 0
    v_mfma_f32_16x16x32_bf16 v[124:127], v[64:67], v[92:95], 0
    v_mfma_f32_16x16x32_bf16 v[152:155], v[72:75], v[88:91], 0
    v_mfma_f32_16x16x32_bf16 v[156:159], v[72:75], v[92:95], 0
    v_mfma_f32_16x16x32_bf16 v[184:187], v[80:83], v[88:91], 0
    v_mfma_f32_16x16x32_bf16 v[188:191], v[80:83], v[92:95], 0
    v_mfma_f32_16x16x32_bf16 v[120:123], v[68:71], v[96:99], v[120:123]
    v_mfma_f32_16x16x32_bf16 v[124:127], v[68:71], v[100:103], v[124:127]
    v_mfma_f32_16x16x32_bf16 v[152:155], v[76:79], v[96:99], v[152:155]
    v_mfma_f32_16x16x32_bf16 v[156:159], v[76:79], v[100:103], v[156:159]
    v_mfma_f32_16x16x32_bf16 v[184:187], v[84:87], v[96:99], v[184:187]
    v_mfma_f32_16x16x32_bf16 v[188:191], v[84:87], v[100:103], v[188:191]
    v_perm_b32 v88, v7, v3, s30
    v_perm_b32 v89, v15, v11, s30
    v_perm_b32 v90, v23, v19, s30
    v_perm_b32 v91, v31, v27, s30
    v_perm_b32 v92, v7, v3, s31
    v_perm_b32 v93, v15, v11, s31
    v_perm_b32 v94, v23, v19, s31
    v_perm_b32 v95, v31, v27, s31
    v_perm_b32 v96, v39, v35, s30
    v_perm_b32 v97, v47, v43, s30
    v_perm_b32 v98, v55, v51, s30
    v_perm_b32 v99, v63, v59, s30
    v_perm_b32 v100, v39, v35, s31
    v_perm_b32 v101, v47, v43, s31
    v_perm_b32 v102, v55, v51, s31
    v_perm_b32 v103, v63, v59, s31
    v_mfma_f32_16x16x32_bf16 v[128:131], v[64:67], v[88:91], 0
    v_mfma_f32_16x16x32_bf16 v[132:135], v[64:67], v[92:95], 0
    v_mfma_f32_16x16x32_bf16 v[160:163], v[72:75], v[88:91], 0
    v_mfma_f32_16x16x32_bf16 v[164:167], v[72:75], v[92:95], 0
    v_mfma_f32_16x16x32_bf16 v[192:195], v[80:83], v[88:91], 0
    v_mfma_f32_16x16x32_bf16 v[196:199], v[80:83], v[92:95], 0
    v_mfma_f32_16x16x32_bf16 v[128:131], v[68:71], v[96:99], v[128:131]
    v_mfma_f32_16x16x32_bf16 v[132:135], v[68:71], v[100:103], v[132:135]
    v_mfma_f32_16x16x32_bf16 v[160:163], v[76:79], v[96:99], v[160:163]
    v_mfma_f32_16x16x32_bf16 v[164:167], v[76:79], v[100:103], v[164:167]
    v_mfma_f32_16x16x32_bf16 v[192:195], v[84:87], v[96:99], v[192:195]
    v_mfma_f32_16x16x32_bf16 v[196:199], v[84:87], v[100:103], v[196:199]
    s_nop 7
    v_mul_f32 v224, v104, v104
    v_mov_b32 v216, v104
    v_fmac_f32 v224, v105, v105
    v_add_f32 v216, v216, v105
    v_fmac_f32 v224, v106, v106
    v_add_f32 v216, v216, v106
    v_fmac_f32 v224, v107, v107
    v_add_f32 v216, v216, v107
    v_fmac_f32 v224, v136, v136
    v_add_f32 v216, v216, v136
    v_fmac_f32 v224, v137, v137
    v_add_f32 v216, v216, v137
    v_fmac_f32 v224, v138, v138
    v_add_f32 v216, v216, v138
    v_fmac_f32 v224, v139, v139
    v_add_f32 v216, v216, v139
    v_fmac_f32 v224, v168, v168
    v_add_f32 v216, v216, v168
    v_fmac_f32 v224, v169, v169
    v_add_f32 v216, v216, v169
    v_fmac_f32 v224, v170, v170
    v_add_f32 v216, v216, v170
    v_fmac_f32 v224, v171, v171
    v_add_f32 v216, v216, v171
    v_mul_f32 v225, v108, v108
    v_mov_b32 v217, v108
    v_fmac_f32 v225, v109, v109
    v_add_f32 v217, v217, v109
    v_fmac_f32 v225, v110, v110
    v_add_f32 v217, v217, v110
    v_fmac_f32 v225, v111, v111
    v_add_f32 v217, v217, v111
    v_fmac_f32 v225, v140, v140
    v_add_f32 v217, v217, v140
    v_fmac_f32 v225, v141, v141
    v_add_f32 v217, v217, v141
    v_fmac_f32 v225, v142, v142
    v_add_f32 v217, v217, v142
    v_fmac_f32 v225, v143, v143
    v_add_f32 v217, v217, v143
    v_fmac_f32 v225, v172, v172
    v_add_f32 v217, v217, v172
    v_fmac_f32 v225, v173, v173
    v_add_f32 v217, v217, v173
    v_fmac_f32 v225, v174, v174
    v_add_f32 v217, v217, v174
    v_fmac_f32 v225, v175, v175
    v_add_f32 v217, v217, v175
    v_mul_f32 v226, v112, v112
    v_mov_b32 v218, v112
    v_fmac_f32 v226, v113, v113
    v_add_f32 v218, v218, v113
    v_fmac_f32 v226, v114, v114
    v_add_f32 v218, v218, v114
    v_fmac_f32 v226, v115, v115
    v_add_f32 v218, v218, v115
    v_fmac_f32 v226, v144, v144
    v_add_f32 v218, v218, v144
    v_fmac_f32 v226, v145, v145
    v_add_f32 v218, v218, v145
    v_fmac_f32 v226, v146, v146
    v_add_f32 v218, v218, v146
    v_fmac_f32 v226, v147, v147
    v_add_f32 v218, v218, v147
    v_fmac_f32 v226, v176, v176
    v_add_f32 v218, v218, v176
    v_fmac_f32 v226, v177, v177
    v_add_f32 v218, v218, v177
    v_fmac_f32 v226, v178, v178
    v_add_f32 v218, v218, v178
    v_fmac_f32 v226, v179, v179
    v_add_f32 v218, v218, v179
    v_mul_f32 v227, v116, v116
    v_mov_b32 v219, v116
    v_fmac_f32 v227, v117, v117
    v_add_f32 v219, v219, v117
    v_fmac_f32 v227, v118, v118
    v_add_f32 v219, v219, v118
    v_fmac_f32 v227, v119, v119
    v_add_f32 v219, v219, v119
    v_fmac_f32 v227, v148, v148
    v_add_f32 v219, v219, v148
    v_fmac_f32 v227, v149, v149
    v_add_f32 v219, v219, v149
    v_fmac_f32 v227, v150, v150
    v_add_f32 v219, v219, v150
    v_fmac_f32 v227, v151, v151
    v_add_f32 v219, v219, v151
    v_fmac_f32 v227, v180, v180
    v_add_f32 v219, v219, v180
    v_fmac_f32 v227, v181, v181
    v_add_f32 v219, v219, v181
    v_fmac_f32 v227, v182, v182
    v_add_f32 v219, v219, v182
    v_fmac_f32 v227, v183, v183
    v_add_f32 v219, v219, v183
    v_mul_f32 v228, v120, v120
    v_mov_b32 v220, v120
    v_fmac_f32 v228, v121, v121
    v_add_f32 v220, v220, v121
    v_fmac_f32 v228, v122, v122
    v_add_f32 v220, v220, v122
    v_fmac_f32 v228, v123, v123
    v_add_f32 v220, v220, v123
    v_fmac_f32 v228, v152, v152
    v_add_f32 v220, v220, v152
    v_fmac_f32 v228, v153, v153
    v_add_f32 v220, v220, v153
    v_fmac_f32 v228, v154, v154
    v_add_f32 v220, v220, v154
    v_fmac_f32 v228, v155, v155
    v_add_f32 v220, v220, v155
    v_fmac_f32 v228, v184, v184
    v_add_f32 v220, v220, v184
    v_fmac_f32 v228, v185, v185
    v_add_f32 v220, v220, v185
    v_fmac_f32 v228, v186, v186
    v_add_f32 v220, v220, v186
    v_fmac_f32 v228, v187, v187
    v_add_f32 v220, v220, v187
    v_mul_f32 v229, v124, v124
    v_mov_b32 v221, v124
    v_fmac_f32 v229, v125, v125
    v_add_f32 v221, v221, v125
    v_fmac_f32 v229, v126, v126
    v_add_f32 v221, v221, v126
    v_fmac_f32 v229, v127, v127
    v_add_f32 v221, v221, v127
    v_fmac_f32 v229, v156, v156
    v_add_f32 v221, v221, v156
    v_fmac_f32 v229, v157, v157
    v_add_f32 v221, v221, v157
    v_fmac_f32 v229, v158, v158
    v_add_f32 v221, v221, v158
    v_fmac_f32 v229, v159, v159
    v_add_f32 v221, v221, v159
    v_fmac_f32 v229, v188, v188
    v_add_f32 v221, v221, v188
    v_fmac_f32 v229, v189, v189
    v_add_f32 v221, v221, v189
    v_fmac_f32 v229, v190, v190
    v_add_f32 v221, v221, v190
    v_fmac_f32 v229, v191, v191
    v_add_f32 v221, v221, v191
    v_mul_f32 v230, v128, v128
    v_mov_b32 v222, v128
    v_fmac_f32 v230, v129, v129
    v_add_f32 v222, v222, v129
    v_fmac_f32 v230, v130, v130
    v_add_f32 v222, v222, v130
    v_fmac_f32 v230, v131, v131
    v_add_f32 v222, v222, v131
    v_fmac_f32 v230, v160, v160
    v_add_f32 v222, v222, v160
    v_fmac_f32 v230, v161, v161
    v_add_f32 v222, v222, v161
    v_fmac_f32 v230, v162, v162
    v_add_f32 v222, v222, v162
    v_fmac_f32 v230, v163, v163
    v_add_f32 v222, v222, v163
    v_fmac_f32 v230, v192, v192
    v_add_f32 v222, v222, v192
    v_fmac_f32 v230, v193, v193
    v_add_f32 v222, v222, v193
    v_fmac_f32 v230, v194, v194
    v_add_f32 v222, v222, v194
    v_fmac_f32 v230, v195, v195
    v_add_f32 v222, v222, v195
    v_mul_f32 v231, v132, v132
    v_mov_b32 v223, v132
    v_fmac_f32 v231, v133, v133
    v_add_f32 v223, v223, v133
    v_fmac_f32 v231, v134, v134
    v_add_f32 v223, v223, v134
    v_fmac_f32 v231, v135, v135
    v_add_f32 v223, v223, v135
    v_fmac_f32 v231, v164, v164
    v_add_f32 v223, v223, v164
    v_fmac_f32 v231, v165, v165
    v_add_f32 v223, v223, v165
    v_fmac_f32 v231, v166, v166
    v_add_f32 v223, v223, v166
    v_fmac_f32 v231, v167, v167
    v_add_f32 v223, v223, v167
    v_fmac_f32 v231, v196, v196
    v_add_f32 v223, v223, v196
    v_fmac_f32 v231, v197, v197
    v_add_f32 v223, v223, v197
    v_fmac_f32 v231, v198, v198
    v_add_f32 v223, v223, v198
    v_fmac_f32 v231, v199, v199
    v_add_f32 v223, v223, v199
    s_branch L_k45_red
L_k45_zero:
    s_waitcnt vmcnt(0) lgkmcnt(0)
    v_mov_b32 v216, 0
    v_mov_b32 v224, 0
    v_mov_b32 v217, 0
    v_mov_b32 v225, 0
    v_mov_b32 v218, 0
    v_mov_b32 v226, 0
    v_mov_b32 v219, 0
    v_mov_b32 v227, 0
    v_mov_b32 v220, 0
    v_mov_b32 v228, 0
    v_mov_b32 v221, 0
    v_mov_b32 v229, 0
    v_mov_b32 v222, 0
    v_mov_b32 v230, 0
    v_mov_b32 v223, 0
    v_mov_b32 v231, 0
L_k45_red:
    s_lshl_b32 s25, s10, 12
    v_lshlrev_b32 v204, 10, v202
    v_lshl_add_u32 v204, v201, 5, v204
    v_add_u32 v204, s25, v204
    ds_write_b128 v204, v[216:219] offset:8192
    ds_write_b128 v204, v[220:223] offset:8208
    ds_write_b128 v204, v[224:227] offset:8704
    ds_write_b128 v204, v[228:231] offset:8720
    s_lshl_b32 s25, s10, 13
    v_lshlrev_b32 v205, 4, v200
    v_add_u32 v205, s25, v205
    ds_write_b96 v205, v[168:170] offset:33792
    ds_write_b96 v205, v[172:174] offset:34816
    ds_write_b96 v205, v[176:178] offset:35840
    ds_write_b96 v205, v[180:182] offset:36864
    ds_write_b96 v205, v[184:186] offset:37888
    ds_write_b96 v205, v[188:190] offset:38912
    ds_write_b96 v205, v[192:194] offset:39936
    ds_write_b96 v205, v[196:198] offset:40960
L_k45_red2:
    s_waitcnt lgkmcnt(0)
    s_barrier
    s_mul_i32 s24, s11, 112
    s_mul_i32 s25, s13, 28
    s_add_u32 s24, s24, s25
    s_lshl_b32 s26, s24, 10
    s_add_u32 s26, s26, 146800640
    s_cmp_ge_u32 s10, 6
    s_cbranch_scc1 L_k45_hread
    s_cmp_ge_u32 s10, 4
    s_cbranch_scc1 L_k45_sumdone
    ds_read_b32 v16, v214 offset:8192
    ds_read_b32 v17, v214 offset:9216
    ds_read_b32 v18, v214 offset:10240
    ds_read_b32 v19, v214 offset:11264
    ds_read_b32 v20, v214 offset:12288
    ds_read_b32 v21, v214 offset:13312
    ds_read_b32 v22, v214 offset:14336
    ds_read_b32 v23, v214 offset:15360
    ds_read_b32 v24, v214 offset:16384
    ds_read_b32 v25, v214 offset:17408
    ds_read_b32 v26, v214 offset:18432
    ds_read_b32 v27, v214 offset:19456
    ds_read_b32 v28, v214 offset:20480
    ds_read_b32 v29, v214 offset:21504
    ds_read_b32 v30, v214 offset:22528
    ds_read_b32 v31, v214 offset:23552
    ds_read_b32 v32, v214 offset:24576
    ds_read_b32 v33, v214 offset:25600
    ds_read_b32 v34, v214 offset:26624
    ds_read_b32 v35, v214 offset:27648
    ds_read_b32 v36, v214 offset:28672
    ds_read_b32 v37, v214 offset:29696
    ds_read_b32 v38, v214 offset:30720
    ds_read_b32 v39, v214 offset:31744
    s_waitcnt lgkmcnt(0)
    v_add_f32 v16, v16, v17
    v_add_f32 v18, v18, v19
    v_add_f32 v20, v20, v21
    v_add_f32 v22, v22, v23
    v_add_f32 v24, v24, v25
    v_add_f32 v26, v26, v27
    v_add_f32 v28, v28, v29
    v_add_f32 v30, v30, v31
    v_add_f32 v32, v32, v33
    v_add_f32 v34, v34, v35
    v_add_f32 v36, v36, v37
    v_add_f32 v38, v38, v39
    v_add_f32 v16, v16, v18
    v_add_f32 v20, v20, v22
    v_add_f32 v24, v24, v26
    v_add_f32 v28, v28, v30
    v_add_f32 v32, v32, v34
    v_add_f32 v36, v36, v38
    v_add_f32 v16, v16, v20
    v_add_f32 v24, v24, v28
    v_add_f32 v32, v32, v36
    v_add_f32 v16, v16, v24
    v_add_f32 v16, v16, v32
    s_lshl_b32 s24, s12, 10
    s_add_u32 s24, s24, s26
    buffer_store_dword v16, v214, s[16:19], s24 offen sc1
    s_mov_b32 s33, 16384
L_k45_poll:
    s_mov_b32 s27, s26
    buffer_load_dword v0, v214, s[16:19], s27 offen offset:0 sc1
    buffer_load_dword v1, v214, s[16:19], s27 offen offset:1024 sc1
    buffer_load_dword v2, v214, s[16:19], s27 offen offset:2048 sc1
    buffer_load_dword v3, v214, s[16:19], s27 offen offset:3072 sc1
    s_add_u32 s27, s27, 4096
    buffer_load_dword v4, v214, s[16:19], s27 offen offset:0 sc1
    buffer_load_dword v5, v214, s[16:19], s27 offen offset:1024 sc1
    buffer_load_dword v6, v214, s[16:19], s27 offen offset:2048 sc1
    buffer_load_dword v7, v214, s[16:19], s27 offen offset:3072 sc1
    s_add_u32 s27, s27, 4096
    buffer_load_dword v8, v214, s[16:19], s27 offen offset:0 sc1
    buffer_load_dword v9, v214, s[16:19], s27 offen offset:1024 sc1
    buffer_load_dword v10, v214, s[16:19], s27 offen offset:2048 sc1
    buffer_load_dword v11, v214, s[16:19], s27 offen offset:3072 sc1
    s_add_u32 s27, s27, 4096
    buffer_load_dword v12, v214, s[16:19], s27 offen offset:0 sc1
    buffer_load_dword v13, v214, s[16:19], s27 offen offset:1024 sc1
    buffer_load_dword v14, v214, s[16:19], s27 offen offset:2048 sc1
    buffer_load_dword v15, v214, s[16:19], s27 offen offset:3072 sc1
    s_add_u32 s27, s27, 4096
    buffer_load_dword v16, v214, s[16:19], s27 offen offset:0 sc1
    buffer_load_dword v17, v214, s[16:19], s27 offen offset:1024 sc1
    buffer_load_dword v18, v214, s[16:19], s27 offen offset:2048 sc1
    buffer_load_dword v19, v214, s[16:19], s27 offen offset:3072 sc1
    s_add_u32 s27, s27, 4096
    buffer_load_dword v20, v214, s[16:19], s27 offen offset:0 sc1
    buffer_load_dword v21, v214, s[16:19], s27 offen offset:1024 sc1
    buffer_load_dword v22, v214, s[16:19], s27 offen offset:2048 sc1
    buffer_load_dword v23, v214, s[16:19], s27 offen offset:3072 sc1
    s_add_u32 s27, s27, 4096
    buffer_load_dword v24, v214, s[16:19], s27 offen offset:0 sc1
    buffer_load_dword v25, v214, s[16:19], s27 offen offset:1024 sc1
    buffer_load_dword v26, v214, s[16:19], s27 offen offset:2048 sc1
    buffer_load_dword v27, v214, s[16:19], s27 offen offset:3072 sc1
    s_waitcnt vmcnt(0)
    v_max3_u32 v32, v0, v1, v2
    v_max3_u32 v32, v32, v3, v4
    v_max3_u32 v32, v32, v5, v6
    v_max3_u32 v32, v32, v7, v8
    v_max3_u32 v32, v32, v9, v10
    v_max3_u32 v32, v32, v11, v12
    v_max3_u32 v32, v32, v13, v14
    v_max3_u32 v32, v32, v15, v16
    v_max3_u32 v32, v32, v17, v18
    v_max3_u32 v32, v32, v19, v20
    v_max3_u32 v32, v32, v21, v22
    v_max3_u32 v32, v32, v23, v24
    v_max3_u32 v32, v32, v25, v26
    v_max_u32 v32, v32, v27
    v_cmp_eq_u32 vcc, -1, v32
    s_nop 3
    s_cmp_eq_u64 vcc, 0
    s_cbranch_scc1 L_k45_got
    s_sub_u32 s33, s33, 1
    s_cmp_eq_u32 s33, 0
    s_cbranch_scc1 L_k45_got
    s_sleep 2
    s_branch L_k45_poll
L_k45_got:
    v_add_f32 v0, v0, v1
    v_add_f32 v2, v2, v3
    v_add_f32 v4, v4, v5
    v_add_f32 v6, v6, v7
    v_add_f32 v8, v8, v9
    v_add_f32 v10, v10, v11
    v_add_f32 v12, v12, v13
    v_add_f32 v14, v14, v15
    v_add_f32 v16, v16, v17
    v_add_f32 v18, v18, v19
    v_add_f32 v20, v20, v21
    v_add_f32 v22, v22, v23
    v_add_f32 v24, v24, v25
    v_add_f32 v26, v26, v27
    v_add_f32 v0, v0, v2
    v_add_f32 v4, v4, v6
    v_add_f32 v8, v8, v10
    v_add_f32 v12, v12, v14
    v_add_f32 v16, v16, v18
    v_add_f32 v20, v20, v22
    v_add_f32 v24, v24, v26
    v_add_f32 v0, v0, v4
    v_add_f32 v8, v8, v12
    v_add_f32 v16, v16, v20
    v_add_f32 v0, v0, v8
    v_add_f32 v16, v16, v24
    v_add_f32 v0, v0, v16
    ds_write_b32 v214, v0 offset:32768
    s_branch L_k45_sumdone
L_k45_hread:
    s_waitcnt vmcnt(0)
    s_sub_u32 s25, s10, 6
    s_mul_i32 s25, s25, 3
    s_lshl_b32 s25, s25, 13
    v_lshlrev_b32 v205, 4, v200
    v_add_u32 v205, s25, v205
    ds_read_b96 v[104:106], v205 offset:33792
    ds_read_b96 v[108:110], v205 offset:34816
    ds_read_b96 v[112:114], v205 offset:35840
    ds_read_b96 v[116:118], v205 offset:36864
    ds_read_b96 v[120:122], v205 offset:37888
    ds_read_b96 v[124:126], v205 offset:38912
    ds_read_b96 v[128:130], v205 offset:39936
    ds_read_b96 v[132:134], v205 offset:40960
    s_waitcnt lgkmcnt(0)
    ds_read_b96 v[136:138], v205 offset:41984
    ds_read_b96 v[140:142], v205 offset:43008
    ds_read_b96 v[144:146], v205 offset:44032
    ds_read_b96 v[148:150], v205 offset:45056
    ds_read_b96 v[152:154], v205 offset:46080
    ds_read_b96 v[156:158], v205 offset:47104
    ds_read_b96 v[160:162], v205 offset:48128
    ds_read_b96 v[164:166], v205 offset:49152
    s_waitcnt lgkmcnt(0)
    ds_read_b96 v[168:170], v205 offset:50176
    ds_read_b96 v[172:174], v205 offset:51200
    ds_read_b96 v[176:178], v205 offset:52224
    ds_read_b96 v[180:182], v205 offset:53248
    ds_read_b96 v[184:186], v205 offset:54272
    ds_read_b96 v[188:190], v205 offset:55296
    ds_read_b96 v[192:194], v205 offset:56320
    ds_read_b96 v[196:198], v205 offset:57344
    s_waitcnt lgkmcnt(0)
L_k45_sumdone:
    s_waitcnt lgkmcnt(0)
    s_barrier
    v_lshlrev_b32 v210, 5, v201
    ds_read_b128 v[44:47], v210 offset:32768
    ds_read_b128 v[48:51], v210 offset:32784
    ds_read_b128 v[52:55], v210 offset:33280
    ds_read_b128 v[56:59], v210 offset:33296
    s_mov_b32 s24, 0x39035177
    s_mov_b32 s25, 0x3727c5ac
    s_waitcnt vmcnt(0) lgkmcnt(0)
    v_mul_f32 v44, s24, v44
    v_mul_f32 v52, s24, v52
    v_fma_f32 v52, -v44, v44, v52
    v_max_f32 v52, 0, v52
    v_add_f32 v52, s25, v52
    v_rsq_f32 v52, v52
    v_lshlrev_b32 v216, 16, v232
    v_lshlrev_b32 v224, 16, v236
    v_mul_f32 v216, v216, v52
    v_fma_f32 v224, -v44, v216, v224
    v_mul_f32 v45, s24, v45
    v_mul_f32 v53, s24, v53
    v_fma_f32 v53, -v45, v45, v53
    v_max_f32 v53, 0, v53
    v_add_f32 v53, s25, v53
    v_rsq_f32 v53, v53
    v_and_b32 v217, 0xffff0000, v232
    v_and_b32 v225, 0xffff0000, v236
    v_mul_f32 v217, v217, v53
    v_fma_f32 v225, -v45, v217, v225
    v_mul_f32 v46, s24, v46
    v_mul_f32 v54, s24, v54
    v_fma_f32 v54, -v46, v46, v54
    v_max_f32 v54, 0, v54
    v_add_f32 v54, s25, v54
    v_rsq_f32 v54, v54
    v_lshlrev_b32 v218, 16, v233
    v_lshlrev_b32 v226, 16, v237
    v_mul_f32 v218, v218, v54
    v_fma_f32 v226, -v46, v218, v226
    v_mul_f32 v47, s24, v47
    v_mul_f32 v55, s24, v55
    v_fma_f32 v55, -v47, v47, v55
    v_max_f32 v55, 0, v55
    v_add_f32 v55, s25, v55
    v_rsq_f32 v55, v55
    v_and_b32 v219, 0xffff0000, v233
    v_and_b32 v227, 0xffff0000, v237
    v_mul_f32 v219, v219, v55
    v_fma_f32 v227, -v47, v219, v227
    v_mul_f32 v48, s24, v48
    v_mul_f32 v56, s24, v56
    v_fma_f32 v56, -v48, v48, v56
    v_max_f32 v56, 0, v56
    v_add_f32 v56, s25, v56
    v_rsq_f32 v56, v56
    v_lshlrev_b32 v220, 16, v234
    v_lshlrev_b32 v228, 16, v238
    v_mul_f32 v220, v220, v56
    v_fma_f32 v228, -v48, v220, v228
    v_mul_f32 v49, s24, v49
    v_mul_f32 v57, s24, v57
    v_fma_f32 v57, -v49, v49, v57
    v_max_f32 v57, 0, v57
    v_add_f32 v57, s25, v57
    v_rsq_f32 v57, v57
    v_and_b32 v221, 0xffff0000, v234
    v_and_b32 v229, 0xffff0000, v238
    v_mul_f32 v221, v221, v57
    v_fma_f32 v229, -v49, v221, v229
    v_mul_f32 v50, s24, v50
    v_mul_f32 v58, s24, v58
    v_fma_f32 v58, -v50, v50, v58
    v_max_f32 v58, 0, v58
    v_add_f32 v58, s25, v58
    v_rsq_f32 v58, v58
    v_lshlrev_b32 v222, 16, v235
    v_lshlrev_b32 v230, 16, v239
    v_mul_f32 v222, v222, v58
    v_fma_f32 v230, -v50, v222, v230
    v_mul_f32 v51, s24, v51
    v_mul_f32 v59, s24, v59
    v_fma_f32 v59, -v51, v51, v59
    v_max_f32 v59, 0, v59
    v_add_f32 v59, s25, v59
    v_rsq_f32 v59, v59
    v_and_b32 v223, 0xffff0000, v235
    v_and_b32 v231, 0xffff0000, v239
    v_mul_f32 v223, v223, v59
    v_fma_f32 v231, -v51, v223, v231
    s_mul_i32 s24, s11, 8176640
    s_add_u32 s28, s28, s24
    s_addc_u32 s29, s29, 0
    s_mov_b32 s32, s28
    s_and_b32 s33, s29, 0xffff
    s_mov_b32 s34, 8176640
    s_mov_b32 s35, 0x00020000
    s_lshl_b32 s25, s13, 8
    v_lshlrev_b32 v210, 12, v202
    v_lshl_add_u32 v210, v201, 4, v210
    v_add_u32 v210, s25, v210
    s_mov_b32 s26, 0xbdd2d3e8
    v_mov_b32 v211, 0xc0135761
    s_cmp_ge_u32 s10, 6
    s_cbranch_scc1 L_k45_hgelu
    s_cmp_ge_u32 s14, 167
    s_cbranch_scc1 L_k45_fin
    s_mul_i32 s24, s14, 49152
    v_fma_f32 v104, v104, v216, v224
    v_fma_f32 v108, v108, v217, v225
    v_fma_f32 v112, v112, v218, v226
    v_fma_f32 v116, v116, v219, v227
    v_fma_f32 v120, v120, v220, v228
    v_fma_f32 v124, v124, v221, v229
    v_fma_f32 v128, v128, v222, v230
    v_fma_f32 v132, v132, v223, v231
    v_mul_f32 v0, v104, v104
    v_mul_f32 v1, v108, v108
    v_mul_f32 v2, v112, v112
    v_mul_f32 v3, v116, v116
    v_mul_f32 v4, v120, v120
    v_mul_f32 v5, v124, v124
    v_mul_f32 v6, v128, v128
    v_mul_f32 v7, v132, v132
    v_fma_f32 v0, v0, s26, v211
    v_fma_f32 v1, v1, s26, v211
    v_fma_f32 v2, v2, s26, v211
    v_fma_f32 v3, v3, s26, v211
    v_fma_f32 v4, v4, s26, v211
    v_fma_f32 v5, v5, s26, v211
    v_fma_f32 v6, v6, s26, v211
    v_fma_f32 v7, v7, s26, v211
    v_mul_f32 v0, v0, v104
    v_mul_f32 v1, v1, v108
    v_mul_f32 v2, v2, v112
    v_mul_f32 v3, v3, v116
    v_mul_f32 v4, v4, v120
    v_mul_f32 v5, v5, v124
    v_mul_f32 v6, v6, v128
    v_mul_f32 v7, v7, v132
    v_exp_f32 v0, v0
    v_exp_f32 v1, v1
    v_exp_f32 v2, v2
    v_exp_f32 v3, v3
    v_exp_f32 v4, v4
    v_exp_f32 v5, v5
    v_exp_f32 v6, v6
    v_exp_f32 v7, v7
    v_add_f32 v0, 1.0, v0
    v_add_f32 v1, 1.0, v1
    v_add_f32 v2, 1.0, v2
    v_add_f32 v3, 1.0, v3
    v_add_f32 v4, 1.0, v4
    v_add_f32 v5, 1.0, v5
    v_add_f32 v6, 1.0, v6
    v_add_f32 v7, 1.0, v7
    v_rcp_f32 v0, v0
    v_rcp_f32 v1, v1
    v_rcp_f32 v2, v2
    v_rcp_f32 v3, v3
    v_rcp_f32 v4, v4
    v_rcp_f32 v5, v5
    v_rcp_f32 v6, v6
    v_rcp_f32 v7, v7
    v_mul_f32 v0, v0, v104
    v_mul_f32 v1, v1, v108
    v_mul_f32 v2, v2, v112
    v_mul_f32 v3, v3, v116
    v_mul_f32 v4, v4, v120
    v_mul_f32 v5, v5, v124
    v_mul_f32 v6, v6, v128
    v_mul_f32 v7, v7, v132
    v_cvt_pk_bf16_f32 v16, v0, v1
    v_cvt_pk_bf16_f32 v17, v2, v3
    v_cvt_pk_bf16_f32 v18, v4, v5
    v_cvt_pk_bf16_f32 v19, v6, v7
    s_add_u32 s27, s24, 0
    buffer_store_dwordx4 v[16:19], v210, s[32:35], s27 offen sc1
    v_fma_f32 v105, v105, v216, v224
    v_fma_f32 v109, v109, v217, v225
    v_fma_f32 v113, v113, v218, v226
    v_fma_f32 v117, v117, v219, v227
    v_fma_f32 v121, v121, v220, v228
    v_fma_f32 v125, v125, v221, v229
    v_fma_f32 v129, v129, v222, v230
    v_fma_f32 v133, v133, v223, v231
    v_mul_f32 v0, v105, v105
    v_mul_f32 v1, v109, v109
    v_mul_f32 v2, v113, v113
    v_mul_f32 v3, v117, v117
    v_mul_f32 v4, v121, v121
    v_mul_f32 v5, v125, v125
    v_mul_f32 v6, v129, v129
    v_mul_f32 v7, v133, v133
    v_fma_f32 v0, v0, s26, v211
    v_fma_f32 v1, v1, s26, v211
    v_fma_f32 v2, v2, s26, v211
    v_fma_f32 v3, v3, s26, v211
    v_fma_f32 v4, v4, s26, v211
    v_fma_f32 v5, v5, s26, v211
    v_fma_f32 v6, v6, s26, v211
    v_fma_f32 v7, v7, s26, v211
    v_mul_f32 v0, v0, v105
    v_mul_f32 v1, v1, v109
    v_mul_f32 v2, v2, v113
    v_mul_f32 v3, v3, v117
    v_mul_f32 v4, v4, v121
    v_mul_f32 v5, v5, v125
    v_mul_f32 v6, v6, v129
    v_mul_f32 v7, v7, v133
    v_exp_f32 v0, v0
    v_exp_f32 v1, v1
    v_exp_f32 v2, v2
    v_exp_f32 v3, v3
    v_exp_f32 v4, v4
    v_exp_f32 v5, v5
    v_exp_f32 v6, v6
    v_exp_f32 v7, v7
    v_add_f32 v0, 1.0, v0
    v_add_f32 v1, 1.0, v1
    v_add_f32 v2, 1.0, v2
    v_add_f32 v3, 1.0, v3
    v_add_f32 v4, 1.0, v4
    v_add_f32 v5, 1.0, v5
    v_add_f32 v6, 1.0, v6
    v_add_f32 v7, 1.0, v7
    v_rcp_f32 v0, v0
    v_rcp_f32 v1, v1
    v_rcp_f32 v2, v2
    v_rcp_f32 v3, v3
    v_rcp_f32 v4, v4
    v_rcp_f32 v5, v5
    v_rcp_f32 v6, v6
    v_rcp_f32 v7, v7
    v_mul_f32 v0, v0, v105
    v_mul_f32 v1, v1, v109
    v_mul_f32 v2, v2, v113
    v_mul_f32 v3, v3, v117
    v_mul_f32 v4, v4, v121
    v_mul_f32 v5, v5, v125
    v_mul_f32 v6, v6, v129
    v_mul_f32 v7, v7, v133
    v_cvt_pk_bf16_f32 v20, v0, v1
    v_cvt_pk_bf16_f32 v21, v2, v3
    v_cvt_pk_bf16_f32 v22, v4, v5
    v_cvt_pk_bf16_f32 v23, v6, v7
    s_add_u32 s27, s24, 1024
    buffer_store_dwordx4 v[20:23], v210, s[32:35], s27 offen sc1
    v_fma_f32 v106, v106, v216, v224
    v_fma_f32 v110, v110, v217, v225
    v_fma_f32 v114, v114, v218, v226
    v_fma_f32 v118, v118, v219, v227
    v_fma_f32 v122, v122, v220, v228
    v_fma_f32 v126, v126, v221, v229
    v_fma_f32 v130, v130, v222, v230
    v_fma_f32 v134, v134, v223, v231
    v_mul_f32 v0, v106, v106
    v_mul_f32 v1, v110, v110
    v_mul_f32 v2, v114, v114
    v_mul_f32 v3, v118, v118
    v_mul_f32 v4, v122, v122
    v_mul_f32 v5, v126, v126
    v_mul_f32 v6, v130, v130
    v_mul_f32 v7, v134, v134
    v_fma_f32 v0, v0, s26, v211
    v_fma_f32 v1, v1, s26, v211
    v_fma_f32 v2, v2, s26, v211
    v_fma_f32 v3, v3, s26, v211
    v_fma_f32 v4, v4, s26, v211
    v_fma_f32 v5, v5, s26, v211
    v_fma_f32 v6, v6, s26, v211
    v_fma_f32 v7, v7, s26, v211
    v_mul_f32 v0, v0, v106
    v_mul_f32 v1, v1, v110
    v_mul_f32 v2, v2, v114
    v_mul_f32 v3, v3, v118
    v_mul_f32 v4, v4, v122
    v_mul_f32 v5, v5, v126
    v_mul_f32 v6, v6, v130
    v_mul_f32 v7, v7, v134
    v_exp_f32 v0, v0
    v_exp_f32 v1, v1
    v_exp_f32 v2, v2
    v_exp_f32 v3, v3
    v_exp_f32 v4, v4
    v_exp_f32 v5, v5
    v_exp_f32 v6, v6
    v_exp_f32 v7, v7
    v_add_f32 v0, 1.0, v0
    v_add_f32 v1, 1.0, v1
    v_add_f32 v2, 1.0, v2
    v_add_f32 v3, 1.0, v3
    v_add_f32 v4, 1.0, v4
    v_add_f32 v5, 1.0, v5
    v_add_f32 v6, 1.0, v6
    v_add_f32 v7, 1.0, v7
    v_rcp_f32 v0, v0
    v_rcp_f32 v1, v1
    v_rcp_f32 v2, v2
    v_rcp_f32 v3, v3
    v_rcp_f32 v4, v4
    v_rcp_f32 v5, v5
    v_rcp_f32 v6, v6
    v_rcp_f32 v7, v7
    v_mul_f32 v0, v0, v106
    v_mul_f32 v1, v1, v110
    v_mul_f32 v2, v2, v114
    v_mul_f32 v3, v3, v118
    v_mul_f32 v4, v4, v122
    v_mul_f32 v5, v5, v126
    v_mul_f32 v6, v6, v130
    v_mul_f32 v7, v7, v134
    v_cvt_pk_bf16_f32 v24, v0, v1
    v_cvt_pk_bf16_f32 v25, v2, v3
    v_cvt_pk_bf16_f32 v26, v4, v5
    v_cvt_pk_bf16_f32 v27, v6, v7
    s_add_u32 s27, s24, 2048
    buffer_store_dwordx4 v[24:27], v210, s[32:35], s27 offen sc1
    v_fma_f32 v107, v107, v216, v224
    v_fma_f32 v111, v111, v217, v225
    v_fma_f32 v115, v115, v218, v226
    v_fma_f32 v119, v119, v219, v227
    v_fma_f32 v123, v123, v220, v228
    v_fma_f32 v127, v127, v221, v229
    v_fma_f32 v131, v131, v222, v230
    v_fma_f32 v135, v135, v223, v231
    v_mul_f32 v0, v107, v107
    v_mul_f32 v1, v111, v111
    v_mul_f32 v2, v115, v115
    v_mul_f32 v3, v119, v119
    v_mul_f32 v4, v123, v123
    v_mul_f32 v5, v127, v127
    v_mul_f32 v6, v131, v131
    v_mul_f32 v7, v135, v135
    v_fma_f32 v0, v0, s26, v211
    v_fma_f32 v1, v1, s26, v211
    v_fma_f32 v2, v2, s26, v211
    v_fma_f32 v3, v3, s26, v211
    v_fma_f32 v4, v4, s26, v211
    v_fma_f32 v5, v5, s26, v211
    v_fma_f32 v6, v6, s26, v211
    v_fma_f32 v7, v7, s26, v211
    v_mul_f32 v0, v0, v107
    v_mul_f32 v1, v1, v111
    v_mul_f32 v2, v2, v115
    v_mul_f32 v3, v3, v119
    v_mul_f32 v4, v4, v123
    v_mul_f32 v5, v5, v127
    v_mul_f32 v6, v6, v131
    v_mul_f32 v7, v7, v135
    v_exp_f32 v0, v0
    v_exp_f32 v1, v1
    v_exp_f32 v2, v2
    v_exp_f32 v3, v3
    v_exp_f32 v4, v4
    v_exp_f32 v5, v5
    v_exp_f32 v6, v6
    v_exp_f32 v7, v7
    v_add_f32 v0, 1.0, v0
    v_add_f32 v1, 1.0, v1
    v_add_f32 v2, 1.0, v2
    v_add_f32 v3, 1.0, v3
    v_add_f32 v4, 1.0, v4
    v_add_f32 v5, 1.0, v5
    v_add_f32 v6, 1.0, v6
    v_add_f32 v7, 1.0, v7
    v_rcp_f32 v0, v0
    v_rcp_f32 v1, v1
    v_rcp_f32 v2, v2
    v_rcp_f32 v3, v3
    v_rcp_f32 v4, v4
    v_rcp_f32 v5, v5
    v_rcp_f32 v6, v6
    v_rcp_f32 v7, v7
    v_mul_f32 v0, v0, v107
    v_mul_f32 v1, v1, v111
    v_mul_f32 v2, v2, v115
    v_mul_f32 v3, v3, v119
    v_mul_f32 v4, v4, v123
    v_mul_f32 v5, v5, v127
    v_mul_f32 v6, v6, v131
    v_mul_f32 v7, v7, v135
    v_cvt_pk_bf16_f32 v28, v0, v1
    v_cvt_pk_bf16_f32 v29, v2, v3
    v_cvt_pk_bf16_f32 v30, v4, v5
    v_cvt_pk_bf16_f32 v31, v6, v7
    s_add_u32 s27, s24, 3072
    buffer_store_dwordx4 v[28:31], v210, s[32:35], s27 offen sc1
    v_fma_f32 v136, v136, v216, v224
    v_fma_f32 v140, v140, v217, v225
    v_fma_f32 v144, v144, v218, v226
    v_fma_f32 v148, v148, v219, v227
    v_fma_f32 v152, v152, v220, v228
    v_fma_f32 v156, v156, v221, v229
    v_fma_f32 v160, v160, v222, v230
    v_fma_f32 v164, v164, v223, v231
    v_mul_f32 v0, v136, v136
    v_mul_f32 v1, v140, v140
    v_mul_f32 v2, v144, v144
    v_mul_f32 v3, v148, v148
    v_mul_f32 v4, v152, v152
    v_mul_f32 v5, v156, v156
    v_mul_f32 v6, v160, v160
    v_mul_f32 v7, v164, v164
    v_fma_f32 v0, v0, s26, v211
    v_fma_f32 v1, v1, s26, v211
    v_fma_f32 v2, v2, s26, v211
    v_fma_f32 v3, v3, s26, v211
    v_fma_f32 v4, v4, s26, v211
    v_fma_f32 v5, v5, s26, v211
    v_fma_f32 v6, v6, s26, v211
    v_fma_f32 v7, v7, s26, v211
    v_mul_f32 v0, v0, v136
    v_mul_f32 v1, v1, v140
    v_mul_f32 v2, v2, v144
    v_mul_f32 v3, v3, v148
    v_mul_f32 v4, v4, v152
    v_mul_f32 v5, v5, v156
    v_mul_f32 v6, v6, v160
    v_mul_f32 v7, v7, v164
    v_exp_f32 v0, v0
    v_exp_f32 v1, v1
    v_exp_f32 v2, v2
    v_exp_f32 v3, v3
    v_exp_f32 v4, v4
    v_exp_f32 v5, v5
    v_exp_f32 v6, v6
    v_exp_f32 v7, v7
    v_add_f32 v0, 1.0, v0
    v_add_f32 v1, 1.0, v1
    v_add_f32 v2, 1.0, v2
    v_add_f32 v3, 1.0, v3
    v_add_f32 v4, 1.0, v4
    v_add_f32 v5, 1.0, v5
    v_add_f32 v6, 1.0, v6
    v_add_f32 v7, 1.0, v7
    v_rcp_f32 v0, v0
    v_rcp_f32 v1, v1
    v_rcp_f32 v2, v2
    v_rcp_f32 v3, v3
    v_rcp_f32 v4, v4
    v_rcp_f32 v5, v5
    v_rcp_f32 v6, v6
    v_rcp_f32 v7, v7
    v_mul_f32 v0, v0, v136
    v_mul_f32 v1, v1, v140
    v_mul_f32 v2, v2, v144
    v_mul_f32 v3, v3, v148
    v_mul_f32 v4, v4, v152
    v_mul_f32 v5, v5, v156
    v_mul_f32 v6, v6, v160
    v_mul_f32 v7, v7, v164
    v_cvt_pk_bf16_f32 v32, v0, v1
    v_cvt_pk_bf16_f32 v33, v2, v3
    v_cvt_pk_bf16_f32 v34, v4, v5
    v_cvt_pk_bf16_f32 v35, v6, v7
    s_add_u32 s27, s24, 16384
    buffer_store_dwordx4 v[32:35], v210, s[32:35], s27 offen sc1
    v_fma_f32 v137, v137, v216, v224
    v_fma_f32 v141, v141, v217, v225
    v_fma_f32 v145, v145, v218, v226
    v_fma_f32 v149, v149, v219, v227
    v_fma_f32 v153, v153, v220, v228
    v_fma_f32 v157, v157, v221, v229
    v_fma_f32 v161, v161, v222, v230
    v_fma_f32 v165, v165, v223, v231
    v_mul_f32 v0, v137, v137
    v_mul_f32 v1, v141, v141
    v_mul_f32 v2, v145, v145
    v_mul_f32 v3, v149, v149
    v_mul_f32 v4, v153, v153
    v_mul_f32 v5, v157, v157
    v_mul_f32 v6, v161, v161
    v_mul_f32 v7, v165, v165
    v_fma_f32 v0, v0, s26, v211
    v_fma_f32 v1, v1, s26, v211
    v_fma_f32 v2, v2, s26, v211
    v_fma_f32 v3, v3, s26, v211
    v_fma_f32 v4, v4, s26, v211
    v_fma_f32 v5, v5, s26, v211
    v_fma_f32 v6, v6, s26, v211
    v_fma_f32 v7, v7, s26, v211
    v_mul_f32 v0, v0, v137
    v_mul_f32 v1, v1, v141
    v_mul_f32 v2, v2, v145
    v_mul_f32 v3, v3, v149
    v_mul_f32 v4, v4, v153
    v_mul_f32 v5, v5, v157
    v_mul_f32 v6, v6, v161
    v_mul_f32 v7, v7, v165
    v_exp_f32 v0, v0
    v_exp_f32 v1, v1
    v_exp_f32 v2, v2
    v_exp_f32 v3, v3
    v_exp_f32 v4, v4
    v_exp_f32 v5, v5
    v_exp_f32 v6, v6
    v_exp_f32 v7, v7
    v_add_f32 v0, 1.0, v0
    v_add_f32 v1, 1.0, v1
    v_add_f32 v2, 1.0, v2
    v_add_f32 v3, 1.0, v3
    v_add_f32 v4, 1.0, v4
    v_add_f32 v5, 1.0, v5
    v_add_f32 v6, 1.0, v6
    v_add_f32 v7, 1.0, v7
    v_rcp_f32 v0, v0
    v_rcp_f32 v1, v1
    v_rcp_f32 v2, v2
    v_rcp_f32 v3, v3
    v_rcp_f32 v4, v4
    v_rcp_f32 v5, v5
    v_rcp_f32 v6, v6
    v_rcp_f32 v7, v7
    v_mul_f32 v0, v0, v137
    v_mul_f32 v1, v1, v141
    v_mul_f32 v2, v2, v145
    v_mul_f32 v3, v3, v149
    v_mul_f32 v4, v4, v153
    v_mul_f32 v5, v5, v157
    v_mul_f32 v6, v6, v161
    v_mul_f32 v7, v7, v165
    v_cvt_pk_bf16_f32 v36, v0, v1
    v_cvt_pk_bf16_f32 v37, v2, v3
    v_cvt_pk_bf16_f32 v38, v4, v5
    v_cvt_pk_bf16_f32 v39, v6, v7
    s_add_u32 s27, s24, 17408
    buffer_store_dwordx4 v[36:39], v210, s[32:35], s27 offen sc1
    v_fma_f32 v138, v138, v216, v224
    v_fma_f32 v142, v142, v217, v225
    v_fma_f32 v146, v146, v218, v226
    v_fma_f32 v150, v150, v219, v227
    v_fma_f32 v154, v154, v220, v228
    v_fma_f32 v158, v158, v221, v229
    v_fma_f32 v162, v162, v222, v230
    v_fma_f32 v166, v166, v223, v231
    v_mul_f32 v0, v138, v138
    v_mul_f32 v1, v142, v142
    v_mul_f32 v2, v146, v146
    v_mul_f32 v3, v150, v150
    v_mul_f32 v4, v154, v154
    v_mul_f32 v5, v158, v158
    v_mul_f32 v6, v162, v162
    v_mul_f32 v7, v166, v166
    v_fma_f32 v0, v0, s26, v211
    v_fma_f32 v1, v1, s26, v211
    v_fma_f32 v2, v2, s26, v211
    v_fma_f32 v3, v3, s26, v211
    v_fma_f32 v4, v4, s26, v211
    v_fma_f32 v5, v5, s26, v211
    v_fma_f32 v6, v6, s26, v211
    v_fma_f32 v7, v7, s26, v211
    v_mul_f32 v0, v0, v138
    v_mul_f32 v1, v1, v142
    v_mul_f32 v2, v2, v146
    v_mul_f32 v3, v3, v150
    v_mul_f32 v4, v4, v154
    v_mul_f32 v5, v5, v158
    v_mul_f32 v6, v6, v162
    v_mul_f32 v7, v7, v166
    v_exp_f32 v0, v0
    v_exp_f32 v1, v1
    v_exp_f32 v2, v2
    v_exp_f32 v3, v3
    v_exp_f32 v4, v4
    v_exp_f32 v5, v5
    v_exp_f32 v6, v6
    v_exp_f32 v7, v7
    v_add_f32 v0, 1.0, v0
    v_add_f32 v1, 1.0, v1
    v_add_f32 v2, 1.0, v2
    v_add_f32 v3, 1.0, v3
    v_add_f32 v4, 1.0, v4
    v_add_f32 v5, 1.0, v5
    v_add_f32 v6, 1.0, v6
    v_add_f32 v7, 1.0, v7
    v_rcp_f32 v0, v0
    v_rcp_f32 v1, v1
    v_rcp_f32 v2, v2
    v_rcp_f32 v3, v3
    v_rcp_f32 v4, v4
    v_rcp_f32 v5, v5
    v_rcp_f32 v6, v6
    v_rcp_f32 v7, v7
    v_mul_f32 v0, v0, v138
    v_mul_f32 v1, v1, v142
    v_mul_f32 v2, v2, v146
    v_mul_f32 v3, v3, v150
    v_mul_f32 v4, v4, v154
    v_mul_f32 v5, v5, v158
    v_mul_f32 v6, v6, v162
    v_mul_f32 v7, v7, v166
    v_cvt_pk_bf16_f32 v40, v0, v1
    v_cvt_pk_bf16_f32 v41, v2, v3
    v_cvt_pk_bf16_f32 v42, v4, v5
    v_cvt_pk_bf16_f32 v43, v6, v7
    s_add_u32 s27, s24, 18432
    buffer_store_dwordx4 v[40:43], v210, s[32:35], s27 offen sc1
    v_fma_f32 v139, v139, v216, v224
    v_fma_f32 v143, v143, v217, v225
    v_fma_f32 v147, v147, v218, v226
    v_fma_f32 v151, v151, v219, v227
    v_fma_f32 v155, v155, v220, v228
    v_fma_f32 v159, v159, v221, v229
    v_fma_f32 v163, v163, v222, v230
    v_fma_f32 v167, v167, v223, v231
    v_mul_f32 v0, v139, v139
    v_mul_f32 v1, v143, v143
    v_mul_f32 v2, v147, v147
    v_mul_f32 v3, v151, v151
    v_mul_f32 v4, v155, v155
    v_mul_f32 v5, v159, v159
    v_mul_f32 v6, v163, v163
    v_mul_f32 v7, v167, v167
    v_fma_f32 v0, v0, s26, v211
    v_fma_f32 v1, v1, s26, v211
    v_fma_f32 v2, v2, s26, v211
    v_fma_f32 v3, v3, s26, v211
    v_fma_f32 v4, v4, s26, v211
    v_fma_f32 v5, v5, s26, v211
    v_fma_f32 v6, v6, s26, v211
    v_fma_f32 v7, v7, s26, v211
    v_mul_f32 v0, v0, v139
    v_mul_f32 v1, v1, v143
    v_mul_f32 v2, v2, v147
    v_mul_f32 v3, v3, v151
    v_mul_f32 v4, v4, v155
    v_mul_f32 v5, v5, v159
    v_mul_f32 v6, v6, v163
    v_mul_f32 v7, v7, v167
    v_exp_f32 v0, v0
    v_exp_f32 v1, v1
    v_exp_f32 v2, v2
    v_exp_f32 v3, v3
    v_exp_f32 v4, v4
    v_exp_f32 v5, v5
    v_exp_f32 v6, v6
    v_exp_f32 v7, v7
    v_add_f32 v0, 1.0, v0
    v_add_f32 v1, 1.0, v1
    v_add_f32 v2, 1.0, v2
    v_add_f32 v3, 1.0, v3
    v_add_f32 v4, 1.0, v4
    v_add_f32 v5, 1.0, v5
    v_add_f32 v6, 1.0, v6
    v_add_f32 v7, 1.0, v7
    v_rcp_f32 v0, v0
    v_rcp_f32 v1, v1
    v_rcp_f32 v2, v2
    v_rcp_f32 v3, v3
    v_rcp_f32 v4, v4
    v_rcp_f32 v5, v5
    v_rcp_f32 v6, v6
    v_rcp_f32 v7, v7
    v_mul_f32 v0, v0, v139
    v_mul_f32 v1, v1, v143
    v_mul_f32 v2, v2, v147
    v_mul_f32 v3, v3, v151
    v_mul_f32 v4, v4, v155
    v_mul_f32 v5, v5, v159
    v_mul_f32 v6, v6, v163
    v_mul_f32 v7, v7, v167
    v_cvt_pk_bf16_f32 v44, v0, v1
    v_cvt_pk_bf16_f32 v45, v2, v3
    v_cvt_pk_bf16_f32 v46, v4, v5
    v_cvt_pk_bf16_f32 v47, v6, v7
    s_add_u32 s27, s24, 19456
    buffer_store_dwordx4 v[44:47], v210, s[32:35], s27 offen sc1
    v_fma_f32 v171, v171, v216, v224
    v_fma_f32 v175, v175, v217, v225
    v_fma_f32 v179, v179, v218, v226
    v_fma_f32 v183, v183, v219, v227
    v_fma_f32 v187, v187, v220, v228
    v_fma_f32 v191, v191, v221, v229
    v_fma_f32 v195, v195, v222, v230
    v_fma_f32 v199, v199, v223, v231
    v_mul_f32 v0, v171, v171
    v_mul_f32 v1, v175, v175
    v_mul_f32 v2, v179, v179
    v_mul_f32 v3, v183, v183
    v_mul_f32 v4, v187, v187
    v_mul_f32 v5, v191, v191
    v_mul_f32 v6, v195, v195
    v_mul_f32 v7, v199, v199
    v_fma_f32 v0, v0, s26, v211
    v_fma_f32 v1, v1, s26, v211
    v_fma_f32 v2, v2, s26, v211
    v_fma_f32 v3, v3, s26, v211
    v_fma_f32 v4, v4, s26, v211
    v_fma_f32 v5, v5, s26, v211
    v_fma_f32 v6, v6, s26, v211
    v_fma_f32 v7, v7, s26, v211
    v_mul_f32 v0, v0, v171
    v_mul_f32 v1, v1, v175
    v_mul_f32 v2, v2, v179
    v_mul_f32 v3, v3, v183
    v_mul_f32 v4, v4, v187
    v_mul_f32 v5, v5, v191
    v_mul_f32 v6, v6, v195
    v_mul_f32 v7, v7, v199
    v_exp_f32 v0, v0
    v_exp_f32 v1, v1
    v_exp_f32 v2, v2
    v_exp_f32 v3, v3
    v_exp_f32 v4, v4
    v_exp_f32 v5, v5
    v_exp_f32 v6, v6
    v_exp_f32 v7, v7
    v_add_f32 v0, 1.0, v0
    v_add_f32 v1, 1.0, v1
    v_add_f32 v2, 1.0, v2
    v_add_f32 v3, 1.0, v3
    v_add_f32 v4, 1.0, v4
    v_add_f32 v5, 1.0, v5
    v_add_f32 v6, 1.0, v6
    v_add_f32 v7, 1.0, v7
    v_rcp_f32 v0, v0
    v_rcp_f32 v1, v1
    v_rcp_f32 v2, v2
    v_rcp_f32 v3, v3
    v_rcp_f32 v4, v4
    v_rcp_f32 v5, v5
    v_rcp_f32 v6, v6
    v_rcp_f32 v7, v7
    v_mul_f32 v0, v0, v171
    v_mul_f32 v1, v1, v175
    v_mul_f32 v2, v2, v179
    v_mul_f32 v3, v3, v183
    v_mul_f32 v4, v4, v187
    v_mul_f32 v5, v5, v191
    v_mul_f32 v6, v6, v195
    v_mul_f32 v7, v7, v199
    v_cvt_pk_bf16_f32 v16, v0, v1
    v_cvt_pk_bf16_f32 v17, v2, v3
    v_cvt_pk_bf16_f32 v18, v4, v5
    v_cvt_pk_bf16_f32 v19, v6, v7
    s_add_u32 s27, s24, 35840
    buffer_store_dwordx4 v[16:19], v210, s[32:35], s27 offen sc1
    s_branch L_k45_fin
L_k45_hgelu:
    s_sub_u32 s25, s10, 6
    s_mul_i32 s25, s25, 3
    s_mul_i32 s24, s12, 6
    s_add_u32 s24, s24, s25
    s_mul_i32 s24, s24, 49152
    v_fma_f32 v104, v104, v216, v224
    v_fma_f32 v108, v108, v217, v225
    v_fma_f32 v112, v112, v218, v226
    v_fma_f32 v116, v116, v219, v227
    v_fma_f32 v120, v120, v220, v228
    v_fma_f32 v124, v124, v221, v229
    v_fma_f32 v128, v128, v222, v230
    v_fma_f32 v132, v132, v223, v231
    v_mul_f32 v0, v104, v104
    v_mul_f32 v1, v108, v108
    v_mul_f32 v2, v112, v112
    v_mul_f32 v3, v116, v116
    v_mul_f32 v4, v120, v120
    v_mul_f32 v5, v124, v124
    v_mul_f32 v6, v128, v128
    v_mul_f32 v7, v132, v132
    v_fma_f32 v0, v0, s26, v211
    v_fma_f32 v1, v1, s26, v211
    v_fma_f32 v2, v2, s26, v211
    v_fma_f32 v3, v3, s26, v211
    v_fma_f32 v4, v4, s26, v211
    v_fma_f32 v5, v5, s26, v211
    v_fma_f32 v6, v6, s26, v211
    v_fma_f32 v7, v7, s26, v211
    v_mul_f32 v0, v0, v104
    v_mul_f32 v1, v1, v108
    v_mul_f32 v2, v2, v112
    v_mul_f32 v3, v3, v116
    v_mul_f32 v4, v4, v120
    v_mul_f32 v5, v5, v124
    v_mul_f32 v6, v6, v128
    v_mul_f32 v7, v7, v132
    v_exp_f32 v0, v0
    v_exp_f32 v1, v1
    v_exp_f32 v2, v2
    v_exp_f32 v3, v3
    v_exp_f32 v4, v4
    v_exp_f32 v5, v5
    v_exp_f32 v6, v6
    v_exp_f32 v7, v7
    v_add_f32 v0, 1.0, v0
    v_add_f32 v1, 1.0, v1
    v_add_f32 v2, 1.0, v2
    v_add_f32 v3, 1.0, v3
    v_add_f32 v4, 1.0, v4
    v_add_f32 v5, 1.0, v5
    v_add_f32 v6, 1.0, v6
    v_add_f32 v7, 1.0, v7
    v_rcp_f32 v0, v0
    v_rcp_f32 v1, v1
    v_rcp_f32 v2, v2
    v_rcp_f32 v3, v3
    v_rcp_f32 v4, v4
    v_rcp_f32 v5, v5
    v_rcp_f32 v6, v6
    v_rcp_f32 v7, v7
    v_mul_f32 v0, v0, v104
    v_mul_f32 v1, v1, v108
    v_mul_f32 v2, v2, v112
    v_mul_f32 v3, v3, v116
    v_mul_f32 v4, v4, v120
    v_mul_f32 v5, v5, v124
    v_mul_f32 v6, v6, v128
    v_mul_f32 v7, v7, v132
    v_cvt_pk_bf16_f32 v20, v0, v1
    v_cvt_pk_bf16_f32 v21, v2, v3
    v_cvt_pk_bf16_f32 v22, v4, v5
    v_cvt_pk_bf16_f32 v23, v6, v7
    s_add_u32 s27, s24, 32768
    buffer_store_dwordx4 v[20:23], v210, s[32:35], s27 offen sc1
    v_fma_f32 v105, v105, v216, v224
    v_fma_f32 v109, v109, v217, v225
    v_fma_f32 v113, v113, v218, v226
    v_fma_f32 v117, v117, v219, v227
    v_fma_f32 v121, v121, v220, v228
    v_fma_f32 v125, v125, v221, v229
    v_fma_f32 v129, v129, v222, v230
    v_fma_f32 v133, v133, v223, v231
    v_mul_f32 v0, v105, v105
    v_mul_f32 v1, v109, v109
    v_mul_f32 v2, v113, v113
    v_mul_f32 v3, v117, v117
    v_mul_f32 v4, v121, v121
    v_mul_f32 v5, v125, v125
    v_mul_f32 v6, v129, v129
    v_mul_f32 v7, v133, v133
    v_fma_f32 v0, v0, s26, v211
    v_fma_f32 v1, v1, s26, v211
    v_fma_f32 v2, v2, s26, v211
    v_fma_f32 v3, v3, s26, v211
    v_fma_f32 v4, v4, s26, v211
    v_fma_f32 v5, v5, s26, v211
    v_fma_f32 v6, v6, s26, v211
    v_fma_f32 v7, v7, s26, v211
    v_mul_f32 v0, v0, v105
    v_mul_f32 v1, v1, v109
    v_mul_f32 v2, v2, v113
    v_mul_f32 v3, v3, v117
    v_mul_f32 v4, v4, v121
    v_mul_f32 v5, v5, v125
    v_mul_f32 v6, v6, v129
    v_mul_f32 v7, v7, v133
    v_exp_f32 v0, v0
    v_exp_f32 v1, v1
    v_exp_f32 v2, v2
    v_exp_f32 v3, v3
    v_exp_f32 v4, v4
    v_exp_f32 v5, v5
    v_exp_f32 v6, v6
    v_exp_f32 v7, v7
    v_add_f32 v0, 1.0, v0
    v_add_f32 v1, 1.0, v1
    v_add_f32 v2, 1.0, v2
    v_add_f32 v3, 1.0, v3
    v_add_f32 v4, 1.0, v4
    v_add_f32 v5, 1.0, v5
    v_add_f32 v6, 1.0, v6
    v_add_f32 v7, 1.0, v7
    v_rcp_f32 v0, v0
    v_rcp_f32 v1, v1
    v_rcp_f32 v2, v2
    v_rcp_f32 v3, v3
    v_rcp_f32 v4, v4
    v_rcp_f32 v5, v5
    v_rcp_f32 v6, v6
    v_rcp_f32 v7, v7
    v_mul_f32 v0, v0, v105
    v_mul_f32 v1, v1, v109
    v_mul_f32 v2, v2, v113
    v_mul_f32 v3, v3, v117
    v_mul_f32 v4, v4, v121
    v_mul_f32 v5, v5, v125
    v_mul_f32 v6, v6, v129
    v_mul_f32 v7, v7, v133
    v_cvt_pk_bf16_f32 v24, v0, v1
    v_cvt_pk_bf16_f32 v25, v2, v3
    v_cvt_pk_bf16_f32 v26, v4, v5
    v_cvt_pk_bf16_f32 v27, v6, v7
    s_add_u32 s27, s24, 33792
    buffer_store_dwordx4 v[24:27], v210, s[32:35], s27 offen sc1
    v_fma_f32 v106, v106, v216, v224
    v_fma_f32 v110, v110, v217, v225
    v_fma_f32 v114, v114, v218, v226
    v_fma_f32 v118, v118, v219, v227
    v_fma_f32 v122, v122, v220, v228
    v_fma_f32 v126, v126, v221, v229
    v_fma_f32 v130, v130, v222, v230
    v_fma_f32 v134, v134, v223, v231
    v_mul_f32 v0, v106, v106
    v_mul_f32 v1, v110, v110
    v_mul_f32 v2, v114, v114
    v_mul_f32 v3, v118, v118
    v_mul_f32 v4, v122, v122
    v_mul_f32 v5, v126, v126
    v_mul_f32 v6, v130, v130
    v_mul_f32 v7, v134, v134
    v_fma_f32 v0, v0, s26, v211
    v_fma_f32 v1, v1, s26, v211
    v_fma_f32 v2, v2, s26, v211
    v_fma_f32 v3, v3, s26, v211
    v_fma_f32 v4, v4, s26, v211
    v_fma_f32 v5, v5, s26, v211
    v_fma_f32 v6, v6, s26, v211
    v_fma_f32 v7, v7, s26, v211
    v_mul_f32 v0, v0, v106
    v_mul_f32 v1, v1, v110
    v_mul_f32 v2, v2, v114
    v_mul_f32 v3, v3, v118
    v_mul_f32 v4, v4, v122
    v_mul_f32 v5, v5, v126
    v_mul_f32 v6, v6, v130
    v_mul_f32 v7, v7, v134
    v_exp_f32 v0, v0
    v_exp_f32 v1, v1
    v_exp_f32 v2, v2
    v_exp_f32 v3, v3
    v_exp_f32 v4, v4
    v_exp_f32 v5, v5
    v_exp_f32 v6, v6
    v_exp_f32 v7, v7
    v_add_f32 v0, 1.0, v0
    v_add_f32 v1, 1.0, v1
    v_add_f32 v2, 1.0, v2
    v_add_f32 v3, 1.0, v3
    v_add_f32 v4, 1.0, v4
    v_add_f32 v5, 1.0, v5
    v_add_f32 v6, 1.0, v6
    v_add_f32 v7, 1.0, v7
    v_rcp_f32 v0, v0
    v_rcp_f32 v1, v1
    v_rcp_f32 v2, v2
    v_rcp_f32 v3, v3
    v_rcp_f32 v4, v4
    v_rcp_f32 v5, v5
    v_rcp_f32 v6, v6
    v_rcp_f32 v7, v7
    v_mul_f32 v0, v0, v106
    v_mul_f32 v1, v1, v110
    v_mul_f32 v2, v2, v114
    v_mul_f32 v3, v3, v118
    v_mul_f32 v4, v4, v122
    v_mul_f32 v5, v5, v126
    v_mul_f32 v6, v6, v130
    v_mul_f32 v7, v7, v134
    v_cvt_pk_bf16_f32 v28, v0, v1
    v_cvt_pk_bf16_f32 v29, v2, v3
    v_cvt_pk_bf16_f32 v30, v4, v5
    v_cvt_pk_bf16_f32 v31, v6, v7
    s_add_u32 s27, s24, 34816
    buffer_store_dwordx4 v[28:31], v210, s[32:35], s27 offen sc1
    v_fma_f32 v136, v136, v216, v224
    v_fma_f32 v140, v140, v217, v225
    v_fma_f32 v144, v144, v218, v226
    v_fma_f32 v148, v148, v219, v227
    v_fma_f32 v152, v152, v220, v228
    v_fma_f32 v156, v156, v221, v229
    v_fma_f32 v160, v160, v222, v230
    v_fma_f32 v164, v164, v223, v231
    v_mul_f32 v0, v136, v136
    v_mul_f32 v1, v140, v140
    v_mul_f32 v2, v144, v144
    v_mul_f32 v3, v148, v148
    v_mul_f32 v4, v152, v152
    v_mul_f32 v5, v156, v156
    v_mul_f32 v6, v160, v160
    v_mul_f32 v7, v164, v164
    v_fma_f32 v0, v0, s26, v211
    v_fma_f32 v1, v1, s26, v211
    v_fma_f32 v2, v2, s26, v211
    v_fma_f32 v3, v3, s26, v211
    v_fma_f32 v4, v4, s26, v211
    v_fma_f32 v5, v5, s26, v211
    v_fma_f32 v6, v6, s26, v211
    v_fma_f32 v7, v7, s26, v211
    v_mul_f32 v0, v0, v136
    v_mul_f32 v1, v1, v140
    v_mul_f32 v2, v2, v144
    v_mul_f32 v3, v3, v148
    v_mul_f32 v4, v4, v152
    v_mul_f32 v5, v5, v156
    v_mul_f32 v6, v6, v160
    v_mul_f32 v7, v7, v164
    v_exp_f32 v0, v0
    v_exp_f32 v1, v1
    v_exp_f32 v2, v2
    v_exp_f32 v3, v3
    v_exp_f32 v4, v4
    v_exp_f32 v5, v5
    v_exp_f32 v6, v6
    v_exp_f32 v7, v7
    v_add_f32 v0, 1.0, v0
    v_add_f32 v1, 1.0, v1
    v_add_f32 v2, 1.0, v2
    v_add_f32 v3, 1.0, v3
    v_add_f32 v4, 1.0, v4
    v_add_f32 v5, 1.0, v5
    v_add_f32 v6, 1.0, v6
    v_add_f32 v7, 1.0, v7
    v_rcp_f32 v0, v0
    v_rcp_f32 v1, v1
    v_rcp_f32 v2, v2
    v_rcp_f32 v3, v3
    v_rcp_f32 v4, v4
    v_rcp_f32 v5, v5
    v_rcp_f32 v6, v6
    v_rcp_f32 v7, v7
    v_mul_f32 v0, v0, v136
    v_mul_f32 v1, v1, v140
    v_mul_f32 v2, v2, v144
    v_mul_f32 v3, v3, v148
    v_mul_f32 v4, v4, v152
    v_mul_f32 v5, v5, v156
    v_mul_f32 v6, v6, v160
    v_mul_f32 v7, v7, v164
    v_cvt_pk_bf16_f32 v32, v0, v1
    v_cvt_pk_bf16_f32 v33, v2, v3
    v_cvt_pk_bf16_f32 v34, v4, v5
    v_cvt_pk_bf16_f32 v35, v6, v7
    s_add_u32 s27, s24, 81920
    buffer_store_dwordx4 v[32:35], v210, s[32:35], s27 offen sc1
    v_fma_f32 v137, v137, v216, v224
    v_fma_f32 v141, v141, v217, v225
    v_fma_f32 v145, v145, v218, v226
    v_fma_f32 v149, v149, v219, v227
    v_fma_f32 v153, v153, v220, v228
    v_fma_f32 v157, v157, v221, v229
    v_fma_f32 v161, v161, v222, v230
    v_fma_f32 v165, v165, v223, v231
    v_mul_f32 v0, v137, v137
    v_mul_f32 v1, v141, v141
    v_mul_f32 v2, v145, v145
    v_mul_f32 v3, v149, v149
    v_mul_f32 v4, v153, v153
    v_mul_f32 v5, v157, v157
    v_mul_f32 v6, v161, v161
    v_mul_f32 v7, v165, v165
    v_fma_f32 v0, v0, s26, v211
    v_fma_f32 v1, v1, s26, v211
    v_fma_f32 v2, v2, s26, v211
    v_fma_f32 v3, v3, s26, v211
    v_fma_f32 v4, v4, s26, v211
    v_fma_f32 v5, v5, s26, v211
    v_fma_f32 v6, v6, s26, v211
    v_fma_f32 v7, v7, s26, v211
    v_mul_f32 v0, v0, v137
    v_mul_f32 v1, v1, v141
    v_mul_f32 v2, v2, v145
    v_mul_f32 v3, v3, v149
    v_mul_f32 v4, v4, v153
    v_mul_f32 v5, v5, v157
    v_mul_f32 v6, v6, v161
    v_mul_f32 v7, v7, v165
    v_exp_f32 v0, v0
    v_exp_f32 v1, v1
    v_exp_f32 v2, v2
    v_exp_f32 v3, v3
    v_exp_f32 v4, v4
    v_exp_f32 v5, v5
    v_exp_f32 v6, v6
    v_exp_f32 v7, v7
    v_add_f32 v0, 1.0, v0
    v_add_f32 v1, 1.0, v1
    v_add_f32 v2, 1.0, v2
    v_add_f32 v3, 1.0, v3
    v_add_f32 v4, 1.0, v4
    v_add_f32 v5, 1.0, v5
    v_add_f32 v6, 1.0, v6
    v_add_f32 v7, 1.0, v7
    v_rcp_f32 v0, v0
    v_rcp_f32 v1, v1
    v_rcp_f32 v2, v2
    v_rcp_f32 v3, v3
    v_rcp_f32 v4, v4
    v_rcp_f32 v5, v5
    v_rcp_f32 v6, v6
    v_rcp_f32 v7, v7
    v_mul_f32 v0, v0, v137
    v_mul_f32 v1, v1, v141
    v_mul_f32 v2, v2, v145
    v_mul_f32 v3, v3, v149
    v_mul_f32 v4, v4, v153
    v_mul_f32 v5, v5, v157
    v_mul_f32 v6, v6, v161
    v_mul_f32 v7, v7, v165
    v_cvt_pk_bf16_f32 v36, v0, v1
    v_cvt_pk_bf16_f32 v37, v2, v3
    v_cvt_pk_bf16_f32 v38, v4, v5
    v_cvt_pk_bf16_f32 v39, v6, v7
    s_add_u32 s27, s24, 82944
    buffer_store_dwordx4 v[36:39], v210, s[32:35], s27 offen sc1
    v_fma_f32 v138, v138, v216, v224
    v_fma_f32 v142, v142, v217, v225
    v_fma_f32 v146, v146, v218, v226
    v_fma_f32 v150, v150, v219, v227
    v_fma_f32 v154, v154, v220, v228
    v_fma_f32 v158, v158, v221, v229
    v_fma_f32 v162, v162, v222, v230
    v_fma_f32 v166, v166, v223, v231
    v_mul_f32 v0, v138, v138
    v_mul_f32 v1, v142, v142
    v_mul_f32 v2, v146, v146
    v_mul_f32 v3, v150, v150
    v_mul_f32 v4, v154, v154
    v_mul_f32 v5, v158, v158
    v_mul_f32 v6, v162, v162
    v_mul_f32 v7, v166, v166
    v_fma_f32 v0, v0, s26, v211
    v_fma_f32 v1, v1, s26, v211
    v_fma_f32 v2, v2, s26, v211
    v_fma_f32 v3, v3, s26, v211
    v_fma_f32 v4, v4, s26, v211
    v_fma_f32 v5, v5, s26, v211
    v_fma_f32 v6, v6, s26, v211
    v_fma_f32 v7, v7, s26, v211
    v_mul_f32 v0, v0, v138
    v_mul_f32 v1, v1, v142
    v_mul_f32 v2, v2, v146
    v_mul_f32 v3, v3, v150
    v_mul_f32 v4, v4, v154
    v_mul_f32 v5, v5, v158
    v_mul_f32 v6, v6, v162
    v_mul_f32 v7, v7, v166
    v_exp_f32 v0, v0
    v_exp_f32 v1, v1
    v_exp_f32 v2, v2
    v_exp_f32 v3, v3
    v_exp_f32 v4, v4
    v_exp_f32 v5, v5
    v_exp_f32 v6, v6
    v_exp_f32 v7, v7
    v_add_f32 v0, 1.0, v0
    v_add_f32 v1, 1.0, v1
    v_add_f32 v2, 1.0, v2
    v_add_f32 v3, 1.0, v3
    v_add_f32 v4, 1.0, v4
    v_add_f32 v5, 1.0, v5
    v_add_f32 v6, 1.0, v6
    v_add_f32 v7, 1.0, v7
    v_rcp_f32 v0, v0
    v_rcp_f32 v1, v1
    v_rcp_f32 v2, v2
    v_rcp_f32 v3, v3
    v_rcp_f32 v4, v4
    v_rcp_f32 v5, v5
    v_rcp_f32 v6, v6
    v_rcp_f32 v7, v7
    v_mul_f32 v0, v0, v138
    v_mul_f32 v1, v1, v142
    v_mul_f32 v2, v2, v146
    v_mul_f32 v3, v3, v150
    v_mul_f32 v4, v4, v154
    v_mul_f32 v5, v5, v158
    v_mul_f32 v6, v6, v162
    v_mul_f32 v7, v7, v166
    v_cvt_pk_bf16_f32 v40, v0, v1
    v_cvt_pk_bf16_f32 v41, v2, v3
    v_cvt_pk_bf16_f32 v42, v4, v5
    v_cvt_pk_bf16_f32 v43, v6, v7
    s_add_u32 s27, s24, 83968
    buffer_store_dwordx4 v[40:43], v210, s[32:35], s27 offen sc1
    v_fma_f32 v168, v168, v216, v224
    v_fma_f32 v172, v172, v217, v225
    v_fma_f32 v176, v176, v218, v226
    v_fma_f32 v180, v180, v219, v227
    v_fma_f32 v184, v184, v220, v228
    v_fma_f32 v188, v188, v221, v229
    v_fma_f32 v192, v192, v222, v230
    v_fma_f32 v196, v196, v223, v231
    v_mul_f32 v0, v168, v168
    v_mul_f32 v1, v172, v172
    v_mul_f32 v2, v176, v176
    v_mul_f32 v3, v180, v180
    v_mul_f32 v4, v184, v184
    v_mul_f32 v5, v188, v188
    v_mul_f32 v6, v192, v192
    v_mul_f32 v7, v196, v196
    v_fma_f32 v0, v0, s26, v211
    v_fma_f32 v1, v1, s26, v211
    v_fma_f32 v2, v2, s26, v211
    v_fma_f32 v3, v3, s26, v211
    v_fma_f32 v4, v4, s26, v211
    v_fma_f32 v5, v5, s26, v211
    v_fma_f32 v6, v6, s26, v211
    v_fma_f32 v7, v7, s26, v211
    v_mul_f32 v0, v0, v168
    v_mul_f32 v1, v1, v172
    v_mul_f32 v2, v2, v176
    v_mul_f32 v3, v3, v180
    v_mul_f32 v4, v4, v184
    v_mul_f32 v5, v5, v188
    v_mul_f32 v6, v6, v192
    v_mul_f32 v7, v7, v196
    v_exp_f32 v0, v0
    v_exp_f32 v1, v1
    v_exp_f32 v2, v2
    v_exp_f32 v3, v3
    v_exp_f32 v4, v4
    v_exp_f32 v5, v5
    v_exp_f32 v6, v6
    v_exp_f32 v7, v7
    v_add_f32 v0, 1.0, v0
    v_add_f32 v1, 1.0, v1
    v_add_f32 v2, 1.0, v2
    v_add_f32 v3, 1.0, v3
    v_add_f32 v4, 1.0, v4
    v_add_f32 v5, 1.0, v5
    v_add_f32 v6, 1.0, v6
    v_add_f32 v7, 1.0, v7
    v_rcp_f32 v0, v0
    v_rcp_f32 v1, v1
    v_rcp_f32 v2, v2
    v_rcp_f32 v3, v3
    v_rcp_f32 v4, v4
    v_rcp_f32 v5, v5
    v_rcp_f32 v6, v6
    v_rcp_f32 v7, v7
    v_mul_f32 v0, v0, v168
    v_mul_f32 v1, v1, v172
    v_mul_f32 v2, v2, v176
    v_mul_f32 v3, v3, v180
    v_mul_f32 v4, v4, v184
    v_mul_f32 v5, v5, v188
    v_mul_f32 v6, v6, v192
    v_mul_f32 v7, v7, v196
    v_cvt_pk_bf16_f32 v44, v0, v1
    v_cvt_pk_bf16_f32 v45, v2, v3
    v_cvt_pk_bf16_f32 v46, v4, v5
    v_cvt_pk_bf16_f32 v47, v6, v7
    s_add_u32 s27, s24, 131072
    buffer_store_dwordx4 v[44:47], v210, s[32:35], s27 offen sc1
    v_fma_f32 v169, v169, v216, v224
    v_fma_f32 v173, v173, v217, v225
    v_fma_f32 v177, v177, v218, v226
    v_fma_f32 v181, v181, v219, v227
    v_fma_f32 v185, v185, v220, v228
    v_fma_f32 v189, v189, v221, v229
    v_fma_f32 v193, v193, v222, v230
    v_fma_f32 v197, v197, v223, v231
    v_mul_f32 v0, v169, v169
    v_mul_f32 v1, v173, v173
    v_mul_f32 v2, v177, v177
    v_mul_f32 v3, v181, v181
    v_mul_f32 v4, v185, v185
    v_mul_f32 v5, v189, v189
    v_mul_f32 v6, v193, v193
    v_mul_f32 v7, v197, v197
    v_fma_f32 v0, v0, s26, v211
    v_fma_f32 v1, v1, s26, v211
    v_fma_f32 v2, v2, s26, v211
    v_fma_f32 v3, v3, s26, v211
    v_fma_f32 v4, v4, s26, v211
    v_fma_f32 v5, v5, s26, v211
    v_fma_f32 v6, v6, s26, v211
    v_fma_f32 v7, v7, s26, v211
    v_mul_f32 v0, v0, v169
    v_mul_f32 v1, v1, v173
    v_mul_f32 v2, v2, v177
    v_mul_f32 v3, v3, v181
    v_mul_f32 v4, v4, v185
    v_mul_f32 v5, v5, v189
    v_mul_f32 v6, v6, v193
    v_mul_f32 v7, v7, v197
    v_exp_f32 v0, v0
    v_exp_f32 v1, v1
    v_exp_f32 v2, v2
    v_exp_f32 v3, v3
    v_exp_f32 v4, v4
    v_exp_f32 v5, v5
    v_exp_f32 v6, v6
    v_exp_f32 v7, v7
    v_add_f32 v0, 1.0, v0
    v_add_f32 v1, 1.0, v1
    v_add_f32 v2, 1.0, v2
    v_add_f32 v3, 1.0, v3
    v_add_f32 v4, 1.0, v4
    v_add_f32 v5, 1.0, v5
    v_add_f32 v6, 1.0, v6
    v_add_f32 v7, 1.0, v7
    v_rcp_f32 v0, v0
    v_rcp_f32 v1, v1
    v_rcp_f32 v2, v2
    v_rcp_f32 v3, v3
    v_rcp_f32 v4, v4
    v_rcp_f32 v5, v5
    v_rcp_f32 v6, v6
    v_rcp_f32 v7, v7
    v_mul_f32 v0, v0, v169
    v_mul_f32 v1, v1, v173
    v_mul_f32 v2, v2, v177
    v_mul_f32 v3, v3, v181
    v_mul_f32 v4, v4, v185
    v_mul_f32 v5, v5, v189
    v_mul_f32 v6, v6, v193
    v_mul_f32 v7, v7, v197
    v_cvt_pk_bf16_f32 v16, v0, v1
    v_cvt_pk_bf16_f32 v17, v2, v3
    v_cvt_pk_bf16_f32 v18, v4, v5
    v_cvt_pk_bf16_f32 v19, v6, v7
    s_add_u32 s27, s24, 132096
    buffer_store_dwordx4 v[16:19], v210, s[32:35], s27 offen sc1
    v_fma_f32 v170, v170, v216, v224
    v_fma_f32 v174, v174, v217, v225
    v_fma_f32 v178, v178, v218, v226
    v_fma_f32 v182, v182, v219, v227
    v_fma_f32 v186, v186, v220, v228
    v_fma_f32 v190, v190, v221, v229
    v_fma_f32 v194, v194, v222, v230
    v_fma_f32 v198, v198, v223, v231
    v_mul_f32 v0, v170, v170
    v_mul_f32 v1, v174, v174
    v_mul_f32 v2, v178, v178
    v_mul_f32 v3, v182, v182
    v_mul_f32 v4, v186, v186
    v_mul_f32 v5, v190, v190
    v_mul_f32 v6, v194, v194
    v_mul_f32 v7, v198, v198
    v_fma_f32 v0, v0, s26, v211
    v_fma_f32 v1, v1, s26, v211
    v_fma_f32 v2, v2, s26, v211
    v_fma_f32 v3, v3, s26, v211
    v_fma_f32 v4, v4, s26, v211
    v_fma_f32 v5, v5, s26, v211
    v_fma_f32 v6, v6, s26, v211
    v_fma_f32 v7, v7, s26, v211
    v_mul_f32 v0, v0, v170
    v_mul_f32 v1, v1, v174
    v_mul_f32 v2, v2, v178
    v_mul_f32 v3, v3, v182
    v_mul_f32 v4, v4, v186
    v_mul_f32 v5, v5, v190
    v_mul_f32 v6, v6, v194
    v_mul_f32 v7, v7, v198
    v_exp_f32 v0, v0
    v_exp_f32 v1, v1
    v_exp_f32 v2, v2
    v_exp_f32 v3, v3
    v_exp_f32 v4, v4
    v_exp_f32 v5, v5
    v_exp_f32 v6, v6
    v_exp_f32 v7, v7
    v_add_f32 v0, 1.0, v0
    v_add_f32 v1, 1.0, v1
    v_add_f32 v2, 1.0, v2
    v_add_f32 v3, 1.0, v3
    v_add_f32 v4, 1.0, v4
    v_add_f32 v5, 1.0, v5
    v_add_f32 v6, 1.0, v6
    v_add_f32 v7, 1.0, v7
    v_rcp_f32 v0, v0
    v_rcp_f32 v1, v1
    v_rcp_f32 v2, v2
    v_rcp_f32 v3, v3
    v_rcp_f32 v4, v4
    v_rcp_f32 v5, v5
    v_rcp_f32 v6, v6
    v_rcp_f32 v7, v7
    v_mul_f32 v0, v0, v170
    v_mul_f32 v1, v1, v174
    v_mul_f32 v2, v2, v178
    v_mul_f32 v3, v3, v182
    v_mul_f32 v4, v4, v186
    v_mul_f32 v5, v5, v190
    v_mul_f32 v6, v6, v194
    v_mul_f32 v7, v7, v198
    v_cvt_pk_bf16_f32 v20, v0, v1
    v_cvt_pk_bf16_f32 v21, v2, v3
    v_cvt_pk_bf16_f32 v22, v4, v5
    v_cvt_pk_bf16_f32 v23, v6, v7
    s_add_u32 s27, s24, 133120
    buffer_store_dwordx4 v[20:23], v210, s[32:35], s27 offen sc1
L_k45_fin:
L_k45_end:
    s_endpgm
L_code_end:
    s_endpgm
.section .rodata,"a"
.p2align 6
.amdhsa_kernel xform_kernel
  .amdhsa_next_free_vgpr 232
  .amdhsa_next_free_sgpr 96
  .amdhsa_accum_offset 232
  .amdhsa_group_segment_fixed_size 0
  .amdhsa_kernarg_size 56
  .amdhsa_user_sgpr_count 2
  .amdhsa_user_sgpr_kernarg_segment_ptr 1
  .amdhsa_system_sgpr_workgroup_id_x 1
  .amdhsa_float_denorm_mode_32 3
.end_amdhsa_kernel

.p2align 6
.amdhsa_kernel gemm_kernel
  .amdhsa_next_free_vgpr 256
  .amdhsa_next_free_sgpr 96
  .amdhsa_accum_offset 256
  .amdhsa_group_segment_fixed_size 0
  .amdhsa_kernarg_size 56
  .amdhsa_user_sgpr_count 2
  .amdhsa_user_sgpr_kernarg_segment_ptr 1
  .amdhsa_system_sgpr_workgroup_id_x 1
  .amdhsa_float_denorm_mode_32 3
.end_amdhsa_kernel

.p2align 6
.amdhsa_kernel final_kernel
  .amdhsa_next_free_vgpr 240
  .amdhsa_next_free_sgpr 96
  .amdhsa_accum_offset 240
  .amdhsa_group_segment_fixed_size 0
  .amdhsa_kernarg_size 56
  .amdhsa_user_sgpr_count 2
  .amdhsa_user_sgpr_kernarg_segment_ptr 1
  .amdhsa_system_sgpr_workgroup_id_x 1
  .amdhsa_float_denorm_mode_32 3
.end_amdhsa_kernel
```

```asm
; @launch kernel=xform_kernel grid=(256,1,1) block=(256,1,1) lds=12352
; @launch kernel=gemm_kernel grid=(256,1,1) block=(512,1,1) lds=155648
; @launch kernel=final_kernel grid=(224,1,1) block=(512,1,1) lds=82944
.amdgcn_target "amdgcn-amd-amdhsa--gfx950"
.text
.globl xform_kernel
.p2align 8
.type xform_kernel,@function
xform_kernel:
    s_cmp_ge_u32 s2, 256
    s_cbranch_scc1 L_k12_end
    s_load_dwordx4 s[4:7], s[0:1], 0
    s_load_dwordx4 s[36:39], s[0:1], 40
    v_lshrrev_b32 v213, 6, v0
    s_cmp_ge_u32 s2, 8
    s_cbranch_scc1 L_nopf12
    v_readfirstlane_b32 s10, v213
    s_nop 3
    s_cmp_lg_u32 s10, 3
    s_cbranch_scc1 L_nopf12
    s_getpc_b64 s[60:61]
L_pf_k12:
    s_sub_u32 s60, s60, L_pf_k12-xform_kernel
    s_subb_u32 s61, s61, 0
    v_mbcnt_lo_u32_b32 v184, -1, 0
    v_mbcnt_hi_u32_b32 v184, -1, v184
    v_lshlrev_b32 v184, 6, v184
    v_add_u32 v185, 0, v184
    v_min_u32 v185, L_code_end-xform_kernel-4, v185
    v_mov_b32 v187, s61
    v_add_co_u32 v186, vcc, s60, v185
    s_nop 1
    v_addc_co_u32 v187, vcc, 0, v187, vcc
    global_load_dword v188, v[186:187], off
    v_add_u32 v185, 4096, v184
    v_min_u32 v185, L_code_end-xform_kernel-4, v185
    v_mov_b32 v187, s61
    v_add_co_u32 v186, vcc, s60, v185
    s_nop 1
    v_addc_co_u32 v187, vcc, 0, v187, vcc
    global_load_dword v188, v[186:187], off
    v_add_u32 v185, 8192, v184
    v_min_u32 v185, L_code_end-xform_kernel-4, v185
    v_mov_b32 v187, s61
    v_add_co_u32 v186, vcc, s60, v185
    s_nop 1
    v_addc_co_u32 v187, vcc, 0, v187, vcc
    global_load_dword v188, v[186:187], off
    v_add_u32 v185, 12288, v184
    v_min_u32 v185, L_code_end-xform_kernel-4, v185
    v_mov_b32 v187, s61
    v_add_co_u32 v186, vcc, s60, v185
    s_nop 1
    v_addc_co_u32 v187, vcc, 0, v187, vcc
    global_load_dword v188, v[186:187], off
    v_add_u32 v185, 16384, v184
    v_min_u32 v185, L_code_end-xform_kernel-4, v185
    v_mov_b32 v187, s61
    v_add_co_u32 v186, vcc, s60, v185
    s_nop 1
    v_addc_co_u32 v187, vcc, 0, v187, vcc
    global_load_dword v188, v[186:187], off
    v_add_u32 v185, 20480, v184
    v_min_u32 v185, L_code_end-xform_kernel-4, v185
    v_mov_b32 v187, s61
    v_add_co_u32 v186, vcc, s60, v185
    s_nop 1
    v_addc_co_u32 v187, vcc, 0, v187, vcc
    global_load_dword v188, v[186:187], off
    v_add_u32 v185, 24576, v184
    v_min_u32 v185, L_code_end-xform_kernel-4, v185
    v_mov_b32 v187, s61
    v_add_co_u32 v186, vcc, s60, v185
    s_nop 1
    v_addc_co_u32 v187, vcc, 0, v187, vcc
    global_load_dword v188, v[186:187], off
    v_add_u32 v185, 28672, v184
    v_min_u32 v185, L_code_end-xform_kernel-4, v185
    v_mov_b32 v187, s61
    v_add_co_u32 v186, vcc, s60, v185
    s_nop 1
    v_addc_co_u32 v187, vcc, 0, v187, vcc
    global_load_dword v188, v[186:187], off
    v_add_u32 v185, 32768, v184
    v_min_u32 v185, L_code_end-xform_kernel-4, v185
    v_mov_b32 v187, s61
    v_add_co_u32 v186, vcc, s60, v185
    s_nop 1
    v_addc_co_u32 v187, vcc, 0, v187, vcc
    global_load_dword v188, v[186:187], off
    v_add_u32 v185, 36864, v184
    v_min_u32 v185, L_code_end-xform_kernel-4, v185
    v_mov_b32 v187, s61
    v_add_co_u32 v186, vcc, s60, v185
    s_nop 1
    v_addc_co_u32 v187, vcc, 0, v187, vcc
    global_load_dword v188, v[186:187], off
L_nopf12:
    v_and_b32 v208, 63, v0
    v_lshrrev_b32 v213, 6, v0
    v_and_b32 v209, 15, v208
    v_readfirstlane_b32 s10, v213
    v_lshrrev_b32 v210, 4, v208
    v_lshlrev_b32 v223, 4, v208
    v_mov_b32 v222, 0
    s_mov_b32 s30, 0x05040100
    s_mov_b32 s31, 0x07060302
    s_mov_b32 s32, 0x01000100
    s_mov_b32 s33, 0x03020302
    s_mov_b32 s40, s2
    s_add_u32 s42, s2, 256
    s_mov_b32 s41, 0
    s_mov_b32 s43, 0
    v_lshlrev_b32 v224, 14, v210
    v_lshl_add_u32 v224, v209, 4, v224
    v_lshlrev_b32 v225, 22, v210
    v_lshrrev_b32 v213, 2, v209
    v_lshl_add_u32 v225, v213, 6, v225
    v_and_b32 v213, 1, v209
    v_lshl_add_u32 v225, v213, 5, v225
    v_bfe_u32 v213, v209, 1, 1
    v_lshl_add_u32 v225, v213, 3, v225
    v_lshrrev_b32 v213, 2, v209
    s_mov_b32 s24, 688128
    v_mul_u32_u24 v226, s24, v213
    s_mov_b32 s24, 43008
    v_mad_u32_u24 v226, v210, s24, v226
    s_mov_b32 s24, 32768
    v_mul_u32_u24 v227, s24, v210
    s_waitcnt lgkmcnt(0)
    s_mov_b32 s16, s38
    s_and_b32 s17, s39, 0xffff
    s_mov_b32 s18, 268435456
    s_mov_b32 s19, 0x00020000
    s_mov_b32 s44, s36
    s_and_b32 s45, s37, 0xffff
    s_mov_b32 s46, 256
    s_mov_b32 s47, 0x00020000
    s_cmp_ge_u32 s40, 1696
    s_cbranch_scc1 L_ld_done0
    s_cmp_ge_u32 s40, 672
    s_cbranch_scc1 L_ld_w0
    s_cmp_ge_u32 s40, 336
    s_cselect_b32 s11, 1, 0
    s_mul_i32 s12, s11, 336
    s_sub_u32 s12, s40, s12
    s_and_b32 s13, s12, 7
    s_lshr_b32 s14, s12, 3
    s_lshl_b32 s14, s14, 2
    s_add_u32 s14, s14, s10
    s_mul_i32 s15, s11, 16384000
    s_add_u32 s34, s4, s15
    s_addc_u32 s35, s5, 0
    s_mov_b32 s20, s34
    s_and_b32 s21, s35, 0xffff
    s_mov_b32 s22, 16384000
    s_mov_b32 s23, 0x00020000
    s_mul_i32 s15, s14, 98304
    s_lshl_b32 s24, s13, 8
    s_add_u32 s15, s15, s24
    s_add_u32 s25, s15, 0
    buffer_load_dwordx4 v[0:3], v224, s[20:23], s25 offen
    s_add_u32 s25, s15, 2048
    buffer_load_dwordx4 v[4:7], v224, s[20:23], s25 offen
    s_add_u32 s25, s15, 4096
    buffer_load_dwordx4 v[8:11], v224, s[20:23], s25 offen
    s_add_u32 s25, s15, 6144
    buffer_load_dwordx4 v[12:15], v224, s[20:23], s25 offen
    s_add_u32 s25, s15, 8192
    buffer_load_dwordx4 v[16:19], v224, s[20:23], s25 offen
    s_add_u32 s25, s15, 10240
    buffer_load_dwordx4 v[20:23], v224, s[20:23], s25 offen
    s_add_u32 s25, s15, 12288
    buffer_load_dwordx4 v[24:27], v224, s[20:23], s25 offen
    s_add_u32 s25, s15, 14336
    buffer_load_dwordx4 v[28:31], v224, s[20:23], s25 offen
    s_add_u32 s25, s15, 65536
    buffer_load_dwordx4 v[32:35], v224, s[20:23], s25 offen
    s_add_u32 s25, s15, 67584
    buffer_load_dwordx4 v[36:39], v224, s[20:23], s25 offen
    s_add_u32 s25, s15, 69632
    buffer_load_dwordx4 v[40:43], v224, s[20:23], s25 offen
    s_add_u32 s25, s15, 71680
    buffer_load_dwordx4 v[44:47], v224, s[20:23], s25 offen
    s_add_u32 s25, s15, 73728
    buffer_load_dwordx4 v[48:51], v224, s[20:23], s25 offen
    s_add_u32 s25, s15, 75776
    buffer_load_dwordx4 v[52:55], v224, s[20:23], s25 offen
    s_add_u32 s25, s15, 77824
    buffer_load_dwordx4 v[56:59], v224, s[20:23], s25 offen
    s_add_u32 s25, s15, 79872
    buffer_load_dwordx4 v[60:63], v224, s[20:23], s25 offen
    s_branch L_ld_done0
L_ld_w0:
    s_sub_u32 s12, s40, 672
    s_and_b32 s13, s12, 3
    s_lshr_b32 s14, s12, 2
    s_lshl_b32 s14, s14, 2
    s_add_u32 s14, s14, s10
    s_mov_b32 s20, s6
    s_and_b32 s21, s7, 0xffff
    s_mov_b32 s22, 16252928
    s_mov_b32 s23, 0x00020000
    s_lshl_b32 s15, s14, 10
    s_lshl_b32 s24, s13, 8
    s_add_u32 s15, s15, s24
    s_add_u32 s25, s15, 0
    buffer_load_dwordx2 v[0:1], v225, s[20:23], s25 offen
    buffer_load_dwordx2 v[2:3], v225, s[20:23], s25 offen offset:16
    s_add_u32 s25, s15, 1048576
    buffer_load_dwordx2 v[4:5], v225, s[20:23], s25 offen
    buffer_load_dwordx2 v[6:7], v225, s[20:23], s25 offen offset:16
    s_add_u32 s25, s15, 2097152
    buffer_load_dwordx2 v[8:9], v225, s[20:23], s25 offen
    buffer_load_dwordx2 v[10:11], v225, s[20:23], s25 offen offset:16
    s_add_u32 s25, s15, 3145728
    buffer_load_dwordx2 v[12:13], v225, s[20:23], s25 offen
    buffer_load_dwordx2 v[14:15], v225, s[20:23], s25 offen offset:16
L_ld_done0:
    v_lshrrev_b32 v213, 2, v209
    v_lshlrev_b32 v213, 1, v213
    v_bfe_u32 v214, v209, 1, 1
    v_add_u32 v213, v213, v214
    s_lshl_b32 s24, s10, 3
    v_add_u32 v213, s24, v213
    v_lshl_add_u32 v213, v213, 1, 1
    v_and_b32 v214, 1, v209
    v_lshlrev_b32 v214, 5, v214
    v_lshlrev_b32 v215, 3, v210
    v_mad_u32_u24 v160, v213, v215, v214
    v_add_u32 v161, v160, v213
    v_add_u32 v162, v161, v213
    v_add_u32 v163, v162, v213
    v_add_u32 v164, v163, v213
    v_add_u32 v165, v164, v213
    v_add_u32 v166, v165, v213
    v_add_u32 v167, v166, v213
    v_and_b32 v160, 127, v160
    v_cvt_f32_u32 v160, v160
    v_mul_f32 v160, 0x3c000000, v160
    v_cos_f32 v160, v160
    v_and_b32 v161, 127, v161
    v_cvt_f32_u32 v161, v161
    v_mul_f32 v161, 0x3c000000, v161
    v_cos_f32 v161, v161
    v_and_b32 v162, 127, v162
    v_cvt_f32_u32 v162, v162
    v_mul_f32 v162, 0x3c000000, v162
    v_cos_f32 v162, v162
    v_and_b32 v163, 127, v163
    v_cvt_f32_u32 v163, v163
    v_mul_f32 v163, 0x3c000000, v163
    v_cos_f32 v163, v163
    v_and_b32 v164, 127, v164
    v_cvt_f32_u32 v164, v164
    v_mul_f32 v164, 0x3c000000, v164
    v_cos_f32 v164, v164
    v_and_b32 v165, 127, v165
    v_cvt_f32_u32 v165, v165
    v_mul_f32 v165, 0x3c000000, v165
    v_cos_f32 v165, v165
    v_and_b32 v166, 127, v166
    v_cvt_f32_u32 v166, v166
    v_mul_f32 v166, 0x3c000000, v166
    v_cos_f32 v166, v166
    v_and_b32 v167, 127, v167
    v_cvt_f32_u32 v167, v167
    v_mul_f32 v167, 0x3c000000, v167
    v_cos_f32 v167, v167
    v_cvt_pk_bf16_f32 v176, v160, v161
    v_cvt_pk_bf16_f32 v177, v162, v163
    v_cvt_pk_bf16_f32 v178, v164, v165
    v_cvt_pk_bf16_f32 v179, v166, v167
    s_lshl_b32 s24, s10, 11
    v_add_u32 v216, s24, v223
    ds_write_b128 v216, v[176:179] offset:0
    v_lshlrev_b32 v215, 3, v210
    v_add_u32 v215, 32, v215
    v_mad_u32_u24 v160, v213, v215, v214
    v_add_u32 v161, v160, v213
    v_add_u32 v162, v161, v213
    v_add_u32 v163, v162, v213
    v_add_u32 v164, v163, v213
    v_add_u32 v165, v164, v213
    v_add_u32 v166, v165, v213
    v_add_u32 v167, v166, v213
    v_and_b32 v160, 127, v160
    v_cvt_f32_u32 v160, v160
    v_mul_f32 v160, 0x3c000000, v160
    v_cos_f32 v160, v160
    v_and_b32 v161, 127, v161
    v_cvt_f32_u32 v161, v161
    v_mul_f32 v161, 0x3c000000, v161
    v_cos_f32 v161, v161
    v_and_b32 v162, 127, v162
    v_cvt_f32_u32 v162, v162
    v_mul_f32 v162, 0x3c000000, v162
    v_cos_f32 v162, v162
    v_and_b32 v163, 127, v163
    v_cvt_f32_u32 v163, v163
    v_mul_f32 v163, 0x3c000000, v163
    v_cos_f32 v163, v163
    v_and_b32 v164, 127, v164
    v_cvt_f32_u32 v164, v164
    v_mul_f32 v164, 0x3c000000, v164
    v_cos_f32 v164, v164
    v_and_b32 v165, 127, v165
    v_cvt_f32_u32 v165, v165
    v_mul_f32 v165, 0x3c000000, v165
    v_cos_f32 v165, v165
    v_and_b32 v166, 127, v166
    v_cvt_f32_u32 v166, v166
    v_mul_f32 v166, 0x3c000000, v166
    v_cos_f32 v166, v166
    v_and_b32 v167, 127, v167
    v_cvt_f32_u32 v167, v167
    v_mul_f32 v167, 0x3c000000, v167
    v_cos_f32 v167, v167
    v_cvt_pk_bf16_f32 v176, v160, v161
    v_cvt_pk_bf16_f32 v177, v162, v163
    v_cvt_pk_bf16_f32 v178, v164, v165
    v_cvt_pk_bf16_f32 v179, v166, v167
    s_lshl_b32 s24, s10, 11
    v_add_u32 v216, s24, v223
    ds_write_b128 v216, v[176:179] offset:1024
    v_lshlrev_b32 v215, 2, v210
    v_mad_u32_u24 v160, v213, v215, v214
    v_add_u32 v161, v160, v213
    v_add_u32 v162, v161, v213
    v_add_u32 v163, v162, v213
    v_and_b32 v160, 127, v160
    v_cvt_f32_u32 v160, v160
    v_mul_f32 v160, 0x3c000000, v160
    v_cos_f32 v160, v160
    v_and_b32 v161, 127, v161
    v_cvt_f32_u32 v161, v161
    v_mul_f32 v161, 0x3c000000, v161
    v_cos_f32 v161, v161
    v_and_b32 v162, 127, v162
    v_cvt_f32_u32 v162, v162
    v_mul_f32 v162, 0x3c000000, v162
    v_cos_f32 v162, v162
    v_and_b32 v163, 127, v163
    v_cvt_f32_u32 v163, v163
    v_mul_f32 v163, 0x3c000000, v163
    v_cos_f32 v163, v163
    v_cvt_pk_bf16_f32 v180, v160, v160
    v_lshlrev_b32 v181, 16, v180
    v_sub_f32 v181, v160, v181
    v_cvt_pk_bf16_f32 v181, v181, v181
    v_perm_b32 v176, v181, v180, s30
    v_cvt_pk_bf16_f32 v180, v161, v161
    v_lshlrev_b32 v181, 16, v180
    v_sub_f32 v181, v161, v181
    v_cvt_pk_bf16_f32 v181, v181, v181
    v_perm_b32 v177, v181, v180, s30
    v_cvt_pk_bf16_f32 v180, v162, v162
    v_lshlrev_b32 v181, 16, v180
    v_sub_f32 v181, v162, v181
    v_cvt_pk_bf16_f32 v181, v181, v181
    v_perm_b32 v178, v181, v180, s30
    v_cvt_pk_bf16_f32 v180, v163, v163
    v_lshlrev_b32 v181, 16, v180
    v_sub_f32 v181, v163, v181
    v_cvt_pk_bf16_f32 v181, v181, v181
    v_perm_b32 v179, v181, v180, s30
    s_lshl_b32 s24, s10, 10
    v_add_u32 v216, s24, v223
    ds_write_b128 v216, v[176:179] offset:8192
    s_waitcnt lgkmcnt(0)
    s_barrier
L_k12_loop:
    s_cmp_lg_u32 s10, 0
    s_cbranch_scc1 L_nofetch0
    v_mov_b32 v221, 1
    s_mov_b64 exec, 1
    buffer_atomic_add v221, v222, s[44:47], 0 offen sc0 sc1
    s_mov_b64 exec, -1
L_nofetch0:
    s_cmp_ge_u32 s42, 1696
    s_cbranch_scc1 L_ld_done1
    s_cmp_ge_u32 s42, 672
    s_cbranch_scc1 L_ld_w1
    s_cmp_ge_u32 s42, 336
    s_cselect_b32 s11, 1, 0
    s_mul_i32 s12, s11, 336
    s_sub_u32 s12, s42, s12
    s_and_b32 s13, s12, 7
    s_lshr_b32 s14, s12, 3
    s_lshl_b32 s14, s14, 2
    s_add_u32 s14, s14, s10
    s_mul_i32 s15, s11, 16384000
    s_add_u32 s34, s4, s15
    s_addc_u32 s35, s5, 0
    s_mov_b32 s20, s34
    s_and_b32 s21, s35, 0xffff
    s_mov_b32 s22, 16384000
    s_mov_b32 s23, 0x00020000
    s_mul_i32 s15, s14, 98304
    s_lshl_b32 s24, s13, 8
    s_add_u32 s15, s15, s24
    s_add_u32 s25, s15, 0
    buffer_load_dwordx4 v[64:67], v224, s[20:23], s25 offen
    s_add_u32 s25, s15, 2048
    buffer_load_dwordx4 v[68:71], v224, s[20:23], s25 offen
    s_add_u32 s25, s15, 4096
    buffer_load_dwordx4 v[72:75], v224, s[20:23], s25 offen
    s_add_u32 s25, s15, 6144
    buffer_load_dwordx4 v[76:79], v224, s[20:23], s25 offen
    s_add_u32 s25, s15, 8192
    buffer_load_dwordx4 v[80:83], v224, s[20:23], s25 offen
    s_add_u32 s25, s15, 10240
    buffer_load_dwordx4 v[84:87], v224, s[20:23], s25 offen
    s_add_u32 s25, s15, 12288
    buffer_load_dwordx4 v[88:91], v224, s[20:23], s25 offen
    s_add_u32 s25, s15, 14336
    buffer_load_dwordx4 v[92:95], v224, s[20:23], s25 offen
    s_add_u32 s25, s15, 65536
    buffer_load_dwordx4 v[96:99], v224, s[20:23], s25 offen
    s_add_u32 s25, s15, 67584
    buffer_load_dwordx4 v[100:103], v224, s[20:23], s25 offen
    s_add_u32 s25, s15, 69632
    buffer_load_dwordx4 v[104:107], v224, s[20:23], s25 offen
    s_add_u32 s25, s15, 71680
    buffer_load_dwordx4 v[108:111], v224, s[20:23], s25 offen
    s_add_u32 s25, s15, 73728
    buffer_load_dwordx4 v[112:115], v224, s[20:23], s25 offen
    s_add_u32 s25, s15, 75776
    buffer_load_dwordx4 v[116:119], v224, s[20:23], s25 offen
    s_add_u32 s25, s15, 77824
    buffer_load_dwordx4 v[120:123], v224, s[20:23], s25 offen
    s_add_u32 s25, s15, 79872
    buffer_load_dwordx4 v[124:127], v224, s[20:23], s25 offen
    s_branch L_ld_done1
L_ld_w1:
    s_sub_u32 s12, s42, 672
    s_and_b32 s13, s12, 3
    s_lshr_b32 s14, s12, 2
    s_lshl_b32 s14, s14, 2
    s_add_u32 s14, s14, s10
    s_mov_b32 s20, s6
    s_and_b32 s21, s7, 0xffff
    s_mov_b32 s22, 16252928
    s_mov_b32 s23, 0x00020000
    s_lshl_b32 s15, s14, 10
    s_lshl_b32 s24, s13, 8
    s_add_u32 s15, s15, s24
    s_add_u32 s25, s15, 0
    buffer_load_dwordx2 v[64:65], v225, s[20:23], s25 offen
    buffer_load_dwordx2 v[66:67], v225, s[20:23], s25 offen offset:16
    s_add_u32 s25, s15, 1048576
    buffer_load_dwordx2 v[68:69], v225, s[20:23], s25 offen
    buffer_load_dwordx2 v[70:71], v225, s[20:23], s25 offen offset:16
    s_add_u32 s25, s15, 2097152
    buffer_load_dwordx2 v[72:73], v225, s[20:23], s25 offen
    buffer_load_dwordx2 v[74:75], v225, s[20:23], s25 offen offset:16
    s_add_u32 s25, s15, 3145728
    buffer_load_dwordx2 v[76:77], v225, s[20:23], s25 offen
    buffer_load_dwordx2 v[78:79], v225, s[20:23], s25 offen offset:16
L_ld_done1:
    s_cmp_lg_u32 s43, 0
    s_cbranch_scc1 L_notfirst
    s_cmp_ge_u32 s42, 1696
    s_cbranch_scc1 L_w0_f
    s_cmp_ge_u32 s42, 672
    s_cbranch_scc1 L_w8_f
    s_waitcnt vmcnt(16)
    s_branch L_wd_f
L_w8_f:
    s_waitcnt vmcnt(8)
    s_branch L_wd_f
L_w0_f:
    s_waitcnt vmcnt(0)
L_wd_f:
    s_mov_b32 s43, 1
    s_branch L_wfin
L_notfirst:
    s_cmp_ge_u32 s42, 1696
    s_cbranch_scc1 L_w0_a0
    s_cmp_ge_u32 s42, 672
    s_cbranch_scc1 L_w8_a0
    s_waitcnt vmcnt(32)
    s_branch L_wd_a0
L_w8_a0:
    s_waitcnt vmcnt(24)
    s_branch L_wd_a0
L_w0_a0:
    s_waitcnt vmcnt(16)
L_wd_a0:
L_wfin:
    s_cmp_ge_u32 s40, 672
    s_cbranch_scc1 L_cw0
    s_cmp_ge_u32 s40, 336
    s_cselect_b32 s11, 1, 0
    s_mul_i32 s12, s11, 336
    s_sub_u32 s12, s40, s12
    s_and_b32 s13, s12, 7
    s_lshr_b32 s14, s12, 3
    s_lshl_b32 s14, s14, 2
    s_add_u32 s14, s14, s10
    ds_read_b128 v[128:131], v223 offset:0
    ds_read_b128 v[132:135], v223 offset:1024
    ds_read_b128 v[136:139], v223 offset:2048
    ds_read_b128 v[140:143], v223 offset:3072
    ds_read_b128 v[144:147], v223 offset:4096
    ds_read_b128 v[148:151], v223 offset:5120
    ds_read_b128 v[152:155], v223 offset:6144
    ds_read_b128 v[156:159], v223 offset:7168
    s_bfe_u32 s24, s14, 0x10003
    s_mul_i32 s24, s24, 3
    v_and_b32 v213, 3, v209
    v_xor_b32 v213, s24, v213
    v_lshl_add_u32 v212, v213, 4, v226
    s_mul_i32 s24, s11, 22020096
    s_mul_i32 s25, s13, 2752512
    s_add_u32 s24, s24, s25
    s_lshl_b32 s25, s14, 6
    s_add_u32 s24, s24, s25
    s_add_u32 s24, s24, 67108864
    v_perm_b32 v160, v4, v0, s30
    v_perm_b32 v161, v12, v8, s30
    v_perm_b32 v162, v20, v16, s30
    v_perm_b32 v163, v28, v24, s30
    v_perm_b32 v164, v4, v0, s31
    v_perm_b32 v165, v12, v8, s31
    v_perm_b32 v166, v20, v16, s31
    v_perm_b32 v167, v28, v24, s31
    v_perm_b32 v168, v36, v32, s30
    v_perm_b32 v169, v44, v40, s30
    v_perm_b32 v170, v52, v48, s30
    v_perm_b32 v171, v60, v56, s30
    v_perm_b32 v172, v36, v32, s31
    v_perm_b32 v173, v44, v40, s31
    v_perm_b32 v174, v52, v48, s31
    v_perm_b32 v175, v60, v56, s31
    s_waitcnt lgkmcnt(0)
    v_mfma_f32_16x16x32_bf16 v[176:179], v[128:131], v[160:163], 0
    v_mfma_f32_16x16x32_bf16 v[180:183], v[128:131], v[164:167], 0
    v_mfma_f32_16x16x32_bf16 v[184:187], v[136:139], v[160:163], 0
    v_mfma_f32_16x16x32_bf16 v[188:191], v[136:139], v[164:167], 0
    v_mfma_f32_16x16x32_bf16 v[192:195], v[144:147], v[160:163], 0
    v_mfma_f32_16x16x32_bf16 v[196:199], v[144:147], v[164:167], 0
    v_mfma_f32_16x16x32_bf16 v[200:203], v[152:155], v[160:163], 0
    v_mfma_f32_16x16x32_bf16 v[204:207], v[152:155], v[164:167], 0
    v_mfma_f32_16x16x32_bf16 v[176:179], v[132:135], v[168:171], v[176:179]
    v_mfma_f32_16x16x32_bf16 v[180:183], v[132:135], v[172:175], v[180:183]
    v_mfma_f32_16x16x32_bf16 v[184:187], v[140:143], v[168:171], v[184:187]
    v_mfma_f32_16x16x32_bf16 v[188:191], v[140:143], v[172:175], v[188:191]
    v_mfma_f32_16x16x32_bf16 v[192:195], v[148:151], v[168:171], v[192:195]
    v_mfma_f32_16x16x32_bf16 v[196:199], v[148:151], v[172:175], v[196:199]
    v_mfma_f32_16x16x32_bf16 v[200:203], v[156:159], v[168:171], v[200:203]
    v_mfma_f32_16x16x32_bf16 v[204:207], v[156:159], v[172:175], v[204:207]
    v_perm_b32 v160, v5, v1, s30
    v_perm_b32 v161, v13, v9, s30
    v_perm_b32 v162, v21, v17, s30
    v_perm_b32 v163, v29, v25, s30
    v_perm_b32 v164, v5, v1, s31
    v_perm_b32 v165, v13, v9, s31
    v_perm_b32 v166, v21, v17, s31
    v_perm_b32 v167, v29, v25, s31
    v_perm_b32 v168, v37, v33, s30
    v_perm_b32 v169, v45, v41, s30
    v_perm_b32 v170, v53, v49, s30
    v_perm_b32 v171, v61, v57, s30
    v_perm_b32 v172, v37, v33, s31
    v_perm_b32 v173, v45, v41, s31
    v_perm_b32 v174, v53, v49, s31
    v_perm_b32 v175, v61, v57, s31
    v_cvt_pk_bf16_f32 v0, v176, v180
    v_cvt_pk_bf16_f32 v4, v177, v181
    v_cvt_pk_bf16_f32 v8, v178, v182
    v_cvt_pk_bf16_f32 v12, v179, v183
    v_cvt_pk_bf16_f32 v16, v184, v188
    v_cvt_pk_bf16_f32 v20, v185, v189
    v_cvt_pk_bf16_f32 v24, v186, v190
    v_cvt_pk_bf16_f32 v28, v187, v191
    v_cvt_pk_bf16_f32 v32, v192, v196
    v_cvt_pk_bf16_f32 v36, v193, v197
    v_cvt_pk_bf16_f32 v40, v194, v198
    v_cvt_pk_bf16_f32 v44, v195, v199
    v_cvt_pk_bf16_f32 v48, v200, v204
    v_cvt_pk_bf16_f32 v52, v201, v205
    v_cvt_pk_bf16_f32 v56, v202, v206
    v_cvt_pk_bf16_f32 v60, v203, v207
    v_mfma_f32_16x16x32_bf16 v[176:179], v[128:131], v[160:163], 0
    v_mfma_f32_16x16x32_bf16 v[180:183], v[128:131], v[164:167], 0
    v_mfma_f32_16x16x32_bf16 v[184:187], v[136:139], v[160:163], 0
    v_mfma_f32_16x16x32_bf16 v[188:191], v[136:139], v[164:167], 0
    v_mfma_f32_16x16x32_bf16 v[192:195], v[144:147], v[160:163], 0
    v_mfma_f32_16x16x32_bf16 v[196:199], v[144:147], v[164:167], 0
    v_mfma_f32_16x16x32_bf16 v[200:203], v[152:155], v[160:163], 0
    v_mfma_f32_16x16x32_bf16 v[204:207], v[152:155], v[164:167], 0
    v_mfma_f32_16x16x32_bf16 v[176:179], v[132:135], v[168:171], v[176:179]
    v_mfma_f32_16x16x32_bf16 v[180:183], v[132:135], v[172:175], v[180:183]
    v_mfma_f32_16x16x32_bf16 v[184:187], v[140:143], v[168:171], v[184:187]
    v_mfma_f32_16x16x32_bf16 v[188:191], v[140:143], v[172:175], v[188:191]
    v_mfma_f32_16x16x32_bf16 v[192:195], v[148:151], v[168:171], v[192:195]
    v_mfma_f32_16x16x32_bf16 v[196:199], v[148:151], v[172:175], v[196:199]
    v_mfma_f32_16x16x32_bf16 v[200:203], v[156:159], v[168:171], v[200:203]
    v_mfma_f32_16x16x32_bf16 v[204:207], v[156:159], v[172:175], v[204:207]
    v_perm_b32 v160, v6, v2, s30
    v_perm_b32 v161, v14, v10, s30
    v_perm_b32 v162, v22, v18, s30
    v_perm_b32 v163, v30, v26, s30
    v_perm_b32 v164, v6, v2, s31
    v_perm_b32 v165, v14, v10, s31
    v_perm_b32 v166, v22, v18, s31
    v_perm_b32 v167, v30, v26, s31
    v_perm_b32 v168, v38, v34, s30
    v_perm_b32 v169, v46, v42, s30
    v_perm_b32 v170, v54, v50, s30
    v_perm_b32 v171, v62, v58, s30
    v_perm_b32 v172, v38, v34, s31
    v_perm_b32 v173, v46, v42, s31
    v_perm_b32 v174, v54, v50, s31
    v_perm_b32 v175, v62, v58, s31
    v_cvt_pk_bf16_f32 v1, v176, v180
    v_cvt_pk_bf16_f32 v5, v177, v181
    v_cvt_pk_bf16_f32 v9, v178, v182
    v_cvt_pk_bf16_f32 v13, v179, v183
    v_cvt_pk_bf16_f32 v17, v184, v188
    v_cvt_pk_bf16_f32 v21, v185, v189
    v_cvt_pk_bf16_f32 v25, v186, v190
    v_cvt_pk_bf16_f32 v29, v187, v191
    v_cvt_pk_bf16_f32 v33, v192, v196
    v_cvt_pk_bf16_f32 v37, v193, v197
    v_cvt_pk_bf16_f32 v41, v194, v198
    v_cvt_pk_bf16_f32 v45, v195, v199
    v_cvt_pk_bf16_f32 v49, v200, v204
    v_cvt_pk_bf16_f32 v53, v201, v205
    v_cvt_pk_bf16_f32 v57, v202, v206
    v_cvt_pk_bf16_f32 v61, v203, v207
    v_mfma_f32_16x16x32_bf16 v[176:179], v[128:131], v[160:163], 0
    v_mfma_f32_16x16x32_bf16 v[180:183], v[128:131], v[164:167], 0
    v_mfma_f32_16x16x32_bf16 v[184:187], v[136:139], v[160:163], 0
    v_mfma_f32_16x16x32_bf16 v[188:191], v[136:139], v[164:167], 0
    v_mfma_f32_16x16x32_bf16 v[192:195], v[144:147], v[160:163], 0
    v_mfma_f32_16x16x32_bf16 v[196:199], v[144:147], v[164:167], 0
    v_mfma_f32_16x16x32_bf16 v[200:203], v[152:155], v[160:163], 0
    v_mfma_f32_16x16x32_bf16 v[204:207], v[152:155], v[164:167], 0
    v_mfma_f32_16x16x32_bf16 v[176:179], v[132:135], v[168:171], v[176:179]
    v_mfma_f32_16x16x32_bf16 v[180:183], v[132:135], v[172:175], v[180:183]
    v_mfma_f32_16x16x32_bf16 v[184:187], v[140:143], v[168:171], v[184:187]
    v_mfma_f32_16x16x32_bf16 v[188:191], v[140:143], v[172:175], v[188:191]
    v_mfma_f32_16x16x32_bf16 v[192:195], v[148:151], v[168:171], v[192:195]
    v_mfma_f32_16x16x32_bf16 v[196:199], v[148:151], v[172:175], v[196:199]
    v_mfma_f32_16x16x32_bf16 v[200:203], v[156:159], v[168:171], v[200:203]
    v_mfma_f32_16x16x32_bf16 v[204:207], v[156:159], v[172:175], v[204:207]
    v_perm_b32 v160, v7, v3, s30
    v_perm_b32 v161, v15, v11, s30
    v_perm_b32 v162, v23, v19, s30
    v_perm_b32 v163, v31, v27, s30
    v_perm_b32 v164, v7, v3, s31
    v_perm_b32 v165, v15, v11, s31
    v_perm_b32 v166, v23, v19, s31
    v_perm_b32 v167, v31, v27, s31
    v_perm_b32 v168, v39, v35, s30
    v_perm_b32 v169, v47, v43, s30
    v_perm_b32 v170, v55, v51, s30
    v_perm_b32 v171, v63, v59, s30
    v_perm_b32 v172, v39, v35, s31
    v_perm_b32 v173, v47, v43, s31
    v_perm_b32 v174, v55, v51, s31
    v_perm_b32 v175, v63, v59, s31
    v_cvt_pk_bf16_f32 v2, v176, v180
    v_cvt_pk_bf16_f32 v6, v177, v181
    v_cvt_pk_bf16_f32 v10, v178, v182
    v_cvt_pk_bf16_f32 v14, v179, v183
    v_cvt_pk_bf16_f32 v18, v184, v188
    v_cvt_pk_bf16_f32 v22, v185, v189
    v_cvt_pk_bf16_f32 v26, v186, v190
    v_cvt_pk_bf16_f32 v30, v187, v191
    v_cvt_pk_bf16_f32 v34, v192, v196
    v_cvt_pk_bf16_f32 v38, v193, v197
    v_cvt_pk_bf16_f32 v42, v194, v198
    v_cvt_pk_bf16_f32 v46, v195, v199
    v_cvt_pk_bf16_f32 v50, v200, v204
    v_cvt_pk_bf16_f32 v54, v201, v205
    v_cvt_pk_bf16_f32 v58, v202, v206
    v_cvt_pk_bf16_f32 v62, v203, v207
    v_mfma_f32_16x16x32_bf16 v[176:179], v[128:131], v[160:163], 0
    v_mfma_f32_16x16x32_bf16 v[180:183], v[128:131], v[164:167], 0
    v_mfma_f32_16x16x32_bf16 v[184:187], v[136:139], v[160:163], 0
    v_mfma_f32_16x16x32_bf16 v[188:191], v[136:139], v[164:167], 0
    v_mfma_f32_16x16x32_bf16 v[192:195], v[144:147], v[160:163], 0
    v_mfma_f32_16x16x32_bf16 v[196:199], v[144:147], v[164:167], 0
    v_mfma_f32_16x16x32_bf16 v[200:203], v[152:155], v[160:163], 0
    v_mfma_f32_16x16x32_bf16 v[204:207], v[152:155], v[164:167], 0
    v_mfma_f32_16x16x32_bf16 v[176:179], v[132:135], v[168:171], v[176:179]
    v_mfma_f32_16x16x32_bf16 v[180:183], v[132:135], v[172:175], v[180:183]
    v_mfma_f32_16x16x32_bf16 v[184:187], v[140:143], v[168:171], v[184:187]
    v_mfma_f32_16x16x32_bf16 v[188:191], v[140:143], v[172:175], v[188:191]
    v_mfma_f32_16x16x32_bf16 v[192:195], v[148:151], v[168:171], v[192:195]
    v_mfma_f32_16x16x32_bf16 v[196:199], v[148:151], v[172:175], v[196:199]
    v_mfma_f32_16x16x32_bf16 v[200:203], v[156:159], v[168:171], v[200:203]
    v_mfma_f32_16x16x32_bf16 v[204:207], v[156:159], v[172:175], v[204:207]
    s_nop 1
    v_cvt_pk_bf16_f32 v3, v176, v180
    v_cvt_pk_bf16_f32 v7, v177, v181
    v_cvt_pk_bf16_f32 v11, v178, v182
    v_cvt_pk_bf16_f32 v15, v179, v183
    v_cvt_pk_bf16_f32 v19, v184, v188
    v_cvt_pk_bf16_f32 v23, v185, v189
    v_cvt_pk_bf16_f32 v27, v186, v190
    v_cvt_pk_bf16_f32 v31, v187, v191
    v_cvt_pk_bf16_f32 v35, v192, v196
    v_cvt_pk_bf16_f32 v39, v193, v197
    v_cvt_pk_bf16_f32 v43, v194, v198
    v_cvt_pk_bf16_f32 v47, v195, v199
    v_cvt_pk_bf16_f32 v51, v200, v204
    v_cvt_pk_bf16_f32 v55, v201, v205
    v_cvt_pk_bf16_f32 v59, v202, v206
    v_cvt_pk_bf16_f32 v63, v203, v207
    s_add_u32 s25, s24, 0
    buffer_store_dwordx4 v[0:3], v212, s[16:19], s25 offen sc1
    s_add_u32 s25, s24, 10752
    buffer_store_dwordx4 v[4:7], v212, s[16:19], s25 offen sc1
    s_add_u32 s25, s24, 21504
    buffer_store_dwordx4 v[8:11], v212, s[16:19], s25 offen sc1
    s_add_u32 s25, s24, 32256
    buffer_store_dwordx4 v[12:15], v212, s[16:19], s25 offen sc1
    s_add_u32 s25, s24, 172032
    buffer_store_dwordx4 v[16:19], v212, s[16:19], s25 offen sc1
    s_add_u32 s25, s24, 182784
    buffer_store_dwordx4 v[20:23], v212, s[16:19], s25 offen sc1
    s_add_u32 s25, s24, 193536
    buffer_store_dwordx4 v[24:27], v212, s[16:19], s25 offen sc1
    s_add_u32 s25, s24, 204288
    buffer_store_dwordx4 v[28:31], v212, s[16:19], s25 offen sc1
    s_add_u32 s25, s24, 344064
    buffer_store_dwordx4 v[32:35], v212, s[16:19], s25 offen sc1
    s_add_u32 s25, s24, 354816
    buffer_store_dwordx4 v[36:39], v212, s[16:19], s25 offen sc1
    s_add_u32 s25, s24, 365568
    buffer_store_dwordx4 v[40:43], v212, s[16:19], s25 offen sc1
    s_add_u32 s25, s24, 376320
    buffer_store_dwordx4 v[44:47], v212, s[16:19], s25 offen sc1
    s_add_u32 s25, s24, 516096
    buffer_store_dwordx4 v[48:51], v212, s[16:19], s25 offen sc1
    s_add_u32 s25, s24, 526848
    buffer_store_dwordx4 v[52:55], v212, s[16:19], s25 offen sc1
    s_add_u32 s25, s24, 537600
    buffer_store_dwordx4 v[56:59], v212, s[16:19], s25 offen sc1
    s_add_u32 s25, s24, 548352
    buffer_store_dwordx4 v[60:63], v212, s[16:19], s25 offen sc1
    s_branch L_next0
L_cw0:
    s_sub_u32 s12, s40, 672
    s_and_b32 s13, s12, 3
    s_lshr_b32 s14, s12, 2
    s_lshl_b32 s14, s14, 2
    s_add_u32 s14, s14, s10
    ds_read_b128 v[128:131], v223 offset:8192
    ds_read_b128 v[132:135], v223 offset:9216
    ds_read_b128 v[136:139], v223 offset:10240
    ds_read_b128 v[140:143], v223 offset:11264
    s_and_b32 s24, s14, 3
    s_bfe_u32 s25, s14, 0x10003
    s_lshl_b32 s25, s25, 2
    s_or_b32 s24, s24, s25
    s_lshl_b32 s24, s24, 1
    v_xor_b32 v213, s24, v209
    v_lshl_add_u32 v212, v213, 4, v227
    s_mul_i32 s24, s13, 16777216
    s_lshr_b32 s25, s14, 5
    s_mul_i32 s25, s25, 524288
    s_add_u32 s24, s24, s25
    s_and_b32 s25, s14, 31
    s_lshl_b32 s25, s25, 8
    s_add_u32 s24, s24, s25
    v_perm_b32 v16, v0, v0, s32
    v_perm_b32 v17, v4, v4, s32
    v_perm_b32 v18, v8, v8, s32
    v_perm_b32 v19, v12, v12, s32
    v_perm_b32 v20, v0, v0, s33
    v_perm_b32 v21, v4, v4, s33
    v_perm_b32 v22, v8, v8, s33
    v_perm_b32 v23, v12, v12, s33
    v_perm_b32 v24, v1, v1, s32
    v_perm_b32 v25, v5, v5, s32
    v_perm_b32 v26, v9, v9, s32
    v_perm_b32 v27, v13, v13, s32
    v_perm_b32 v28, v1, v1, s33
    v_perm_b32 v29, v5, v5, s33
    v_perm_b32 v30, v9, v9, s33
    v_perm_b32 v31, v13, v13, s33
    v_perm_b32 v32, v2, v2, s32
    v_perm_b32 v33, v6, v6, s32
    v_perm_b32 v34, v10, v10, s32
    v_perm_b32 v35, v14, v14, s32
    v_perm_b32 v36, v2, v2, s33
    v_perm_b32 v37, v6, v6, s33
    v_perm_b32 v38, v10, v10, s33
    v_perm_b32 v39, v14, v14, s33
    v_perm_b32 v40, v3, v3, s32
    v_perm_b32 v41, v7, v7, s32
    v_perm_b32 v42, v11, v11, s32
    v_perm_b32 v43, v15, v15, s32
    v_perm_b32 v44, v3, v3, s33
    v_perm_b32 v45, v7, v7, s33
    v_perm_b32 v46, v11, v11, s33
    v_perm_b32 v47, v15, v15, s33
    s_waitcnt lgkmcnt(0)
    v_mfma_f32_16x16x32_bf16 v[176:179], v[128:131], v[16:19], 0
    v_mfma_f32_16x16x32_bf16 v[180:183], v[128:131], v[20:23], 0
    v_mfma_f32_16x16x32_bf16 v[184:187], v[128:131], v[24:27], 0
    v_mfma_f32_16x16x32_bf16 v[188:191], v[128:131], v[28:31], 0
    v_mfma_f32_16x16x32_bf16 v[192:195], v[128:131], v[32:35], 0
    v_mfma_f32_16x16x32_bf16 v[196:199], v[128:131], v[36:39], 0
    v_mfma_f32_16x16x32_bf16 v[200:203], v[128:131], v[40:43], 0
    v_mfma_f32_16x16x32_bf16 v[204:207], v[128:131], v[44:47], 0
    s_nop 1
    v_cvt_pk_bf16_f32 v0, v176, v180
    s_nop 0
    v_cvt_pk_bf16_f32 v1, v184, v188
    s_nop 0
    v_cvt_pk_bf16_f32 v2, v192, v196
    s_nop 0
    v_cvt_pk_bf16_f32 v3, v200, v204
    v_cvt_pk_bf16_f32 v4, v177, v181
    v_cvt_pk_bf16_f32 v5, v185, v189
    v_cvt_pk_bf16_f32 v6, v193, v197
    v_cvt_pk_bf16_f32 v7, v201, v205
    v_cvt_pk_bf16_f32 v8, v178, v182
    v_cvt_pk_bf16_f32 v9, v186, v190
    v_cvt_pk_bf16_f32 v10, v194, v198
    v_cvt_pk_bf16_f32 v11, v202, v206
    v_cvt_pk_bf16_f32 v12, v179, v183
    v_cvt_pk_bf16_f32 v13, v187, v191
    v_cvt_pk_bf16_f32 v14, v195, v199
    v_cvt_pk_bf16_f32 v15, v203, v207
    s_add_u32 s25, s24, 0
    buffer_store_dwordx4 v[0:3], v212, s[16:19], s25 offen sc1
    s_add_u32 s25, s24, 8192
    buffer_store_dwordx4 v[4:7], v212, s[16:19], s25 offen sc1
    s_add_u32 s25, s24, 16384
    buffer_store_dwordx4 v[8:11], v212, s[16:19], s25 offen sc1
    s_add_u32 s25, s24, 24576
    buffer_store_dwordx4 v[12:15], v212, s[16:19], s25 offen sc1
    v_mfma_f32_16x16x32_bf16 v[176:179], v[132:135], v[16:19], 0
    v_mfma_f32_16x16x32_bf16 v[180:183], v[132:135], v[20:23], 0
    v_mfma_f32_16x16x32_bf16 v[184:187], v[132:135], v[24:27], 0
    v_mfma_f32_16x16x32_bf16 v[188:191], v[132:135], v[28:31], 0
    v_mfma_f32_16x16x32_bf16 v[192:195], v[132:135], v[32:35], 0
    v_mfma_f32_16x16x32_bf16 v[196:199], v[132:135], v[36:39], 0
    v_mfma_f32_16x16x32_bf16 v[200:203], v[132:135], v[40:43], 0
    v_mfma_f32_16x16x32_bf16 v[204:207], v[132:135], v[44:47], 0
    s_nop 1
    v_cvt_pk_bf16_f32 v48, v176, v180
    s_nop 0
    v_cvt_pk_bf16_f32 v49, v184, v188
    s_nop 0
    v_cvt_pk_bf16_f32 v50, v192, v196
    s_nop 0
    v_cvt_pk_bf16_f32 v51, v200, v204
    v_cvt_pk_bf16_f32 v52, v177, v181
    v_cvt_pk_bf16_f32 v53, v185, v189
    v_cvt_pk_bf16_f32 v54, v193, v197
    v_cvt_pk_bf16_f32 v55, v201, v205
    v_cvt_pk_bf16_f32 v56, v178, v182
    v_cvt_pk_bf16_f32 v57, v186, v190
    v_cvt_pk_bf16_f32 v58, v194, v198
    v_cvt_pk_bf16_f32 v59, v202, v206
    v_cvt_pk_bf16_f32 v60, v179, v183
    v_cvt_pk_bf16_f32 v61, v187, v191
    v_cvt_pk_bf16_f32 v62, v195, v199
    v_cvt_pk_bf16_f32 v63, v203, v207
    s_add_u32 s25, s24, 131072
    buffer_store_dwordx4 v[48:51], v212, s[16:19], s25 offen sc1
    s_add_u32 s25, s24, 139264
    buffer_store_dwordx4 v[52:55], v212, s[16:19], s25 offen sc1
    s_add_u32 s25, s24, 147456
    buffer_store_dwordx4 v[56:59], v212, s[16:19], s25 offen sc1
    s_add_u32 s25, s24, 155648
    buffer_store_dwordx4 v[60:63], v212, s[16:19], s25 offen sc1
    v_mfma_f32_16x16x32_bf16 v[176:179], v[136:139], v[16:19], 0
    v_mfma_f32_16x16x32_bf16 v[180:183], v[136:139], v[20:23], 0
    v_mfma_f32_16x16x32_bf16 v[184:187], v[136:139], v[24:27], 0
    v_mfma_f32_16x16x32_bf16 v[188:191], v[136:139], v[28:31], 0
    v_mfma_f32_16x16x32_bf16 v[192:195], v[136:139], v[32:35], 0
    v_mfma_f32_16x16x32_bf16 v[196:199], v[136:139], v[36:39], 0
    v_mfma_f32_16x16x32_bf16 v[200:203], v[136:139], v[40:43], 0
    v_mfma_f32_16x16x32_bf16 v[204:207], v[136:139], v[44:47], 0
    s_nop 1
    v_cvt_pk_bf16_f32 v0, v176, v180
    s_nop 0
    v_cvt_pk_bf16_f32 v1, v184, v188
    s_nop 0
    v_cvt_pk_bf16_f32 v2, v192, v196
    s_nop 0
    v_cvt_pk_bf16_f32 v3, v200, v204
    v_cvt_pk_bf16_f32 v4, v177, v181
    v_cvt_pk_bf16_f32 v5, v185, v189
    v_cvt_pk_bf16_f32 v6, v193, v197
    v_cvt_pk_bf16_f32 v7, v201, v205
    v_cvt_pk_bf16_f32 v8, v178, v182
    v_cvt_pk_bf16_f32 v9, v186, v190
    v_cvt_pk_bf16_f32 v10, v194, v198
    v_cvt_pk_bf16_f32 v11, v202, v206
    v_cvt_pk_bf16_f32 v12, v179, v183
    v_cvt_pk_bf16_f32 v13, v187, v191
    v_cvt_pk_bf16_f32 v14, v195, v199
    v_cvt_pk_bf16_f32 v15, v203, v207
    s_add_u32 s25, s24, 262144
    buffer_store_dwordx4 v[0:3], v212, s[16:19], s25 offen sc1
    s_add_u32 s25, s24, 270336
    buffer_store_dwordx4 v[4:7], v212, s[16:19], s25 offen sc1
    s_add_u32 s25, s24, 278528
    buffer_store_dwordx4 v[8:11], v212, s[16:19], s25 offen sc1
    s_add_u32 s25, s24, 286720
    buffer_store_dwordx4 v[12:15], v212, s[16:19], s25 offen sc1
    v_mfma_f32_16x16x32_bf16 v[176:179], v[140:143], v[16:19], 0
    v_mfma_f32_16x16x32_bf16 v[180:183], v[140:143], v[20:23], 0
    v_mfma_f32_16x16x32_bf16 v[184:187], v[140:143], v[24:27], 0
    v_mfma_f32_16x16x32_bf16 v[188:191], v[140:143], v[28:31], 0
    v_mfma_f32_16x16x32_bf16 v[192:195], v[140:143], v[32:35], 0
    v_mfma_f32_16x16x32_bf16 v[196:199], v[140:143], v[36:39], 0
    v_mfma_f32_16x16x32_bf16 v[200:203], v[140:143], v[40:43], 0
    v_mfma_f32_16x16x32_bf16 v[204:207], v[140:143], v[44:47], 0
    s_nop 1
    v_cvt_pk_bf16_f32 v48, v176, v180
    s_nop 0
    v_cvt_pk_bf16_f32 v49, v184, v188
    s_nop 0
    v_cvt_pk_bf16_f32 v50, v192, v196
    s_nop 0
    v_cvt_pk_bf16_f32 v51, v200, v204
    v_cvt_pk_bf16_f32 v52, v177, v181
    v_cvt_pk_bf16_f32 v53, v185, v189
    v_cvt_pk_bf16_f32 v54, v193, v197
    v_cvt_pk_bf16_f32 v55, v201, v205
    v_cvt_pk_bf16_f32 v56, v178, v182
    v_cvt_pk_bf16_f32 v57, v186, v190
    v_cvt_pk_bf16_f32 v58, v194, v198
    v_cvt_pk_bf16_f32 v59, v202, v206
    v_cvt_pk_bf16_f32 v60, v179, v183
    v_cvt_pk_bf16_f32 v61, v187, v191
    v_cvt_pk_bf16_f32 v62, v195, v199
    v_cvt_pk_bf16_f32 v63, v203, v207
    s_add_u32 s25, s24, 393216
    buffer_store_dwordx4 v[48:51], v212, s[16:19], s25 offen sc1
    s_add_u32 s25, s24, 401408
    buffer_store_dwordx4 v[52:55], v212, s[16:19], s25 offen sc1
    s_add_u32 s25, s24, 409600
    buffer_store_dwordx4 v[56:59], v212, s[16:19], s25 offen sc1
    s_add_u32 s25, s24, 417792
    buffer_store_dwordx4 v[60:63], v212, s[16:19], s25 offen sc1
L_next0:
    s_cmp_lg_u32 s10, 0
    s_cbranch_scc1 L_pub0
    s_cmp_ge_u32 s42, 1696
    s_cbranch_scc1 L_w0_p0
    s_cmp_ge_u32 s42, 672
    s_cbranch_scc1 L_w8_p0
    s_waitcnt vmcnt(32)
    s_branch L_wd_p0
L_w8_p0:
    s_waitcnt vmcnt(24)
    s_branch L_wd_p0
L_w0_p0:
    s_waitcnt vmcnt(16)
L_wd_p0:
    v_add_u32 v221, 512, v221
    v_mov_b32 v213, s41
    s_mov_b64 exec, 1
    ds_write_b32 v213, v221 offset:12288
    s_mov_b64 exec, -1
L_pub0:
    s_waitcnt lgkmcnt(0)
    s_barrier
    v_mov_b32 v213, s41
    ds_read_b32 v214, v213 offset:12288
    s_xor_b32 s41, s41, 4
    s_mov_b32 s40, s42
    s_waitcnt lgkmcnt(0)
    v_readfirstlane_b32 s42, v214
    s_cmp_ge_u32 s40, 1696
    s_cbranch_scc1 L_k12_fin
    s_cmp_lg_u32 s10, 0
    s_cbranch_scc1 L_nofetch1
    v_mov_b32 v221, 1
    s_mov_b64 exec, 1
    buffer_atomic_add v221, v222, s[44:47], 0 offen sc0 sc1
    s_mov_b64 exec, -1
L_nofetch1:
    s_cmp_ge_u32 s42, 1696
    s_cbranch_scc1 L_ld_done2
    s_cmp_ge_u32 s42, 672
    s_cbranch_scc1 L_ld_w2
    s_cmp_ge_u32 s42, 336
    s_cselect_b32 s11, 1, 0
    s_mul_i32 s12, s11, 336
    s_sub_u32 s12, s42, s12
    s_and_b32 s13, s12, 7
    s_lshr_b32 s14, s12, 3
    s_lshl_b32 s14, s14, 2
    s_add_u32 s14, s14, s10
    s_mul_i32 s15, s11, 16384000
    s_add_u32 s34, s4, s15
    s_addc_u32 s35, s5, 0
    s_mov_b32 s20, s34
    s_and_b32 s21, s35, 0xffff
    s_mov_b32 s22, 16384000
    s_mov_b32 s23, 0x00020000
    s_mul_i32 s15, s14, 98304
    s_lshl_b32 s24, s13, 8
    s_add_u32 s15, s15, s24
    s_add_u32 s25, s15, 0
    buffer_load_dwordx4 v[0:3], v224, s[20:23], s25 offen
    s_add_u32 s25, s15, 2048
    buffer_load_dwordx4 v[4:7], v224, s[20:23], s25 offen
    s_add_u32 s25, s15, 4096
    buffer_load_dwordx4 v[8:11], v224, s[20:23], s25 offen
    s_add_u32 s25, s15, 6144
    buffer_load_dwordx4 v[12:15], v224, s[20:23], s25 offen
    s_add_u32 s25, s15, 8192
    buffer_load_dwordx4 v[16:19], v224, s[20:23], s25 offen
    s_add_u32 s25, s15, 10240
    buffer_load_dwordx4 v[20:23], v224, s[20:23], s25 offen
    s_add_u32 s25, s15, 12288
    buffer_load_dwordx4 v[24:27], v224, s[20:23], s25 offen
    s_add_u32 s25, s15, 14336
    buffer_load_dwordx4 v[28:31], v224, s[20:23], s25 offen
    s_add_u32 s25, s15, 65536
    buffer_load_dwordx4 v[32:35], v224, s[20:23], s25 offen
    s_add_u32 s25, s15, 67584
    buffer_load_dwordx4 v[36:39], v224, s[20:23], s25 offen
    s_add_u32 s25, s15, 69632
    buffer_load_dwordx4 v[40:43], v224, s[20:23], s25 offen
    s_add_u32 s25, s15, 71680
    buffer_load_dwordx4 v[44:47], v224, s[20:23], s25 offen
    s_add_u32 s25, s15, 73728
    buffer_load_dwordx4 v[48:51], v224, s[20:23], s25 offen
    s_add_u32 s25, s15, 75776
    buffer_load_dwordx4 v[52:55], v224, s[20:23], s25 offen
    s_add_u32 s25, s15, 77824
    buffer_load_dwordx4 v[56:59], v224, s[20:23], s25 offen
    s_add_u32 s25, s15, 79872
    buffer_load_dwordx4 v[60:63], v224, s[20:23], s25 offen
    s_branch L_ld_done2
L_ld_w2:
    s_sub_u32 s12, s42, 672
    s_and_b32 s13, s12, 3
    s_lshr_b32 s14, s12, 2
    s_lshl_b32 s14, s14, 2
    s_add_u32 s14, s14, s10
    s_mov_b32 s20, s6
    s_and_b32 s21, s7, 0xffff
    s_mov_b32 s22, 16252928
    s_mov_b32 s23, 0x00020000
    s_lshl_b32 s15, s14, 10
    s_lshl_b32 s24, s13, 8
    s_add_u32 s15, s15, s24
    s_add_u32 s25, s15, 0
    buffer_load_dwordx2 v[0:1], v225, s[20:23], s25 offen
    buffer_load_dwordx2 v[2:3], v225, s[20:23], s25 offen offset:16
    s_add_u32 s25, s15, 1048576
    buffer_load_dwordx2 v[4:5], v225, s[20:23], s25 offen
    buffer_load_dwordx2 v[6:7], v225, s[20:23], s25 offen offset:16
    s_add_u32 s25, s15, 2097152
    buffer_load_dwordx2 v[8:9], v225, s[20:23], s25 offen
    buffer_load_dwordx2 v[10:11], v225, s[20:23], s25 offen offset:16
    s_add_u32 s25, s15, 3145728
    buffer_load_dwordx2 v[12:13], v225, s[20:23], s25 offen
    buffer_load_dwordx2 v[14:15], v225, s[20:23], s25 offen offset:16
L_ld_done2:
    s_cmp_ge_u32 s42, 1696
    s_cbranch_scc1 L_w0_a1
    s_cmp_ge_u32 s42, 672
    s_cbranch_scc1 L_w8_a1
    s_waitcnt vmcnt(32)
    s_branch L_wd_a1
L_w8_a1:
    s_waitcnt vmcnt(24)
    s_branch L_wd_a1
L_w0_a1:
    s_waitcnt vmcnt(16)
L_wd_a1:
    s_cmp_ge_u32 s40, 672
    s_cbranch_scc1 L_cw1
    s_cmp_ge_u32 s40, 336
    s_cselect_b32 s11, 1, 0
    s_mul_i32 s12, s11, 336
    s_sub_u32 s12, s40, s12
    s_and_b32 s13, s12, 7
    s_lshr_b32 s14, s12, 3
    s_lshl_b32 s14, s14, 2
    s_add_u32 s14, s14, s10
    ds_read_b128 v[128:131], v223 offset:0
    ds_read_b128 v[132:135], v223 offset:1024
    ds_read_b128 v[136:139], v223 offset:2048
    ds_read_b128 v[140:143], v223 offset:3072
    ds_read_b128 v[144:147], v223 offset:4096
    ds_read_b128 v[148:151], v223 offset:5120
    ds_read_b128 v[152:155], v223 offset:6144
    ds_read_b128 v[156:159], v223 offset:7168
    s_bfe_u32 s24, s14, 0x10003
    s_mul_i32 s24, s24, 3
    v_and_b32 v213, 3, v209
    v_xor_b32 v213, s24, v213
    v_lshl_add_u32 v212, v213, 4, v226
    s_mul_i32 s24, s11, 22020096
    s_mul_i32 s25, s13, 2752512
    s_add_u32 s24, s24, s25
    s_lshl_b32 s25, s14, 6
    s_add_u32 s24, s24, s25
    s_add_u32 s24, s24, 67108864
    v_perm_b32 v160, v68, v64, s30
    v_perm_b32 v161, v76, v72, s30
    v_perm_b32 v162, v84, v80, s30
    v_perm_b32 v163, v92, v88, s30
    v_perm_b32 v164, v68, v64, s31
    v_perm_b32 v165, v76, v72, s31
    v_perm_b32 v166, v84, v80, s31
    v_perm_b32 v167, v92, v88, s31
    v_perm_b32 v168, v100, v96, s30
    v_perm_b32 v169, v108, v104, s30
    v_perm_b32 v170, v116, v112, s30
    v_perm_b32 v171, v124, v120, s30
    v_perm_b32 v172, v100, v96, s31
    v_perm_b32 v173, v108, v104, s31
    v_perm_b32 v174, v116, v112, s31
    v_perm_b32 v175, v124, v120, s31
    s_waitcnt lgkmcnt(0)
    v_mfma_f32_16x16x32_bf16 v[176:179], v[128:131], v[160:163], 0
    v_mfma_f32_16x16x32_bf16 v[180:183], v[128:131], v[164:167], 0
    v_mfma_f32_16x16x32_bf16 v[184:187], v[136:139], v[160:163], 0
    v_mfma_f32_16x16x32_bf16 v[188:191], v[136:139], v[164:167], 0
    v_mfma_f32_16x16x32_bf16 v[192:195], v[144:147], v[160:163], 0
    v_mfma_f32_16x16x32_bf16 v[196:199], v[144:147], v[164:167], 0
    v_mfma_f32_16x16x32_bf16 v[200:203], v[152:155], v[160:163], 0
    v_mfma_f32_16x16x32_bf16 v[204:207], v[152:155], v[164:167], 0
    v_mfma_f32_16x16x32_bf16 v[176:179], v[132:135], v[168:171], v[176:179]
    v_mfma_f32_16x16x32_bf16 v[180:183], v[132:135], v[172:175], v[180:183]
    v_mfma_f32_16x16x32_bf16 v[184:187], v[140:143], v[168:171], v[184:187]
    v_mfma_f32_16x16x32_bf16 v[188:191], v[140:143], v[172:175], v[188:191]
    v_mfma_f32_16x16x32_bf16 v[192:195], v[148:151], v[168:171], v[192:195]
    v_mfma_f32_16x16x32_bf16 v[196:199], v[148:151], v[172:175], v[196:199]
    v_mfma_f32_16x16x32_bf16 v[200:203], v[156:159], v[168:171], v[200:203]
    v_mfma_f32_16x16x32_bf16 v[204:207], v[156:159], v[172:175], v[204:207]
    v_perm_b32 v160, v69, v65, s30
    v_perm_b32 v161, v77, v73, s30
    v_perm_b32 v162, v85, v81, s30
    v_perm_b32 v163, v93, v89, s30
    v_perm_b32 v164, v69, v65, s31
    v_perm_b32 v165, v77, v73, s31
    v_perm_b32 v166, v85, v81, s31
    v_perm_b32 v167, v93, v89, s31
    v_perm_b32 v168, v101, v97, s30
    v_perm_b32 v169, v109, v105, s30
    v_perm_b32 v170, v117, v113, s30
    v_perm_b32 v171, v125, v121, s30
    v_perm_b32 v172, v101, v97, s31
    v_perm_b32 v173, v109, v105, s31
    v_perm_b32 v174, v117, v113, s31
    v_perm_b32 v175, v125, v121, s31
    v_cvt_pk_bf16_f32 v64, v176, v180
    v_cvt_pk_bf16_f32 v68, v177, v181
    v_cvt_pk_bf16_f32 v72, v178, v182
    v_cvt_pk_bf16_f32 v76, v179, v183
    v_cvt_pk_bf16_f32 v80, v184, v188
    v_cvt_pk_bf16_f32 v84, v185, v189
    v_cvt_pk_bf16_f32 v88, v186, v190
    v_cvt_pk_bf16_f32 v92, v187, v191
    v_cvt_pk_bf16_f32 v96, v192, v196
    v_cvt_pk_bf16_f32 v100, v193, v197
    v_cvt_pk_bf16_f32 v104, v194, v198
    v_cvt_pk_bf16_f32 v108, v195, v199
    v_cvt_pk_bf16_f32 v112, v200, v204
    v_cvt_pk_bf16_f32 v116, v201, v205
    v_cvt_pk_bf16_f32 v120, v202, v206
    v_cvt_pk_bf16_f32 v124, v203, v207
    v_mfma_f32_16x16x32_bf16 v[176:179], v[128:131], v[160:163], 0
    v_mfma_f32_16x16x32_bf16 v[180:183], v[128:131], v[164:167], 0
    v_mfma_f32_16x16x32_bf16 v[184:187], v[136:139], v[160:163], 0
    v_mfma_f32_16x16x32_bf16 v[188:191], v[136:139], v[164:167], 0
    v_mfma_f32_16x16x32_bf16 v[192:195], v[144:147], v[160:163], 0
    v_mfma_f32_16x16x32_bf16 v[196:199], v[144:147], v[164:167], 0
    v_mfma_f32_16x16x32_bf16 v[200:203], v[152:155], v[160:163], 0
    v_mfma_f32_16x16x32_bf16 v[204:207], v[152:155], v[164:167], 0
    v_mfma_f32_16x16x32_bf16 v[176:179], v[132:135], v[168:171], v[176:179]
    v_mfma_f32_16x16x32_bf16 v[180:183], v[132:135], v[172:175], v[180:183]
    v_mfma_f32_16x16x32_bf16 v[184:187], v[140:143], v[168:171], v[184:187]
    v_mfma_f32_16x16x32_bf16 v[188:191], v[140:143], v[172:175], v[188:191]
    v_mfma_f32_16x16x32_bf16 v[192:195], v[148:151], v[168:171], v[192:195]
    v_mfma_f32_16x16x32_bf16 v[196:199], v[148:151], v[172:175], v[196:199]
    v_mfma_f32_16x16x32_bf16 v[200:203], v[156:159], v[168:171], v[200:203]
    v_mfma_f32_16x16x32_bf16 v[204:207], v[156:159], v[172:175], v[204:207]
    v_perm_b32 v160, v70, v66, s30
    v_perm_b32 v161, v78, v74, s30
    v_perm_b32 v162, v86, v82, s30
    v_perm_b32 v163, v94, v90, s30
    v_perm_b32 v164, v70, v66, s31
    v_perm_b32 v165, v78, v74, s31
    v_perm_b32 v166, v86, v82, s31
    v_perm_b32 v167, v94, v90, s31
    v_perm_b32 v168, v102, v98, s30
    v_perm_b32 v169, v110, v106, s30
    v_perm_b32 v170, v118, v114, s30
    v_perm_b32 v171, v126, v122, s30
    v_perm_b32 v172, v102, v98, s31
    v_perm_b32 v173, v110, v106, s31
    v_perm_b32 v174, v118, v114, s31
    v_perm_b32 v175, v126, v122, s31
    v_cvt_pk_bf16_f32 v65, v176, v180
    v_cvt_pk_bf16_f32 v69, v177, v181
    v_cvt_pk_bf16_f32 v73, v178, v182
    v_cvt_pk_bf16_f32 v77, v179, v183
    v_cvt_pk_bf16_f32 v81, v184, v188
    v_cvt_pk_bf16_f32 v85, v185, v189
    v_cvt_pk_bf16_f32 v89, v186, v190
    v_cvt_pk_bf16_f32 v93, v187, v191
    v_cvt_pk_bf16_f32 v97, v192, v196
    v_cvt_pk_bf16_f32 v101, v193, v197
    v_cvt_pk_bf16_f32 v105, v194, v198
    v_cvt_pk_bf16_f32 v109, v195, v199
    v_cvt_pk_bf16_f32 v113, v200, v204
    v_cvt_pk_bf16_f32 v117, v201, v205
    v_cvt_pk_bf16_f32 v121, v202, v206
    v_cvt_pk_bf16_f32 v125, v203, v207
    v_mfma_f32_16x16x32_bf16 v[176:179], v[128:131], v[160:163], 0
    v_mfma_f32_16x16x32_bf16 v[180:183], v[128:131], v[164:167], 0
    v_mfma_f32_16x16x32_bf16 v[184:187], v[136:139], v[160:163], 0
    v_mfma_f32_16x16x32_bf16 v[188:191], v[136:139], v[164:167], 0
    v_mfma_f32_16x16x32_bf16 v[192:195], v[144:147], v[160:163], 0
    v_mfma_f32_16x16x32_bf16 v[196:199], v[144:147], v[164:167], 0
    v_mfma_f32_16x16x32_bf16 v[200:203], v[152:155], v[160:163], 0
    v_mfma_f32_16x16x32_bf16 v[204:207], v[152:155], v[164:167], 0
    v_mfma_f32_16x16x32_bf16 v[176:179], v[132:135], v[168:171], v[176:179]
    v_mfma_f32_16x16x32_bf16 v[180:183], v[132:135], v[172:175], v[180:183]
    v_mfma_f32_16x16x32_bf16 v[184:187], v[140:143], v[168:171], v[184:187]
    v_mfma_f32_16x16x32_bf16 v[188:191], v[140:143], v[172:175], v[188:191]
    v_mfma_f32_16x16x32_bf16 v[192:195], v[148:151], v[168:171], v[192:195]
    v_mfma_f32_16x16x32_bf16 v[196:199], v[148:151], v[172:175], v[196:199]
    v_mfma_f32_16x16x32_bf16 v[200:203], v[156:159], v[168:171], v[200:203]
    v_mfma_f32_16x16x32_bf16 v[204:207], v[156:159], v[172:175], v[204:207]
    v_perm_b32 v160, v71, v67, s30
    v_perm_b32 v161, v79, v75, s30
    v_perm_b32 v162, v87, v83, s30
    v_perm_b32 v163, v95, v91, s30
    v_perm_b32 v164, v71, v67, s31
    v_perm_b32 v165, v79, v75, s31
    v_perm_b32 v166, v87, v83, s31
    v_perm_b32 v167, v95, v91, s31
    v_perm_b32 v168, v103, v99, s30
    v_perm_b32 v169, v111, v107, s30
    v_perm_b32 v170, v119, v115, s30
    v_perm_b32 v171, v127, v123, s30
    v_perm_b32 v172, v103, v99, s31
    v_perm_b32 v173, v111, v107, s31
    v_perm_b32 v174, v119, v115, s31
    v_perm_b32 v175, v127, v123, s31
    v_cvt_pk_bf16_f32 v66, v176, v180
    v_cvt_pk_bf16_f32 v70, v177, v181
    v_cvt_pk_bf16_f32 v74, v178, v182
    v_cvt_pk_bf16_f32 v78, v179, v183
    v_cvt_pk_bf16_f32 v82, v184, v188
    v_cvt_pk_bf16_f32 v86, v185, v189
    v_cvt_pk_bf16_f32 v90, v186, v190
    v_cvt_pk_bf16_f32 v94, v187, v191
    v_cvt_pk_bf16_f32 v98, v192, v196
    v_cvt_pk_bf16_f32 v102, v193, v197
    v_cvt_pk_bf16_f32 v106, v194, v198
    v_cvt_pk_bf16_f32 v110, v195, v199
    v_cvt_pk_bf16_f32 v114, v200, v204
    v_cvt_pk_bf16_f32 v118, v201, v205
    v_cvt_pk_bf16_f32 v122, v202, v206
    v_cvt_pk_bf16_f32 v126, v203, v207
    v_mfma_f32_16x16x32_bf16 v[176:179], v[128:131], v[160:163], 0
    v_mfma_f32_16x16x32_bf16 v[180:183], v[128:131], v[164:167], 0
    v_mfma_f32_16x16x32_bf16 v[184:187], v[136:139], v[160:163], 0
    v_mfma_f32_16x16x32_bf16 v[188:191], v[136:139], v[164:167], 0
    v_mfma_f32_16x16x32_bf16 v[192:195], v[144:147], v[160:163], 0
    v_mfma_f32_16x16x32_bf16 v[196:199], v[144:147], v[164:167], 0
    v_mfma_f32_16x16x32_bf16 v[200:203], v[152:155], v[160:163], 0
    v_mfma_f32_16x16x32_bf16 v[204:207], v[152:155], v[164:167], 0
    v_mfma_f32_16x16x32_bf16 v[176:179], v[132:135], v[168:171], v[176:179]
    v_mfma_f32_16x16x32_bf16 v[180:183], v[132:135], v[172:175], v[180:183]
    v_mfma_f32_16x16x32_bf16 v[184:187], v[140:143], v[168:171], v[184:187]
    v_mfma_f32_16x16x32_bf16 v[188:191], v[140:143], v[172:175], v[188:191]
    v_mfma_f32_16x16x32_bf16 v[192:195], v[148:151], v[168:171], v[192:195]
    v_mfma_f32_16x16x32_bf16 v[196:199], v[148:151], v[172:175], v[196:199]
    v_mfma_f32_16x16x32_bf16 v[200:203], v[156:159], v[168:171], v[200:203]
    v_mfma_f32_16x16x32_bf16 v[204:207], v[156:159], v[172:175], v[204:207]
    s_nop 1
    v_cvt_pk_bf16_f32 v67, v176, v180
    v_cvt_pk_bf16_f32 v71, v177, v181
    v_cvt_pk_bf16_f32 v75, v178, v182
    v_cvt_pk_bf16_f32 v79, v179, v183
    v_cvt_pk_bf16_f32 v83, v184, v188
    v_cvt_pk_bf16_f32 v87, v185, v189
    v_cvt_pk_bf16_f32 v91, v186, v190
    v_cvt_pk_bf16_f32 v95, v187, v191
    v_cvt_pk_bf16_f32 v99, v192, v196
    v_cvt_pk_bf16_f32 v103, v193, v197
    v_cvt_pk_bf16_f32 v107, v194, v198
    v_cvt_pk_bf16_f32 v111, v195, v199
    v_cvt_pk_bf16_f32 v115, v200, v204
    v_cvt_pk_bf16_f32 v119, v201, v205
    v_cvt_pk_bf16_f32 v123, v202, v206
    v_cvt_pk_bf16_f32 v127, v203, v207
    s_add_u32 s25, s24, 0
    buffer_store_dwordx4 v[64:67], v212, s[16:19], s25 offen sc1
    s_add_u32 s25, s24, 10752
    buffer_store_dwordx4 v[68:71], v212, s[16:19], s25 offen sc1
    s_add_u32 s25, s24, 21504
    buffer_store_dwordx4 v[72:75], v212, s[16:19], s25 offen sc1
    s_add_u32 s25, s24, 32256
    buffer_store_dwordx4 v[76:79], v212, s[16:19], s25 offen sc1
    s_add_u32 s25, s24, 172032
    buffer_store_dwordx4 v[80:83], v212, s[16:19], s25 offen sc1
    s_add_u32 s25, s24, 182784
    buffer_store_dwordx4 v[84:87], v212, s[16:19], s25 offen sc1
    s_add_u32 s25, s24, 193536
    buffer_store_dwordx4 v[88:91], v212, s[16:19], s25 offen sc1
    s_add_u32 s25, s24, 204288
    buffer_store_dwordx4 v[92:95], v212, s[16:19], s25 offen sc1
    s_add_u32 s25, s24, 344064
    buffer_store_dwordx4 v[96:99], v212, s[16:19], s25 offen sc1
    s_add_u32 s25, s24, 354816
    buffer_store_dwordx4 v[100:103], v212, s[16:19], s25 offen sc1
    s_add_u32 s25, s24, 365568
    buffer_store_dwordx4 v[104:107], v212, s[16:19], s25 offen sc1
    s_add_u32 s25, s24, 376320
    buffer_store_dwordx4 v[108:111], v212, s[16:19], s25 offen sc1
    s_add_u32 s25, s24, 516096
    buffer_store_dwordx4 v[112:115], v212, s[16:19], s25 offen sc1
    s_add_u32 s25, s24, 526848
    buffer_store_dwordx4 v[116:119], v212, s[16:19], s25 offen sc1
    s_add_u32 s25, s24, 537600
    buffer_store_dwordx4 v[120:123], v212, s[16:19], s25 offen sc1
    s_add_u32 s25, s24, 548352
    buffer_store_dwordx4 v[124:127], v212, s[16:19], s25 offen sc1
    s_branch L_next1
L_cw1:
    s_sub_u32 s12, s40, 672
    s_and_b32 s13, s12, 3
    s_lshr_b32 s14, s12, 2
    s_lshl_b32 s14, s14, 2
    s_add_u32 s14, s14, s10
    ds_read_b128 v[128:131], v223 offset:8192
    ds_read_b128 v[132:135], v223 offset:9216
    ds_read_b128 v[136:139], v223 offset:10240
    ds_read_b128 v[140:143], v223 offset:11264
    s_and_b32 s24, s14, 3
    s_bfe_u32 s25, s14, 0x10003
    s_lshl_b32 s25, s25, 2
    s_or_b32 s24, s24, s25
    s_lshl_b32 s24, s24, 1
    v_xor_b32 v213, s24, v209
    v_lshl_add_u32 v212, v213, 4, v227
    s_mul_i32 s24, s13, 16777216
    s_lshr_b32 s25, s14, 5
    s_mul_i32 s25, s25, 524288
    s_add_u32 s24, s24, s25
    s_and_b32 s25, s14, 31
    s_lshl_b32 s25, s25, 8
    s_add_u32 s24, s24, s25
    v_perm_b32 v80, v64, v64, s32
    v_perm_b32 v81, v68, v68, s32
    v_perm_b32 v82, v72, v72, s32
    v_perm_b32 v83, v76, v76, s32
    v_perm_b32 v84, v64, v64, s33
    v_perm_b32 v85, v68, v68, s33
    v_perm_b32 v86, v72, v72, s33
    v_perm_b32 v87, v76, v76, s33
    v_perm_b32 v88, v65, v65, s32
    v_perm_b32 v89, v69, v69, s32
    v_perm_b32 v90, v73, v73, s32
    v_perm_b32 v91, v77, v77, s32
    v_perm_b32 v92, v65, v65, s33
    v_perm_b32 v93, v69, v69, s33
    v_perm_b32 v94, v73, v73, s33
    v_perm_b32 v95, v77, v77, s33
    v_perm_b32 v96, v66, v66, s32
    v_perm_b32 v97, v70, v70, s32
    v_perm_b32 v98, v74, v74, s32
    v_perm_b32 v99, v78, v78, s32
    v_perm_b32 v100, v66, v66, s33
    v_perm_b32 v101, v70, v70, s33
    v_perm_b32 v102, v74, v74, s33
    v_perm_b32 v103, v78, v78, s33
    v_perm_b32 v104, v67, v67, s32
    v_perm_b32 v105, v71, v71, s32
    v_perm_b32 v106, v75, v75, s32
    v_perm_b32 v107, v79, v79, s32
    v_perm_b32 v108, v67, v67, s33
    v_perm_b32 v109, v71, v71, s33
    v_perm_b32 v110, v75, v75, s33
    v_perm_b32 v111, v79, v79, s33
    s_waitcnt lgkmcnt(0)
    v_mfma_f32_16x16x32_bf16 v[176:179], v[128:131], v[80:83], 0
    v_mfma_f32_16x16x32_bf16 v[180:183], v[128:131], v[84:87], 0
    v_mfma_f32_16x16x32_bf16 v[184:187], v[128:131], v[88:91], 0
    v_mfma_f32_16x16x32_bf16 v[188:191], v[128:131], v[92:95], 0
    v_mfma_f32_16x16x32_bf16 v[192:195], v[128:131], v[96:99], 0
    v_mfma_f32_16x16x32_bf16 v[196:199], v[128:131], v[100:103], 0
    v_mfma_f32_16x16x32_bf16 v[200:203], v[128:131], v[104:107], 0
    v_mfma_f32_16x16x32_bf16 v[204:207], v[128:131], v[108:111], 0
    s_nop 1
    v_cvt_pk_bf16_f32 v64, v176, v180
    s_nop 0
    v_cvt_pk_bf16_f32 v65, v184, v188
    s_nop 0
    v_cvt_pk_bf16_f32 v66, v192, v196
    s_nop 0
    v_cvt_pk_bf16_f32 v67, v200, v204
    v_cvt_pk_bf16_f32 v68, v177, v181
    v_cvt_pk_bf16_f32 v69, v185, v189
    v_cvt_pk_bf16_f32 v70, v193, v197
    v_cvt_pk_bf16_f32 v71, v201, v205
    v_cvt_pk_bf16_f32 v72, v178, v182
    v_cvt_pk_bf16_f32 v73, v186, v190
    v_cvt_pk_bf16_f32 v74, v194, v198
    v_cvt_pk_bf16_f32 v75, v202, v206
    v_cvt_pk_bf16_f32 v76, v179, v183
    v_cvt_pk_bf16_f32 v77, v187, v191
    v_cvt_pk_bf16_f32 v78, v195, v199
    v_cvt_pk_bf16_f32 v79, v203, v207
    s_add_u32 s25, s24, 0
    buffer_store_dwordx4 v[64:67], v212, s[16:19], s25 offen sc1
    s_add_u32 s25, s24, 8192
    buffer_store_dwordx4 v[68:71], v212, s[16:19], s25 offen sc1
    s_add_u32 s25, s24, 16384
    buffer_store_dwordx4 v[72:75], v212, s[16:19], s25 offen sc1
    s_add_u32 s25, s24, 24576
    buffer_store_dwordx4 v[76:79], v212, s[16:19], s25 offen sc1
    v_mfma_f32_16x16x32_bf16 v[176:179], v[132:135], v[80:83], 0
    v_mfma_f32_16x16x32_bf16 v[180:183], v[132:135], v[84:87], 0
    v_mfma_f32_16x16x32_bf16 v[184:187], v[132:135], v[88:91], 0
    v_mfma_f32_16x16x32_bf16 v[188:191], v[132:135], v[92:95], 0
    v_mfma_f32_16x16x32_bf16 v[192:195], v[132:135], v[96:99], 0
    v_mfma_f32_16x16x32_bf16 v[196:199], v[132:135], v[100:103], 0
    v_mfma_f32_16x16x32_bf16 v[200:203], v[132:135], v[104:107], 0
    v_mfma_f32_16x16x32_bf16 v[204:207], v[132:135], v[108:111], 0
    s_nop 1
    v_cvt_pk_bf16_f32 v112, v176, v180
    s_nop 0
    v_cvt_pk_bf16_f32 v113, v184, v188
    s_nop 0
    v_cvt_pk_bf16_f32 v114, v192, v196
    s_nop 0
    v_cvt_pk_bf16_f32 v115, v200, v204
    v_cvt_pk_bf16_f32 v116, v177, v181
    v_cvt_pk_bf16_f32 v117, v185, v189
    v_cvt_pk_bf16_f32 v118, v193, v197
    v_cvt_pk_bf16_f32 v119, v201, v205
    v_cvt_pk_bf16_f32 v120, v178, v182
    v_cvt_pk_bf16_f32 v121, v186, v190
    v_cvt_pk_bf16_f32 v122, v194, v198
    v_cvt_pk_bf16_f32 v123, v202, v206
    v_cvt_pk_bf16_f32 v124, v179, v183
    v_cvt_pk_bf16_f32 v125, v187, v191
    v_cvt_pk_bf16_f32 v126, v195, v199
    v_cvt_pk_bf16_f32 v127, v203, v207
    s_add_u32 s25, s24, 131072
    buffer_store_dwordx4 v[112:115], v212, s[16:19], s25 offen sc1
    s_add_u32 s25, s24, 139264
    buffer_store_dwordx4 v[116:119], v212, s[16:19], s25 offen sc1
    s_add_u32 s25, s24, 147456
    buffer_store_dwordx4 v[120:123], v212, s[16:19], s25 offen sc1
    s_add_u32 s25, s24, 155648
    buffer_store_dwordx4 v[124:127], v212, s[16:19], s25 offen sc1
    v_mfma_f32_16x16x32_bf16 v[176:179], v[136:139], v[80:83], 0
    v_mfma_f32_16x16x32_bf16 v[180:183], v[136:139], v[84:87], 0
    v_mfma_f32_16x16x32_bf16 v[184:187], v[136:139], v[88:91], 0
    v_mfma_f32_16x16x32_bf16 v[188:191], v[136:139], v[92:95], 0
    v_mfma_f32_16x16x32_bf16 v[192:195], v[136:139], v[96:99], 0
    v_mfma_f32_16x16x32_bf16 v[196:199], v[136:139], v[100:103], 0
    v_mfma_f32_16x16x32_bf16 v[200:203], v[136:139], v[104:107], 0
    v_mfma_f32_16x16x32_bf16 v[204:207], v[136:139], v[108:111], 0
    s_nop 1
    v_cvt_pk_bf16_f32 v64, v176, v180
    s_nop 0
    v_cvt_pk_bf16_f32 v65, v184, v188
    s_nop 0
    v_cvt_pk_bf16_f32 v66, v192, v196
    s_nop 0
    v_cvt_pk_bf16_f32 v67, v200, v204
    v_cvt_pk_bf16_f32 v68, v177, v181
    v_cvt_pk_bf16_f32 v69, v185, v189
    v_cvt_pk_bf16_f32 v70, v193, v197
    v_cvt_pk_bf16_f32 v71, v201, v205
    v_cvt_pk_bf16_f32 v72, v178, v182
    v_cvt_pk_bf16_f32 v73, v186, v190
    v_cvt_pk_bf16_f32 v74, v194, v198
    v_cvt_pk_bf16_f32 v75, v202, v206
    v_cvt_pk_bf16_f32 v76, v179, v183
    v_cvt_pk_bf16_f32 v77, v187, v191
    v_cvt_pk_bf16_f32 v78, v195, v199
    v_cvt_pk_bf16_f32 v79, v203, v207
    s_add_u32 s25, s24, 262144
    buffer_store_dwordx4 v[64:67], v212, s[16:19], s25 offen sc1
    s_add_u32 s25, s24, 270336
    buffer_store_dwordx4 v[68:71], v212, s[16:19], s25 offen sc1
    s_add_u32 s25, s24, 278528
    buffer_store_dwordx4 v[72:75], v212, s[16:19], s25 offen sc1
    s_add_u32 s25, s24, 286720
    buffer_store_dwordx4 v[76:79], v212, s[16:19], s25 offen sc1
    v_mfma_f32_16x16x32_bf16 v[176:179], v[140:143], v[80:83], 0
    v_mfma_f32_16x16x32_bf16 v[180:183], v[140:143], v[84:87], 0
    v_mfma_f32_16x16x32_bf16 v[184:187], v[140:143], v[88:91], 0
    v_mfma_f32_16x16x32_bf16 v[188:191], v[140:143], v[92:95], 0
    v_mfma_f32_16x16x32_bf16 v[192:195], v[140:143], v[96:99], 0
    v_mfma_f32_16x16x32_bf16 v[196:199], v[140:143], v[100:103], 0
    v_mfma_f32_16x16x32_bf16 v[200:203], v[140:143], v[104:107], 0
    v_mfma_f32_16x16x32_bf16 v[204:207], v[140:143], v[108:111], 0
    s_nop 1
    v_cvt_pk_bf16_f32 v112, v176, v180
    s_nop 0
    v_cvt_pk_bf16_f32 v113, v184, v188
    s_nop 0
    v_cvt_pk_bf16_f32 v114, v192, v196
    s_nop 0
    v_cvt_pk_bf16_f32 v115, v200, v204
    v_cvt_pk_bf16_f32 v116, v177, v181
    v_cvt_pk_bf16_f32 v117, v185, v189
    v_cvt_pk_bf16_f32 v118, v193, v197
    v_cvt_pk_bf16_f32 v119, v201, v205
    v_cvt_pk_bf16_f32 v120, v178, v182
    v_cvt_pk_bf16_f32 v121, v186, v190
    v_cvt_pk_bf16_f32 v122, v194, v198
    v_cvt_pk_bf16_f32 v123, v202, v206
    v_cvt_pk_bf16_f32 v124, v179, v183
    v_cvt_pk_bf16_f32 v125, v187, v191
    v_cvt_pk_bf16_f32 v126, v195, v199
    v_cvt_pk_bf16_f32 v127, v203, v207
    s_add_u32 s25, s24, 393216
    buffer_store_dwordx4 v[112:115], v212, s[16:19], s25 offen sc1
    s_add_u32 s25, s24, 401408
    buffer_store_dwordx4 v[116:119], v212, s[16:19], s25 offen sc1
    s_add_u32 s25, s24, 409600
    buffer_store_dwordx4 v[120:123], v212, s[16:19], s25 offen sc1
    s_add_u32 s25, s24, 417792
    buffer_store_dwordx4 v[124:127], v212, s[16:19], s25 offen sc1
L_next1:
    s_cmp_lg_u32 s10, 0
    s_cbranch_scc1 L_pub1
    s_cmp_ge_u32 s42, 1696
    s_cbranch_scc1 L_w0_p1
    s_cmp_ge_u32 s42, 672
    s_cbranch_scc1 L_w8_p1
    s_waitcnt vmcnt(32)
    s_branch L_wd_p1
L_w8_p1:
    s_waitcnt vmcnt(24)
    s_branch L_wd_p1
L_w0_p1:
    s_waitcnt vmcnt(16)
L_wd_p1:
    v_add_u32 v221, 512, v221
    v_mov_b32 v213, s41
    s_mov_b64 exec, 1
    ds_write_b32 v213, v221 offset:12288
    s_mov_b64 exec, -1
L_pub1:
    s_waitcnt lgkmcnt(0)
    s_barrier
    v_mov_b32 v213, s41
    ds_read_b32 v214, v213 offset:12288
    s_xor_b32 s41, s41, 4
    s_mov_b32 s40, s42
    s_waitcnt lgkmcnt(0)
    v_readfirstlane_b32 s42, v214
    s_cmp_ge_u32 s40, 1696
    s_cbranch_scc1 L_k12_fin
    s_branch L_k12_loop
L_k12_fin:
L_k12_end:
    s_endpgm
.globl gemm_kernel
.p2align 8
.type gemm_kernel,@function
gemm_kernel:
    s_cmp_ge_u32 s2, 256
    s_cbranch_scc1 L_k3_end
    s_load_dwordx2 s[8:9], s[0:1], 48
    v_lshrrev_b32 v253, 6, v0
    v_and_b32 v0, 63, v0
    v_readfirstlane_b32 s10, v253
    s_cmp_ge_u32 s2, 8
    s_cbranch_scc1 L_nopf3
    s_nop 1
    s_cmp_lg_u32 s10, 7
    s_cbranch_scc1 L_nopf3
    s_getpc_b64 s[60:61]
L_pf_k3:
    s_sub_u32 s60, s60, L_pf_k3-gemm_kernel
    s_subb_u32 s61, s61, 0
    v_mbcnt_lo_u32_b32 v12, -1, 0
    v_mbcnt_hi_u32_b32 v12, -1, v12
    v_lshlrev_b32 v12, 6, v12
    v_add_u32 v13, 0, v12
    v_min_u32 v13, final_kernel-gemm_kernel-4, v13
    v_mov_b32 v15, s61
    v_add_co_u32 v14, vcc, s60, v13
    s_nop 1
    v_addc_co_u32 v15, vcc, 0, v15, vcc
    global_load_dword v16, v[14:15], off
    v_add_u32 v13, 4096, v12
    v_min_u32 v13, final_kernel-gemm_kernel-4, v13
    v_mov_b32 v15, s61
    v_add_co_u32 v14, vcc, s60, v13
    s_nop 1
    v_addc_co_u32 v15, vcc, 0, v15, vcc
    global_load_dword v16, v[14:15], off
    v_add_u32 v13, 8192, v12
    v_min_u32 v13, final_kernel-gemm_kernel-4, v13
    v_mov_b32 v15, s61
    v_add_co_u32 v14, vcc, s60, v13
    s_nop 1
    v_addc_co_u32 v15, vcc, 0, v15, vcc
    global_load_dword v16, v[14:15], off
    v_add_u32 v13, 12288, v12
    v_min_u32 v13, final_kernel-gemm_kernel-4, v13
    v_mov_b32 v15, s61
    v_add_co_u32 v14, vcc, s60, v13
    s_nop 1
    v_addc_co_u32 v15, vcc, 0, v15, vcc
    global_load_dword v16, v[14:15], off
L_nopf3:
    s_and_b32 s11, s2, 7
    s_lshr_b32 s12, s2, 3
    s_lshr_b32 s13, s12, 3
    s_lshl_b32 s11, s11, 2
    s_add_u32 s11, s11, s13
    s_bfe_u32 s13, s12, 0x10002
    s_and_b32 s14, s12, 3
    s_and_b32 s15, s10, 3
    s_waitcnt lgkmcnt(0)
    s_mov_b32 s16, s8
    s_and_b32 s17, s9, 0xffff
    s_mov_b32 s18, 268435456
    s_mov_b32 s19, 0x00020000
    s_cmp_ge_u32 s10, 4
    s_cbranch_scc1 L_k3_helper
    v_lshrrev_b32 v253, 4, v0
    v_and_b32 v254, 15, v0
    v_bfe_u32 v255, v254, 3, 1
    v_mul_u32_u24 v255, 3, v255
    v_xor_b32 v255, v255, v253
    v_lshlrev_b32 v255, 4, v255
    v_lshl_add_u32 v250, v254, 6, v255
    v_lshrrev_b32 v255, 2, v254
    v_and_b32 v216, 1, v253
    v_lshl_or_b32 v216, v216, 2, v255
    v_lshl_add_u32 v255, v253, 3, v255
    v_lshlrev_b32 v255, 8, v255
    v_and_b32 v217, 3, v254
    v_lshl_add_u32 v255, v217, 3, v255
    s_lshl_b32 s20, s15, 1
    s_add_u32 s20, s20, s13
    v_xor_b32 v217, s20, v216
    v_lshl_add_u32 v248, v217, 5, v255
    s_xor_b32 s20, s20, 1
    v_xor_b32 v217, s20, v216
    v_lshl_add_u32 v249, v217, 5, v255
    v_lshlrev_b32 v251, 6, v254
    v_lshl_add_u32 v251, v253, 4, v251
    v_and_b32 v255, 7, v254
    v_lshlrev_b32 v252, 6, v255
    v_lshrrev_b32 v216, 3, v254
    v_xor_b32 v216, s13, v216
    s_mov_b32 s22, 11534336
    v_mul_lo_u32 v216, v216, s22
    v_add_u32 v252, v252, v216
    v_lshl_add_u32 v252, v253, 4, v252
    s_lshl_b32 s22, s13, 3
    v_add_u32 v252, s22, v252
    v_cmp_gt_u32 vcc, 7, v255
    v_mov_b32 v216, 0x80000000
    s_nop 0
    v_cndmask_b32 v252, v216, v252, vcc
    s_lshl_b32 s20, s14, 2
    s_add_u32 s20, s20, s15
    s_mul_i32 s48, s20, 720896
    s_mul_i32 s20, s11, 22528
    s_add_u32 s48, s48, s20
    s_add_u32 s48, s48, 117440512
    s_add_u32 s49, s48, 10240
    s_mul_i32 s20, s13, 11534336
    s_add_u32 s48, s48, s20
    v_mov_b32 v0, 0
    v_mov_b32 v1, 0
    v_mov_b32 v2, 0
    v_mov_b32 v3, 0
    v_mov_b32 v4, 0
    v_mov_b32 v5, 0
    v_mov_b32 v6, 0
    v_mov_b32 v7, 0
    v_mov_b32 v8, 0
    v_mov_b32 v9, 0
    v_mov_b32 v10, 0
    v_mov_b32 v11, 0
    v_mov_b32 v12, 0
    v_mov_b32 v13, 0
    v_mov_b32 v14, 0
    v_mov_b32 v15, 0
    v_mov_b32 v16, 0
    v_mov_b32 v17, 0
    v_mov_b32 v18, 0
    v_mov_b32 v19, 0
    v_mov_b32 v20, 0
    v_mov_b32 v21, 0
    v_mov_b32 v22, 0
    v_mov_b32 v23, 0
    v_mov_b32 v24, 0
    v_mov_b32 v25, 0
    v_mov_b32 v26, 0
    v_mov_b32 v27, 0
    v_mov_b32 v28, 0
    v_mov_b32 v29, 0
    v_mov_b32 v30, 0
    v_mov_b32 v31, 0
    v_mov_b32 v32, 0
    v_mov_b32 v33, 0
    v_mov_b32 v34, 0
    v_mov_b32 v35, 0
    v_mov_b32 v36, 0
    v_mov_b32 v37, 0
    v_mov_b32 v38, 0
    v_mov_b32 v39, 0
    v_mov_b32 v40, 0
    v_mov_b32 v41, 0
    v_mov_b32 v42, 0
    v_mov_b32 v43, 0
    v_mov_b32 v44, 0
    v_mov_b32 v45, 0
    v_mov_b32 v46, 0
    v_mov_b32 v47, 0
    v_mov_b32 v48, 0
    v_mov_b32 v49, 0
    v_mov_b32 v50, 0
    v_mov_b32 v51, 0
    v_mov_b32 v52, 0
    v_mov_b32 v53, 0
    v_mov_b32 v54, 0
    v_mov_b32 v55, 0
    v_mov_b32 v56, 0
    v_mov_b32 v57, 0
    v_mov_b32 v58, 0
    v_mov_b32 v59, 0
    v_mov_b32 v60, 0
    v_mov_b32 v61, 0
    v_mov_b32 v62, 0
    v_mov_b32 v63, 0
    v_mov_b32 v64, 0
    v_mov_b32 v65, 0
    v_mov_b32 v66, 0
    v_mov_b32 v67, 0
    v_mov_b32 v68, 0
    v_mov_b32 v69, 0
    v_mov_b32 v70, 0
    v_mov_b32 v71, 0
    v_mov_b32 v72, 0
    v_mov_b32 v73, 0
    v_mov_b32 v74, 0
    v_mov_b32 v75, 0
    v_mov_b32 v76, 0
    v_mov_b32 v77, 0
    v_mov_b32 v78, 0
    v_mov_b32 v79, 0
    v_mov_b32 v80, 0
    v_mov_b32 v81, 0
    v_mov_b32 v82, 0
    v_mov_b32 v83, 0
    v_mov_b32 v84, 0
    v_mov_b32 v85, 0
    v_mov_b32 v86, 0
    v_mov_b32 v87, 0
    v_mov_b32 v88, 0
    v_mov_b32 v89, 0
    v_mov_b32 v90, 0
    v_mov_b32 v91, 0
    v_mov_b32 v92, 0
    v_mov_b32 v93, 0
    v_mov_b32 v94, 0
    v_mov_b32 v95, 0
    v_mov_b32 v96, 0
    v_mov_b32 v97, 0
    v_mov_b32 v98, 0
    v_mov_b32 v99, 0
    v_mov_b32 v100, 0
    v_mov_b32 v101, 0
    v_mov_b32 v102, 0
    v_mov_b32 v103, 0
    v_mov_b32 v104, 0
    v_mov_b32 v105, 0
    v_mov_b32 v106, 0
    v_mov_b32 v107, 0
    v_mov_b32 v108, 0
    v_mov_b32 v109, 0
    v_mov_b32 v110, 0
    v_mov_b32 v111, 0
    v_mov_b32 v112, 0
    v_mov_b32 v113, 0
    v_mov_b32 v114, 0
    v_mov_b32 v115, 0
    v_mov_b32 v116, 0
    v_mov_b32 v117, 0
    v_mov_b32 v118, 0
    v_mov_b32 v119, 0
    v_mov_b32 v120, 0
    v_mov_b32 v121, 0
    v_mov_b32 v122, 0
    v_mov_b32 v123, 0
    v_mov_b32 v124, 0
    v_mov_b32 v125, 0
    v_mov_b32 v126, 0
    v_mov_b32 v127, 0
    v_mov_b32 v128, 0
    v_mov_b32 v129, 0
    v_mov_b32 v130, 0
    v_mov_b32 v131, 0
    v_mov_b32 v132, 0
    v_mov_b32 v133, 0
    v_mov_b32 v134, 0
    v_mov_b32 v135, 0
    v_mov_b32 v136, 0
    v_mov_b32 v137, 0
    v_mov_b32 v138, 0
    v_mov_b32 v139, 0
    v_mov_b32 v140, 0
    v_mov_b32 v141, 0
    v_mov_b32 v142, 0
    v_mov_b32 v143, 0
    v_mov_b32 v144, 0
    v_mov_b32 v145, 0
    v_mov_b32 v146, 0
    v_mov_b32 v147, 0
    v_mov_b32 v148, 0
    v_mov_b32 v149, 0
    v_mov_b32 v150, 0
    v_mov_b32 v151, 0
    v_mov_b32 v152, 0
    v_mov_b32 v153, 0
    v_mov_b32 v154, 0
    v_mov_b32 v155, 0
    v_mov_b32 v156, 0
    v_mov_b32 v157, 0
    v_mov_b32 v158, 0
    v_mov_b32 v159, 0
    v_mov_b32 v160, 0
    v_mov_b32 v161, 0
    v_mov_b32 v162, 0
    v_mov_b32 v163, 0
    v_mov_b32 v164, 0
    v_mov_b32 v165, 0
    v_mov_b32 v166, 0
    v_mov_b32 v167, 0
    s_barrier
    ds_read_b64_tr_b16 v[176:177], v248 offset:0
    ds_read_b64_tr_b16 v[178:179], v248 offset:1024
    ds_read_b64_tr_b16 v[180:181], v249 offset:0
    ds_read_b64_tr_b16 v[182:183], v249 offset:1024
    ds_read_b64_tr_b16 v[184:185], v248 offset:8192
    ds_read_b64_tr_b16 v[186:187], v248 offset:9216
    ds_read_b64_tr_b16 v[188:189], v249 offset:8192
    ds_read_b64_tr_b16 v[190:191], v249 offset:9216
    ds_read_b128 v[216:219], v250 offset:16384
    ds_read_b128 v[220:223], v250 offset:27648
    ds_read_b128 v[224:227], v250 offset:17408
    ds_read_b128 v[228:231], v250 offset:28672
    s_waitcnt lgkmcnt(4)
    v_xor_b32 v208, 0x80008000, v184
    v_xor_b32 v209, 0x80008000, v185
    v_xor_b32 v210, 0x80008000, v186
    v_xor_b32 v211, 0x80008000, v187
    v_xor_b32 v212, 0x80008000, v188
    v_xor_b32 v213, 0x80008000, v189
    v_xor_b32 v214, 0x80008000, v190
    v_xor_b32 v215, 0x80008000, v191
    s_mov_b32 s46, 7
L_g_loop:
    s_barrier
    s_waitcnt lgkmcnt(2)
    v_mfma_f32_16x16x32_bf16 v[0:3], v[176:179], v[216:219], v[0:3]
    ds_read_b128 v[232:235], v250 offset:18432
    ds_read_b128 v[236:239], v250 offset:29696
    v_mfma_f32_16x16x32_bf16 v[4:7], v[180:183], v[216:219], v[4:7]
    v_mfma_f32_16x16x32_bf16 v[8:11], v[208:211], v[216:219], v[8:11]
    v_mfma_f32_16x16x32_bf16 v[12:15], v[212:215], v[216:219], v[12:15]
    v_mfma_f32_16x16x32_bf16 v[0:3], v[184:187], v[220:223], v[0:3]
    v_mfma_f32_16x16x32_bf16 v[4:7], v[188:191], v[220:223], v[4:7]
    v_mfma_f32_16x16x32_bf16 v[8:11], v[176:179], v[220:223], v[8:11]
    v_mfma_f32_16x16x32_bf16 v[12:15], v[180:183], v[220:223], v[12:15]
    s_waitcnt lgkmcnt(2)
    v_mfma_f32_16x16x32_bf16 v[16:19], v[176:179], v[224:227], v[16:19]
    ds_read_b128 v[240:243], v250 offset:19456
    ds_read_b128 v[244:247], v250 offset:30720
    v_mfma_f32_16x16x32_bf16 v[20:23], v[180:183], v[224:227], v[20:23]
    v_mfma_f32_16x16x32_bf16 v[24:27], v[208:211], v[224:227], v[24:27]
    v_mfma_f32_16x16x32_bf16 v[28:31], v[212:215], v[224:227], v[28:31]
    v_mfma_f32_16x16x32_bf16 v[16:19], v[184:187], v[228:231], v[16:19]
    v_mfma_f32_16x16x32_bf16 v[20:23], v[188:191], v[228:231], v[20:23]
    v_mfma_f32_16x16x32_bf16 v[24:27], v[176:179], v[228:231], v[24:27]
    v_mfma_f32_16x16x32_bf16 v[28:31], v[180:183], v[228:231], v[28:31]
    s_waitcnt lgkmcnt(2)
    v_mfma_f32_16x16x32_bf16 v[32:35], v[176:179], v[232:235], v[32:35]
    ds_read_b128 v[216:219], v250 offset:20480
    ds_read_b128 v[220:223], v250 offset:31744
    v_mfma_f32_16x16x32_bf16 v[36:39], v[180:183], v[232:235], v[36:39]
    v_mfma_f32_16x16x32_bf16 v[40:43], v[208:211], v[232:235], v[40:43]
    v_mfma_f32_16x16x32_bf16 v[44:47], v[212:215], v[232:235], v[44:47]
    v_mfma_f32_16x16x32_bf16 v[32:35], v[184:187], v[236:239], v[32:35]
    v_mfma_f32_16x16x32_bf16 v[36:39], v[188:191], v[236:239], v[36:39]
    v_mfma_f32_16x16x32_bf16 v[40:43], v[176:179], v[236:239], v[40:43]
    v_mfma_f32_16x16x32_bf16 v[44:47], v[180:183], v[236:239], v[44:47]
    s_waitcnt lgkmcnt(2)
    v_mfma_f32_16x16x32_bf16 v[48:51], v[176:179], v[240:243], v[48:51]
    ds_read_b128 v[224:227], v250 offset:21504
    ds_read_b128 v[228:231], v250 offset:32768
    v_mfma_f32_16x16x32_bf16 v[52:55], v[180:183], v[240:243], v[52:55]
    v_mfma_f32_16x16x32_bf16 v[56:59], v[208:211], v[240:243], v[56:59]
    v_mfma_f32_16x16x32_bf16 v[60:63], v[212:215], v[240:243], v[60:63]
    v_mfma_f32_16x16x32_bf16 v[48:51], v[184:187], v[244:247], v[48:51]
    v_mfma_f32_16x16x32_bf16 v[52:55], v[188:191], v[244:247], v[52:55]
    v_mfma_f32_16x16x32_bf16 v[56:59], v[176:179], v[244:247], v[56:59]
    v_mfma_f32_16x16x32_bf16 v[60:63], v[180:183], v[244:247], v[60:63]
    s_waitcnt lgkmcnt(2)
    v_mfma_f32_16x16x32_bf16 v[64:67], v[176:179], v[216:219], v[64:67]
    ds_read_b128 v[232:235], v250 offset:22528
    ds_read_b128 v[236:239], v250 offset:33792
    v_mfma_f32_16x16x32_bf16 v[68:71], v[180:183], v[216:219], v[68:71]
    v_mfma_f32_16x16x32_bf16 v[72:75], v[208:211], v[216:219], v[72:75]
    v_mfma_f32_16x16x32_bf16 v[76:79], v[212:215], v[216:219], v[76:79]
    v_mfma_f32_16x16x32_bf16 v[64:67], v[184:187], v[220:223], v[64:67]
    v_mfma_f32_16x16x32_bf16 v[68:71], v[188:191], v[220:223], v[68:71]
    v_mfma_f32_16x16x32_bf16 v[72:75], v[176:179], v[220:223], v[72:75]
    v_mfma_f32_16x16x32_bf16 v[76:79], v[180:183], v[220:223], v[76:79]
    s_waitcnt lgkmcnt(2)
    v_mfma_f32_16x16x32_bf16 v[80:83], v[176:179], v[224:227], v[80:83]
    ds_read_b128 v[240:243], v250 offset:23552
    ds_read_b128 v[244:247], v250 offset:34816
    v_mfma_f32_16x16x32_bf16 v[84:87], v[180:183], v[224:227], v[84:87]
    v_mfma_f32_16x16x32_bf16 v[88:91], v[208:211], v[224:227], v[88:91]
    v_mfma_f32_16x16x32_bf16 v[92:95], v[212:215], v[224:227], v[92:95]
    v_mfma_f32_16x16x32_bf16 v[80:83], v[184:187], v[228:231], v[80:83]
    v_add_u32 v248, 0x9800, v248
    v_add_u32 v249, 0x9800, v249
    v_mfma_f32_16x16x32_bf16 v[84:87], v[188:191], v[228:231], v[84:87]
    v_mfma_f32_16x16x32_bf16 v[88:91], v[176:179], v[228:231], v[88:91]
    v_mfma_f32_16x16x32_bf16 v[92:95], v[180:183], v[228:231], v[92:95]
    s_waitcnt lgkmcnt(2)
    v_mfma_f32_16x16x32_bf16 v[96:99], v[176:179], v[232:235], v[96:99]
    ds_read_b128 v[216:219], v250 offset:24576
    ds_read_b128 v[220:223], v250 offset:35840
    v_mfma_f32_16x16x32_bf16 v[100:103], v[180:183], v[232:235], v[100:103]
    v_mfma_f32_16x16x32_bf16 v[104:107], v[208:211], v[232:235], v[104:107]
    v_mfma_f32_16x16x32_bf16 v[108:111], v[212:215], v[232:235], v[108:111]
    ds_read_b64_tr_b16 v[192:193], v248 offset:0
    ds_read_b64_tr_b16 v[194:195], v248 offset:1024
    ds_read_b64_tr_b16 v[196:197], v249 offset:0
    ds_read_b64_tr_b16 v[198:199], v249 offset:1024
    v_mfma_f32_16x16x32_bf16 v[96:99], v[184:187], v[236:239], v[96:99]
    v_mfma_f32_16x16x32_bf16 v[100:103], v[188:191], v[236:239], v[100:103]
    v_mfma_f32_16x16x32_bf16 v[104:107], v[176:179], v[236:239], v[104:107]
    v_mfma_f32_16x16x32_bf16 v[108:111], v[180:183], v[236:239], v[108:111]
    s_waitcnt lgkmcnt(6)
    v_mfma_f32_16x16x32_bf16 v[112:115], v[176:179], v[240:243], v[112:115]
    ds_read_b128 v[224:227], v250 offset:25600
    ds_read_b128 v[228:231], v250 offset:36864
    v_mfma_f32_16x16x32_bf16 v[116:119], v[180:183], v[240:243], v[116:119]
    v_mfma_f32_16x16x32_bf16 v[120:123], v[208:211], v[240:243], v[120:123]
    v_mfma_f32_16x16x32_bf16 v[124:127], v[212:215], v[240:243], v[124:127]
    ds_read_b64_tr_b16 v[200:201], v248 offset:8192
    ds_read_b64_tr_b16 v[202:203], v248 offset:9216
    ds_read_b64_tr_b16 v[204:205], v249 offset:8192
    ds_read_b64_tr_b16 v[206:207], v249 offset:9216
    v_mfma_f32_16x16x32_bf16 v[112:115], v[184:187], v[244:247], v[112:115]
    v_mfma_f32_16x16x32_bf16 v[116:119], v[188:191], v[244:247], v[116:119]
    v_mfma_f32_16x16x32_bf16 v[120:123], v[176:179], v[244:247], v[120:123]
    v_mfma_f32_16x16x32_bf16 v[124:127], v[180:183], v[244:247], v[124:127]
    s_waitcnt lgkmcnt(10)
    v_mfma_f32_16x16x32_bf16 v[128:131], v[176:179], v[216:219], v[128:131]
    ds_read_b128 v[232:235], v250 offset:26624
    ds_read_b128 v[236:239], v250 offset:37888
    v_mfma_f32_16x16x32_bf16 v[132:135], v[180:183], v[216:219], v[132:135]
    v_mfma_f32_16x16x32_bf16 v[136:139], v[208:211], v[216:219], v[136:139]
    v_mfma_f32_16x16x32_bf16 v[140:143], v[212:215], v[216:219], v[140:143]
    v_mfma_f32_16x16x32_bf16 v[128:131], v[184:187], v[220:223], v[128:131]
    v_mfma_f32_16x16x32_bf16 v[132:135], v[188:191], v[220:223], v[132:135]
    v_mfma_f32_16x16x32_bf16 v[136:139], v[176:179], v[220:223], v[136:139]
    v_mfma_f32_16x16x32_bf16 v[140:143], v[180:183], v[220:223], v[140:143]
    s_waitcnt lgkmcnt(6)
    v_mfma_f32_16x16x32_bf16 v[144:147], v[176:179], v[224:227], v[144:147]
    v_add_u32 v250, 0x9800, v250
    ds_read_b128 v[240:243], v250 offset:16384
    ds_read_b128 v[244:247], v250 offset:27648
    v_mfma_f32_16x16x32_bf16 v[148:151], v[180:183], v[224:227], v[148:151]
    v_mfma_f32_16x16x32_bf16 v[152:155], v[208:211], v[224:227], v[152:155]
    v_mfma_f32_16x16x32_bf16 v[156:159], v[212:215], v[224:227], v[156:159]
    v_mfma_f32_16x16x32_bf16 v[144:147], v[184:187], v[228:231], v[144:147]
    s_waitcnt lgkmcnt(4)
    v_xor_b32 v212, 0x80008000, v204
    v_xor_b32 v213, 0x80008000, v205
    v_mfma_f32_16x16x32_bf16 v[148:151], v[188:191], v[228:231], v[148:151]
    v_xor_b32 v214, 0x80008000, v206
    v_xor_b32 v215, 0x80008000, v207
    v_mfma_f32_16x16x32_bf16 v[152:155], v[176:179], v[228:231], v[152:155]
    v_mfma_f32_16x16x32_bf16 v[156:159], v[180:183], v[228:231], v[156:159]
    s_waitcnt lgkmcnt(2)
    v_mfma_f32_16x16x32_bf16 v[160:163], v[176:179], v[232:235], v[160:163]
    ds_read_b128 v[216:219], v250 offset:17408
    ds_read_b128 v[220:223], v250 offset:28672
    v_mfma_f32_16x16x32_bf16 v[164:167], v[208:211], v[232:235], v[164:167]
    v_xor_b32 v208, 0x80008000, v200
    v_xor_b32 v209, 0x80008000, v201
    v_mfma_f32_16x16x32_bf16 v[160:163], v[184:187], v[236:239], v[160:163]
    v_xor_b32 v210, 0x80008000, v202
    v_xor_b32 v211, 0x80008000, v203
    v_mfma_f32_16x16x32_bf16 v[164:167], v[176:179], v[236:239], v[164:167]
    s_barrier
    s_waitcnt lgkmcnt(2)
    v_mfma_f32_16x16x32_bf16 v[0:3], v[192:195], v[240:243], v[0:3]
    ds_read_b128 v[224:227], v250 offset:18432
    ds_read_b128 v[228:231], v250 offset:29696
    v_mfma_f32_16x16x32_bf16 v[4:7], v[196:199], v[240:243], v[4:7]
    v_mfma_f32_16x16x32_bf16 v[8:11], v[208:211], v[240:243], v[8:11]
    v_mfma_f32_16x16x32_bf16 v[12:15], v[212:215], v[240:243], v[12:15]
    v_mfma_f32_16x16x32_bf16 v[0:3], v[200:203], v[244:247], v[0:3]
    v_mfma_f32_16x16x32_bf16 v[4:7], v[204:207], v[244:247], v[4:7]
    v_mfma_f32_16x16x32_bf16 v[8:11], v[192:195], v[244:247], v[8:11]
    v_mfma_f32_16x16x32_bf16 v[12:15], v[196:199], v[244:247], v[12:15]
    s_waitcnt lgkmcnt(2)
    v_mfma_f32_16x16x32_bf16 v[16:19], v[192:195], v[216:219], v[16:19]
    ds_read_b128 v[232:235], v250 offset:19456
    ds_read_b128 v[236:239], v250 offset:30720
    v_mfma_f32_16x16x32_bf16 v[20:23], v[196:199], v[216:219], v[20:23]
    v_mfma_f32_16x16x32_bf16 v[24:27], v[208:211], v[216:219], v[24:27]
    v_mfma_f32_16x16x32_bf16 v[28:31], v[212:215], v[216:219], v[28:31]
    v_mfma_f32_16x16x32_bf16 v[16:19], v[200:203], v[220:223], v[16:19]
    v_mfma_f32_16x16x32_bf16 v[20:23], v[204:207], v[220:223], v[20:23]
    v_mfma_f32_16x16x32_bf16 v[24:27], v[192:195], v[220:223], v[24:27]
    v_mfma_f32_16x16x32_bf16 v[28:31], v[196:199], v[220:223], v[28:31]
    s_waitcnt lgkmcnt(2)
    v_mfma_f32_16x16x32_bf16 v[32:35], v[192:195], v[224:227], v[32:35]
    ds_read_b128 v[240:243], v250 offset:20480
    ds_read_b128 v[244:247], v250 offset:31744
    v_mfma_f32_16x16x32_bf16 v[36:39], v[196:199], v[224:227], v[36:39]
    v_mfma_f32_16x16x32_bf16 v[40:43], v[208:211], v[224:227], v[40:43]
    v_mfma_f32_16x16x32_bf16 v[44:47], v[212:215], v[224:227], v[44:47]
    v_mfma_f32_16x16x32_bf16 v[32:35], v[200:203], v[228:231], v[32:35]
    v_mfma_f32_16x16x32_bf16 v[36:39], v[204:207], v[228:231], v[36:39]
    v_mfma_f32_16x16x32_bf16 v[40:43], v[192:195], v[228:231], v[40:43]
    v_mfma_f32_16x16x32_bf16 v[44:47], v[196:199], v[228:231], v[44:47]
    s_waitcnt lgkmcnt(2)
    v_mfma_f32_16x16x32_bf16 v[48:51], v[192:195], v[232:235], v[48:51]
    ds_read_b128 v[216:219], v250 offset:21504
    ds_read_b128 v[220:223], v250 offset:32768
    v_mfma_f32_16x16x32_bf16 v[52:55], v[196:199], v[232:235], v[52:55]
    v_mfma_f32_16x16x32_bf16 v[56:59], v[208:211], v[232:235], v[56:59]
    v_mfma_f32_16x16x32_bf16 v[60:63], v[212:215], v[232:235], v[60:63]
    v_mfma_f32_16x16x32_bf16 v[48:51], v[200:203], v[236:239], v[48:51]
    v_mfma_f32_16x16x32_bf16 v[52:55], v[204:207], v[236:239], v[52:55]
    v_mfma_f32_16x16x32_bf16 v[56:59], v[192:195], v[236:239], v[56:59]
    v_mfma_f32_16x16x32_bf16 v[60:63], v[196:199], v[236:239], v[60:63]
    s_waitcnt lgkmcnt(2)
    v_mfma_f32_16x16x32_bf16 v[64:67], v[192:195], v[240:243], v[64:67]
    ds_read_b128 v[224:227], v250 offset:22528
    ds_read_b128 v[228:231], v250 offset:33792
    v_mfma_f32_16x16x32_bf16 v[68:71], v[196:199], v[240:243], v[68:71]
    v_mfma_f32_16x16x32_bf16 v[72:75], v[208:211], v[240:243], v[72:75]
    v_mfma_f32_16x16x32_bf16 v[76:79], v[212:215], v[240:243], v[76:79]
    v_mfma_f32_16x16x32_bf16 v[64:67], v[200:203], v[244:247], v[64:67]
    v_mfma_f32_16x16x32_bf16 v[68:71], v[204:207], v[244:247], v[68:71]
    v_mfma_f32_16x16x32_bf16 v[72:75], v[192:195], v[244:247], v[72:75]
    v_mfma_f32_16x16x32_bf16 v[76:79], v[196:199], v[244:247], v[76:79]
    s_waitcnt lgkmcnt(2)
    v_mfma_f32_16x16x32_bf16 v[80:83], v[192:195], v[216:219], v[80:83]
    ds_read_b128 v[232:235], v250 offset:23552
    ds_read_b128 v[236:239], v250 offset:34816
    v_mfma_f32_16x16x32_bf16 v[84:87], v[196:199], v[216:219], v[84:87]
    v_mfma_f32_16x16x32_bf16 v[88:91], v[208:211], v[216:219], v[88:91]
    v_mfma_f32_16x16x32_bf16 v[92:95], v[212:215], v[216:219], v[92:95]
    v_mfma_f32_16x16x32_bf16 v[80:83], v[200:203], v[220:223], v[80:83]
    v_add_u32 v248, 0x9800, v248
    v_add_u32 v249, 0x9800, v249
    v_mfma_f32_16x16x32_bf16 v[84:87], v[204:207], v[220:223], v[84:87]
    v_mfma_f32_16x16x32_bf16 v[88:91], v[192:195], v[220:223], v[88:91]
    v_mfma_f32_16x16x32_bf16 v[92:95], v[196:199], v[220:223], v[92:95]
    s_waitcnt lgkmcnt(2)
    v_mfma_f32_16x16x32_bf16 v[96:99], v[192:195], v[224:227], v[96:99]
    ds_read_b128 v[240:243], v250 offset:24576
    ds_read_b128 v[244:247], v250 offset:35840
    v_mfma_f32_16x16x32_bf16 v[100:103], v[196:199], v[224:227], v[100:103]
    v_mfma_f32_16x16x32_bf16 v[104:107], v[208:211], v[224:227], v[104:107]
    v_mfma_f32_16x16x32_bf16 v[108:111], v[212:215], v[224:227], v[108:111]
    ds_read_b64_tr_b16 v[176:177], v248 offset:0
    ds_read_b64_tr_b16 v[178:179], v248 offset:1024
    ds_read_b64_tr_b16 v[180:181], v249 offset:0
    ds_read_b64_tr_b16 v[182:183], v249 offset:1024
    v_mfma_f32_16x16x32_bf16 v[96:99], v[200:203], v[228:231], v[96:99]
    v_mfma_f32_16x16x32_bf16 v[100:103], v[204:207], v[228:231], v[100:103]
    v_mfma_f32_16x16x32_bf16 v[104:107], v[192:195], v[228:231], v[104:107]
    v_mfma_f32_16x16x32_bf16 v[108:111], v[196:199], v[228:231], v[108:111]
    s_waitcnt lgkmcnt(6)
    v_mfma_f32_16x16x32_bf16 v[112:115], v[192:195], v[232:235], v[112:115]
    ds_read_b128 v[216:219], v250 offset:25600
    ds_read_b128 v[220:223], v250 offset:36864
    v_mfma_f32_16x16x32_bf16 v[116:119], v[196:199], v[232:235], v[116:119]
    v_mfma_f32_16x16x32_bf16 v[120:123], v[208:211], v[232:235], v[120:123]
    v_mfma_f32_16x16x32_bf16 v[124:127], v[212:215], v[232:235], v[124:127]
    ds_read_b64_tr_b16 v[184:185], v248 offset:8192
    ds_read_b64_tr_b16 v[186:187], v248 offset:9216
    ds_read_b64_tr_b16 v[188:189], v249 offset:8192
    ds_read_b64_tr_b16 v[190:191], v249 offset:9216
    v_mfma_f32_16x16x32_bf16 v[112:115], v[200:203], v[236:239], v[112:115]
    v_mfma_f32_16x16x32_bf16 v[116:119], v[204:207], v[236:239], v[116:119]
    v_mfma_f32_16x16x32_bf16 v[120:123], v[192:195], v[236:239], v[120:123]
    v_mfma_f32_16x16x32_bf16 v[124:127], v[196:199], v[236:239], v[124:127]
    s_waitcnt lgkmcnt(10)
    v_mfma_f32_16x16x32_bf16 v[128:131], v[192:195], v[240:243], v[128:131]
    ds_read_b128 v[224:227], v250 offset:26624
    ds_read_b128 v[228:231], v250 offset:37888
    v_mfma_f32_16x16x32_bf16 v[132:135], v[196:199], v[240:243], v[132:135]
    v_mfma_f32_16x16x32_bf16 v[136:139], v[208:211], v[240:243], v[136:139]
    v_mfma_f32_16x16x32_bf16 v[140:143], v[212:215], v[240:243], v[140:143]
    v_mfma_f32_16x16x32_bf16 v[128:131], v[200:203], v[244:247], v[128:131]
    v_mfma_f32_16x16x32_bf16 v[132:135], v[204:207], v[244:247], v[132:135]
    v_mfma_f32_16x16x32_bf16 v[136:139], v[192:195], v[244:247], v[136:139]
    v_mfma_f32_16x16x32_bf16 v[140:143], v[196:199], v[244:247], v[140:143]
    s_waitcnt lgkmcnt(6)
    v_mfma_f32_16x16x32_bf16 v[144:147], v[192:195], v[216:219], v[144:147]
    v_add_u32 v250, 0x9800, v250
    ds_read_b128 v[232:235], v250 offset:16384
    ds_read_b128 v[236:239], v250 offset:27648
    v_mfma_f32_16x16x32_bf16 v[148:151], v[196:199], v[216:219], v[148:151]
    v_mfma_f32_16x16x32_bf16 v[152:155], v[208:211], v[216:219], v[152:155]
    v_mfma_f32_16x16x32_bf16 v[156:159], v[212:215], v[216:219], v[156:159]
    v_mfma_f32_16x16x32_bf16 v[144:147], v[200:203], v[220:223], v[144:147]
    s_waitcnt lgkmcnt(4)
    v_xor_b32 v212, 0x80008000, v188
    v_xor_b32 v213, 0x80008000, v189
    v_mfma_f32_16x16x32_bf16 v[148:151], v[204:207], v[220:223], v[148:151]
    v_xor_b32 v214, 0x80008000, v190
    v_xor_b32 v215, 0x80008000, v191
    v_mfma_f32_16x16x32_bf16 v[152:155], v[192:195], v[220:223], v[152:155]
    v_mfma_f32_16x16x32_bf16 v[156:159], v[196:199], v[220:223], v[156:159]
    s_waitcnt lgkmcnt(2)
    v_mfma_f32_16x16x32_bf16 v[160:163], v[192:195], v[224:227], v[160:163]
    ds_read_b128 v[240:243], v250 offset:17408
    ds_read_b128 v[244:247], v250 offset:28672
    v_mfma_f32_16x16x32_bf16 v[164:167], v[208:211], v[224:227], v[164:167]
    v_xor_b32 v208, 0x80008000, v184
    v_xor_b32 v209, 0x80008000, v185
    v_mfma_f32_16x16x32_bf16 v[160:163], v[200:203], v[228:231], v[160:163]
    v_xor_b32 v210, 0x80008000, v186
    v_xor_b32 v211, 0x80008000, v187
    v_mfma_f32_16x16x32_bf16 v[164:167], v[192:195], v[228:231], v[164:167]
    s_barrier
    s_waitcnt lgkmcnt(2)
    v_mfma_f32_16x16x32_bf16 v[0:3], v[176:179], v[232:235], v[0:3]
    ds_read_b128 v[216:219], v250 offset:18432
    ds_read_b128 v[220:223], v250 offset:29696
    v_mfma_f32_16x16x32_bf16 v[4:7], v[180:183], v[232:235], v[4:7]
    v_mfma_f32_16x16x32_bf16 v[8:11], v[208:211], v[232:235], v[8:11]
    v_mfma_f32_16x16x32_bf16 v[12:15], v[212:215], v[232:235], v[12:15]
    v_mfma_f32_16x16x32_bf16 v[0:3], v[184:187], v[236:239], v[0:3]
    v_mfma_f32_16x16x32_bf16 v[4:7], v[188:191], v[236:239], v[4:7]
    v_mfma_f32_16x16x32_bf16 v[8:11], v[176:179], v[236:239], v[8:11]
    v_mfma_f32_16x16x32_bf16 v[12:15], v[180:183], v[236:239], v[12:15]
    s_waitcnt lgkmcnt(2)
    v_mfma_f32_16x16x32_bf16 v[16:19], v[176:179], v[240:243], v[16:19]
    ds_read_b128 v[224:227], v250 offset:19456
    ds_read_b128 v[228:231], v250 offset:30720
    v_mfma_f32_16x16x32_bf16 v[20:23], v[180:183], v[240:243], v[20:23]
    v_mfma_f32_16x16x32_bf16 v[24:27], v[208:211], v[240:243], v[24:27]
    v_mfma_f32_16x16x32_bf16 v[28:31], v[212:215], v[240:243], v[28:31]
    v_mfma_f32_16x16x32_bf16 v[16:19], v[184:187], v[244:247], v[16:19]
    v_mfma_f32_16x16x32_bf16 v[20:23], v[188:191], v[244:247], v[20:23]
    v_mfma_f32_16x16x32_bf16 v[24:27], v[176:179], v[244:247], v[24:27]
    v_mfma_f32_16x16x32_bf16 v[28:31], v[180:183], v[244:247], v[28:31]
    s_waitcnt lgkmcnt(2)
    v_mfma_f32_16x16x32_bf16 v[32:35], v[176:179], v[216:219], v[32:35]
    ds_read_b128 v[232:235], v250 offset:20480
    ds_read_b128 v[236:239], v250 offset:31744
    v_mfma_f32_16x16x32_bf16 v[36:39], v[180:183], v[216:219], v[36:39]
    v_mfma_f32_16x16x32_bf16 v[40:43], v[208:211], v[216:219], v[40:43]
    v_mfma_f32_16x16x32_bf16 v[44:47], v[212:215], v[216:219], v[44:47]
    v_mfma_f32_16x16x32_bf16 v[32:35], v[184:187], v[220:223], v[32:35]
    v_mfma_f32_16x16x32_bf16 v[36:39], v[188:191], v[220:223], v[36:39]
    v_mfma_f32_16x16x32_bf16 v[40:43], v[176:179], v[220:223], v[40:43]
    v_mfma_f32_16x16x32_bf16 v[44:47], v[180:183], v[220:223], v[44:47]
    s_waitcnt lgkmcnt(2)
    v_mfma_f32_16x16x32_bf16 v[48:51], v[176:179], v[224:227], v[48:51]
    ds_read_b128 v[240:243], v250 offset:21504
    ds_read_b128 v[244:247], v250 offset:32768
    v_mfma_f32_16x16x32_bf16 v[52:55], v[180:183], v[224:227], v[52:55]
    v_mfma_f32_16x16x32_bf16 v[56:59], v[208:211], v[224:227], v[56:59]
    v_mfma_f32_16x16x32_bf16 v[60:63], v[212:215], v[224:227], v[60:63]
    v_mfma_f32_16x16x32_bf16 v[48:51], v[184:187], v[228:231], v[48:51]
    v_mfma_f32_16x16x32_bf16 v[52:55], v[188:191], v[228:231], v[52:55]
    v_mfma_f32_16x16x32_bf16 v[56:59], v[176:179], v[228:231], v[56:59]
    v_mfma_f32_16x16x32_bf16 v[60:63], v[180:183], v[228:231], v[60:63]
    s_waitcnt lgkmcnt(2)
    v_mfma_f32_16x16x32_bf16 v[64:67], v[176:179], v[232:235], v[64:67]
    ds_read_b128 v[216:219], v250 offset:22528
    ds_read_b128 v[220:223], v250 offset:33792
    v_mfma_f32_16x16x32_bf16 v[68:71], v[180:183], v[232:235], v[68:71]
    v_mfma_f32_16x16x32_bf16 v[72:75], v[208:211], v[232:235], v[72:75]
    v_mfma_f32_16x16x32_bf16 v[76:79], v[212:215], v[232:235], v[76:79]
    v_mfma_f32_16x16x32_bf16 v[64:67], v[184:187], v[236:239], v[64:67]
    v_mfma_f32_16x16x32_bf16 v[68:71], v[188:191], v[236:239], v[68:71]
    v_mfma_f32_16x16x32_bf16 v[72:75], v[176:179], v[236:239], v[72:75]
    v_mfma_f32_16x16x32_bf16 v[76:79], v[180:183], v[236:239], v[76:79]
    s_waitcnt lgkmcnt(2)
    v_mfma_f32_16x16x32_bf16 v[80:83], v[176:179], v[240:243], v[80:83]
    ds_read_b128 v[224:227], v250 offset:23552
    ds_read_b128 v[228:231], v250 offset:34816
    v_mfma_f32_16x16x32_bf16 v[84:87], v[180:183], v[240:243], v[84:87]
    v_mfma_f32_16x16x32_bf16 v[88:91], v[208:211], v[240:243], v[88:91]
    v_mfma_f32_16x16x32_bf16 v[92:95], v[212:215], v[240:243], v[92:95]
    v_mfma_f32_16x16x32_bf16 v[80:83], v[184:187], v[244:247], v[80:83]
    v_add_u32 v248, 0x9800, v248
    v_add_u32 v249, 0x9800, v249
    v_mfma_f32_16x16x32_bf16 v[84:87], v[188:191], v[244:247], v[84:87]
    v_mfma_f32_16x16x32_bf16 v[88:91], v[176:179], v[244:247], v[88:91]
    v_mfma_f32_16x16x32_bf16 v[92:95], v[180:183], v[244:247], v[92:95]
    s_waitcnt lgkmcnt(2)
    v_mfma_f32_16x16x32_bf16 v[96:99], v[176:179], v[216:219], v[96:99]
    ds_read_b128 v[232:235], v250 offset:24576
    ds_read_b128 v[236:239], v250 offset:35840
    v_mfma_f32_16x16x32_bf16 v[100:103], v[180:183], v[216:219], v[100:103]
    v_mfma_f32_16x16x32_bf16 v[104:107], v[208:211], v[216:219], v[104:107]
    v_mfma_f32_16x16x32_bf16 v[108:111], v[212:215], v[216:219], v[108:111]
    ds_read_b64_tr_b16 v[192:193], v248 offset:0
    ds_read_b64_tr_b16 v[194:195], v248 offset:1024
    ds_read_b64_tr_b16 v[196:197], v249 offset:0
    ds_read_b64_tr_b16 v[198:199], v249 offset:1024
    v_mfma_f32_16x16x32_bf16 v[96:99], v[184:187], v[220:223], v[96:99]
    v_mfma_f32_16x16x32_bf16 v[100:103], v[188:191], v[220:223], v[100:103]
    v_mfma_f32_16x16x32_bf16 v[104:107], v[176:179], v[220:223], v[104:107]
    v_mfma_f32_16x16x32_bf16 v[108:111], v[180:183], v[220:223], v[108:111]
    s_waitcnt lgkmcnt(6)
    v_mfma_f32_16x16x32_bf16 v[112:115], v[176:179], v[224:227], v[112:115]
    ds_read_b128 v[240:243], v250 offset:25600
    ds_read_b128 v[244:247], v250 offset:36864
    v_mfma_f32_16x16x32_bf16 v[116:119], v[180:183], v[224:227], v[116:119]
    v_mfma_f32_16x16x32_bf16 v[120:123], v[208:211], v[224:227], v[120:123]
    v_mfma_f32_16x16x32_bf16 v[124:127], v[212:215], v[224:227], v[124:127]
    ds_read_b64_tr_b16 v[200:201], v248 offset:8192
    ds_read_b64_tr_b16 v[202:203], v248 offset:9216
    ds_read_b64_tr_b16 v[204:205], v249 offset:8192
    ds_read_b64_tr_b16 v[206:207], v249 offset:9216
    v_mfma_f32_16x16x32_bf16 v[112:115], v[184:187], v[228:231], v[112:115]
    v_mfma_f32_16x16x32_bf16 v[116:119], v[188:191], v[228:231], v[116:119]
    v_mfma_f32_16x16x32_bf16 v[120:123], v[176:179], v[228:231], v[120:123]
    v_mfma_f32_16x16x32_bf16 v[124:127], v[180:183], v[228:231], v[124:127]
    s_waitcnt lgkmcnt(10)
    v_mfma_f32_16x16x32_bf16 v[128:131], v[176:179], v[232:235], v[128:131]
    ds_read_b128 v[216:219], v250 offset:26624
    ds_read_b128 v[220:223], v250 offset:37888
    v_mfma_f32_16x16x32_bf16 v[132:135], v[180:183], v[232:235], v[132:135]
    v_mfma_f32_16x16x32_bf16 v[136:139], v[208:211], v[232:235], v[136:139]
    v_mfma_f32_16x16x32_bf16 v[140:143], v[212:215], v[232:235], v[140:143]
    v_mfma_f32_16x16x32_bf16 v[128:131], v[184:187], v[236:239], v[128:131]
    v_mfma_f32_16x16x32_bf16 v[132:135], v[188:191], v[236:239], v[132:135]
    v_mfma_f32_16x16x32_bf16 v[136:139], v[176:179], v[236:239], v[136:139]
    v_mfma_f32_16x16x32_bf16 v[140:143], v[180:183], v[236:239], v[140:143]
    s_waitcnt lgkmcnt(6)
    v_mfma_f32_16x16x32_bf16 v[144:147], v[176:179], v[240:243], v[144:147]
    v_add_u32 v250, 0x9800, v250
    ds_read_b128 v[224:227], v250 offset:16384
    ds_read_b128 v[228:231], v250 offset:27648
    v_mfma_f32_16x16x32_bf16 v[148:151], v[180:183], v[240:243], v[148:151]
    v_mfma_f32_16x16x32_bf16 v[152:155], v[208:211], v[240:243], v[152:155]
    v_mfma_f32_16x16x32_bf16 v[156:159], v[212:215], v[240:243], v[156:159]
    v_mfma_f32_16x16x32_bf16 v[144:147], v[184:187], v[244:247], v[144:147]
    s_waitcnt lgkmcnt(4)
    v_xor_b32 v212, 0x80008000, v204
    v_xor_b32 v213, 0x80008000, v205
    v_mfma_f32_16x16x32_bf16 v[148:151], v[188:191], v[244:247], v[148:151]
    v_xor_b32 v214, 0x80008000, v206
    v_xor_b32 v215, 0x80008000, v207
    v_mfma_f32_16x16x32_bf16 v[152:155], v[176:179], v[244:247], v[152:155]
    v_mfma_f32_16x16x32_bf16 v[156:159], v[180:183], v[244:247], v[156:159]
    s_waitcnt lgkmcnt(2)
    v_mfma_f32_16x16x32_bf16 v[160:163], v[176:179], v[216:219], v[160:163]
    ds_read_b128 v[232:235], v250 offset:17408
    ds_read_b128 v[236:239], v250 offset:28672
    v_mfma_f32_16x16x32_bf16 v[164:167], v[208:211], v[216:219], v[164:167]
    v_xor_b32 v208, 0x80008000, v200
    v_xor_b32 v209, 0x80008000, v201
    v_mfma_f32_16x16x32_bf16 v[160:163], v[184:187], v[220:223], v[160:163]
    v_xor_b32 v210, 0x80008000, v202
    v_xor_b32 v211, 0x80008000, v203
    v_mfma_f32_16x16x32_bf16 v[164:167], v[176:179], v[220:223], v[164:167]
    s_barrier
    s_waitcnt lgkmcnt(2)
    v_mfma_f32_16x16x32_bf16 v[0:3], v[192:195], v[224:227], v[0:3]
    ds_read_b128 v[240:243], v250 offset:18432
    ds_read_b128 v[244:247], v250 offset:29696
    v_mfma_f32_16x16x32_bf16 v[4:7], v[196:199], v[224:227], v[4:7]
    v_mfma_f32_16x16x32_bf16 v[8:11], v[208:211], v[224:227], v[8:11]
    v_mfma_f32_16x16x32_bf16 v[12:15], v[212:215], v[224:227], v[12:15]
    v_mfma_f32_16x16x32_bf16 v[0:3], v[200:203], v[228:231], v[0:3]
    v_mfma_f32_16x16x32_bf16 v[4:7], v[204:207], v[228:231], v[4:7]
    v_mfma_f32_16x16x32_bf16 v[8:11], v[192:195], v[228:231], v[8:11]
    v_mfma_f32_16x16x32_bf16 v[12:15], v[196:199], v[228:231], v[12:15]
    s_waitcnt lgkmcnt(2)
    v_mfma_f32_16x16x32_bf16 v[16:19], v[192:195], v[232:235], v[16:19]
    ds_read_b128 v[216:219], v250 offset:19456
    ds_read_b128 v[220:223], v250 offset:30720
    v_mfma_f32_16x16x32_bf16 v[20:23], v[196:199], v[232:235], v[20:23]
    v_mfma_f32_16x16x32_bf16 v[24:27], v[208:211], v[232:235], v[24:27]
    v_mfma_f32_16x16x32_bf16 v[28:31], v[212:215], v[232:235], v[28:31]
    v_mfma_f32_16x16x32_bf16 v[16:19], v[200:203], v[236:239], v[16:19]
    v_mfma_f32_16x16x32_bf16 v[20:23], v[204:207], v[236:239], v[20:23]
    v_mfma_f32_16x16x32_bf16 v[24:27], v[192:195], v[236:239], v[24:27]
    v_mfma_f32_16x16x32_bf16 v[28:31], v[196:199], v[236:239], v[28:31]
    s_waitcnt lgkmcnt(2)
    v_mfma_f32_16x16x32_bf16 v[32:35], v[192:195], v[240:243], v[32:35]
    ds_read_b128 v[224:227], v250 offset:20480
    ds_read_b128 v[228:231], v250 offset:31744
    v_mfma_f32_16x16x32_bf16 v[36:39], v[196:199], v[240:243], v[36:39]
    v_mfma_f32_16x16x32_bf16 v[40:43], v[208:211], v[240:243], v[40:43]
    v_mfma_f32_16x16x32_bf16 v[44:47], v[212:215], v[240:243], v[44:47]
    v_mfma_f32_16x16x32_bf16 v[32:35], v[200:203], v[244:247], v[32:35]
    v_mfma_f32_16x16x32_bf16 v[36:39], v[204:207], v[244:247], v[36:39]
    v_mfma_f32_16x16x32_bf16 v[40:43], v[192:195], v[244:247], v[40:43]
    v_mfma_f32_16x16x32_bf16 v[44:47], v[196:199], v[244:247], v[44:47]
    s_waitcnt lgkmcnt(2)
    v_mfma_f32_16x16x32_bf16 v[48:51], v[192:195], v[216:219], v[48:51]
    ds_read_b128 v[232:235], v250 offset:21504
    ds_read_b128 v[236:239], v250 offset:32768
    v_mfma_f32_16x16x32_bf16 v[52:55], v[196:199], v[216:219], v[52:55]
    v_mfma_f32_16x16x32_bf16 v[56:59], v[208:211], v[216:219], v[56:59]
    v_mfma_f32_16x16x32_bf16 v[60:63], v[212:215], v[216:219], v[60:63]
    v_mfma_f32_16x16x32_bf16 v[48:51], v[200:203], v[220:223], v[48:51]
    v_mfma_f32_16x16x32_bf16 v[52:55], v[204:207], v[220:223], v[52:55]
    v_mfma_f32_16x16x32_bf16 v[56:59], v[192:195], v[220:223], v[56:59]
    v_mfma_f32_16x16x32_bf16 v[60:63], v[196:199], v[220:223], v[60:63]
    s_waitcnt lgkmcnt(2)
    v_mfma_f32_16x16x32_bf16 v[64:67], v[192:195], v[224:227], v[64:67]
    ds_read_b128 v[240:243], v250 offset:22528
    ds_read_b128 v[244:247], v250 offset:33792
    v_mfma_f32_16x16x32_bf16 v[68:71], v[196:199], v[224:227], v[68:71]
    v_mfma_f32_16x16x32_bf16 v[72:75], v[208:211], v[224:227], v[72:75]
    v_mfma_f32_16x16x32_bf16 v[76:79], v[212:215], v[224:227], v[76:79]
    v_mfma_f32_16x16x32_bf16 v[64:67], v[200:203], v[228:231], v[64:67]
    v_mfma_f32_16x16x32_bf16 v[68:71], v[204:207], v[228:231], v[68:71]
    v_mfma_f32_16x16x32_bf16 v[72:75], v[192:195], v[228:231], v[72:75]
    v_mfma_f32_16x16x32_bf16 v[76:79], v[196:199], v[228:231], v[76:79]
    s_waitcnt lgkmcnt(2)
    v_mfma_f32_16x16x32_bf16 v[80:83], v[192:195], v[232:235], v[80:83]
    ds_read_b128 v[216:219], v250 offset:23552
    ds_read_b128 v[220:223], v250 offset:34816
    v_mfma_f32_16x16x32_bf16 v[84:87], v[196:199], v[232:235], v[84:87]
    v_mfma_f32_16x16x32_bf16 v[88:91], v[208:211], v[232:235], v[88:91]
    v_mfma_f32_16x16x32_bf16 v[92:95], v[212:215], v[232:235], v[92:95]
    v_mfma_f32_16x16x32_bf16 v[80:83], v[200:203], v[236:239], v[80:83]
    v_add_u32 v248, 0xfffe3800, v248
    v_add_u32 v249, 0xfffe3800, v249
    v_mfma_f32_16x16x32_bf16 v[84:87], v[204:207], v[236:239], v[84:87]
    v_mfma_f32_16x16x32_bf16 v[88:91], v[192:195], v[236:239], v[88:91]
    v_mfma_f32_16x16x32_bf16 v[92:95], v[196:199], v[236:239], v[92:95]
    s_waitcnt lgkmcnt(2)
    v_mfma_f32_16x16x32_bf16 v[96:99], v[192:195], v[240:243], v[96:99]
    ds_read_b128 v[224:227], v250 offset:24576
    ds_read_b128 v[228:231], v250 offset:35840
    v_mfma_f32_16x16x32_bf16 v[100:103], v[196:199], v[240:243], v[100:103]
    v_mfma_f32_16x16x32_bf16 v[104:107], v[208:211], v[240:243], v[104:107]
    v_mfma_f32_16x16x32_bf16 v[108:111], v[212:215], v[240:243], v[108:111]
    ds_read_b64_tr_b16 v[176:177], v248 offset:0
    ds_read_b64_tr_b16 v[178:179], v248 offset:1024
    ds_read_b64_tr_b16 v[180:181], v249 offset:0
    ds_read_b64_tr_b16 v[182:183], v249 offset:1024
    v_mfma_f32_16x16x32_bf16 v[96:99], v[200:203], v[244:247], v[96:99]
    v_mfma_f32_16x16x32_bf16 v[100:103], v[204:207], v[244:247], v[100:103]
    v_mfma_f32_16x16x32_bf16 v[104:107], v[192:195], v[244:247], v[104:107]
    v_mfma_f32_16x16x32_bf16 v[108:111], v[196:199], v[244:247], v[108:111]
    s_waitcnt lgkmcnt(6)
    v_mfma_f32_16x16x32_bf16 v[112:115], v[192:195], v[216:219], v[112:115]
    ds_read_b128 v[232:235], v250 offset:25600
    ds_read_b128 v[236:239], v250 offset:36864
    v_mfma_f32_16x16x32_bf16 v[116:119], v[196:199], v[216:219], v[116:119]
    v_mfma_f32_16x16x32_bf16 v[120:123], v[208:211], v[216:219], v[120:123]
    v_mfma_f32_16x16x32_bf16 v[124:127], v[212:215], v[216:219], v[124:127]
    ds_read_b64_tr_b16 v[184:185], v248 offset:8192
    ds_read_b64_tr_b16 v[186:187], v248 offset:9216
    ds_read_b64_tr_b16 v[188:189], v249 offset:8192
    ds_read_b64_tr_b16 v[190:191], v249 offset:9216
    v_mfma_f32_16x16x32_bf16 v[112:115], v[200:203], v[220:223], v[112:115]
    v_mfma_f32_16x16x32_bf16 v[116:119], v[204:207], v[220:223], v[116:119]
    v_mfma_f32_16x16x32_bf16 v[120:123], v[192:195], v[220:223], v[120:123]
    v_mfma_f32_16x16x32_bf16 v[124:127], v[196:199], v[220:223], v[124:127]
    s_waitcnt lgkmcnt(10)
    v_mfma_f32_16x16x32_bf16 v[128:131], v[192:195], v[224:227], v[128:131]
    ds_read_b128 v[240:243], v250 offset:26624
    ds_read_b128 v[244:247], v250 offset:37888
    v_mfma_f32_16x16x32_bf16 v[132:135], v[196:199], v[224:227], v[132:135]
    v_mfma_f32_16x16x32_bf16 v[136:139], v[208:211], v[224:227], v[136:139]
    v_mfma_f32_16x16x32_bf16 v[140:143], v[212:215], v[224:227], v[140:143]
    v_mfma_f32_16x16x32_bf16 v[128:131], v[200:203], v[228:231], v[128:131]
    v_mfma_f32_16x16x32_bf16 v[132:135], v[204:207], v[228:231], v[132:135]
    v_mfma_f32_16x16x32_bf16 v[136:139], v[192:195], v[228:231], v[136:139]
    v_mfma_f32_16x16x32_bf16 v[140:143], v[196:199], v[228:231], v[140:143]
    s_waitcnt lgkmcnt(6)
    v_mfma_f32_16x16x32_bf16 v[144:147], v[192:195], v[232:235], v[144:147]
    v_add_u32 v250, 0xfffe3800, v250
    ds_read_b128 v[216:219], v250 offset:16384
    ds_read_b128 v[220:223], v250 offset:27648
    v_mfma_f32_16x16x32_bf16 v[148:151], v[196:199], v[232:235], v[148:151]
    v_mfma_f32_16x16x32_bf16 v[152:155], v[208:211], v[232:235], v[152:155]
    v_mfma_f32_16x16x32_bf16 v[156:159], v[212:215], v[232:235], v[156:159]
    v_mfma_f32_16x16x32_bf16 v[144:147], v[200:203], v[236:239], v[144:147]
    s_waitcnt lgkmcnt(4)
    v_xor_b32 v212, 0x80008000, v188
    v_xor_b32 v213, 0x80008000, v189
    v_mfma_f32_16x16x32_bf16 v[148:151], v[204:207], v[236:239], v[148:151]
    v_xor_b32 v214, 0x80008000, v190
    v_xor_b32 v215, 0x80008000, v191
    v_mfma_f32_16x16x32_bf16 v[152:155], v[192:195], v[236:239], v[152:155]
    v_mfma_f32_16x16x32_bf16 v[156:159], v[196:199], v[236:239], v[156:159]
    s_waitcnt lgkmcnt(2)
    v_mfma_f32_16x16x32_bf16 v[160:163], v[192:195], v[240:243], v[160:163]
    ds_read_b128 v[224:227], v250 offset:17408
    ds_read_b128 v[228:231], v250 offset:28672
    v_mfma_f32_16x16x32_bf16 v[164:167], v[208:211], v[240:243], v[164:167]
    v_xor_b32 v208, 0x80008000, v184
    v_xor_b32 v209, 0x80008000, v185
    v_mfma_f32_16x16x32_bf16 v[160:163], v[200:203], v[244:247], v[160:163]
    v_xor_b32 v210, 0x80008000, v186
    v_xor_b32 v211, 0x80008000, v187
    v_mfma_f32_16x16x32_bf16 v[164:167], v[192:195], v[244:247], v[164:167]
    s_sub_u32 s46, s46, 1
    s_cmp_lg_u32 s46, 0
    s_cbranch_scc1 L_g_loop
    s_barrier
    s_waitcnt lgkmcnt(2)
    v_mfma_f32_16x16x32_bf16 v[0:3], v[176:179], v[216:219], v[0:3]
    ds_read_b128 v[232:235], v250 offset:18432
    ds_read_b128 v[236:239], v250 offset:29696
    v_mfma_f32_16x16x32_bf16 v[4:7], v[180:183], v[216:219], v[4:7]
    v_mfma_f32_16x16x32_bf16 v[8:11], v[208:211], v[216:219], v[8:11]
    v_mfma_f32_16x16x32_bf16 v[12:15], v[212:215], v[216:219], v[12:15]
    v_mfma_f32_16x16x32_bf16 v[0:3], v[184:187], v[220:223], v[0:3]
    v_mfma_f32_16x16x32_bf16 v[4:7], v[188:191], v[220:223], v[4:7]
    v_mfma_f32_16x16x32_bf16 v[8:11], v[176:179], v[220:223], v[8:11]
    v_mfma_f32_16x16x32_bf16 v[12:15], v[180:183], v[220:223], v[12:15]
    s_waitcnt lgkmcnt(2)
    v_mfma_f32_16x16x32_bf16 v[16:19], v[176:179], v[224:227], v[16:19]
    ds_read_b128 v[240:243], v250 offset:19456
    ds_read_b128 v[244:247], v250 offset:30720
    v_mfma_f32_16x16x32_bf16 v[20:23], v[180:183], v[224:227], v[20:23]
    v_mfma_f32_16x16x32_bf16 v[24:27], v[208:211], v[224:227], v[24:27]
    v_mfma_f32_16x16x32_bf16 v[28:31], v[212:215], v[224:227], v[28:31]
    v_mfma_f32_16x16x32_bf16 v[16:19], v[184:187], v[228:231], v[16:19]
    v_mfma_f32_16x16x32_bf16 v[20:23], v[188:191], v[228:231], v[20:23]
    v_mfma_f32_16x16x32_bf16 v[24:27], v[176:179], v[228:231], v[24:27]
    v_mfma_f32_16x16x32_bf16 v[28:31], v[180:183], v[228:231], v[28:31]
    s_waitcnt lgkmcnt(2)
    v_mfma_f32_16x16x32_bf16 v[32:35], v[176:179], v[232:235], v[32:35]
    ds_read_b128 v[216:219], v250 offset:20480
    ds_read_b128 v[220:223], v250 offset:31744
    v_mfma_f32_16x16x32_bf16 v[36:39], v[180:183], v[232:235], v[36:39]
    v_mfma_f32_16x16x32_bf16 v[40:43], v[208:211], v[232:235], v[40:43]
    v_mfma_f32_16x16x32_bf16 v[44:47], v[212:215], v[232:235], v[44:47]
    v_mfma_f32_16x16x32_bf16 v[32:35], v[184:187], v[236:239], v[32:35]
    v_mfma_f32_16x16x32_bf16 v[36:39], v[188:191], v[236:239], v[36:39]
    v_mfma_f32_16x16x32_bf16 v[40:43], v[176:179], v[236:239], v[40:43]
    v_mfma_f32_16x16x32_bf16 v[44:47], v[180:183], v[236:239], v[44:47]
    s_waitcnt lgkmcnt(2)
    v_mfma_f32_16x16x32_bf16 v[48:51], v[176:179], v[240:243], v[48:51]
    ds_read_b128 v[224:227], v250 offset:21504
    ds_read_b128 v[228:231], v250 offset:32768
    v_mfma_f32_16x16x32_bf16 v[52:55], v[180:183], v[240:243], v[52:55]
    v_mfma_f32_16x16x32_bf16 v[56:59], v[208:211], v[240:243], v[56:59]
    v_mfma_f32_16x16x32_bf16 v[60:63], v[212:215], v[240:243], v[60:63]
    v_mfma_f32_16x16x32_bf16 v[48:51], v[184:187], v[244:247], v[48:51]
    v_mfma_f32_16x16x32_bf16 v[52:55], v[188:191], v[244:247], v[52:55]
    v_mfma_f32_16x16x32_bf16 v[56:59], v[176:179], v[244:247], v[56:59]
    v_mfma_f32_16x16x32_bf16 v[60:63], v[180:183], v[244:247], v[60:63]
    s_waitcnt lgkmcnt(2)
    v_mfma_f32_16x16x32_bf16 v[64:67], v[176:179], v[216:219], v[64:67]
    ds_read_b128 v[232:235], v250 offset:22528
    ds_read_b128 v[236:239], v250 offset:33792
    v_mfma_f32_16x16x32_bf16 v[68:71], v[180:183], v[216:219], v[68:71]
    v_mfma_f32_16x16x32_bf16 v[72:75], v[208:211], v[216:219], v[72:75]
    v_mfma_f32_16x16x32_bf16 v[76:79], v[212:215], v[216:219], v[76:79]
    v_mfma_f32_16x16x32_bf16 v[64:67], v[184:187], v[220:223], v[64:67]
    v_mfma_f32_16x16x32_bf16 v[68:71], v[188:191], v[220:223], v[68:71]
    v_mfma_f32_16x16x32_bf16 v[72:75], v[176:179], v[220:223], v[72:75]
    v_mfma_f32_16x16x32_bf16 v[76:79], v[180:183], v[220:223], v[76:79]
    s_waitcnt lgkmcnt(2)
    v_mfma_f32_16x16x32_bf16 v[80:83], v[176:179], v[224:227], v[80:83]
    ds_read_b128 v[240:243], v250 offset:23552
    ds_read_b128 v[244:247], v250 offset:34816
    v_mfma_f32_16x16x32_bf16 v[84:87], v[180:183], v[224:227], v[84:87]
    v_mfma_f32_16x16x32_bf16 v[88:91], v[208:211], v[224:227], v[88:91]
    v_mfma_f32_16x16x32_bf16 v[92:95], v[212:215], v[224:227], v[92:95]
    v_mfma_f32_16x16x32_bf16 v[80:83], v[184:187], v[228:231], v[80:83]
    v_add_u32 v248, 0x9800, v248
    v_add_u32 v249, 0x9800, v249
    v_mfma_f32_16x16x32_bf16 v[84:87], v[188:191], v[228:231], v[84:87]
    v_mfma_f32_16x16x32_bf16 v[88:91], v[176:179], v[228:231], v[88:91]
    v_mfma_f32_16x16x32_bf16 v[92:95], v[180:183], v[228:231], v[92:95]
    s_waitcnt lgkmcnt(2)
    v_mfma_f32_16x16x32_bf16 v[96:99], v[176:179], v[232:235], v[96:99]
    ds_read_b128 v[216:219], v250 offset:24576
    ds_read_b128 v[220:223], v250 offset:35840
    v_mfma_f32_16x16x32_bf16 v[100:103], v[180:183], v[232:235], v[100:103]
    v_mfma_f32_16x16x32_bf16 v[104:107], v[208:211], v[232:235], v[104:107]
    v_mfma_f32_16x16x32_bf16 v[108:111], v[212:215], v[232:235], v[108:111]
    ds_read_b64_tr_b16 v[192:193], v248 offset:0
    ds_read_b64_tr_b16 v[194:195], v248 offset:1024
    ds_read_b64_tr_b16 v[196:197], v249 offset:0
    ds_read_b64_tr_b16 v[198:199], v249 offset:1024
    v_mfma_f32_16x16x32_bf16 v[96:99], v[184:187], v[236:239], v[96:99]
    v_mfma_f32_16x16x32_bf16 v[100:103], v[188:191], v[236:239], v[100:103]
    v_mfma_f32_16x16x32_bf16 v[104:107], v[176:179], v[236:239], v[104:107]
    v_mfma_f32_16x16x32_bf16 v[108:111], v[180:183], v[236:239], v[108:111]
    s_waitcnt lgkmcnt(6)
    v_mfma_f32_16x16x32_bf16 v[112:115], v[176:179], v[240:243], v[112:115]
    ds_read_b128 v[224:227], v250 offset:25600
    ds_read_b128 v[228:231], v250 offset:36864
    v_mfma_f32_16x16x32_bf16 v[116:119], v[180:183], v[240:243], v[116:119]
    v_mfma_f32_16x16x32_bf16 v[120:123], v[208:211], v[240:243], v[120:123]
    v_mfma_f32_16x16x32_bf16 v[124:127], v[212:215], v[240:243], v[124:127]
    ds_read_b64_tr_b16 v[200:201], v248 offset:8192
    ds_read_b64_tr_b16 v[202:203], v248 offset:9216
    ds_read_b64_tr_b16 v[204:205], v249 offset:8192
    ds_read_b64_tr_b16 v[206:207], v249 offset:9216
    v_mfma_f32_16x16x32_bf16 v[112:115], v[184:187], v[244:247], v[112:115]
    v_mfma_f32_16x16x32_bf16 v[116:119], v[188:191], v[244:247], v[116:119]
    v_mfma_f32_16x16x32_bf16 v[120:123], v[176:179], v[244:247], v[120:123]
    v_mfma_f32_16x16x32_bf16 v[124:127], v[180:183], v[244:247], v[124:127]
    s_waitcnt lgkmcnt(10)
    v_mfma_f32_16x16x32_bf16 v[128:131], v[176:179], v[216:219], v[128:131]
    ds_read_b128 v[232:235], v250 offset:26624
    ds_read_b128 v[236:239], v250 offset:37888
    v_mfma_f32_16x16x32_bf16 v[132:135], v[180:183], v[216:219], v[132:135]
    v_mfma_f32_16x16x32_bf16 v[136:139], v[208:211], v[216:219], v[136:139]
    v_mfma_f32_16x16x32_bf16 v[140:143], v[212:215], v[216:219], v[140:143]
    v_mfma_f32_16x16x32_bf16 v[128:131], v[184:187], v[220:223], v[128:131]
    v_mfma_f32_16x16x32_bf16 v[132:135], v[188:191], v[220:223], v[132:135]
    v_mfma_f32_16x16x32_bf16 v[136:139], v[176:179], v[220:223], v[136:139]
    v_mfma_f32_16x16x32_bf16 v[140:143], v[180:183], v[220:223], v[140:143]
    s_waitcnt lgkmcnt(6)
    v_mfma_f32_16x16x32_bf16 v[144:147], v[176:179], v[224:227], v[144:147]
    v_add_u32 v250, 0x9800, v250
    ds_read_b128 v[240:243], v250 offset:16384
    ds_read_b128 v[244:247], v250 offset:27648
    v_mfma_f32_16x16x32_bf16 v[148:151], v[180:183], v[224:227], v[148:151]
    v_mfma_f32_16x16x32_bf16 v[152:155], v[208:211], v[224:227], v[152:155]
    v_mfma_f32_16x16x32_bf16 v[156:159], v[212:215], v[224:227], v[156:159]
    v_mfma_f32_16x16x32_bf16 v[144:147], v[184:187], v[228:231], v[144:147]
    s_waitcnt lgkmcnt(4)
    v_xor_b32 v212, 0x80008000, v204
    v_xor_b32 v213, 0x80008000, v205
    v_mfma_f32_16x16x32_bf16 v[148:151], v[188:191], v[228:231], v[148:151]
    v_xor_b32 v214, 0x80008000, v206
    v_xor_b32 v215, 0x80008000, v207
    v_mfma_f32_16x16x32_bf16 v[152:155], v[176:179], v[228:231], v[152:155]
    v_mfma_f32_16x16x32_bf16 v[156:159], v[180:183], v[228:231], v[156:159]
    s_waitcnt lgkmcnt(2)
    v_mfma_f32_16x16x32_bf16 v[160:163], v[176:179], v[232:235], v[160:163]
    ds_read_b128 v[216:219], v250 offset:17408
    ds_read_b128 v[220:223], v250 offset:28672
    v_mfma_f32_16x16x32_bf16 v[164:167], v[208:211], v[232:235], v[164:167]
    v_xor_b32 v208, 0x80008000, v200
    v_xor_b32 v209, 0x80008000, v201
    v_mfma_f32_16x16x32_bf16 v[160:163], v[184:187], v[236:239], v[160:163]
    v_xor_b32 v210, 0x80008000, v202
    v_xor_b32 v211, 0x80008000, v203
    v_mfma_f32_16x16x32_bf16 v[164:167], v[176:179], v[236:239], v[164:167]
    s_barrier
    s_waitcnt lgkmcnt(2)
    v_mfma_f32_16x16x32_bf16 v[0:3], v[192:195], v[240:243], v[0:3]
    ds_read_b128 v[224:227], v250 offset:18432
    ds_read_b128 v[228:231], v250 offset:29696
    v_mfma_f32_16x16x32_bf16 v[4:7], v[196:199], v[240:243], v[4:7]
    v_mfma_f32_16x16x32_bf16 v[8:11], v[208:211], v[240:243], v[8:11]
    v_mfma_f32_16x16x32_bf16 v[12:15], v[212:215], v[240:243], v[12:15]
    v_mfma_f32_16x16x32_bf16 v[0:3], v[200:203], v[244:247], v[0:3]
    v_mfma_f32_16x16x32_bf16 v[4:7], v[204:207], v[244:247], v[4:7]
    v_mfma_f32_16x16x32_bf16 v[8:11], v[192:195], v[244:247], v[8:11]
    v_mfma_f32_16x16x32_bf16 v[12:15], v[196:199], v[244:247], v[12:15]
    s_waitcnt lgkmcnt(2)
    v_mfma_f32_16x16x32_bf16 v[16:19], v[192:195], v[216:219], v[16:19]
    ds_read_b128 v[232:235], v250 offset:19456
    ds_read_b128 v[236:239], v250 offset:30720
    v_mfma_f32_16x16x32_bf16 v[20:23], v[196:199], v[216:219], v[20:23]
    v_mfma_f32_16x16x32_bf16 v[24:27], v[208:211], v[216:219], v[24:27]
    v_mfma_f32_16x16x32_bf16 v[28:31], v[212:215], v[216:219], v[28:31]
    v_mfma_f32_16x16x32_bf16 v[16:19], v[200:203], v[220:223], v[16:19]
    v_mfma_f32_16x16x32_bf16 v[20:23], v[204:207], v[220:223], v[20:23]
    v_mfma_f32_16x16x32_bf16 v[24:27], v[192:195], v[220:223], v[24:27]
    v_mfma_f32_16x16x32_bf16 v[28:31], v[196:199], v[220:223], v[28:31]
    s_waitcnt lgkmcnt(2)
    v_mfma_f32_16x16x32_bf16 v[32:35], v[192:195], v[224:227], v[32:35]
    ds_read_b128 v[240:243], v250 offset:20480
    ds_read_b128 v[244:247], v250 offset:31744
    v_mfma_f32_16x16x32_bf16 v[36:39], v[196:199], v[224:227], v[36:39]
    v_mfma_f32_16x16x32_bf16 v[40:43], v[208:211], v[224:227], v[40:43]
    v_mfma_f32_16x16x32_bf16 v[44:47], v[212:215], v[224:227], v[44:47]
    v_mfma_f32_16x16x32_bf16 v[32:35], v[200:203], v[228:231], v[32:35]
    v_mfma_f32_16x16x32_bf16 v[36:39], v[204:207], v[228:231], v[36:39]
    v_mfma_f32_16x16x32_bf16 v[40:43], v[192:195], v[228:231], v[40:43]
    v_mfma_f32_16x16x32_bf16 v[44:47], v[196:199], v[228:231], v[44:47]
    s_waitcnt lgkmcnt(2)
    v_mfma_f32_16x16x32_bf16 v[48:51], v[192:195], v[232:235], v[48:51]
    ds_read_b128 v[216:219], v250 offset:21504
    ds_read_b128 v[220:223], v250 offset:32768
    v_mfma_f32_16x16x32_bf16 v[52:55], v[196:199], v[232:235], v[52:55]
    v_mfma_f32_16x16x32_bf16 v[56:59], v[208:211], v[232:235], v[56:59]
    v_mfma_f32_16x16x32_bf16 v[60:63], v[212:215], v[232:235], v[60:63]
    v_mfma_f32_16x16x32_bf16 v[48:51], v[200:203], v[236:239], v[48:51]
    v_mfma_f32_16x16x32_bf16 v[52:55], v[204:207], v[236:239], v[52:55]
    v_mfma_f32_16x16x32_bf16 v[56:59], v[192:195], v[236:239], v[56:59]
    v_mfma_f32_16x16x32_bf16 v[60:63], v[196:199], v[236:239], v[60:63]
    s_waitcnt lgkmcnt(2)
    v_mfma_f32_16x16x32_bf16 v[64:67], v[192:195], v[240:243], v[64:67]
    ds_read_b128 v[224:227], v250 offset:22528
    ds_read_b128 v[228:231], v250 offset:33792
    v_mfma_f32_16x16x32_bf16 v[68:71], v[196:199], v[240:243], v[68:71]
    v_mfma_f32_16x16x32_bf16 v[72:75], v[208:211], v[240:243], v[72:75]
    v_mfma_f32_16x16x32_bf16 v[76:79], v[212:215], v[240:243], v[76:79]
    v_mfma_f32_16x16x32_bf16 v[64:67], v[200:203], v[244:247], v[64:67]
    v_mfma_f32_16x16x32_bf16 v[68:71], v[204:207], v[244:247], v[68:71]
    v_mfma_f32_16x16x32_bf16 v[72:75], v[192:195], v[244:247], v[72:75]
    v_mfma_f32_16x16x32_bf16 v[76:79], v[196:199], v[244:247], v[76:79]
    s_waitcnt lgkmcnt(2)
    v_mfma_f32_16x16x32_bf16 v[80:83], v[192:195], v[216:219], v[80:83]
    ds_read_b128 v[232:235], v250 offset:23552
    ds_read_b128 v[236:239], v250 offset:34816
    v_mfma_f32_16x16x32_bf16 v[84:87], v[196:199], v[216:219], v[84:87]
    v_mfma_f32_16x16x32_bf16 v[88:91], v[208:211], v[216:219], v[88:91]
    v_mfma_f32_16x16x32_bf16 v[92:95], v[212:215], v[216:219], v[92:95]
    v_mfma_f32_16x16x32_bf16 v[80:83], v[200:203], v[220:223], v[80:83]
    v_add_u32 v248, 0x9800, v248
    v_add_u32 v249, 0x9800, v249
    v_mfma_f32_16x16x32_bf16 v[84:87], v[204:207], v[220:223], v[84:87]
    v_mfma_f32_16x16x32_bf16 v[88:91], v[192:195], v[220:223], v[88:91]
    v_mfma_f32_16x16x32_bf16 v[92:95], v[196:199], v[220:223], v[92:95]
    s_waitcnt lgkmcnt(2)
    v_mfma_f32_16x16x32_bf16 v[96:99], v[192:195], v[224:227], v[96:99]
    ds_read_b128 v[240:243], v250 offset:24576
    ds_read_b128 v[244:247], v250 offset:35840
    v_mfma_f32_16x16x32_bf16 v[100:103], v[196:199], v[224:227], v[100:103]
    v_mfma_f32_16x16x32_bf16 v[104:107], v[208:211], v[224:227], v[104:107]
    v_mfma_f32_16x16x32_bf16 v[108:111], v[212:215], v[224:227], v[108:111]
    ds_read_b64_tr_b16 v[176:177], v248 offset:0
    ds_read_b64_tr_b16 v[178:179], v248 offset:1024
    ds_read_b64_tr_b16 v[180:181], v249 offset:0
    ds_read_b64_tr_b16 v[182:183], v249 offset:1024
    v_mfma_f32_16x16x32_bf16 v[96:99], v[200:203], v[228:231], v[96:99]
    v_mfma_f32_16x16x32_bf16 v[100:103], v[204:207], v[228:231], v[100:103]
    v_mfma_f32_16x16x32_bf16 v[104:107], v[192:195], v[228:231], v[104:107]
    v_mfma_f32_16x16x32_bf16 v[108:111], v[196:199], v[228:231], v[108:111]
    s_waitcnt lgkmcnt(6)
    v_mfma_f32_16x16x32_bf16 v[112:115], v[192:195], v[232:235], v[112:115]
    ds_read_b128 v[216:219], v250 offset:25600
    ds_read_b128 v[220:223], v250 offset:36864
    v_mfma_f32_16x16x32_bf16 v[116:119], v[196:199], v[232:235], v[116:119]
    v_mfma_f32_16x16x32_bf16 v[120:123], v[208:211], v[232:235], v[120:123]
    v_mfma_f32_16x16x32_bf16 v[124:127], v[212:215], v[232:235], v[124:127]
    ds_read_b64_tr_b16 v[184:185], v248 offset:8192
    ds_read_b64_tr_b16 v[186:187], v248 offset:9216
    ds_read_b64_tr_b16 v[188:189], v249 offset:8192
    ds_read_b64_tr_b16 v[190:191], v249 offset:9216
    v_mfma_f32_16x16x32_bf16 v[112:115], v[200:203], v[236:239], v[112:115]
    v_mfma_f32_16x16x32_bf16 v[116:119], v[204:207], v[236:239], v[116:119]
    v_mfma_f32_16x16x32_bf16 v[120:123], v[192:195], v[236:239], v[120:123]
    v_mfma_f32_16x16x32_bf16 v[124:127], v[196:199], v[236:239], v[124:127]
    s_waitcnt lgkmcnt(10)
    v_mfma_f32_16x16x32_bf16 v[128:131], v[192:195], v[240:243], v[128:131]
    ds_read_b128 v[224:227], v250 offset:26624
    ds_read_b128 v[228:231], v250 offset:37888
    v_mfma_f32_16x16x32_bf16 v[132:135], v[196:199], v[240:243], v[132:135]
    v_mfma_f32_16x16x32_bf16 v[136:139], v[208:211], v[240:243], v[136:139]
    v_mfma_f32_16x16x32_bf16 v[140:143], v[212:215], v[240:243], v[140:143]
    v_mfma_f32_16x16x32_bf16 v[128:131], v[200:203], v[244:247], v[128:131]
    v_mfma_f32_16x16x32_bf16 v[132:135], v[204:207], v[244:247], v[132:135]
    v_mfma_f32_16x16x32_bf16 v[136:139], v[192:195], v[244:247], v[136:139]
    v_mfma_f32_16x16x32_bf16 v[140:143], v[196:199], v[244:247], v[140:143]
    s_waitcnt lgkmcnt(6)
    v_mfma_f32_16x16x32_bf16 v[144:147], v[192:195], v[216:219], v[144:147]
    v_add_u32 v250, 0x9800, v250
    ds_read_b128 v[232:235], v250 offset:16384
    ds_read_b128 v[236:239], v250 offset:27648
    v_mfma_f32_16x16x32_bf16 v[148:151], v[196:199], v[216:219], v[148:151]
    v_mfma_f32_16x16x32_bf16 v[152:155], v[208:211], v[216:219], v[152:155]
    v_mfma_f32_16x16x32_bf16 v[156:159], v[212:215], v[216:219], v[156:159]
    v_mfma_f32_16x16x32_bf16 v[144:147], v[200:203], v[220:223], v[144:147]
    s_waitcnt lgkmcnt(4)
    v_xor_b32 v212, 0x80008000, v188
    v_xor_b32 v213, 0x80008000, v189
    v_mfma_f32_16x16x32_bf16 v[148:151], v[204:207], v[220:223], v[148:151]
    v_xor_b32 v214, 0x80008000, v190
    v_xor_b32 v215, 0x80008000, v191
    v_mfma_f32_16x16x32_bf16 v[152:155], v[192:195], v[220:223], v[152:155]
    v_mfma_f32_16x16x32_bf16 v[156:159], v[196:199], v[220:223], v[156:159]
    s_waitcnt lgkmcnt(2)
    v_mfma_f32_16x16x32_bf16 v[160:163], v[192:195], v[224:227], v[160:163]
    ds_read_b128 v[240:243], v250 offset:17408
    ds_read_b128 v[244:247], v250 offset:28672
    v_mfma_f32_16x16x32_bf16 v[164:167], v[208:211], v[224:227], v[164:167]
    v_xor_b32 v208, 0x80008000, v184
    v_xor_b32 v209, 0x80008000, v185
    v_mfma_f32_16x16x32_bf16 v[160:163], v[200:203], v[228:231], v[160:163]
    v_xor_b32 v210, 0x80008000, v186
    v_xor_b32 v211, 0x80008000, v187
    v_mfma_f32_16x16x32_bf16 v[164:167], v[192:195], v[228:231], v[164:167]
    s_barrier
    s_cmp_lg_u32 s13, 0
    s_cbranch_scc1 L_epi_b1
    v_add_u32 v248, 0x9800, v248
    v_add_u32 v249, 0x9800, v249
    v_add_u32 v253, 38912, v250
    ds_read_b64_tr_b16 v[192:193], v248 offset:0
    ds_read_b64_tr_b16 v[194:195], v248 offset:1024
    ds_read_b64_tr_b16 v[196:197], v249 offset:0
    ds_read_b64_tr_b16 v[198:199], v249 offset:1024
    ds_read_b64_tr_b16 v[200:201], v248 offset:8192
    ds_read_b64_tr_b16 v[202:203], v248 offset:9216
    ds_read_b64_tr_b16 v[204:205], v249 offset:8192
    ds_read_b64_tr_b16 v[206:207], v249 offset:9216
    s_waitcnt lgkmcnt(10)
    v_mfma_f32_16x16x32_bf16 v[0:3], v[176:179], v[232:235], v[0:3]
    ds_read_b128 v[216:219], v250 offset:18432
    ds_read_b128 v[220:223], v250 offset:29696
    v_mfma_f32_16x16x32_bf16 v[4:7], v[180:183], v[232:235], v[4:7]
    v_mfma_f32_16x16x32_bf16 v[8:11], v[208:211], v[232:235], v[8:11]
    v_mfma_f32_16x16x32_bf16 v[12:15], v[212:215], v[232:235], v[12:15]
    v_mfma_f32_16x16x32_bf16 v[0:3], v[184:187], v[236:239], v[0:3]
    v_mfma_f32_16x16x32_bf16 v[4:7], v[188:191], v[236:239], v[4:7]
    v_mfma_f32_16x16x32_bf16 v[8:11], v[176:179], v[236:239], v[8:11]
    v_mfma_f32_16x16x32_bf16 v[12:15], v[180:183], v[236:239], v[12:15]
    s_waitcnt lgkmcnt(10)
    v_mfma_f32_16x16x32_bf16 v[16:19], v[176:179], v[240:243], v[16:19]
    ds_read_b128 v[224:227], v253 offset:16384
    ds_read_b128 v[228:231], v253 offset:27648
    v_mfma_f32_16x16x32_bf16 v[20:23], v[180:183], v[240:243], v[20:23]
    v_mfma_f32_16x16x32_bf16 v[24:27], v[208:211], v[240:243], v[24:27]
    v_mfma_f32_16x16x32_bf16 v[28:31], v[212:215], v[240:243], v[28:31]
    v_mfma_f32_16x16x32_bf16 v[16:19], v[184:187], v[244:247], v[16:19]
    v_mfma_f32_16x16x32_bf16 v[20:23], v[188:191], v[244:247], v[20:23]
    v_mfma_f32_16x16x32_bf16 v[24:27], v[176:179], v[244:247], v[24:27]
    v_mfma_f32_16x16x32_bf16 v[28:31], v[180:183], v[244:247], v[28:31]
    s_waitcnt lgkmcnt(2)
    v_mfma_f32_16x16x32_bf16 v[32:35], v[176:179], v[216:219], v[32:35]
    ds_read_b128 v[232:235], v250 offset:19456
    ds_read_b128 v[236:239], v250 offset:30720
    v_mfma_f32_16x16x32_bf16 v[36:39], v[180:183], v[216:219], v[36:39]
    v_mfma_f32_16x16x32_bf16 v[40:43], v[208:211], v[216:219], v[40:43]
    v_mfma_f32_16x16x32_bf16 v[44:47], v[212:215], v[216:219], v[44:47]
    v_mfma_f32_16x16x32_bf16 v[32:35], v[184:187], v[220:223], v[32:35]
    v_mfma_f32_16x16x32_bf16 v[36:39], v[188:191], v[220:223], v[36:39]
    v_mfma_f32_16x16x32_bf16 v[40:43], v[176:179], v[220:223], v[40:43]
    v_mfma_f32_16x16x32_bf16 v[44:47], v[180:183], v[220:223], v[44:47]
    v_xor_b32 v168, 0x80008000, v200
    v_xor_b32 v169, 0x80008000, v201
    v_xor_b32 v170, 0x80008000, v202
    v_xor_b32 v171, 0x80008000, v203
    v_xor_b32 v172, 0x80008000, v204
    v_xor_b32 v173, 0x80008000, v205
    v_xor_b32 v174, 0x80008000, v206
    v_xor_b32 v175, 0x80008000, v207
    s_waitcnt lgkmcnt(2)
    v_mfma_f32_16x16x32_bf16 v[0:3], v[192:195], v[224:227], v[0:3]
    ds_read_b128 v[240:243], v253 offset:17408
    ds_read_b128 v[244:247], v253 offset:28672
    v_mfma_f32_16x16x32_bf16 v[4:7], v[196:199], v[224:227], v[4:7]
    v_mfma_f32_16x16x32_bf16 v[8:11], v[168:171], v[224:227], v[8:11]
    v_mfma_f32_16x16x32_bf16 v[12:15], v[172:175], v[224:227], v[12:15]
    v_mfma_f32_16x16x32_bf16 v[0:3], v[200:203], v[228:231], v[0:3]
    v_mfma_f32_16x16x32_bf16 v[4:7], v[204:207], v[228:231], v[4:7]
    v_mfma_f32_16x16x32_bf16 v[8:11], v[192:195], v[228:231], v[8:11]
    v_mfma_f32_16x16x32_bf16 v[12:15], v[196:199], v[228:231], v[12:15]
    s_waitcnt lgkmcnt(2)
    v_mfma_f32_16x16x32_bf16 v[48:51], v[176:179], v[232:235], v[48:51]
    ds_read_b128 v[216:219], v250 offset:20480
    ds_read_b128 v[220:223], v250 offset:31744
    v_mfma_f32_16x16x32_bf16 v[52:55], v[180:183], v[232:235], v[52:55]
    v_mfma_f32_16x16x32_bf16 v[56:59], v[208:211], v[232:235], v[56:59]
    v_mfma_f32_16x16x32_bf16 v[60:63], v[212:215], v[232:235], v[60:63]
    v_mfma_f32_16x16x32_bf16 v[48:51], v[184:187], v[236:239], v[48:51]
    v_mfma_f32_16x16x32_bf16 v[52:55], v[188:191], v[236:239], v[52:55]
    v_mfma_f32_16x16x32_bf16 v[56:59], v[176:179], v[236:239], v[56:59]
    v_mfma_f32_16x16x32_bf16 v[60:63], v[180:183], v[236:239], v[60:63]
    s_waitcnt lgkmcnt(2)
    v_mfma_f32_16x16x32_bf16 v[16:19], v[192:195], v[240:243], v[16:19]
    ds_read_b128 v[224:227], v253 offset:18432
    ds_read_b128 v[228:231], v253 offset:29696
    v_mfma_f32_16x16x32_bf16 v[20:23], v[196:199], v[240:243], v[20:23]
    v_cvt_pk_bf16_f32 v0, v0, v1
    v_cvt_pk_bf16_f32 v1, v2, v3
    v_mfma_f32_16x16x32_bf16 v[24:27], v[168:171], v[240:243], v[24:27]
    v_cvt_pk_bf16_f32 v2, v4, v5
    v_cvt_pk_bf16_f32 v3, v6, v7
    v_mfma_f32_16x16x32_bf16 v[28:31], v[172:175], v[240:243], v[28:31]
    s_add_u32 s47, s48, 0
    buffer_store_dwordx4 v[0:3], v251, s[16:19], s47 offen sc1
    v_mfma_f32_16x16x32_bf16 v[16:19], v[200:203], v[244:247], v[16:19]
    v_cvt_pk_bf16_f32 v8, v8, v9
    v_cvt_pk_bf16_f32 v9, v10, v11
    v_mfma_f32_16x16x32_bf16 v[20:23], v[204:207], v[244:247], v[20:23]
    v_cvt_pk_bf16_f32 v10, v12, v13
    v_cvt_pk_bf16_f32 v11, v14, v15
    v_mfma_f32_16x16x32_bf16 v[24:27], v[192:195], v[244:247], v[24:27]
    s_add_u32 s47, s48, 11264
    buffer_store_dwordx4 v[8:11], v251, s[16:19], s47 offen sc1
    v_mfma_f32_16x16x32_bf16 v[28:31], v[196:199], v[244:247], v[28:31]
    s_waitcnt lgkmcnt(2)
    v_mfma_f32_16x16x32_bf16 v[64:67], v[176:179], v[216:219], v[64:67]
    ds_read_b128 v[232:235], v250 offset:21504
    ds_read_b128 v[236:239], v250 offset:32768
    v_mfma_f32_16x16x32_bf16 v[68:71], v[180:183], v[216:219], v[68:71]
    v_mfma_f32_16x16x32_bf16 v[72:75], v[208:211], v[216:219], v[72:75]
    v_mfma_f32_16x16x32_bf16 v[76:79], v[212:215], v[216:219], v[76:79]
    v_mfma_f32_16x16x32_bf16 v[64:67], v[184:187], v[220:223], v[64:67]
    v_mfma_f32_16x16x32_bf16 v[68:71], v[188:191], v[220:223], v[68:71]
    v_mfma_f32_16x16x32_bf16 v[72:75], v[176:179], v[220:223], v[72:75]
    v_mfma_f32_16x16x32_bf16 v[76:79], v[180:183], v[220:223], v[76:79]
    s_waitcnt lgkmcnt(2)
    v_mfma_f32_16x16x32_bf16 v[32:35], v[192:195], v[224:227], v[32:35]
    ds_read_b128 v[240:243], v253 offset:19456
    ds_read_b128 v[244:247], v253 offset:30720
    v_mfma_f32_16x16x32_bf16 v[36:39], v[196:199], v[224:227], v[36:39]
    v_cvt_pk_bf16_f32 v16, v16, v17
    v_cvt_pk_bf16_f32 v17, v18, v19
    v_mfma_f32_16x16x32_bf16 v[40:43], v[168:171], v[224:227], v[40:43]
    v_cvt_pk_bf16_f32 v18, v20, v21
    v_cvt_pk_bf16_f32 v19, v22, v23
    v_mfma_f32_16x16x32_bf16 v[44:47], v[172:175], v[224:227], v[44:47]
    s_add_u32 s47, s48, 1024
    buffer_store_dwordx4 v[16:19], v251, s[16:19], s47 offen sc1
    v_mfma_f32_16x16x32_bf16 v[32:35], v[200:203], v[228:231], v[32:35]
    v_cvt_pk_bf16_f32 v24, v24, v25
    v_cvt_pk_bf16_f32 v25, v26, v27
    v_mfma_f32_16x16x32_bf16 v[36:39], v[204:207], v[228:231], v[36:39]
    v_cvt_pk_bf16_f32 v26, v28, v29
    v_cvt_pk_bf16_f32 v27, v30, v31
    v_mfma_f32_16x16x32_bf16 v[40:43], v[192:195], v[228:231], v[40:43]
    s_add_u32 s47, s48, 12288
    buffer_store_dwordx4 v[24:27], v251, s[16:19], s47 offen sc1
    v_mfma_f32_16x16x32_bf16 v[44:47], v[196:199], v[228:231], v[44:47]
    s_waitcnt lgkmcnt(2)
    v_mfma_f32_16x16x32_bf16 v[80:83], v[176:179], v[232:235], v[80:83]
    ds_read_b128 v[216:219], v250 offset:22528
    ds_read_b128 v[220:223], v250 offset:33792
    v_mfma_f32_16x16x32_bf16 v[84:87], v[180:183], v[232:235], v[84:87]
    v_mfma_f32_16x16x32_bf16 v[88:91], v[208:211], v[232:235], v[88:91]
    v_mfma_f32_16x16x32_bf16 v[92:95], v[212:215], v[232:235], v[92:95]
    v_mfma_f32_16x16x32_bf16 v[80:83], v[184:187], v[236:239], v[80:83]
    v_mfma_f32_16x16x32_bf16 v[84:87], v[188:191], v[236:239], v[84:87]
    v_mfma_f32_16x16x32_bf16 v[88:91], v[176:179], v[236:239], v[88:91]
    v_mfma_f32_16x16x32_bf16 v[92:95], v[180:183], v[236:239], v[92:95]
    s_waitcnt lgkmcnt(2)
    v_mfma_f32_16x16x32_bf16 v[48:51], v[192:195], v[240:243], v[48:51]
    ds_read_b128 v[224:227], v253 offset:20480
    ds_read_b128 v[228:231], v253 offset:31744
    v_mfma_f32_16x16x32_bf16 v[52:55], v[196:199], v[240:243], v[52:55]
    v_cvt_pk_bf16_f32 v32, v32, v33
    v_cvt_pk_bf16_f32 v33, v34, v35
    v_mfma_f32_16x16x32_bf16 v[56:59], v[168:171], v[240:243], v[56:59]
    v_cvt_pk_bf16_f32 v34, v36, v37
    v_cvt_pk_bf16_f32 v35, v38, v39
    v_mfma_f32_16x16x32_bf16 v[60:63], v[172:175], v[240:243], v[60:63]
    s_add_u32 s47, s48, 2048
    buffer_store_dwordx4 v[32:35], v251, s[16:19], s47 offen sc1
    v_mfma_f32_16x16x32_bf16 v[48:51], v[200:203], v[244:247], v[48:51]
    v_cvt_pk_bf16_f32 v40, v40, v41
    v_cvt_pk_bf16_f32 v41, v42, v43
    v_mfma_f32_16x16x32_bf16 v[52:55], v[204:207], v[244:247], v[52:55]
    v_cvt_pk_bf16_f32 v42, v44, v45
    v_cvt_pk_bf16_f32 v43, v46, v47
    v_mfma_f32_16x16x32_bf16 v[56:59], v[192:195], v[244:247], v[56:59]
    s_add_u32 s47, s48, 13312
    buffer_store_dwordx4 v[40:43], v251, s[16:19], s47 offen sc1
    v_mfma_f32_16x16x32_bf16 v[60:63], v[196:199], v[244:247], v[60:63]
    s_waitcnt lgkmcnt(2)
    v_mfma_f32_16x16x32_bf16 v[96:99], v[176:179], v[216:219], v[96:99]
    ds_read_b128 v[232:235], v250 offset:23552
    ds_read_b128 v[236:239], v250 offset:34816
    v_mfma_f32_16x16x32_bf16 v[100:103], v[180:183], v[216:219], v[100:103]
    v_mfma_f32_16x16x32_bf16 v[104:107], v[208:211], v[216:219], v[104:107]
    v_mfma_f32_16x16x32_bf16 v[108:111], v[212:215], v[216:219], v[108:111]
    v_mfma_f32_16x16x32_bf16 v[96:99], v[184:187], v[220:223], v[96:99]
    v_mfma_f32_16x16x32_bf16 v[100:103], v[188:191], v[220:223], v[100:103]
    v_mfma_f32_16x16x32_bf16 v[104:107], v[176:179], v[220:223], v[104:107]
    v_mfma_f32_16x16x32_bf16 v[108:111], v[180:183], v[220:223], v[108:111]
    s_waitcnt lgkmcnt(2)
    v_mfma_f32_16x16x32_bf16 v[64:67], v[192:195], v[224:227], v[64:67]
    ds_read_b128 v[240:243], v253 offset:21504
    ds_read_b128 v[244:247], v253 offset:32768
    v_mfma_f32_16x16x32_bf16 v[68:71], v[196:199], v[224:227], v[68:71]
    v_cvt_pk_bf16_f32 v48, v48, v49
    v_cvt_pk_bf16_f32 v49, v50, v51
    v_mfma_f32_16x16x32_bf16 v[72:75], v[168:171], v[224:227], v[72:75]
    v_cvt_pk_bf16_f32 v50, v52, v53
    v_cvt_pk_bf16_f32 v51, v54, v55
    v_mfma_f32_16x16x32_bf16 v[76:79], v[172:175], v[224:227], v[76:79]
    s_add_u32 s47, s48, 3072
    buffer_store_dwordx4 v[48:51], v251, s[16:19], s47 offen sc1
    v_mfma_f32_16x16x32_bf16 v[64:67], v[200:203], v[228:231], v[64:67]
    v_cvt_pk_bf16_f32 v56, v56, v57
    v_cvt_pk_bf16_f32 v57, v58, v59
    v_mfma_f32_16x16x32_bf16 v[68:71], v[204:207], v[228:231], v[68:71]
    v_cvt_pk_bf16_f32 v58, v60, v61
    v_cvt_pk_bf16_f32 v59, v62, v63
    v_mfma_f32_16x16x32_bf16 v[72:75], v[192:195], v[228:231], v[72:75]
    s_add_u32 s47, s48, 14336
    buffer_store_dwordx4 v[56:59], v251, s[16:19], s47 offen sc1
    v_mfma_f32_16x16x32_bf16 v[76:79], v[196:199], v[228:231], v[76:79]
    s_waitcnt lgkmcnt(2)
    v_mfma_f32_16x16x32_bf16 v[112:115], v[176:179], v[232:235], v[112:115]
    ds_read_b128 v[216:219], v250 offset:24576
    ds_read_b128 v[220:223], v250 offset:35840
    v_mfma_f32_16x16x32_bf16 v[116:119], v[180:183], v[232:235], v[116:119]
    v_mfma_f32_16x16x32_bf16 v[120:123], v[208:211], v[232:235], v[120:123]
    v_mfma_f32_16x16x32_bf16 v[124:127], v[212:215], v[232:235], v[124:127]
    v_mfma_f32_16x16x32_bf16 v[112:115], v[184:187], v[236:239], v[112:115]
    v_mfma_f32_16x16x32_bf16 v[116:119], v[188:191], v[236:239], v[116:119]
    v_mfma_f32_16x16x32_bf16 v[120:123], v[176:179], v[236:239], v[120:123]
    v_mfma_f32_16x16x32_bf16 v[124:127], v[180:183], v[236:239], v[124:127]
    s_waitcnt lgkmcnt(2)
    v_mfma_f32_16x16x32_bf16 v[80:83], v[192:195], v[240:243], v[80:83]
    ds_read_b128 v[224:227], v253 offset:22528
    ds_read_b128 v[228:231], v253 offset:33792
    v_mfma_f32_16x16x32_bf16 v[84:87], v[196:199], v[240:243], v[84:87]
    v_cvt_pk_bf16_f32 v64, v64, v65
    v_cvt_pk_bf16_f32 v65, v66, v67
    v_mfma_f32_16x16x32_bf16 v[88:91], v[168:171], v[240:243], v[88:91]
    v_cvt_pk_bf16_f32 v66, v68, v69
    v_cvt_pk_bf16_f32 v67, v70, v71
    v_mfma_f32_16x16x32_bf16 v[92:95], v[172:175], v[240:243], v[92:95]
    s_add_u32 s47, s48, 4096
    buffer_store_dwordx4 v[64:67], v251, s[16:19], s47 offen sc1
    v_mfma_f32_16x16x32_bf16 v[80:83], v[200:203], v[244:247], v[80:83]
    v_cvt_pk_bf16_f32 v72, v72, v73
    v_cvt_pk_bf16_f32 v73, v74, v75
    v_mfma_f32_16x16x32_bf16 v[84:87], v[204:207], v[244:247], v[84:87]
    v_cvt_pk_bf16_f32 v74, v76, v77
    v_cvt_pk_bf16_f32 v75, v78, v79
    v_mfma_f32_16x16x32_bf16 v[88:91], v[192:195], v[244:247], v[88:91]
    s_add_u32 s47, s48, 15360
    buffer_store_dwordx4 v[72:75], v251, s[16:19], s47 offen sc1
    v_mfma_f32_16x16x32_bf16 v[92:95], v[196:199], v[244:247], v[92:95]
    s_waitcnt lgkmcnt(2)
    v_mfma_f32_16x16x32_bf16 v[128:131], v[176:179], v[216:219], v[128:131]
    ds_read_b128 v[232:235], v250 offset:25600
    ds_read_b128 v[236:239], v250 offset:36864
    v_mfma_f32_16x16x32_bf16 v[132:135], v[180:183], v[216:219], v[132:135]
    v_mfma_f32_16x16x32_bf16 v[136:139], v[208:211], v[216:219], v[136:139]
    v_mfma_f32_16x16x32_bf16 v[140:143], v[212:215], v[216:219], v[140:143]
    v_mfma_f32_16x16x32_bf16 v[128:131], v[184:187], v[220:223], v[128:131]
    v_mfma_f32_16x16x32_bf16 v[132:135], v[188:191], v[220:223], v[132:135]
    v_mfma_f32_16x16x32_bf16 v[136:139], v[176:179], v[220:223], v[136:139]
    v_mfma_f32_16x16x32_bf16 v[140:143], v[180:183], v[220:223], v[140:143]
    s_waitcnt lgkmcnt(2)
    v_mfma_f32_16x16x32_bf16 v[96:99], v[192:195], v[224:227], v[96:99]
    ds_read_b128 v[240:243], v253 offset:23552
    ds_read_b128 v[244:247], v253 offset:34816
    v_mfma_f32_16x16x32_bf16 v[100:103], v[196:199], v[224:227], v[100:103]
    v_cvt_pk_bf16_f32 v80, v80, v81
    v_cvt_pk_bf16_f32 v81, v82, v83
    v_mfma_f32_16x16x32_bf16 v[104:107], v[168:171], v[224:227], v[104:107]
    v_cvt_pk_bf16_f32 v82, v84, v85
    v_cvt_pk_bf16_f32 v83, v86, v87
    v_mfma_f32_16x16x32_bf16 v[108:111], v[172:175], v[224:227], v[108:111]
    s_add_u32 s47, s48, 5120
    buffer_store_dwordx4 v[80:83], v251, s[16:19], s47 offen sc1
    v_mfma_f32_16x16x32_bf16 v[96:99], v[200:203], v[228:231], v[96:99]
    v_cvt_pk_bf16_f32 v88, v88, v89
    v_cvt_pk_bf16_f32 v89, v90, v91
    v_mfma_f32_16x16x32_bf16 v[100:103], v[204:207], v[228:231], v[100:103]
    v_cvt_pk_bf16_f32 v90, v92, v93
    v_cvt_pk_bf16_f32 v91, v94, v95
    v_mfma_f32_16x16x32_bf16 v[104:107], v[192:195], v[228:231], v[104:107]
    s_add_u32 s47, s48, 16384
    buffer_store_dwordx4 v[88:91], v251, s[16:19], s47 offen sc1
    v_mfma_f32_16x16x32_bf16 v[108:111], v[196:199], v[228:231], v[108:111]
    s_waitcnt lgkmcnt(2)
    v_mfma_f32_16x16x32_bf16 v[144:147], v[176:179], v[232:235], v[144:147]
    ds_read_b128 v[216:219], v250 offset:26624
    ds_read_b128 v[220:223], v250 offset:37888
    v_mfma_f32_16x16x32_bf16 v[148:151], v[180:183], v[232:235], v[148:151]
    v_mfma_f32_16x16x32_bf16 v[152:155], v[208:211], v[232:235], v[152:155]
    v_mfma_f32_16x16x32_bf16 v[156:159], v[212:215], v[232:235], v[156:159]
    v_mfma_f32_16x16x32_bf16 v[144:147], v[184:187], v[236:239], v[144:147]
    v_mfma_f32_16x16x32_bf16 v[148:151], v[188:191], v[236:239], v[148:151]
    v_mfma_f32_16x16x32_bf16 v[152:155], v[176:179], v[236:239], v[152:155]
    v_mfma_f32_16x16x32_bf16 v[156:159], v[180:183], v[236:239], v[156:159]
    s_waitcnt lgkmcnt(2)
    v_mfma_f32_16x16x32_bf16 v[112:115], v[192:195], v[240:243], v[112:115]
    ds_read_b128 v[224:227], v253 offset:24576
    ds_read_b128 v[228:231], v253 offset:35840
    v_mfma_f32_16x16x32_bf16 v[116:119], v[196:199], v[240:243], v[116:119]
    v_cvt_pk_bf16_f32 v96, v96, v97
    v_cvt_pk_bf16_f32 v97, v98, v99
    v_mfma_f32_16x16x32_bf16 v[120:123], v[168:171], v[240:243], v[120:123]
    v_cvt_pk_bf16_f32 v98, v100, v101
    v_cvt_pk_bf16_f32 v99, v102, v103
    v_mfma_f32_16x16x32_bf16 v[124:127], v[172:175], v[240:243], v[124:127]
    s_add_u32 s47, s48, 6144
    buffer_store_dwordx4 v[96:99], v251, s[16:19], s47 offen sc1
    v_mfma_f32_16x16x32_bf16 v[112:115], v[200:203], v[244:247], v[112:115]
    v_cvt_pk_bf16_f32 v104, v104, v105
    v_cvt_pk_bf16_f32 v105, v106, v107
    v_mfma_f32_16x16x32_bf16 v[116:119], v[204:207], v[244:247], v[116:119]
    v_cvt_pk_bf16_f32 v106, v108, v109
    v_cvt_pk_bf16_f32 v107, v110, v111
    v_mfma_f32_16x16x32_bf16 v[120:123], v[192:195], v[244:247], v[120:123]
    s_add_u32 s47, s48, 17408
    buffer_store_dwordx4 v[104:107], v251, s[16:19], s47 offen sc1
    v_mfma_f32_16x16x32_bf16 v[124:127], v[196:199], v[244:247], v[124:127]
    s_waitcnt lgkmcnt(2)
    v_mfma_f32_16x16x32_bf16 v[160:163], v[176:179], v[216:219], v[160:163]
    ds_read_b128 v[232:235], v253 offset:25600
    ds_read_b128 v[236:239], v253 offset:36864
    v_mfma_f32_16x16x32_bf16 v[164:167], v[208:211], v[216:219], v[164:167]
    v_mfma_f32_16x16x32_bf16 v[160:163], v[184:187], v[220:223], v[160:163]
    v_mfma_f32_16x16x32_bf16 v[164:167], v[176:179], v[220:223], v[164:167]
    s_waitcnt lgkmcnt(2)
    v_mfma_f32_16x16x32_bf16 v[128:131], v[192:195], v[224:227], v[128:131]
    ds_read_b128 v[240:243], v253 offset:26624
    ds_read_b128 v[244:247], v253 offset:37888
    v_mfma_f32_16x16x32_bf16 v[132:135], v[196:199], v[224:227], v[132:135]
    v_cvt_pk_bf16_f32 v112, v112, v113
    v_cvt_pk_bf16_f32 v113, v114, v115
    v_mfma_f32_16x16x32_bf16 v[136:139], v[168:171], v[224:227], v[136:139]
    v_cvt_pk_bf16_f32 v114, v116, v117
    v_cvt_pk_bf16_f32 v115, v118, v119
    v_mfma_f32_16x16x32_bf16 v[140:143], v[172:175], v[224:227], v[140:143]
    s_add_u32 s47, s48, 7168
    buffer_store_dwordx4 v[112:115], v251, s[16:19], s47 offen sc1
    v_mfma_f32_16x16x32_bf16 v[128:131], v[200:203], v[228:231], v[128:131]
    v_cvt_pk_bf16_f32 v120, v120, v121
    v_cvt_pk_bf16_f32 v121, v122, v123
    v_mfma_f32_16x16x32_bf16 v[132:135], v[204:207], v[228:231], v[132:135]
    v_cvt_pk_bf16_f32 v122, v124, v125
    v_cvt_pk_bf16_f32 v123, v126, v127
    v_mfma_f32_16x16x32_bf16 v[136:139], v[192:195], v[228:231], v[136:139]
    s_add_u32 s47, s48, 18432
    buffer_store_dwordx4 v[120:123], v251, s[16:19], s47 offen sc1
    v_mfma_f32_16x16x32_bf16 v[140:143], v[196:199], v[228:231], v[140:143]
    s_waitcnt lgkmcnt(2)
    v_mfma_f32_16x16x32_bf16 v[144:147], v[192:195], v[232:235], v[144:147]
    v_mfma_f32_16x16x32_bf16 v[148:151], v[196:199], v[232:235], v[148:151]
    v_mfma_f32_16x16x32_bf16 v[152:155], v[168:171], v[232:235], v[152:155]
    v_mfma_f32_16x16x32_bf16 v[156:159], v[172:175], v[232:235], v[156:159]
    v_mfma_f32_16x16x32_bf16 v[144:147], v[200:203], v[236:239], v[144:147]
    v_mfma_f32_16x16x32_bf16 v[148:151], v[204:207], v[236:239], v[148:151]
    v_mfma_f32_16x16x32_bf16 v[152:155], v[192:195], v[236:239], v[152:155]
    v_mfma_f32_16x16x32_bf16 v[156:159], v[196:199], v[236:239], v[156:159]
    s_waitcnt lgkmcnt(0)
    v_mfma_f32_16x16x32_bf16 v[160:163], v[192:195], v[240:243], v[160:163]
    v_mfma_f32_16x16x32_bf16 v[164:167], v[168:171], v[240:243], v[164:167]
    v_cvt_pk_bf16_f32 v128, v128, v129
    v_cvt_pk_bf16_f32 v129, v130, v131
    v_mfma_f32_16x16x32_bf16 v[160:163], v[200:203], v[244:247], v[160:163]
    v_cvt_pk_bf16_f32 v130, v132, v133
    v_cvt_pk_bf16_f32 v131, v134, v135
    v_mfma_f32_16x16x32_bf16 v[164:167], v[192:195], v[244:247], v[164:167]
    s_add_u32 s47, s48, 8192
    buffer_store_dwordx4 v[128:131], v251, s[16:19], s47 offen sc1
    s_nop 7
    v_cvt_pk_bf16_f32 v136, v136, v137
    v_cvt_pk_bf16_f32 v137, v138, v139
    v_cvt_pk_bf16_f32 v138, v140, v141
    v_cvt_pk_bf16_f32 v139, v142, v143
    s_add_u32 s47, s48, 19456
    buffer_store_dwordx4 v[136:139], v251, s[16:19], s47 offen sc1
    v_cvt_pk_bf16_f32 v144, v144, v145
    v_cvt_pk_bf16_f32 v145, v146, v147
    v_cvt_pk_bf16_f32 v146, v148, v149
    v_cvt_pk_bf16_f32 v147, v150, v151
    s_add_u32 s47, s48, 9216
    buffer_store_dwordx4 v[144:147], v251, s[16:19], s47 offen sc1
    v_cvt_pk_bf16_f32 v152, v152, v153
    v_cvt_pk_bf16_f32 v153, v154, v155
    v_cvt_pk_bf16_f32 v154, v156, v157
    v_cvt_pk_bf16_f32 v155, v158, v159
    s_add_u32 s47, s48, 20480
    buffer_store_dwordx4 v[152:155], v251, s[16:19], s47 offen sc1
    v_cvt_pk_bf16_f32 v160, v160, v161
    v_cvt_pk_bf16_f32 v161, v162, v163
    s_add_u32 s47, s49, 0
    buffer_store_dwordx2 v[160:161], v252, s[16:19], s47 offen sc1
    v_cvt_pk_bf16_f32 v164, v164, v165
    v_cvt_pk_bf16_f32 v165, v166, v167
    s_add_u32 s47, s49, 11264
    buffer_store_dwordx2 v[164:165], v252, s[16:19], s47 offen sc1
    s_branch L_epi_done
L_epi_b1:
    v_add_u32 v248, 0x9800, v248
    v_add_u32 v249, 0x9800, v249
    v_add_u32 v253, 38912, v250
    ds_read_b64_tr_b16 v[192:193], v248 offset:0
    ds_read_b64_tr_b16 v[194:195], v248 offset:1024
    ds_read_b64_tr_b16 v[196:197], v249 offset:0
    ds_read_b64_tr_b16 v[198:199], v249 offset:1024
    ds_read_b64_tr_b16 v[200:201], v248 offset:8192
    ds_read_b64_tr_b16 v[202:203], v248 offset:9216
    ds_read_b64_tr_b16 v[204:205], v249 offset:8192
    ds_read_b64_tr_b16 v[206:207], v249 offset:9216
    s_waitcnt lgkmcnt(10)
    v_mfma_f32_16x16x32_bf16 v[0:3], v[176:179], v[232:235], v[0:3]
    ds_read_b128 v[216:219], v250 offset:18432
    ds_read_b128 v[220:223], v250 offset:29696
    v_mfma_f32_16x16x32_bf16 v[4:7], v[180:183], v[232:235], v[4:7]
    v_mfma_f32_16x16x32_bf16 v[8:11], v[208:211], v[232:235], v[8:11]
    v_mfma_f32_16x16x32_bf16 v[12:15], v[212:215], v[232:235], v[12:15]
    v_mfma_f32_16x16x32_bf16 v[0:3], v[184:187], v[236:239], v[0:3]
    v_mfma_f32_16x16x32_bf16 v[4:7], v[188:191], v[236:239], v[4:7]
    v_mfma_f32_16x16x32_bf16 v[8:11], v[176:179], v[236:239], v[8:11]
    v_mfma_f32_16x16x32_bf16 v[12:15], v[180:183], v[236:239], v[12:15]
    s_waitcnt lgkmcnt(10)
    v_mfma_f32_16x16x32_bf16 v[16:19], v[176:179], v[240:243], v[16:19]
    ds_read_b128 v[224:227], v253 offset:16384
    ds_read_b128 v[228:231], v253 offset:27648
    v_mfma_f32_16x16x32_bf16 v[20:23], v[180:183], v[240:243], v[20:23]
    v_mfma_f32_16x16x32_bf16 v[24:27], v[208:211], v[240:243], v[24:27]
    v_mfma_f32_16x16x32_bf16 v[28:31], v[212:215], v[240:243], v[28:31]
    v_mfma_f32_16x16x32_bf16 v[16:19], v[184:187], v[244:247], v[16:19]
    v_mfma_f32_16x16x32_bf16 v[20:23], v[188:191], v[244:247], v[20:23]
    v_mfma_f32_16x16x32_bf16 v[24:27], v[176:179], v[244:247], v[24:27]
    v_mfma_f32_16x16x32_bf16 v[28:31], v[180:183], v[244:247], v[28:31]
    s_waitcnt lgkmcnt(2)
    v_mfma_f32_16x16x32_bf16 v[32:35], v[176:179], v[216:219], v[32:35]
    ds_read_b128 v[232:235], v250 offset:19456
    ds_read_b128 v[236:239], v250 offset:30720
    v_mfma_f32_16x16x32_bf16 v[36:39], v[180:183], v[216:219], v[36:39]
    v_mfma_f32_16x16x32_bf16 v[40:43], v[208:211], v[216:219], v[40:43]
    v_mfma_f32_16x16x32_bf16 v[44:47], v[212:215], v[216:219], v[44:47]
    v_mfma_f32_16x16x32_bf16 v[32:35], v[184:187], v[220:223], v[32:35]
    v_mfma_f32_16x16x32_bf16 v[36:39], v[188:191], v[220:223], v[36:39]
    v_mfma_f32_16x16x32_bf16 v[40:43], v[176:179], v[220:223], v[40:43]
    v_mfma_f32_16x16x32_bf16 v[44:47], v[180:183], v[220:223], v[44:47]
    v_xor_b32 v168, 0x80008000, v200
    v_xor_b32 v169, 0x80008000, v201
    v_xor_b32 v170, 0x80008000, v202
    v_xor_b32 v171, 0x80008000, v203
    v_xor_b32 v172, 0x80008000, v204
    v_xor_b32 v173, 0x80008000, v205
    v_xor_b32 v174, 0x80008000, v206
    v_xor_b32 v175, 0x80008000, v207
    s_waitcnt lgkmcnt(2)
    v_mfma_f32_16x16x32_bf16 v[0:3], v[192:195], v[224:227], v[0:3]
    ds_read_b128 v[240:243], v253 offset:17408
    ds_read_b128 v[244:247], v253 offset:28672
    v_mfma_f32_16x16x32_bf16 v[4:7], v[196:199], v[224:227], v[4:7]
    v_mfma_f32_16x16x32_bf16 v[8:11], v[168:171], v[224:227], v[8:11]
    v_mfma_f32_16x16x32_bf16 v[12:15], v[172:175], v[224:227], v[12:15]
    v_mfma_f32_16x16x32_bf16 v[0:3], v[200:203], v[228:231], v[0:3]
    v_mfma_f32_16x16x32_bf16 v[4:7], v[204:207], v[228:231], v[4:7]
    v_mfma_f32_16x16x32_bf16 v[8:11], v[192:195], v[228:231], v[8:11]
    v_mfma_f32_16x16x32_bf16 v[12:15], v[196:199], v[228:231], v[12:15]
    s_waitcnt lgkmcnt(2)
    v_mfma_f32_16x16x32_bf16 v[48:51], v[176:179], v[232:235], v[48:51]
    ds_read_b128 v[216:219], v250 offset:20480
    ds_read_b128 v[220:223], v250 offset:31744
    v_mfma_f32_16x16x32_bf16 v[52:55], v[180:183], v[232:235], v[52:55]
    v_mfma_f32_16x16x32_bf16 v[56:59], v[208:211], v[232:235], v[56:59]
    v_mfma_f32_16x16x32_bf16 v[60:63], v[212:215], v[232:235], v[60:63]
    v_mfma_f32_16x16x32_bf16 v[48:51], v[184:187], v[236:239], v[48:51]
    v_mfma_f32_16x16x32_bf16 v[52:55], v[188:191], v[236:239], v[52:55]
    v_mfma_f32_16x16x32_bf16 v[56:59], v[176:179], v[236:239], v[56:59]
    v_mfma_f32_16x16x32_bf16 v[60:63], v[180:183], v[236:239], v[60:63]
    s_waitcnt lgkmcnt(2)
    v_mfma_f32_16x16x32_bf16 v[16:19], v[192:195], v[240:243], v[16:19]
    ds_read_b128 v[224:227], v253 offset:18432
    ds_read_b128 v[228:231], v253 offset:29696
    v_mfma_f32_16x16x32_bf16 v[20:23], v[196:199], v[240:243], v[20:23]
    v_cvt_pk_bf16_f32 v4, v4, v5
    v_cvt_pk_bf16_f32 v5, v6, v7
    v_mfma_f32_16x16x32_bf16 v[24:27], v[168:171], v[240:243], v[24:27]
    v_cvt_pk_bf16_f32 v6, v0, v1
    v_cvt_pk_bf16_f32 v7, v2, v3
    v_mfma_f32_16x16x32_bf16 v[28:31], v[172:175], v[240:243], v[28:31]
    s_add_u32 s47, s48, 0
    buffer_store_dwordx4 v[4:7], v251, s[16:19], s47 offen sc1
    v_mfma_f32_16x16x32_bf16 v[16:19], v[200:203], v[244:247], v[16:19]
    v_cvt_pk_bf16_f32 v12, v12, v13
    v_cvt_pk_bf16_f32 v13, v14, v15
    v_mfma_f32_16x16x32_bf16 v[20:23], v[204:207], v[244:247], v[20:23]
    v_cvt_pk_bf16_f32 v14, v8, v9
    v_cvt_pk_bf16_f32 v15, v10, v11
    v_mfma_f32_16x16x32_bf16 v[24:27], v[192:195], v[244:247], v[24:27]
    s_add_u32 s47, s48, 11264
    buffer_store_dwordx4 v[12:15], v251, s[16:19], s47 offen sc1
    v_mfma_f32_16x16x32_bf16 v[28:31], v[196:199], v[244:247], v[28:31]
    s_waitcnt lgkmcnt(2)
    v_mfma_f32_16x16x32_bf16 v[64:67], v[176:179], v[216:219], v[64:67]
    ds_read_b128 v[232:235], v250 offset:21504
    ds_read_b128 v[236:239], v250 offset:32768
    v_mfma_f32_16x16x32_bf16 v[68:71], v[180:183], v[216:219], v[68:71]
    v_mfma_f32_16x16x32_bf16 v[72:75], v[208:211], v[216:219], v[72:75]
    v_mfma_f32_16x16x32_bf16 v[76:79], v[212:215], v[216:219], v[76:79]
    v_mfma_f32_16x16x32_bf16 v[64:67], v[184:187], v[220:223], v[64:67]
    v_mfma_f32_16x16x32_bf16 v[68:71], v[188:191], v[220:223], v[68:71]
    v_mfma_f32_16x16x32_bf16 v[72:75], v[176:179], v[220:223], v[72:75]
    v_mfma_f32_16x16x32_bf16 v[76:79], v[180:183], v[220:223], v[76:79]
    s_waitcnt lgkmcnt(2)
    v_mfma_f32_16x16x32_bf16 v[32:35], v[192:195], v[224:227], v[32:35]
    ds_read_b128 v[240:243], v253 offset:19456
    ds_read_b128 v[244:247], v253 offset:30720
    v_mfma_f32_16x16x32_bf16 v[36:39], v[196:199], v[224:227], v[36:39]
    v_cvt_pk_bf16_f32 v20, v20, v21
    v_cvt_pk_bf16_f32 v21, v22, v23
    v_mfma_f32_16x16x32_bf16 v[40:43], v[168:171], v[224:227], v[40:43]
    v_cvt_pk_bf16_f32 v22, v16, v17
    v_cvt_pk_bf16_f32 v23, v18, v19
    v_mfma_f32_16x16x32_bf16 v[44:47], v[172:175], v[224:227], v[44:47]
    s_add_u32 s47, s48, 1024
    buffer_store_dwordx4 v[20:23], v251, s[16:19], s47 offen sc1
    v_mfma_f32_16x16x32_bf16 v[32:35], v[200:203], v[228:231], v[32:35]
    v_cvt_pk_bf16_f32 v28, v28, v29
    v_cvt_pk_bf16_f32 v29, v30, v31
    v_mfma_f32_16x16x32_bf16 v[36:39], v[204:207], v[228:231], v[36:39]
    v_cvt_pk_bf16_f32 v30, v24, v25
    v_cvt_pk_bf16_f32 v31, v26, v27
    v_mfma_f32_16x16x32_bf16 v[40:43], v[192:195], v[228:231], v[40:43]
    s_add_u32 s47, s48, 12288
    buffer_store_dwordx4 v[28:31], v251, s[16:19], s47 offen sc1
    v_mfma_f32_16x16x32_bf16 v[44:47], v[196:199], v[228:231], v[44:47]
    s_waitcnt lgkmcnt(2)
    v_mfma_f32_16x16x32_bf16 v[80:83], v[176:179], v[232:235], v[80:83]
    ds_read_b128 v[216:219], v250 offset:22528
    ds_read_b128 v[220:223], v250 offset:33792
    v_mfma_f32_16x16x32_bf16 v[84:87], v[180:183], v[232:235], v[84:87]
    v_mfma_f32_16x16x32_bf16 v[88:91], v[208:211], v[232:235], v[88:91]
    v_mfma_f32_16x16x32_bf16 v[92:95], v[212:215], v[232:235], v[92:95]
    v_mfma_f32_16x16x32_bf16 v[80:83], v[184:187], v[236:239], v[80:83]
    v_mfma_f32_16x16x32_bf16 v[84:87], v[188:191], v[236:239], v[84:87]
    v_mfma_f32_16x16x32_bf16 v[88:91], v[176:179], v[236:239], v[88:91]
    v_mfma_f32_16x16x32_bf16 v[92:95], v[180:183], v[236:239], v[92:95]
    s_waitcnt lgkmcnt(2)
    v_mfma_f32_16x16x32_bf16 v[48:51], v[192:195], v[240:243], v[48:51]
    ds_read_b128 v[224:227], v253 offset:20480
    ds_read_b128 v[228:231], v253 offset:31744
    v_mfma_f32_16x16x32_bf16 v[52:55], v[196:199], v[240:243], v[52:55]
    v_cvt_pk_bf16_f32 v36, v36, v37
    v_cvt_pk_bf16_f32 v37, v38, v39
    v_mfma_f32_16x16x32_bf16 v[56:59], v[168:171], v[240:243], v[56:59]
    v_cvt_pk_bf16_f32 v38, v32, v33
    v_cvt_pk_bf16_f32 v39, v34, v35
    v_mfma_f32_16x16x32_bf16 v[60:63], v[172:175], v[240:243], v[60:63]
    s_add_u32 s47, s48, 2048
    buffer_store_dwordx4 v[36:39], v251, s[16:19], s47 offen sc1
    v_mfma_f32_16x16x32_bf16 v[48:51], v[200:203], v[244:247], v[48:51]
    v_cvt_pk_bf16_f32 v44, v44, v45
    v_cvt_pk_bf16_f32 v45, v46, v47
    v_mfma_f32_16x16x32_bf16 v[52:55], v[204:207], v[244:247], v[52:55]
    v_cvt_pk_bf16_f32 v46, v40, v41
    v_cvt_pk_bf16_f32 v47, v42, v43
    v_mfma_f32_16x16x32_bf16 v[56:59], v[192:195], v[244:247], v[56:59]
    s_add_u32 s47, s48, 13312
    buffer_store_dwordx4 v[44:47], v251, s[16:19], s47 offen sc1
    v_mfma_f32_16x16x32_bf16 v[60:63], v[196:199], v[244:247], v[60:63]
    s_waitcnt lgkmcnt(2)
    v_mfma_f32_16x16x32_bf16 v[96:99], v[176:179], v[216:219], v[96:99]
    ds_read_b128 v[232:235], v250 offset:23552
    ds_read_b128 v[236:239], v250 offset:34816
    v_mfma_f32_16x16x32_bf16 v[100:103], v[180:183], v[216:219], v[100:103]
    v_mfma_f32_16x16x32_bf16 v[104:107], v[208:211], v[216:219], v[104:107]
    v_mfma_f32_16x16x32_bf16 v[108:111], v[212:215], v[216:219], v[108:111]
    v_mfma_f32_16x16x32_bf16 v[96:99], v[184:187], v[220:223], v[96:99]
    v_mfma_f32_16x16x32_bf16 v[100:103], v[188:191], v[220:223], v[100:103]
    v_mfma_f32_16x16x32_bf16 v[104:107], v[176:179], v[220:223], v[104:107]
    v_mfma_f32_16x16x32_bf16 v[108:111], v[180:183], v[220:223], v[108:111]
    s_waitcnt lgkmcnt(2)
    v_mfma_f32_16x16x32_bf16 v[64:67], v[192:195], v[224:227], v[64:67]
    ds_read_b128 v[240:243], v253 offset:21504
    ds_read_b128 v[244:247], v253 offset:32768
    v_mfma_f32_16x16x32_bf16 v[68:71], v[196:199], v[224:227], v[68:71]
    v_cvt_pk_bf16_f32 v52, v52, v53
    v_cvt_pk_bf16_f32 v53, v54, v55
    v_mfma_f32_16x16x32_bf16 v[72:75], v[168:171], v[224:227], v[72:75]
    v_cvt_pk_bf16_f32 v54, v48, v49
    v_cvt_pk_bf16_f32 v55, v50, v51
    v_mfma_f32_16x16x32_bf16 v[76:79], v[172:175], v[224:227], v[76:79]
    s_add_u32 s47, s48, 3072
    buffer_store_dwordx4 v[52:55], v251, s[16:19], s47 offen sc1
    v_mfma_f32_16x16x32_bf16 v[64:67], v[200:203], v[228:231], v[64:67]
    v_cvt_pk_bf16_f32 v60, v60, v61
    v_cvt_pk_bf16_f32 v61, v62, v63
    v_mfma_f32_16x16x32_bf16 v[68:71], v[204:207], v[228:231], v[68:71]
    v_cvt_pk_bf16_f32 v62, v56, v57
    v_cvt_pk_bf16_f32 v63, v58, v59
    v_mfma_f32_16x16x32_bf16 v[72:75], v[192:195], v[228:231], v[72:75]
    s_add_u32 s47, s48, 14336
    buffer_store_dwordx4 v[60:63], v251, s[16:19], s47 offen sc1
    v_mfma_f32_16x16x32_bf16 v[76:79], v[196:199], v[228:231], v[76:79]
    s_waitcnt lgkmcnt(2)
    v_mfma_f32_16x16x32_bf16 v[112:115], v[176:179], v[232:235], v[112:115]
    ds_read_b128 v[216:219], v250 offset:24576
    ds_read_b128 v[220:223], v250 offset:35840
    v_mfma_f32_16x16x32_bf16 v[116:119], v[180:183], v[232:235], v[116:119]
    v_mfma_f32_16x16x32_bf16 v[120:123], v[208:211], v[232:235], v[120:123]
    v_mfma_f32_16x16x32_bf16 v[124:127], v[212:215], v[232:235], v[124:127]
    v_mfma_f32_16x16x32_bf16 v[112:115], v[184:187], v[236:239], v[112:115]
    v_mfma_f32_16x16x32_bf16 v[116:119], v[188:191], v[236:239], v[116:119]
    v_mfma_f32_16x16x32_bf16 v[120:123], v[176:179], v[236:239], v[120:123]
    v_mfma_f32_16x16x32_bf16 v[124:127], v[180:183], v[236:239], v[124:127]
    s_waitcnt lgkmcnt(2)
    v_mfma_f32_16x16x32_bf16 v[80:83], v[192:195], v[240:243], v[80:83]
    ds_read_b128 v[224:227], v253 offset:22528
    ds_read_b128 v[228:231], v253 offset:33792
    v_mfma_f32_16x16x32_bf16 v[84:87], v[196:199], v[240:243], v[84:87]
    v_cvt_pk_bf16_f32 v68, v68, v69
    v_cvt_pk_bf16_f32 v69, v70, v71
    v_mfma_f32_16x16x32_bf16 v[88:91], v[168:171], v[240:243], v[88:91]
    v_cvt_pk_bf16_f32 v70, v64, v65
    v_cvt_pk_bf16_f32 v71, v66, v67
    v_mfma_f32_16x16x32_bf16 v[92:95], v[172:175], v[240:243], v[92:95]
    s_add_u32 s47, s48, 4096
    buffer_store_dwordx4 v[68:71], v251, s[16:19], s47 offen sc1
    v_mfma_f32_16x16x32_bf16 v[80:83], v[200:203], v[244:247], v[80:83]
    v_cvt_pk_bf16_f32 v76, v76, v77
    v_cvt_pk_bf16_f32 v77, v78, v79
    v_mfma_f32_16x16x32_bf16 v[84:87], v[204:207], v[244:247], v[84:87]
    v_cvt_pk_bf16_f32 v78, v72, v73
    v_cvt_pk_bf16_f32 v79, v74, v75
    v_mfma_f32_16x16x32_bf16 v[88:91], v[192:195], v[244:247], v[88:91]
    s_add_u32 s47, s48, 15360
    buffer_store_dwordx4 v[76:79], v251, s[16:19], s47 offen sc1
    v_mfma_f32_16x16x32_bf16 v[92:95], v[196:199], v[244:247], v[92:95]
    s_waitcnt lgkmcnt(2)
    v_mfma_f32_16x16x32_bf16 v[128:131], v[176:179], v[216:219], v[128:131]
    ds_read_b128 v[232:235], v250 offset:25600
    ds_read_b128 v[236:239], v250 offset:36864
    v_mfma_f32_16x16x32_bf16 v[132:135], v[180:183], v[216:219], v[132:135]
    v_mfma_f32_16x16x32_bf16 v[136:139], v[208:211], v[216:219], v[136:139]
    v_mfma_f32_16x16x32_bf16 v[140:143], v[212:215], v[216:219], v[140:143]
    v_mfma_f32_16x16x32_bf16 v[128:131], v[184:187], v[220:223], v[128:131]
    v_mfma_f32_16x16x32_bf16 v[132:135], v[188:191], v[220:223], v[132:135]
    v_mfma_f32_16x16x32_bf16 v[136:139], v[176:179], v[220:223], v[136:139]
    v_mfma_f32_16x16x32_bf16 v[140:143], v[180:183], v[220:223], v[140:143]
    s_waitcnt lgkmcnt(2)
    v_mfma_f32_16x16x32_bf16 v[96:99], v[192:195], v[224:227], v[96:99]
    ds_read_b128 v[240:243], v253 offset:23552
    ds_read_b128 v[244:247], v253 offset:34816
    v_mfma_f32_16x16x32_bf16 v[100:103], v[196:199], v[224:227], v[100:103]
    v_cvt_pk_bf16_f32 v84, v84, v85
    v_cvt_pk_bf16_f32 v85, v86, v87
    v_mfma_f32_16x16x32_bf16 v[104:107], v[168:171], v[224:227], v[104:107]
    v_cvt_pk_bf16_f32 v86, v80, v81
    v_cvt_pk_bf16_f32 v87, v82, v83
    v_mfma_f32_16x16x32_bf16 v[108:111], v[172:175], v[224:227], v[108:111]
    s_add_u32 s47, s48, 5120
    buffer_store_dwordx4 v[84:87], v251, s[16:19], s47 offen sc1
    v_mfma_f32_16x16x32_bf16 v[96:99], v[200:203], v[228:231], v[96:99]
    v_cvt_pk_bf16_f32 v92, v92, v93
    v_cvt_pk_bf16_f32 v93, v94, v95
    v_mfma_f32_16x16x32_bf16 v[100:103], v[204:207], v[228:231], v[100:103]
    v_cvt_pk_bf16_f32 v94, v88, v89
    v_cvt_pk_bf16_f32 v95, v90, v91
    v_mfma_f32_16x16x32_bf16 v[104:107], v[192:195], v[228:231], v[104:107]
    s_add_u32 s47, s48, 16384
    buffer_store_dwordx4 v[92:95], v251, s[16:19], s47 offen sc1
    v_mfma_f32_16x16x32_bf16 v[108:111], v[196:199], v[228:231], v[108:111]
    s_waitcnt lgkmcnt(2)
    v_mfma_f32_16x16x32_bf16 v[144:147], v[176:179], v[232:235], v[144:147]
    ds_read_b128 v[216:219], v250 offset:26624
    ds_read_b128 v[220:223], v250 offset:37888
    v_mfma_f32_16x16x32_bf16 v[148:151], v[180:183], v[232:235], v[148:151]
    v_mfma_f32_16x16x32_bf16 v[152:155], v[208:211], v[232:235], v[152:155]
    v_mfma_f32_16x16x32_bf16 v[156:159], v[212:215], v[232:235], v[156:159]
    v_mfma_f32_16x16x32_bf16 v[144:147], v[184:187], v[236:239], v[144:147]
    v_mfma_f32_16x16x32_bf16 v[148:151], v[188:191], v[236:239], v[148:151]
    v_mfma_f32_16x16x32_bf16 v[152:155], v[176:179], v[236:239], v[152:155]
    v_mfma_f32_16x16x32_bf16 v[156:159], v[180:183], v[236:239], v[156:159]
    s_waitcnt lgkmcnt(2)
    v_mfma_f32_16x16x32_bf16 v[112:115], v[192:195], v[240:243], v[112:115]
    ds_read_b128 v[224:227], v253 offset:24576
    ds_read_b128 v[228:231], v253 offset:35840
    v_mfma_f32_16x16x32_bf16 v[116:119], v[196:199], v[240:243], v[116:119]
    v_cvt_pk_bf16_f32 v100, v100, v101
    v_cvt_pk_bf16_f32 v101, v102, v103
    v_mfma_f32_16x16x32_bf16 v[120:123], v[168:171], v[240:243], v[120:123]
    v_cvt_pk_bf16_f32 v102, v96, v97
    v_cvt_pk_bf16_f32 v103, v98, v99
    v_mfma_f32_16x16x32_bf16 v[124:127], v[172:175], v[240:243], v[124:127]
    s_add_u32 s47, s48, 6144
    buffer_store_dwordx4 v[100:103], v251, s[16:19], s47 offen sc1
    v_mfma_f32_16x16x32_bf16 v[112:115], v[200:203], v[244:247], v[112:115]
    v_cvt_pk_bf16_f32 v108, v108, v109
    v_cvt_pk_bf16_f32 v109, v110, v111
    v_mfma_f32_16x16x32_bf16 v[116:119], v[204:207], v[244:247], v[116:119]
    v_cvt_pk_bf16_f32 v110, v104, v105
    v_cvt_pk_bf16_f32 v111, v106, v107
    v_mfma_f32_16x16x32_bf16 v[120:123], v[192:195], v[244:247], v[120:123]
    s_add_u32 s47, s48, 17408
    buffer_store_dwordx4 v[108:111], v251, s[16:19], s47 offen sc1
    v_mfma_f32_16x16x32_bf16 v[124:127], v[196:199], v[244:247], v[124:127]
    s_waitcnt lgkmcnt(2)
    v_mfma_f32_16x16x32_bf16 v[160:163], v[176:179], v[216:219], v[160:163]
    ds_read_b128 v[232:235], v253 offset:25600
    ds_read_b128 v[236:239], v253 offset:36864
    v_mfma_f32_16x16x32_bf16 v[164:167], v[208:211], v[216:219], v[164:167]
    v_mfma_f32_16x16x32_bf16 v[160:163], v[184:187], v[220:223], v[160:163]
    v_mfma_f32_16x16x32_bf16 v[164:167], v[176:179], v[220:223], v[164:167]
    s_waitcnt lgkmcnt(2)
    v_mfma_f32_16x16x32_bf16 v[128:131], v[192:195], v[224:227], v[128:131]
    ds_read_b128 v[240:243], v253 offset:26624
    ds_read_b128 v[244:247], v253 offset:37888
    v_mfma_f32_16x16x32_bf16 v[132:135], v[196:199], v[224:227], v[132:135]
    v_cvt_pk_bf16_f32 v116, v116, v117
    v_cvt_pk_bf16_f32 v117, v118, v119
    v_mfma_f32_16x16x32_bf16 v[136:139], v[168:171], v[224:227], v[136:139]
    v_cvt_pk_bf16_f32 v118, v112, v113
    v_cvt_pk_bf16_f32 v119, v114, v115
    v_mfma_f32_16x16x32_bf16 v[140:143], v[172:175], v[224:227], v[140:143]
    s_add_u32 s47, s48, 7168
    buffer_store_dwordx4 v[116:119], v251, s[16:19], s47 offen sc1
    v_mfma_f32_16x16x32_bf16 v[128:131], v[200:203], v[228:231], v[128:131]
    v_cvt_pk_bf16_f32 v124, v124, v125
    v_cvt_pk_bf16_f32 v125, v126, v127
    v_mfma_f32_16x16x32_bf16 v[132:135], v[204:207], v[228:231], v[132:135]
    v_cvt_pk_bf16_f32 v126, v120, v121
    v_cvt_pk_bf16_f32 v127, v122, v123
    v_mfma_f32_16x16x32_bf16 v[136:139], v[192:195], v[228:231], v[136:139]
    s_add_u32 s47, s48, 18432
    buffer_store_dwordx4 v[124:127], v251, s[16:19], s47 offen sc1
    v_mfma_f32_16x16x32_bf16 v[140:143], v[196:199], v[228:231], v[140:143]
    s_waitcnt lgkmcnt(2)
    v_mfma_f32_16x16x32_bf16 v[144:147], v[192:195], v[232:235], v[144:147]
    v_mfma_f32_16x16x32_bf16 v[148:151], v[196:199], v[232:235], v[148:151]
    v_mfma_f32_16x16x32_bf16 v[152:155], v[168:171], v[232:235], v[152:155]
    v_mfma_f32_16x16x32_bf16 v[156:159], v[172:175], v[232:235], v[156:159]
    v_mfma_f32_16x16x32_bf16 v[144:147], v[200:203], v[236:239], v[144:147]
    v_mfma_f32_16x16x32_bf16 v[148:151], v[204:207], v[236:239], v[148:151]
    v_mfma_f32_16x16x32_bf16 v[152:155], v[192:195], v[236:239], v[152:155]
    v_mfma_f32_16x16x32_bf16 v[156:159], v[196:199], v[236:239], v[156:159]
    s_waitcnt lgkmcnt(0)
    v_mfma_f32_16x16x32_bf16 v[160:163], v[192:195], v[240:243], v[160:163]
    v_mfma_f32_16x16x32_bf16 v[164:167], v[168:171], v[240:243], v[164:167]
    v_cvt_pk_bf16_f32 v132, v132, v133
    v_cvt_pk_bf16_f32 v133, v134, v135
    v_mfma_f32_16x16x32_bf16 v[160:163], v[200:203], v[244:247], v[160:163]
    v_cvt_pk_bf16_f32 v134, v128, v129
    v_cvt_pk_bf16_f32 v135, v130, v131
    v_mfma_f32_16x16x32_bf16 v[164:167], v[192:195], v[244:247], v[164:167]
    s_add_u32 s47, s48, 8192
    buffer_store_dwordx4 v[132:135], v251, s[16:19], s47 offen sc1
    s_nop 7
    v_cvt_pk_bf16_f32 v140, v140, v141
    v_cvt_pk_bf16_f32 v141, v142, v143
    v_cvt_pk_bf16_f32 v142, v136, v137
    v_cvt_pk_bf16_f32 v143, v138, v139
    s_add_u32 s47, s48, 19456
    buffer_store_dwordx4 v[140:143], v251, s[16:19], s47 offen sc1
    v_cvt_pk_bf16_f32 v148, v148, v149
    v_cvt_pk_bf16_f32 v149, v150, v151
    v_cvt_pk_bf16_f32 v150, v144, v145
    v_cvt_pk_bf16_f32 v151, v146, v147
    s_add_u32 s47, s48, 9216
    buffer_store_dwordx4 v[148:151], v251, s[16:19], s47 offen sc1
    v_cvt_pk_bf16_f32 v156, v156, v157
    v_cvt_pk_bf16_f32 v157, v158, v159
    v_cvt_pk_bf16_f32 v158, v152, v153
    v_cvt_pk_bf16_f32 v159, v154, v155
    s_add_u32 s47, s48, 20480
    buffer_store_dwordx4 v[156:159], v251, s[16:19], s47 offen sc1
    v_cvt_pk_bf16_f32 v160, v160, v161
    v_cvt_pk_bf16_f32 v161, v162, v163
    s_add_u32 s47, s49, 0
    buffer_store_dwordx2 v[160:161], v252, s[16:19], s47 offen sc1
    v_cvt_pk_bf16_f32 v164, v164, v165
    v_cvt_pk_bf16_f32 v165, v166, v167
    s_add_u32 s47, s49, 11264
    buffer_store_dwordx2 v[164:165], v252, s[16:19], s47 offen sc1
L_epi_done:
    s_endpgm
L_k3_helper:
    s_mul_i32 s40, s11, 16384
    s_mul_i32 s20, s14, 16777216
    s_add_u32 s40, s40, s20
    s_mul_i32 s41, s11, 21504
    s_mul_i32 s20, s13, 22020096
    s_add_u32 s41, s41, s20
    s_add_u32 s41, s41, 67108864
    s_lshl_b32 s42, s15, 12
    s_mul_i32 s43, s15, 5632
    s_lshr_b32 s20, s15, 1
    s_lshl_b32 s21, s20, 9
    s_sub_u32 s21, s43, s21
    v_lshlrev_b32 v1, 4, v0
    v_lshlrev_b32 v1, 4, v0
    v_add_u32 v2, s21, v1
    s_add_u32 s22, s21, 4096
    v_add_u32 v5, s22, v1
    s_mov_b32 s44, s41
    s_bitcmp1_b32 s15, 0
    s_cbranch_scc0 L_six_even
    s_mul_i32 s22, s20, 10752
    s_add_u32 s22, s22, 9216
    v_lshrrev_b32 v5, 2, v0
    v_lshlrev_b32 v5, 6, v5
    v_and_b32 v3, 3, v0
    v_xor_b32 v3, 3, v3
    v_lshl_add_u32 v5, v3, 4, v5
    v_add_u32 v5, s22, v5
    s_mul_i32 s44, s11, 21504
    s_xor_b32 s22, s13, 1
    s_mul_i32 s22, s22, 22020096
    s_add_u32 s44, s44, s22
    s_add_u32 s44, s44, 67108864
L_six_even:
    s_mov_b32 s50, -1
    s_mov_b32 s51, 0
    v_add_u32 v1, s42, v1
    s_add_u32 s43, s43, 16384
    s_cmp_ge_u32 s2, 8
    s_cbranch_scc1 L_nozero
    s_cmp_lg_u32 s15, 0
    s_cbranch_scc1 L_nozero
    s_mul_i32 s20, s2, 8448
    s_add_u32 s20, s20, 147849216
    v_mov_b32 v3, 0
    v_lshlrev_b32 v4, 2, v0
    buffer_store_dword v3, v4, s[16:19], s20 offen
L_nozero:
    s_cmp_ge_u32 s2, 224
    s_cbranch_scc1 L_nofill
    s_cmp_lg_u32 s15, 1
    s_cbranch_scc1 L_nofill
    s_lshl_b32 s20, s2, 10
    s_add_u32 s20, s20, 146800640
    v_mov_b32 v8, -1
    v_mov_b32 v9, -1
    v_mov_b32 v10, -1
    v_mov_b32 v11, -1
    v_lshlrev_b32 v4, 4, v0
    buffer_store_dwordx4 v[8:11], v4, s[16:19], s20 offen
L_nofill:
    s_add_u32 m0, s42, 0
    s_nop 0
    buffer_load_dwordx4 v1, s[16:19], s40 offen offset:0 lds
    buffer_load_dwordx4 v1, s[16:19], s40 offen offset:1024 lds
    buffer_load_dwordx4 v1, s[16:19], s40 offen offset:2048 lds
    buffer_load_dwordx4 v1, s[16:19], s40 offen offset:3072 lds
    s_add_u32 s40, s40, 524288
    s_add_u32 m0, s43, 0
    s_nop 0
    buffer_load_dwordx4 v2, s[16:19], s41 offen offset:0 lds
    buffer_load_dwordx4 v2, s[16:19], s41 offen offset:1024 lds
    buffer_load_dwordx4 v2, s[16:19], s41 offen offset:2048 lds
    buffer_load_dwordx4 v2, s[16:19], s41 offen offset:3072 lds
    s_add_u32 m0, s43, 4096
    s_add_u32 s49, s41, 4096
    buffer_load_dwordx4 v2, s[16:19], s49 offen lds
    s_mov_b64 exec, s[50:51]
    buffer_load_dwordx4 v5, s[16:19], s44 offen offset:1024 lds
    s_mov_b64 exec, -1
    s_add_u32 s41, s41, 688128
    s_add_u32 s44, s44, 688128
    s_add_u32 m0, s42, 38912
    s_nop 0
    buffer_load_dwordx4 v1, s[16:19], s40 offen offset:0 lds
    buffer_load_dwordx4 v1, s[16:19], s40 offen offset:1024 lds
    buffer_load_dwordx4 v1, s[16:19], s40 offen offset:2048 lds
    buffer_load_dwordx4 v1, s[16:19], s40 offen offset:3072 lds
    s_add_u32 s40, s40, 524288
    s_add_u32 m0, s43, 38912
    s_nop 0
    buffer_load_dwordx4 v2, s[16:19], s41 offen offset:0 lds
    buffer_load_dwordx4 v2, s[16:19], s41 offen offset:1024 lds
    buffer_load_dwordx4 v2, s[16:19], s41 offen offset:2048 lds
    buffer_load_dwordx4 v2, s[16:19], s41 offen offset:3072 lds
    s_add_u32 m0, s43, 43008
    s_add_u32 s49, s41, 4096
    buffer_load_dwordx4 v2, s[16:19], s49 offen lds
    s_mov_b64 exec, s[50:51]
    buffer_load_dwordx4 v5, s[16:19], s44 offen offset:1024 lds
    s_mov_b64 exec, -1
    s_add_u32 s41, s41, 688128
    s_add_u32 s44, s44, 688128
    s_add_u32 m0, s42, 77824
    s_nop 0
    buffer_load_dwordx4 v1, s[16:19], s40 offen offset:0 lds
    buffer_load_dwordx4 v1, s[16:19], s40 offen offset:1024 lds
    buffer_load_dwordx4 v1, s[16:19], s40 offen offset:2048 lds
    buffer_load_dwordx4 v1, s[16:19], s40 offen offset:3072 lds
    s_add_u32 s40, s40, 524288
    s_add_u32 m0, s43, 77824
    s_nop 0
    buffer_load_dwordx4 v2, s[16:19], s41 offen offset:0 lds
    buffer_load_dwordx4 v2, s[16:19], s41 offen offset:1024 lds
    buffer_load_dwordx4 v2, s[16:19], s41 offen offset:2048 lds
    buffer_load_dwordx4 v2, s[16:19], s41 offen offset:3072 lds
    s_add_u32 m0, s43, 81920
    s_add_u32 s49, s41, 4096
    buffer_load_dwordx4 v2, s[16:19], s49 offen lds
    s_mov_b64 exec, s[50:51]
    buffer_load_dwordx4 v5, s[16:19], s44 offen offset:1024 lds
    s_mov_b64 exec, -1
    s_add_u32 s41, s41, 688128
    s_add_u32 s44, s44, 688128
    s_waitcnt vmcnt(20)
    s_barrier
    s_mov_b32 s46, 7
L_h_loop:
    s_waitcnt vmcnt(10)
    s_barrier
    s_add_u32 m0, s42, 116736
    s_nop 0
    buffer_load_dwordx4 v1, s[16:19], s40 offen offset:0 lds
    buffer_load_dwordx4 v1, s[16:19], s40 offen offset:1024 lds
    buffer_load_dwordx4 v1, s[16:19], s40 offen offset:2048 lds
    buffer_load_dwordx4 v1, s[16:19], s40 offen offset:3072 lds
    s_add_u32 s40, s40, 524288
    s_add_u32 m0, s43, 116736
    s_nop 0
    buffer_load_dwordx4 v2, s[16:19], s41 offen offset:0 lds
    buffer_load_dwordx4 v2, s[16:19], s41 offen offset:1024 lds
    buffer_load_dwordx4 v2, s[16:19], s41 offen offset:2048 lds
    buffer_load_dwordx4 v2, s[16:19], s41 offen offset:3072 lds
    s_add_u32 m0, s43, 120832
    s_add_u32 s49, s41, 4096
    buffer_load_dwordx4 v2, s[16:19], s49 offen lds
    s_mov_b64 exec, s[50:51]
    buffer_load_dwordx4 v5, s[16:19], s44 offen offset:1024 lds
    s_mov_b64 exec, -1
    s_add_u32 s41, s41, 688128
    s_add_u32 s44, s44, 688128
    s_waitcnt vmcnt(10)
    s_barrier
    s_add_u32 m0, s42, 0
    s_nop 0
    buffer_load_dwordx4 v1, s[16:19], s40 offen offset:0 lds
    buffer_load_dwordx4 v1, s[16:19], s40 offen offset:1024 lds
    buffer_load_dwordx4 v1, s[16:19], s40 offen offset:2048 lds
    buffer_load_dwordx4 v1, s[16:19], s40 offen offset:3072 lds
    s_add_u32 s40, s40, 524288
    s_add_u32 m0, s43, 0
    s_nop 0
    buffer_load_dwordx4 v2, s[16:19], s41 offen offset:0 lds
    buffer_load_dwordx4 v2, s[16:19], s41 offen offset:1024 lds
    buffer_load_dwordx4 v2, s[16:19], s41 offen offset:2048 lds
    buffer_load_dwordx4 v2, s[16:19], s41 offen offset:3072 lds
    s_add_u32 m0, s43, 4096
    s_add_u32 s49, s41, 4096
    buffer_load_dwordx4 v2, s[16:19], s49 offen lds
    s_mov_b64 exec, s[50:51]
    buffer_load_dwordx4 v5, s[16:19], s44 offen offset:1024 lds
    s_mov_b64 exec, -1
    s_add_u32 s41, s41, 688128
    s_add_u32 s44, s44, 688128
    s_waitcnt vmcnt(10)
    s_barrier
    s_add_u32 m0, s42, 38912
    s_nop 0
    buffer_load_dwordx4 v1, s[16:19], s40 offen offset:0 lds
    buffer_load_dwordx4 v1, s[16:19], s40 offen offset:1024 lds
    buffer_load_dwordx4 v1, s[16:19], s40 offen offset:2048 lds
    buffer_load_dwordx4 v1, s[16:19], s40 offen offset:3072 lds
    s_add_u32 s40, s40, 524288
    s_add_u32 m0, s43, 38912
    s_nop 0
    buffer_load_dwordx4 v2, s[16:19], s41 offen offset:0 lds
    buffer_load_dwordx4 v2, s[16:19], s41 offen offset:1024 lds
    buffer_load_dwordx4 v2, s[16:19], s41 offen offset:2048 lds
    buffer_load_dwordx4 v2, s[16:19], s41 offen offset:3072 lds
    s_add_u32 m0, s43, 43008
    s_add_u32 s49, s41, 4096
    buffer_load_dwordx4 v2, s[16:19], s49 offen lds
    s_mov_b64 exec, s[50:51]
    buffer_load_dwordx4 v5, s[16:19], s44 offen offset:1024 lds
    s_mov_b64 exec, -1
    s_add_u32 s41, s41, 688128
    s_add_u32 s44, s44, 688128
    s_waitcnt vmcnt(10)
    s_barrier
    s_add_u32 m0, s42, 77824
    s_nop 0
    buffer_load_dwordx4 v1, s[16:19], s40 offen offset:0 lds
    buffer_load_dwordx4 v1, s[16:19], s40 offen offset:1024 lds
    buffer_load_dwordx4 v1, s[16:19], s40 offen offset:2048 lds
    buffer_load_dwordx4 v1, s[16:19], s40 offen offset:3072 lds
    s_add_u32 s40, s40, 524288
    s_add_u32 m0, s43, 77824
    s_nop 0
    buffer_load_dwordx4 v2, s[16:19], s41 offen offset:0 lds
    buffer_load_dwordx4 v2, s[16:19], s41 offen offset:1024 lds
    buffer_load_dwordx4 v2, s[16:19], s41 offen offset:2048 lds
    buffer_load_dwordx4 v2, s[16:19], s41 offen offset:3072 lds
    s_add_u32 m0, s43, 81920
    s_add_u32 s49, s41, 4096
    buffer_load_dwordx4 v2, s[16:19], s49 offen lds
    s_mov_b64 exec, s[50:51]
    buffer_load_dwordx4 v5, s[16:19], s44 offen offset:1024 lds
    s_mov_b64 exec, -1
    s_add_u32 s41, s41, 688128
    s_add_u32 s44, s44, 688128
    s_sub_u32 s46, s46, 1
    s_cmp_lg_u32 s46, 0
    s_cbranch_scc1 L_h_loop
    s_waitcnt vmcnt(10)
    s_barrier
    s_add_u32 m0, s42, 116736
    s_nop 0
    buffer_load_dwordx4 v1, s[16:19], s40 offen offset:0 lds
    buffer_load_dwordx4 v1, s[16:19], s40 offen offset:1024 lds
    buffer_load_dwordx4 v1, s[16:19], s40 offen offset:2048 lds
    buffer_load_dwordx4 v1, s[16:19], s40 offen offset:3072 lds
    s_add_u32 s40, s40, 524288
    s_add_u32 m0, s43, 116736
    s_nop 0
    buffer_load_dwordx4 v2, s[16:19], s41 offen offset:0 lds
    buffer_load_dwordx4 v2, s[16:19], s41 offen offset:1024 lds
    buffer_load_dwordx4 v2, s[16:19], s41 offen offset:2048 lds
    buffer_load_dwordx4 v2, s[16:19], s41 offen offset:3072 lds
    s_add_u32 m0, s43, 120832
    s_add_u32 s49, s41, 4096
    buffer_load_dwordx4 v2, s[16:19], s49 offen lds
    s_mov_b64 exec, s[50:51]
    buffer_load_dwordx4 v5, s[16:19], s44 offen offset:1024 lds
    s_mov_b64 exec, -1
    s_add_u32 s41, s41, 688128
    s_add_u32 s44, s44, 688128
    s_waitcnt vmcnt(10)
    s_barrier
    s_waitcnt vmcnt(0)
    s_barrier
    s_endpgm
L_k3_end:
    s_endpgm
.globl final_kernel
.p2align 8
.type final_kernel,@function
final_kernel:
    s_cmp_ge_u32 s2, 224
    s_cbranch_scc1 L_k45_end
    s_load_dwordx2 s[8:9], s[0:1], 48
    s_load_dwordx4 s[4:7], s[0:1], 16
    s_load_dwordx2 s[28:29], s[0:1], 32
    v_lshrrev_b32 v204, 6, v0
    v_and_b32 v200, 63, v0
    v_readfirstlane_b32 s10, v204
    s_cmp_ge_u32 s2, 8
    s_cbranch_scc1 L_nopf45
    s_nop 1
    s_cmp_lg_u32 s10, 7
    s_cbranch_scc1 L_nopf45
    s_getpc_b64 s[60:61]
L_pf_k45:
    s_sub_u32 s60, s60, L_pf_k45-final_kernel
    s_subb_u32 s61, s61, 0
    v_mbcnt_lo_u32_b32 v112, -1, 0
    v_mbcnt_hi_u32_b32 v112, -1, v112
    v_lshlrev_b32 v112, 6, v112
    v_add_u32 v113, 0, v112
    v_min_u32 v113, L_code_end-final_kernel-4, v113
    v_mov_b32 v115, s61
    v_add_co_u32 v114, vcc, s60, v113
    s_nop 1
    v_addc_co_u32 v115, vcc, 0, v115, vcc
    global_load_dword v116, v[114:115], off
    v_add_u32 v113, 4096, v112
    v_min_u32 v113, L_code_end-final_kernel-4, v113
    v_mov_b32 v115, s61
    v_add_co_u32 v114, vcc, s60, v113
    s_nop 1
    v_addc_co_u32 v115, vcc, 0, v115, vcc
    global_load_dword v116, v[114:115], off
    v_add_u32 v113, 8192, v112
    v_min_u32 v113, L_code_end-final_kernel-4, v113
    v_mov_b32 v115, s61
    v_add_co_u32 v114, vcc, s60, v113
    s_nop 1
    v_addc_co_u32 v115, vcc, 0, v115, vcc
    global_load_dword v116, v[114:115], off
L_nopf45:
    v_lshlrev_b32 v214, 2, v0
    v_and_b32 v201, 15, v200
    v_lshrrev_b32 v202, 4, v200
    s_and_b32 s13, s2, 3
    s_lshr_b32 s12, s2, 2
    s_cmp_ge_u32 s12, 28
    s_cselect_b32 s11, 1, 0
    s_mul_i32 s15, s11, 28
    s_sub_u32 s12, s12, s15
    s_mul_i32 s14, s12, 6
    s_add_u32 s14, s14, s10
    s_mov_b32 s24, 90112
    v_mul_u32_u24 v203, s24, v202
    v_lshrrev_b32 v205, 2, v201
    s_mov_b32 s24, 720896
    v_mad_u32_u24 v203, v205, s24, v203
    v_and_b32 v205, 3, v201
    v_lshl_add_u32 v203, v205, 4, v203
    s_mul_i32 s24, s11, 11534336
    s_mul_i32 s25, s13, 2883584
    s_add_u32 s24, s24, s25
    s_lshl_b32 s25, s14, 6
    s_add_u32 s24, s24, s25
    s_add_u32 s24, s24, 117440512
    s_mov_b32 s30, 0x05040100
    s_mov_b32 s31, 0x07060302
    s_waitcnt lgkmcnt(0)
    s_mov_b32 s16, s8
    s_and_b32 s17, s9, 0xffff
    s_mov_b32 s18, 268435456
    s_mov_b32 s19, 0x00020000
    s_cmp_ge_u32 s10, 6
    s_cbranch_scc1 L_k45_gb
    s_add_u32 s25, s24, 0
    buffer_load_dwordx4 v[0:3], v203, s[16:19], s25 offen
    s_add_u32 s25, s24, 11264
    buffer_load_dwordx4 v[4:7], v203, s[16:19], s25 offen
    s_add_u32 s25, s24, 22528
    buffer_load_dwordx4 v[8:11], v203, s[16:19], s25 offen
    s_add_u32 s25, s24, 33792
    buffer_load_dwordx4 v[12:15], v203, s[16:19], s25 offen
    s_add_u32 s25, s24, 45056
    buffer_load_dwordx4 v[16:19], v203, s[16:19], s25 offen
    s_add_u32 s25, s24, 56320
    buffer_load_dwordx4 v[20:23], v203, s[16:19], s25 offen
    s_add_u32 s25, s24, 67584
    buffer_load_dwordx4 v[24:27], v203, s[16:19], s25 offen
    s_add_u32 s25, s24, 78848
    buffer_load_dwordx4 v[28:31], v203, s[16:19], s25 offen
    s_add_u32 s25, s24, 360448
    buffer_load_dwordx4 v[32:35], v203, s[16:19], s25 offen
    s_add_u32 s25, s24, 371712
    buffer_load_dwordx4 v[36:39], v203, s[16:19], s25 offen
    s_add_u32 s25, s24, 382976
    buffer_load_dwordx4 v[40:43], v203, s[16:19], s25 offen
    s_add_u32 s25, s24, 394240
    buffer_load_dwordx4 v[44:47], v203, s[16:19], s25 offen
    s_add_u32 s25, s24, 405504
    buffer_load_dwordx4 v[48:51], v203, s[16:19], s25 offen
    s_add_u32 s25, s24, 416768
    buffer_load_dwordx4 v[52:55], v203, s[16:19], s25 offen
    s_add_u32 s25, s24, 428032
    buffer_load_dwordx4 v[56:59], v203, s[16:19], s25 offen
    s_add_u32 s25, s24, 439296
    buffer_load_dwordx4 v[60:63], v203, s[16:19], s25 offen
    s_lshr_b32 s27, s10, 1
    s_and_b32 s33, s10, 1
    s_lshl_b32 s27, s27, 4
    v_add_u32 v204, s27, v201
    s_lshl_b32 s33, s33, 5
    s_add_u32 s33, s33, 1
    v_lshlrev_b32 v205, 3, v202
    v_add_u32 v205, s33, v205
    v_mul_u32_u24 v88, v205, v204
    v_add_u32 v89, 32, v88
    v_add_u32 v205, 2, v205
    v_mul_u32_u24 v90, v205, v204
    v_add_u32 v91, 32, v90
    v_add_u32 v205, 2, v205
    v_mul_u32_u24 v92, v205, v204
    v_add_u32 v93, 32, v92
    v_add_u32 v205, 2, v205
    v_mul_u32_u24 v94, v205, v204
    v_add_u32 v95, 32, v94
    v_and_b32 v88, 127, v88
    v_cvt_f32_u32 v88, v88
    v_mul_f32 v88, 0x3c000000, v88
    v_cos_f32 v88, v88
    v_and_b32 v89, 127, v89
    v_cvt_f32_u32 v89, v89
    v_mul_f32 v89, 0x3c000000, v89
    v_cos_f32 v89, v89
    v_and_b32 v90, 127, v90
    v_cvt_f32_u32 v90, v90
    v_mul_f32 v90, 0x3c000000, v90
    v_cos_f32 v90, v90
    v_and_b32 v91, 127, v91
    v_cvt_f32_u32 v91, v91
    v_mul_f32 v91, 0x3c000000, v91
    v_cos_f32 v91, v91
    v_and_b32 v92, 127, v92
    v_cvt_f32_u32 v92, v92
    v_mul_f32 v92, 0x3c000000, v92
    v_cos_f32 v92, v92
    v_and_b32 v93, 127, v93
    v_cvt_f32_u32 v93, v93
    v_mul_f32 v93, 0x3c000000, v93
    v_cos_f32 v93, v93
    v_and_b32 v94, 127, v94
    v_cvt_f32_u32 v94, v94
    v_mul_f32 v94, 0x3c000000, v94
    v_cos_f32 v94, v94
    v_and_b32 v95, 127, v95
    v_cvt_f32_u32 v95, v95
    v_mul_f32 v95, 0x3c000000, v95
    v_cos_f32 v95, v95
    v_mul_f32 v88, 0x3d000000, v88
    v_mul_f32 v89, 0x3d000000, v89
    v_mul_f32 v90, 0x3d000000, v90
    v_mul_f32 v91, 0x3d000000, v91
    v_mul_f32 v92, 0x3d000000, v92
    v_mul_f32 v93, 0x3d000000, v93
    v_mul_f32 v94, 0x3d000000, v94
    v_mul_f32 v95, 0x3d000000, v95
    v_cvt_pk_bf16_f32 v104, v88, v89
    v_cvt_pk_bf16_f32 v105, v90, v91
    v_cvt_pk_bf16_f32 v106, v92, v93
    v_cvt_pk_bf16_f32 v107, v94, v95
    s_lshl_b32 s26, s10, 10
    v_lshlrev_b32 v207, 4, v200
    v_add_u32 v207, s26, v207
    ds_write_b128 v207, v[104:107] offset:0
L_k45_gb:
    s_mov_b32 s20, s4
    s_and_b32 s21, s5, 0xffff
    s_mov_b32 s22, 1024
    s_mov_b32 s23, 0x00020000
    s_mov_b32 s36, s6
    s_and_b32 s37, s7, 0xffff
    s_mov_b32 s38, 1024
    s_mov_b32 s39, 0x00020000
    v_lshlrev_b32 v210, 4, v201
    s_lshl_b32 s25, s13, 8
    buffer_load_dwordx4 v[232:235], v210, s[20:23], s25 offen
    buffer_load_dwordx4 v[236:239], v210, s[36:39], s25 offen
    s_waitcnt lgkmcnt(0)
    s_barrier
    s_cmp_ge_u32 s10, 6
    s_cbranch_scc1 L_k45_red2
    v_lshlrev_b32 v207, 4, v200
    ds_read_b128 v[64:67], v207 offset:0
    ds_read_b128 v[68:71], v207 offset:1024
    ds_read_b128 v[72:75], v207 offset:2048
    ds_read_b128 v[76:79], v207 offset:3072
    ds_read_b128 v[80:83], v207 offset:4096
    ds_read_b128 v[84:87], v207 offset:5120
    s_cmp_ge_u32 s14, 167
    s_cbranch_scc1 L_k45_zero
    s_waitcnt lgkmcnt(0)
    s_cmp_lg_u32 s14, 166
    s_cbranch_scc1 L_k45_full
    v_cmp_gt_i32 vcc, 17, v201
    s_nop 1
    v_cndmask_b32 v64, 0, v64, vcc
    v_cndmask_b32 v65, 0, v65, vcc
    v_cndmask_b32 v66, 0, v66, vcc
    v_cndmask_b32 v67, 0, v67, vcc
    v_cndmask_b32 v68, 0, v68, vcc
    v_cndmask_b32 v69, 0, v69, vcc
    v_cndmask_b32 v70, 0, v70, vcc
    v_cndmask_b32 v71, 0, v71, vcc
    v_cmp_gt_i32 vcc, 1, v201
    s_nop 1
    v_cndmask_b32 v72, 0, v72, vcc
    v_cndmask_b32 v73, 0, v73, vcc
    v_cndmask_b32 v74, 0, v74, vcc
    v_cndmask_b32 v75, 0, v75, vcc
    v_cndmask_b32 v76, 0, v76, vcc
    v_cndmask_b32 v77, 0, v77, vcc
    v_cndmask_b32 v78, 0, v78, vcc
    v_cndmask_b32 v79, 0, v79, vcc
    v_cmp_gt_i32 vcc, 0, v201
    s_nop 1
    v_cndmask_b32 v80, 0, v80, vcc
    v_cndmask_b32 v81, 0, v81, vcc
    v_cndmask_b32 v82, 0, v82, vcc
    v_cndmask_b32 v83, 0, v83, vcc
    v_cndmask_b32 v84, 0, v84, vcc
    v_cndmask_b32 v85, 0, v85, vcc
    v_cndmask_b32 v86, 0, v86, vcc
    v_cndmask_b32 v87, 0, v87, vcc
L_k45_full:
    s_waitcnt vmcnt(2)
    v_perm_b32 v88, v4, v0, s30
    v_perm_b32 v89, v12, v8, s30
    v_perm_b32 v90, v20, v16, s30
    v_perm_b32 v91, v28, v24, s30
    v_perm_b32 v92, v4, v0, s31
    v_perm_b32 v93, v12, v8, s31
    v_perm_b32 v94, v20, v16, s31
    v_perm_b32 v95, v28, v24, s31
    v_perm_b32 v96, v36, v32, s30
    v_perm_b32 v97, v44, v40, s30
    v_perm_b32 v98, v52, v48, s30
    v_perm_b32 v99, v60, v56, s30
    v_perm_b32 v100, v36, v32, s31
    v_perm_b32 v101, v44, v40, s31
    v_perm_b32 v102, v52, v48, s31
    v_perm_b32 v103, v60, v56, s31
    v_mfma_f32_16x16x32_bf16 v[104:107], v[64:67], v[88:91], 0
    v_mfma_f32_16x16x32_bf16 v[108:111], v[64:67], v[92:95], 0
    v_mfma_f32_16x16x32_bf16 v[136:139], v[72:75], v[88:91], 0
    v_mfma_f32_16x16x32_bf16 v[140:143], v[72:75], v[92:95], 0
    v_mfma_f32_16x16x32_bf16 v[168:171], v[80:83], v[88:91], 0
    v_mfma_f32_16x16x32_bf16 v[172:175], v[80:83], v[92:95], 0
    v_mfma_f32_16x16x32_bf16 v[104:107], v[68:71], v[96:99], v[104:107]
    v_mfma_f32_16x16x32_bf16 v[108:111], v[68:71], v[100:103], v[108:111]
    v_mfma_f32_16x16x32_bf16 v[136:139], v[76:79], v[96:99], v[136:139]
    v_mfma_f32_16x16x32_bf16 v[140:143], v[76:79], v[100:103], v[140:143]
    v_mfma_f32_16x16x32_bf16 v[168:171], v[84:87], v[96:99], v[168:171]
    v_mfma_f32_16x16x32_bf16 v[172:175], v[84:87], v[100:103], v[172:175]
    v_perm_b32 v88, v5, v1, s30
    v_perm_b32 v89, v13, v9, s30
    v_perm_b32 v90, v21, v17, s30
    v_perm_b32 v91, v29, v25, s30
    v_perm_b32 v92, v5, v1, s31
    v_perm_b32 v93, v13, v9, s31
    v_perm_b32 v94, v21, v17, s31
    v_perm_b32 v95, v29, v25, s31
    v_perm_b32 v96, v37, v33, s30
    v_perm_b32 v97, v45, v41, s30
    v_perm_b32 v98, v53, v49, s30
    v_perm_b32 v99, v61, v57, s30
    v_perm_b32 v100, v37, v33, s31
    v_perm_b32 v101, v45, v41, s31
    v_perm_b32 v102, v53, v49, s31
    v_perm_b32 v103, v61, v57, s31
    v_mfma_f32_16x16x32_bf16 v[112:115], v[64:67], v[88:91], 0
    v_mfma_f32_16x16x32_bf16 v[116:119], v[64:67], v[92:95], 0
    v_mfma_f32_16x16x32_bf16 v[144:147], v[72:75], v[88:91], 0
    v_mfma_f32_16x16x32_bf16 v[148:151], v[72:75], v[92:95], 0
    v_mfma_f32_16x16x32_bf16 v[176:179], v[80:83], v[88:91], 0
    v_mfma_f32_16x16x32_bf16 v[180:183], v[80:83], v[92:95], 0
    v_mfma_f32_16x16x32_bf16 v[112:115], v[68:71], v[96:99], v[112:115]
    v_mfma_f32_16x16x32_bf16 v[116:119], v[68:71], v[100:103], v[116:119]
    v_mfma_f32_16x16x32_bf16 v[144:147], v[76:79], v[96:99], v[144:147]
    v_mfma_f32_16x16x32_bf16 v[148:151], v[76:79], v[100:103], v[148:151]
    v_mfma_f32_16x16x32_bf16 v[176:179], v[84:87], v[96:99], v[176:179]
    v_mfma_f32_16x16x32_bf16 v[180:183], v[84:87], v[100:103], v[180:183]
    v_perm_b32 v88, v6, v2, s30
    v_perm_b32 v89, v14, v10, s30
    v_perm_b32 v90, v22, v18, s30
    v_perm_b32 v91, v30, v26, s30
    v_perm_b32 v92, v6, v2, s31
    v_perm_b32 v93, v14, v10, s31
    v_perm_b32 v94, v22, v18, s31
    v_perm_b32 v95, v30, v26, s31
    v_perm_b32 v96, v38, v34, s30
    v_perm_b32 v97, v46, v42, s30
    v_perm_b32 v98, v54, v50, s30
    v_perm_b32 v99, v62, v58, s30
    v_perm_b32 v100, v38, v34, s31
    v_perm_b32 v101, v46, v42, s31
    v_perm_b32 v102, v54, v50, s31
    v_perm_b32 v103, v62, v58, s31
    v_mfma_f32_16x16x32_bf16 v[120:123], v[64:67], v[88:91], 0
    v_mfma_f32_16x16x32_bf16 v[124:127], v[64:67], v[92:95], 0
    v_mfma_f32_16x16x32_bf16 v[152:155], v[72:75], v[88:91], 0
    v_mfma_f32_16x16x32_bf16 v[156:159], v[72:75], v[92:95], 0
    v_mfma_f32_16x16x32_bf16 v[184:187], v[80:83], v[88:91], 0
    v_mfma_f32_16x16x32_bf16 v[188:191], v[80:83], v[92:95], 0
    v_mfma_f32_16x16x32_bf16 v[120:123], v[68:71], v[96:99], v[120:123]
    v_mfma_f32_16x16x32_bf16 v[124:127], v[68:71], v[100:103], v[124:127]
    v_mfma_f32_16x16x32_bf16 v[152:155], v[76:79], v[96:99], v[152:155]
    v_mfma_f32_16x16x32_bf16 v[156:159], v[76:79], v[100:103], v[156:159]
    v_mfma_f32_16x16x32_bf16 v[184:187], v[84:87], v[96:99], v[184:187]
    v_mfma_f32_16x16x32_bf16 v[188:191], v[84:87], v[100:103], v[188:191]
    v_perm_b32 v88, v7, v3, s30
    v_perm_b32 v89, v15, v11, s30
    v_perm_b32 v90, v23, v19, s30
    v_perm_b32 v91, v31, v27, s30
    v_perm_b32 v92, v7, v3, s31
    v_perm_b32 v93, v15, v11, s31
    v_perm_b32 v94, v23, v19, s31
    v_perm_b32 v95, v31, v27, s31
    v_perm_b32 v96, v39, v35, s30
    v_perm_b32 v97, v47, v43, s30
    v_perm_b32 v98, v55, v51, s30
    v_perm_b32 v99, v63, v59, s30
    v_perm_b32 v100, v39, v35, s31
    v_perm_b32 v101, v47, v43, s31
    v_perm_b32 v102, v55, v51, s31
    v_perm_b32 v103, v63, v59, s31
    v_mfma_f32_16x16x32_bf16 v[128:131], v[64:67], v[88:91], 0
    v_mfma_f32_16x16x32_bf16 v[132:135], v[64:67], v[92:95], 0
    v_mfma_f32_16x16x32_bf16 v[160:163], v[72:75], v[88:91], 0
    v_mfma_f32_16x16x32_bf16 v[164:167], v[72:75], v[92:95], 0
    v_mfma_f32_16x16x32_bf16 v[192:195], v[80:83], v[88:91], 0
    v_mfma_f32_16x16x32_bf16 v[196:199], v[80:83], v[92:95], 0
    v_mfma_f32_16x16x32_bf16 v[128:131], v[68:71], v[96:99], v[128:131]
    v_mfma_f32_16x16x32_bf16 v[132:135], v[68:71], v[100:103], v[132:135]
    v_mfma_f32_16x16x32_bf16 v[160:163], v[76:79], v[96:99], v[160:163]
    v_mfma_f32_16x16x32_bf16 v[164:167], v[76:79], v[100:103], v[164:167]
    v_mfma_f32_16x16x32_bf16 v[192:195], v[84:87], v[96:99], v[192:195]
    v_mfma_f32_16x16x32_bf16 v[196:199], v[84:87], v[100:103], v[196:199]
    s_nop 7
    v_mul_f32 v224, v104, v104
    v_mov_b32 v216, v104
    v_fmac_f32 v224, v105, v105
    v_add_f32 v216, v216, v105
    v_fmac_f32 v224, v106, v106
    v_add_f32 v216, v216, v106
    v_fmac_f32 v224, v107, v107
    v_add_f32 v216, v216, v107
    v_fmac_f32 v224, v136, v136
    v_add_f32 v216, v216, v136
    v_fmac_f32 v224, v137, v137
    v_add_f32 v216, v216, v137
    v_fmac_f32 v224, v138, v138
    v_add_f32 v216, v216, v138
    v_fmac_f32 v224, v139, v139
    v_add_f32 v216, v216, v139
    v_fmac_f32 v224, v168, v168
    v_add_f32 v216, v216, v168
    v_fmac_f32 v224, v169, v169
    v_add_f32 v216, v216, v169
    v_fmac_f32 v224, v170, v170
    v_add_f32 v216, v216, v170
    v_fmac_f32 v224, v171, v171
    v_add_f32 v216, v216, v171
    v_mul_f32 v225, v108, v108
    v_mov_b32 v217, v108
    v_fmac_f32 v225, v109, v109
    v_add_f32 v217, v217, v109
    v_fmac_f32 v225, v110, v110
    v_add_f32 v217, v217, v110
    v_fmac_f32 v225, v111, v111
    v_add_f32 v217, v217, v111
    v_fmac_f32 v225, v140, v140
    v_add_f32 v217, v217, v140
    v_fmac_f32 v225, v141, v141
    v_add_f32 v217, v217, v141
    v_fmac_f32 v225, v142, v142
    v_add_f32 v217, v217, v142
    v_fmac_f32 v225, v143, v143
    v_add_f32 v217, v217, v143
    v_fmac_f32 v225, v172, v172
    v_add_f32 v217, v217, v172
    v_fmac_f32 v225, v173, v173
    v_add_f32 v217, v217, v173
    v_fmac_f32 v225, v174, v174
    v_add_f32 v217, v217, v174
    v_fmac_f32 v225, v175, v175
    v_add_f32 v217, v217, v175
    v_mul_f32 v226, v112, v112
    v_mov_b32 v218, v112
    v_fmac_f32 v226, v113, v113
    v_add_f32 v218, v218, v113
    v_fmac_f32 v226, v114, v114
    v_add_f32 v218, v218, v114
    v_fmac_f32 v226, v115, v115
    v_add_f32 v218, v218, v115
    v_fmac_f32 v226, v144, v144
    v_add_f32 v218, v218, v144
    v_fmac_f32 v226, v145, v145
    v_add_f32 v218, v218, v145
    v_fmac_f32 v226, v146, v146
    v_add_f32 v218, v218, v146
    v_fmac_f32 v226, v147, v147
    v_add_f32 v218, v218, v147
    v_fmac_f32 v226, v176, v176
    v_add_f32 v218, v218, v176
    v_fmac_f32 v226, v177, v177
    v_add_f32 v218, v218, v177
    v_fmac_f32 v226, v178, v178
    v_add_f32 v218, v218, v178
    v_fmac_f32 v226, v179, v179
    v_add_f32 v218, v218, v179
    v_mul_f32 v227, v116, v116
    v_mov_b32 v219, v116
    v_fmac_f32 v227, v117, v117
    v_add_f32 v219, v219, v117
    v_fmac_f32 v227, v118, v118
    v_add_f32 v219, v219, v118
    v_fmac_f32 v227, v119, v119
    v_add_f32 v219, v219, v119
    v_fmac_f32 v227, v148, v148
    v_add_f32 v219, v219, v148
    v_fmac_f32 v227, v149, v149
    v_add_f32 v219, v219, v149
    v_fmac_f32 v227, v150, v150
    v_add_f32 v219, v219, v150
    v_fmac_f32 v227, v151, v151
    v_add_f32 v219, v219, v151
    v_fmac_f32 v227, v180, v180
    v_add_f32 v219, v219, v180
    v_fmac_f32 v227, v181, v181
    v_add_f32 v219, v219, v181
    v_fmac_f32 v227, v182, v182
    v_add_f32 v219, v219, v182
    v_fmac_f32 v227, v183, v183
    v_add_f32 v219, v219, v183
    v_mul_f32 v228, v120, v120
    v_mov_b32 v220, v120
    v_fmac_f32 v228, v121, v121
    v_add_f32 v220, v220, v121
    v_fmac_f32 v228, v122, v122
    v_add_f32 v220, v220, v122
    v_fmac_f32 v228, v123, v123
    v_add_f32 v220, v220, v123
    v_fmac_f32 v228, v152, v152
    v_add_f32 v220, v220, v152
    v_fmac_f32 v228, v153, v153
    v_add_f32 v220, v220, v153
    v_fmac_f32 v228, v154, v154
    v_add_f32 v220, v220, v154
    v_fmac_f32 v228, v155, v155
    v_add_f32 v220, v220, v155
    v_fmac_f32 v228, v184, v184
    v_add_f32 v220, v220, v184
    v_fmac_f32 v228, v185, v185
    v_add_f32 v220, v220, v185
    v_fmac_f32 v228, v186, v186
    v_add_f32 v220, v220, v186
    v_fmac_f32 v228, v187, v187
    v_add_f32 v220, v220, v187
    v_mul_f32 v229, v124, v124
    v_mov_b32 v221, v124
    v_fmac_f32 v229, v125, v125
    v_add_f32 v221, v221, v125
    v_fmac_f32 v229, v126, v126
    v_add_f32 v221, v221, v126
    v_fmac_f32 v229, v127, v127
    v_add_f32 v221, v221, v127
    v_fmac_f32 v229, v156, v156
    v_add_f32 v221, v221, v156
    v_fmac_f32 v229, v157, v157
    v_add_f32 v221, v221, v157
    v_fmac_f32 v229, v158, v158
    v_add_f32 v221, v221, v158
    v_fmac_f32 v229, v159, v159
    v_add_f32 v221, v221, v159
    v_fmac_f32 v229, v188, v188
    v_add_f32 v221, v221, v188
    v_fmac_f32 v229, v189, v189
    v_add_f32 v221, v221, v189
    v_fmac_f32 v229, v190, v190
    v_add_f32 v221, v221, v190
    v_fmac_f32 v229, v191, v191
    v_add_f32 v221, v221, v191
    v_mul_f32 v230, v128, v128
    v_mov_b32 v222, v128
    v_fmac_f32 v230, v129, v129
    v_add_f32 v222, v222, v129
    v_fmac_f32 v230, v130, v130
    v_add_f32 v222, v222, v130
    v_fmac_f32 v230, v131, v131
    v_add_f32 v222, v222, v131
    v_fmac_f32 v230, v160, v160
    v_add_f32 v222, v222, v160
    v_fmac_f32 v230, v161, v161
    v_add_f32 v222, v222, v161
    v_fmac_f32 v230, v162, v162
    v_add_f32 v222, v222, v162
    v_fmac_f32 v230, v163, v163
    v_add_f32 v222, v222, v163
    v_fmac_f32 v230, v192, v192
    v_add_f32 v222, v222, v192
    v_fmac_f32 v230, v193, v193
    v_add_f32 v222, v222, v193
    v_fmac_f32 v230, v194, v194
    v_add_f32 v222, v222, v194
    v_fmac_f32 v230, v195, v195
    v_add_f32 v222, v222, v195
    v_mul_f32 v231, v132, v132
    v_mov_b32 v223, v132
    v_fmac_f32 v231, v133, v133
    v_add_f32 v223, v223, v133
    v_fmac_f32 v231, v134, v134
    v_add_f32 v223, v223, v134
    v_fmac_f32 v231, v135, v135
    v_add_f32 v223, v223, v135
    v_fmac_f32 v231, v164, v164
    v_add_f32 v223, v223, v164
    v_fmac_f32 v231, v165, v165
    v_add_f32 v223, v223, v165
    v_fmac_f32 v231, v166, v166
    v_add_f32 v223, v223, v166
    v_fmac_f32 v231, v167, v167
    v_add_f32 v223, v223, v167
    v_fmac_f32 v231, v196, v196
    v_add_f32 v223, v223, v196
    v_fmac_f32 v231, v197, v197
    v_add_f32 v223, v223, v197
    v_fmac_f32 v231, v198, v198
    v_add_f32 v223, v223, v198
    v_fmac_f32 v231, v199, v199
    v_add_f32 v223, v223, v199
    s_branch L_k45_red
L_k45_zero:
    s_waitcnt vmcnt(0) lgkmcnt(0)
    v_mov_b32 v216, 0
    v_mov_b32 v224, 0
    v_mov_b32 v217, 0
    v_mov_b32 v225, 0
    v_mov_b32 v218, 0
    v_mov_b32 v226, 0
    v_mov_b32 v219, 0
    v_mov_b32 v227, 0
    v_mov_b32 v220, 0
    v_mov_b32 v228, 0
    v_mov_b32 v221, 0
    v_mov_b32 v229, 0
    v_mov_b32 v222, 0
    v_mov_b32 v230, 0
    v_mov_b32 v223, 0
    v_mov_b32 v231, 0
L_k45_red:
    s_lshl_b32 s25, s10, 12
    v_lshlrev_b32 v204, 10, v202
    v_lshl_add_u32 v204, v201, 5, v204
    v_add_u32 v204, s25, v204
    ds_write_b128 v204, v[216:219] offset:8192
    ds_write_b128 v204, v[220:223] offset:8208
    ds_write_b128 v204, v[224:227] offset:8704
    ds_write_b128 v204, v[228:231] offset:8720
    s_lshl_b32 s25, s10, 13
    v_lshlrev_b32 v205, 4, v200
    v_add_u32 v205, s25, v205
    ds_write_b96 v205, v[168:170] offset:33792
    ds_write_b96 v205, v[172:174] offset:34816
    ds_write_b96 v205, v[176:178] offset:35840
    ds_write_b96 v205, v[180:182] offset:36864
    ds_write_b96 v205, v[184:186] offset:37888
    ds_write_b96 v205, v[188:190] offset:38912
    ds_write_b96 v205, v[192:194] offset:39936
    ds_write_b96 v205, v[196:198] offset:40960
L_k45_red2:
    s_waitcnt lgkmcnt(0)
    s_barrier
    s_mul_i32 s24, s11, 112
    s_mul_i32 s25, s13, 28
    s_add_u32 s24, s24, s25
    s_lshl_b32 s26, s24, 10
    s_add_u32 s26, s26, 146800640
    s_cmp_ge_u32 s10, 6
    s_cbranch_scc1 L_k45_hread
    s_cmp_ge_u32 s10, 4
    s_cbranch_scc1 L_k45_sumdone
    ds_read_b32 v16, v214 offset:8192
    ds_read_b32 v17, v214 offset:9216
    ds_read_b32 v18, v214 offset:10240
    ds_read_b32 v19, v214 offset:11264
    ds_read_b32 v20, v214 offset:12288
    ds_read_b32 v21, v214 offset:13312
    ds_read_b32 v22, v214 offset:14336
    ds_read_b32 v23, v214 offset:15360
    ds_read_b32 v24, v214 offset:16384
    ds_read_b32 v25, v214 offset:17408
    ds_read_b32 v26, v214 offset:18432
    ds_read_b32 v27, v214 offset:19456
    ds_read_b32 v28, v214 offset:20480
    ds_read_b32 v29, v214 offset:21504
    ds_read_b32 v30, v214 offset:22528
    ds_read_b32 v31, v214 offset:23552
    ds_read_b32 v32, v214 offset:24576
    ds_read_b32 v33, v214 offset:25600
    ds_read_b32 v34, v214 offset:26624
    ds_read_b32 v35, v214 offset:27648
    ds_read_b32 v36, v214 offset:28672
    ds_read_b32 v37, v214 offset:29696
    ds_read_b32 v38, v214 offset:30720
    ds_read_b32 v39, v214 offset:31744
    s_waitcnt lgkmcnt(0)
    v_add_f32 v16, v16, v17
    v_add_f32 v18, v18, v19
    v_add_f32 v20, v20, v21
    v_add_f32 v22, v22, v23
    v_add_f32 v24, v24, v25
    v_add_f32 v26, v26, v27
    v_add_f32 v28, v28, v29
    v_add_f32 v30, v30, v31
    v_add_f32 v32, v32, v33
    v_add_f32 v34, v34, v35
    v_add_f32 v36, v36, v37
    v_add_f32 v38, v38, v39
    v_add_f32 v16, v16, v18
    v_add_f32 v20, v20, v22
    v_add_f32 v24, v24, v26
    v_add_f32 v28, v28, v30
    v_add_f32 v32, v32, v34
    v_add_f32 v36, v36, v38
    v_add_f32 v16, v16, v20
    v_add_f32 v24, v24, v28
    v_add_f32 v32, v32, v36
    v_add_f32 v16, v16, v24
    v_add_f32 v16, v16, v32
    s_lshl_b32 s24, s12, 10
    s_add_u32 s24, s24, s26
    buffer_store_dword v16, v214, s[16:19], s24 offen sc1
    s_mov_b32 s33, 16384
L_k45_poll:
    s_mov_b32 s27, s26
    buffer_load_dword v0, v214, s[16:19], s27 offen offset:0 sc1
    buffer_load_dword v1, v214, s[16:19], s27 offen offset:1024 sc1
    buffer_load_dword v2, v214, s[16:19], s27 offen offset:2048 sc1
    buffer_load_dword v3, v214, s[16:19], s27 offen offset:3072 sc1
    s_add_u32 s27, s27, 4096
    buffer_load_dword v4, v214, s[16:19], s27 offen offset:0 sc1
    buffer_load_dword v5, v214, s[16:19], s27 offen offset:1024 sc1
    buffer_load_dword v6, v214, s[16:19], s27 offen offset:2048 sc1
    buffer_load_dword v7, v214, s[16:19], s27 offen offset:3072 sc1
    s_add_u32 s27, s27, 4096
    buffer_load_dword v8, v214, s[16:19], s27 offen offset:0 sc1
    buffer_load_dword v9, v214, s[16:19], s27 offen offset:1024 sc1
    buffer_load_dword v10, v214, s[16:19], s27 offen offset:2048 sc1
    buffer_load_dword v11, v214, s[16:19], s27 offen offset:3072 sc1
    s_add_u32 s27, s27, 4096
    buffer_load_dword v12, v214, s[16:19], s27 offen offset:0 sc1
    buffer_load_dword v13, v214, s[16:19], s27 offen offset:1024 sc1
    buffer_load_dword v14, v214, s[16:19], s27 offen offset:2048 sc1
    buffer_load_dword v15, v214, s[16:19], s27 offen offset:3072 sc1
    s_add_u32 s27, s27, 4096
    buffer_load_dword v16, v214, s[16:19], s27 offen offset:0 sc1
    buffer_load_dword v17, v214, s[16:19], s27 offen offset:1024 sc1
    buffer_load_dword v18, v214, s[16:19], s27 offen offset:2048 sc1
    buffer_load_dword v19, v214, s[16:19], s27 offen offset:3072 sc1
    s_add_u32 s27, s27, 4096
    buffer_load_dword v20, v214, s[16:19], s27 offen offset:0 sc1
    buffer_load_dword v21, v214, s[16:19], s27 offen offset:1024 sc1
    buffer_load_dword v22, v214, s[16:19], s27 offen offset:2048 sc1
    buffer_load_dword v23, v214, s[16:19], s27 offen offset:3072 sc1
    s_add_u32 s27, s27, 4096
    buffer_load_dword v24, v214, s[16:19], s27 offen offset:0 sc1
    buffer_load_dword v25, v214, s[16:19], s27 offen offset:1024 sc1
    buffer_load_dword v26, v214, s[16:19], s27 offen offset:2048 sc1
    buffer_load_dword v27, v214, s[16:19], s27 offen offset:3072 sc1
    s_waitcnt vmcnt(0)
    v_max3_u32 v32, v0, v1, v2
    v_max3_u32 v32, v32, v3, v4
    v_max3_u32 v32, v32, v5, v6
    v_max3_u32 v32, v32, v7, v8
    v_max3_u32 v32, v32, v9, v10
    v_max3_u32 v32, v32, v11, v12
    v_max3_u32 v32, v32, v13, v14
    v_max3_u32 v32, v32, v15, v16
    v_max3_u32 v32, v32, v17, v18
    v_max3_u32 v32, v32, v19, v20
    v_max3_u32 v32, v32, v21, v22
    v_max3_u32 v32, v32, v23, v24
    v_max3_u32 v32, v32, v25, v26
    v_max_u32 v32, v32, v27
    v_cmp_eq_u32 vcc, -1, v32
    s_nop 3
    s_cmp_eq_u64 vcc, 0
    s_cbranch_scc1 L_k45_got
    s_sub_u32 s33, s33, 1
    s_cmp_eq_u32 s33, 0
    s_cbranch_scc1 L_k45_got
    s_sleep 2
    s_branch L_k45_poll
L_k45_got:
    v_add_f32 v0, v0, v1
    v_add_f32 v2, v2, v3
    v_add_f32 v4, v4, v5
    v_add_f32 v6, v6, v7
    v_add_f32 v8, v8, v9
    v_add_f32 v10, v10, v11
    v_add_f32 v12, v12, v13
    v_add_f32 v14, v14, v15
    v_add_f32 v16, v16, v17
    v_add_f32 v18, v18, v19
    v_add_f32 v20, v20, v21
    v_add_f32 v22, v22, v23
    v_add_f32 v24, v24, v25
    v_add_f32 v26, v26, v27
    v_add_f32 v0, v0, v2
    v_add_f32 v4, v4, v6
    v_add_f32 v8, v8, v10
    v_add_f32 v12, v12, v14
    v_add_f32 v16, v16, v18
    v_add_f32 v20, v20, v22
    v_add_f32 v24, v24, v26
    v_add_f32 v0, v0, v4
    v_add_f32 v8, v8, v12
    v_add_f32 v16, v16, v20
    v_add_f32 v0, v0, v8
    v_add_f32 v16, v16, v24
    v_add_f32 v0, v0, v16
    ds_write_b32 v214, v0 offset:32768
    s_branch L_k45_sumdone
L_k45_hread:
    s_waitcnt vmcnt(0)
    s_sub_u32 s25, s10, 6
    s_mul_i32 s25, s25, 3
    s_lshl_b32 s25, s25, 13
    v_lshlrev_b32 v205, 4, v200
    v_add_u32 v205, s25, v205
    ds_read_b96 v[104:106], v205 offset:33792
    ds_read_b96 v[108:110], v205 offset:34816
    ds_read_b96 v[112:114], v205 offset:35840
    ds_read_b96 v[116:118], v205 offset:36864
    ds_read_b96 v[120:122], v205 offset:37888
    ds_read_b96 v[124:126], v205 offset:38912
    ds_read_b96 v[128:130], v205 offset:39936
    ds_read_b96 v[132:134], v205 offset:40960
    s_waitcnt lgkmcnt(0)
    ds_read_b96 v[136:138], v205 offset:41984
    ds_read_b96 v[140:142], v205 offset:43008
    ds_read_b96 v[144:146], v205 offset:44032
    ds_read_b96 v[148:150], v205 offset:45056
    ds_read_b96 v[152:154], v205 offset:46080
    ds_read_b96 v[156:158], v205 offset:47104
    ds_read_b96 v[160:162], v205 offset:48128
    ds_read_b96 v[164:166], v205 offset:49152
    s_waitcnt lgkmcnt(0)
    ds_read_b96 v[168:170], v205 offset:50176
    ds_read_b96 v[172:174], v205 offset:51200
    ds_read_b96 v[176:178], v205 offset:52224
    ds_read_b96 v[180:182], v205 offset:53248
    ds_read_b96 v[184:186], v205 offset:54272
    ds_read_b96 v[188:190], v205 offset:55296
    ds_read_b96 v[192:194], v205 offset:56320
    ds_read_b96 v[196:198], v205 offset:57344
    s_waitcnt lgkmcnt(0)
L_k45_sumdone:
    s_waitcnt lgkmcnt(0)
    s_barrier
    v_lshlrev_b32 v210, 5, v201
    ds_read_b128 v[44:47], v210 offset:32768
    ds_read_b128 v[48:51], v210 offset:32784
    ds_read_b128 v[52:55], v210 offset:33280
    ds_read_b128 v[56:59], v210 offset:33296
    s_mov_b32 s24, 0x39035177
    s_mov_b32 s25, 0x3727c5ac
    s_waitcnt vmcnt(0) lgkmcnt(0)
    v_mul_f32 v44, s24, v44
    v_mul_f32 v52, s24, v52
    v_fma_f32 v52, -v44, v44, v52
    v_max_f32 v52, 0, v52
    v_add_f32 v52, s25, v52
    v_rsq_f32 v52, v52
    v_lshlrev_b32 v216, 16, v232
    v_lshlrev_b32 v224, 16, v236
    v_mul_f32 v216, v216, v52
    v_fma_f32 v224, -v44, v216, v224
    v_mul_f32 v45, s24, v45
    v_mul_f32 v53, s24, v53
    v_fma_f32 v53, -v45, v45, v53
    v_max_f32 v53, 0, v53
    v_add_f32 v53, s25, v53
    v_rsq_f32 v53, v53
    v_and_b32 v217, 0xffff0000, v232
    v_and_b32 v225, 0xffff0000, v236
    v_mul_f32 v217, v217, v53
    v_fma_f32 v225, -v45, v217, v225
    v_mul_f32 v46, s24, v46
    v_mul_f32 v54, s24, v54
    v_fma_f32 v54, -v46, v46, v54
    v_max_f32 v54, 0, v54
    v_add_f32 v54, s25, v54
    v_rsq_f32 v54, v54
    v_lshlrev_b32 v218, 16, v233
    v_lshlrev_b32 v226, 16, v237
    v_mul_f32 v218, v218, v54
    v_fma_f32 v226, -v46, v218, v226
    v_mul_f32 v47, s24, v47
    v_mul_f32 v55, s24, v55
    v_fma_f32 v55, -v47, v47, v55
    v_max_f32 v55, 0, v55
    v_add_f32 v55, s25, v55
    v_rsq_f32 v55, v55
    v_and_b32 v219, 0xffff0000, v233
    v_and_b32 v227, 0xffff0000, v237
    v_mul_f32 v219, v219, v55
    v_fma_f32 v227, -v47, v219, v227
    v_mul_f32 v48, s24, v48
    v_mul_f32 v56, s24, v56
    v_fma_f32 v56, -v48, v48, v56
    v_max_f32 v56, 0, v56
    v_add_f32 v56, s25, v56
    v_rsq_f32 v56, v56
    v_lshlrev_b32 v220, 16, v234
    v_lshlrev_b32 v228, 16, v238
    v_mul_f32 v220, v220, v56
    v_fma_f32 v228, -v48, v220, v228
    v_mul_f32 v49, s24, v49
    v_mul_f32 v57, s24, v57
    v_fma_f32 v57, -v49, v49, v57
    v_max_f32 v57, 0, v57
    v_add_f32 v57, s25, v57
    v_rsq_f32 v57, v57
    v_and_b32 v221, 0xffff0000, v234
    v_and_b32 v229, 0xffff0000, v238
    v_mul_f32 v221, v221, v57
    v_fma_f32 v229, -v49, v221, v229
    v_mul_f32 v50, s24, v50
    v_mul_f32 v58, s24, v58
    v_fma_f32 v58, -v50, v50, v58
    v_max_f32 v58, 0, v58
    v_add_f32 v58, s25, v58
    v_rsq_f32 v58, v58
    v_lshlrev_b32 v222, 16, v235
    v_lshlrev_b32 v230, 16, v239
    v_mul_f32 v222, v222, v58
    v_fma_f32 v230, -v50, v222, v230
    v_mul_f32 v51, s24, v51
    v_mul_f32 v59, s24, v59
    v_fma_f32 v59, -v51, v51, v59
    v_max_f32 v59, 0, v59
    v_add_f32 v59, s25, v59
    v_rsq_f32 v59, v59
    v_and_b32 v223, 0xffff0000, v235
    v_and_b32 v231, 0xffff0000, v239
    v_mul_f32 v223, v223, v59
    v_fma_f32 v231, -v51, v223, v231
    s_mul_i32 s24, s11, 8176640
    s_add_u32 s28, s28, s24
    s_addc_u32 s29, s29, 0
    s_mov_b32 s32, s28
    s_and_b32 s33, s29, 0xffff
    s_mov_b32 s34, 8176640
    s_mov_b32 s35, 0x00020000
    s_lshl_b32 s25, s13, 8
    v_lshlrev_b32 v210, 12, v202
    v_lshl_add_u32 v210, v201, 4, v210
    v_add_u32 v210, s25, v210
    s_mov_b32 s26, 0xbdd2d3e8
    v_mov_b32 v211, 0xc0135761
    s_cmp_ge_u32 s10, 6
    s_cbranch_scc1 L_k45_hgelu
    s_cmp_ge_u32 s14, 167
    s_cbranch_scc1 L_k45_fin
    s_mul_i32 s24, s14, 49152
    v_fma_f32 v104, v104, v216, v224
    v_fma_f32 v108, v108, v217, v225
    v_fma_f32 v112, v112, v218, v226
    v_fma_f32 v116, v116, v219, v227
    v_fma_f32 v120, v120, v220, v228
    v_fma_f32 v124, v124, v221, v229
    v_fma_f32 v128, v128, v222, v230
    v_fma_f32 v132, v132, v223, v231
    v_mul_f32 v0, v104, v104
    v_mul_f32 v1, v108, v108
    v_mul_f32 v2, v112, v112
    v_mul_f32 v3, v116, v116
    v_mul_f32 v4, v120, v120
    v_mul_f32 v5, v124, v124
    v_mul_f32 v6, v128, v128
    v_mul_f32 v7, v132, v132
    v_fma_f32 v0, v0, s26, v211
    v_fma_f32 v1, v1, s26, v211
    v_fma_f32 v2, v2, s26, v211
    v_fma_f32 v3, v3, s26, v211
    v_fma_f32 v4, v4, s26, v211
    v_fma_f32 v5, v5, s26, v211
    v_fma_f32 v6, v6, s26, v211
    v_fma_f32 v7, v7, s26, v211
    v_mul_f32 v0, v0, v104
    v_mul_f32 v1, v1, v108
    v_mul_f32 v2, v2, v112
    v_mul_f32 v3, v3, v116
    v_mul_f32 v4, v4, v120
    v_mul_f32 v5, v5, v124
    v_mul_f32 v6, v6, v128
    v_mul_f32 v7, v7, v132
    v_exp_f32 v0, v0
    v_exp_f32 v1, v1
    v_exp_f32 v2, v2
    v_exp_f32 v3, v3
    v_exp_f32 v4, v4
    v_exp_f32 v5, v5
    v_exp_f32 v6, v6
    v_exp_f32 v7, v7
    v_add_f32 v0, 1.0, v0
    v_add_f32 v1, 1.0, v1
    v_add_f32 v2, 1.0, v2
    v_add_f32 v3, 1.0, v3
    v_add_f32 v4, 1.0, v4
    v_add_f32 v5, 1.0, v5
    v_add_f32 v6, 1.0, v6
    v_add_f32 v7, 1.0, v7
    v_rcp_f32 v0, v0
    v_rcp_f32 v1, v1
    v_rcp_f32 v2, v2
    v_rcp_f32 v3, v3
    v_rcp_f32 v4, v4
    v_rcp_f32 v5, v5
    v_rcp_f32 v6, v6
    v_rcp_f32 v7, v7
    v_mul_f32 v0, v0, v104
    v_mul_f32 v1, v1, v108
    v_mul_f32 v2, v2, v112
    v_mul_f32 v3, v3, v116
    v_mul_f32 v4, v4, v120
    v_mul_f32 v5, v5, v124
    v_mul_f32 v6, v6, v128
    v_mul_f32 v7, v7, v132
    v_cvt_pk_bf16_f32 v16, v0, v1
    v_cvt_pk_bf16_f32 v17, v2, v3
    v_cvt_pk_bf16_f32 v18, v4, v5
    v_cvt_pk_bf16_f32 v19, v6, v7
    s_add_u32 s27, s24, 0
    buffer_store_dwordx4 v[16:19], v210, s[32:35], s27 offen sc1
    v_fma_f32 v105, v105, v216, v224
    v_fma_f32 v109, v109, v217, v225
    v_fma_f32 v113, v113, v218, v226
    v_fma_f32 v117, v117, v219, v227
    v_fma_f32 v121, v121, v220, v228
    v_fma_f32 v125, v125, v221, v229
    v_fma_f32 v129, v129, v222, v230
    v_fma_f32 v133, v133, v223, v231
    v_mul_f32 v0, v105, v105
    v_mul_f32 v1, v109, v109
    v_mul_f32 v2, v113, v113
    v_mul_f32 v3, v117, v117
    v_mul_f32 v4, v121, v121
    v_mul_f32 v5, v125, v125
    v_mul_f32 v6, v129, v129
    v_mul_f32 v7, v133, v133
    v_fma_f32 v0, v0, s26, v211
    v_fma_f32 v1, v1, s26, v211
    v_fma_f32 v2, v2, s26, v211
    v_fma_f32 v3, v3, s26, v211
    v_fma_f32 v4, v4, s26, v211
    v_fma_f32 v5, v5, s26, v211
    v_fma_f32 v6, v6, s26, v211
    v_fma_f32 v7, v7, s26, v211
    v_mul_f32 v0, v0, v105
    v_mul_f32 v1, v1, v109
    v_mul_f32 v2, v2, v113
    v_mul_f32 v3, v3, v117
    v_mul_f32 v4, v4, v121
    v_mul_f32 v5, v5, v125
    v_mul_f32 v6, v6, v129
    v_mul_f32 v7, v7, v133
    v_exp_f32 v0, v0
    v_exp_f32 v1, v1
    v_exp_f32 v2, v2
    v_exp_f32 v3, v3
    v_exp_f32 v4, v4
    v_exp_f32 v5, v5
    v_exp_f32 v6, v6
    v_exp_f32 v7, v7
    v_add_f32 v0, 1.0, v0
    v_add_f32 v1, 1.0, v1
    v_add_f32 v2, 1.0, v2
    v_add_f32 v3, 1.0, v3
    v_add_f32 v4, 1.0, v4
    v_add_f32 v5, 1.0, v5
    v_add_f32 v6, 1.0, v6
    v_add_f32 v7, 1.0, v7
    v_rcp_f32 v0, v0
    v_rcp_f32 v1, v1
    v_rcp_f32 v2, v2
    v_rcp_f32 v3, v3
    v_rcp_f32 v4, v4
    v_rcp_f32 v5, v5
    v_rcp_f32 v6, v6
    v_rcp_f32 v7, v7
    v_mul_f32 v0, v0, v105
    v_mul_f32 v1, v1, v109
    v_mul_f32 v2, v2, v113
    v_mul_f32 v3, v3, v117
    v_mul_f32 v4, v4, v121
    v_mul_f32 v5, v5, v125
    v_mul_f32 v6, v6, v129
    v_mul_f32 v7, v7, v133
    v_cvt_pk_bf16_f32 v20, v0, v1
    v_cvt_pk_bf16_f32 v21, v2, v3
    v_cvt_pk_bf16_f32 v22, v4, v5
    v_cvt_pk_bf16_f32 v23, v6, v7
    s_add_u32 s27, s24, 1024
    buffer_store_dwordx4 v[20:23], v210, s[32:35], s27 offen sc1
    v_fma_f32 v106, v106, v216, v224
    v_fma_f32 v110, v110, v217, v225
    v_fma_f32 v114, v114, v218, v226
    v_fma_f32 v118, v118, v219, v227
    v_fma_f32 v122, v122, v220, v228
    v_fma_f32 v126, v126, v221, v229
    v_fma_f32 v130, v130, v222, v230
    v_fma_f32 v134, v134, v223, v231
    v_mul_f32 v0, v106, v106
    v_mul_f32 v1, v110, v110
    v_mul_f32 v2, v114, v114
    v_mul_f32 v3, v118, v118
    v_mul_f32 v4, v122, v122
    v_mul_f32 v5, v126, v126
    v_mul_f32 v6, v130, v130
    v_mul_f32 v7, v134, v134
    v_fma_f32 v0, v0, s26, v211
    v_fma_f32 v1, v1, s26, v211
    v_fma_f32 v2, v2, s26, v211
    v_fma_f32 v3, v3, s26, v211
    v_fma_f32 v4, v4, s26, v211
    v_fma_f32 v5, v5, s26, v211
    v_fma_f32 v6, v6, s26, v211
    v_fma_f32 v7, v7, s26, v211
    v_mul_f32 v0, v0, v106
    v_mul_f32 v1, v1, v110
    v_mul_f32 v2, v2, v114
    v_mul_f32 v3, v3, v118
    v_mul_f32 v4, v4, v122
    v_mul_f32 v5, v5, v126
    v_mul_f32 v6, v6, v130
    v_mul_f32 v7, v7, v134
    v_exp_f32 v0, v0
    v_exp_f32 v1, v1
    v_exp_f32 v2, v2
    v_exp_f32 v3, v3
    v_exp_f32 v4, v4
    v_exp_f32 v5, v5
    v_exp_f32 v6, v6
    v_exp_f32 v7, v7
    v_add_f32 v0, 1.0, v0
    v_add_f32 v1, 1.0, v1
    v_add_f32 v2, 1.0, v2
    v_add_f32 v3, 1.0, v3
    v_add_f32 v4, 1.0, v4
    v_add_f32 v5, 1.0, v5
    v_add_f32 v6, 1.0, v6
    v_add_f32 v7, 1.0, v7
    v_rcp_f32 v0, v0
    v_rcp_f32 v1, v1
    v_rcp_f32 v2, v2
    v_rcp_f32 v3, v3
    v_rcp_f32 v4, v4
    v_rcp_f32 v5, v5
    v_rcp_f32 v6, v6
    v_rcp_f32 v7, v7
    v_mul_f32 v0, v0, v106
    v_mul_f32 v1, v1, v110
    v_mul_f32 v2, v2, v114
    v_mul_f32 v3, v3, v118
    v_mul_f32 v4, v4, v122
    v_mul_f32 v5, v5, v126
    v_mul_f32 v6, v6, v130
    v_mul_f32 v7, v7, v134
    v_cvt_pk_bf16_f32 v24, v0, v1
    v_cvt_pk_bf16_f32 v25, v2, v3
    v_cvt_pk_bf16_f32 v26, v4, v5
    v_cvt_pk_bf16_f32 v27, v6, v7
    s_add_u32 s27, s24, 2048
    buffer_store_dwordx4 v[24:27], v210, s[32:35], s27 offen sc1
    v_fma_f32 v107, v107, v216, v224
    v_fma_f32 v111, v111, v217, v225
    v_fma_f32 v115, v115, v218, v226
    v_fma_f32 v119, v119, v219, v227
    v_fma_f32 v123, v123, v220, v228
    v_fma_f32 v127, v127, v221, v229
    v_fma_f32 v131, v131, v222, v230
    v_fma_f32 v135, v135, v223, v231
    v_mul_f32 v0, v107, v107
    v_mul_f32 v1, v111, v111
    v_mul_f32 v2, v115, v115
    v_mul_f32 v3, v119, v119
    v_mul_f32 v4, v123, v123
    v_mul_f32 v5, v127, v127
    v_mul_f32 v6, v131, v131
    v_mul_f32 v7, v135, v135
    v_fma_f32 v0, v0, s26, v211
    v_fma_f32 v1, v1, s26, v211
    v_fma_f32 v2, v2, s26, v211
    v_fma_f32 v3, v3, s26, v211
    v_fma_f32 v4, v4, s26, v211
    v_fma_f32 v5, v5, s26, v211
    v_fma_f32 v6, v6, s26, v211
    v_fma_f32 v7, v7, s26, v211
    v_mul_f32 v0, v0, v107
    v_mul_f32 v1, v1, v111
    v_mul_f32 v2, v2, v115
    v_mul_f32 v3, v3, v119
    v_mul_f32 v4, v4, v123
    v_mul_f32 v5, v5, v127
    v_mul_f32 v6, v6, v131
    v_mul_f32 v7, v7, v135
    v_exp_f32 v0, v0
    v_exp_f32 v1, v1
    v_exp_f32 v2, v2
    v_exp_f32 v3, v3
    v_exp_f32 v4, v4
    v_exp_f32 v5, v5
    v_exp_f32 v6, v6
    v_exp_f32 v7, v7
    v_add_f32 v0, 1.0, v0
    v_add_f32 v1, 1.0, v1
    v_add_f32 v2, 1.0, v2
    v_add_f32 v3, 1.0, v3
    v_add_f32 v4, 1.0, v4
    v_add_f32 v5, 1.0, v5
    v_add_f32 v6, 1.0, v6
    v_add_f32 v7, 1.0, v7
    v_rcp_f32 v0, v0
    v_rcp_f32 v1, v1
    v_rcp_f32 v2, v2
    v_rcp_f32 v3, v3
    v_rcp_f32 v4, v4
    v_rcp_f32 v5, v5
    v_rcp_f32 v6, v6
    v_rcp_f32 v7, v7
    v_mul_f32 v0, v0, v107
    v_mul_f32 v1, v1, v111
    v_mul_f32 v2, v2, v115
    v_mul_f32 v3, v3, v119
    v_mul_f32 v4, v4, v123
    v_mul_f32 v5, v5, v127
    v_mul_f32 v6, v6, v131
    v_mul_f32 v7, v7, v135
    v_cvt_pk_bf16_f32 v28, v0, v1
    v_cvt_pk_bf16_f32 v29, v2, v3
    v_cvt_pk_bf16_f32 v30, v4, v5
    v_cvt_pk_bf16_f32 v31, v6, v7
    s_add_u32 s27, s24, 3072
    buffer_store_dwordx4 v[28:31], v210, s[32:35], s27 offen sc1
    v_fma_f32 v136, v136, v216, v224
    v_fma_f32 v140, v140, v217, v225
    v_fma_f32 v144, v144, v218, v226
    v_fma_f32 v148, v148, v219, v227
    v_fma_f32 v152, v152, v220, v228
    v_fma_f32 v156, v156, v221, v229
    v_fma_f32 v160, v160, v222, v230
    v_fma_f32 v164, v164, v223, v231
    v_mul_f32 v0, v136, v136
    v_mul_f32 v1, v140, v140
    v_mul_f32 v2, v144, v144
    v_mul_f32 v3, v148, v148
    v_mul_f32 v4, v152, v152
    v_mul_f32 v5, v156, v156
    v_mul_f32 v6, v160, v160
    v_mul_f32 v7, v164, v164
    v_fma_f32 v0, v0, s26, v211
    v_fma_f32 v1, v1, s26, v211
    v_fma_f32 v2, v2, s26, v211
    v_fma_f32 v3, v3, s26, v211
    v_fma_f32 v4, v4, s26, v211
    v_fma_f32 v5, v5, s26, v211
    v_fma_f32 v6, v6, s26, v211
    v_fma_f32 v7, v7, s26, v211
    v_mul_f32 v0, v0, v136
    v_mul_f32 v1, v1, v140
    v_mul_f32 v2, v2, v144
    v_mul_f32 v3, v3, v148
    v_mul_f32 v4, v4, v152
    v_mul_f32 v5, v5, v156
    v_mul_f32 v6, v6, v160
    v_mul_f32 v7, v7, v164
    v_exp_f32 v0, v0
    v_exp_f32 v1, v1
    v_exp_f32 v2, v2
    v_exp_f32 v3, v3
    v_exp_f32 v4, v4
    v_exp_f32 v5, v5
    v_exp_f32 v6, v6
    v_exp_f32 v7, v7
    v_add_f32 v0, 1.0, v0
    v_add_f32 v1, 1.0, v1
    v_add_f32 v2, 1.0, v2
    v_add_f32 v3, 1.0, v3
    v_add_f32 v4, 1.0, v4
    v_add_f32 v5, 1.0, v5
    v_add_f32 v6, 1.0, v6
    v_add_f32 v7, 1.0, v7
    v_rcp_f32 v0, v0
    v_rcp_f32 v1, v1
    v_rcp_f32 v2, v2
    v_rcp_f32 v3, v3
    v_rcp_f32 v4, v4
    v_rcp_f32 v5, v5
    v_rcp_f32 v6, v6
    v_rcp_f32 v7, v7
    v_mul_f32 v0, v0, v136
    v_mul_f32 v1, v1, v140
    v_mul_f32 v2, v2, v144
    v_mul_f32 v3, v3, v148
    v_mul_f32 v4, v4, v152
    v_mul_f32 v5, v5, v156
    v_mul_f32 v6, v6, v160
    v_mul_f32 v7, v7, v164
    v_cvt_pk_bf16_f32 v32, v0, v1
    v_cvt_pk_bf16_f32 v33, v2, v3
    v_cvt_pk_bf16_f32 v34, v4, v5
    v_cvt_pk_bf16_f32 v35, v6, v7
    s_add_u32 s27, s24, 16384
    buffer_store_dwordx4 v[32:35], v210, s[32:35], s27 offen sc1
    v_fma_f32 v137, v137, v216, v224
    v_fma_f32 v141, v141, v217, v225
    v_fma_f32 v145, v145, v218, v226
    v_fma_f32 v149, v149, v219, v227
    v_fma_f32 v153, v153, v220, v228
    v_fma_f32 v157, v157, v221, v229
    v_fma_f32 v161, v161, v222, v230
    v_fma_f32 v165, v165, v223, v231
    v_mul_f32 v0, v137, v137
    v_mul_f32 v1, v141, v141
    v_mul_f32 v2, v145, v145
    v_mul_f32 v3, v149, v149
    v_mul_f32 v4, v153, v153
    v_mul_f32 v5, v157, v157
    v_mul_f32 v6, v161, v161
    v_mul_f32 v7, v165, v165
    v_fma_f32 v0, v0, s26, v211
    v_fma_f32 v1, v1, s26, v211
    v_fma_f32 v2, v2, s26, v211
    v_fma_f32 v3, v3, s26, v211
    v_fma_f32 v4, v4, s26, v211
    v_fma_f32 v5, v5, s26, v211
    v_fma_f32 v6, v6, s26, v211
    v_fma_f32 v7, v7, s26, v211
    v_mul_f32 v0, v0, v137
    v_mul_f32 v1, v1, v141
    v_mul_f32 v2, v2, v145
    v_mul_f32 v3, v3, v149
    v_mul_f32 v4, v4, v153
    v_mul_f32 v5, v5, v157
    v_mul_f32 v6, v6, v161
    v_mul_f32 v7, v7, v165
    v_exp_f32 v0, v0
    v_exp_f32 v1, v1
    v_exp_f32 v2, v2
    v_exp_f32 v3, v3
    v_exp_f32 v4, v4
    v_exp_f32 v5, v5
    v_exp_f32 v6, v6
    v_exp_f32 v7, v7
    v_add_f32 v0, 1.0, v0
    v_add_f32 v1, 1.0, v1
    v_add_f32 v2, 1.0, v2
    v_add_f32 v3, 1.0, v3
    v_add_f32 v4, 1.0, v4
    v_add_f32 v5, 1.0, v5
    v_add_f32 v6, 1.0, v6
    v_add_f32 v7, 1.0, v7
    v_rcp_f32 v0, v0
    v_rcp_f32 v1, v1
    v_rcp_f32 v2, v2
    v_rcp_f32 v3, v3
    v_rcp_f32 v4, v4
    v_rcp_f32 v5, v5
    v_rcp_f32 v6, v6
    v_rcp_f32 v7, v7
    v_mul_f32 v0, v0, v137
    v_mul_f32 v1, v1, v141
    v_mul_f32 v2, v2, v145
    v_mul_f32 v3, v3, v149
    v_mul_f32 v4, v4, v153
    v_mul_f32 v5, v5, v157
    v_mul_f32 v6, v6, v161
    v_mul_f32 v7, v7, v165
    v_cvt_pk_bf16_f32 v36, v0, v1
    v_cvt_pk_bf16_f32 v37, v2, v3
    v_cvt_pk_bf16_f32 v38, v4, v5
    v_cvt_pk_bf16_f32 v39, v6, v7
    s_add_u32 s27, s24, 17408
    buffer_store_dwordx4 v[36:39], v210, s[32:35], s27 offen sc1
    v_fma_f32 v138, v138, v216, v224
    v_fma_f32 v142, v142, v217, v225
    v_fma_f32 v146, v146, v218, v226
    v_fma_f32 v150, v150, v219, v227
    v_fma_f32 v154, v154, v220, v228
    v_fma_f32 v158, v158, v221, v229
    v_fma_f32 v162, v162, v222, v230
    v_fma_f32 v166, v166, v223, v231
    v_mul_f32 v0, v138, v138
    v_mul_f32 v1, v142, v142
    v_mul_f32 v2, v146, v146
    v_mul_f32 v3, v150, v150
    v_mul_f32 v4, v154, v154
    v_mul_f32 v5, v158, v158
    v_mul_f32 v6, v162, v162
    v_mul_f32 v7, v166, v166
    v_fma_f32 v0, v0, s26, v211
    v_fma_f32 v1, v1, s26, v211
    v_fma_f32 v2, v2, s26, v211
    v_fma_f32 v3, v3, s26, v211
    v_fma_f32 v4, v4, s26, v211
    v_fma_f32 v5, v5, s26, v211
    v_fma_f32 v6, v6, s26, v211
    v_fma_f32 v7, v7, s26, v211
    v_mul_f32 v0, v0, v138
    v_mul_f32 v1, v1, v142
    v_mul_f32 v2, v2, v146
    v_mul_f32 v3, v3, v150
    v_mul_f32 v4, v4, v154
    v_mul_f32 v5, v5, v158
    v_mul_f32 v6, v6, v162
    v_mul_f32 v7, v7, v166
    v_exp_f32 v0, v0
    v_exp_f32 v1, v1
    v_exp_f32 v2, v2
    v_exp_f32 v3, v3
    v_exp_f32 v4, v4
    v_exp_f32 v5, v5
    v_exp_f32 v6, v6
    v_exp_f32 v7, v7
    v_add_f32 v0, 1.0, v0
    v_add_f32 v1, 1.0, v1
    v_add_f32 v2, 1.0, v2
    v_add_f32 v3, 1.0, v3
    v_add_f32 v4, 1.0, v4
    v_add_f32 v5, 1.0, v5
    v_add_f32 v6, 1.0, v6
    v_add_f32 v7, 1.0, v7
    v_rcp_f32 v0, v0
    v_rcp_f32 v1, v1
    v_rcp_f32 v2, v2
    v_rcp_f32 v3, v3
    v_rcp_f32 v4, v4
    v_rcp_f32 v5, v5
    v_rcp_f32 v6, v6
    v_rcp_f32 v7, v7
    v_mul_f32 v0, v0, v138
    v_mul_f32 v1, v1, v142
    v_mul_f32 v2, v2, v146
    v_mul_f32 v3, v3, v150
    v_mul_f32 v4, v4, v154
    v_mul_f32 v5, v5, v158
    v_mul_f32 v6, v6, v162
    v_mul_f32 v7, v7, v166
    v_cvt_pk_bf16_f32 v40, v0, v1
    v_cvt_pk_bf16_f32 v41, v2, v3
    v_cvt_pk_bf16_f32 v42, v4, v5
    v_cvt_pk_bf16_f32 v43, v6, v7
    s_add_u32 s27, s24, 18432
    buffer_store_dwordx4 v[40:43], v210, s[32:35], s27 offen sc1
    v_fma_f32 v139, v139, v216, v224
    v_fma_f32 v143, v143, v217, v225
    v_fma_f32 v147, v147, v218, v226
    v_fma_f32 v151, v151, v219, v227
    v_fma_f32 v155, v155, v220, v228
    v_fma_f32 v159, v159, v221, v229
    v_fma_f32 v163, v163, v222, v230
    v_fma_f32 v167, v167, v223, v231
    v_mul_f32 v0, v139, v139
    v_mul_f32 v1, v143, v143
    v_mul_f32 v2, v147, v147
    v_mul_f32 v3, v151, v151
    v_mul_f32 v4, v155, v155
    v_mul_f32 v5, v159, v159
    v_mul_f32 v6, v163, v163
    v_mul_f32 v7, v167, v167
    v_fma_f32 v0, v0, s26, v211
    v_fma_f32 v1, v1, s26, v211
    v_fma_f32 v2, v2, s26, v211
    v_fma_f32 v3, v3, s26, v211
    v_fma_f32 v4, v4, s26, v211
    v_fma_f32 v5, v5, s26, v211
    v_fma_f32 v6, v6, s26, v211
    v_fma_f32 v7, v7, s26, v211
    v_mul_f32 v0, v0, v139
    v_mul_f32 v1, v1, v143
    v_mul_f32 v2, v2, v147
    v_mul_f32 v3, v3, v151
    v_mul_f32 v4, v4, v155
    v_mul_f32 v5, v5, v159
    v_mul_f32 v6, v6, v163
    v_mul_f32 v7, v7, v167
    v_exp_f32 v0, v0
    v_exp_f32 v1, v1
    v_exp_f32 v2, v2
    v_exp_f32 v3, v3
    v_exp_f32 v4, v4
    v_exp_f32 v5, v5
    v_exp_f32 v6, v6
    v_exp_f32 v7, v7
    v_add_f32 v0, 1.0, v0
    v_add_f32 v1, 1.0, v1
    v_add_f32 v2, 1.0, v2
    v_add_f32 v3, 1.0, v3
    v_add_f32 v4, 1.0, v4
    v_add_f32 v5, 1.0, v5
    v_add_f32 v6, 1.0, v6
    v_add_f32 v7, 1.0, v7
    v_rcp_f32 v0, v0
    v_rcp_f32 v1, v1
    v_rcp_f32 v2, v2
    v_rcp_f32 v3, v3
    v_rcp_f32 v4, v4
    v_rcp_f32 v5, v5
    v_rcp_f32 v6, v6
    v_rcp_f32 v7, v7
    v_mul_f32 v0, v0, v139
    v_mul_f32 v1, v1, v143
    v_mul_f32 v2, v2, v147
    v_mul_f32 v3, v3, v151
    v_mul_f32 v4, v4, v155
    v_mul_f32 v5, v5, v159
    v_mul_f32 v6, v6, v163
    v_mul_f32 v7, v7, v167
    v_cvt_pk_bf16_f32 v44, v0, v1
    v_cvt_pk_bf16_f32 v45, v2, v3
    v_cvt_pk_bf16_f32 v46, v4, v5
    v_cvt_pk_bf16_f32 v47, v6, v7
    s_add_u32 s27, s24, 19456
    buffer_store_dwordx4 v[44:47], v210, s[32:35], s27 offen sc1
    v_fma_f32 v171, v171, v216, v224
    v_fma_f32 v175, v175, v217, v225
    v_fma_f32 v179, v179, v218, v226
    v_fma_f32 v183, v183, v219, v227
    v_fma_f32 v187, v187, v220, v228
    v_fma_f32 v191, v191, v221, v229
    v_fma_f32 v195, v195, v222, v230
    v_fma_f32 v199, v199, v223, v231
    v_mul_f32 v0, v171, v171
    v_mul_f32 v1, v175, v175
    v_mul_f32 v2, v179, v179
    v_mul_f32 v3, v183, v183
    v_mul_f32 v4, v187, v187
    v_mul_f32 v5, v191, v191
    v_mul_f32 v6, v195, v195
    v_mul_f32 v7, v199, v199
    v_fma_f32 v0, v0, s26, v211
    v_fma_f32 v1, v1, s26, v211
    v_fma_f32 v2, v2, s26, v211
    v_fma_f32 v3, v3, s26, v211
    v_fma_f32 v4, v4, s26, v211
    v_fma_f32 v5, v5, s26, v211
    v_fma_f32 v6, v6, s26, v211
    v_fma_f32 v7, v7, s26, v211
    v_mul_f32 v0, v0, v171
    v_mul_f32 v1, v1, v175
    v_mul_f32 v2, v2, v179
    v_mul_f32 v3, v3, v183
    v_mul_f32 v4, v4, v187
    v_mul_f32 v5, v5, v191
    v_mul_f32 v6, v6, v195
    v_mul_f32 v7, v7, v199
    v_exp_f32 v0, v0
    v_exp_f32 v1, v1
    v_exp_f32 v2, v2
    v_exp_f32 v3, v3
    v_exp_f32 v4, v4
    v_exp_f32 v5, v5
    v_exp_f32 v6, v6
    v_exp_f32 v7, v7
    v_add_f32 v0, 1.0, v0
    v_add_f32 v1, 1.0, v1
    v_add_f32 v2, 1.0, v2
    v_add_f32 v3, 1.0, v3
    v_add_f32 v4, 1.0, v4
    v_add_f32 v5, 1.0, v5
    v_add_f32 v6, 1.0, v6
    v_add_f32 v7, 1.0, v7
    v_rcp_f32 v0, v0
    v_rcp_f32 v1, v1
    v_rcp_f32 v2, v2
    v_rcp_f32 v3, v3
    v_rcp_f32 v4, v4
    v_rcp_f32 v5, v5
    v_rcp_f32 v6, v6
    v_rcp_f32 v7, v7
    v_mul_f32 v0, v0, v171
    v_mul_f32 v1, v1, v175
    v_mul_f32 v2, v2, v179
    v_mul_f32 v3, v3, v183
    v_mul_f32 v4, v4, v187
    v_mul_f32 v5, v5, v191
    v_mul_f32 v6, v6, v195
    v_mul_f32 v7, v7, v199
    v_cvt_pk_bf16_f32 v16, v0, v1
    v_cvt_pk_bf16_f32 v17, v2, v3
    v_cvt_pk_bf16_f32 v18, v4, v5
    v_cvt_pk_bf16_f32 v19, v6, v7
    s_add_u32 s27, s24, 35840
    buffer_store_dwordx4 v[16:19], v210, s[32:35], s27 offen sc1
    s_branch L_k45_fin
L_k45_hgelu:
    s_sub_u32 s25, s10, 6
    s_mul_i32 s25, s25, 3
    s_mul_i32 s24, s12, 6
    s_add_u32 s24, s24, s25
    s_mul_i32 s24, s24, 49152
    v_fma_f32 v104, v104, v216, v224
    v_fma_f32 v108, v108, v217, v225
    v_fma_f32 v112, v112, v218, v226
    v_fma_f32 v116, v116, v219, v227
    v_fma_f32 v120, v120, v220, v228
    v_fma_f32 v124, v124, v221, v229
    v_fma_f32 v128, v128, v222, v230
    v_fma_f32 v132, v132, v223, v231
    v_mul_f32 v0, v104, v104
    v_mul_f32 v1, v108, v108
    v_mul_f32 v2, v112, v112
    v_mul_f32 v3, v116, v116
    v_mul_f32 v4, v120, v120
    v_mul_f32 v5, v124, v124
    v_mul_f32 v6, v128, v128
    v_mul_f32 v7, v132, v132
    v_fma_f32 v0, v0, s26, v211
    v_fma_f32 v1, v1, s26, v211
    v_fma_f32 v2, v2, s26, v211
    v_fma_f32 v3, v3, s26, v211
    v_fma_f32 v4, v4, s26, v211
    v_fma_f32 v5, v5, s26, v211
    v_fma_f32 v6, v6, s26, v211
    v_fma_f32 v7, v7, s26, v211
    v_mul_f32 v0, v0, v104
    v_mul_f32 v1, v1, v108
    v_mul_f32 v2, v2, v112
    v_mul_f32 v3, v3, v116
    v_mul_f32 v4, v4, v120
    v_mul_f32 v5, v5, v124
    v_mul_f32 v6, v6, v128
    v_mul_f32 v7, v7, v132
    v_exp_f32 v0, v0
    v_exp_f32 v1, v1
    v_exp_f32 v2, v2
    v_exp_f32 v3, v3
    v_exp_f32 v4, v4
    v_exp_f32 v5, v5
    v_exp_f32 v6, v6
    v_exp_f32 v7, v7
    v_add_f32 v0, 1.0, v0
    v_add_f32 v1, 1.0, v1
    v_add_f32 v2, 1.0, v2
    v_add_f32 v3, 1.0, v3
    v_add_f32 v4, 1.0, v4
    v_add_f32 v5, 1.0, v5
    v_add_f32 v6, 1.0, v6
    v_add_f32 v7, 1.0, v7
    v_rcp_f32 v0, v0
    v_rcp_f32 v1, v1
    v_rcp_f32 v2, v2
    v_rcp_f32 v3, v3
    v_rcp_f32 v4, v4
    v_rcp_f32 v5, v5
    v_rcp_f32 v6, v6
    v_rcp_f32 v7, v7
    v_mul_f32 v0, v0, v104
    v_mul_f32 v1, v1, v108
    v_mul_f32 v2, v2, v112
    v_mul_f32 v3, v3, v116
    v_mul_f32 v4, v4, v120
    v_mul_f32 v5, v5, v124
    v_mul_f32 v6, v6, v128
    v_mul_f32 v7, v7, v132
    v_cvt_pk_bf16_f32 v20, v0, v1
    v_cvt_pk_bf16_f32 v21, v2, v3
    v_cvt_pk_bf16_f32 v22, v4, v5
    v_cvt_pk_bf16_f32 v23, v6, v7
    s_add_u32 s27, s24, 32768
    buffer_store_dwordx4 v[20:23], v210, s[32:35], s27 offen sc1
    v_fma_f32 v105, v105, v216, v224
    v_fma_f32 v109, v109, v217, v225
    v_fma_f32 v113, v113, v218, v226
    v_fma_f32 v117, v117, v219, v227
    v_fma_f32 v121, v121, v220, v228
    v_fma_f32 v125, v125, v221, v229
    v_fma_f32 v129, v129, v222, v230
    v_fma_f32 v133, v133, v223, v231
    v_mul_f32 v0, v105, v105
    v_mul_f32 v1, v109, v109
    v_mul_f32 v2, v113, v113
    v_mul_f32 v3, v117, v117
    v_mul_f32 v4, v121, v121
    v_mul_f32 v5, v125, v125
    v_mul_f32 v6, v129, v129
    v_mul_f32 v7, v133, v133
    v_fma_f32 v0, v0, s26, v211
    v_fma_f32 v1, v1, s26, v211
    v_fma_f32 v2, v2, s26, v211
    v_fma_f32 v3, v3, s26, v211
    v_fma_f32 v4, v4, s26, v211
    v_fma_f32 v5, v5, s26, v211
    v_fma_f32 v6, v6, s26, v211
    v_fma_f32 v7, v7, s26, v211
    v_mul_f32 v0, v0, v105
    v_mul_f32 v1, v1, v109
    v_mul_f32 v2, v2, v113
    v_mul_f32 v3, v3, v117
    v_mul_f32 v4, v4, v121
    v_mul_f32 v5, v5, v125
    v_mul_f32 v6, v6, v129
    v_mul_f32 v7, v7, v133
    v_exp_f32 v0, v0
    v_exp_f32 v1, v1
    v_exp_f32 v2, v2
    v_exp_f32 v3, v3
    v_exp_f32 v4, v4
    v_exp_f32 v5, v5
    v_exp_f32 v6, v6
    v_exp_f32 v7, v7
    v_add_f32 v0, 1.0, v0
    v_add_f32 v1, 1.0, v1
    v_add_f32 v2, 1.0, v2
    v_add_f32 v3, 1.0, v3
    v_add_f32 v4, 1.0, v4
    v_add_f32 v5, 1.0, v5
    v_add_f32 v6, 1.0, v6
    v_add_f32 v7, 1.0, v7
    v_rcp_f32 v0, v0
    v_rcp_f32 v1, v1
    v_rcp_f32 v2, v2
    v_rcp_f32 v3, v3
    v_rcp_f32 v4, v4
    v_rcp_f32 v5, v5
    v_rcp_f32 v6, v6
    v_rcp_f32 v7, v7
    v_mul_f32 v0, v0, v105
    v_mul_f32 v1, v1, v109
    v_mul_f32 v2, v2, v113
    v_mul_f32 v3, v3, v117
    v_mul_f32 v4, v4, v121
    v_mul_f32 v5, v5, v125
    v_mul_f32 v6, v6, v129
    v_mul_f32 v7, v7, v133
    v_cvt_pk_bf16_f32 v24, v0, v1
    v_cvt_pk_bf16_f32 v25, v2, v3
    v_cvt_pk_bf16_f32 v26, v4, v5
    v_cvt_pk_bf16_f32 v27, v6, v7
    s_add_u32 s27, s24, 33792
    buffer_store_dwordx4 v[24:27], v210, s[32:35], s27 offen sc1
    v_fma_f32 v106, v106, v216, v224
    v_fma_f32 v110, v110, v217, v225
    v_fma_f32 v114, v114, v218, v226
    v_fma_f32 v118, v118, v219, v227
    v_fma_f32 v122, v122, v220, v228
    v_fma_f32 v126, v126, v221, v229
    v_fma_f32 v130, v130, v222, v230
    v_fma_f32 v134, v134, v223, v231
    v_mul_f32 v0, v106, v106
    v_mul_f32 v1, v110, v110
    v_mul_f32 v2, v114, v114
    v_mul_f32 v3, v118, v118
    v_mul_f32 v4, v122, v122
    v_mul_f32 v5, v126, v126
    v_mul_f32 v6, v130, v130
    v_mul_f32 v7, v134, v134
    v_fma_f32 v0, v0, s26, v211
    v_fma_f32 v1, v1, s26, v211
    v_fma_f32 v2, v2, s26, v211
    v_fma_f32 v3, v3, s26, v211
    v_fma_f32 v4, v4, s26, v211
    v_fma_f32 v5, v5, s26, v211
    v_fma_f32 v6, v6, s26, v211
    v_fma_f32 v7, v7, s26, v211
    v_mul_f32 v0, v0, v106
    v_mul_f32 v1, v1, v110
    v_mul_f32 v2, v2, v114
    v_mul_f32 v3, v3, v118
    v_mul_f32 v4, v4, v122
    v_mul_f32 v5, v5, v126
    v_mul_f32 v6, v6, v130
    v_mul_f32 v7, v7, v134
    v_exp_f32 v0, v0
    v_exp_f32 v1, v1
    v_exp_f32 v2, v2
    v_exp_f32 v3, v3
    v_exp_f32 v4, v4
    v_exp_f32 v5, v5
    v_exp_f32 v6, v6
    v_exp_f32 v7, v7
    v_add_f32 v0, 1.0, v0
    v_add_f32 v1, 1.0, v1
    v_add_f32 v2, 1.0, v2
    v_add_f32 v3, 1.0, v3
    v_add_f32 v4, 1.0, v4
    v_add_f32 v5, 1.0, v5
    v_add_f32 v6, 1.0, v6
    v_add_f32 v7, 1.0, v7
    v_rcp_f32 v0, v0
    v_rcp_f32 v1, v1
    v_rcp_f32 v2, v2
    v_rcp_f32 v3, v3
    v_rcp_f32 v4, v4
    v_rcp_f32 v5, v5
    v_rcp_f32 v6, v6
    v_rcp_f32 v7, v7
    v_mul_f32 v0, v0, v106
    v_mul_f32 v1, v1, v110
    v_mul_f32 v2, v2, v114
    v_mul_f32 v3, v3, v118
    v_mul_f32 v4, v4, v122
    v_mul_f32 v5, v5, v126
    v_mul_f32 v6, v6, v130
    v_mul_f32 v7, v7, v134
    v_cvt_pk_bf16_f32 v28, v0, v1
    v_cvt_pk_bf16_f32 v29, v2, v3
    v_cvt_pk_bf16_f32 v30, v4, v5
    v_cvt_pk_bf16_f32 v31, v6, v7
    s_add_u32 s27, s24, 34816
    buffer_store_dwordx4 v[28:31], v210, s[32:35], s27 offen sc1
    v_fma_f32 v136, v136, v216, v224
    v_fma_f32 v140, v140, v217, v225
    v_fma_f32 v144, v144, v218, v226
    v_fma_f32 v148, v148, v219, v227
    v_fma_f32 v152, v152, v220, v228
    v_fma_f32 v156, v156, v221, v229
    v_fma_f32 v160, v160, v222, v230
    v_fma_f32 v164, v164, v223, v231
    v_mul_f32 v0, v136, v136
    v_mul_f32 v1, v140, v140
    v_mul_f32 v2, v144, v144
    v_mul_f32 v3, v148, v148
    v_mul_f32 v4, v152, v152
    v_mul_f32 v5, v156, v156
    v_mul_f32 v6, v160, v160
    v_mul_f32 v7, v164, v164
    v_fma_f32 v0, v0, s26, v211
    v_fma_f32 v1, v1, s26, v211
    v_fma_f32 v2, v2, s26, v211
    v_fma_f32 v3, v3, s26, v211
    v_fma_f32 v4, v4, s26, v211
    v_fma_f32 v5, v5, s26, v211
    v_fma_f32 v6, v6, s26, v211
    v_fma_f32 v7, v7, s26, v211
    v_mul_f32 v0, v0, v136
    v_mul_f32 v1, v1, v140
    v_mul_f32 v2, v2, v144
    v_mul_f32 v3, v3, v148
    v_mul_f32 v4, v4, v152
    v_mul_f32 v5, v5, v156
    v_mul_f32 v6, v6, v160
    v_mul_f32 v7, v7, v164
    v_exp_f32 v0, v0
    v_exp_f32 v1, v1
    v_exp_f32 v2, v2
    v_exp_f32 v3, v3
    v_exp_f32 v4, v4
    v_exp_f32 v5, v5
    v_exp_f32 v6, v6
    v_exp_f32 v7, v7
    v_add_f32 v0, 1.0, v0
    v_add_f32 v1, 1.0, v1
    v_add_f32 v2, 1.0, v2
    v_add_f32 v3, 1.0, v3
    v_add_f32 v4, 1.0, v4
    v_add_f32 v5, 1.0, v5
    v_add_f32 v6, 1.0, v6
    v_add_f32 v7, 1.0, v7
    v_rcp_f32 v0, v0
    v_rcp_f32 v1, v1
    v_rcp_f32 v2, v2
    v_rcp_f32 v3, v3
    v_rcp_f32 v4, v4
    v_rcp_f32 v5, v5
    v_rcp_f32 v6, v6
    v_rcp_f32 v7, v7
    v_mul_f32 v0, v0, v136
    v_mul_f32 v1, v1, v140
    v_mul_f32 v2, v2, v144
    v_mul_f32 v3, v3, v148
    v_mul_f32 v4, v4, v152
    v_mul_f32 v5, v5, v156
    v_mul_f32 v6, v6, v160
    v_mul_f32 v7, v7, v164
    v_cvt_pk_bf16_f32 v32, v0, v1
    v_cvt_pk_bf16_f32 v33, v2, v3
    v_cvt_pk_bf16_f32 v34, v4, v5
    v_cvt_pk_bf16_f32 v35, v6, v7
    s_add_u32 s27, s24, 81920
    buffer_store_dwordx4 v[32:35], v210, s[32:35], s27 offen sc1
    v_fma_f32 v137, v137, v216, v224
    v_fma_f32 v141, v141, v217, v225
    v_fma_f32 v145, v145, v218, v226
    v_fma_f32 v149, v149, v219, v227
    v_fma_f32 v153, v153, v220, v228
    v_fma_f32 v157, v157, v221, v229
    v_fma_f32 v161, v161, v222, v230
    v_fma_f32 v165, v165, v223, v231
    v_mul_f32 v0, v137, v137
    v_mul_f32 v1, v141, v141
    v_mul_f32 v2, v145, v145
    v_mul_f32 v3, v149, v149
    v_mul_f32 v4, v153, v153
    v_mul_f32 v5, v157, v157
    v_mul_f32 v6, v161, v161
    v_mul_f32 v7, v165, v165
    v_fma_f32 v0, v0, s26, v211
    v_fma_f32 v1, v1, s26, v211
    v_fma_f32 v2, v2, s26, v211
    v_fma_f32 v3, v3, s26, v211
    v_fma_f32 v4, v4, s26, v211
    v_fma_f32 v5, v5, s26, v211
    v_fma_f32 v6, v6, s26, v211
    v_fma_f32 v7, v7, s26, v211
    v_mul_f32 v0, v0, v137
    v_mul_f32 v1, v1, v141
    v_mul_f32 v2, v2, v145
    v_mul_f32 v3, v3, v149
    v_mul_f32 v4, v4, v153
    v_mul_f32 v5, v5, v157
    v_mul_f32 v6, v6, v161
    v_mul_f32 v7, v7, v165
    v_exp_f32 v0, v0
    v_exp_f32 v1, v1
    v_exp_f32 v2, v2
    v_exp_f32 v3, v3
    v_exp_f32 v4, v4
    v_exp_f32 v5, v5
    v_exp_f32 v6, v6
    v_exp_f32 v7, v7
    v_add_f32 v0, 1.0, v0
    v_add_f32 v1, 1.0, v1
    v_add_f32 v2, 1.0, v2
    v_add_f32 v3, 1.0, v3
    v_add_f32 v4, 1.0, v4
    v_add_f32 v5, 1.0, v5
    v_add_f32 v6, 1.0, v6
    v_add_f32 v7, 1.0, v7
    v_rcp_f32 v0, v0
    v_rcp_f32 v1, v1
    v_rcp_f32 v2, v2
    v_rcp_f32 v3, v3
    v_rcp_f32 v4, v4
    v_rcp_f32 v5, v5
    v_rcp_f32 v6, v6
    v_rcp_f32 v7, v7
    v_mul_f32 v0, v0, v137
    v_mul_f32 v1, v1, v141
    v_mul_f32 v2, v2, v145
    v_mul_f32 v3, v3, v149
    v_mul_f32 v4, v4, v153
    v_mul_f32 v5, v5, v157
    v_mul_f32 v6, v6, v161
    v_mul_f32 v7, v7, v165
    v_cvt_pk_bf16_f32 v36, v0, v1
    v_cvt_pk_bf16_f32 v37, v2, v3
    v_cvt_pk_bf16_f32 v38, v4, v5
    v_cvt_pk_bf16_f32 v39, v6, v7
    s_add_u32 s27, s24, 82944
    buffer_store_dwordx4 v[36:39], v210, s[32:35], s27 offen sc1
    v_fma_f32 v138, v138, v216, v224
    v_fma_f32 v142, v142, v217, v225
    v_fma_f32 v146, v146, v218, v226
    v_fma_f32 v150, v150, v219, v227
    v_fma_f32 v154, v154, v220, v228
    v_fma_f32 v158, v158, v221, v229
    v_fma_f32 v162, v162, v222, v230
    v_fma_f32 v166, v166, v223, v231
    v_mul_f32 v0, v138, v138
    v_mul_f32 v1, v142, v142
    v_mul_f32 v2, v146, v146
    v_mul_f32 v3, v150, v150
    v_mul_f32 v4, v154, v154
    v_mul_f32 v5, v158, v158
    v_mul_f32 v6, v162, v162
    v_mul_f32 v7, v166, v166
    v_fma_f32 v0, v0, s26, v211
    v_fma_f32 v1, v1, s26, v211
    v_fma_f32 v2, v2, s26, v211
    v_fma_f32 v3, v3, s26, v211
    v_fma_f32 v4, v4, s26, v211
    v_fma_f32 v5, v5, s26, v211
    v_fma_f32 v6, v6, s26, v211
    v_fma_f32 v7, v7, s26, v211
    v_mul_f32 v0, v0, v138
    v_mul_f32 v1, v1, v142
    v_mul_f32 v2, v2, v146
    v_mul_f32 v3, v3, v150
    v_mul_f32 v4, v4, v154
    v_mul_f32 v5, v5, v158
    v_mul_f32 v6, v6, v162
    v_mul_f32 v7, v7, v166
    v_exp_f32 v0, v0
    v_exp_f32 v1, v1
    v_exp_f32 v2, v2
    v_exp_f32 v3, v3
    v_exp_f32 v4, v4
    v_exp_f32 v5, v5
    v_exp_f32 v6, v6
    v_exp_f32 v7, v7
    v_add_f32 v0, 1.0, v0
    v_add_f32 v1, 1.0, v1
    v_add_f32 v2, 1.0, v2
    v_add_f32 v3, 1.0, v3
    v_add_f32 v4, 1.0, v4
    v_add_f32 v5, 1.0, v5
    v_add_f32 v6, 1.0, v6
    v_add_f32 v7, 1.0, v7
    v_rcp_f32 v0, v0
    v_rcp_f32 v1, v1
    v_rcp_f32 v2, v2
    v_rcp_f32 v3, v3
    v_rcp_f32 v4, v4
    v_rcp_f32 v5, v5
    v_rcp_f32 v6, v6
    v_rcp_f32 v7, v7
    v_mul_f32 v0, v0, v138
    v_mul_f32 v1, v1, v142
    v_mul_f32 v2, v2, v146
    v_mul_f32 v3, v3, v150
    v_mul_f32 v4, v4, v154
    v_mul_f32 v5, v5, v158
    v_mul_f32 v6, v6, v162
    v_mul_f32 v7, v7, v166
    v_cvt_pk_bf16_f32 v40, v0, v1
    v_cvt_pk_bf16_f32 v41, v2, v3
    v_cvt_pk_bf16_f32 v42, v4, v5
    v_cvt_pk_bf16_f32 v43, v6, v7
    s_add_u32 s27, s24, 83968
    buffer_store_dwordx4 v[40:43], v210, s[32:35], s27 offen sc1
    v_fma_f32 v168, v168, v216, v224
    v_fma_f32 v172, v172, v217, v225
    v_fma_f32 v176, v176, v218, v226
    v_fma_f32 v180, v180, v219, v227
    v_fma_f32 v184, v184, v220, v228
    v_fma_f32 v188, v188, v221, v229
    v_fma_f32 v192, v192, v222, v230
    v_fma_f32 v196, v196, v223, v231
    v_mul_f32 v0, v168, v168
    v_mul_f32 v1, v172, v172
    v_mul_f32 v2, v176, v176
    v_mul_f32 v3, v180, v180
    v_mul_f32 v4, v184, v184
    v_mul_f32 v5, v188, v188
    v_mul_f32 v6, v192, v192
    v_mul_f32 v7, v196, v196
    v_fma_f32 v0, v0, s26, v211
    v_fma_f32 v1, v1, s26, v211
    v_fma_f32 v2, v2, s26, v211
    v_fma_f32 v3, v3, s26, v211
    v_fma_f32 v4, v4, s26, v211
    v_fma_f32 v5, v5, s26, v211
    v_fma_f32 v6, v6, s26, v211
    v_fma_f32 v7, v7, s26, v211
    v_mul_f32 v0, v0, v168
    v_mul_f32 v1, v1, v172
    v_mul_f32 v2, v2, v176
    v_mul_f32 v3, v3, v180
    v_mul_f32 v4, v4, v184
    v_mul_f32 v5, v5, v188
    v_mul_f32 v6, v6, v192
    v_mul_f32 v7, v7, v196
    v_exp_f32 v0, v0
    v_exp_f32 v1, v1
    v_exp_f32 v2, v2
    v_exp_f32 v3, v3
    v_exp_f32 v4, v4
    v_exp_f32 v5, v5
    v_exp_f32 v6, v6
    v_exp_f32 v7, v7
    v_add_f32 v0, 1.0, v0
    v_add_f32 v1, 1.0, v1
    v_add_f32 v2, 1.0, v2
    v_add_f32 v3, 1.0, v3
    v_add_f32 v4, 1.0, v4
    v_add_f32 v5, 1.0, v5
    v_add_f32 v6, 1.0, v6
    v_add_f32 v7, 1.0, v7
    v_rcp_f32 v0, v0
    v_rcp_f32 v1, v1
    v_rcp_f32 v2, v2
    v_rcp_f32 v3, v3
    v_rcp_f32 v4, v4
    v_rcp_f32 v5, v5
    v_rcp_f32 v6, v6
    v_rcp_f32 v7, v7
    v_mul_f32 v0, v0, v168
    v_mul_f32 v1, v1, v172
    v_mul_f32 v2, v2, v176
    v_mul_f32 v3, v3, v180
    v_mul_f32 v4, v4, v184
    v_mul_f32 v5, v5, v188
    v_mul_f32 v6, v6, v192
    v_mul_f32 v7, v7, v196
    v_cvt_pk_bf16_f32 v44, v0, v1
    v_cvt_pk_bf16_f32 v45, v2, v3
    v_cvt_pk_bf16_f32 v46, v4, v5
    v_cvt_pk_bf16_f32 v47, v6, v7
    s_add_u32 s27, s24, 131072
    buffer_store_dwordx4 v[44:47], v210, s[32:35], s27 offen sc1
    v_fma_f32 v169, v169, v216, v224
    v_fma_f32 v173, v173, v217, v225
    v_fma_f32 v177, v177, v218, v226
    v_fma_f32 v181, v181, v219, v227
    v_fma_f32 v185, v185, v220, v228
    v_fma_f32 v189, v189, v221, v229
    v_fma_f32 v193, v193, v222, v230
    v_fma_f32 v197, v197, v223, v231
    v_mul_f32 v0, v169, v169
    v_mul_f32 v1, v173, v173
    v_mul_f32 v2, v177, v177
    v_mul_f32 v3, v181, v181
    v_mul_f32 v4, v185, v185
    v_mul_f32 v5, v189, v189
    v_mul_f32 v6, v193, v193
    v_mul_f32 v7, v197, v197
    v_fma_f32 v0, v0, s26, v211
    v_fma_f32 v1, v1, s26, v211
    v_fma_f32 v2, v2, s26, v211
    v_fma_f32 v3, v3, s26, v211
    v_fma_f32 v4, v4, s26, v211
    v_fma_f32 v5, v5, s26, v211
    v_fma_f32 v6, v6, s26, v211
    v_fma_f32 v7, v7, s26, v211
    v_mul_f32 v0, v0, v169
    v_mul_f32 v1, v1, v173
    v_mul_f32 v2, v2, v177
    v_mul_f32 v3, v3, v181
    v_mul_f32 v4, v4, v185
    v_mul_f32 v5, v5, v189
    v_mul_f32 v6, v6, v193
    v_mul_f32 v7, v7, v197
    v_exp_f32 v0, v0
    v_exp_f32 v1, v1
    v_exp_f32 v2, v2
    v_exp_f32 v3, v3
    v_exp_f32 v4, v4
    v_exp_f32 v5, v5
    v_exp_f32 v6, v6
    v_exp_f32 v7, v7
    v_add_f32 v0, 1.0, v0
    v_add_f32 v1, 1.0, v1
    v_add_f32 v2, 1.0, v2
    v_add_f32 v3, 1.0, v3
    v_add_f32 v4, 1.0, v4
    v_add_f32 v5, 1.0, v5
    v_add_f32 v6, 1.0, v6
    v_add_f32 v7, 1.0, v7
    v_rcp_f32 v0, v0
    v_rcp_f32 v1, v1
    v_rcp_f32 v2, v2
    v_rcp_f32 v3, v3
    v_rcp_f32 v4, v4
    v_rcp_f32 v5, v5
    v_rcp_f32 v6, v6
    v_rcp_f32 v7, v7
    v_mul_f32 v0, v0, v169
    v_mul_f32 v1, v1, v173
    v_mul_f32 v2, v2, v177
    v_mul_f32 v3, v3, v181
    v_mul_f32 v4, v4, v185
    v_mul_f32 v5, v5, v189
    v_mul_f32 v6, v6, v193
    v_mul_f32 v7, v7, v197
    v_cvt_pk_bf16_f32 v16, v0, v1
    v_cvt_pk_bf16_f32 v17, v2, v3
    v_cvt_pk_bf16_f32 v18, v4, v5
    v_cvt_pk_bf16_f32 v19, v6, v7
    s_add_u32 s27, s24, 132096
    buffer_store_dwordx4 v[16:19], v210, s[32:35], s27 offen sc1
    v_fma_f32 v170, v170, v216, v224
    v_fma_f32 v174, v174, v217, v225
    v_fma_f32 v178, v178, v218, v226
    v_fma_f32 v182, v182, v219, v227
    v_fma_f32 v186, v186, v220, v228
    v_fma_f32 v190, v190, v221, v229
    v_fma_f32 v194, v194, v222, v230
    v_fma_f32 v198, v198, v223, v231
    v_mul_f32 v0, v170, v170
    v_mul_f32 v1, v174, v174
    v_mul_f32 v2, v178, v178
    v_mul_f32 v3, v182, v182
    v_mul_f32 v4, v186, v186
    v_mul_f32 v5, v190, v190
    v_mul_f32 v6, v194, v194
    v_mul_f32 v7, v198, v198
    v_fma_f32 v0, v0, s26, v211
    v_fma_f32 v1, v1, s26, v211
    v_fma_f32 v2, v2, s26, v211
    v_fma_f32 v3, v3, s26, v211
    v_fma_f32 v4, v4, s26, v211
    v_fma_f32 v5, v5, s26, v211
    v_fma_f32 v6, v6, s26, v211
    v_fma_f32 v7, v7, s26, v211
    v_mul_f32 v0, v0, v170
    v_mul_f32 v1, v1, v174
    v_mul_f32 v2, v2, v178
    v_mul_f32 v3, v3, v182
    v_mul_f32 v4, v4, v186
    v_mul_f32 v5, v5, v190
    v_mul_f32 v6, v6, v194
    v_mul_f32 v7, v7, v198
    v_exp_f32 v0, v0
    v_exp_f32 v1, v1
    v_exp_f32 v2, v2
    v_exp_f32 v3, v3
    v_exp_f32 v4, v4
    v_exp_f32 v5, v5
    v_exp_f32 v6, v6
    v_exp_f32 v7, v7
    v_add_f32 v0, 1.0, v0
    v_add_f32 v1, 1.0, v1
    v_add_f32 v2, 1.0, v2
    v_add_f32 v3, 1.0, v3
    v_add_f32 v4, 1.0, v4
    v_add_f32 v5, 1.0, v5
    v_add_f32 v6, 1.0, v6
    v_add_f32 v7, 1.0, v7
    v_rcp_f32 v0, v0
    v_rcp_f32 v1, v1
    v_rcp_f32 v2, v2
    v_rcp_f32 v3, v3
    v_rcp_f32 v4, v4
    v_rcp_f32 v5, v5
    v_rcp_f32 v6, v6
    v_rcp_f32 v7, v7
    v_mul_f32 v0, v0, v170
    v_mul_f32 v1, v1, v174
    v_mul_f32 v2, v2, v178
    v_mul_f32 v3, v3, v182
    v_mul_f32 v4, v4, v186
    v_mul_f32 v5, v5, v190
    v_mul_f32 v6, v6, v194
    v_mul_f32 v7, v7, v198
    v_cvt_pk_bf16_f32 v20, v0, v1
    v_cvt_pk_bf16_f32 v21, v2, v3
    v_cvt_pk_bf16_f32 v22, v4, v5
    v_cvt_pk_bf16_f32 v23, v6, v7
    s_add_u32 s27, s24, 133120
    buffer_store_dwordx4 v[20:23], v210, s[32:35], s27 offen sc1
L_k45_fin:
L_k45_end:
    s_endpgm
L_code_end:
    s_endpgm
.section .rodata,"a"
.p2align 6
.amdhsa_kernel xform_kernel
  .amdhsa_next_free_vgpr 232
  .amdhsa_next_free_sgpr 96
  .amdhsa_accum_offset 232
  .amdhsa_group_segment_fixed_size 0
  .amdhsa_kernarg_size 56
  .amdhsa_user_sgpr_count 2
  .amdhsa_user_sgpr_kernarg_segment_ptr 1
  .amdhsa_system_sgpr_workgroup_id_x 1
  .amdhsa_float_denorm_mode_32 3
.end_amdhsa_kernel

.p2align 6
.amdhsa_kernel gemm_kernel
  .amdhsa_next_free_vgpr 256
  .amdhsa_next_free_sgpr 96
  .amdhsa_accum_offset 256
  .amdhsa_group_segment_fixed_size 0
  .amdhsa_kernarg_size 56
  .amdhsa_user_sgpr_count 2
  .amdhsa_user_sgpr_kernarg_segment_ptr 1
  .amdhsa_system_sgpr_workgroup_id_x 1
  .amdhsa_float_denorm_mode_32 3
.end_amdhsa_kernel

.p2align 6
.amdhsa_kernel final_kernel
  .amdhsa_next_free_vgpr 240
  .amdhsa_next_free_sgpr 96
  .amdhsa_accum_offset 240
  .amdhsa_group_segment_fixed_size 0
  .amdhsa_kernarg_size 56
  .amdhsa_user_sgpr_count 2
  .amdhsa_user_sgpr_kernarg_segment_ptr 1
  .amdhsa_system_sgpr_workgroup_id_x 1
  .amdhsa_float_denorm_mode_32 3
.end_amdhsa_kernel
```

```asm
; @launch kernel=xform_kernel grid=(256,1,1) block=(256,1,1) lds=12352
; @launch kernel=gemm_kernel grid=(256,1,1) block=(512,1,1) lds=155648
; @launch kernel=final_kernel grid=(224,1,1) block=(512,1,1) lds=82944
.amdgcn_target "amdgcn-amd-amdhsa--gfx950"
.text
.globl xform_kernel
.p2align 8
.type xform_kernel,@function
xform_kernel:
    s_cmp_ge_u32 s2, 256
    s_cbranch_scc1 L_k12_end
    s_load_dwordx4 s[4:7], s[0:1], 0
    s_load_dwordx4 s[36:39], s[0:1], 40
    v_lshrrev_b32 v213, 6, v0
    s_cmp_ge_u32 s2, 8
    s_cbranch_scc1 L_nopf12
    v_readfirstlane_b32 s10, v213
    s_nop 3
    s_cmp_lg_u32 s10, 3
    s_cbranch_scc1 L_nopf12
    s_getpc_b64 s[60:61]
L_pf_k12:
    s_sub_u32 s60, s60, L_pf_k12-xform_kernel
    s_subb_u32 s61, s61, 0
    v_mbcnt_lo_u32_b32 v184, -1, 0
    v_mbcnt_hi_u32_b32 v184, -1, v184
    v_lshlrev_b32 v184, 6, v184
    v_add_u32 v185, 0, v184
    v_min_u32 v185, L_code_end-xform_kernel-4, v185
    v_mov_b32 v187, s61
    v_add_co_u32 v186, vcc, s60, v185
    s_nop 1
    v_addc_co_u32 v187, vcc, 0, v187, vcc
    global_load_dword v188, v[186:187], off
    v_add_u32 v185, 4096, v184
    v_min_u32 v185, L_code_end-xform_kernel-4, v185
    v_mov_b32 v187, s61
    v_add_co_u32 v186, vcc, s60, v185
    s_nop 1
    v_addc_co_u32 v187, vcc, 0, v187, vcc
    global_load_dword v188, v[186:187], off
    v_add_u32 v185, 8192, v184
    v_min_u32 v185, L_code_end-xform_kernel-4, v185
    v_mov_b32 v187, s61
    v_add_co_u32 v186, vcc, s60, v185
    s_nop 1
    v_addc_co_u32 v187, vcc, 0, v187, vcc
    global_load_dword v188, v[186:187], off
    v_add_u32 v185, 12288, v184
    v_min_u32 v185, L_code_end-xform_kernel-4, v185
    v_mov_b32 v187, s61
    v_add_co_u32 v186, vcc, s60, v185
    s_nop 1
    v_addc_co_u32 v187, vcc, 0, v187, vcc
    global_load_dword v188, v[186:187], off
    v_add_u32 v185, 16384, v184
    v_min_u32 v185, L_code_end-xform_kernel-4, v185
    v_mov_b32 v187, s61
    v_add_co_u32 v186, vcc, s60, v185
    s_nop 1
    v_addc_co_u32 v187, vcc, 0, v187, vcc
    global_load_dword v188, v[186:187], off
    v_add_u32 v185, 20480, v184
    v_min_u32 v185, L_code_end-xform_kernel-4, v185
    v_mov_b32 v187, s61
    v_add_co_u32 v186, vcc, s60, v185
    s_nop 1
    v_addc_co_u32 v187, vcc, 0, v187, vcc
    global_load_dword v188, v[186:187], off
    v_add_u32 v185, 24576, v184
    v_min_u32 v185, L_code_end-xform_kernel-4, v185
    v_mov_b32 v187, s61
    v_add_co_u32 v186, vcc, s60, v185
    s_nop 1
    v_addc_co_u32 v187, vcc, 0, v187, vcc
    global_load_dword v188, v[186:187], off
    v_add_u32 v185, 28672, v184
    v_min_u32 v185, L_code_end-xform_kernel-4, v185
    v_mov_b32 v187, s61
    v_add_co_u32 v186, vcc, s60, v185
    s_nop 1
    v_addc_co_u32 v187, vcc, 0, v187, vcc
    global_load_dword v188, v[186:187], off
    v_add_u32 v185, 32768, v184
    v_min_u32 v185, L_code_end-xform_kernel-4, v185
    v_mov_b32 v187, s61
    v_add_co_u32 v186, vcc, s60, v185
    s_nop 1
    v_addc_co_u32 v187, vcc, 0, v187, vcc
    global_load_dword v188, v[186:187], off
    v_add_u32 v185, 36864, v184
    v_min_u32 v185, L_code_end-xform_kernel-4, v185
    v_mov_b32 v187, s61
    v_add_co_u32 v186, vcc, s60, v185
    s_nop 1
    v_addc_co_u32 v187, vcc, 0, v187, vcc
    global_load_dword v188, v[186:187], off
L_nopf12:
    v_and_b32 v208, 63, v0
    v_lshrrev_b32 v213, 6, v0
    v_and_b32 v209, 15, v208
    v_readfirstlane_b32 s10, v213
    v_lshrrev_b32 v210, 4, v208
    v_lshlrev_b32 v223, 4, v208
    v_mov_b32 v222, 0
    s_mov_b32 s30, 0x05040100
    s_mov_b32 s31, 0x07060302
    s_mov_b32 s32, 0x01000100
    s_mov_b32 s33, 0x03020302
    s_mov_b32 s40, s2
    s_add_u32 s42, s2, 256
    s_mov_b32 s41, 0
    s_mov_b32 s43, 0
    v_lshlrev_b32 v224, 14, v210
    v_lshl_add_u32 v224, v209, 4, v224
    v_lshlrev_b32 v225, 22, v210
    v_lshrrev_b32 v213, 2, v209
    v_lshl_add_u32 v225, v213, 6, v225
    v_and_b32 v213, 1, v209
    v_lshl_add_u32 v225, v213, 5, v225
    v_bfe_u32 v213, v209, 1, 1
    v_lshl_add_u32 v225, v213, 3, v225
    v_lshrrev_b32 v213, 2, v209
    s_mov_b32 s24, 688128
    v_mul_u32_u24 v226, s24, v213
    s_mov_b32 s24, 43008
    v_mad_u32_u24 v226, v210, s24, v226
    s_mov_b32 s24, 32768
    v_mul_u32_u24 v227, s24, v210
    s_waitcnt lgkmcnt(0)
    s_mov_b32 s16, s38
    s_and_b32 s17, s39, 0xffff
    s_mov_b32 s18, 268435456
    s_mov_b32 s19, 0x00020000
    s_mov_b32 s44, s36
    s_and_b32 s45, s37, 0xffff
    s_mov_b32 s46, 256
    s_mov_b32 s47, 0x00020000
    s_cmp_ge_u32 s40, 1696
    s_cbranch_scc1 L_ld_done0
    s_cmp_ge_u32 s40, 672
    s_cbranch_scc1 L_ld_w0
    s_cmp_ge_u32 s40, 336
    s_cselect_b32 s11, 1, 0
    s_mul_i32 s12, s11, 336
    s_sub_u32 s12, s40, s12
    s_and_b32 s13, s12, 7
    s_lshr_b32 s14, s12, 3
    s_lshl_b32 s14, s14, 2
    s_add_u32 s14, s14, s10
    s_mul_i32 s15, s11, 16384000
    s_add_u32 s34, s4, s15
    s_addc_u32 s35, s5, 0
    s_mov_b32 s20, s34
    s_and_b32 s21, s35, 0xffff
    s_mov_b32 s22, 16384000
    s_mov_b32 s23, 0x00020000
    s_mul_i32 s15, s14, 98304
    s_lshl_b32 s24, s13, 8
    s_add_u32 s15, s15, s24
    s_add_u32 s25, s15, 0
    buffer_load_dwordx4 v[0:3], v224, s[20:23], s25 offen
    s_add_u32 s25, s15, 2048
    buffer_load_dwordx4 v[4:7], v224, s[20:23], s25 offen
    s_add_u32 s25, s15, 4096
    buffer_load_dwordx4 v[8:11], v224, s[20:23], s25 offen
    s_add_u32 s25, s15, 6144
    buffer_load_dwordx4 v[12:15], v224, s[20:23], s25 offen
    s_add_u32 s25, s15, 8192
    buffer_load_dwordx4 v[16:19], v224, s[20:23], s25 offen
    s_add_u32 s25, s15, 10240
    buffer_load_dwordx4 v[20:23], v224, s[20:23], s25 offen
    s_add_u32 s25, s15, 12288
    buffer_load_dwordx4 v[24:27], v224, s[20:23], s25 offen
    s_add_u32 s25, s15, 14336
    buffer_load_dwordx4 v[28:31], v224, s[20:23], s25 offen
    s_add_u32 s25, s15, 65536
    buffer_load_dwordx4 v[32:35], v224, s[20:23], s25 offen
    s_add_u32 s25, s15, 67584
    buffer_load_dwordx4 v[36:39], v224, s[20:23], s25 offen
    s_add_u32 s25, s15, 69632
    buffer_load_dwordx4 v[40:43], v224, s[20:23], s25 offen
    s_add_u32 s25, s15, 71680
    buffer_load_dwordx4 v[44:47], v224, s[20:23], s25 offen
    s_add_u32 s25, s15, 73728
    buffer_load_dwordx4 v[48:51], v224, s[20:23], s25 offen
    s_add_u32 s25, s15, 75776
    buffer_load_dwordx4 v[52:55], v224, s[20:23], s25 offen
    s_add_u32 s25, s15, 77824
    buffer_load_dwordx4 v[56:59], v224, s[20:23], s25 offen
    s_add_u32 s25, s15, 79872
    buffer_load_dwordx4 v[60:63], v224, s[20:23], s25 offen
    s_branch L_ld_done0
L_ld_w0:
    s_sub_u32 s12, s40, 672
    s_and_b32 s13, s12, 3
    s_lshr_b32 s14, s12, 2
    s_lshl_b32 s14, s14, 2
    s_add_u32 s14, s14, s10
    s_mov_b32 s20, s6
    s_and_b32 s21, s7, 0xffff
    s_mov_b32 s22, 16252928
    s_mov_b32 s23, 0x00020000
    s_lshl_b32 s15, s14, 10
    s_lshl_b32 s24, s13, 8
    s_add_u32 s15, s15, s24
    s_add_u32 s25, s15, 0
    buffer_load_dwordx2 v[0:1], v225, s[20:23], s25 offen
    buffer_load_dwordx2 v[2:3], v225, s[20:23], s25 offen offset:16
    s_add_u32 s25, s15, 1048576
    buffer_load_dwordx2 v[4:5], v225, s[20:23], s25 offen
    buffer_load_dwordx2 v[6:7], v225, s[20:23], s25 offen offset:16
    s_add_u32 s25, s15, 2097152
    buffer_load_dwordx2 v[8:9], v225, s[20:23], s25 offen
    buffer_load_dwordx2 v[10:11], v225, s[20:23], s25 offen offset:16
    s_add_u32 s25, s15, 3145728
    buffer_load_dwordx2 v[12:13], v225, s[20:23], s25 offen
    buffer_load_dwordx2 v[14:15], v225, s[20:23], s25 offen offset:16
L_ld_done0:
    v_lshrrev_b32 v213, 2, v209
    v_lshlrev_b32 v213, 1, v213
    v_bfe_u32 v214, v209, 1, 1
    v_add_u32 v213, v213, v214
    s_lshl_b32 s24, s10, 3
    v_add_u32 v213, s24, v213
    v_lshl_add_u32 v213, v213, 1, 1
    v_and_b32 v214, 1, v209
    v_lshlrev_b32 v214, 5, v214
    v_lshlrev_b32 v215, 3, v210
    v_mad_u32_u24 v160, v213, v215, v214
    v_add_u32 v161, v160, v213
    v_add_u32 v162, v161, v213
    v_add_u32 v163, v162, v213
    v_add_u32 v164, v163, v213
    v_add_u32 v165, v164, v213
    v_add_u32 v166, v165, v213
    v_add_u32 v167, v166, v213
    v_and_b32 v160, 127, v160
    v_cvt_f32_u32 v160, v160
    v_mul_f32 v160, 0x3c000000, v160
    v_cos_f32 v160, v160
    v_and_b32 v161, 127, v161
    v_cvt_f32_u32 v161, v161
    v_mul_f32 v161, 0x3c000000, v161
    v_cos_f32 v161, v161
    v_and_b32 v162, 127, v162
    v_cvt_f32_u32 v162, v162
    v_mul_f32 v162, 0x3c000000, v162
    v_cos_f32 v162, v162
    v_and_b32 v163, 127, v163
    v_cvt_f32_u32 v163, v163
    v_mul_f32 v163, 0x3c000000, v163
    v_cos_f32 v163, v163
    v_and_b32 v164, 127, v164
    v_cvt_f32_u32 v164, v164
    v_mul_f32 v164, 0x3c000000, v164
    v_cos_f32 v164, v164
    v_and_b32 v165, 127, v165
    v_cvt_f32_u32 v165, v165
    v_mul_f32 v165, 0x3c000000, v165
    v_cos_f32 v165, v165
    v_and_b32 v166, 127, v166
    v_cvt_f32_u32 v166, v166
    v_mul_f32 v166, 0x3c000000, v166
    v_cos_f32 v166, v166
    v_and_b32 v167, 127, v167
    v_cvt_f32_u32 v167, v167
    v_mul_f32 v167, 0x3c000000, v167
    v_cos_f32 v167, v167
    v_cvt_pk_bf16_f32 v176, v160, v161
    v_cvt_pk_bf16_f32 v177, v162, v163
    v_cvt_pk_bf16_f32 v178, v164, v165
    v_cvt_pk_bf16_f32 v179, v166, v167
    s_lshl_b32 s24, s10, 11
    v_add_u32 v216, s24, v223
    ds_write_b128 v216, v[176:179] offset:0
    v_lshlrev_b32 v215, 3, v210
    v_add_u32 v215, 32, v215
    v_mad_u32_u24 v160, v213, v215, v214
    v_add_u32 v161, v160, v213
    v_add_u32 v162, v161, v213
    v_add_u32 v163, v162, v213
    v_add_u32 v164, v163, v213
    v_add_u32 v165, v164, v213
    v_add_u32 v166, v165, v213
    v_add_u32 v167, v166, v213
    v_and_b32 v160, 127, v160
    v_cvt_f32_u32 v160, v160
    v_mul_f32 v160, 0x3c000000, v160
    v_cos_f32 v160, v160
    v_and_b32 v161, 127, v161
    v_cvt_f32_u32 v161, v161
    v_mul_f32 v161, 0x3c000000, v161
    v_cos_f32 v161, v161
    v_and_b32 v162, 127, v162
    v_cvt_f32_u32 v162, v162
    v_mul_f32 v162, 0x3c000000, v162
    v_cos_f32 v162, v162
    v_and_b32 v163, 127, v163
    v_cvt_f32_u32 v163, v163
    v_mul_f32 v163, 0x3c000000, v163
    v_cos_f32 v163, v163
    v_and_b32 v164, 127, v164
    v_cvt_f32_u32 v164, v164
    v_mul_f32 v164, 0x3c000000, v164
    v_cos_f32 v164, v164
    v_and_b32 v165, 127, v165
    v_cvt_f32_u32 v165, v165
    v_mul_f32 v165, 0x3c000000, v165
    v_cos_f32 v165, v165
    v_and_b32 v166, 127, v166
    v_cvt_f32_u32 v166, v166
    v_mul_f32 v166, 0x3c000000, v166
    v_cos_f32 v166, v166
    v_and_b32 v167, 127, v167
    v_cvt_f32_u32 v167, v167
    v_mul_f32 v167, 0x3c000000, v167
    v_cos_f32 v167, v167
    v_cvt_pk_bf16_f32 v176, v160, v161
    v_cvt_pk_bf16_f32 v177, v162, v163
    v_cvt_pk_bf16_f32 v178, v164, v165
    v_cvt_pk_bf16_f32 v179, v166, v167
    s_lshl_b32 s24, s10, 11
    v_add_u32 v216, s24, v223
    ds_write_b128 v216, v[176:179] offset:1024
    v_lshlrev_b32 v215, 2, v210
    v_mad_u32_u24 v160, v213, v215, v214
    v_add_u32 v161, v160, v213
    v_add_u32 v162, v161, v213
    v_add_u32 v163, v162, v213
    v_and_b32 v160, 127, v160
    v_cvt_f32_u32 v160, v160
    v_mul_f32 v160, 0x3c000000, v160
    v_cos_f32 v160, v160
    v_and_b32 v161, 127, v161
    v_cvt_f32_u32 v161, v161
    v_mul_f32 v161, 0x3c000000, v161
    v_cos_f32 v161, v161
    v_and_b32 v162, 127, v162
    v_cvt_f32_u32 v162, v162
    v_mul_f32 v162, 0x3c000000, v162
    v_cos_f32 v162, v162
    v_and_b32 v163, 127, v163
    v_cvt_f32_u32 v163, v163
    v_mul_f32 v163, 0x3c000000, v163
    v_cos_f32 v163, v163
    v_cvt_pk_bf16_f32 v180, v160, v160
    v_lshlrev_b32 v181, 16, v180
    v_sub_f32 v181, v160, v181
    v_cvt_pk_bf16_f32 v181, v181, v181
    v_perm_b32 v176, v181, v180, s30
    v_cvt_pk_bf16_f32 v180, v161, v161
    v_lshlrev_b32 v181, 16, v180
    v_sub_f32 v181, v161, v181
    v_cvt_pk_bf16_f32 v181, v181, v181
    v_perm_b32 v177, v181, v180, s30
    v_cvt_pk_bf16_f32 v180, v162, v162
    v_lshlrev_b32 v181, 16, v180
    v_sub_f32 v181, v162, v181
    v_cvt_pk_bf16_f32 v181, v181, v181
    v_perm_b32 v178, v181, v180, s30
    v_cvt_pk_bf16_f32 v180, v163, v163
    v_lshlrev_b32 v181, 16, v180
    v_sub_f32 v181, v163, v181
    v_cvt_pk_bf16_f32 v181, v181, v181
    v_perm_b32 v179, v181, v180, s30
    s_lshl_b32 s24, s10, 10
    v_add_u32 v216, s24, v223
    ds_write_b128 v216, v[176:179] offset:8192
    s_waitcnt lgkmcnt(0)
    s_barrier
L_k12_loop:
    s_cmp_lg_u32 s10, 0
    s_cbranch_scc1 L_nofetch0
    v_mov_b32 v221, 1
    s_mov_b64 exec, 1
    buffer_atomic_add v221, v222, s[44:47], 0 offen sc0 sc1
    s_mov_b64 exec, -1
L_nofetch0:
    s_cmp_ge_u32 s42, 1696
    s_cbranch_scc1 L_ld_done1
    s_cmp_ge_u32 s42, 672
    s_cbranch_scc1 L_ld_w1
    s_cmp_ge_u32 s42, 336
    s_cselect_b32 s11, 1, 0
    s_mul_i32 s12, s11, 336
    s_sub_u32 s12, s42, s12
    s_and_b32 s13, s12, 7
    s_lshr_b32 s14, s12, 3
    s_lshl_b32 s14, s14, 2
    s_add_u32 s14, s14, s10
    s_mul_i32 s15, s11, 16384000
    s_add_u32 s34, s4, s15
    s_addc_u32 s35, s5, 0
    s_mov_b32 s20, s34
    s_and_b32 s21, s35, 0xffff
    s_mov_b32 s22, 16384000
    s_mov_b32 s23, 0x00020000
    s_mul_i32 s15, s14, 98304
    s_lshl_b32 s24, s13, 8
    s_add_u32 s15, s15, s24
    s_add_u32 s25, s15, 0
    buffer_load_dwordx4 v[64:67], v224, s[20:23], s25 offen
    s_add_u32 s25, s15, 2048
    buffer_load_dwordx4 v[68:71], v224, s[20:23], s25 offen
    s_add_u32 s25, s15, 4096
    buffer_load_dwordx4 v[72:75], v224, s[20:23], s25 offen
    s_add_u32 s25, s15, 6144
    buffer_load_dwordx4 v[76:79], v224, s[20:23], s25 offen
    s_add_u32 s25, s15, 8192
    buffer_load_dwordx4 v[80:83], v224, s[20:23], s25 offen
    s_add_u32 s25, s15, 10240
    buffer_load_dwordx4 v[84:87], v224, s[20:23], s25 offen
    s_add_u32 s25, s15, 12288
    buffer_load_dwordx4 v[88:91], v224, s[20:23], s25 offen
    s_add_u32 s25, s15, 14336
    buffer_load_dwordx4 v[92:95], v224, s[20:23], s25 offen
    s_add_u32 s25, s15, 65536
    buffer_load_dwordx4 v[96:99], v224, s[20:23], s25 offen
    s_add_u32 s25, s15, 67584
    buffer_load_dwordx4 v[100:103], v224, s[20:23], s25 offen
    s_add_u32 s25, s15, 69632
    buffer_load_dwordx4 v[104:107], v224, s[20:23], s25 offen
    s_add_u32 s25, s15, 71680
    buffer_load_dwordx4 v[108:111], v224, s[20:23], s25 offen
    s_add_u32 s25, s15, 73728
    buffer_load_dwordx4 v[112:115], v224, s[20:23], s25 offen
    s_add_u32 s25, s15, 75776
    buffer_load_dwordx4 v[116:119], v224, s[20:23], s25 offen
    s_add_u32 s25, s15, 77824
    buffer_load_dwordx4 v[120:123], v224, s[20:23], s25 offen
    s_add_u32 s25, s15, 79872
    buffer_load_dwordx4 v[124:127], v224, s[20:23], s25 offen
    s_branch L_ld_done1
L_ld_w1:
    s_sub_u32 s12, s42, 672
    s_and_b32 s13, s12, 3
    s_lshr_b32 s14, s12, 2
    s_lshl_b32 s14, s14, 2
    s_add_u32 s14, s14, s10
    s_mov_b32 s20, s6
    s_and_b32 s21, s7, 0xffff
    s_mov_b32 s22, 16252928
    s_mov_b32 s23, 0x00020000
    s_lshl_b32 s15, s14, 10
    s_lshl_b32 s24, s13, 8
    s_add_u32 s15, s15, s24
    s_add_u32 s25, s15, 0
    buffer_load_dwordx2 v[64:65], v225, s[20:23], s25 offen
    buffer_load_dwordx2 v[66:67], v225, s[20:23], s25 offen offset:16
    s_add_u32 s25, s15, 1048576
    buffer_load_dwordx2 v[68:69], v225, s[20:23], s25 offen
    buffer_load_dwordx2 v[70:71], v225, s[20:23], s25 offen offset:16
    s_add_u32 s25, s15, 2097152
    buffer_load_dwordx2 v[72:73], v225, s[20:23], s25 offen
    buffer_load_dwordx2 v[74:75], v225, s[20:23], s25 offen offset:16
    s_add_u32 s25, s15, 3145728
    buffer_load_dwordx2 v[76:77], v225, s[20:23], s25 offen
    buffer_load_dwordx2 v[78:79], v225, s[20:23], s25 offen offset:16
L_ld_done1:
    s_cmp_lg_u32 s43, 0
    s_cbranch_scc1 L_notfirst
    s_cmp_ge_u32 s42, 1696
    s_cbranch_scc1 L_w0_f
    s_cmp_ge_u32 s42, 672
    s_cbranch_scc1 L_w8_f
    s_waitcnt vmcnt(16)
    s_branch L_wd_f
L_w8_f:
    s_waitcnt vmcnt(8)
    s_branch L_wd_f
L_w0_f:
    s_waitcnt vmcnt(0)
L_wd_f:
    s_mov_b32 s43, 1
    s_branch L_wfin
L_notfirst:
    s_cmp_ge_u32 s42, 1696
    s_cbranch_scc1 L_w0_a0
    s_cmp_ge_u32 s42, 672
    s_cbranch_scc1 L_w8_a0
    s_waitcnt vmcnt(32)
    s_branch L_wd_a0
L_w8_a0:
    s_waitcnt vmcnt(24)
    s_branch L_wd_a0
L_w0_a0:
    s_waitcnt vmcnt(16)
L_wd_a0:
L_wfin:
    s_cmp_ge_u32 s40, 672
    s_cbranch_scc1 L_cw0
    s_cmp_ge_u32 s40, 336
    s_cselect_b32 s11, 1, 0
    s_mul_i32 s12, s11, 336
    s_sub_u32 s12, s40, s12
    s_and_b32 s13, s12, 7
    s_lshr_b32 s14, s12, 3
    s_lshl_b32 s14, s14, 2
    s_add_u32 s14, s14, s10
    ds_read_b128 v[128:131], v223 offset:0
    ds_read_b128 v[132:135], v223 offset:1024
    ds_read_b128 v[136:139], v223 offset:2048
    ds_read_b128 v[140:143], v223 offset:3072
    ds_read_b128 v[144:147], v223 offset:4096
    ds_read_b128 v[148:151], v223 offset:5120
    ds_read_b128 v[152:155], v223 offset:6144
    ds_read_b128 v[156:159], v223 offset:7168
    s_bfe_u32 s24, s14, 0x10003
    s_mul_i32 s24, s24, 3
    v_and_b32 v213, 3, v209
    v_xor_b32 v213, s24, v213
    v_lshl_add_u32 v212, v213, 4, v226
    s_mul_i32 s24, s11, 22020096
    s_mul_i32 s25, s13, 2752512
    s_add_u32 s24, s24, s25
    s_lshl_b32 s25, s14, 6
    s_add_u32 s24, s24, s25
    s_add_u32 s24, s24, 67108864
    v_perm_b32 v160, v4, v0, s30
    v_perm_b32 v161, v12, v8, s30
    v_perm_b32 v162, v20, v16, s30
    v_perm_b32 v163, v28, v24, s30
    v_perm_b32 v164, v4, v0, s31
    v_perm_b32 v165, v12, v8, s31
    v_perm_b32 v166, v20, v16, s31
    v_perm_b32 v167, v28, v24, s31
    v_perm_b32 v168, v36, v32, s30
    v_perm_b32 v169, v44, v40, s30
    v_perm_b32 v170, v52, v48, s30
    v_perm_b32 v171, v60, v56, s30
    v_perm_b32 v172, v36, v32, s31
    v_perm_b32 v173, v44, v40, s31
    v_perm_b32 v174, v52, v48, s31
    v_perm_b32 v175, v60, v56, s31
    s_waitcnt lgkmcnt(0)
    v_mfma_f32_16x16x32_bf16 v[176:179], v[128:131], v[160:163], 0
    v_mfma_f32_16x16x32_bf16 v[180:183], v[128:131], v[164:167], 0
    v_mfma_f32_16x16x32_bf16 v[184:187], v[136:139], v[160:163], 0
    v_mfma_f32_16x16x32_bf16 v[188:191], v[136:139], v[164:167], 0
    v_mfma_f32_16x16x32_bf16 v[192:195], v[144:147], v[160:163], 0
    v_mfma_f32_16x16x32_bf16 v[196:199], v[144:147], v[164:167], 0
    v_mfma_f32_16x16x32_bf16 v[200:203], v[152:155], v[160:163], 0
    v_mfma_f32_16x16x32_bf16 v[204:207], v[152:155], v[164:167], 0
    v_mfma_f32_16x16x32_bf16 v[176:179], v[132:135], v[168:171], v[176:179]
    v_mfma_f32_16x16x32_bf16 v[180:183], v[132:135], v[172:175], v[180:183]
    v_mfma_f32_16x16x32_bf16 v[184:187], v[140:143], v[168:171], v[184:187]
    v_mfma_f32_16x16x32_bf16 v[188:191], v[140:143], v[172:175], v[188:191]
    v_mfma_f32_16x16x32_bf16 v[192:195], v[148:151], v[168:171], v[192:195]
    v_mfma_f32_16x16x32_bf16 v[196:199], v[148:151], v[172:175], v[196:199]
    v_mfma_f32_16x16x32_bf16 v[200:203], v[156:159], v[168:171], v[200:203]
    v_mfma_f32_16x16x32_bf16 v[204:207], v[156:159], v[172:175], v[204:207]
    v_perm_b32 v160, v5, v1, s30
    v_perm_b32 v161, v13, v9, s30
    v_perm_b32 v162, v21, v17, s30
    v_perm_b32 v163, v29, v25, s30
    v_perm_b32 v164, v5, v1, s31
    v_perm_b32 v165, v13, v9, s31
    v_perm_b32 v166, v21, v17, s31
    v_perm_b32 v167, v29, v25, s31
    v_perm_b32 v168, v37, v33, s30
    v_perm_b32 v169, v45, v41, s30
    v_perm_b32 v170, v53, v49, s30
    v_perm_b32 v171, v61, v57, s30
    v_perm_b32 v172, v37, v33, s31
    v_perm_b32 v173, v45, v41, s31
    v_perm_b32 v174, v53, v49, s31
    v_perm_b32 v175, v61, v57, s31
    v_cvt_pk_bf16_f32 v0, v176, v180
    v_cvt_pk_bf16_f32 v4, v177, v181
    v_cvt_pk_bf16_f32 v8, v178, v182
    v_cvt_pk_bf16_f32 v12, v179, v183
    v_cvt_pk_bf16_f32 v16, v184, v188
    v_cvt_pk_bf16_f32 v20, v185, v189
    v_cvt_pk_bf16_f32 v24, v186, v190
    v_cvt_pk_bf16_f32 v28, v187, v191
    v_cvt_pk_bf16_f32 v32, v192, v196
    v_cvt_pk_bf16_f32 v36, v193, v197
    v_cvt_pk_bf16_f32 v40, v194, v198
    v_cvt_pk_bf16_f32 v44, v195, v199
    v_cvt_pk_bf16_f32 v48, v200, v204
    v_cvt_pk_bf16_f32 v52, v201, v205
    v_cvt_pk_bf16_f32 v56, v202, v206
    v_cvt_pk_bf16_f32 v60, v203, v207
    v_mfma_f32_16x16x32_bf16 v[176:179], v[128:131], v[160:163], 0
    v_mfma_f32_16x16x32_bf16 v[180:183], v[128:131], v[164:167], 0
    v_mfma_f32_16x16x32_bf16 v[184:187], v[136:139], v[160:163], 0
    v_mfma_f32_16x16x32_bf16 v[188:191], v[136:139], v[164:167], 0
    v_mfma_f32_16x16x32_bf16 v[192:195], v[144:147], v[160:163], 0
    v_mfma_f32_16x16x32_bf16 v[196:199], v[144:147], v[164:167], 0
    v_mfma_f32_16x16x32_bf16 v[200:203], v[152:155], v[160:163], 0
    v_mfma_f32_16x16x32_bf16 v[204:207], v[152:155], v[164:167], 0
    v_mfma_f32_16x16x32_bf16 v[176:179], v[132:135], v[168:171], v[176:179]
    v_mfma_f32_16x16x32_bf16 v[180:183], v[132:135], v[172:175], v[180:183]
    v_mfma_f32_16x16x32_bf16 v[184:187], v[140:143], v[168:171], v[184:187]
    v_mfma_f32_16x16x32_bf16 v[188:191], v[140:143], v[172:175], v[188:191]
    v_mfma_f32_16x16x32_bf16 v[192:195], v[148:151], v[168:171], v[192:195]
    v_mfma_f32_16x16x32_bf16 v[196:199], v[148:151], v[172:175], v[196:199]
    v_mfma_f32_16x16x32_bf16 v[200:203], v[156:159], v[168:171], v[200:203]
    v_mfma_f32_16x16x32_bf16 v[204:207], v[156:159], v[172:175], v[204:207]
    v_perm_b32 v160, v6, v2, s30
    v_perm_b32 v161, v14, v10, s30
    v_perm_b32 v162, v22, v18, s30
    v_perm_b32 v163, v30, v26, s30
    v_perm_b32 v164, v6, v2, s31
    v_perm_b32 v165, v14, v10, s31
    v_perm_b32 v166, v22, v18, s31
    v_perm_b32 v167, v30, v26, s31
    v_perm_b32 v168, v38, v34, s30
    v_perm_b32 v169, v46, v42, s30
    v_perm_b32 v170, v54, v50, s30
    v_perm_b32 v171, v62, v58, s30
    v_perm_b32 v172, v38, v34, s31
    v_perm_b32 v173, v46, v42, s31
    v_perm_b32 v174, v54, v50, s31
    v_perm_b32 v175, v62, v58, s31
    v_cvt_pk_bf16_f32 v1, v176, v180
    v_cvt_pk_bf16_f32 v5, v177, v181
    v_cvt_pk_bf16_f32 v9, v178, v182
    v_cvt_pk_bf16_f32 v13, v179, v183
    v_cvt_pk_bf16_f32 v17, v184, v188
    v_cvt_pk_bf16_f32 v21, v185, v189
    v_cvt_pk_bf16_f32 v25, v186, v190
    v_cvt_pk_bf16_f32 v29, v187, v191
    v_cvt_pk_bf16_f32 v33, v192, v196
    v_cvt_pk_bf16_f32 v37, v193, v197
    v_cvt_pk_bf16_f32 v41, v194, v198
    v_cvt_pk_bf16_f32 v45, v195, v199
    v_cvt_pk_bf16_f32 v49, v200, v204
    v_cvt_pk_bf16_f32 v53, v201, v205
    v_cvt_pk_bf16_f32 v57, v202, v206
    v_cvt_pk_bf16_f32 v61, v203, v207
    v_mfma_f32_16x16x32_bf16 v[176:179], v[128:131], v[160:163], 0
    v_mfma_f32_16x16x32_bf16 v[180:183], v[128:131], v[164:167], 0
    v_mfma_f32_16x16x32_bf16 v[184:187], v[136:139], v[160:163], 0
    v_mfma_f32_16x16x32_bf16 v[188:191], v[136:139], v[164:167], 0
    v_mfma_f32_16x16x32_bf16 v[192:195], v[144:147], v[160:163], 0
    v_mfma_f32_16x16x32_bf16 v[196:199], v[144:147], v[164:167], 0
    v_mfma_f32_16x16x32_bf16 v[200:203], v[152:155], v[160:163], 0
    v_mfma_f32_16x16x32_bf16 v[204:207], v[152:155], v[164:167], 0
    v_mfma_f32_16x16x32_bf16 v[176:179], v[132:135], v[168:171], v[176:179]
    v_mfma_f32_16x16x32_bf16 v[180:183], v[132:135], v[172:175], v[180:183]
    v_mfma_f32_16x16x32_bf16 v[184:187], v[140:143], v[168:171], v[184:187]
    v_mfma_f32_16x16x32_bf16 v[188:191], v[140:143], v[172:175], v[188:191]
    v_mfma_f32_16x16x32_bf16 v[192:195], v[148:151], v[168:171], v[192:195]
    v_mfma_f32_16x16x32_bf16 v[196:199], v[148:151], v[172:175], v[196:199]
    v_mfma_f32_16x16x32_bf16 v[200:203], v[156:159], v[168:171], v[200:203]
    v_mfma_f32_16x16x32_bf16 v[204:207], v[156:159], v[172:175], v[204:207]
    v_perm_b32 v160, v7, v3, s30
    v_perm_b32 v161, v15, v11, s30
    v_perm_b32 v162, v23, v19, s30
    v_perm_b32 v163, v31, v27, s30
    v_perm_b32 v164, v7, v3, s31
    v_perm_b32 v165, v15, v11, s31
    v_perm_b32 v166, v23, v19, s31
    v_perm_b32 v167, v31, v27, s31
    v_perm_b32 v168, v39, v35, s30
    v_perm_b32 v169, v47, v43, s30
    v_perm_b32 v170, v55, v51, s30
    v_perm_b32 v171, v63, v59, s30
    v_perm_b32 v172, v39, v35, s31
    v_perm_b32 v173, v47, v43, s31
    v_perm_b32 v174, v55, v51, s31
    v_perm_b32 v175, v63, v59, s31
    v_cvt_pk_bf16_f32 v2, v176, v180
    v_cvt_pk_bf16_f32 v6, v177, v181
    v_cvt_pk_bf16_f32 v10, v178, v182
    v_cvt_pk_bf16_f32 v14, v179, v183
    v_cvt_pk_bf16_f32 v18, v184, v188
    v_cvt_pk_bf16_f32 v22, v185, v189
    v_cvt_pk_bf16_f32 v26, v186, v190
    v_cvt_pk_bf16_f32 v30, v187, v191
    v_cvt_pk_bf16_f32 v34, v192, v196
    v_cvt_pk_bf16_f32 v38, v193, v197
    v_cvt_pk_bf16_f32 v42, v194, v198
    v_cvt_pk_bf16_f32 v46, v195, v199
    v_cvt_pk_bf16_f32 v50, v200, v204
    v_cvt_pk_bf16_f32 v54, v201, v205
    v_cvt_pk_bf16_f32 v58, v202, v206
    v_cvt_pk_bf16_f32 v62, v203, v207
    v_mfma_f32_16x16x32_bf16 v[176:179], v[128:131], v[160:163], 0
    v_mfma_f32_16x16x32_bf16 v[180:183], v[128:131], v[164:167], 0
    v_mfma_f32_16x16x32_bf16 v[184:187], v[136:139], v[160:163], 0
    v_mfma_f32_16x16x32_bf16 v[188:191], v[136:139], v[164:167], 0
    v_mfma_f32_16x16x32_bf16 v[192:195], v[144:147], v[160:163], 0
    v_mfma_f32_16x16x32_bf16 v[196:199], v[144:147], v[164:167], 0
    v_mfma_f32_16x16x32_bf16 v[200:203], v[152:155], v[160:163], 0
    v_mfma_f32_16x16x32_bf16 v[204:207], v[152:155], v[164:167], 0
    v_mfma_f32_16x16x32_bf16 v[176:179], v[132:135], v[168:171], v[176:179]
    v_mfma_f32_16x16x32_bf16 v[180:183], v[132:135], v[172:175], v[180:183]
    v_mfma_f32_16x16x32_bf16 v[184:187], v[140:143], v[168:171], v[184:187]
    v_mfma_f32_16x16x32_bf16 v[188:191], v[140:143], v[172:175], v[188:191]
    v_mfma_f32_16x16x32_bf16 v[192:195], v[148:151], v[168:171], v[192:195]
    v_mfma_f32_16x16x32_bf16 v[196:199], v[148:151], v[172:175], v[196:199]
    v_mfma_f32_16x16x32_bf16 v[200:203], v[156:159], v[168:171], v[200:203]
    v_mfma_f32_16x16x32_bf16 v[204:207], v[156:159], v[172:175], v[204:207]
    s_nop 1
    v_cvt_pk_bf16_f32 v3, v176, v180
    v_cvt_pk_bf16_f32 v7, v177, v181
    v_cvt_pk_bf16_f32 v11, v178, v182
    v_cvt_pk_bf16_f32 v15, v179, v183
    v_cvt_pk_bf16_f32 v19, v184, v188
    v_cvt_pk_bf16_f32 v23, v185, v189
    v_cvt_pk_bf16_f32 v27, v186, v190
    v_cvt_pk_bf16_f32 v31, v187, v191
    v_cvt_pk_bf16_f32 v35, v192, v196
    v_cvt_pk_bf16_f32 v39, v193, v197
    v_cvt_pk_bf16_f32 v43, v194, v198
    v_cvt_pk_bf16_f32 v47, v195, v199
    v_cvt_pk_bf16_f32 v51, v200, v204
    v_cvt_pk_bf16_f32 v55, v201, v205
    v_cvt_pk_bf16_f32 v59, v202, v206
    v_cvt_pk_bf16_f32 v63, v203, v207
    s_add_u32 s25, s24, 0
    buffer_store_dwordx4 v[0:3], v212, s[16:19], s25 offen sc1
    s_add_u32 s25, s24, 10752
    buffer_store_dwordx4 v[4:7], v212, s[16:19], s25 offen sc1
    s_add_u32 s25, s24, 21504
    buffer_store_dwordx4 v[8:11], v212, s[16:19], s25 offen sc1
    s_add_u32 s25, s24, 32256
    buffer_store_dwordx4 v[12:15], v212, s[16:19], s25 offen sc1
    s_add_u32 s25, s24, 172032
    buffer_store_dwordx4 v[16:19], v212, s[16:19], s25 offen sc1
    s_add_u32 s25, s24, 182784
    buffer_store_dwordx4 v[20:23], v212, s[16:19], s25 offen sc1
    s_add_u32 s25, s24, 193536
    buffer_store_dwordx4 v[24:27], v212, s[16:19], s25 offen sc1
    s_add_u32 s25, s24, 204288
    buffer_store_dwordx4 v[28:31], v212, s[16:19], s25 offen sc1
    s_add_u32 s25, s24, 344064
    buffer_store_dwordx4 v[32:35], v212, s[16:19], s25 offen sc1
    s_add_u32 s25, s24, 354816
    buffer_store_dwordx4 v[36:39], v212, s[16:19], s25 offen sc1
    s_add_u32 s25, s24, 365568
    buffer_store_dwordx4 v[40:43], v212, s[16:19], s25 offen sc1
    s_add_u32 s25, s24, 376320
    buffer_store_dwordx4 v[44:47], v212, s[16:19], s25 offen sc1
    s_add_u32 s25, s24, 516096
    buffer_store_dwordx4 v[48:51], v212, s[16:19], s25 offen sc1
    s_add_u32 s25, s24, 526848
    buffer_store_dwordx4 v[52:55], v212, s[16:19], s25 offen sc1
    s_add_u32 s25, s24, 537600
    buffer_store_dwordx4 v[56:59], v212, s[16:19], s25 offen sc1
    s_add_u32 s25, s24, 548352
    buffer_store_dwordx4 v[60:63], v212, s[16:19], s25 offen sc1
    s_branch L_next0
L_cw0:
    s_sub_u32 s12, s40, 672
    s_and_b32 s13, s12, 3
    s_lshr_b32 s14, s12, 2
    s_lshl_b32 s14, s14, 2
    s_add_u32 s14, s14, s10
    ds_read_b128 v[128:131], v223 offset:8192
    ds_read_b128 v[132:135], v223 offset:9216
    ds_read_b128 v[136:139], v223 offset:10240
    ds_read_b128 v[140:143], v223 offset:11264
    s_and_b32 s24, s14, 3
    s_bfe_u32 s25, s14, 0x10003
    s_lshl_b32 s25, s25, 2
    s_or_b32 s24, s24, s25
    s_lshl_b32 s24, s24, 1
    v_xor_b32 v213, s24, v209
    v_lshl_add_u32 v212, v213, 4, v227
    s_mul_i32 s24, s13, 16777216
    s_lshr_b32 s25, s14, 5
    s_mul_i32 s25, s25, 524288
    s_add_u32 s24, s24, s25
    s_and_b32 s25, s14, 31
    s_lshl_b32 s25, s25, 8
    s_add_u32 s24, s24, s25
    v_perm_b32 v16, v0, v0, s32
    v_perm_b32 v17, v4, v4, s32
    v_perm_b32 v18, v8, v8, s32
    v_perm_b32 v19, v12, v12, s32
    v_perm_b32 v20, v0, v0, s33
    v_perm_b32 v21, v4, v4, s33
    v_perm_b32 v22, v8, v8, s33
    v_perm_b32 v23, v12, v12, s33
    v_perm_b32 v24, v1, v1, s32
    v_perm_b32 v25, v5, v5, s32
    v_perm_b32 v26, v9, v9, s32
    v_perm_b32 v27, v13, v13, s32
    v_perm_b32 v28, v1, v1, s33
    v_perm_b32 v29, v5, v5, s33
    v_perm_b32 v30, v9, v9, s33
    v_perm_b32 v31, v13, v13, s33
    v_perm_b32 v32, v2, v2, s32
    v_perm_b32 v33, v6, v6, s32
    v_perm_b32 v34, v10, v10, s32
    v_perm_b32 v35, v14, v14, s32
    v_perm_b32 v36, v2, v2, s33
    v_perm_b32 v37, v6, v6, s33
    v_perm_b32 v38, v10, v10, s33
    v_perm_b32 v39, v14, v14, s33
    v_perm_b32 v40, v3, v3, s32
    v_perm_b32 v41, v7, v7, s32
    v_perm_b32 v42, v11, v11, s32
    v_perm_b32 v43, v15, v15, s32
    v_perm_b32 v44, v3, v3, s33
    v_perm_b32 v45, v7, v7, s33
    v_perm_b32 v46, v11, v11, s33
    v_perm_b32 v47, v15, v15, s33
    s_waitcnt lgkmcnt(0)
    v_mfma_f32_16x16x32_bf16 v[176:179], v[128:131], v[16:19], 0
    v_mfma_f32_16x16x32_bf16 v[180:183], v[128:131], v[20:23], 0
    v_mfma_f32_16x16x32_bf16 v[184:187], v[128:131], v[24:27], 0
    v_mfma_f32_16x16x32_bf16 v[188:191], v[128:131], v[28:31], 0
    v_mfma_f32_16x16x32_bf16 v[192:195], v[128:131], v[32:35], 0
    v_mfma_f32_16x16x32_bf16 v[196:199], v[128:131], v[36:39], 0
    v_mfma_f32_16x16x32_bf16 v[200:203], v[128:131], v[40:43], 0
    v_mfma_f32_16x16x32_bf16 v[204:207], v[128:131], v[44:47], 0
    s_nop 1
    v_cvt_pk_bf16_f32 v0, v176, v180
    s_nop 0
    v_cvt_pk_bf16_f32 v1, v184, v188
    s_nop 0
    v_cvt_pk_bf16_f32 v2, v192, v196
    s_nop 0
    v_cvt_pk_bf16_f32 v3, v200, v204
    v_cvt_pk_bf16_f32 v4, v177, v181
    v_cvt_pk_bf16_f32 v5, v185, v189
    v_cvt_pk_bf16_f32 v6, v193, v197
    v_cvt_pk_bf16_f32 v7, v201, v205
    v_cvt_pk_bf16_f32 v8, v178, v182
    v_cvt_pk_bf16_f32 v9, v186, v190
    v_cvt_pk_bf16_f32 v10, v194, v198
    v_cvt_pk_bf16_f32 v11, v202, v206
    v_cvt_pk_bf16_f32 v12, v179, v183
    v_cvt_pk_bf16_f32 v13, v187, v191
    v_cvt_pk_bf16_f32 v14, v195, v199
    v_cvt_pk_bf16_f32 v15, v203, v207
    s_add_u32 s25, s24, 0
    buffer_store_dwordx4 v[0:3], v212, s[16:19], s25 offen sc1
    s_add_u32 s25, s24, 8192
    buffer_store_dwordx4 v[4:7], v212, s[16:19], s25 offen sc1
    s_add_u32 s25, s24, 16384
    buffer_store_dwordx4 v[8:11], v212, s[16:19], s25 offen sc1
    s_add_u32 s25, s24, 24576
    buffer_store_dwordx4 v[12:15], v212, s[16:19], s25 offen sc1
    v_mfma_f32_16x16x32_bf16 v[176:179], v[132:135], v[16:19], 0
    v_mfma_f32_16x16x32_bf16 v[180:183], v[132:135], v[20:23], 0
    v_mfma_f32_16x16x32_bf16 v[184:187], v[132:135], v[24:27], 0
    v_mfma_f32_16x16x32_bf16 v[188:191], v[132:135], v[28:31], 0
    v_mfma_f32_16x16x32_bf16 v[192:195], v[132:135], v[32:35], 0
    v_mfma_f32_16x16x32_bf16 v[196:199], v[132:135], v[36:39], 0
    v_mfma_f32_16x16x32_bf16 v[200:203], v[132:135], v[40:43], 0
    v_mfma_f32_16x16x32_bf16 v[204:207], v[132:135], v[44:47], 0
    s_nop 1
    v_cvt_pk_bf16_f32 v48, v176, v180
    s_nop 0
    v_cvt_pk_bf16_f32 v49, v184, v188
    s_nop 0
    v_cvt_pk_bf16_f32 v50, v192, v196
    s_nop 0
    v_cvt_pk_bf16_f32 v51, v200, v204
    v_cvt_pk_bf16_f32 v52, v177, v181
    v_cvt_pk_bf16_f32 v53, v185, v189
    v_cvt_pk_bf16_f32 v54, v193, v197
    v_cvt_pk_bf16_f32 v55, v201, v205
    v_cvt_pk_bf16_f32 v56, v178, v182
    v_cvt_pk_bf16_f32 v57, v186, v190
    v_cvt_pk_bf16_f32 v58, v194, v198
    v_cvt_pk_bf16_f32 v59, v202, v206
    v_cvt_pk_bf16_f32 v60, v179, v183
    v_cvt_pk_bf16_f32 v61, v187, v191
    v_cvt_pk_bf16_f32 v62, v195, v199
    v_cvt_pk_bf16_f32 v63, v203, v207
    s_add_u32 s25, s24, 131072
    buffer_store_dwordx4 v[48:51], v212, s[16:19], s25 offen sc1
    s_add_u32 s25, s24, 139264
    buffer_store_dwordx4 v[52:55], v212, s[16:19], s25 offen sc1
    s_add_u32 s25, s24, 147456
    buffer_store_dwordx4 v[56:59], v212, s[16:19], s25 offen sc1
    s_add_u32 s25, s24, 155648
    buffer_store_dwordx4 v[60:63], v212, s[16:19], s25 offen sc1
    v_mfma_f32_16x16x32_bf16 v[176:179], v[136:139], v[16:19], 0
    v_mfma_f32_16x16x32_bf16 v[180:183], v[136:139], v[20:23], 0
    v_mfma_f32_16x16x32_bf16 v[184:187], v[136:139], v[24:27], 0
    v_mfma_f32_16x16x32_bf16 v[188:191], v[136:139], v[28:31], 0
    v_mfma_f32_16x16x32_bf16 v[192:195], v[136:139], v[32:35], 0
    v_mfma_f32_16x16x32_bf16 v[196:199], v[136:139], v[36:39], 0
    v_mfma_f32_16x16x32_bf16 v[200:203], v[136:139], v[40:43], 0
    v_mfma_f32_16x16x32_bf16 v[204:207], v[136:139], v[44:47], 0
    s_nop 1
    v_cvt_pk_bf16_f32 v0, v176, v180
    s_nop 0
    v_cvt_pk_bf16_f32 v1, v184, v188
    s_nop 0
    v_cvt_pk_bf16_f32 v2, v192, v196
    s_nop 0
    v_cvt_pk_bf16_f32 v3, v200, v204
    v_cvt_pk_bf16_f32 v4, v177, v181
    v_cvt_pk_bf16_f32 v5, v185, v189
    v_cvt_pk_bf16_f32 v6, v193, v197
    v_cvt_pk_bf16_f32 v7, v201, v205
    v_cvt_pk_bf16_f32 v8, v178, v182
    v_cvt_pk_bf16_f32 v9, v186, v190
    v_cvt_pk_bf16_f32 v10, v194, v198
    v_cvt_pk_bf16_f32 v11, v202, v206
    v_cvt_pk_bf16_f32 v12, v179, v183
    v_cvt_pk_bf16_f32 v13, v187, v191
    v_cvt_pk_bf16_f32 v14, v195, v199
    v_cvt_pk_bf16_f32 v15, v203, v207
    s_add_u32 s25, s24, 262144
    buffer_store_dwordx4 v[0:3], v212, s[16:19], s25 offen sc1
    s_add_u32 s25, s24, 270336
    buffer_store_dwordx4 v[4:7], v212, s[16:19], s25 offen sc1
    s_add_u32 s25, s24, 278528
    buffer_store_dwordx4 v[8:11], v212, s[16:19], s25 offen sc1
    s_add_u32 s25, s24, 286720
    buffer_store_dwordx4 v[12:15], v212, s[16:19], s25 offen sc1
    v_mfma_f32_16x16x32_bf16 v[176:179], v[140:143], v[16:19], 0
    v_mfma_f32_16x16x32_bf16 v[180:183], v[140:143], v[20:23], 0
    v_mfma_f32_16x16x32_bf16 v[184:187], v[140:143], v[24:27], 0
    v_mfma_f32_16x16x32_bf16 v[188:191], v[140:143], v[28:31], 0
    v_mfma_f32_16x16x32_bf16 v[192:195], v[140:143], v[32:35], 0
    v_mfma_f32_16x16x32_bf16 v[196:199], v[140:143], v[36:39], 0
    v_mfma_f32_16x16x32_bf16 v[200:203], v[140:143], v[40:43], 0
    v_mfma_f32_16x16x32_bf16 v[204:207], v[140:143], v[44:47], 0
    s_nop 1
    v_cvt_pk_bf16_f32 v48, v176, v180
    s_nop 0
    v_cvt_pk_bf16_f32 v49, v184, v188
    s_nop 0
    v_cvt_pk_bf16_f32 v50, v192, v196
    s_nop 0
    v_cvt_pk_bf16_f32 v51, v200, v204
    v_cvt_pk_bf16_f32 v52, v177, v181
    v_cvt_pk_bf16_f32 v53, v185, v189
    v_cvt_pk_bf16_f32 v54, v193, v197
    v_cvt_pk_bf16_f32 v55, v201, v205
    v_cvt_pk_bf16_f32 v56, v178, v182
    v_cvt_pk_bf16_f32 v57, v186, v190
    v_cvt_pk_bf16_f32 v58, v194, v198
    v_cvt_pk_bf16_f32 v59, v202, v206
    v_cvt_pk_bf16_f32 v60, v179, v183
    v_cvt_pk_bf16_f32 v61, v187, v191
    v_cvt_pk_bf16_f32 v62, v195, v199
    v_cvt_pk_bf16_f32 v63, v203, v207
    s_add_u32 s25, s24, 393216
    buffer_store_dwordx4 v[48:51], v212, s[16:19], s25 offen sc1
    s_add_u32 s25, s24, 401408
    buffer_store_dwordx4 v[52:55], v212, s[16:19], s25 offen sc1
    s_add_u32 s25, s24, 409600
    buffer_store_dwordx4 v[56:59], v212, s[16:19], s25 offen sc1
    s_add_u32 s25, s24, 417792
    buffer_store_dwordx4 v[60:63], v212, s[16:19], s25 offen sc1
L_next0:
    s_cmp_lg_u32 s10, 0
    s_cbranch_scc1 L_pub0
    s_cmp_ge_u32 s42, 1696
    s_cbranch_scc1 L_w0_p0
    s_cmp_ge_u32 s42, 672
    s_cbranch_scc1 L_w8_p0
    s_waitcnt vmcnt(32)
    s_branch L_wd_p0
L_w8_p0:
    s_waitcnt vmcnt(24)
    s_branch L_wd_p0
L_w0_p0:
    s_waitcnt vmcnt(16)
L_wd_p0:
    v_add_u32 v221, 512, v221
    v_mov_b32 v213, s41
    s_mov_b64 exec, 1
    ds_write_b32 v213, v221 offset:12288
    s_mov_b64 exec, -1
L_pub0:
    s_waitcnt lgkmcnt(0)
    s_barrier
    v_mov_b32 v213, s41
    ds_read_b32 v214, v213 offset:12288
    s_xor_b32 s41, s41, 4
    s_mov_b32 s40, s42
    s_waitcnt lgkmcnt(0)
    v_readfirstlane_b32 s42, v214
    s_cmp_ge_u32 s40, 1696
    s_cbranch_scc1 L_k12_fin
    s_cmp_lg_u32 s10, 0
    s_cbranch_scc1 L_nofetch1
    v_mov_b32 v221, 1
    s_mov_b64 exec, 1
    buffer_atomic_add v221, v222, s[44:47], 0 offen sc0 sc1
    s_mov_b64 exec, -1
L_nofetch1:
    s_cmp_ge_u32 s42, 1696
    s_cbranch_scc1 L_ld_done2
    s_cmp_ge_u32 s42, 672
    s_cbranch_scc1 L_ld_w2
    s_cmp_ge_u32 s42, 336
    s_cselect_b32 s11, 1, 0
    s_mul_i32 s12, s11, 336
    s_sub_u32 s12, s42, s12
    s_and_b32 s13, s12, 7
    s_lshr_b32 s14, s12, 3
    s_lshl_b32 s14, s14, 2
    s_add_u32 s14, s14, s10
    s_mul_i32 s15, s11, 16384000
    s_add_u32 s34, s4, s15
    s_addc_u32 s35, s5, 0
    s_mov_b32 s20, s34
    s_and_b32 s21, s35, 0xffff
    s_mov_b32 s22, 16384000
    s_mov_b32 s23, 0x00020000
    s_mul_i32 s15, s14, 98304
    s_lshl_b32 s24, s13, 8
    s_add_u32 s15, s15, s24
    s_add_u32 s25, s15, 0
    buffer_load_dwordx4 v[0:3], v224, s[20:23], s25 offen
    s_add_u32 s25, s15, 2048
    buffer_load_dwordx4 v[4:7], v224, s[20:23], s25 offen
    s_add_u32 s25, s15, 4096
    buffer_load_dwordx4 v[8:11], v224, s[20:23], s25 offen
    s_add_u32 s25, s15, 6144
    buffer_load_dwordx4 v[12:15], v224, s[20:23], s25 offen
    s_add_u32 s25, s15, 8192
    buffer_load_dwordx4 v[16:19], v224, s[20:23], s25 offen
    s_add_u32 s25, s15, 10240
    buffer_load_dwordx4 v[20:23], v224, s[20:23], s25 offen
    s_add_u32 s25, s15, 12288
    buffer_load_dwordx4 v[24:27], v224, s[20:23], s25 offen
    s_add_u32 s25, s15, 14336
    buffer_load_dwordx4 v[28:31], v224, s[20:23], s25 offen
    s_add_u32 s25, s15, 65536
    buffer_load_dwordx4 v[32:35], v224, s[20:23], s25 offen
    s_add_u32 s25, s15, 67584
    buffer_load_dwordx4 v[36:39], v224, s[20:23], s25 offen
    s_add_u32 s25, s15, 69632
    buffer_load_dwordx4 v[40:43], v224, s[20:23], s25 offen
    s_add_u32 s25, s15, 71680
    buffer_load_dwordx4 v[44:47], v224, s[20:23], s25 offen
    s_add_u32 s25, s15, 73728
    buffer_load_dwordx4 v[48:51], v224, s[20:23], s25 offen
    s_add_u32 s25, s15, 75776
    buffer_load_dwordx4 v[52:55], v224, s[20:23], s25 offen
    s_add_u32 s25, s15, 77824
    buffer_load_dwordx4 v[56:59], v224, s[20:23], s25 offen
    s_add_u32 s25, s15, 79872
    buffer_load_dwordx4 v[60:63], v224, s[20:23], s25 offen
    s_branch L_ld_done2
L_ld_w2:
    s_sub_u32 s12, s42, 672
    s_and_b32 s13, s12, 3
    s_lshr_b32 s14, s12, 2
    s_lshl_b32 s14, s14, 2
    s_add_u32 s14, s14, s10
    s_mov_b32 s20, s6
    s_and_b32 s21, s7, 0xffff
    s_mov_b32 s22, 16252928
    s_mov_b32 s23, 0x00020000
    s_lshl_b32 s15, s14, 10
    s_lshl_b32 s24, s13, 8
    s_add_u32 s15, s15, s24
    s_add_u32 s25, s15, 0
    buffer_load_dwordx2 v[0:1], v225, s[20:23], s25 offen
    buffer_load_dwordx2 v[2:3], v225, s[20:23], s25 offen offset:16
    s_add_u32 s25, s15, 1048576
    buffer_load_dwordx2 v[4:5], v225, s[20:23], s25 offen
    buffer_load_dwordx2 v[6:7], v225, s[20:23], s25 offen offset:16
    s_add_u32 s25, s15, 2097152
    buffer_load_dwordx2 v[8:9], v225, s[20:23], s25 offen
    buffer_load_dwordx2 v[10:11], v225, s[20:23], s25 offen offset:16
    s_add_u32 s25, s15, 3145728
    buffer_load_dwordx2 v[12:13], v225, s[20:23], s25 offen
    buffer_load_dwordx2 v[14:15], v225, s[20:23], s25 offen offset:16
L_ld_done2:
    s_cmp_ge_u32 s42, 1696
    s_cbranch_scc1 L_w0_a1
    s_cmp_ge_u32 s42, 672
    s_cbranch_scc1 L_w8_a1
    s_waitcnt vmcnt(32)
    s_branch L_wd_a1
L_w8_a1:
    s_waitcnt vmcnt(24)
    s_branch L_wd_a1
L_w0_a1:
    s_waitcnt vmcnt(16)
L_wd_a1:
    s_cmp_ge_u32 s40, 672
    s_cbranch_scc1 L_cw1
    s_cmp_ge_u32 s40, 336
    s_cselect_b32 s11, 1, 0
    s_mul_i32 s12, s11, 336
    s_sub_u32 s12, s40, s12
    s_and_b32 s13, s12, 7
    s_lshr_b32 s14, s12, 3
    s_lshl_b32 s14, s14, 2
    s_add_u32 s14, s14, s10
    ds_read_b128 v[128:131], v223 offset:0
    ds_read_b128 v[132:135], v223 offset:1024
    ds_read_b128 v[136:139], v223 offset:2048
    ds_read_b128 v[140:143], v223 offset:3072
    ds_read_b128 v[144:147], v223 offset:4096
    ds_read_b128 v[148:151], v223 offset:5120
    ds_read_b128 v[152:155], v223 offset:6144
    ds_read_b128 v[156:159], v223 offset:7168
    s_bfe_u32 s24, s14, 0x10003
    s_mul_i32 s24, s24, 3
    v_and_b32 v213, 3, v209
    v_xor_b32 v213, s24, v213
    v_lshl_add_u32 v212, v213, 4, v226
    s_mul_i32 s24, s11, 22020096
    s_mul_i32 s25, s13, 2752512
    s_add_u32 s24, s24, s25
    s_lshl_b32 s25, s14, 6
    s_add_u32 s24, s24, s25
    s_add_u32 s24, s24, 67108864
    v_perm_b32 v160, v68, v64, s30
    v_perm_b32 v161, v76, v72, s30
    v_perm_b32 v162, v84, v80, s30
    v_perm_b32 v163, v92, v88, s30
    v_perm_b32 v164, v68, v64, s31
    v_perm_b32 v165, v76, v72, s31
    v_perm_b32 v166, v84, v80, s31
    v_perm_b32 v167, v92, v88, s31
    v_perm_b32 v168, v100, v96, s30
    v_perm_b32 v169, v108, v104, s30
    v_perm_b32 v170, v116, v112, s30
    v_perm_b32 v171, v124, v120, s30
    v_perm_b32 v172, v100, v96, s31
    v_perm_b32 v173, v108, v104, s31
    v_perm_b32 v174, v116, v112, s31
    v_perm_b32 v175, v124, v120, s31
    s_waitcnt lgkmcnt(0)
    v_mfma_f32_16x16x32_bf16 v[176:179], v[128:131], v[160:163], 0
    v_mfma_f32_16x16x32_bf16 v[180:183], v[128:131], v[164:167], 0
    v_mfma_f32_16x16x32_bf16 v[184:187], v[136:139], v[160:163], 0
    v_mfma_f32_16x16x32_bf16 v[188:191], v[136:139], v[164:167], 0
    v_mfma_f32_16x16x32_bf16 v[192:195], v[144:147], v[160:163], 0
    v_mfma_f32_16x16x32_bf16 v[196:199], v[144:147], v[164:167], 0
    v_mfma_f32_16x16x32_bf16 v[200:203], v[152:155], v[160:163], 0
    v_mfma_f32_16x16x32_bf16 v[204:207], v[152:155], v[164:167], 0
    v_mfma_f32_16x16x32_bf16 v[176:179], v[132:135], v[168:171], v[176:179]
    v_mfma_f32_16x16x32_bf16 v[180:183], v[132:135], v[172:175], v[180:183]
    v_mfma_f32_16x16x32_bf16 v[184:187], v[140:143], v[168:171], v[184:187]
    v_mfma_f32_16x16x32_bf16 v[188:191], v[140:143], v[172:175], v[188:191]
    v_mfma_f32_16x16x32_bf16 v[192:195], v[148:151], v[168:171], v[192:195]
    v_mfma_f32_16x16x32_bf16 v[196:199], v[148:151], v[172:175], v[196:199]
    v_mfma_f32_16x16x32_bf16 v[200:203], v[156:159], v[168:171], v[200:203]
    v_mfma_f32_16x16x32_bf16 v[204:207], v[156:159], v[172:175], v[204:207]
    v_perm_b32 v160, v69, v65, s30
    v_perm_b32 v161, v77, v73, s30
    v_perm_b32 v162, v85, v81, s30
    v_perm_b32 v163, v93, v89, s30
    v_perm_b32 v164, v69, v65, s31
    v_perm_b32 v165, v77, v73, s31
    v_perm_b32 v166, v85, v81, s31
    v_perm_b32 v167, v93, v89, s31
    v_perm_b32 v168, v101, v97, s30
    v_perm_b32 v169, v109, v105, s30
    v_perm_b32 v170, v117, v113, s30
    v_perm_b32 v171, v125, v121, s30
    v_perm_b32 v172, v101, v97, s31
    v_perm_b32 v173, v109, v105, s31
    v_perm_b32 v174, v117, v113, s31
    v_perm_b32 v175, v125, v121, s31
    v_cvt_pk_bf16_f32 v64, v176, v180
    v_cvt_pk_bf16_f32 v68, v177, v181
    v_cvt_pk_bf16_f32 v72, v178, v182
    v_cvt_pk_bf16_f32 v76, v179, v183
    v_cvt_pk_bf16_f32 v80, v184, v188
    v_cvt_pk_bf16_f32 v84, v185, v189
    v_cvt_pk_bf16_f32 v88, v186, v190
    v_cvt_pk_bf16_f32 v92, v187, v191
    v_cvt_pk_bf16_f32 v96, v192, v196
    v_cvt_pk_bf16_f32 v100, v193, v197
    v_cvt_pk_bf16_f32 v104, v194, v198
    v_cvt_pk_bf16_f32 v108, v195, v199
    v_cvt_pk_bf16_f32 v112, v200, v204
    v_cvt_pk_bf16_f32 v116, v201, v205
    v_cvt_pk_bf16_f32 v120, v202, v206
    v_cvt_pk_bf16_f32 v124, v203, v207
    v_mfma_f32_16x16x32_bf16 v[176:179], v[128:131], v[160:163], 0
    v_mfma_f32_16x16x32_bf16 v[180:183], v[128:131], v[164:167], 0
    v_mfma_f32_16x16x32_bf16 v[184:187], v[136:139], v[160:163], 0
    v_mfma_f32_16x16x32_bf16 v[188:191], v[136:139], v[164:167], 0
    v_mfma_f32_16x16x32_bf16 v[192:195], v[144:147], v[160:163], 0
    v_mfma_f32_16x16x32_bf16 v[196:199], v[144:147], v[164:167], 0
    v_mfma_f32_16x16x32_bf16 v[200:203], v[152:155], v[160:163], 0
    v_mfma_f32_16x16x32_bf16 v[204:207], v[152:155], v[164:167], 0
    v_mfma_f32_16x16x32_bf16 v[176:179], v[132:135], v[168:171], v[176:179]
    v_mfma_f32_16x16x32_bf16 v[180:183], v[132:135], v[172:175], v[180:183]
    v_mfma_f32_16x16x32_bf16 v[184:187], v[140:143], v[168:171], v[184:187]
    v_mfma_f32_16x16x32_bf16 v[188:191], v[140:143], v[172:175], v[188:191]
    v_mfma_f32_16x16x32_bf16 v[192:195], v[148:151], v[168:171], v[192:195]
    v_mfma_f32_16x16x32_bf16 v[196:199], v[148:151], v[172:175], v[196:199]
    v_mfma_f32_16x16x32_bf16 v[200:203], v[156:159], v[168:171], v[200:203]
    v_mfma_f32_16x16x32_bf16 v[204:207], v[156:159], v[172:175], v[204:207]
    v_perm_b32 v160, v70, v66, s30
    v_perm_b32 v161, v78, v74, s30
    v_perm_b32 v162, v86, v82, s30
    v_perm_b32 v163, v94, v90, s30
    v_perm_b32 v164, v70, v66, s31
    v_perm_b32 v165, v78, v74, s31
    v_perm_b32 v166, v86, v82, s31
    v_perm_b32 v167, v94, v90, s31
    v_perm_b32 v168, v102, v98, s30
    v_perm_b32 v169, v110, v106, s30
    v_perm_b32 v170, v118, v114, s30
    v_perm_b32 v171, v126, v122, s30
    v_perm_b32 v172, v102, v98, s31
    v_perm_b32 v173, v110, v106, s31
    v_perm_b32 v174, v118, v114, s31
    v_perm_b32 v175, v126, v122, s31
    v_cvt_pk_bf16_f32 v65, v176, v180
    v_cvt_pk_bf16_f32 v69, v177, v181
    v_cvt_pk_bf16_f32 v73, v178, v182
    v_cvt_pk_bf16_f32 v77, v179, v183
    v_cvt_pk_bf16_f32 v81, v184, v188
    v_cvt_pk_bf16_f32 v85, v185, v189
    v_cvt_pk_bf16_f32 v89, v186, v190
    v_cvt_pk_bf16_f32 v93, v187, v191
    v_cvt_pk_bf16_f32 v97, v192, v196
    v_cvt_pk_bf16_f32 v101, v193, v197
    v_cvt_pk_bf16_f32 v105, v194, v198
    v_cvt_pk_bf16_f32 v109, v195, v199
    v_cvt_pk_bf16_f32 v113, v200, v204
    v_cvt_pk_bf16_f32 v117, v201, v205
    v_cvt_pk_bf16_f32 v121, v202, v206
    v_cvt_pk_bf16_f32 v125, v203, v207
    v_mfma_f32_16x16x32_bf16 v[176:179], v[128:131], v[160:163], 0
    v_mfma_f32_16x16x32_bf16 v[180:183], v[128:131], v[164:167], 0
    v_mfma_f32_16x16x32_bf16 v[184:187], v[136:139], v[160:163], 0
    v_mfma_f32_16x16x32_bf16 v[188:191], v[136:139], v[164:167], 0
    v_mfma_f32_16x16x32_bf16 v[192:195], v[144:147], v[160:163], 0
    v_mfma_f32_16x16x32_bf16 v[196:199], v[144:147], v[164:167], 0
    v_mfma_f32_16x16x32_bf16 v[200:203], v[152:155], v[160:163], 0
    v_mfma_f32_16x16x32_bf16 v[204:207], v[152:155], v[164:167], 0
    v_mfma_f32_16x16x32_bf16 v[176:179], v[132:135], v[168:171], v[176:179]
    v_mfma_f32_16x16x32_bf16 v[180:183], v[132:135], v[172:175], v[180:183]
    v_mfma_f32_16x16x32_bf16 v[184:187], v[140:143], v[168:171], v[184:187]
    v_mfma_f32_16x16x32_bf16 v[188:191], v[140:143], v[172:175], v[188:191]
    v_mfma_f32_16x16x32_bf16 v[192:195], v[148:151], v[168:171], v[192:195]
    v_mfma_f32_16x16x32_bf16 v[196:199], v[148:151], v[172:175], v[196:199]
    v_mfma_f32_16x16x32_bf16 v[200:203], v[156:159], v[168:171], v[200:203]
    v_mfma_f32_16x16x32_bf16 v[204:207], v[156:159], v[172:175], v[204:207]
    v_perm_b32 v160, v71, v67, s30
    v_perm_b32 v161, v79, v75, s30
    v_perm_b32 v162, v87, v83, s30
    v_perm_b32 v163, v95, v91, s30
    v_perm_b32 v164, v71, v67, s31
    v_perm_b32 v165, v79, v75, s31
    v_perm_b32 v166, v87, v83, s31
    v_perm_b32 v167, v95, v91, s31
    v_perm_b32 v168, v103, v99, s30
    v_perm_b32 v169, v111, v107, s30
    v_perm_b32 v170, v119, v115, s30
    v_perm_b32 v171, v127, v123, s30
    v_perm_b32 v172, v103, v99, s31
    v_perm_b32 v173, v111, v107, s31
    v_perm_b32 v174, v119, v115, s31
    v_perm_b32 v175, v127, v123, s31
    v_cvt_pk_bf16_f32 v66, v176, v180
    v_cvt_pk_bf16_f32 v70, v177, v181
    v_cvt_pk_bf16_f32 v74, v178, v182
    v_cvt_pk_bf16_f32 v78, v179, v183
    v_cvt_pk_bf16_f32 v82, v184, v188
    v_cvt_pk_bf16_f32 v86, v185, v189
    v_cvt_pk_bf16_f32 v90, v186, v190
    v_cvt_pk_bf16_f32 v94, v187, v191
    v_cvt_pk_bf16_f32 v98, v192, v196
    v_cvt_pk_bf16_f32 v102, v193, v197
    v_cvt_pk_bf16_f32 v106, v194, v198
    v_cvt_pk_bf16_f32 v110, v195, v199
    v_cvt_pk_bf16_f32 v114, v200, v204
    v_cvt_pk_bf16_f32 v118, v201, v205
    v_cvt_pk_bf16_f32 v122, v202, v206
    v_cvt_pk_bf16_f32 v126, v203, v207
    v_mfma_f32_16x16x32_bf16 v[176:179], v[128:131], v[160:163], 0
    v_mfma_f32_16x16x32_bf16 v[180:183], v[128:131], v[164:167], 0
    v_mfma_f32_16x16x32_bf16 v[184:187], v[136:139], v[160:163], 0
    v_mfma_f32_16x16x32_bf16 v[188:191], v[136:139], v[164:167], 0
    v_mfma_f32_16x16x32_bf16 v[192:195], v[144:147], v[160:163], 0
    v_mfma_f32_16x16x32_bf16 v[196:199], v[144:147], v[164:167], 0
    v_mfma_f32_16x16x32_bf16 v[200:203], v[152:155], v[160:163], 0
    v_mfma_f32_16x16x32_bf16 v[204:207], v[152:155], v[164:167], 0
    v_mfma_f32_16x16x32_bf16 v[176:179], v[132:135], v[168:171], v[176:179]
    v_mfma_f32_16x16x32_bf16 v[180:183], v[132:135], v[172:175], v[180:183]
    v_mfma_f32_16x16x32_bf16 v[184:187], v[140:143], v[168:171], v[184:187]
    v_mfma_f32_16x16x32_bf16 v[188:191], v[140:143], v[172:175], v[188:191]
    v_mfma_f32_16x16x32_bf16 v[192:195], v[148:151], v[168:171], v[192:195]
    v_mfma_f32_16x16x32_bf16 v[196:199], v[148:151], v[172:175], v[196:199]
    v_mfma_f32_16x16x32_bf16 v[200:203], v[156:159], v[168:171], v[200:203]
    v_mfma_f32_16x16x32_bf16 v[204:207], v[156:159], v[172:175], v[204:207]
    s_nop 1
    v_cvt_pk_bf16_f32 v67, v176, v180
    v_cvt_pk_bf16_f32 v71, v177, v181
    v_cvt_pk_bf16_f32 v75, v178, v182
    v_cvt_pk_bf16_f32 v79, v179, v183
    v_cvt_pk_bf16_f32 v83, v184, v188
    v_cvt_pk_bf16_f32 v87, v185, v189
    v_cvt_pk_bf16_f32 v91, v186, v190
    v_cvt_pk_bf16_f32 v95, v187, v191
    v_cvt_pk_bf16_f32 v99, v192, v196
    v_cvt_pk_bf16_f32 v103, v193, v197
    v_cvt_pk_bf16_f32 v107, v194, v198
    v_cvt_pk_bf16_f32 v111, v195, v199
    v_cvt_pk_bf16_f32 v115, v200, v204
    v_cvt_pk_bf16_f32 v119, v201, v205
    v_cvt_pk_bf16_f32 v123, v202, v206
    v_cvt_pk_bf16_f32 v127, v203, v207
    s_add_u32 s25, s24, 0
    buffer_store_dwordx4 v[64:67], v212, s[16:19], s25 offen sc1
    s_add_u32 s25, s24, 10752
    buffer_store_dwordx4 v[68:71], v212, s[16:19], s25 offen sc1
    s_add_u32 s25, s24, 21504
    buffer_store_dwordx4 v[72:75], v212, s[16:19], s25 offen sc1
    s_add_u32 s25, s24, 32256
    buffer_store_dwordx4 v[76:79], v212, s[16:19], s25 offen sc1
    s_add_u32 s25, s24, 172032
    buffer_store_dwordx4 v[80:83], v212, s[16:19], s25 offen sc1
    s_add_u32 s25, s24, 182784
    buffer_store_dwordx4 v[84:87], v212, s[16:19], s25 offen sc1
    s_add_u32 s25, s24, 193536
    buffer_store_dwordx4 v[88:91], v212, s[16:19], s25 offen sc1
    s_add_u32 s25, s24, 204288
    buffer_store_dwordx4 v[92:95], v212, s[16:19], s25 offen sc1
    s_add_u32 s25, s24, 344064
    buffer_store_dwordx4 v[96:99], v212, s[16:19], s25 offen sc1
    s_add_u32 s25, s24, 354816
    buffer_store_dwordx4 v[100:103], v212, s[16:19], s25 offen sc1
    s_add_u32 s25, s24, 365568
    buffer_store_dwordx4 v[104:107], v212, s[16:19], s25 offen sc1
    s_add_u32 s25, s24, 376320
    buffer_store_dwordx4 v[108:111], v212, s[16:19], s25 offen sc1
    s_add_u32 s25, s24, 516096
    buffer_store_dwordx4 v[112:115], v212, s[16:19], s25 offen sc1
    s_add_u32 s25, s24, 526848
    buffer_store_dwordx4 v[116:119], v212, s[16:19], s25 offen sc1
    s_add_u32 s25, s24, 537600
    buffer_store_dwordx4 v[120:123], v212, s[16:19], s25 offen sc1
    s_add_u32 s25, s24, 548352
    buffer_store_dwordx4 v[124:127], v212, s[16:19], s25 offen sc1
    s_branch L_next1
L_cw1:
    s_sub_u32 s12, s40, 672
    s_and_b32 s13, s12, 3
    s_lshr_b32 s14, s12, 2
    s_lshl_b32 s14, s14, 2
    s_add_u32 s14, s14, s10
    ds_read_b128 v[128:131], v223 offset:8192
    ds_read_b128 v[132:135], v223 offset:9216
    ds_read_b128 v[136:139], v223 offset:10240
    ds_read_b128 v[140:143], v223 offset:11264
    s_and_b32 s24, s14, 3
    s_bfe_u32 s25, s14, 0x10003
    s_lshl_b32 s25, s25, 2
    s_or_b32 s24, s24, s25
    s_lshl_b32 s24, s24, 1
    v_xor_b32 v213, s24, v209
    v_lshl_add_u32 v212, v213, 4, v227
    s_mul_i32 s24, s13, 16777216
    s_lshr_b32 s25, s14, 5
    s_mul_i32 s25, s25, 524288
    s_add_u32 s24, s24, s25
    s_and_b32 s25, s14, 31
    s_lshl_b32 s25, s25, 8
    s_add_u32 s24, s24, s25
    v_perm_b32 v80, v64, v64, s32
    v_perm_b32 v81, v68, v68, s32
    v_perm_b32 v82, v72, v72, s32
    v_perm_b32 v83, v76, v76, s32
    v_perm_b32 v84, v64, v64, s33
    v_perm_b32 v85, v68, v68, s33
    v_perm_b32 v86, v72, v72, s33
    v_perm_b32 v87, v76, v76, s33
    v_perm_b32 v88, v65, v65, s32
    v_perm_b32 v89, v69, v69, s32
    v_perm_b32 v90, v73, v73, s32
    v_perm_b32 v91, v77, v77, s32
    v_perm_b32 v92, v65, v65, s33
    v_perm_b32 v93, v69, v69, s33
    v_perm_b32 v94, v73, v73, s33
    v_perm_b32 v95, v77, v77, s33
    v_perm_b32 v96, v66, v66, s32
    v_perm_b32 v97, v70, v70, s32
    v_perm_b32 v98, v74, v74, s32
    v_perm_b32 v99, v78, v78, s32
    v_perm_b32 v100, v66, v66, s33
    v_perm_b32 v101, v70, v70, s33
    v_perm_b32 v102, v74, v74, s33
    v_perm_b32 v103, v78, v78, s33
    v_perm_b32 v104, v67, v67, s32
    v_perm_b32 v105, v71, v71, s32
    v_perm_b32 v106, v75, v75, s32
    v_perm_b32 v107, v79, v79, s32
    v_perm_b32 v108, v67, v67, s33
    v_perm_b32 v109, v71, v71, s33
    v_perm_b32 v110, v75, v75, s33
    v_perm_b32 v111, v79, v79, s33
    s_waitcnt lgkmcnt(0)
    v_mfma_f32_16x16x32_bf16 v[176:179], v[128:131], v[80:83], 0
    v_mfma_f32_16x16x32_bf16 v[180:183], v[128:131], v[84:87], 0
    v_mfma_f32_16x16x32_bf16 v[184:187], v[128:131], v[88:91], 0
    v_mfma_f32_16x16x32_bf16 v[188:191], v[128:131], v[92:95], 0
    v_mfma_f32_16x16x32_bf16 v[192:195], v[128:131], v[96:99], 0
    v_mfma_f32_16x16x32_bf16 v[196:199], v[128:131], v[100:103], 0
    v_mfma_f32_16x16x32_bf16 v[200:203], v[128:131], v[104:107], 0
    v_mfma_f32_16x16x32_bf16 v[204:207], v[128:131], v[108:111], 0
    s_nop 1
    v_cvt_pk_bf16_f32 v64, v176, v180
    s_nop 0
    v_cvt_pk_bf16_f32 v65, v184, v188
    s_nop 0
    v_cvt_pk_bf16_f32 v66, v192, v196
    s_nop 0
    v_cvt_pk_bf16_f32 v67, v200, v204
    v_cvt_pk_bf16_f32 v68, v177, v181
    v_cvt_pk_bf16_f32 v69, v185, v189
    v_cvt_pk_bf16_f32 v70, v193, v197
    v_cvt_pk_bf16_f32 v71, v201, v205
    v_cvt_pk_bf16_f32 v72, v178, v182
    v_cvt_pk_bf16_f32 v73, v186, v190
    v_cvt_pk_bf16_f32 v74, v194, v198
    v_cvt_pk_bf16_f32 v75, v202, v206
    v_cvt_pk_bf16_f32 v76, v179, v183
    v_cvt_pk_bf16_f32 v77, v187, v191
    v_cvt_pk_bf16_f32 v78, v195, v199
    v_cvt_pk_bf16_f32 v79, v203, v207
    s_add_u32 s25, s24, 0
    buffer_store_dwordx4 v[64:67], v212, s[16:19], s25 offen sc1
    s_add_u32 s25, s24, 8192
    buffer_store_dwordx4 v[68:71], v212, s[16:19], s25 offen sc1
    s_add_u32 s25, s24, 16384
    buffer_store_dwordx4 v[72:75], v212, s[16:19], s25 offen sc1
    s_add_u32 s25, s24, 24576
    buffer_store_dwordx4 v[76:79], v212, s[16:19], s25 offen sc1
    v_mfma_f32_16x16x32_bf16 v[176:179], v[132:135], v[80:83], 0
    v_mfma_f32_16x16x32_bf16 v[180:183], v[132:135], v[84:87], 0
    v_mfma_f32_16x16x32_bf16 v[184:187], v[132:135], v[88:91], 0
    v_mfma_f32_16x16x32_bf16 v[188:191], v[132:135], v[92:95], 0
    v_mfma_f32_16x16x32_bf16 v[192:195], v[132:135], v[96:99], 0
    v_mfma_f32_16x16x32_bf16 v[196:199], v[132:135], v[100:103], 0
    v_mfma_f32_16x16x32_bf16 v[200:203], v[132:135], v[104:107], 0
    v_mfma_f32_16x16x32_bf16 v[204:207], v[132:135], v[108:111], 0
    s_nop 1
    v_cvt_pk_bf16_f32 v112, v176, v180
    s_nop 0
    v_cvt_pk_bf16_f32 v113, v184, v188
    s_nop 0
    v_cvt_pk_bf16_f32 v114, v192, v196
    s_nop 0
    v_cvt_pk_bf16_f32 v115, v200, v204
    v_cvt_pk_bf16_f32 v116, v177, v181
    v_cvt_pk_bf16_f32 v117, v185, v189
    v_cvt_pk_bf16_f32 v118, v193, v197
    v_cvt_pk_bf16_f32 v119, v201, v205
    v_cvt_pk_bf16_f32 v120, v178, v182
    v_cvt_pk_bf16_f32 v121, v186, v190
    v_cvt_pk_bf16_f32 v122, v194, v198
    v_cvt_pk_bf16_f32 v123, v202, v206
    v_cvt_pk_bf16_f32 v124, v179, v183
    v_cvt_pk_bf16_f32 v125, v187, v191
    v_cvt_pk_bf16_f32 v126, v195, v199
    v_cvt_pk_bf16_f32 v127, v203, v207
    s_add_u32 s25, s24, 131072
    buffer_store_dwordx4 v[112:115], v212, s[16:19], s25 offen sc1
    s_add_u32 s25, s24, 139264
    buffer_store_dwordx4 v[116:119], v212, s[16:19], s25 offen sc1
    s_add_u32 s25, s24, 147456
    buffer_store_dwordx4 v[120:123], v212, s[16:19], s25 offen sc1
    s_add_u32 s25, s24, 155648
    buffer_store_dwordx4 v[124:127], v212, s[16:19], s25 offen sc1
    v_mfma_f32_16x16x32_bf16 v[176:179], v[136:139], v[80:83], 0
    v_mfma_f32_16x16x32_bf16 v[180:183], v[136:139], v[84:87], 0
    v_mfma_f32_16x16x32_bf16 v[184:187], v[136:139], v[88:91], 0
    v_mfma_f32_16x16x32_bf16 v[188:191], v[136:139], v[92:95], 0
    v_mfma_f32_16x16x32_bf16 v[192:195], v[136:139], v[96:99], 0
    v_mfma_f32_16x16x32_bf16 v[196:199], v[136:139], v[100:103], 0
    v_mfma_f32_16x16x32_bf16 v[200:203], v[136:139], v[104:107], 0
    v_mfma_f32_16x16x32_bf16 v[204:207], v[136:139], v[108:111], 0
    s_nop 1
    v_cvt_pk_bf16_f32 v64, v176, v180
    s_nop 0
    v_cvt_pk_bf16_f32 v65, v184, v188
    s_nop 0
    v_cvt_pk_bf16_f32 v66, v192, v196
    s_nop 0
    v_cvt_pk_bf16_f32 v67, v200, v204
    v_cvt_pk_bf16_f32 v68, v177, v181
    v_cvt_pk_bf16_f32 v69, v185, v189
    v_cvt_pk_bf16_f32 v70, v193, v197
    v_cvt_pk_bf16_f32 v71, v201, v205
    v_cvt_pk_bf16_f32 v72, v178, v182
    v_cvt_pk_bf16_f32 v73, v186, v190
    v_cvt_pk_bf16_f32 v74, v194, v198
    v_cvt_pk_bf16_f32 v75, v202, v206
    v_cvt_pk_bf16_f32 v76, v179, v183
    v_cvt_pk_bf16_f32 v77, v187, v191
    v_cvt_pk_bf16_f32 v78, v195, v199
    v_cvt_pk_bf16_f32 v79, v203, v207
    s_add_u32 s25, s24, 262144
    buffer_store_dwordx4 v[64:67], v212, s[16:19], s25 offen sc1
    s_add_u32 s25, s24, 270336
    buffer_store_dwordx4 v[68:71], v212, s[16:19], s25 offen sc1
    s_add_u32 s25, s24, 278528
    buffer_store_dwordx4 v[72:75], v212, s[16:19], s25 offen sc1
    s_add_u32 s25, s24, 286720
    buffer_store_dwordx4 v[76:79], v212, s[16:19], s25 offen sc1
    v_mfma_f32_16x16x32_bf16 v[176:179], v[140:143], v[80:83], 0
    v_mfma_f32_16x16x32_bf16 v[180:183], v[140:143], v[84:87], 0
    v_mfma_f32_16x16x32_bf16 v[184:187], v[140:143], v[88:91], 0
    v_mfma_f32_16x16x32_bf16 v[188:191], v[140:143], v[92:95], 0
    v_mfma_f32_16x16x32_bf16 v[192:195], v[140:143], v[96:99], 0
    v_mfma_f32_16x16x32_bf16 v[196:199], v[140:143], v[100:103], 0
    v_mfma_f32_16x16x32_bf16 v[200:203], v[140:143], v[104:107], 0
    v_mfma_f32_16x16x32_bf16 v[204:207], v[140:143], v[108:111], 0
    s_nop 1
    v_cvt_pk_bf16_f32 v112, v176, v180
    s_nop 0
    v_cvt_pk_bf16_f32 v113, v184, v188
    s_nop 0
    v_cvt_pk_bf16_f32 v114, v192, v196
    s_nop 0
    v_cvt_pk_bf16_f32 v115, v200, v204
    v_cvt_pk_bf16_f32 v116, v177, v181
    v_cvt_pk_bf16_f32 v117, v185, v189
    v_cvt_pk_bf16_f32 v118, v193, v197
    v_cvt_pk_bf16_f32 v119, v201, v205
    v_cvt_pk_bf16_f32 v120, v178, v182
    v_cvt_pk_bf16_f32 v121, v186, v190
    v_cvt_pk_bf16_f32 v122, v194, v198
    v_cvt_pk_bf16_f32 v123, v202, v206
    v_cvt_pk_bf16_f32 v124, v179, v183
    v_cvt_pk_bf16_f32 v125, v187, v191
    v_cvt_pk_bf16_f32 v126, v195, v199
    v_cvt_pk_bf16_f32 v127, v203, v207
    s_add_u32 s25, s24, 393216
    buffer_store_dwordx4 v[112:115], v212, s[16:19], s25 offen sc1
    s_add_u32 s25, s24, 401408
    buffer_store_dwordx4 v[116:119], v212, s[16:19], s25 offen sc1
    s_add_u32 s25, s24, 409600
    buffer_store_dwordx4 v[120:123], v212, s[16:19], s25 offen sc1
    s_add_u32 s25, s24, 417792
    buffer_store_dwordx4 v[124:127], v212, s[16:19], s25 offen sc1
L_next1:
    s_cmp_lg_u32 s10, 0
    s_cbranch_scc1 L_pub1
    s_cmp_ge_u32 s42, 1696
    s_cbranch_scc1 L_w0_p1
    s_cmp_ge_u32 s42, 672
    s_cbranch_scc1 L_w8_p1
    s_waitcnt vmcnt(32)
    s_branch L_wd_p1
L_w8_p1:
    s_waitcnt vmcnt(24)
    s_branch L_wd_p1
L_w0_p1:
    s_waitcnt vmcnt(16)
L_wd_p1:
    v_add_u32 v221, 512, v221
    v_mov_b32 v213, s41
    s_mov_b64 exec, 1
    ds_write_b32 v213, v221 offset:12288
    s_mov_b64 exec, -1
L_pub1:
    s_waitcnt lgkmcnt(0)
    s_barrier
    v_mov_b32 v213, s41
    ds_read_b32 v214, v213 offset:12288
    s_xor_b32 s41, s41, 4
    s_mov_b32 s40, s42
    s_waitcnt lgkmcnt(0)
    v_readfirstlane_b32 s42, v214
    s_cmp_ge_u32 s40, 1696
    s_cbranch_scc1 L_k12_fin
    s_branch L_k12_loop
L_k12_fin:
L_k12_end:
    s_endpgm
.globl gemm_kernel
.p2align 8
.type gemm_kernel,@function
gemm_kernel:
    s_cmp_ge_u32 s2, 256
    s_cbranch_scc1 L_k3_end
    s_load_dwordx2 s[8:9], s[0:1], 48
    v_lshrrev_b32 v253, 6, v0
    v_and_b32 v0, 63, v0
    v_readfirstlane_b32 s10, v253
    s_cmp_ge_u32 s2, 8
    s_cbranch_scc1 L_nopf3
    s_nop 1
    s_cmp_lg_u32 s10, 7
    s_cbranch_scc1 L_nopf3
    s_getpc_b64 s[60:61]
L_pf_k3:
    s_sub_u32 s60, s60, L_pf_k3-gemm_kernel
    s_subb_u32 s61, s61, 0
    v_mbcnt_lo_u32_b32 v12, -1, 0
    v_mbcnt_hi_u32_b32 v12, -1, v12
    v_lshlrev_b32 v12, 6, v12
    v_add_u32 v13, 0, v12
    v_min_u32 v13, final_kernel-gemm_kernel-4, v13
    v_mov_b32 v15, s61
    v_add_co_u32 v14, vcc, s60, v13
    s_nop 1
    v_addc_co_u32 v15, vcc, 0, v15, vcc
    global_load_dword v16, v[14:15], off
    v_add_u32 v13, 4096, v12
    v_min_u32 v13, final_kernel-gemm_kernel-4, v13
    v_mov_b32 v15, s61
    v_add_co_u32 v14, vcc, s60, v13
    s_nop 1
    v_addc_co_u32 v15, vcc, 0, v15, vcc
    global_load_dword v16, v[14:15], off
    v_add_u32 v13, 8192, v12
    v_min_u32 v13, final_kernel-gemm_kernel-4, v13
    v_mov_b32 v15, s61
    v_add_co_u32 v14, vcc, s60, v13
    s_nop 1
    v_addc_co_u32 v15, vcc, 0, v15, vcc
    global_load_dword v16, v[14:15], off
    v_add_u32 v13, 12288, v12
    v_min_u32 v13, final_kernel-gemm_kernel-4, v13
    v_mov_b32 v15, s61
    v_add_co_u32 v14, vcc, s60, v13
    s_nop 1
    v_addc_co_u32 v15, vcc, 0, v15, vcc
    global_load_dword v16, v[14:15], off
L_nopf3:
    s_and_b32 s11, s2, 7
    s_lshr_b32 s12, s2, 3
    s_lshr_b32 s13, s12, 3
    s_lshl_b32 s11, s11, 2
    s_add_u32 s11, s11, s13
    s_bfe_u32 s13, s12, 0x10002
    s_and_b32 s14, s12, 3
    s_and_b32 s15, s10, 3
    s_waitcnt lgkmcnt(0)
    s_mov_b32 s16, s8
    s_and_b32 s17, s9, 0xffff
    s_mov_b32 s18, 268435456
    s_mov_b32 s19, 0x00020000
    s_cmp_ge_u32 s10, 4
    s_cbranch_scc1 L_k3_helper
    v_lshrrev_b32 v253, 4, v0
    v_and_b32 v254, 15, v0
    v_bfe_u32 v255, v254, 3, 1
    v_mul_u32_u24 v255, 3, v255
    v_xor_b32 v255, v255, v253
    v_lshlrev_b32 v255, 4, v255
    v_lshl_add_u32 v250, v254, 6, v255
    v_lshrrev_b32 v255, 2, v254
    v_and_b32 v216, 1, v253
    v_lshl_or_b32 v216, v216, 2, v255
    v_lshl_add_u32 v255, v253, 3, v255
    v_lshlrev_b32 v255, 8, v255
    v_and_b32 v217, 3, v254
    v_lshl_add_u32 v255, v217, 3, v255
    s_lshl_b32 s20, s15, 1
    s_add_u32 s20, s20, s13
    v_xor_b32 v217, s20, v216
    v_lshl_add_u32 v248, v217, 5, v255
    s_xor_b32 s20, s20, 1
    v_xor_b32 v217, s20, v216
    v_lshl_add_u32 v249, v217, 5, v255
    v_lshlrev_b32 v251, 6, v254
    v_lshl_add_u32 v251, v253, 4, v251
    v_and_b32 v255, 7, v254
    v_lshlrev_b32 v252, 6, v255
    v_lshrrev_b32 v216, 3, v254
    v_xor_b32 v216, s13, v216
    s_mov_b32 s22, 11534336
    v_mul_lo_u32 v216, v216, s22
    v_add_u32 v252, v252, v216
    v_lshl_add_u32 v252, v253, 4, v252
    s_lshl_b32 s22, s13, 3
    v_add_u32 v252, s22, v252
    v_cmp_gt_u32 vcc, 7, v255
    v_mov_b32 v216, 0x80000000
    s_nop 0
    v_cndmask_b32 v252, v216, v252, vcc
    s_lshl_b32 s20, s14, 2
    s_add_u32 s20, s20, s15
    s_mul_i32 s48, s20, 720896
    s_mul_i32 s20, s11, 22528
    s_add_u32 s48, s48, s20
    s_add_u32 s48, s48, 117440512
    s_add_u32 s49, s48, 10240
    s_mul_i32 s20, s13, 11534336
    s_add_u32 s48, s48, s20
    v_mov_b32 v0, 0
    v_mov_b32 v1, 0
    v_mov_b32 v2, 0
    v_mov_b32 v3, 0
    v_mov_b32 v4, 0
    v_mov_b32 v5, 0
    v_mov_b32 v6, 0
    v_mov_b32 v7, 0
    v_mov_b32 v8, 0
    v_mov_b32 v9, 0
    v_mov_b32 v10, 0
    v_mov_b32 v11, 0
    v_mov_b32 v12, 0
    v_mov_b32 v13, 0
    v_mov_b32 v14, 0
    v_mov_b32 v15, 0
    v_mov_b32 v16, 0
    v_mov_b32 v17, 0
    v_mov_b32 v18, 0
    v_mov_b32 v19, 0
    v_mov_b32 v20, 0
    v_mov_b32 v21, 0
    v_mov_b32 v22, 0
    v_mov_b32 v23, 0
    v_mov_b32 v24, 0
    v_mov_b32 v25, 0
    v_mov_b32 v26, 0
    v_mov_b32 v27, 0
    v_mov_b32 v28, 0
    v_mov_b32 v29, 0
    v_mov_b32 v30, 0
    v_mov_b32 v31, 0
    v_mov_b32 v32, 0
    v_mov_b32 v33, 0
    v_mov_b32 v34, 0
    v_mov_b32 v35, 0
    v_mov_b32 v36, 0
    v_mov_b32 v37, 0
    v_mov_b32 v38, 0
    v_mov_b32 v39, 0
    v_mov_b32 v40, 0
    v_mov_b32 v41, 0
    v_mov_b32 v42, 0
    v_mov_b32 v43, 0
    v_mov_b32 v44, 0
    v_mov_b32 v45, 0
    v_mov_b32 v46, 0
    v_mov_b32 v47, 0
    v_mov_b32 v48, 0
    v_mov_b32 v49, 0
    v_mov_b32 v50, 0
    v_mov_b32 v51, 0
    v_mov_b32 v52, 0
    v_mov_b32 v53, 0
    v_mov_b32 v54, 0
    v_mov_b32 v55, 0
    v_mov_b32 v56, 0
    v_mov_b32 v57, 0
    v_mov_b32 v58, 0
    v_mov_b32 v59, 0
    v_mov_b32 v60, 0
    v_mov_b32 v61, 0
    v_mov_b32 v62, 0
    v_mov_b32 v63, 0
    v_mov_b32 v64, 0
    v_mov_b32 v65, 0
    v_mov_b32 v66, 0
    v_mov_b32 v67, 0
    v_mov_b32 v68, 0
    v_mov_b32 v69, 0
    v_mov_b32 v70, 0
    v_mov_b32 v71, 0
    v_mov_b32 v72, 0
    v_mov_b32 v73, 0
    v_mov_b32 v74, 0
    v_mov_b32 v75, 0
    v_mov_b32 v76, 0
    v_mov_b32 v77, 0
    v_mov_b32 v78, 0
    v_mov_b32 v79, 0
    v_mov_b32 v80, 0
    v_mov_b32 v81, 0
    v_mov_b32 v82, 0
    v_mov_b32 v83, 0
    v_mov_b32 v84, 0
    v_mov_b32 v85, 0
    v_mov_b32 v86, 0
    v_mov_b32 v87, 0
    v_mov_b32 v88, 0
    v_mov_b32 v89, 0
    v_mov_b32 v90, 0
    v_mov_b32 v91, 0
    v_mov_b32 v92, 0
    v_mov_b32 v93, 0
    v_mov_b32 v94, 0
    v_mov_b32 v95, 0
    v_mov_b32 v96, 0
    v_mov_b32 v97, 0
    v_mov_b32 v98, 0
    v_mov_b32 v99, 0
    v_mov_b32 v100, 0
    v_mov_b32 v101, 0
    v_mov_b32 v102, 0
    v_mov_b32 v103, 0
    v_mov_b32 v104, 0
    v_mov_b32 v105, 0
    v_mov_b32 v106, 0
    v_mov_b32 v107, 0
    v_mov_b32 v108, 0
    v_mov_b32 v109, 0
    v_mov_b32 v110, 0
    v_mov_b32 v111, 0
    v_mov_b32 v112, 0
    v_mov_b32 v113, 0
    v_mov_b32 v114, 0
    v_mov_b32 v115, 0
    v_mov_b32 v116, 0
    v_mov_b32 v117, 0
    v_mov_b32 v118, 0
    v_mov_b32 v119, 0
    v_mov_b32 v120, 0
    v_mov_b32 v121, 0
    v_mov_b32 v122, 0
    v_mov_b32 v123, 0
    v_mov_b32 v124, 0
    v_mov_b32 v125, 0
    v_mov_b32 v126, 0
    v_mov_b32 v127, 0
    v_mov_b32 v128, 0
    v_mov_b32 v129, 0
    v_mov_b32 v130, 0
    v_mov_b32 v131, 0
    v_mov_b32 v132, 0
    v_mov_b32 v133, 0
    v_mov_b32 v134, 0
    v_mov_b32 v135, 0
    v_mov_b32 v136, 0
    v_mov_b32 v137, 0
    v_mov_b32 v138, 0
    v_mov_b32 v139, 0
    v_mov_b32 v140, 0
    v_mov_b32 v141, 0
    v_mov_b32 v142, 0
    v_mov_b32 v143, 0
    v_mov_b32 v144, 0
    v_mov_b32 v145, 0
    v_mov_b32 v146, 0
    v_mov_b32 v147, 0
    v_mov_b32 v148, 0
    v_mov_b32 v149, 0
    v_mov_b32 v150, 0
    v_mov_b32 v151, 0
    v_mov_b32 v152, 0
    v_mov_b32 v153, 0
    v_mov_b32 v154, 0
    v_mov_b32 v155, 0
    v_mov_b32 v156, 0
    v_mov_b32 v157, 0
    v_mov_b32 v158, 0
    v_mov_b32 v159, 0
    v_mov_b32 v160, 0
    v_mov_b32 v161, 0
    v_mov_b32 v162, 0
    v_mov_b32 v163, 0
    v_mov_b32 v164, 0
    v_mov_b32 v165, 0
    v_mov_b32 v166, 0
    v_mov_b32 v167, 0
    s_barrier
    ds_read_b64_tr_b16 v[176:177], v248 offset:0
    ds_read_b64_tr_b16 v[178:179], v248 offset:1024
    ds_read_b64_tr_b16 v[180:181], v249 offset:0
    ds_read_b64_tr_b16 v[182:183], v249 offset:1024
    ds_read_b64_tr_b16 v[184:185], v248 offset:8192
    ds_read_b64_tr_b16 v[186:187], v248 offset:9216
    ds_read_b64_tr_b16 v[188:189], v249 offset:8192
    ds_read_b64_tr_b16 v[190:191], v249 offset:9216
    ds_read_b128 v[216:219], v250 offset:16384
    ds_read_b128 v[220:223], v250 offset:27648
    ds_read_b128 v[224:227], v250 offset:17408
    ds_read_b128 v[228:231], v250 offset:28672
    s_waitcnt lgkmcnt(4)
    v_xor_b32 v208, 0x80008000, v184
    v_xor_b32 v209, 0x80008000, v185
    v_xor_b32 v210, 0x80008000, v186
    v_xor_b32 v211, 0x80008000, v187
    v_xor_b32 v212, 0x80008000, v188
    v_xor_b32 v213, 0x80008000, v189
    v_xor_b32 v214, 0x80008000, v190
    v_xor_b32 v215, 0x80008000, v191
    s_mov_b32 s46, 7
L_g_loop:
    s_barrier
    s_waitcnt lgkmcnt(2)
    v_mfma_f32_16x16x32_bf16 v[0:3], v[176:179], v[216:219], v[0:3]
    ds_read_b128 v[232:235], v250 offset:18432
    ds_read_b128 v[236:239], v250 offset:29696
    v_mfma_f32_16x16x32_bf16 v[4:7], v[180:183], v[216:219], v[4:7]
    v_mfma_f32_16x16x32_bf16 v[8:11], v[208:211], v[216:219], v[8:11]
    v_mfma_f32_16x16x32_bf16 v[12:15], v[212:215], v[216:219], v[12:15]
    v_mfma_f32_16x16x32_bf16 v[0:3], v[184:187], v[220:223], v[0:3]
    v_mfma_f32_16x16x32_bf16 v[4:7], v[188:191], v[220:223], v[4:7]
    v_mfma_f32_16x16x32_bf16 v[8:11], v[176:179], v[220:223], v[8:11]
    v_mfma_f32_16x16x32_bf16 v[12:15], v[180:183], v[220:223], v[12:15]
    s_waitcnt lgkmcnt(2)
    v_mfma_f32_16x16x32_bf16 v[16:19], v[176:179], v[224:227], v[16:19]
    ds_read_b128 v[240:243], v250 offset:19456
    ds_read_b128 v[244:247], v250 offset:30720
    v_mfma_f32_16x16x32_bf16 v[20:23], v[180:183], v[224:227], v[20:23]
    v_mfma_f32_16x16x32_bf16 v[24:27], v[208:211], v[224:227], v[24:27]
    v_mfma_f32_16x16x32_bf16 v[28:31], v[212:215], v[224:227], v[28:31]
    v_mfma_f32_16x16x32_bf16 v[16:19], v[184:187], v[228:231], v[16:19]
    v_mfma_f32_16x16x32_bf16 v[20:23], v[188:191], v[228:231], v[20:23]
    v_mfma_f32_16x16x32_bf16 v[24:27], v[176:179], v[228:231], v[24:27]
    v_mfma_f32_16x16x32_bf16 v[28:31], v[180:183], v[228:231], v[28:31]
    s_waitcnt lgkmcnt(2)
    v_mfma_f32_16x16x32_bf16 v[32:35], v[176:179], v[232:235], v[32:35]
    ds_read_b128 v[216:219], v250 offset:20480
    ds_read_b128 v[220:223], v250 offset:31744
    v_mfma_f32_16x16x32_bf16 v[36:39], v[180:183], v[232:235], v[36:39]
    v_mfma_f32_16x16x32_bf16 v[40:43], v[208:211], v[232:235], v[40:43]
    v_mfma_f32_16x16x32_bf16 v[44:47], v[212:215], v[232:235], v[44:47]
    v_mfma_f32_16x16x32_bf16 v[32:35], v[184:187], v[236:239], v[32:35]
    v_mfma_f32_16x16x32_bf16 v[36:39], v[188:191], v[236:239], v[36:39]
    v_mfma_f32_16x16x32_bf16 v[40:43], v[176:179], v[236:239], v[40:43]
    v_mfma_f32_16x16x32_bf16 v[44:47], v[180:183], v[236:239], v[44:47]
    s_waitcnt lgkmcnt(2)
    v_mfma_f32_16x16x32_bf16 v[48:51], v[176:179], v[240:243], v[48:51]
    ds_read_b128 v[224:227], v250 offset:21504
    ds_read_b128 v[228:231], v250 offset:32768
    v_mfma_f32_16x16x32_bf16 v[52:55], v[180:183], v[240:243], v[52:55]
    v_mfma_f32_16x16x32_bf16 v[56:59], v[208:211], v[240:243], v[56:59]
    v_mfma_f32_16x16x32_bf16 v[60:63], v[212:215], v[240:243], v[60:63]
    v_mfma_f32_16x16x32_bf16 v[48:51], v[184:187], v[244:247], v[48:51]
    v_mfma_f32_16x16x32_bf16 v[52:55], v[188:191], v[244:247], v[52:55]
    v_mfma_f32_16x16x32_bf16 v[56:59], v[176:179], v[244:247], v[56:59]
    v_mfma_f32_16x16x32_bf16 v[60:63], v[180:183], v[244:247], v[60:63]
    s_waitcnt lgkmcnt(2)
    v_mfma_f32_16x16x32_bf16 v[64:67], v[176:179], v[216:219], v[64:67]
    ds_read_b128 v[232:235], v250 offset:22528
    ds_read_b128 v[236:239], v250 offset:33792
    v_mfma_f32_16x16x32_bf16 v[68:71], v[180:183], v[216:219], v[68:71]
    v_mfma_f32_16x16x32_bf16 v[72:75], v[208:211], v[216:219], v[72:75]
    v_mfma_f32_16x16x32_bf16 v[76:79], v[212:215], v[216:219], v[76:79]
    v_mfma_f32_16x16x32_bf16 v[64:67], v[184:187], v[220:223], v[64:67]
    v_mfma_f32_16x16x32_bf16 v[68:71], v[188:191], v[220:223], v[68:71]
    v_mfma_f32_16x16x32_bf16 v[72:75], v[176:179], v[220:223], v[72:75]
    v_mfma_f32_16x16x32_bf16 v[76:79], v[180:183], v[220:223], v[76:79]
    s_waitcnt lgkmcnt(2)
    v_mfma_f32_16x16x32_bf16 v[80:83], v[176:179], v[224:227], v[80:83]
    ds_read_b128 v[240:243], v250 offset:23552
    ds_read_b128 v[244:247], v250 offset:34816
    v_mfma_f32_16x16x32_bf16 v[84:87], v[180:183], v[224:227], v[84:87]
    v_mfma_f32_16x16x32_bf16 v[88:91], v[208:211], v[224:227], v[88:91]
    v_mfma_f32_16x16x32_bf16 v[92:95], v[212:215], v[224:227], v[92:95]
    v_mfma_f32_16x16x32_bf16 v[80:83], v[184:187], v[228:231], v[80:83]
    v_add_u32 v248, 0x9800, v248
    v_add_u32 v249, 0x9800, v249
    v_mfma_f32_16x16x32_bf16 v[84:87], v[188:191], v[228:231], v[84:87]
    v_mfma_f32_16x16x32_bf16 v[88:91], v[176:179], v[228:231], v[88:91]
    v_mfma_f32_16x16x32_bf16 v[92:95], v[180:183], v[228:231], v[92:95]
    s_waitcnt lgkmcnt(2)
    v_mfma_f32_16x16x32_bf16 v[96:99], v[176:179], v[232:235], v[96:99]
    ds_read_b128 v[216:219], v250 offset:24576
    ds_read_b128 v[220:223], v250 offset:35840
    v_mfma_f32_16x16x32_bf16 v[100:103], v[180:183], v[232:235], v[100:103]
    v_mfma_f32_16x16x32_bf16 v[104:107], v[208:211], v[232:235], v[104:107]
    v_mfma_f32_16x16x32_bf16 v[108:111], v[212:215], v[232:235], v[108:111]
    ds_read_b64_tr_b16 v[192:193], v248 offset:0
    ds_read_b64_tr_b16 v[194:195], v248 offset:1024
    ds_read_b64_tr_b16 v[196:197], v249 offset:0
    ds_read_b64_tr_b16 v[198:199], v249 offset:1024
    v_mfma_f32_16x16x32_bf16 v[96:99], v[184:187], v[236:239], v[96:99]
    v_mfma_f32_16x16x32_bf16 v[100:103], v[188:191], v[236:239], v[100:103]
    v_mfma_f32_16x16x32_bf16 v[104:107], v[176:179], v[236:239], v[104:107]
    v_mfma_f32_16x16x32_bf16 v[108:111], v[180:183], v[236:239], v[108:111]
    s_waitcnt lgkmcnt(6)
    v_mfma_f32_16x16x32_bf16 v[112:115], v[176:179], v[240:243], v[112:115]
    ds_read_b128 v[224:227], v250 offset:25600
    ds_read_b128 v[228:231], v250 offset:36864
    v_mfma_f32_16x16x32_bf16 v[116:119], v[180:183], v[240:243], v[116:119]
    v_mfma_f32_16x16x32_bf16 v[120:123], v[208:211], v[240:243], v[120:123]
    v_mfma_f32_16x16x32_bf16 v[124:127], v[212:215], v[240:243], v[124:127]
    ds_read_b64_tr_b16 v[200:201], v248 offset:8192
    ds_read_b64_tr_b16 v[202:203], v248 offset:9216
    ds_read_b64_tr_b16 v[204:205], v249 offset:8192
    ds_read_b64_tr_b16 v[206:207], v249 offset:9216
    v_mfma_f32_16x16x32_bf16 v[112:115], v[184:187], v[244:247], v[112:115]
    v_mfma_f32_16x16x32_bf16 v[116:119], v[188:191], v[244:247], v[116:119]
    v_mfma_f32_16x16x32_bf16 v[120:123], v[176:179], v[244:247], v[120:123]
    v_mfma_f32_16x16x32_bf16 v[124:127], v[180:183], v[244:247], v[124:127]
    s_waitcnt lgkmcnt(10)
    v_mfma_f32_16x16x32_bf16 v[128:131], v[176:179], v[216:219], v[128:131]
    ds_read_b128 v[232:235], v250 offset:26624
    ds_read_b128 v[236:239], v250 offset:37888
    v_mfma_f32_16x16x32_bf16 v[132:135], v[180:183], v[216:219], v[132:135]
    v_mfma_f32_16x16x32_bf16 v[136:139], v[208:211], v[216:219], v[136:139]
    v_mfma_f32_16x16x32_bf16 v[140:143], v[212:215], v[216:219], v[140:143]
    v_mfma_f32_16x16x32_bf16 v[128:131], v[184:187], v[220:223], v[128:131]
    v_mfma_f32_16x16x32_bf16 v[132:135], v[188:191], v[220:223], v[132:135]
    v_mfma_f32_16x16x32_bf16 v[136:139], v[176:179], v[220:223], v[136:139]
    v_mfma_f32_16x16x32_bf16 v[140:143], v[180:183], v[220:223], v[140:143]
    s_waitcnt lgkmcnt(6)
    v_mfma_f32_16x16x32_bf16 v[144:147], v[176:179], v[224:227], v[144:147]
    v_add_u32 v250, 0x9800, v250
    ds_read_b128 v[240:243], v250 offset:16384
    ds_read_b128 v[244:247], v250 offset:27648
    v_mfma_f32_16x16x32_bf16 v[148:151], v[180:183], v[224:227], v[148:151]
    v_mfma_f32_16x16x32_bf16 v[152:155], v[208:211], v[224:227], v[152:155]
    v_mfma_f32_16x16x32_bf16 v[156:159], v[212:215], v[224:227], v[156:159]
    v_mfma_f32_16x16x32_bf16 v[144:147], v[184:187], v[228:231], v[144:147]
    s_waitcnt lgkmcnt(4)
    v_xor_b32 v212, 0x80008000, v204
    v_xor_b32 v213, 0x80008000, v205
    v_mfma_f32_16x16x32_bf16 v[148:151], v[188:191], v[228:231], v[148:151]
    v_xor_b32 v214, 0x80008000, v206
    v_xor_b32 v215, 0x80008000, v207
    v_mfma_f32_16x16x32_bf16 v[152:155], v[176:179], v[228:231], v[152:155]
    v_mfma_f32_16x16x32_bf16 v[156:159], v[180:183], v[228:231], v[156:159]
    s_waitcnt lgkmcnt(2)
    v_mfma_f32_16x16x32_bf16 v[160:163], v[176:179], v[232:235], v[160:163]
    ds_read_b128 v[216:219], v250 offset:17408
    ds_read_b128 v[220:223], v250 offset:28672
    v_mfma_f32_16x16x32_bf16 v[164:167], v[208:211], v[232:235], v[164:167]
    v_xor_b32 v208, 0x80008000, v200
    v_xor_b32 v209, 0x80008000, v201
    v_mfma_f32_16x16x32_bf16 v[160:163], v[184:187], v[236:239], v[160:163]
    v_xor_b32 v210, 0x80008000, v202
    v_xor_b32 v211, 0x80008000, v203
    v_mfma_f32_16x16x32_bf16 v[164:167], v[176:179], v[236:239], v[164:167]
    s_barrier
    s_waitcnt lgkmcnt(2)
    v_mfma_f32_16x16x32_bf16 v[0:3], v[192:195], v[240:243], v[0:3]
    ds_read_b128 v[224:227], v250 offset:18432
    ds_read_b128 v[228:231], v250 offset:29696
    v_mfma_f32_16x16x32_bf16 v[4:7], v[196:199], v[240:243], v[4:7]
    v_mfma_f32_16x16x32_bf16 v[8:11], v[208:211], v[240:243], v[8:11]
    v_mfma_f32_16x16x32_bf16 v[12:15], v[212:215], v[240:243], v[12:15]
    v_mfma_f32_16x16x32_bf16 v[0:3], v[200:203], v[244:247], v[0:3]
    v_mfma_f32_16x16x32_bf16 v[4:7], v[204:207], v[244:247], v[4:7]
    v_mfma_f32_16x16x32_bf16 v[8:11], v[192:195], v[244:247], v[8:11]
    v_mfma_f32_16x16x32_bf16 v[12:15], v[196:199], v[244:247], v[12:15]
    s_waitcnt lgkmcnt(2)
    v_mfma_f32_16x16x32_bf16 v[16:19], v[192:195], v[216:219], v[16:19]
    ds_read_b128 v[232:235], v250 offset:19456
    ds_read_b128 v[236:239], v250 offset:30720
    v_mfma_f32_16x16x32_bf16 v[20:23], v[196:199], v[216:219], v[20:23]
    v_mfma_f32_16x16x32_bf16 v[24:27], v[208:211], v[216:219], v[24:27]
    v_mfma_f32_16x16x32_bf16 v[28:31], v[212:215], v[216:219], v[28:31]
    v_mfma_f32_16x16x32_bf16 v[16:19], v[200:203], v[220:223], v[16:19]
    v_mfma_f32_16x16x32_bf16 v[20:23], v[204:207], v[220:223], v[20:23]
    v_mfma_f32_16x16x32_bf16 v[24:27], v[192:195], v[220:223], v[24:27]
    v_mfma_f32_16x16x32_bf16 v[28:31], v[196:199], v[220:223], v[28:31]
    s_waitcnt lgkmcnt(2)
    v_mfma_f32_16x16x32_bf16 v[32:35], v[192:195], v[224:227], v[32:35]
    ds_read_b128 v[240:243], v250 offset:20480
    ds_read_b128 v[244:247], v250 offset:31744
    v_mfma_f32_16x16x32_bf16 v[36:39], v[196:199], v[224:227], v[36:39]
    v_mfma_f32_16x16x32_bf16 v[40:43], v[208:211], v[224:227], v[40:43]
    v_mfma_f32_16x16x32_bf16 v[44:47], v[212:215], v[224:227], v[44:47]
    v_mfma_f32_16x16x32_bf16 v[32:35], v[200:203], v[228:231], v[32:35]
    v_mfma_f32_16x16x32_bf16 v[36:39], v[204:207], v[228:231], v[36:39]
    v_mfma_f32_16x16x32_bf16 v[40:43], v[192:195], v[228:231], v[40:43]
    v_mfma_f32_16x16x32_bf16 v[44:47], v[196:199], v[228:231], v[44:47]
    s_waitcnt lgkmcnt(2)
    v_mfma_f32_16x16x32_bf16 v[48:51], v[192:195], v[232:235], v[48:51]
    ds_read_b128 v[216:219], v250 offset:21504
    ds_read_b128 v[220:223], v250 offset:32768
    v_mfma_f32_16x16x32_bf16 v[52:55], v[196:199], v[232:235], v[52:55]
    v_mfma_f32_16x16x32_bf16 v[56:59], v[208:211], v[232:235], v[56:59]
    v_mfma_f32_16x16x32_bf16 v[60:63], v[212:215], v[232:235], v[60:63]
    v_mfma_f32_16x16x32_bf16 v[48:51], v[200:203], v[236:239], v[48:51]
    v_mfma_f32_16x16x32_bf16 v[52:55], v[204:207], v[236:239], v[52:55]
    v_mfma_f32_16x16x32_bf16 v[56:59], v[192:195], v[236:239], v[56:59]
    v_mfma_f32_16x16x32_bf16 v[60:63], v[196:199], v[236:239], v[60:63]
    s_waitcnt lgkmcnt(2)
    v_mfma_f32_16x16x32_bf16 v[64:67], v[192:195], v[240:243], v[64:67]
    ds_read_b128 v[224:227], v250 offset:22528
    ds_read_b128 v[228:231], v250 offset:33792
    v_mfma_f32_16x16x32_bf16 v[68:71], v[196:199], v[240:243], v[68:71]
    v_mfma_f32_16x16x32_bf16 v[72:75], v[208:211], v[240:243], v[72:75]
    v_mfma_f32_16x16x32_bf16 v[76:79], v[212:215], v[240:243], v[76:79]
    v_mfma_f32_16x16x32_bf16 v[64:67], v[200:203], v[244:247], v[64:67]
    v_mfma_f32_16x16x32_bf16 v[68:71], v[204:207], v[244:247], v[68:71]
    v_mfma_f32_16x16x32_bf16 v[72:75], v[192:195], v[244:247], v[72:75]
    v_mfma_f32_16x16x32_bf16 v[76:79], v[196:199], v[244:247], v[76:79]
    s_waitcnt lgkmcnt(2)
    v_mfma_f32_16x16x32_bf16 v[80:83], v[192:195], v[216:219], v[80:83]
    ds_read_b128 v[232:235], v250 offset:23552
    ds_read_b128 v[236:239], v250 offset:34816
    v_mfma_f32_16x16x32_bf16 v[84:87], v[196:199], v[216:219], v[84:87]
    v_mfma_f32_16x16x32_bf16 v[88:91], v[208:211], v[216:219], v[88:91]
    v_mfma_f32_16x16x32_bf16 v[92:95], v[212:215], v[216:219], v[92:95]
    v_mfma_f32_16x16x32_bf16 v[80:83], v[200:203], v[220:223], v[80:83]
    v_add_u32 v248, 0x9800, v248
    v_add_u32 v249, 0x9800, v249
    v_mfma_f32_16x16x32_bf16 v[84:87], v[204:207], v[220:223], v[84:87]
    v_mfma_f32_16x16x32_bf16 v[88:91], v[192:195], v[220:223], v[88:91]
    v_mfma_f32_16x16x32_bf16 v[92:95], v[196:199], v[220:223], v[92:95]
    s_waitcnt lgkmcnt(2)
    v_mfma_f32_16x16x32_bf16 v[96:99], v[192:195], v[224:227], v[96:99]
    ds_read_b128 v[240:243], v250 offset:24576
    ds_read_b128 v[244:247], v250 offset:35840
    v_mfma_f32_16x16x32_bf16 v[100:103], v[196:199], v[224:227], v[100:103]
    v_mfma_f32_16x16x32_bf16 v[104:107], v[208:211], v[224:227], v[104:107]
    v_mfma_f32_16x16x32_bf16 v[108:111], v[212:215], v[224:227], v[108:111]
    ds_read_b64_tr_b16 v[176:177], v248 offset:0
    ds_read_b64_tr_b16 v[178:179], v248 offset:1024
    ds_read_b64_tr_b16 v[180:181], v249 offset:0
    ds_read_b64_tr_b16 v[182:183], v249 offset:1024
    v_mfma_f32_16x16x32_bf16 v[96:99], v[200:203], v[228:231], v[96:99]
    v_mfma_f32_16x16x32_bf16 v[100:103], v[204:207], v[228:231], v[100:103]
    v_mfma_f32_16x16x32_bf16 v[104:107], v[192:195], v[228:231], v[104:107]
    v_mfma_f32_16x16x32_bf16 v[108:111], v[196:199], v[228:231], v[108:111]
    s_waitcnt lgkmcnt(6)
    v_mfma_f32_16x16x32_bf16 v[112:115], v[192:195], v[232:235], v[112:115]
    ds_read_b128 v[216:219], v250 offset:25600
    ds_read_b128 v[220:223], v250 offset:36864
    v_mfma_f32_16x16x32_bf16 v[116:119], v[196:199], v[232:235], v[116:119]
    v_mfma_f32_16x16x32_bf16 v[120:123], v[208:211], v[232:235], v[120:123]
    v_mfma_f32_16x16x32_bf16 v[124:127], v[212:215], v[232:235], v[124:127]
    ds_read_b64_tr_b16 v[184:185], v248 offset:8192
    ds_read_b64_tr_b16 v[186:187], v248 offset:9216
    ds_read_b64_tr_b16 v[188:189], v249 offset:8192
    ds_read_b64_tr_b16 v[190:191], v249 offset:9216
    v_mfma_f32_16x16x32_bf16 v[112:115], v[200:203], v[236:239], v[112:115]
    v_mfma_f32_16x16x32_bf16 v[116:119], v[204:207], v[236:239], v[116:119]
    v_mfma_f32_16x16x32_bf16 v[120:123], v[192:195], v[236:239], v[120:123]
    v_mfma_f32_16x16x32_bf16 v[124:127], v[196:199], v[236:239], v[124:127]
    s_waitcnt lgkmcnt(10)
    v_mfma_f32_16x16x32_bf16 v[128:131], v[192:195], v[240:243], v[128:131]
    ds_read_b128 v[224:227], v250 offset:26624
    ds_read_b128 v[228:231], v250 offset:37888
    v_mfma_f32_16x16x32_bf16 v[132:135], v[196:199], v[240:243], v[132:135]
    v_mfma_f32_16x16x32_bf16 v[136:139], v[208:211], v[240:243], v[136:139]
    v_mfma_f32_16x16x32_bf16 v[140:143], v[212:215], v[240:243], v[140:143]
    v_mfma_f32_16x16x32_bf16 v[128:131], v[200:203], v[244:247], v[128:131]
    v_mfma_f32_16x16x32_bf16 v[132:135], v[204:207], v[244:247], v[132:135]
    v_mfma_f32_16x16x32_bf16 v[136:139], v[192:195], v[244:247], v[136:139]
    v_mfma_f32_16x16x32_bf16 v[140:143], v[196:199], v[244:247], v[140:143]
    s_waitcnt lgkmcnt(6)
    v_mfma_f32_16x16x32_bf16 v[144:147], v[192:195], v[216:219], v[144:147]
    v_add_u32 v250, 0x9800, v250
    ds_read_b128 v[232:235], v250 offset:16384
    ds_read_b128 v[236:239], v250 offset:27648
    v_mfma_f32_16x16x32_bf16 v[148:151], v[196:199], v[216:219], v[148:151]
    v_mfma_f32_16x16x32_bf16 v[152:155], v[208:211], v[216:219], v[152:155]
    v_mfma_f32_16x16x32_bf16 v[156:159], v[212:215], v[216:219], v[156:159]
    v_mfma_f32_16x16x32_bf16 v[144:147], v[200:203], v[220:223], v[144:147]
    s_waitcnt lgkmcnt(4)
    v_xor_b32 v212, 0x80008000, v188
    v_xor_b32 v213, 0x80008000, v189
    v_mfma_f32_16x16x32_bf16 v[148:151], v[204:207], v[220:223], v[148:151]
    v_xor_b32 v214, 0x80008000, v190
    v_xor_b32 v215, 0x80008000, v191
    v_mfma_f32_16x16x32_bf16 v[152:155], v[192:195], v[220:223], v[152:155]
    v_mfma_f32_16x16x32_bf16 v[156:159], v[196:199], v[220:223], v[156:159]
    s_waitcnt lgkmcnt(2)
    v_mfma_f32_16x16x32_bf16 v[160:163], v[192:195], v[224:227], v[160:163]
    ds_read_b128 v[240:243], v250 offset:17408
    ds_read_b128 v[244:247], v250 offset:28672
    v_mfma_f32_16x16x32_bf16 v[164:167], v[208:211], v[224:227], v[164:167]
    v_xor_b32 v208, 0x80008000, v184
    v_xor_b32 v209, 0x80008000, v185
    v_mfma_f32_16x16x32_bf16 v[160:163], v[200:203], v[228:231], v[160:163]
    v_xor_b32 v210, 0x80008000, v186
    v_xor_b32 v211, 0x80008000, v187
    v_mfma_f32_16x16x32_bf16 v[164:167], v[192:195], v[228:231], v[164:167]
    s_barrier
    s_waitcnt lgkmcnt(2)
    v_mfma_f32_16x16x32_bf16 v[0:3], v[176:179], v[232:235], v[0:3]
    ds_read_b128 v[216:219], v250 offset:18432
    ds_read_b128 v[220:223], v250 offset:29696
    v_mfma_f32_16x16x32_bf16 v[4:7], v[180:183], v[232:235], v[4:7]
    v_mfma_f32_16x16x32_bf16 v[8:11], v[208:211], v[232:235], v[8:11]
    v_mfma_f32_16x16x32_bf16 v[12:15], v[212:215], v[232:235], v[12:15]
    v_mfma_f32_16x16x32_bf16 v[0:3], v[184:187], v[236:239], v[0:3]
    v_mfma_f32_16x16x32_bf16 v[4:7], v[188:191], v[236:239], v[4:7]
    v_mfma_f32_16x16x32_bf16 v[8:11], v[176:179], v[236:239], v[8:11]
    v_mfma_f32_16x16x32_bf16 v[12:15], v[180:183], v[236:239], v[12:15]
    s_waitcnt lgkmcnt(2)
    v_mfma_f32_16x16x32_bf16 v[16:19], v[176:179], v[240:243], v[16:19]
    ds_read_b128 v[224:227], v250 offset:19456
    ds_read_b128 v[228:231], v250 offset:30720
    v_mfma_f32_16x16x32_bf16 v[20:23], v[180:183], v[240:243], v[20:23]
    v_mfma_f32_16x16x32_bf16 v[24:27], v[208:211], v[240:243], v[24:27]
    v_mfma_f32_16x16x32_bf16 v[28:31], v[212:215], v[240:243], v[28:31]
    v_mfma_f32_16x16x32_bf16 v[16:19], v[184:187], v[244:247], v[16:19]
    v_mfma_f32_16x16x32_bf16 v[20:23], v[188:191], v[244:247], v[20:23]
    v_mfma_f32_16x16x32_bf16 v[24:27], v[176:179], v[244:247], v[24:27]
    v_mfma_f32_16x16x32_bf16 v[28:31], v[180:183], v[244:247], v[28:31]
    s_waitcnt lgkmcnt(2)
    v_mfma_f32_16x16x32_bf16 v[32:35], v[176:179], v[216:219], v[32:35]
    ds_read_b128 v[232:235], v250 offset:20480
    ds_read_b128 v[236:239], v250 offset:31744
    v_mfma_f32_16x16x32_bf16 v[36:39], v[180:183], v[216:219], v[36:39]
    v_mfma_f32_16x16x32_bf16 v[40:43], v[208:211], v[216:219], v[40:43]
    v_mfma_f32_16x16x32_bf16 v[44:47], v[212:215], v[216:219], v[44:47]
    v_mfma_f32_16x16x32_bf16 v[32:35], v[184:187], v[220:223], v[32:35]
    v_mfma_f32_16x16x32_bf16 v[36:39], v[188:191], v[220:223], v[36:39]
    v_mfma_f32_16x16x32_bf16 v[40:43], v[176:179], v[220:223], v[40:43]
    v_mfma_f32_16x16x32_bf16 v[44:47], v[180:183], v[220:223], v[44:47]
    s_waitcnt lgkmcnt(2)
    v_mfma_f32_16x16x32_bf16 v[48:51], v[176:179], v[224:227], v[48:51]
    ds_read_b128 v[240:243], v250 offset:21504
    ds_read_b128 v[244:247], v250 offset:32768
    v_mfma_f32_16x16x32_bf16 v[52:55], v[180:183], v[224:227], v[52:55]
    v_mfma_f32_16x16x32_bf16 v[56:59], v[208:211], v[224:227], v[56:59]
    v_mfma_f32_16x16x32_bf16 v[60:63], v[212:215], v[224:227], v[60:63]
    v_mfma_f32_16x16x32_bf16 v[48:51], v[184:187], v[228:231], v[48:51]
    v_mfma_f32_16x16x32_bf16 v[52:55], v[188:191], v[228:231], v[52:55]
    v_mfma_f32_16x16x32_bf16 v[56:59], v[176:179], v[228:231], v[56:59]
    v_mfma_f32_16x16x32_bf16 v[60:63], v[180:183], v[228:231], v[60:63]
    s_waitcnt lgkmcnt(2)
    v_mfma_f32_16x16x32_bf16 v[64:67], v[176:179], v[232:235], v[64:67]
    ds_read_b128 v[216:219], v250 offset:22528
    ds_read_b128 v[220:223], v250 offset:33792
    v_mfma_f32_16x16x32_bf16 v[68:71], v[180:183], v[232:235], v[68:71]
    v_mfma_f32_16x16x32_bf16 v[72:75], v[208:211], v[232:235], v[72:75]
    v_mfma_f32_16x16x32_bf16 v[76:79], v[212:215], v[232:235], v[76:79]
    v_mfma_f32_16x16x32_bf16 v[64:67], v[184:187], v[236:239], v[64:67]
    v_mfma_f32_16x16x32_bf16 v[68:71], v[188:191], v[236:239], v[68:71]
    v_mfma_f32_16x16x32_bf16 v[72:75], v[176:179], v[236:239], v[72:75]
    v_mfma_f32_16x16x32_bf16 v[76:79], v[180:183], v[236:239], v[76:79]
    s_waitcnt lgkmcnt(2)
    v_mfma_f32_16x16x32_bf16 v[80:83], v[176:179], v[240:243], v[80:83]
    ds_read_b128 v[224:227], v250 offset:23552
    ds_read_b128 v[228:231], v250 offset:34816
    v_mfma_f32_16x16x32_bf16 v[84:87], v[180:183], v[240:243], v[84:87]
    v_mfma_f32_16x16x32_bf16 v[88:91], v[208:211], v[240:243], v[88:91]
    v_mfma_f32_16x16x32_bf16 v[92:95], v[212:215], v[240:243], v[92:95]
    v_mfma_f32_16x16x32_bf16 v[80:83], v[184:187], v[244:247], v[80:83]
    v_add_u32 v248, 0x9800, v248
    v_add_u32 v249, 0x9800, v249
    v_mfma_f32_16x16x32_bf16 v[84:87], v[188:191], v[244:247], v[84:87]
    v_mfma_f32_16x16x32_bf16 v[88:91], v[176:179], v[244:247], v[88:91]
    v_mfma_f32_16x16x32_bf16 v[92:95], v[180:183], v[244:247], v[92:95]
    s_waitcnt lgkmcnt(2)
    v_mfma_f32_16x16x32_bf16 v[96:99], v[176:179], v[216:219], v[96:99]
    ds_read_b128 v[232:235], v250 offset:24576
    ds_read_b128 v[236:239], v250 offset:35840
    v_mfma_f32_16x16x32_bf16 v[100:103], v[180:183], v[216:219], v[100:103]
    v_mfma_f32_16x16x32_bf16 v[104:107], v[208:211], v[216:219], v[104:107]
    v_mfma_f32_16x16x32_bf16 v[108:111], v[212:215], v[216:219], v[108:111]
    ds_read_b64_tr_b16 v[192:193], v248 offset:0
    ds_read_b64_tr_b16 v[194:195], v248 offset:1024
    ds_read_b64_tr_b16 v[196:197], v249 offset:0
    ds_read_b64_tr_b16 v[198:199], v249 offset:1024
    v_mfma_f32_16x16x32_bf16 v[96:99], v[184:187], v[220:223], v[96:99]
    v_mfma_f32_16x16x32_bf16 v[100:103], v[188:191], v[220:223], v[100:103]
    v_mfma_f32_16x16x32_bf16 v[104:107], v[176:179], v[220:223], v[104:107]
    v_mfma_f32_16x16x32_bf16 v[108:111], v[180:183], v[220:223], v[108:111]
    s_waitcnt lgkmcnt(6)
    v_mfma_f32_16x16x32_bf16 v[112:115], v[176:179], v[224:227], v[112:115]
    ds_read_b128 v[240:243], v250 offset:25600
    ds_read_b128 v[244:247], v250 offset:36864
    v_mfma_f32_16x16x32_bf16 v[116:119], v[180:183], v[224:227], v[116:119]
    v_mfma_f32_16x16x32_bf16 v[120:123], v[208:211], v[224:227], v[120:123]
    v_mfma_f32_16x16x32_bf16 v[124:127], v[212:215], v[224:227], v[124:127]
    ds_read_b64_tr_b16 v[200:201], v248 offset:8192
    ds_read_b64_tr_b16 v[202:203], v248 offset:9216
    ds_read_b64_tr_b16 v[204:205], v249 offset:8192
    ds_read_b64_tr_b16 v[206:207], v249 offset:9216
    v_mfma_f32_16x16x32_bf16 v[112:115], v[184:187], v[228:231], v[112:115]
    v_mfma_f32_16x16x32_bf16 v[116:119], v[188:191], v[228:231], v[116:119]
    v_mfma_f32_16x16x32_bf16 v[120:123], v[176:179], v[228:231], v[120:123]
    v_mfma_f32_16x16x32_bf16 v[124:127], v[180:183], v[228:231], v[124:127]
    s_waitcnt lgkmcnt(10)
    v_mfma_f32_16x16x32_bf16 v[128:131], v[176:179], v[232:235], v[128:131]
    ds_read_b128 v[216:219], v250 offset:26624
    ds_read_b128 v[220:223], v250 offset:37888
    v_mfma_f32_16x16x32_bf16 v[132:135], v[180:183], v[232:235], v[132:135]
    v_mfma_f32_16x16x32_bf16 v[136:139], v[208:211], v[232:235], v[136:139]
    v_mfma_f32_16x16x32_bf16 v[140:143], v[212:215], v[232:235], v[140:143]
    v_mfma_f32_16x16x32_bf16 v[128:131], v[184:187], v[236:239], v[128:131]
    v_mfma_f32_16x16x32_bf16 v[132:135], v[188:191], v[236:239], v[132:135]
    v_mfma_f32_16x16x32_bf16 v[136:139], v[176:179], v[236:239], v[136:139]
    v_mfma_f32_16x16x32_bf16 v[140:143], v[180:183], v[236:239], v[140:143]
    s_waitcnt lgkmcnt(6)
    v_mfma_f32_16x16x32_bf16 v[144:147], v[176:179], v[240:243], v[144:147]
    v_add_u32 v250, 0x9800, v250
    ds_read_b128 v[224:227], v250 offset:16384
    ds_read_b128 v[228:231], v250 offset:27648
    v_mfma_f32_16x16x32_bf16 v[148:151], v[180:183], v[240:243], v[148:151]
    v_mfma_f32_16x16x32_bf16 v[152:155], v[208:211], v[240:243], v[152:155]
    v_mfma_f32_16x16x32_bf16 v[156:159], v[212:215], v[240:243], v[156:159]
    v_mfma_f32_16x16x32_bf16 v[144:147], v[184:187], v[244:247], v[144:147]
    s_waitcnt lgkmcnt(4)
    v_xor_b32 v212, 0x80008000, v204
    v_xor_b32 v213, 0x80008000, v205
    v_mfma_f32_16x16x32_bf16 v[148:151], v[188:191], v[244:247], v[148:151]
    v_xor_b32 v214, 0x80008000, v206
    v_xor_b32 v215, 0x80008000, v207
    v_mfma_f32_16x16x32_bf16 v[152:155], v[176:179], v[244:247], v[152:155]
    v_mfma_f32_16x16x32_bf16 v[156:159], v[180:183], v[244:247], v[156:159]
    s_waitcnt lgkmcnt(2)
    v_mfma_f32_16x16x32_bf16 v[160:163], v[176:179], v[216:219], v[160:163]
    ds_read_b128 v[232:235], v250 offset:17408
    ds_read_b128 v[236:239], v250 offset:28672
    v_mfma_f32_16x16x32_bf16 v[164:167], v[208:211], v[216:219], v[164:167]
    v_xor_b32 v208, 0x80008000, v200
    v_xor_b32 v209, 0x80008000, v201
    v_mfma_f32_16x16x32_bf16 v[160:163], v[184:187], v[220:223], v[160:163]
    v_xor_b32 v210, 0x80008000, v202
    v_xor_b32 v211, 0x80008000, v203
    v_mfma_f32_16x16x32_bf16 v[164:167], v[176:179], v[220:223], v[164:167]
    s_barrier
    s_waitcnt lgkmcnt(2)
    v_mfma_f32_16x16x32_bf16 v[0:3], v[192:195], v[224:227], v[0:3]
    ds_read_b128 v[240:243], v250 offset:18432
    ds_read_b128 v[244:247], v250 offset:29696
    v_mfma_f32_16x16x32_bf16 v[4:7], v[196:199], v[224:227], v[4:7]
    v_mfma_f32_16x16x32_bf16 v[8:11], v[208:211], v[224:227], v[8:11]
    v_mfma_f32_16x16x32_bf16 v[12:15], v[212:215], v[224:227], v[12:15]
    v_mfma_f32_16x16x32_bf16 v[0:3], v[200:203], v[228:231], v[0:3]
    v_mfma_f32_16x16x32_bf16 v[4:7], v[204:207], v[228:231], v[4:7]
    v_mfma_f32_16x16x32_bf16 v[8:11], v[192:195], v[228:231], v[8:11]
    v_mfma_f32_16x16x32_bf16 v[12:15], v[196:199], v[228:231], v[12:15]
    s_waitcnt lgkmcnt(2)
    v_mfma_f32_16x16x32_bf16 v[16:19], v[192:195], v[232:235], v[16:19]
    ds_read_b128 v[216:219], v250 offset:19456
    ds_read_b128 v[220:223], v250 offset:30720
    v_mfma_f32_16x16x32_bf16 v[20:23], v[196:199], v[232:235], v[20:23]
    v_mfma_f32_16x16x32_bf16 v[24:27], v[208:211], v[232:235], v[24:27]
    v_mfma_f32_16x16x32_bf16 v[28:31], v[212:215], v[232:235], v[28:31]
    v_mfma_f32_16x16x32_bf16 v[16:19], v[200:203], v[236:239], v[16:19]
    v_mfma_f32_16x16x32_bf16 v[20:23], v[204:207], v[236:239], v[20:23]
    v_mfma_f32_16x16x32_bf16 v[24:27], v[192:195], v[236:239], v[24:27]
    v_mfma_f32_16x16x32_bf16 v[28:31], v[196:199], v[236:239], v[28:31]
    s_waitcnt lgkmcnt(2)
    v_mfma_f32_16x16x32_bf16 v[32:35], v[192:195], v[240:243], v[32:35]
    ds_read_b128 v[224:227], v250 offset:20480
    ds_read_b128 v[228:231], v250 offset:31744
    v_mfma_f32_16x16x32_bf16 v[36:39], v[196:199], v[240:243], v[36:39]
    v_mfma_f32_16x16x32_bf16 v[40:43], v[208:211], v[240:243], v[40:43]
    v_mfma_f32_16x16x32_bf16 v[44:47], v[212:215], v[240:243], v[44:47]
    v_mfma_f32_16x16x32_bf16 v[32:35], v[200:203], v[244:247], v[32:35]
    v_mfma_f32_16x16x32_bf16 v[36:39], v[204:207], v[244:247], v[36:39]
    v_mfma_f32_16x16x32_bf16 v[40:43], v[192:195], v[244:247], v[40:43]
    v_mfma_f32_16x16x32_bf16 v[44:47], v[196:199], v[244:247], v[44:47]
    s_waitcnt lgkmcnt(2)
    v_mfma_f32_16x16x32_bf16 v[48:51], v[192:195], v[216:219], v[48:51]
    ds_read_b128 v[232:235], v250 offset:21504
    ds_read_b128 v[236:239], v250 offset:32768
    v_mfma_f32_16x16x32_bf16 v[52:55], v[196:199], v[216:219], v[52:55]
    v_mfma_f32_16x16x32_bf16 v[56:59], v[208:211], v[216:219], v[56:59]
    v_mfma_f32_16x16x32_bf16 v[60:63], v[212:215], v[216:219], v[60:63]
    v_mfma_f32_16x16x32_bf16 v[48:51], v[200:203], v[220:223], v[48:51]
    v_mfma_f32_16x16x32_bf16 v[52:55], v[204:207], v[220:223], v[52:55]
    v_mfma_f32_16x16x32_bf16 v[56:59], v[192:195], v[220:223], v[56:59]
    v_mfma_f32_16x16x32_bf16 v[60:63], v[196:199], v[220:223], v[60:63]
    s_waitcnt lgkmcnt(2)
    v_mfma_f32_16x16x32_bf16 v[64:67], v[192:195], v[224:227], v[64:67]
    ds_read_b128 v[240:243], v250 offset:22528
    ds_read_b128 v[244:247], v250 offset:33792
    v_mfma_f32_16x16x32_bf16 v[68:71], v[196:199], v[224:227], v[68:71]
    v_mfma_f32_16x16x32_bf16 v[72:75], v[208:211], v[224:227], v[72:75]
    v_mfma_f32_16x16x32_bf16 v[76:79], v[212:215], v[224:227], v[76:79]
    v_mfma_f32_16x16x32_bf16 v[64:67], v[200:203], v[228:231], v[64:67]
    v_mfma_f32_16x16x32_bf16 v[68:71], v[204:207], v[228:231], v[68:71]
    v_mfma_f32_16x16x32_bf16 v[72:75], v[192:195], v[228:231], v[72:75]
    v_mfma_f32_16x16x32_bf16 v[76:79], v[196:199], v[228:231], v[76:79]
    s_waitcnt lgkmcnt(2)
    v_mfma_f32_16x16x32_bf16 v[80:83], v[192:195], v[232:235], v[80:83]
    ds_read_b128 v[216:219], v250 offset:23552
    ds_read_b128 v[220:223], v250 offset:34816
    v_mfma_f32_16x16x32_bf16 v[84:87], v[196:199], v[232:235], v[84:87]
    v_mfma_f32_16x16x32_bf16 v[88:91], v[208:211], v[232:235], v[88:91]
    v_mfma_f32_16x16x32_bf16 v[92:95], v[212:215], v[232:235], v[92:95]
    v_mfma_f32_16x16x32_bf16 v[80:83], v[200:203], v[236:239], v[80:83]
    v_add_u32 v248, 0xfffe3800, v248
    v_add_u32 v249, 0xfffe3800, v249
    v_mfma_f32_16x16x32_bf16 v[84:87], v[204:207], v[236:239], v[84:87]
    v_mfma_f32_16x16x32_bf16 v[88:91], v[192:195], v[236:239], v[88:91]
    v_mfma_f32_16x16x32_bf16 v[92:95], v[196:199], v[236:239], v[92:95]
    s_waitcnt lgkmcnt(2)
    v_mfma_f32_16x16x32_bf16 v[96:99], v[192:195], v[240:243], v[96:99]
    ds_read_b128 v[224:227], v250 offset:24576
    ds_read_b128 v[228:231], v250 offset:35840
    v_mfma_f32_16x16x32_bf16 v[100:103], v[196:199], v[240:243], v[100:103]
    v_mfma_f32_16x16x32_bf16 v[104:107], v[208:211], v[240:243], v[104:107]
    v_mfma_f32_16x16x32_bf16 v[108:111], v[212:215], v[240:243], v[108:111]
    ds_read_b64_tr_b16 v[176:177], v248 offset:0
    ds_read_b64_tr_b16 v[178:179], v248 offset:1024
    ds_read_b64_tr_b16 v[180:181], v249 offset:0
    ds_read_b64_tr_b16 v[182:183], v249 offset:1024
    v_mfma_f32_16x16x32_bf16 v[96:99], v[200:203], v[244:247], v[96:99]
    v_mfma_f32_16x16x32_bf16 v[100:103], v[204:207], v[244:247], v[100:103]
    v_mfma_f32_16x16x32_bf16 v[104:107], v[192:195], v[244:247], v[104:107]
    v_mfma_f32_16x16x32_bf16 v[108:111], v[196:199], v[244:247], v[108:111]
    s_waitcnt lgkmcnt(6)
    v_mfma_f32_16x16x32_bf16 v[112:115], v[192:195], v[216:219], v[112:115]
    ds_read_b128 v[232:235], v250 offset:25600
    ds_read_b128 v[236:239], v250 offset:36864
    v_mfma_f32_16x16x32_bf16 v[116:119], v[196:199], v[216:219], v[116:119]
    v_mfma_f32_16x16x32_bf16 v[120:123], v[208:211], v[216:219], v[120:123]
    v_mfma_f32_16x16x32_bf16 v[124:127], v[212:215], v[216:219], v[124:127]
    ds_read_b64_tr_b16 v[184:185], v248 offset:8192
    ds_read_b64_tr_b16 v[186:187], v248 offset:9216
    ds_read_b64_tr_b16 v[188:189], v249 offset:8192
    ds_read_b64_tr_b16 v[190:191], v249 offset:9216
    v_mfma_f32_16x16x32_bf16 v[112:115], v[200:203], v[220:223], v[112:115]
    v_mfma_f32_16x16x32_bf16 v[116:119], v[204:207], v[220:223], v[116:119]
    v_mfma_f32_16x16x32_bf16 v[120:123], v[192:195], v[220:223], v[120:123]
    v_mfma_f32_16x16x32_bf16 v[124:127], v[196:199], v[220:223], v[124:127]
    s_waitcnt lgkmcnt(10)
    v_mfma_f32_16x16x32_bf16 v[128:131], v[192:195], v[224:227], v[128:131]
    ds_read_b128 v[240:243], v250 offset:26624
    ds_read_b128 v[244:247], v250 offset:37888
    v_mfma_f32_16x16x32_bf16 v[132:135], v[196:199], v[224:227], v[132:135]
    v_mfma_f32_16x16x32_bf16 v[136:139], v[208:211], v[224:227], v[136:139]
    v_mfma_f32_16x16x32_bf16 v[140:143], v[212:215], v[224:227], v[140:143]
    v_mfma_f32_16x16x32_bf16 v[128:131], v[200:203], v[228:231], v[128:131]
    v_mfma_f32_16x16x32_bf16 v[132:135], v[204:207], v[228:231], v[132:135]
    v_mfma_f32_16x16x32_bf16 v[136:139], v[192:195], v[228:231], v[136:139]
    v_mfma_f32_16x16x32_bf16 v[140:143], v[196:199], v[228:231], v[140:143]
    s_waitcnt lgkmcnt(6)
    v_mfma_f32_16x16x32_bf16 v[144:147], v[192:195], v[232:235], v[144:147]
    v_add_u32 v250, 0xfffe3800, v250
    ds_read_b128 v[216:219], v250 offset:16384
    ds_read_b128 v[220:223], v250 offset:27648
    v_mfma_f32_16x16x32_bf16 v[148:151], v[196:199], v[232:235], v[148:151]
    v_mfma_f32_16x16x32_bf16 v[152:155], v[208:211], v[232:235], v[152:155]
    v_mfma_f32_16x16x32_bf16 v[156:159], v[212:215], v[232:235], v[156:159]
    v_mfma_f32_16x16x32_bf16 v[144:147], v[200:203], v[236:239], v[144:147]
    s_waitcnt lgkmcnt(4)
    v_xor_b32 v212, 0x80008000, v188
    v_xor_b32 v213, 0x80008000, v189
    v_mfma_f32_16x16x32_bf16 v[148:151], v[204:207], v[236:239], v[148:151]
    v_xor_b32 v214, 0x80008000, v190
    v_xor_b32 v215, 0x80008000, v191
    v_mfma_f32_16x16x32_bf16 v[152:155], v[192:195], v[236:239], v[152:155]
    v_mfma_f32_16x16x32_bf16 v[156:159], v[196:199], v[236:239], v[156:159]
    s_waitcnt lgkmcnt(2)
    v_mfma_f32_16x16x32_bf16 v[160:163], v[192:195], v[240:243], v[160:163]
    ds_read_b128 v[224:227], v250 offset:17408
    ds_read_b128 v[228:231], v250 offset:28672
    v_mfma_f32_16x16x32_bf16 v[164:167], v[208:211], v[240:243], v[164:167]
    v_xor_b32 v208, 0x80008000, v184
    v_xor_b32 v209, 0x80008000, v185
    v_mfma_f32_16x16x32_bf16 v[160:163], v[200:203], v[244:247], v[160:163]
    v_xor_b32 v210, 0x80008000, v186
    v_xor_b32 v211, 0x80008000, v187
    v_mfma_f32_16x16x32_bf16 v[164:167], v[192:195], v[244:247], v[164:167]
    s_sub_u32 s46, s46, 1
    s_cmp_lg_u32 s46, 0
    s_cbranch_scc1 L_g_loop
    s_barrier
    s_waitcnt lgkmcnt(2)
    v_mfma_f32_16x16x32_bf16 v[0:3], v[176:179], v[216:219], v[0:3]
    ds_read_b128 v[232:235], v250 offset:18432
    ds_read_b128 v[236:239], v250 offset:29696
    v_mfma_f32_16x16x32_bf16 v[4:7], v[180:183], v[216:219], v[4:7]
    v_mfma_f32_16x16x32_bf16 v[8:11], v[208:211], v[216:219], v[8:11]
    v_mfma_f32_16x16x32_bf16 v[12:15], v[212:215], v[216:219], v[12:15]
    v_mfma_f32_16x16x32_bf16 v[0:3], v[184:187], v[220:223], v[0:3]
    v_mfma_f32_16x16x32_bf16 v[4:7], v[188:191], v[220:223], v[4:7]
    v_mfma_f32_16x16x32_bf16 v[8:11], v[176:179], v[220:223], v[8:11]
    v_mfma_f32_16x16x32_bf16 v[12:15], v[180:183], v[220:223], v[12:15]
    s_waitcnt lgkmcnt(2)
    v_mfma_f32_16x16x32_bf16 v[16:19], v[176:179], v[224:227], v[16:19]
    ds_read_b128 v[240:243], v250 offset:19456
    ds_read_b128 v[244:247], v250 offset:30720
    v_mfma_f32_16x16x32_bf16 v[20:23], v[180:183], v[224:227], v[20:23]
    v_mfma_f32_16x16x32_bf16 v[24:27], v[208:211], v[224:227], v[24:27]
    v_mfma_f32_16x16x32_bf16 v[28:31], v[212:215], v[224:227], v[28:31]
    v_mfma_f32_16x16x32_bf16 v[16:19], v[184:187], v[228:231], v[16:19]
    v_mfma_f32_16x16x32_bf16 v[20:23], v[188:191], v[228:231], v[20:23]
    v_mfma_f32_16x16x32_bf16 v[24:27], v[176:179], v[228:231], v[24:27]
    v_mfma_f32_16x16x32_bf16 v[28:31], v[180:183], v[228:231], v[28:31]
    s_waitcnt lgkmcnt(2)
    v_mfma_f32_16x16x32_bf16 v[32:35], v[176:179], v[232:235], v[32:35]
    ds_read_b128 v[216:219], v250 offset:20480
    ds_read_b128 v[220:223], v250 offset:31744
    v_mfma_f32_16x16x32_bf16 v[36:39], v[180:183], v[232:235], v[36:39]
    v_mfma_f32_16x16x32_bf16 v[40:43], v[208:211], v[232:235], v[40:43]
    v_mfma_f32_16x16x32_bf16 v[44:47], v[212:215], v[232:235], v[44:47]
    v_mfma_f32_16x16x32_bf16 v[32:35], v[184:187], v[236:239], v[32:35]
    v_mfma_f32_16x16x32_bf16 v[36:39], v[188:191], v[236:239], v[36:39]
    v_mfma_f32_16x16x32_bf16 v[40:43], v[176:179], v[236:239], v[40:43]
    v_mfma_f32_16x16x32_bf16 v[44:47], v[180:183], v[236:239], v[44:47]
    s_waitcnt lgkmcnt(2)
    v_mfma_f32_16x16x32_bf16 v[48:51], v[176:179], v[240:243], v[48:51]
    ds_read_b128 v[224:227], v250 offset:21504
    ds_read_b128 v[228:231], v250 offset:32768
    v_mfma_f32_16x16x32_bf16 v[52:55], v[180:183], v[240:243], v[52:55]
    v_mfma_f32_16x16x32_bf16 v[56:59], v[208:211], v[240:243], v[56:59]
    v_mfma_f32_16x16x32_bf16 v[60:63], v[212:215], v[240:243], v[60:63]
    v_mfma_f32_16x16x32_bf16 v[48:51], v[184:187], v[244:247], v[48:51]
    v_mfma_f32_16x16x32_bf16 v[52:55], v[188:191], v[244:247], v[52:55]
    v_mfma_f32_16x16x32_bf16 v[56:59], v[176:179], v[244:247], v[56:59]
    v_mfma_f32_16x16x32_bf16 v[60:63], v[180:183], v[244:247], v[60:63]
    s_waitcnt lgkmcnt(2)
    v_mfma_f32_16x16x32_bf16 v[64:67], v[176:179], v[216:219], v[64:67]
    ds_read_b128 v[232:235], v250 offset:22528
    ds_read_b128 v[236:239], v250 offset:33792
    v_mfma_f32_16x16x32_bf16 v[68:71], v[180:183], v[216:219], v[68:71]
    v_mfma_f32_16x16x32_bf16 v[72:75], v[208:211], v[216:219], v[72:75]
    v_mfma_f32_16x16x32_bf16 v[76:79], v[212:215], v[216:219], v[76:79]
    v_mfma_f32_16x16x32_bf16 v[64:67], v[184:187], v[220:223], v[64:67]
    v_mfma_f32_16x16x32_bf16 v[68:71], v[188:191], v[220:223], v[68:71]
    v_mfma_f32_16x16x32_bf16 v[72:75], v[176:179], v[220:223], v[72:75]
    v_mfma_f32_16x16x32_bf16 v[76:79], v[180:183], v[220:223], v[76:79]
    s_waitcnt lgkmcnt(2)
    v_mfma_f32_16x16x32_bf16 v[80:83], v[176:179], v[224:227], v[80:83]
    ds_read_b128 v[240:243], v250 offset:23552
    ds_read_b128 v[244:247], v250 offset:34816
    v_mfma_f32_16x16x32_bf16 v[84:87], v[180:183], v[224:227], v[84:87]
    v_mfma_f32_16x16x32_bf16 v[88:91], v[208:211], v[224:227], v[88:91]
    v_mfma_f32_16x16x32_bf16 v[92:95], v[212:215], v[224:227], v[92:95]
    v_mfma_f32_16x16x32_bf16 v[80:83], v[184:187], v[228:231], v[80:83]
    v_add_u32 v248, 0x9800, v248
    v_add_u32 v249, 0x9800, v249
    v_mfma_f32_16x16x32_bf16 v[84:87], v[188:191], v[228:231], v[84:87]
    v_mfma_f32_16x16x32_bf16 v[88:91], v[176:179], v[228:231], v[88:91]
    v_mfma_f32_16x16x32_bf16 v[92:95], v[180:183], v[228:231], v[92:95]
    s_waitcnt lgkmcnt(2)
    v_mfma_f32_16x16x32_bf16 v[96:99], v[176:179], v[232:235], v[96:99]
    ds_read_b128 v[216:219], v250 offset:24576
    ds_read_b128 v[220:223], v250 offset:35840
    v_mfma_f32_16x16x32_bf16 v[100:103], v[180:183], v[232:235], v[100:103]
    v_mfma_f32_16x16x32_bf16 v[104:107], v[208:211], v[232:235], v[104:107]
    v_mfma_f32_16x16x32_bf16 v[108:111], v[212:215], v[232:235], v[108:111]
    ds_read_b64_tr_b16 v[192:193], v248 offset:0
    ds_read_b64_tr_b16 v[194:195], v248 offset:1024
    ds_read_b64_tr_b16 v[196:197], v249 offset:0
    ds_read_b64_tr_b16 v[198:199], v249 offset:1024
    v_mfma_f32_16x16x32_bf16 v[96:99], v[184:187], v[236:239], v[96:99]
    v_mfma_f32_16x16x32_bf16 v[100:103], v[188:191], v[236:239], v[100:103]
    v_mfma_f32_16x16x32_bf16 v[104:107], v[176:179], v[236:239], v[104:107]
    v_mfma_f32_16x16x32_bf16 v[108:111], v[180:183], v[236:239], v[108:111]
    s_waitcnt lgkmcnt(6)
    v_mfma_f32_16x16x32_bf16 v[112:115], v[176:179], v[240:243], v[112:115]
    ds_read_b128 v[224:227], v250 offset:25600
    ds_read_b128 v[228:231], v250 offset:36864
    v_mfma_f32_16x16x32_bf16 v[116:119], v[180:183], v[240:243], v[116:119]
    v_mfma_f32_16x16x32_bf16 v[120:123], v[208:211], v[240:243], v[120:123]
    v_mfma_f32_16x16x32_bf16 v[124:127], v[212:215], v[240:243], v[124:127]
    ds_read_b64_tr_b16 v[200:201], v248 offset:8192
    ds_read_b64_tr_b16 v[202:203], v248 offset:9216
    ds_read_b64_tr_b16 v[204:205], v249 offset:8192
    ds_read_b64_tr_b16 v[206:207], v249 offset:9216
    v_mfma_f32_16x16x32_bf16 v[112:115], v[184:187], v[244:247], v[112:115]
    v_mfma_f32_16x16x32_bf16 v[116:119], v[188:191], v[244:247], v[116:119]
    v_mfma_f32_16x16x32_bf16 v[120:123], v[176:179], v[244:247], v[120:123]
    v_mfma_f32_16x16x32_bf16 v[124:127], v[180:183], v[244:247], v[124:127]
    s_waitcnt lgkmcnt(10)
    v_mfma_f32_16x16x32_bf16 v[128:131], v[176:179], v[216:219], v[128:131]
    ds_read_b128 v[232:235], v250 offset:26624
    ds_read_b128 v[236:239], v250 offset:37888
    v_mfma_f32_16x16x32_bf16 v[132:135], v[180:183], v[216:219], v[132:135]
    v_mfma_f32_16x16x32_bf16 v[136:139], v[208:211], v[216:219], v[136:139]
    v_mfma_f32_16x16x32_bf16 v[140:143], v[212:215], v[216:219], v[140:143]
    v_mfma_f32_16x16x32_bf16 v[128:131], v[184:187], v[220:223], v[128:131]
    v_mfma_f32_16x16x32_bf16 v[132:135], v[188:191], v[220:223], v[132:135]
    v_mfma_f32_16x16x32_bf16 v[136:139], v[176:179], v[220:223], v[136:139]
    v_mfma_f32_16x16x32_bf16 v[140:143], v[180:183], v[220:223], v[140:143]
    s_waitcnt lgkmcnt(6)
    v_mfma_f32_16x16x32_bf16 v[144:147], v[176:179], v[224:227], v[144:147]
    v_add_u32 v250, 0x9800, v250
    ds_read_b128 v[240:243], v250 offset:16384
    ds_read_b128 v[244:247], v250 offset:27648
    v_mfma_f32_16x16x32_bf16 v[148:151], v[180:183], v[224:227], v[148:151]
    v_mfma_f32_16x16x32_bf16 v[152:155], v[208:211], v[224:227], v[152:155]
    v_mfma_f32_16x16x32_bf16 v[156:159], v[212:215], v[224:227], v[156:159]
    v_mfma_f32_16x16x32_bf16 v[144:147], v[184:187], v[228:231], v[144:147]
    s_waitcnt lgkmcnt(4)
    v_xor_b32 v212, 0x80008000, v204
    v_xor_b32 v213, 0x80008000, v205
    v_mfma_f32_16x16x32_bf16 v[148:151], v[188:191], v[228:231], v[148:151]
    v_xor_b32 v214, 0x80008000, v206
    v_xor_b32 v215, 0x80008000, v207
    v_mfma_f32_16x16x32_bf16 v[152:155], v[176:179], v[228:231], v[152:155]
    v_mfma_f32_16x16x32_bf16 v[156:159], v[180:183], v[228:231], v[156:159]
    s_waitcnt lgkmcnt(2)
    v_mfma_f32_16x16x32_bf16 v[160:163], v[176:179], v[232:235], v[160:163]
    ds_read_b128 v[216:219], v250 offset:17408
    ds_read_b128 v[220:223], v250 offset:28672
    v_mfma_f32_16x16x32_bf16 v[164:167], v[208:211], v[232:235], v[164:167]
    v_xor_b32 v208, 0x80008000, v200
    v_xor_b32 v209, 0x80008000, v201
    v_mfma_f32_16x16x32_bf16 v[160:163], v[184:187], v[236:239], v[160:163]
    v_xor_b32 v210, 0x80008000, v202
    v_xor_b32 v211, 0x80008000, v203
    v_mfma_f32_16x16x32_bf16 v[164:167], v[176:179], v[236:239], v[164:167]
    s_barrier
    s_waitcnt lgkmcnt(2)
    v_mfma_f32_16x16x32_bf16 v[0:3], v[192:195], v[240:243], v[0:3]
    ds_read_b128 v[224:227], v250 offset:18432
    ds_read_b128 v[228:231], v250 offset:29696
    v_mfma_f32_16x16x32_bf16 v[4:7], v[196:199], v[240:243], v[4:7]
    v_mfma_f32_16x16x32_bf16 v[8:11], v[208:211], v[240:243], v[8:11]
    v_mfma_f32_16x16x32_bf16 v[12:15], v[212:215], v[240:243], v[12:15]
    v_mfma_f32_16x16x32_bf16 v[0:3], v[200:203], v[244:247], v[0:3]
    v_mfma_f32_16x16x32_bf16 v[4:7], v[204:207], v[244:247], v[4:7]
    v_mfma_f32_16x16x32_bf16 v[8:11], v[192:195], v[244:247], v[8:11]
    v_mfma_f32_16x16x32_bf16 v[12:15], v[196:199], v[244:247], v[12:15]
    s_waitcnt lgkmcnt(2)
    v_mfma_f32_16x16x32_bf16 v[16:19], v[192:195], v[216:219], v[16:19]
    ds_read_b128 v[232:235], v250 offset:19456
    ds_read_b128 v[236:239], v250 offset:30720
    v_mfma_f32_16x16x32_bf16 v[20:23], v[196:199], v[216:219], v[20:23]
    v_mfma_f32_16x16x32_bf16 v[24:27], v[208:211], v[216:219], v[24:27]
    v_mfma_f32_16x16x32_bf16 v[28:31], v[212:215], v[216:219], v[28:31]
    v_mfma_f32_16x16x32_bf16 v[16:19], v[200:203], v[220:223], v[16:19]
    v_mfma_f32_16x16x32_bf16 v[20:23], v[204:207], v[220:223], v[20:23]
    v_mfma_f32_16x16x32_bf16 v[24:27], v[192:195], v[220:223], v[24:27]
    v_mfma_f32_16x16x32_bf16 v[28:31], v[196:199], v[220:223], v[28:31]
    s_waitcnt lgkmcnt(2)
    v_mfma_f32_16x16x32_bf16 v[32:35], v[192:195], v[224:227], v[32:35]
    ds_read_b128 v[240:243], v250 offset:20480
    ds_read_b128 v[244:247], v250 offset:31744
    v_mfma_f32_16x16x32_bf16 v[36:39], v[196:199], v[224:227], v[36:39]
    v_mfma_f32_16x16x32_bf16 v[40:43], v[208:211], v[224:227], v[40:43]
    v_mfma_f32_16x16x32_bf16 v[44:47], v[212:215], v[224:227], v[44:47]
    v_mfma_f32_16x16x32_bf16 v[32:35], v[200:203], v[228:231], v[32:35]
    v_mfma_f32_16x16x32_bf16 v[36:39], v[204:207], v[228:231], v[36:39]
    v_mfma_f32_16x16x32_bf16 v[40:43], v[192:195], v[228:231], v[40:43]
    v_mfma_f32_16x16x32_bf16 v[44:47], v[196:199], v[228:231], v[44:47]
    s_waitcnt lgkmcnt(2)
    v_mfma_f32_16x16x32_bf16 v[48:51], v[192:195], v[232:235], v[48:51]
    ds_read_b128 v[216:219], v250 offset:21504
    ds_read_b128 v[220:223], v250 offset:32768
    v_mfma_f32_16x16x32_bf16 v[52:55], v[196:199], v[232:235], v[52:55]
    v_mfma_f32_16x16x32_bf16 v[56:59], v[208:211], v[232:235], v[56:59]
    v_mfma_f32_16x16x32_bf16 v[60:63], v[212:215], v[232:235], v[60:63]
    v_mfma_f32_16x16x32_bf16 v[48:51], v[200:203], v[236:239], v[48:51]
    v_mfma_f32_16x16x32_bf16 v[52:55], v[204:207], v[236:239], v[52:55]
    v_mfma_f32_16x16x32_bf16 v[56:59], v[192:195], v[236:239], v[56:59]
    v_mfma_f32_16x16x32_bf16 v[60:63], v[196:199], v[236:239], v[60:63]
    s_waitcnt lgkmcnt(2)
    v_mfma_f32_16x16x32_bf16 v[64:67], v[192:195], v[240:243], v[64:67]
    ds_read_b128 v[224:227], v250 offset:22528
    ds_read_b128 v[228:231], v250 offset:33792
    v_mfma_f32_16x16x32_bf16 v[68:71], v[196:199], v[240:243], v[68:71]
    v_mfma_f32_16x16x32_bf16 v[72:75], v[208:211], v[240:243], v[72:75]
    v_mfma_f32_16x16x32_bf16 v[76:79], v[212:215], v[240:243], v[76:79]
    v_mfma_f32_16x16x32_bf16 v[64:67], v[200:203], v[244:247], v[64:67]
    v_mfma_f32_16x16x32_bf16 v[68:71], v[204:207], v[244:247], v[68:71]
    v_mfma_f32_16x16x32_bf16 v[72:75], v[192:195], v[244:247], v[72:75]
    v_mfma_f32_16x16x32_bf16 v[76:79], v[196:199], v[244:247], v[76:79]
    s_waitcnt lgkmcnt(2)
    v_mfma_f32_16x16x32_bf16 v[80:83], v[192:195], v[216:219], v[80:83]
    ds_read_b128 v[232:235], v250 offset:23552
    ds_read_b128 v[236:239], v250 offset:34816
    v_mfma_f32_16x16x32_bf16 v[84:87], v[196:199], v[216:219], v[84:87]
    v_mfma_f32_16x16x32_bf16 v[88:91], v[208:211], v[216:219], v[88:91]
    v_mfma_f32_16x16x32_bf16 v[92:95], v[212:215], v[216:219], v[92:95]
    v_mfma_f32_16x16x32_bf16 v[80:83], v[200:203], v[220:223], v[80:83]
    v_add_u32 v248, 0x9800, v248
    v_add_u32 v249, 0x9800, v249
    v_mfma_f32_16x16x32_bf16 v[84:87], v[204:207], v[220:223], v[84:87]
    v_mfma_f32_16x16x32_bf16 v[88:91], v[192:195], v[220:223], v[88:91]
    v_mfma_f32_16x16x32_bf16 v[92:95], v[196:199], v[220:223], v[92:95]
    s_waitcnt lgkmcnt(2)
    v_mfma_f32_16x16x32_bf16 v[96:99], v[192:195], v[224:227], v[96:99]
    ds_read_b128 v[240:243], v250 offset:24576
    ds_read_b128 v[244:247], v250 offset:35840
    v_mfma_f32_16x16x32_bf16 v[100:103], v[196:199], v[224:227], v[100:103]
    v_mfma_f32_16x16x32_bf16 v[104:107], v[208:211], v[224:227], v[104:107]
    v_mfma_f32_16x16x32_bf16 v[108:111], v[212:215], v[224:227], v[108:111]
    ds_read_b64_tr_b16 v[176:177], v248 offset:0
    ds_read_b64_tr_b16 v[178:179], v248 offset:1024
    ds_read_b64_tr_b16 v[180:181], v249 offset:0
    ds_read_b64_tr_b16 v[182:183], v249 offset:1024
    v_mfma_f32_16x16x32_bf16 v[96:99], v[200:203], v[228:231], v[96:99]
    v_mfma_f32_16x16x32_bf16 v[100:103], v[204:207], v[228:231], v[100:103]
    v_mfma_f32_16x16x32_bf16 v[104:107], v[192:195], v[228:231], v[104:107]
    v_mfma_f32_16x16x32_bf16 v[108:111], v[196:199], v[228:231], v[108:111]
    s_waitcnt lgkmcnt(6)
    v_mfma_f32_16x16x32_bf16 v[112:115], v[192:195], v[232:235], v[112:115]
    ds_read_b128 v[216:219], v250 offset:25600
    ds_read_b128 v[220:223], v250 offset:36864
    v_mfma_f32_16x16x32_bf16 v[116:119], v[196:199], v[232:235], v[116:119]
    v_mfma_f32_16x16x32_bf16 v[120:123], v[208:211], v[232:235], v[120:123]
    v_mfma_f32_16x16x32_bf16 v[124:127], v[212:215], v[232:235], v[124:127]
    ds_read_b64_tr_b16 v[184:185], v248 offset:8192
    ds_read_b64_tr_b16 v[186:187], v248 offset:9216
    ds_read_b64_tr_b16 v[188:189], v249 offset:8192
    ds_read_b64_tr_b16 v[190:191], v249 offset:9216
    v_mfma_f32_16x16x32_bf16 v[112:115], v[200:203], v[236:239], v[112:115]
    v_mfma_f32_16x16x32_bf16 v[116:119], v[204:207], v[236:239], v[116:119]
    v_mfma_f32_16x16x32_bf16 v[120:123], v[192:195], v[236:239], v[120:123]
    v_mfma_f32_16x16x32_bf16 v[124:127], v[196:199], v[236:239], v[124:127]
    s_waitcnt lgkmcnt(10)
    v_mfma_f32_16x16x32_bf16 v[128:131], v[192:195], v[240:243], v[128:131]
    ds_read_b128 v[224:227], v250 offset:26624
    ds_read_b128 v[228:231], v250 offset:37888
    v_mfma_f32_16x16x32_bf16 v[132:135], v[196:199], v[240:243], v[132:135]
    v_mfma_f32_16x16x32_bf16 v[136:139], v[208:211], v[240:243], v[136:139]
    v_mfma_f32_16x16x32_bf16 v[140:143], v[212:215], v[240:243], v[140:143]
    v_mfma_f32_16x16x32_bf16 v[128:131], v[200:203], v[244:247], v[128:131]
    v_mfma_f32_16x16x32_bf16 v[132:135], v[204:207], v[244:247], v[132:135]
    v_mfma_f32_16x16x32_bf16 v[136:139], v[192:195], v[244:247], v[136:139]
    v_mfma_f32_16x16x32_bf16 v[140:143], v[196:199], v[244:247], v[140:143]
    s_waitcnt lgkmcnt(6)
    v_mfma_f32_16x16x32_bf16 v[144:147], v[192:195], v[216:219], v[144:147]
    v_add_u32 v250, 0x9800, v250
    ds_read_b128 v[232:235], v250 offset:16384
    ds_read_b128 v[236:239], v250 offset:27648
    v_mfma_f32_16x16x32_bf16 v[148:151], v[196:199], v[216:219], v[148:151]
    v_mfma_f32_16x16x32_bf16 v[152:155], v[208:211], v[216:219], v[152:155]
    v_mfma_f32_16x16x32_bf16 v[156:159], v[212:215], v[216:219], v[156:159]
    v_mfma_f32_16x16x32_bf16 v[144:147], v[200:203], v[220:223], v[144:147]
    s_waitcnt lgkmcnt(4)
    v_xor_b32 v212, 0x80008000, v188
    v_xor_b32 v213, 0x80008000, v189
    v_mfma_f32_16x16x32_bf16 v[148:151], v[204:207], v[220:223], v[148:151]
    v_xor_b32 v214, 0x80008000, v190
    v_xor_b32 v215, 0x80008000, v191
    v_mfma_f32_16x16x32_bf16 v[152:155], v[192:195], v[220:223], v[152:155]
    v_mfma_f32_16x16x32_bf16 v[156:159], v[196:199], v[220:223], v[156:159]
    s_waitcnt lgkmcnt(2)
    v_mfma_f32_16x16x32_bf16 v[160:163], v[192:195], v[224:227], v[160:163]
    ds_read_b128 v[240:243], v250 offset:17408
    ds_read_b128 v[244:247], v250 offset:28672
    v_mfma_f32_16x16x32_bf16 v[164:167], v[208:211], v[224:227], v[164:167]
    v_xor_b32 v208, 0x80008000, v184
    v_xor_b32 v209, 0x80008000, v185
    v_mfma_f32_16x16x32_bf16 v[160:163], v[200:203], v[228:231], v[160:163]
    v_xor_b32 v210, 0x80008000, v186
    v_xor_b32 v211, 0x80008000, v187
    v_mfma_f32_16x16x32_bf16 v[164:167], v[192:195], v[228:231], v[164:167]
    s_barrier
    s_cmp_lg_u32 s13, 0
    s_cbranch_scc1 L_epi_b1
    v_add_u32 v248, 0x9800, v248
    v_add_u32 v249, 0x9800, v249
    v_add_u32 v253, 38912, v250
    ds_read_b64_tr_b16 v[192:193], v248 offset:0
    ds_read_b64_tr_b16 v[194:195], v248 offset:1024
    ds_read_b64_tr_b16 v[196:197], v249 offset:0
    ds_read_b64_tr_b16 v[198:199], v249 offset:1024
    ds_read_b64_tr_b16 v[200:201], v248 offset:8192
    ds_read_b64_tr_b16 v[202:203], v248 offset:9216
    ds_read_b64_tr_b16 v[204:205], v249 offset:8192
    ds_read_b64_tr_b16 v[206:207], v249 offset:9216
    s_waitcnt lgkmcnt(10)
    v_mfma_f32_16x16x32_bf16 v[0:3], v[176:179], v[232:235], v[0:3]
    ds_read_b128 v[216:219], v250 offset:18432
    ds_read_b128 v[220:223], v250 offset:29696
    v_mfma_f32_16x16x32_bf16 v[4:7], v[180:183], v[232:235], v[4:7]
    v_mfma_f32_16x16x32_bf16 v[8:11], v[208:211], v[232:235], v[8:11]
    v_mfma_f32_16x16x32_bf16 v[12:15], v[212:215], v[232:235], v[12:15]
    v_mfma_f32_16x16x32_bf16 v[0:3], v[184:187], v[236:239], v[0:3]
    v_mfma_f32_16x16x32_bf16 v[4:7], v[188:191], v[236:239], v[4:7]
    v_mfma_f32_16x16x32_bf16 v[8:11], v[176:179], v[236:239], v[8:11]
    v_mfma_f32_16x16x32_bf16 v[12:15], v[180:183], v[236:239], v[12:15]
    s_waitcnt lgkmcnt(10)
    v_mfma_f32_16x16x32_bf16 v[16:19], v[176:179], v[240:243], v[16:19]
    ds_read_b128 v[224:227], v253 offset:16384
    ds_read_b128 v[228:231], v253 offset:27648
    v_mfma_f32_16x16x32_bf16 v[20:23], v[180:183], v[240:243], v[20:23]
    v_mfma_f32_16x16x32_bf16 v[24:27], v[208:211], v[240:243], v[24:27]
    v_mfma_f32_16x16x32_bf16 v[28:31], v[212:215], v[240:243], v[28:31]
    v_mfma_f32_16x16x32_bf16 v[16:19], v[184:187], v[244:247], v[16:19]
    v_mfma_f32_16x16x32_bf16 v[20:23], v[188:191], v[244:247], v[20:23]
    v_mfma_f32_16x16x32_bf16 v[24:27], v[176:179], v[244:247], v[24:27]
    v_mfma_f32_16x16x32_bf16 v[28:31], v[180:183], v[244:247], v[28:31]
    s_waitcnt lgkmcnt(2)
    v_mfma_f32_16x16x32_bf16 v[32:35], v[176:179], v[216:219], v[32:35]
    ds_read_b128 v[232:235], v250 offset:19456
    ds_read_b128 v[236:239], v250 offset:30720
    v_mfma_f32_16x16x32_bf16 v[36:39], v[180:183], v[216:219], v[36:39]
    v_mfma_f32_16x16x32_bf16 v[40:43], v[208:211], v[216:219], v[40:43]
    v_mfma_f32_16x16x32_bf16 v[44:47], v[212:215], v[216:219], v[44:47]
    v_mfma_f32_16x16x32_bf16 v[32:35], v[184:187], v[220:223], v[32:35]
    v_mfma_f32_16x16x32_bf16 v[36:39], v[188:191], v[220:223], v[36:39]
    v_mfma_f32_16x16x32_bf16 v[40:43], v[176:179], v[220:223], v[40:43]
    v_mfma_f32_16x16x32_bf16 v[44:47], v[180:183], v[220:223], v[44:47]
    v_xor_b32 v168, 0x80008000, v200
    v_xor_b32 v169, 0x80008000, v201
    v_xor_b32 v170, 0x80008000, v202
    v_xor_b32 v171, 0x80008000, v203
    v_xor_b32 v172, 0x80008000, v204
    v_xor_b32 v173, 0x80008000, v205
    v_xor_b32 v174, 0x80008000, v206
    v_xor_b32 v175, 0x80008000, v207
    s_waitcnt lgkmcnt(2)
    v_mfma_f32_16x16x32_bf16 v[0:3], v[192:195], v[224:227], v[0:3]
    ds_read_b128 v[240:243], v253 offset:17408
    ds_read_b128 v[244:247], v253 offset:28672
    v_mfma_f32_16x16x32_bf16 v[4:7], v[196:199], v[224:227], v[4:7]
    v_mfma_f32_16x16x32_bf16 v[8:11], v[168:171], v[224:227], v[8:11]
    v_mfma_f32_16x16x32_bf16 v[12:15], v[172:175], v[224:227], v[12:15]
    v_mfma_f32_16x16x32_bf16 v[0:3], v[200:203], v[228:231], v[0:3]
    v_mfma_f32_16x16x32_bf16 v[4:7], v[204:207], v[228:231], v[4:7]
    v_mfma_f32_16x16x32_bf16 v[8:11], v[192:195], v[228:231], v[8:11]
    v_mfma_f32_16x16x32_bf16 v[12:15], v[196:199], v[228:231], v[12:15]
    s_waitcnt lgkmcnt(2)
    v_mfma_f32_16x16x32_bf16 v[48:51], v[176:179], v[232:235], v[48:51]
    ds_read_b128 v[216:219], v250 offset:20480
    ds_read_b128 v[220:223], v250 offset:31744
    v_mfma_f32_16x16x32_bf16 v[52:55], v[180:183], v[232:235], v[52:55]
    v_mfma_f32_16x16x32_bf16 v[56:59], v[208:211], v[232:235], v[56:59]
    v_mfma_f32_16x16x32_bf16 v[60:63], v[212:215], v[232:235], v[60:63]
    v_mfma_f32_16x16x32_bf16 v[48:51], v[184:187], v[236:239], v[48:51]
    v_mfma_f32_16x16x32_bf16 v[52:55], v[188:191], v[236:239], v[52:55]
    v_mfma_f32_16x16x32_bf16 v[56:59], v[176:179], v[236:239], v[56:59]
    v_mfma_f32_16x16x32_bf16 v[60:63], v[180:183], v[236:239], v[60:63]
    s_waitcnt lgkmcnt(2)
    v_mfma_f32_16x16x32_bf16 v[16:19], v[192:195], v[240:243], v[16:19]
    ds_read_b128 v[224:227], v253 offset:18432
    ds_read_b128 v[228:231], v253 offset:29696
    v_mfma_f32_16x16x32_bf16 v[20:23], v[196:199], v[240:243], v[20:23]
    v_cvt_pk_bf16_f32 v0, v0, v1
    v_cvt_pk_bf16_f32 v1, v2, v3
    v_mfma_f32_16x16x32_bf16 v[24:27], v[168:171], v[240:243], v[24:27]
    v_cvt_pk_bf16_f32 v2, v4, v5
    v_cvt_pk_bf16_f32 v3, v6, v7
    v_mfma_f32_16x16x32_bf16 v[28:31], v[172:175], v[240:243], v[28:31]
    s_add_u32 s47, s48, 0
    buffer_store_dwordx4 v[0:3], v251, s[16:19], s47 offen sc1
    v_mfma_f32_16x16x32_bf16 v[16:19], v[200:203], v[244:247], v[16:19]
    v_cvt_pk_bf16_f32 v8, v8, v9
    v_cvt_pk_bf16_f32 v9, v10, v11
    v_mfma_f32_16x16x32_bf16 v[20:23], v[204:207], v[244:247], v[20:23]
    v_cvt_pk_bf16_f32 v10, v12, v13
    v_cvt_pk_bf16_f32 v11, v14, v15
    v_mfma_f32_16x16x32_bf16 v[24:27], v[192:195], v[244:247], v[24:27]
    s_add_u32 s47, s48, 11264
    buffer_store_dwordx4 v[8:11], v251, s[16:19], s47 offen sc1
    v_mfma_f32_16x16x32_bf16 v[28:31], v[196:199], v[244:247], v[28:31]
    s_waitcnt lgkmcnt(2)
    v_mfma_f32_16x16x32_bf16 v[64:67], v[176:179], v[216:219], v[64:67]
    ds_read_b128 v[232:235], v250 offset:21504
    ds_read_b128 v[236:239], v250 offset:32768
    v_mfma_f32_16x16x32_bf16 v[68:71], v[180:183], v[216:219], v[68:71]
    v_mfma_f32_16x16x32_bf16 v[72:75], v[208:211], v[216:219], v[72:75]
    v_mfma_f32_16x16x32_bf16 v[76:79], v[212:215], v[216:219], v[76:79]
    v_mfma_f32_16x16x32_bf16 v[64:67], v[184:187], v[220:223], v[64:67]
    v_mfma_f32_16x16x32_bf16 v[68:71], v[188:191], v[220:223], v[68:71]
    v_mfma_f32_16x16x32_bf16 v[72:75], v[176:179], v[220:223], v[72:75]
    v_mfma_f32_16x16x32_bf16 v[76:79], v[180:183], v[220:223], v[76:79]
    s_waitcnt lgkmcnt(2)
    v_mfma_f32_16x16x32_bf16 v[32:35], v[192:195], v[224:227], v[32:35]
    ds_read_b128 v[240:243], v253 offset:19456
    ds_read_b128 v[244:247], v253 offset:30720
    v_mfma_f32_16x16x32_bf16 v[36:39], v[196:199], v[224:227], v[36:39]
    v_cvt_pk_bf16_f32 v16, v16, v17
    v_cvt_pk_bf16_f32 v17, v18, v19
    v_mfma_f32_16x16x32_bf16 v[40:43], v[168:171], v[224:227], v[40:43]
    v_cvt_pk_bf16_f32 v18, v20, v21
    v_cvt_pk_bf16_f32 v19, v22, v23
    v_mfma_f32_16x16x32_bf16 v[44:47], v[172:175], v[224:227], v[44:47]
    s_add_u32 s47, s48, 1024
    buffer_store_dwordx4 v[16:19], v251, s[16:19], s47 offen sc1
    v_mfma_f32_16x16x32_bf16 v[32:35], v[200:203], v[228:231], v[32:35]
    v_cvt_pk_bf16_f32 v24, v24, v25
    v_cvt_pk_bf16_f32 v25, v26, v27
    v_mfma_f32_16x16x32_bf16 v[36:39], v[204:207], v[228:231], v[36:39]
    v_cvt_pk_bf16_f32 v26, v28, v29
    v_cvt_pk_bf16_f32 v27, v30, v31
    v_mfma_f32_16x16x32_bf16 v[40:43], v[192:195], v[228:231], v[40:43]
    s_add_u32 s47, s48, 12288
    buffer_store_dwordx4 v[24:27], v251, s[16:19], s47 offen sc1
    v_mfma_f32_16x16x32_bf16 v[44:47], v[196:199], v[228:231], v[44:47]
    s_waitcnt lgkmcnt(2)
    v_mfma_f32_16x16x32_bf16 v[80:83], v[176:179], v[232:235], v[80:83]
    ds_read_b128 v[216:219], v250 offset:22528
    ds_read_b128 v[220:223], v250 offset:33792
    v_mfma_f32_16x16x32_bf16 v[84:87], v[180:183], v[232:235], v[84:87]
    v_mfma_f32_16x16x32_bf16 v[88:91], v[208:211], v[232:235], v[88:91]
    v_mfma_f32_16x16x32_bf16 v[92:95], v[212:215], v[232:235], v[92:95]
    v_mfma_f32_16x16x32_bf16 v[80:83], v[184:187], v[236:239], v[80:83]
    v_mfma_f32_16x16x32_bf16 v[84:87], v[188:191], v[236:239], v[84:87]
    v_mfma_f32_16x16x32_bf16 v[88:91], v[176:179], v[236:239], v[88:91]
    v_mfma_f32_16x16x32_bf16 v[92:95], v[180:183], v[236:239], v[92:95]
    s_waitcnt lgkmcnt(2)
    v_mfma_f32_16x16x32_bf16 v[48:51], v[192:195], v[240:243], v[48:51]
    ds_read_b128 v[224:227], v253 offset:20480
    ds_read_b128 v[228:231], v253 offset:31744
    v_mfma_f32_16x16x32_bf16 v[52:55], v[196:199], v[240:243], v[52:55]
    v_cvt_pk_bf16_f32 v32, v32, v33
    v_cvt_pk_bf16_f32 v33, v34, v35
    v_mfma_f32_16x16x32_bf16 v[56:59], v[168:171], v[240:243], v[56:59]
    v_cvt_pk_bf16_f32 v34, v36, v37
    v_cvt_pk_bf16_f32 v35, v38, v39
    v_mfma_f32_16x16x32_bf16 v[60:63], v[172:175], v[240:243], v[60:63]
    s_add_u32 s47, s48, 2048
    buffer_store_dwordx4 v[32:35], v251, s[16:19], s47 offen sc1
    v_mfma_f32_16x16x32_bf16 v[48:51], v[200:203], v[244:247], v[48:51]
    v_cvt_pk_bf16_f32 v40, v40, v41
    v_cvt_pk_bf16_f32 v41, v42, v43
    v_mfma_f32_16x16x32_bf16 v[52:55], v[204:207], v[244:247], v[52:55]
    v_cvt_pk_bf16_f32 v42, v44, v45
    v_cvt_pk_bf16_f32 v43, v46, v47
    v_mfma_f32_16x16x32_bf16 v[56:59], v[192:195], v[244:247], v[56:59]
    s_add_u32 s47, s48, 13312
    buffer_store_dwordx4 v[40:43], v251, s[16:19], s47 offen sc1
    v_mfma_f32_16x16x32_bf16 v[60:63], v[196:199], v[244:247], v[60:63]
    s_waitcnt lgkmcnt(2)
    v_mfma_f32_16x16x32_bf16 v[96:99], v[176:179], v[216:219], v[96:99]
    ds_read_b128 v[232:235], v250 offset:23552
    ds_read_b128 v[236:239], v250 offset:34816
    v_mfma_f32_16x16x32_bf16 v[100:103], v[180:183], v[216:219], v[100:103]
    v_mfma_f32_16x16x32_bf16 v[104:107], v[208:211], v[216:219], v[104:107]
    v_mfma_f32_16x16x32_bf16 v[108:111], v[212:215], v[216:219], v[108:111]
    v_mfma_f32_16x16x32_bf16 v[96:99], v[184:187], v[220:223], v[96:99]
    v_mfma_f32_16x16x32_bf16 v[100:103], v[188:191], v[220:223], v[100:103]
    v_mfma_f32_16x16x32_bf16 v[104:107], v[176:179], v[220:223], v[104:107]
    v_mfma_f32_16x16x32_bf16 v[108:111], v[180:183], v[220:223], v[108:111]
    s_waitcnt lgkmcnt(2)
    v_mfma_f32_16x16x32_bf16 v[64:67], v[192:195], v[224:227], v[64:67]
    ds_read_b128 v[240:243], v253 offset:21504
    ds_read_b128 v[244:247], v253 offset:32768
    v_mfma_f32_16x16x32_bf16 v[68:71], v[196:199], v[224:227], v[68:71]
    v_cvt_pk_bf16_f32 v48, v48, v49
    v_cvt_pk_bf16_f32 v49, v50, v51
    v_mfma_f32_16x16x32_bf16 v[72:75], v[168:171], v[224:227], v[72:75]
    v_cvt_pk_bf16_f32 v50, v52, v53
    v_cvt_pk_bf16_f32 v51, v54, v55
    v_mfma_f32_16x16x32_bf16 v[76:79], v[172:175], v[224:227], v[76:79]
    s_add_u32 s47, s48, 3072
    buffer_store_dwordx4 v[48:51], v251, s[16:19], s47 offen sc1
    v_mfma_f32_16x16x32_bf16 v[64:67], v[200:203], v[228:231], v[64:67]
    v_cvt_pk_bf16_f32 v56, v56, v57
    v_cvt_pk_bf16_f32 v57, v58, v59
    v_mfma_f32_16x16x32_bf16 v[68:71], v[204:207], v[228:231], v[68:71]
    v_cvt_pk_bf16_f32 v58, v60, v61
    v_cvt_pk_bf16_f32 v59, v62, v63
    v_mfma_f32_16x16x32_bf16 v[72:75], v[192:195], v[228:231], v[72:75]
    s_add_u32 s47, s48, 14336
    buffer_store_dwordx4 v[56:59], v251, s[16:19], s47 offen sc1
    v_mfma_f32_16x16x32_bf16 v[76:79], v[196:199], v[228:231], v[76:79]
    s_waitcnt lgkmcnt(2)
    v_mfma_f32_16x16x32_bf16 v[112:115], v[176:179], v[232:235], v[112:115]
    ds_read_b128 v[216:219], v250 offset:24576
    ds_read_b128 v[220:223], v250 offset:35840
    v_mfma_f32_16x16x32_bf16 v[116:119], v[180:183], v[232:235], v[116:119]
    v_mfma_f32_16x16x32_bf16 v[120:123], v[208:211], v[232:235], v[120:123]
    v_mfma_f32_16x16x32_bf16 v[124:127], v[212:215], v[232:235], v[124:127]
    v_mfma_f32_16x16x32_bf16 v[112:115], v[184:187], v[236:239], v[112:115]
    v_mfma_f32_16x16x32_bf16 v[116:119], v[188:191], v[236:239], v[116:119]
    v_mfma_f32_16x16x32_bf16 v[120:123], v[176:179], v[236:239], v[120:123]
    v_mfma_f32_16x16x32_bf16 v[124:127], v[180:183], v[236:239], v[124:127]
    s_waitcnt lgkmcnt(2)
    v_mfma_f32_16x16x32_bf16 v[80:83], v[192:195], v[240:243], v[80:83]
    ds_read_b128 v[224:227], v253 offset:22528
    ds_read_b128 v[228:231], v253 offset:33792
    v_mfma_f32_16x16x32_bf16 v[84:87], v[196:199], v[240:243], v[84:87]
    v_cvt_pk_bf16_f32 v64, v64, v65
    v_cvt_pk_bf16_f32 v65, v66, v67
    v_mfma_f32_16x16x32_bf16 v[88:91], v[168:171], v[240:243], v[88:91]
    v_cvt_pk_bf16_f32 v66, v68, v69
    v_cvt_pk_bf16_f32 v67, v70, v71
    v_mfma_f32_16x16x32_bf16 v[92:95], v[172:175], v[240:243], v[92:95]
    s_add_u32 s47, s48, 4096
    buffer_store_dwordx4 v[64:67], v251, s[16:19], s47 offen sc1
    v_mfma_f32_16x16x32_bf16 v[80:83], v[200:203], v[244:247], v[80:83]
    v_cvt_pk_bf16_f32 v72, v72, v73
    v_cvt_pk_bf16_f32 v73, v74, v75
    v_mfma_f32_16x16x32_bf16 v[84:87], v[204:207], v[244:247], v[84:87]
    v_cvt_pk_bf16_f32 v74, v76, v77
    v_cvt_pk_bf16_f32 v75, v78, v79
    v_mfma_f32_16x16x32_bf16 v[88:91], v[192:195], v[244:247], v[88:91]
    s_add_u32 s47, s48, 15360
    buffer_store_dwordx4 v[72:75], v251, s[16:19], s47 offen sc1
    v_mfma_f32_16x16x32_bf16 v[92:95], v[196:199], v[244:247], v[92:95]
    s_waitcnt lgkmcnt(2)
    v_mfma_f32_16x16x32_bf16 v[128:131], v[176:179], v[216:219], v[128:131]
    ds_read_b128 v[232:235], v250 offset:25600
    ds_read_b128 v[236:239], v250 offset:36864
    v_mfma_f32_16x16x32_bf16 v[132:135], v[180:183], v[216:219], v[132:135]
    v_mfma_f32_16x16x32_bf16 v[136:139], v[208:211], v[216:219], v[136:139]
    v_mfma_f32_16x16x32_bf16 v[140:143], v[212:215], v[216:219], v[140:143]
    v_mfma_f32_16x16x32_bf16 v[128:131], v[184:187], v[220:223], v[128:131]
    v_mfma_f32_16x16x32_bf16 v[132:135], v[188:191], v[220:223], v[132:135]
    v_mfma_f32_16x16x32_bf16 v[136:139], v[176:179], v[220:223], v[136:139]
    v_mfma_f32_16x16x32_bf16 v[140:143], v[180:183], v[220:223], v[140:143]
    s_waitcnt lgkmcnt(2)
    v_mfma_f32_16x16x32_bf16 v[96:99], v[192:195], v[224:227], v[96:99]
    ds_read_b128 v[240:243], v253 offset:23552
    ds_read_b128 v[244:247], v253 offset:34816
    v_mfma_f32_16x16x32_bf16 v[100:103], v[196:199], v[224:227], v[100:103]
    v_cvt_pk_bf16_f32 v80, v80, v81
    v_cvt_pk_bf16_f32 v81, v82, v83
    v_mfma_f32_16x16x32_bf16 v[104:107], v[168:171], v[224:227], v[104:107]
    v_cvt_pk_bf16_f32 v82, v84, v85
    v_cvt_pk_bf16_f32 v83, v86, v87
    v_mfma_f32_16x16x32_bf16 v[108:111], v[172:175], v[224:227], v[108:111]
    s_add_u32 s47, s48, 5120
    buffer_store_dwordx4 v[80:83], v251, s[16:19], s47 offen sc1
    v_mfma_f32_16x16x32_bf16 v[96:99], v[200:203], v[228:231], v[96:99]
    v_cvt_pk_bf16_f32 v88, v88, v89
    v_cvt_pk_bf16_f32 v89, v90, v91
    v_mfma_f32_16x16x32_bf16 v[100:103], v[204:207], v[228:231], v[100:103]
    v_cvt_pk_bf16_f32 v90, v92, v93
    v_cvt_pk_bf16_f32 v91, v94, v95
    v_mfma_f32_16x16x32_bf16 v[104:107], v[192:195], v[228:231], v[104:107]
    s_add_u32 s47, s48, 16384
    buffer_store_dwordx4 v[88:91], v251, s[16:19], s47 offen sc1
    v_mfma_f32_16x16x32_bf16 v[108:111], v[196:199], v[228:231], v[108:111]
    s_waitcnt lgkmcnt(2)
    v_mfma_f32_16x16x32_bf16 v[144:147], v[176:179], v[232:235], v[144:147]
    ds_read_b128 v[216:219], v250 offset:26624
    ds_read_b128 v[220:223], v250 offset:37888
    v_mfma_f32_16x16x32_bf16 v[148:151], v[180:183], v[232:235], v[148:151]
    v_mfma_f32_16x16x32_bf16 v[152:155], v[208:211], v[232:235], v[152:155]
    v_mfma_f32_16x16x32_bf16 v[156:159], v[212:215], v[232:235], v[156:159]
    v_mfma_f32_16x16x32_bf16 v[144:147], v[184:187], v[236:239], v[144:147]
    v_mfma_f32_16x16x32_bf16 v[148:151], v[188:191], v[236:239], v[148:151]
    v_mfma_f32_16x16x32_bf16 v[152:155], v[176:179], v[236:239], v[152:155]
    v_mfma_f32_16x16x32_bf16 v[156:159], v[180:183], v[236:239], v[156:159]
    s_waitcnt lgkmcnt(2)
    v_mfma_f32_16x16x32_bf16 v[112:115], v[192:195], v[240:243], v[112:115]
    ds_read_b128 v[224:227], v253 offset:24576
    ds_read_b128 v[228:231], v253 offset:35840
    v_mfma_f32_16x16x32_bf16 v[116:119], v[196:199], v[240:243], v[116:119]
    v_cvt_pk_bf16_f32 v96, v96, v97
    v_cvt_pk_bf16_f32 v97, v98, v99
    v_mfma_f32_16x16x32_bf16 v[120:123], v[168:171], v[240:243], v[120:123]
    v_cvt_pk_bf16_f32 v98, v100, v101
    v_cvt_pk_bf16_f32 v99, v102, v103
    v_mfma_f32_16x16x32_bf16 v[124:127], v[172:175], v[240:243], v[124:127]
    s_add_u32 s47, s48, 6144
    buffer_store_dwordx4 v[96:99], v251, s[16:19], s47 offen sc1
    v_mfma_f32_16x16x32_bf16 v[112:115], v[200:203], v[244:247], v[112:115]
    v_cvt_pk_bf16_f32 v104, v104, v105
    v_cvt_pk_bf16_f32 v105, v106, v107
    v_mfma_f32_16x16x32_bf16 v[116:119], v[204:207], v[244:247], v[116:119]
    v_cvt_pk_bf16_f32 v106, v108, v109
    v_cvt_pk_bf16_f32 v107, v110, v111
    v_mfma_f32_16x16x32_bf16 v[120:123], v[192:195], v[244:247], v[120:123]
    s_add_u32 s47, s48, 17408
    buffer_store_dwordx4 v[104:107], v251, s[16:19], s47 offen sc1
    v_mfma_f32_16x16x32_bf16 v[124:127], v[196:199], v[244:247], v[124:127]
    s_waitcnt lgkmcnt(2)
    v_mfma_f32_16x16x32_bf16 v[160:163], v[176:179], v[216:219], v[160:163]
    ds_read_b128 v[232:235], v253 offset:25600
    ds_read_b128 v[236:239], v253 offset:36864
    v_mfma_f32_16x16x32_bf16 v[164:167], v[208:211], v[216:219], v[164:167]
    v_mfma_f32_16x16x32_bf16 v[160:163], v[184:187], v[220:223], v[160:163]
    v_mfma_f32_16x16x32_bf16 v[164:167], v[176:179], v[220:223], v[164:167]
    s_waitcnt lgkmcnt(2)
    v_mfma_f32_16x16x32_bf16 v[128:131], v[192:195], v[224:227], v[128:131]
    ds_read_b128 v[240:243], v253 offset:26624
    ds_read_b128 v[244:247], v253 offset:37888
    v_mfma_f32_16x16x32_bf16 v[132:135], v[196:199], v[224:227], v[132:135]
    v_cvt_pk_bf16_f32 v112, v112, v113
    v_cvt_pk_bf16_f32 v113, v114, v115
    v_mfma_f32_16x16x32_bf16 v[136:139], v[168:171], v[224:227], v[136:139]
    v_cvt_pk_bf16_f32 v114, v116, v117
    v_cvt_pk_bf16_f32 v115, v118, v119
    v_mfma_f32_16x16x32_bf16 v[140:143], v[172:175], v[224:227], v[140:143]
    s_add_u32 s47, s48, 7168
    buffer_store_dwordx4 v[112:115], v251, s[16:19], s47 offen sc1
    v_mfma_f32_16x16x32_bf16 v[128:131], v[200:203], v[228:231], v[128:131]
    v_cvt_pk_bf16_f32 v120, v120, v121
    v_cvt_pk_bf16_f32 v121, v122, v123
    v_mfma_f32_16x16x32_bf16 v[132:135], v[204:207], v[228:231], v[132:135]
    v_cvt_pk_bf16_f32 v122, v124, v125
    v_cvt_pk_bf16_f32 v123, v126, v127
    v_mfma_f32_16x16x32_bf16 v[136:139], v[192:195], v[228:231], v[136:139]
    s_add_u32 s47, s48, 18432
    buffer_store_dwordx4 v[120:123], v251, s[16:19], s47 offen sc1
    v_mfma_f32_16x16x32_bf16 v[140:143], v[196:199], v[228:231], v[140:143]
    s_waitcnt lgkmcnt(2)
    v_mfma_f32_16x16x32_bf16 v[144:147], v[192:195], v[232:235], v[144:147]
    v_mfma_f32_16x16x32_bf16 v[148:151], v[196:199], v[232:235], v[148:151]
    v_mfma_f32_16x16x32_bf16 v[152:155], v[168:171], v[232:235], v[152:155]
    v_mfma_f32_16x16x32_bf16 v[156:159], v[172:175], v[232:235], v[156:159]
    v_mfma_f32_16x16x32_bf16 v[144:147], v[200:203], v[236:239], v[144:147]
    v_mfma_f32_16x16x32_bf16 v[148:151], v[204:207], v[236:239], v[148:151]
    v_mfma_f32_16x16x32_bf16 v[152:155], v[192:195], v[236:239], v[152:155]
    v_mfma_f32_16x16x32_bf16 v[156:159], v[196:199], v[236:239], v[156:159]
    s_waitcnt lgkmcnt(0)
    v_mfma_f32_16x16x32_bf16 v[160:163], v[192:195], v[240:243], v[160:163]
    v_mfma_f32_16x16x32_bf16 v[164:167], v[168:171], v[240:243], v[164:167]
    v_cvt_pk_bf16_f32 v128, v128, v129
    v_cvt_pk_bf16_f32 v129, v130, v131
    v_mfma_f32_16x16x32_bf16 v[160:163], v[200:203], v[244:247], v[160:163]
    v_cvt_pk_bf16_f32 v130, v132, v133
    v_cvt_pk_bf16_f32 v131, v134, v135
    v_mfma_f32_16x16x32_bf16 v[164:167], v[192:195], v[244:247], v[164:167]
    s_add_u32 s47, s48, 8192
    buffer_store_dwordx4 v[128:131], v251, s[16:19], s47 offen sc1
    s_nop 7
    v_cvt_pk_bf16_f32 v136, v136, v137
    v_cvt_pk_bf16_f32 v137, v138, v139
    v_cvt_pk_bf16_f32 v138, v140, v141
    v_cvt_pk_bf16_f32 v139, v142, v143
    s_add_u32 s47, s48, 19456
    buffer_store_dwordx4 v[136:139], v251, s[16:19], s47 offen sc1
    v_cvt_pk_bf16_f32 v144, v144, v145
    v_cvt_pk_bf16_f32 v145, v146, v147
    v_cvt_pk_bf16_f32 v146, v148, v149
    v_cvt_pk_bf16_f32 v147, v150, v151
    s_add_u32 s47, s48, 9216
    buffer_store_dwordx4 v[144:147], v251, s[16:19], s47 offen sc1
    v_cvt_pk_bf16_f32 v152, v152, v153
    v_cvt_pk_bf16_f32 v153, v154, v155
    v_cvt_pk_bf16_f32 v154, v156, v157
    v_cvt_pk_bf16_f32 v155, v158, v159
    s_add_u32 s47, s48, 20480
    buffer_store_dwordx4 v[152:155], v251, s[16:19], s47 offen sc1
    v_cvt_pk_bf16_f32 v160, v160, v161
    v_cvt_pk_bf16_f32 v161, v162, v163
    s_add_u32 s47, s49, 0
    buffer_store_dwordx2 v[160:161], v252, s[16:19], s47 offen sc1
    v_cvt_pk_bf16_f32 v164, v164, v165
    v_cvt_pk_bf16_f32 v165, v166, v167
    s_add_u32 s47, s49, 11264
    buffer_store_dwordx2 v[164:165], v252, s[16:19], s47 offen sc1
    s_branch L_epi_done
L_epi_b1:
    v_add_u32 v248, 0x9800, v248
    v_add_u32 v249, 0x9800, v249
    v_add_u32 v253, 38912, v250
    ds_read_b64_tr_b16 v[192:193], v248 offset:0
    ds_read_b64_tr_b16 v[194:195], v248 offset:1024
    ds_read_b64_tr_b16 v[196:197], v249 offset:0
    ds_read_b64_tr_b16 v[198:199], v249 offset:1024
    ds_read_b64_tr_b16 v[200:201], v248 offset:8192
    ds_read_b64_tr_b16 v[202:203], v248 offset:9216
    ds_read_b64_tr_b16 v[204:205], v249 offset:8192
    ds_read_b64_tr_b16 v[206:207], v249 offset:9216
    s_waitcnt lgkmcnt(10)
    v_mfma_f32_16x16x32_bf16 v[0:3], v[176:179], v[232:235], v[0:3]
    ds_read_b128 v[216:219], v250 offset:18432
    ds_read_b128 v[220:223], v250 offset:29696
    v_mfma_f32_16x16x32_bf16 v[4:7], v[180:183], v[232:235], v[4:7]
    v_mfma_f32_16x16x32_bf16 v[8:11], v[208:211], v[232:235], v[8:11]
    v_mfma_f32_16x16x32_bf16 v[12:15], v[212:215], v[232:235], v[12:15]
    v_mfma_f32_16x16x32_bf16 v[0:3], v[184:187], v[236:239], v[0:3]
    v_mfma_f32_16x16x32_bf16 v[4:7], v[188:191], v[236:239], v[4:7]
    v_mfma_f32_16x16x32_bf16 v[8:11], v[176:179], v[236:239], v[8:11]
    v_mfma_f32_16x16x32_bf16 v[12:15], v[180:183], v[236:239], v[12:15]
    s_waitcnt lgkmcnt(10)
    v_mfma_f32_16x16x32_bf16 v[16:19], v[176:179], v[240:243], v[16:19]
    ds_read_b128 v[224:227], v253 offset:16384
    ds_read_b128 v[228:231], v253 offset:27648
    v_mfma_f32_16x16x32_bf16 v[20:23], v[180:183], v[240:243], v[20:23]
    v_mfma_f32_16x16x32_bf16 v[24:27], v[208:211], v[240:243], v[24:27]
    v_mfma_f32_16x16x32_bf16 v[28:31], v[212:215], v[240:243], v[28:31]
    v_mfma_f32_16x16x32_bf16 v[16:19], v[184:187], v[244:247], v[16:19]
    v_mfma_f32_16x16x32_bf16 v[20:23], v[188:191], v[244:247], v[20:23]
    v_mfma_f32_16x16x32_bf16 v[24:27], v[176:179], v[244:247], v[24:27]
    v_mfma_f32_16x16x32_bf16 v[28:31], v[180:183], v[244:247], v[28:31]
    s_waitcnt lgkmcnt(2)
    v_mfma_f32_16x16x32_bf16 v[32:35], v[176:179], v[216:219], v[32:35]
    ds_read_b128 v[232:235], v250 offset:19456
    ds_read_b128 v[236:239], v250 offset:30720
    v_mfma_f32_16x16x32_bf16 v[36:39], v[180:183], v[216:219], v[36:39]
    v_mfma_f32_16x16x32_bf16 v[40:43], v[208:211], v[216:219], v[40:43]
    v_mfma_f32_16x16x32_bf16 v[44:47], v[212:215], v[216:219], v[44:47]
    v_mfma_f32_16x16x32_bf16 v[32:35], v[184:187], v[220:223], v[32:35]
    v_mfma_f32_16x16x32_bf16 v[36:39], v[188:191], v[220:223], v[36:39]
    v_mfma_f32_16x16x32_bf16 v[40:43], v[176:179], v[220:223], v[40:43]
    v_mfma_f32_16x16x32_bf16 v[44:47], v[180:183], v[220:223], v[44:47]
    v_xor_b32 v168, 0x80008000, v200
    v_xor_b32 v169, 0x80008000, v201
    v_xor_b32 v170, 0x80008000, v202
    v_xor_b32 v171, 0x80008000, v203
    v_xor_b32 v172, 0x80008000, v204
    v_xor_b32 v173, 0x80008000, v205
    v_xor_b32 v174, 0x80008000, v206
    v_xor_b32 v175, 0x80008000, v207
    s_waitcnt lgkmcnt(2)
    v_mfma_f32_16x16x32_bf16 v[0:3], v[192:195], v[224:227], v[0:3]
    ds_read_b128 v[240:243], v253 offset:17408
    ds_read_b128 v[244:247], v253 offset:28672
    v_mfma_f32_16x16x32_bf16 v[4:7], v[196:199], v[224:227], v[4:7]
    v_mfma_f32_16x16x32_bf16 v[8:11], v[168:171], v[224:227], v[8:11]
    v_mfma_f32_16x16x32_bf16 v[12:15], v[172:175], v[224:227], v[12:15]
    v_mfma_f32_16x16x32_bf16 v[0:3], v[200:203], v[228:231], v[0:3]
    v_mfma_f32_16x16x32_bf16 v[4:7], v[204:207], v[228:231], v[4:7]
    v_mfma_f32_16x16x32_bf16 v[8:11], v[192:195], v[228:231], v[8:11]
    v_mfma_f32_16x16x32_bf16 v[12:15], v[196:199], v[228:231], v[12:15]
    s_waitcnt lgkmcnt(2)
    v_mfma_f32_16x16x32_bf16 v[48:51], v[176:179], v[232:235], v[48:51]
    ds_read_b128 v[216:219], v250 offset:20480
    ds_read_b128 v[220:223], v250 offset:31744
    v_mfma_f32_16x16x32_bf16 v[52:55], v[180:183], v[232:235], v[52:55]
    v_mfma_f32_16x16x32_bf16 v[56:59], v[208:211], v[232:235], v[56:59]
    v_mfma_f32_16x16x32_bf16 v[60:63], v[212:215], v[232:235], v[60:63]
    v_mfma_f32_16x16x32_bf16 v[48:51], v[184:187], v[236:239], v[48:51]
    v_mfma_f32_16x16x32_bf16 v[52:55], v[188:191], v[236:239], v[52:55]
    v_mfma_f32_16x16x32_bf16 v[56:59], v[176:179], v[236:239], v[56:59]
    v_mfma_f32_16x16x32_bf16 v[60:63], v[180:183], v[236:239], v[60:63]
    s_waitcnt lgkmcnt(2)
    v_mfma_f32_16x16x32_bf16 v[16:19], v[192:195], v[240:243], v[16:19]
    ds_read_b128 v[224:227], v253 offset:18432
    ds_read_b128 v[228:231], v253 offset:29696
    v_mfma_f32_16x16x32_bf16 v[20:23], v[196:199], v[240:243], v[20:23]
    v_cvt_pk_bf16_f32 v4, v4, v5
    v_cvt_pk_bf16_f32 v5, v6, v7
    v_mfma_f32_16x16x32_bf16 v[24:27], v[168:171], v[240:243], v[24:27]
    v_cvt_pk_bf16_f32 v6, v0, v1
    v_cvt_pk_bf16_f32 v7, v2, v3
    v_mfma_f32_16x16x32_bf16 v[28:31], v[172:175], v[240:243], v[28:31]
    s_add_u32 s47, s48, 0
    buffer_store_dwordx4 v[4:7], v251, s[16:19], s47 offen sc1
    v_mfma_f32_16x16x32_bf16 v[16:19], v[200:203], v[244:247], v[16:19]
    v_cvt_pk_bf16_f32 v12, v12, v13
    v_cvt_pk_bf16_f32 v13, v14, v15
    v_mfma_f32_16x16x32_bf16 v[20:23], v[204:207], v[244:247], v[20:23]
    v_cvt_pk_bf16_f32 v14, v8, v9
    v_cvt_pk_bf16_f32 v15, v10, v11
    v_mfma_f32_16x16x32_bf16 v[24:27], v[192:195], v[244:247], v[24:27]
    s_add_u32 s47, s48, 11264
    buffer_store_dwordx4 v[12:15], v251, s[16:19], s47 offen sc1
    v_mfma_f32_16x16x32_bf16 v[28:31], v[196:199], v[244:247], v[28:31]
    s_waitcnt lgkmcnt(2)
    v_mfma_f32_16x16x32_bf16 v[64:67], v[176:179], v[216:219], v[64:67]
    ds_read_b128 v[232:235], v250 offset:21504
    ds_read_b128 v[236:239], v250 offset:32768
    v_mfma_f32_16x16x32_bf16 v[68:71], v[180:183], v[216:219], v[68:71]
    v_mfma_f32_16x16x32_bf16 v[72:75], v[208:211], v[216:219], v[72:75]
    v_mfma_f32_16x16x32_bf16 v[76:79], v[212:215], v[216:219], v[76:79]
    v_mfma_f32_16x16x32_bf16 v[64:67], v[184:187], v[220:223], v[64:67]
    v_mfma_f32_16x16x32_bf16 v[68:71], v[188:191], v[220:223], v[68:71]
    v_mfma_f32_16x16x32_bf16 v[72:75], v[176:179], v[220:223], v[72:75]
    v_mfma_f32_16x16x32_bf16 v[76:79], v[180:183], v[220:223], v[76:79]
    s_waitcnt lgkmcnt(2)
    v_mfma_f32_16x16x32_bf16 v[32:35], v[192:195], v[224:227], v[32:35]
    ds_read_b128 v[240:243], v253 offset:19456
    ds_read_b128 v[244:247], v253 offset:30720
    v_mfma_f32_16x16x32_bf16 v[36:39], v[196:199], v[224:227], v[36:39]
    v_cvt_pk_bf16_f32 v20, v20, v21
    v_cvt_pk_bf16_f32 v21, v22, v23
    v_mfma_f32_16x16x32_bf16 v[40:43], v[168:171], v[224:227], v[40:43]
    v_cvt_pk_bf16_f32 v22, v16, v17
    v_cvt_pk_bf16_f32 v23, v18, v19
    v_mfma_f32_16x16x32_bf16 v[44:47], v[172:175], v[224:227], v[44:47]
    s_add_u32 s47, s48, 1024
    buffer_store_dwordx4 v[20:23], v251, s[16:19], s47 offen sc1
    v_mfma_f32_16x16x32_bf16 v[32:35], v[200:203], v[228:231], v[32:35]
    v_cvt_pk_bf16_f32 v28, v28, v29
    v_cvt_pk_bf16_f32 v29, v30, v31
    v_mfma_f32_16x16x32_bf16 v[36:39], v[204:207], v[228:231], v[36:39]
    v_cvt_pk_bf16_f32 v30, v24, v25
    v_cvt_pk_bf16_f32 v31, v26, v27
    v_mfma_f32_16x16x32_bf16 v[40:43], v[192:195], v[228:231], v[40:43]
    s_add_u32 s47, s48, 12288
    buffer_store_dwordx4 v[28:31], v251, s[16:19], s47 offen sc1
    v_mfma_f32_16x16x32_bf16 v[44:47], v[196:199], v[228:231], v[44:47]
    s_waitcnt lgkmcnt(2)
    v_mfma_f32_16x16x32_bf16 v[80:83], v[176:179], v[232:235], v[80:83]
    ds_read_b128 v[216:219], v250 offset:22528
    ds_read_b128 v[220:223], v250 offset:33792
    v_mfma_f32_16x16x32_bf16 v[84:87], v[180:183], v[232:235], v[84:87]
    v_mfma_f32_16x16x32_bf16 v[88:91], v[208:211], v[232:235], v[88:91]
    v_mfma_f32_16x16x32_bf16 v[92:95], v[212:215], v[232:235], v[92:95]
    v_mfma_f32_16x16x32_bf16 v[80:83], v[184:187], v[236:239], v[80:83]
    v_mfma_f32_16x16x32_bf16 v[84:87], v[188:191], v[236:239], v[84:87]
    v_mfma_f32_16x16x32_bf16 v[88:91], v[176:179], v[236:239], v[88:91]
    v_mfma_f32_16x16x32_bf16 v[92:95], v[180:183], v[236:239], v[92:95]
    s_waitcnt lgkmcnt(2)
    v_mfma_f32_16x16x32_bf16 v[48:51], v[192:195], v[240:243], v[48:51]
    ds_read_b128 v[224:227], v253 offset:20480
    ds_read_b128 v[228:231], v253 offset:31744
    v_mfma_f32_16x16x32_bf16 v[52:55], v[196:199], v[240:243], v[52:55]
    v_cvt_pk_bf16_f32 v36, v36, v37
    v_cvt_pk_bf16_f32 v37, v38, v39
    v_mfma_f32_16x16x32_bf16 v[56:59], v[168:171], v[240:243], v[56:59]
    v_cvt_pk_bf16_f32 v38, v32, v33
    v_cvt_pk_bf16_f32 v39, v34, v35
    v_mfma_f32_16x16x32_bf16 v[60:63], v[172:175], v[240:243], v[60:63]
    s_add_u32 s47, s48, 2048
    buffer_store_dwordx4 v[36:39], v251, s[16:19], s47 offen sc1
    v_mfma_f32_16x16x32_bf16 v[48:51], v[200:203], v[244:247], v[48:51]
    v_cvt_pk_bf16_f32 v44, v44, v45
    v_cvt_pk_bf16_f32 v45, v46, v47
    v_mfma_f32_16x16x32_bf16 v[52:55], v[204:207], v[244:247], v[52:55]
    v_cvt_pk_bf16_f32 v46, v40, v41
    v_cvt_pk_bf16_f32 v47, v42, v43
    v_mfma_f32_16x16x32_bf16 v[56:59], v[192:195], v[244:247], v[56:59]
    s_add_u32 s47, s48, 13312
    buffer_store_dwordx4 v[44:47], v251, s[16:19], s47 offen sc1
    v_mfma_f32_16x16x32_bf16 v[60:63], v[196:199], v[244:247], v[60:63]
    s_waitcnt lgkmcnt(2)
    v_mfma_f32_16x16x32_bf16 v[96:99], v[176:179], v[216:219], v[96:99]
    ds_read_b128 v[232:235], v250 offset:23552
    ds_read_b128 v[236:239], v250 offset:34816
    v_mfma_f32_16x16x32_bf16 v[100:103], v[180:183], v[216:219], v[100:103]
    v_mfma_f32_16x16x32_bf16 v[104:107], v[208:211], v[216:219], v[104:107]
    v_mfma_f32_16x16x32_bf16 v[108:111], v[212:215], v[216:219], v[108:111]
    v_mfma_f32_16x16x32_bf16 v[96:99], v[184:187], v[220:223], v[96:99]
    v_mfma_f32_16x16x32_bf16 v[100:103], v[188:191], v[220:223], v[100:103]
    v_mfma_f32_16x16x32_bf16 v[104:107], v[176:179], v[220:223], v[104:107]
    v_mfma_f32_16x16x32_bf16 v[108:111], v[180:183], v[220:223], v[108:111]
    s_waitcnt lgkmcnt(2)
    v_mfma_f32_16x16x32_bf16 v[64:67], v[192:195], v[224:227], v[64:67]
    ds_read_b128 v[240:243], v253 offset:21504
    ds_read_b128 v[244:247], v253 offset:32768
    v_mfma_f32_16x16x32_bf16 v[68:71], v[196:199], v[224:227], v[68:71]
    v_cvt_pk_bf16_f32 v52, v52, v53
    v_cvt_pk_bf16_f32 v53, v54, v55
    v_mfma_f32_16x16x32_bf16 v[72:75], v[168:171], v[224:227], v[72:75]
    v_cvt_pk_bf16_f32 v54, v48, v49
    v_cvt_pk_bf16_f32 v55, v50, v51
    v_mfma_f32_16x16x32_bf16 v[76:79], v[172:175], v[224:227], v[76:79]
    s_add_u32 s47, s48, 3072
    buffer_store_dwordx4 v[52:55], v251, s[16:19], s47 offen sc1
    v_mfma_f32_16x16x32_bf16 v[64:67], v[200:203], v[228:231], v[64:67]
    v_cvt_pk_bf16_f32 v60, v60, v61
    v_cvt_pk_bf16_f32 v61, v62, v63
    v_mfma_f32_16x16x32_bf16 v[68:71], v[204:207], v[228:231], v[68:71]
    v_cvt_pk_bf16_f32 v62, v56, v57
    v_cvt_pk_bf16_f32 v63, v58, v59
    v_mfma_f32_16x16x32_bf16 v[72:75], v[192:195], v[228:231], v[72:75]
    s_add_u32 s47, s48, 14336
    buffer_store_dwordx4 v[60:63], v251, s[16:19], s47 offen sc1
    v_mfma_f32_16x16x32_bf16 v[76:79], v[196:199], v[228:231], v[76:79]
    s_waitcnt lgkmcnt(2)
    v_mfma_f32_16x16x32_bf16 v[112:115], v[176:179], v[232:235], v[112:115]
    ds_read_b128 v[216:219], v250 offset:24576
    ds_read_b128 v[220:223], v250 offset:35840
    v_mfma_f32_16x16x32_bf16 v[116:119], v[180:183], v[232:235], v[116:119]
    v_mfma_f32_16x16x32_bf16 v[120:123], v[208:211], v[232:235], v[120:123]
    v_mfma_f32_16x16x32_bf16 v[124:127], v[212:215], v[232:235], v[124:127]
    v_mfma_f32_16x16x32_bf16 v[112:115], v[184:187], v[236:239], v[112:115]
    v_mfma_f32_16x16x32_bf16 v[116:119], v[188:191], v[236:239], v[116:119]
    v_mfma_f32_16x16x32_bf16 v[120:123], v[176:179], v[236:239], v[120:123]
    v_mfma_f32_16x16x32_bf16 v[124:127], v[180:183], v[236:239], v[124:127]
    s_waitcnt lgkmcnt(2)
    v_mfma_f32_16x16x32_bf16 v[80:83], v[192:195], v[240:243], v[80:83]
    ds_read_b128 v[224:227], v253 offset:22528
    ds_read_b128 v[228:231], v253 offset:33792
    v_mfma_f32_16x16x32_bf16 v[84:87], v[196:199], v[240:243], v[84:87]
    v_cvt_pk_bf16_f32 v68, v68, v69
    v_cvt_pk_bf16_f32 v69, v70, v71
    v_mfma_f32_16x16x32_bf16 v[88:91], v[168:171], v[240:243], v[88:91]
    v_cvt_pk_bf16_f32 v70, v64, v65
    v_cvt_pk_bf16_f32 v71, v66, v67
    v_mfma_f32_16x16x32_bf16 v[92:95], v[172:175], v[240:243], v[92:95]
    s_add_u32 s47, s48, 4096
    buffer_store_dwordx4 v[68:71], v251, s[16:19], s47 offen sc1
    v_mfma_f32_16x16x32_bf16 v[80:83], v[200:203], v[244:247], v[80:83]
    v_cvt_pk_bf16_f32 v76, v76, v77
    v_cvt_pk_bf16_f32 v77, v78, v79
    v_mfma_f32_16x16x32_bf16 v[84:87], v[204:207], v[244:247], v[84:87]
    v_cvt_pk_bf16_f32 v78, v72, v73
    v_cvt_pk_bf16_f32 v79, v74, v75
    v_mfma_f32_16x16x32_bf16 v[88:91], v[192:195], v[244:247], v[88:91]
    s_add_u32 s47, s48, 15360
    buffer_store_dwordx4 v[76:79], v251, s[16:19], s47 offen sc1
    v_mfma_f32_16x16x32_bf16 v[92:95], v[196:199], v[244:247], v[92:95]
    s_waitcnt lgkmcnt(2)
    v_mfma_f32_16x16x32_bf16 v[128:131], v[176:179], v[216:219], v[128:131]
    ds_read_b128 v[232:235], v250 offset:25600
    ds_read_b128 v[236:239], v250 offset:36864
    v_mfma_f32_16x16x32_bf16 v[132:135], v[180:183], v[216:219], v[132:135]
    v_mfma_f32_16x16x32_bf16 v[136:139], v[208:211], v[216:219], v[136:139]
    v_mfma_f32_16x16x32_bf16 v[140:143], v[212:215], v[216:219], v[140:143]
    v_mfma_f32_16x16x32_bf16 v[128:131], v[184:187], v[220:223], v[128:131]
    v_mfma_f32_16x16x32_bf16 v[132:135], v[188:191], v[220:223], v[132:135]
    v_mfma_f32_16x16x32_bf16 v[136:139], v[176:179], v[220:223], v[136:139]
    v_mfma_f32_16x16x32_bf16 v[140:143], v[180:183], v[220:223], v[140:143]
    s_waitcnt lgkmcnt(2)
    v_mfma_f32_16x16x32_bf16 v[96:99], v[192:195], v[224:227], v[96:99]
    ds_read_b128 v[240:243], v253 offset:23552
    ds_read_b128 v[244:247], v253 offset:34816
    v_mfma_f32_16x16x32_bf16 v[100:103], v[196:199], v[224:227], v[100:103]
    v_cvt_pk_bf16_f32 v84, v84, v85
    v_cvt_pk_bf16_f32 v85, v86, v87
    v_mfma_f32_16x16x32_bf16 v[104:107], v[168:171], v[224:227], v[104:107]
    v_cvt_pk_bf16_f32 v86, v80, v81
    v_cvt_pk_bf16_f32 v87, v82, v83
    v_mfma_f32_16x16x32_bf16 v[108:111], v[172:175], v[224:227], v[108:111]
    s_add_u32 s47, s48, 5120
    buffer_store_dwordx4 v[84:87], v251, s[16:19], s47 offen sc1
    v_mfma_f32_16x16x32_bf16 v[96:99], v[200:203], v[228:231], v[96:99]
    v_cvt_pk_bf16_f32 v92, v92, v93
    v_cvt_pk_bf16_f32 v93, v94, v95
    v_mfma_f32_16x16x32_bf16 v[100:103], v[204:207], v[228:231], v[100:103]
    v_cvt_pk_bf16_f32 v94, v88, v89
    v_cvt_pk_bf16_f32 v95, v90, v91
    v_mfma_f32_16x16x32_bf16 v[104:107], v[192:195], v[228:231], v[104:107]
    s_add_u32 s47, s48, 16384
    buffer_store_dwordx4 v[92:95], v251, s[16:19], s47 offen sc1
    v_mfma_f32_16x16x32_bf16 v[108:111], v[196:199], v[228:231], v[108:111]
    s_waitcnt lgkmcnt(2)
    v_mfma_f32_16x16x32_bf16 v[144:147], v[176:179], v[232:235], v[144:147]
    ds_read_b128 v[216:219], v250 offset:26624
    ds_read_b128 v[220:223], v250 offset:37888
    v_mfma_f32_16x16x32_bf16 v[148:151], v[180:183], v[232:235], v[148:151]
    v_mfma_f32_16x16x32_bf16 v[152:155], v[208:211], v[232:235], v[152:155]
    v_mfma_f32_16x16x32_bf16 v[156:159], v[212:215], v[232:235], v[156:159]
    v_mfma_f32_16x16x32_bf16 v[144:147], v[184:187], v[236:239], v[144:147]
    v_mfma_f32_16x16x32_bf16 v[148:151], v[188:191], v[236:239], v[148:151]
    v_mfma_f32_16x16x32_bf16 v[152:155], v[176:179], v[236:239], v[152:155]
    v_mfma_f32_16x16x32_bf16 v[156:159], v[180:183], v[236:239], v[156:159]
    s_waitcnt lgkmcnt(2)
    v_mfma_f32_16x16x32_bf16 v[112:115], v[192:195], v[240:243], v[112:115]
    ds_read_b128 v[224:227], v253 offset:24576
    ds_read_b128 v[228:231], v253 offset:35840
    v_mfma_f32_16x16x32_bf16 v[116:119], v[196:199], v[240:243], v[116:119]
    v_cvt_pk_bf16_f32 v100, v100, v101
    v_cvt_pk_bf16_f32 v101, v102, v103
    v_mfma_f32_16x16x32_bf16 v[120:123], v[168:171], v[240:243], v[120:123]
    v_cvt_pk_bf16_f32 v102, v96, v97
    v_cvt_pk_bf16_f32 v103, v98, v99
    v_mfma_f32_16x16x32_bf16 v[124:127], v[172:175], v[240:243], v[124:127]
    s_add_u32 s47, s48, 6144
    buffer_store_dwordx4 v[100:103], v251, s[16:19], s47 offen sc1
    v_mfma_f32_16x16x32_bf16 v[112:115], v[200:203], v[244:247], v[112:115]
    v_cvt_pk_bf16_f32 v108, v108, v109
    v_cvt_pk_bf16_f32 v109, v110, v111
    v_mfma_f32_16x16x32_bf16 v[116:119], v[204:207], v[244:247], v[116:119]
    v_cvt_pk_bf16_f32 v110, v104, v105
    v_cvt_pk_bf16_f32 v111, v106, v107
    v_mfma_f32_16x16x32_bf16 v[120:123], v[192:195], v[244:247], v[120:123]
    s_add_u32 s47, s48, 17408
    buffer_store_dwordx4 v[108:111], v251, s[16:19], s47 offen sc1
    v_mfma_f32_16x16x32_bf16 v[124:127], v[196:199], v[244:247], v[124:127]
    s_waitcnt lgkmcnt(2)
    v_mfma_f32_16x16x32_bf16 v[160:163], v[176:179], v[216:219], v[160:163]
    ds_read_b128 v[232:235], v253 offset:25600
    ds_read_b128 v[236:239], v253 offset:36864
    v_mfma_f32_16x16x32_bf16 v[164:167], v[208:211], v[216:219], v[164:167]
    v_mfma_f32_16x16x32_bf16 v[160:163], v[184:187], v[220:223], v[160:163]
    v_mfma_f32_16x16x32_bf16 v[164:167], v[176:179], v[220:223], v[164:167]
    s_waitcnt lgkmcnt(2)
    v_mfma_f32_16x16x32_bf16 v[128:131], v[192:195], v[224:227], v[128:131]
    ds_read_b128 v[240:243], v253 offset:26624
    ds_read_b128 v[244:247], v253 offset:37888
    v_mfma_f32_16x16x32_bf16 v[132:135], v[196:199], v[224:227], v[132:135]
    v_cvt_pk_bf16_f32 v116, v116, v117
    v_cvt_pk_bf16_f32 v117, v118, v119
    v_mfma_f32_16x16x32_bf16 v[136:139], v[168:171], v[224:227], v[136:139]
    v_cvt_pk_bf16_f32 v118, v112, v113
    v_cvt_pk_bf16_f32 v119, v114, v115
    v_mfma_f32_16x16x32_bf16 v[140:143], v[172:175], v[224:227], v[140:143]
    s_add_u32 s47, s48, 7168
    buffer_store_dwordx4 v[116:119], v251, s[16:19], s47 offen sc1
    v_mfma_f32_16x16x32_bf16 v[128:131], v[200:203], v[228:231], v[128:131]
    v_cvt_pk_bf16_f32 v124, v124, v125
    v_cvt_pk_bf16_f32 v125, v126, v127
    v_mfma_f32_16x16x32_bf16 v[132:135], v[204:207], v[228:231], v[132:135]
    v_cvt_pk_bf16_f32 v126, v120, v121
    v_cvt_pk_bf16_f32 v127, v122, v123
    v_mfma_f32_16x16x32_bf16 v[136:139], v[192:195], v[228:231], v[136:139]
    s_add_u32 s47, s48, 18432
    buffer_store_dwordx4 v[124:127], v251, s[16:19], s47 offen sc1
    v_mfma_f32_16x16x32_bf16 v[140:143], v[196:199], v[228:231], v[140:143]
    s_waitcnt lgkmcnt(2)
    v_mfma_f32_16x16x32_bf16 v[144:147], v[192:195], v[232:235], v[144:147]
    v_mfma_f32_16x16x32_bf16 v[148:151], v[196:199], v[232:235], v[148:151]
    v_mfma_f32_16x16x32_bf16 v[152:155], v[168:171], v[232:235], v[152:155]
    v_mfma_f32_16x16x32_bf16 v[156:159], v[172:175], v[232:235], v[156:159]
    v_mfma_f32_16x16x32_bf16 v[144:147], v[200:203], v[236:239], v[144:147]
    v_mfma_f32_16x16x32_bf16 v[148:151], v[204:207], v[236:239], v[148:151]
    v_mfma_f32_16x16x32_bf16 v[152:155], v[192:195], v[236:239], v[152:155]
    v_mfma_f32_16x16x32_bf16 v[156:159], v[196:199], v[236:239], v[156:159]
    s_waitcnt lgkmcnt(0)
    v_mfma_f32_16x16x32_bf16 v[160:163], v[192:195], v[240:243], v[160:163]
    v_mfma_f32_16x16x32_bf16 v[164:167], v[168:171], v[240:243], v[164:167]
    v_cvt_pk_bf16_f32 v132, v132, v133
    v_cvt_pk_bf16_f32 v133, v134, v135
    v_mfma_f32_16x16x32_bf16 v[160:163], v[200:203], v[244:247], v[160:163]
    v_cvt_pk_bf16_f32 v134, v128, v129
    v_cvt_pk_bf16_f32 v135, v130, v131
    v_mfma_f32_16x16x32_bf16 v[164:167], v[192:195], v[244:247], v[164:167]
    s_add_u32 s47, s48, 8192
    buffer_store_dwordx4 v[132:135], v251, s[16:19], s47 offen sc1
    s_nop 7
    v_cvt_pk_bf16_f32 v140, v140, v141
    v_cvt_pk_bf16_f32 v141, v142, v143
    v_cvt_pk_bf16_f32 v142, v136, v137
    v_cvt_pk_bf16_f32 v143, v138, v139
    s_add_u32 s47, s48, 19456
    buffer_store_dwordx4 v[140:143], v251, s[16:19], s47 offen sc1
    v_cvt_pk_bf16_f32 v148, v148, v149
    v_cvt_pk_bf16_f32 v149, v150, v151
    v_cvt_pk_bf16_f32 v150, v144, v145
    v_cvt_pk_bf16_f32 v151, v146, v147
    s_add_u32 s47, s48, 9216
    buffer_store_dwordx4 v[148:151], v251, s[16:19], s47 offen sc1
    v_cvt_pk_bf16_f32 v156, v156, v157
    v_cvt_pk_bf16_f32 v157, v158, v159
    v_cvt_pk_bf16_f32 v158, v152, v153
    v_cvt_pk_bf16_f32 v159, v154, v155
    s_add_u32 s47, s48, 20480
    buffer_store_dwordx4 v[156:159], v251, s[16:19], s47 offen sc1
    v_cvt_pk_bf16_f32 v160, v160, v161
    v_cvt_pk_bf16_f32 v161, v162, v163
    s_add_u32 s47, s49, 0
    buffer_store_dwordx2 v[160:161], v252, s[16:19], s47 offen sc1
    v_cvt_pk_bf16_f32 v164, v164, v165
    v_cvt_pk_bf16_f32 v165, v166, v167
    s_add_u32 s47, s49, 11264
    buffer_store_dwordx2 v[164:165], v252, s[16:19], s47 offen sc1
L_epi_done:
    s_endpgm
L_k3_helper:
    s_mul_i32 s40, s11, 16384
    s_mul_i32 s20, s14, 16777216
    s_add_u32 s40, s40, s20
    s_mul_i32 s41, s11, 21504
    s_mul_i32 s20, s13, 22020096
    s_add_u32 s41, s41, s20
    s_add_u32 s41, s41, 67108864
    s_lshl_b32 s42, s15, 12
    s_mul_i32 s43, s15, 5632
    s_lshr_b32 s20, s15, 1
    s_lshl_b32 s21, s20, 9
    s_sub_u32 s21, s43, s21
    v_lshlrev_b32 v1, 4, v0
    v_lshlrev_b32 v1, 4, v0
    v_add_u32 v2, s21, v1
    s_add_u32 s22, s21, 4096
    v_add_u32 v5, s22, v1
    s_mov_b32 s44, s41
    s_bitcmp1_b32 s15, 0
    s_cbranch_scc0 L_six_even
    s_mul_i32 s22, s20, 10752
    s_add_u32 s22, s22, 9216
    v_lshrrev_b32 v5, 2, v0
    v_lshlrev_b32 v5, 6, v5
    v_and_b32 v3, 3, v0
    v_xor_b32 v3, 3, v3
    v_lshl_add_u32 v5, v3, 4, v5
    v_add_u32 v5, s22, v5
    s_mul_i32 s44, s11, 21504
    s_xor_b32 s22, s13, 1
    s_mul_i32 s22, s22, 22020096
    s_add_u32 s44, s44, s22
    s_add_u32 s44, s44, 67108864
L_six_even:
    s_mov_b32 s50, -1
    s_mov_b32 s51, 0
    v_add_u32 v1, s42, v1
    s_add_u32 s43, s43, 16384
    s_cmp_ge_u32 s2, 8
    s_cbranch_scc1 L_nozero
    s_cmp_lg_u32 s15, 0
    s_cbranch_scc1 L_nozero
    s_mul_i32 s20, s2, 8448
    s_add_u32 s20, s20, 147849216
    v_mov_b32 v3, 0
    v_lshlrev_b32 v4, 2, v0
    buffer_store_dword v3, v4, s[16:19], s20 offen
L_nozero:
    s_cmp_ge_u32 s2, 224
    s_cbranch_scc1 L_nofill
    s_cmp_lg_u32 s15, 1
    s_cbranch_scc1 L_nofill
    s_lshl_b32 s20, s2, 10
    s_add_u32 s20, s20, 146800640
    v_mov_b32 v8, -1
    v_mov_b32 v9, -1
    v_mov_b32 v10, -1
    v_mov_b32 v11, -1
    v_lshlrev_b32 v4, 4, v0
    buffer_store_dwordx4 v[8:11], v4, s[16:19], s20 offen
L_nofill:
    s_add_u32 m0, s42, 0
    s_nop 0
    buffer_load_dwordx4 v1, s[16:19], s40 offen offset:0 lds
    buffer_load_dwordx4 v1, s[16:19], s40 offen offset:1024 lds
    buffer_load_dwordx4 v1, s[16:19], s40 offen offset:2048 lds
    buffer_load_dwordx4 v1, s[16:19], s40 offen offset:3072 lds
    s_add_u32 s40, s40, 524288
    s_add_u32 m0, s43, 0
    s_nop 0
    buffer_load_dwordx4 v2, s[16:19], s41 offen offset:0 lds
    buffer_load_dwordx4 v2, s[16:19], s41 offen offset:1024 lds
    buffer_load_dwordx4 v2, s[16:19], s41 offen offset:2048 lds
    buffer_load_dwordx4 v2, s[16:19], s41 offen offset:3072 lds
    s_add_u32 m0, s43, 4096
    s_add_u32 s49, s41, 4096
    buffer_load_dwordx4 v2, s[16:19], s49 offen lds
    s_mov_b64 exec, s[50:51]
    buffer_load_dwordx4 v5, s[16:19], s44 offen offset:1024 lds
    s_mov_b64 exec, -1
    s_add_u32 s41, s41, 688128
    s_add_u32 s44, s44, 688128
    s_add_u32 m0, s42, 38912
    s_nop 0
    buffer_load_dwordx4 v1, s[16:19], s40 offen offset:0 lds
    buffer_load_dwordx4 v1, s[16:19], s40 offen offset:1024 lds
    buffer_load_dwordx4 v1, s[16:19], s40 offen offset:2048 lds
    buffer_load_dwordx4 v1, s[16:19], s40 offen offset:3072 lds
    s_add_u32 s40, s40, 524288
    s_add_u32 m0, s43, 38912
    s_nop 0
    buffer_load_dwordx4 v2, s[16:19], s41 offen offset:0 lds
    buffer_load_dwordx4 v2, s[16:19], s41 offen offset:1024 lds
    buffer_load_dwordx4 v2, s[16:19], s41 offen offset:2048 lds
    buffer_load_dwordx4 v2, s[16:19], s41 offen offset:3072 lds
    s_add_u32 m0, s43, 43008
    s_add_u32 s49, s41, 4096
    buffer_load_dwordx4 v2, s[16:19], s49 offen lds
    s_mov_b64 exec, s[50:51]
    buffer_load_dwordx4 v5, s[16:19], s44 offen offset:1024 lds
    s_mov_b64 exec, -1
    s_add_u32 s41, s41, 688128
    s_add_u32 s44, s44, 688128
    s_add_u32 m0, s42, 77824
    s_nop 0
    buffer_load_dwordx4 v1, s[16:19], s40 offen offset:0 lds
    buffer_load_dwordx4 v1, s[16:19], s40 offen offset:1024 lds
    buffer_load_dwordx4 v1, s[16:19], s40 offen offset:2048 lds
    buffer_load_dwordx4 v1, s[16:19], s40 offen offset:3072 lds
    s_add_u32 s40, s40, 524288
    s_add_u32 m0, s43, 77824
    s_nop 0
    buffer_load_dwordx4 v2, s[16:19], s41 offen offset:0 lds
    buffer_load_dwordx4 v2, s[16:19], s41 offen offset:1024 lds
    buffer_load_dwordx4 v2, s[16:19], s41 offen offset:2048 lds
    buffer_load_dwordx4 v2, s[16:19], s41 offen offset:3072 lds
    s_add_u32 m0, s43, 81920
    s_add_u32 s49, s41, 4096
    buffer_load_dwordx4 v2, s[16:19], s49 offen lds
    s_mov_b64 exec, s[50:51]
    buffer_load_dwordx4 v5, s[16:19], s44 offen offset:1024 lds
    s_mov_b64 exec, -1
    s_add_u32 s41, s41, 688128
    s_add_u32 s44, s44, 688128
    s_waitcnt vmcnt(20)
    s_barrier
    s_mov_b32 s46, 7
L_h_loop:
    s_waitcnt vmcnt(10)
    s_barrier
    s_add_u32 m0, s42, 116736
    s_nop 0
    buffer_load_dwordx4 v1, s[16:19], s40 offen offset:0 lds
    buffer_load_dwordx4 v1, s[16:19], s40 offen offset:1024 lds
    buffer_load_dwordx4 v1, s[16:19], s40 offen offset:2048 lds
    buffer_load_dwordx4 v1, s[16:19], s40 offen offset:3072 lds
    s_add_u32 s40, s40, 524288
    s_add_u32 m0, s43, 116736
    s_nop 0
    buffer_load_dwordx4 v2, s[16:19], s41 offen offset:0 lds
    buffer_load_dwordx4 v2, s[16:19], s41 offen offset:1024 lds
    buffer_load_dwordx4 v2, s[16:19], s41 offen offset:2048 lds
    buffer_load_dwordx4 v2, s[16:19], s41 offen offset:3072 lds
    s_add_u32 m0, s43, 120832
    s_add_u32 s49, s41, 4096
    buffer_load_dwordx4 v2, s[16:19], s49 offen lds
    s_mov_b64 exec, s[50:51]
    buffer_load_dwordx4 v5, s[16:19], s44 offen offset:1024 lds
    s_mov_b64 exec, -1
    s_add_u32 s41, s41, 688128
    s_add_u32 s44, s44, 688128
    s_waitcnt vmcnt(10)
    s_barrier
    s_add_u32 m0, s42, 0
    s_nop 0
    buffer_load_dwordx4 v1, s[16:19], s40 offen offset:0 lds
    buffer_load_dwordx4 v1, s[16:19], s40 offen offset:1024 lds
    buffer_load_dwordx4 v1, s[16:19], s40 offen offset:2048 lds
    buffer_load_dwordx4 v1, s[16:19], s40 offen offset:3072 lds
    s_add_u32 s40, s40, 524288
    s_add_u32 m0, s43, 0
    s_nop 0
    buffer_load_dwordx4 v2, s[16:19], s41 offen offset:0 lds
    buffer_load_dwordx4 v2, s[16:19], s41 offen offset:1024 lds
    buffer_load_dwordx4 v2, s[16:19], s41 offen offset:2048 lds
    buffer_load_dwordx4 v2, s[16:19], s41 offen offset:3072 lds
    s_add_u32 m0, s43, 4096
    s_add_u32 s49, s41, 4096
    buffer_load_dwordx4 v2, s[16:19], s49 offen lds
    s_mov_b64 exec, s[50:51]
    buffer_load_dwordx4 v5, s[16:19], s44 offen offset:1024 lds
    s_mov_b64 exec, -1
    s_add_u32 s41, s41, 688128
    s_add_u32 s44, s44, 688128
    s_waitcnt vmcnt(10)
    s_barrier
    s_add_u32 m0, s42, 38912
    s_nop 0
    buffer_load_dwordx4 v1, s[16:19], s40 offen offset:0 lds
    buffer_load_dwordx4 v1, s[16:19], s40 offen offset:1024 lds
    buffer_load_dwordx4 v1, s[16:19], s40 offen offset:2048 lds
    buffer_load_dwordx4 v1, s[16:19], s40 offen offset:3072 lds
    s_add_u32 s40, s40, 524288
    s_add_u32 m0, s43, 38912
    s_nop 0
    buffer_load_dwordx4 v2, s[16:19], s41 offen offset:0 lds
    buffer_load_dwordx4 v2, s[16:19], s41 offen offset:1024 lds
    buffer_load_dwordx4 v2, s[16:19], s41 offen offset:2048 lds
    buffer_load_dwordx4 v2, s[16:19], s41 offen offset:3072 lds
    s_add_u32 m0, s43, 43008
    s_add_u32 s49, s41, 4096
    buffer_load_dwordx4 v2, s[16:19], s49 offen lds
    s_mov_b64 exec, s[50:51]
    buffer_load_dwordx4 v5, s[16:19], s44 offen offset:1024 lds
    s_mov_b64 exec, -1
    s_add_u32 s41, s41, 688128
    s_add_u32 s44, s44, 688128
    s_waitcnt vmcnt(10)
    s_barrier
    s_add_u32 m0, s42, 77824
    s_nop 0
    buffer_load_dwordx4 v1, s[16:19], s40 offen offset:0 lds
    buffer_load_dwordx4 v1, s[16:19], s40 offen offset:1024 lds
    buffer_load_dwordx4 v1, s[16:19], s40 offen offset:2048 lds
    buffer_load_dwordx4 v1, s[16:19], s40 offen offset:3072 lds
    s_add_u32 s40, s40, 524288
    s_add_u32 m0, s43, 77824
    s_nop 0
    buffer_load_dwordx4 v2, s[16:19], s41 offen offset:0 lds
    buffer_load_dwordx4 v2, s[16:19], s41 offen offset:1024 lds
    buffer_load_dwordx4 v2, s[16:19], s41 offen offset:2048 lds
    buffer_load_dwordx4 v2, s[16:19], s41 offen offset:3072 lds
    s_add_u32 m0, s43, 81920
    s_add_u32 s49, s41, 4096
    buffer_load_dwordx4 v2, s[16:19], s49 offen lds
    s_mov_b64 exec, s[50:51]
    buffer_load_dwordx4 v5, s[16:19], s44 offen offset:1024 lds
    s_mov_b64 exec, -1
    s_add_u32 s41, s41, 688128
    s_add_u32 s44, s44, 688128
    s_sub_u32 s46, s46, 1
    s_cmp_lg_u32 s46, 0
    s_cbranch_scc1 L_h_loop
    s_waitcnt vmcnt(10)
    s_barrier
    s_add_u32 m0, s42, 116736
    s_nop 0
    buffer_load_dwordx4 v1, s[16:19], s40 offen offset:0 lds
    buffer_load_dwordx4 v1, s[16:19], s40 offen offset:1024 lds
    buffer_load_dwordx4 v1, s[16:19], s40 offen offset:2048 lds
    buffer_load_dwordx4 v1, s[16:19], s40 offen offset:3072 lds
    s_add_u32 s40, s40, 524288
    s_add_u32 m0, s43, 116736
    s_nop 0
    buffer_load_dwordx4 v2, s[16:19], s41 offen offset:0 lds
    buffer_load_dwordx4 v2, s[16:19], s41 offen offset:1024 lds
    buffer_load_dwordx4 v2, s[16:19], s41 offen offset:2048 lds
    buffer_load_dwordx4 v2, s[16:19], s41 offen offset:3072 lds
    s_add_u32 m0, s43, 120832
    s_add_u32 s49, s41, 4096
    buffer_load_dwordx4 v2, s[16:19], s49 offen lds
    s_mov_b64 exec, s[50:51]
    buffer_load_dwordx4 v5, s[16:19], s44 offen offset:1024 lds
    s_mov_b64 exec, -1
    s_add_u32 s41, s41, 688128
    s_add_u32 s44, s44, 688128
    s_waitcnt vmcnt(10)
    s_barrier
    s_waitcnt vmcnt(0)
    s_barrier
    s_endpgm
L_k3_end:
    s_endpgm
.globl final_kernel
.p2align 8
.type final_kernel,@function
final_kernel:
    s_cmp_ge_u32 s2, 224
    s_cbranch_scc1 L_k45_end
    s_load_dwordx2 s[8:9], s[0:1], 48
    s_load_dwordx4 s[4:7], s[0:1], 16
    s_load_dwordx2 s[28:29], s[0:1], 32
    v_lshrrev_b32 v204, 6, v0
    v_and_b32 v200, 63, v0
    v_readfirstlane_b32 s10, v204
    s_cmp_ge_u32 s2, 8
    s_cbranch_scc1 L_nopf45
    s_nop 1
    s_cmp_lg_u32 s10, 7
    s_cbranch_scc1 L_nopf45
    s_getpc_b64 s[60:61]
L_pf_k45:
    s_sub_u32 s60, s60, L_pf_k45-final_kernel
    s_subb_u32 s61, s61, 0
    v_mbcnt_lo_u32_b32 v112, -1, 0
    v_mbcnt_hi_u32_b32 v112, -1, v112
    v_lshlrev_b32 v112, 6, v112
    v_add_u32 v113, 0, v112
    v_min_u32 v113, L_code_end-final_kernel-4, v113
    v_mov_b32 v115, s61
    v_add_co_u32 v114, vcc, s60, v113
    s_nop 1
    v_addc_co_u32 v115, vcc, 0, v115, vcc
    global_load_dword v116, v[114:115], off
    v_add_u32 v113, 4096, v112
    v_min_u32 v113, L_code_end-final_kernel-4, v113
    v_mov_b32 v115, s61
    v_add_co_u32 v114, vcc, s60, v113
    s_nop 1
    v_addc_co_u32 v115, vcc, 0, v115, vcc
    global_load_dword v116, v[114:115], off
    v_add_u32 v113, 8192, v112
    v_min_u32 v113, L_code_end-final_kernel-4, v113
    v_mov_b32 v115, s61
    v_add_co_u32 v114, vcc, s60, v113
    s_nop 1
    v_addc_co_u32 v115, vcc, 0, v115, vcc
    global_load_dword v116, v[114:115], off
L_nopf45:
    v_lshlrev_b32 v214, 2, v0
    v_and_b32 v201, 15, v200
    v_lshrrev_b32 v202, 4, v200
    s_and_b32 s13, s2, 3
    s_lshr_b32 s12, s2, 2
    s_cmp_ge_u32 s12, 28
    s_cselect_b32 s11, 1, 0
    s_mul_i32 s15, s11, 28
    s_sub_u32 s12, s12, s15
    s_mul_i32 s14, s12, 6
    s_add_u32 s14, s14, s10
    s_mov_b32 s24, 90112
    v_mul_u32_u24 v203, s24, v202
    v_lshrrev_b32 v205, 2, v201
    s_mov_b32 s24, 720896
    v_mad_u32_u24 v203, v205, s24, v203
    v_and_b32 v205, 3, v201
    v_lshl_add_u32 v203, v205, 4, v203
    s_mul_i32 s24, s11, 11534336
    s_mul_i32 s25, s13, 2883584
    s_add_u32 s24, s24, s25
    s_lshl_b32 s25, s14, 6
    s_add_u32 s24, s24, s25
    s_add_u32 s24, s24, 117440512
    s_mov_b32 s30, 0x05040100
    s_mov_b32 s31, 0x07060302
    s_waitcnt lgkmcnt(0)
    s_mov_b32 s16, s8
    s_and_b32 s17, s9, 0xffff
    s_mov_b32 s18, 268435456
    s_mov_b32 s19, 0x00020000
    s_cmp_ge_u32 s10, 6
    s_cbranch_scc1 L_k45_gb
    s_add_u32 s25, s24, 0
    buffer_load_dwordx4 v[0:3], v203, s[16:19], s25 offen
    s_add_u32 s25, s24, 11264
    buffer_load_dwordx4 v[4:7], v203, s[16:19], s25 offen
    s_add_u32 s25, s24, 22528
    buffer_load_dwordx4 v[8:11], v203, s[16:19], s25 offen
    s_add_u32 s25, s24, 33792
    buffer_load_dwordx4 v[12:15], v203, s[16:19], s25 offen
    s_add_u32 s25, s24, 45056
    buffer_load_dwordx4 v[16:19], v203, s[16:19], s25 offen
    s_add_u32 s25, s24, 56320
    buffer_load_dwordx4 v[20:23], v203, s[16:19], s25 offen
    s_add_u32 s25, s24, 67584
    buffer_load_dwordx4 v[24:27], v203, s[16:19], s25 offen
    s_add_u32 s25, s24, 78848
    buffer_load_dwordx4 v[28:31], v203, s[16:19], s25 offen
    s_add_u32 s25, s24, 360448
    buffer_load_dwordx4 v[32:35], v203, s[16:19], s25 offen
    s_add_u32 s25, s24, 371712
    buffer_load_dwordx4 v[36:39], v203, s[16:19], s25 offen
    s_add_u32 s25, s24, 382976
    buffer_load_dwordx4 v[40:43], v203, s[16:19], s25 offen
    s_add_u32 s25, s24, 394240
    buffer_load_dwordx4 v[44:47], v203, s[16:19], s25 offen
    s_add_u32 s25, s24, 405504
    buffer_load_dwordx4 v[48:51], v203, s[16:19], s25 offen
    s_add_u32 s25, s24, 416768
    buffer_load_dwordx4 v[52:55], v203, s[16:19], s25 offen
    s_add_u32 s25, s24, 428032
    buffer_load_dwordx4 v[56:59], v203, s[16:19], s25 offen
    s_add_u32 s25, s24, 439296
    buffer_load_dwordx4 v[60:63], v203, s[16:19], s25 offen
    s_lshr_b32 s27, s10, 1
    s_and_b32 s33, s10, 1
    s_lshl_b32 s27, s27, 4
    v_add_u32 v204, s27, v201
    s_lshl_b32 s33, s33, 5
    s_add_u32 s33, s33, 1
    v_lshlrev_b32 v205, 3, v202
    v_add_u32 v205, s33, v205
    v_mul_u32_u24 v88, v205, v204
    v_add_u32 v89, 32, v88
    v_add_u32 v205, 2, v205
    v_mul_u32_u24 v90, v205, v204
    v_add_u32 v91, 32, v90
    v_add_u32 v205, 2, v205
    v_mul_u32_u24 v92, v205, v204
    v_add_u32 v93, 32, v92
    v_add_u32 v205, 2, v205
    v_mul_u32_u24 v94, v205, v204
    v_add_u32 v95, 32, v94
    v_and_b32 v88, 127, v88
    v_cvt_f32_u32 v88, v88
    v_mul_f32 v88, 0x3c000000, v88
    v_cos_f32 v88, v88
    v_and_b32 v89, 127, v89
    v_cvt_f32_u32 v89, v89
    v_mul_f32 v89, 0x3c000000, v89
    v_cos_f32 v89, v89
    v_and_b32 v90, 127, v90
    v_cvt_f32_u32 v90, v90
    v_mul_f32 v90, 0x3c000000, v90
    v_cos_f32 v90, v90
    v_and_b32 v91, 127, v91
    v_cvt_f32_u32 v91, v91
    v_mul_f32 v91, 0x3c000000, v91
    v_cos_f32 v91, v91
    v_and_b32 v92, 127, v92
    v_cvt_f32_u32 v92, v92
    v_mul_f32 v92, 0x3c000000, v92
    v_cos_f32 v92, v92
    v_and_b32 v93, 127, v93
    v_cvt_f32_u32 v93, v93
    v_mul_f32 v93, 0x3c000000, v93
    v_cos_f32 v93, v93
    v_and_b32 v94, 127, v94
    v_cvt_f32_u32 v94, v94
    v_mul_f32 v94, 0x3c000000, v94
    v_cos_f32 v94, v94
    v_and_b32 v95, 127, v95
    v_cvt_f32_u32 v95, v95
    v_mul_f32 v95, 0x3c000000, v95
    v_cos_f32 v95, v95
    v_mul_f32 v88, 0x3d000000, v88
    v_mul_f32 v89, 0x3d000000, v89
    v_mul_f32 v90, 0x3d000000, v90
    v_mul_f32 v91, 0x3d000000, v91
    v_mul_f32 v92, 0x3d000000, v92
    v_mul_f32 v93, 0x3d000000, v93
    v_mul_f32 v94, 0x3d000000, v94
    v_mul_f32 v95, 0x3d000000, v95
    v_cvt_pk_bf16_f32 v104, v88, v89
    v_cvt_pk_bf16_f32 v105, v90, v91
    v_cvt_pk_bf16_f32 v106, v92, v93
    v_cvt_pk_bf16_f32 v107, v94, v95
    s_lshl_b32 s26, s10, 10
    v_lshlrev_b32 v207, 4, v200
    v_add_u32 v207, s26, v207
    ds_write_b128 v207, v[104:107] offset:0
L_k45_gb:
    s_mov_b32 s20, s4
    s_and_b32 s21, s5, 0xffff
    s_mov_b32 s22, 1024
    s_mov_b32 s23, 0x00020000
    s_mov_b32 s36, s6
    s_and_b32 s37, s7, 0xffff
    s_mov_b32 s38, 1024
    s_mov_b32 s39, 0x00020000
    v_lshlrev_b32 v210, 4, v201
    s_lshl_b32 s25, s13, 8
    buffer_load_dwordx4 v[232:235], v210, s[20:23], s25 offen
    buffer_load_dwordx4 v[236:239], v210, s[36:39], s25 offen
    s_waitcnt lgkmcnt(0)
    s_barrier
    s_cmp_ge_u32 s10, 6
    s_cbranch_scc1 L_k45_red2
    v_lshlrev_b32 v207, 4, v200
    ds_read_b128 v[64:67], v207 offset:0
    ds_read_b128 v[68:71], v207 offset:1024
    ds_read_b128 v[72:75], v207 offset:2048
    ds_read_b128 v[76:79], v207 offset:3072
    ds_read_b128 v[80:83], v207 offset:4096
    ds_read_b128 v[84:87], v207 offset:5120
    s_cmp_ge_u32 s14, 167
    s_cbranch_scc1 L_k45_zero
    s_waitcnt lgkmcnt(0)
    s_cmp_lg_u32 s14, 166
    s_cbranch_scc1 L_k45_full
    v_cmp_gt_i32 vcc, 17, v201
    s_nop 1
    v_cndmask_b32 v64, 0, v64, vcc
    v_cndmask_b32 v65, 0, v65, vcc
    v_cndmask_b32 v66, 0, v66, vcc
    v_cndmask_b32 v67, 0, v67, vcc
    v_cndmask_b32 v68, 0, v68, vcc
    v_cndmask_b32 v69, 0, v69, vcc
    v_cndmask_b32 v70, 0, v70, vcc
    v_cndmask_b32 v71, 0, v71, vcc
    v_cmp_gt_i32 vcc, 1, v201
    s_nop 1
    v_cndmask_b32 v72, 0, v72, vcc
    v_cndmask_b32 v73, 0, v73, vcc
    v_cndmask_b32 v74, 0, v74, vcc
    v_cndmask_b32 v75, 0, v75, vcc
    v_cndmask_b32 v76, 0, v76, vcc
    v_cndmask_b32 v77, 0, v77, vcc
    v_cndmask_b32 v78, 0, v78, vcc
    v_cndmask_b32 v79, 0, v79, vcc
    v_cmp_gt_i32 vcc, 0, v201
    s_nop 1
    v_cndmask_b32 v80, 0, v80, vcc
    v_cndmask_b32 v81, 0, v81, vcc
    v_cndmask_b32 v82, 0, v82, vcc
    v_cndmask_b32 v83, 0, v83, vcc
    v_cndmask_b32 v84, 0, v84, vcc
    v_cndmask_b32 v85, 0, v85, vcc
    v_cndmask_b32 v86, 0, v86, vcc
    v_cndmask_b32 v87, 0, v87, vcc
L_k45_full:
    s_waitcnt vmcnt(2)
    v_perm_b32 v88, v4, v0, s30
    v_perm_b32 v89, v12, v8, s30
    v_perm_b32 v90, v20, v16, s30
    v_perm_b32 v91, v28, v24, s30
    v_perm_b32 v92, v4, v0, s31
    v_perm_b32 v93, v12, v8, s31
    v_perm_b32 v94, v20, v16, s31
    v_perm_b32 v95, v28, v24, s31
    v_perm_b32 v96, v36, v32, s30
    v_perm_b32 v97, v44, v40, s30
    v_perm_b32 v98, v52, v48, s30
    v_perm_b32 v99, v60, v56, s30
    v_perm_b32 v100, v36, v32, s31
    v_perm_b32 v101, v44, v40, s31
    v_perm_b32 v102, v52, v48, s31
    v_perm_b32 v103, v60, v56, s31
    v_mfma_f32_16x16x32_bf16 v[104:107], v[64:67], v[88:91], 0
    v_mfma_f32_16x16x32_bf16 v[108:111], v[64:67], v[92:95], 0
    v_mfma_f32_16x16x32_bf16 v[136:139], v[72:75], v[88:91], 0
    v_mfma_f32_16x16x32_bf16 v[140:143], v[72:75], v[92:95], 0
    v_mfma_f32_16x16x32_bf16 v[168:171], v[80:83], v[88:91], 0
    v_mfma_f32_16x16x32_bf16 v[172:175], v[80:83], v[92:95], 0
    v_mfma_f32_16x16x32_bf16 v[104:107], v[68:71], v[96:99], v[104:107]
    v_mfma_f32_16x16x32_bf16 v[108:111], v[68:71], v[100:103], v[108:111]
    v_mfma_f32_16x16x32_bf16 v[136:139], v[76:79], v[96:99], v[136:139]
    v_mfma_f32_16x16x32_bf16 v[140:143], v[76:79], v[100:103], v[140:143]
    v_mfma_f32_16x16x32_bf16 v[168:171], v[84:87], v[96:99], v[168:171]
    v_mfma_f32_16x16x32_bf16 v[172:175], v[84:87], v[100:103], v[172:175]
    v_perm_b32 v88, v5, v1, s30
    v_perm_b32 v89, v13, v9, s30
    v_perm_b32 v90, v21, v17, s30
    v_perm_b32 v91, v29, v25, s30
    v_perm_b32 v92, v5, v1, s31
    v_perm_b32 v93, v13, v9, s31
    v_perm_b32 v94, v21, v17, s31
    v_perm_b32 v95, v29, v25, s31
    v_perm_b32 v96, v37, v33, s30
    v_perm_b32 v97, v45, v41, s30
    v_perm_b32 v98, v53, v49, s30
    v_perm_b32 v99, v61, v57, s30
    v_perm_b32 v100, v37, v33, s31
    v_perm_b32 v101, v45, v41, s31
    v_perm_b32 v102, v53, v49, s31
    v_perm_b32 v103, v61, v57, s31
    v_mfma_f32_16x16x32_bf16 v[112:115], v[64:67], v[88:91], 0
    v_mfma_f32_16x16x32_bf16 v[116:119], v[64:67], v[92:95], 0
    v_mfma_f32_16x16x32_bf16 v[144:147], v[72:75], v[88:91], 0
    v_mfma_f32_16x16x32_bf16 v[148:151], v[72:75], v[92:95], 0
    v_mfma_f32_16x16x32_bf16 v[176:179], v[80:83], v[88:91], 0
    v_mfma_f32_16x16x32_bf16 v[180:183], v[80:83], v[92:95], 0
    v_mfma_f32_16x16x32_bf16 v[112:115], v[68:71], v[96:99], v[112:115]
    v_mfma_f32_16x16x32_bf16 v[116:119], v[68:71], v[100:103], v[116:119]
    v_mfma_f32_16x16x32_bf16 v[144:147], v[76:79], v[96:99], v[144:147]
    v_mfma_f32_16x16x32_bf16 v[148:151], v[76:79], v[100:103], v[148:151]
    v_mfma_f32_16x16x32_bf16 v[176:179], v[84:87], v[96:99], v[176:179]
    v_mfma_f32_16x16x32_bf16 v[180:183], v[84:87], v[100:103], v[180:183]
    v_perm_b32 v88, v6, v2, s30
    v_perm_b32 v89, v14, v10, s30
    v_perm_b32 v90, v22, v18, s30
    v_perm_b32 v91, v30, v26, s30
    v_perm_b32 v92, v6, v2, s31
    v_perm_b32 v93, v14, v10, s31
    v_perm_b32 v94, v22, v18, s31
    v_perm_b32 v95, v30, v26, s31
    v_perm_b32 v96, v38, v34, s30
    v_perm_b32 v97, v46, v42, s30
    v_perm_b32 v98, v54, v50, s30
    v_perm_b32 v99, v62, v58, s30
    v_perm_b32 v100, v38, v34, s31
    v_perm_b32 v101, v46, v42, s31
    v_perm_b32 v102, v54, v50, s31
    v_perm_b32 v103, v62, v58, s31
    v_mfma_f32_16x16x32_bf16 v[120:123], v[64:67], v[88:91], 0
    v_mfma_f32_16x16x32_bf16 v[124:127], v[64:67], v[92:95], 0
    v_mfma_f32_16x16x32_bf16 v[152:155], v[72:75], v[88:91], 0
    v_mfma_f32_16x16x32_bf16 v[156:159], v[72:75], v[92:95], 0
    v_mfma_f32_16x16x32_bf16 v[184:187], v[80:83], v[88:91], 0
    v_mfma_f32_16x16x32_bf16 v[188:191], v[80:83], v[92:95], 0
    v_mfma_f32_16x16x32_bf16 v[120:123], v[68:71], v[96:99], v[120:123]
    v_mfma_f32_16x16x32_bf16 v[124:127], v[68:71], v[100:103], v[124:127]
    v_mfma_f32_16x16x32_bf16 v[152:155], v[76:79], v[96:99], v[152:155]
    v_mfma_f32_16x16x32_bf16 v[156:159], v[76:79], v[100:103], v[156:159]
    v_mfma_f32_16x16x32_bf16 v[184:187], v[84:87], v[96:99], v[184:187]
    v_mfma_f32_16x16x32_bf16 v[188:191], v[84:87], v[100:103], v[188:191]
    v_perm_b32 v88, v7, v3, s30
    v_perm_b32 v89, v15, v11, s30
    v_perm_b32 v90, v23, v19, s30
    v_perm_b32 v91, v31, v27, s30
    v_perm_b32 v92, v7, v3, s31
    v_perm_b32 v93, v15, v11, s31
    v_perm_b32 v94, v23, v19, s31
    v_perm_b32 v95, v31, v27, s31
    v_perm_b32 v96, v39, v35, s30
    v_perm_b32 v97, v47, v43, s30
    v_perm_b32 v98, v55, v51, s30
    v_perm_b32 v99, v63, v59, s30
    v_perm_b32 v100, v39, v35, s31
    v_perm_b32 v101, v47, v43, s31
    v_perm_b32 v102, v55, v51, s31
    v_perm_b32 v103, v63, v59, s31
    v_mfma_f32_16x16x32_bf16 v[128:131], v[64:67], v[88:91], 0
    v_mfma_f32_16x16x32_bf16 v[132:135], v[64:67], v[92:95], 0
    v_mfma_f32_16x16x32_bf16 v[160:163], v[72:75], v[88:91], 0
    v_mfma_f32_16x16x32_bf16 v[164:167], v[72:75], v[92:95], 0
    v_mfma_f32_16x16x32_bf16 v[192:195], v[80:83], v[88:91], 0
    v_mfma_f32_16x16x32_bf16 v[196:199], v[80:83], v[92:95], 0
    v_mfma_f32_16x16x32_bf16 v[128:131], v[68:71], v[96:99], v[128:131]
    v_mfma_f32_16x16x32_bf16 v[132:135], v[68:71], v[100:103], v[132:135]
    v_mfma_f32_16x16x32_bf16 v[160:163], v[76:79], v[96:99], v[160:163]
    v_mfma_f32_16x16x32_bf16 v[164:167], v[76:79], v[100:103], v[164:167]
    v_mfma_f32_16x16x32_bf16 v[192:195], v[84:87], v[96:99], v[192:195]
    v_mfma_f32_16x16x32_bf16 v[196:199], v[84:87], v[100:103], v[196:199]
    s_nop 7
    v_mul_f32 v224, v104, v104
    v_mov_b32 v216, v104
    v_fmac_f32 v224, v105, v105
    v_add_f32 v216, v216, v105
    v_fmac_f32 v224, v106, v106
    v_add_f32 v216, v216, v106
    v_fmac_f32 v224, v107, v107
    v_add_f32 v216, v216, v107
    v_fmac_f32 v224, v136, v136
    v_add_f32 v216, v216, v136
    v_fmac_f32 v224, v137, v137
    v_add_f32 v216, v216, v137
    v_fmac_f32 v224, v138, v138
    v_add_f32 v216, v216, v138
    v_fmac_f32 v224, v139, v139
    v_add_f32 v216, v216, v139
    v_fmac_f32 v224, v168, v168
    v_add_f32 v216, v216, v168
    v_fmac_f32 v224, v169, v169
    v_add_f32 v216, v216, v169
    v_fmac_f32 v224, v170, v170
    v_add_f32 v216, v216, v170
    v_fmac_f32 v224, v171, v171
    v_add_f32 v216, v216, v171
    v_mul_f32 v225, v108, v108
    v_mov_b32 v217, v108
    v_fmac_f32 v225, v109, v109
    v_add_f32 v217, v217, v109
    v_fmac_f32 v225, v110, v110
    v_add_f32 v217, v217, v110
    v_fmac_f32 v225, v111, v111
    v_add_f32 v217, v217, v111
    v_fmac_f32 v225, v140, v140
    v_add_f32 v217, v217, v140
    v_fmac_f32 v225, v141, v141
    v_add_f32 v217, v217, v141
    v_fmac_f32 v225, v142, v142
    v_add_f32 v217, v217, v142
    v_fmac_f32 v225, v143, v143
    v_add_f32 v217, v217, v143
    v_fmac_f32 v225, v172, v172
    v_add_f32 v217, v217, v172
    v_fmac_f32 v225, v173, v173
    v_add_f32 v217, v217, v173
    v_fmac_f32 v225, v174, v174
    v_add_f32 v217, v217, v174
    v_fmac_f32 v225, v175, v175
    v_add_f32 v217, v217, v175
    v_mul_f32 v226, v112, v112
    v_mov_b32 v218, v112
    v_fmac_f32 v226, v113, v113
    v_add_f32 v218, v218, v113
    v_fmac_f32 v226, v114, v114
    v_add_f32 v218, v218, v114
    v_fmac_f32 v226, v115, v115
    v_add_f32 v218, v218, v115
    v_fmac_f32 v226, v144, v144
    v_add_f32 v218, v218, v144
    v_fmac_f32 v226, v145, v145
    v_add_f32 v218, v218, v145
    v_fmac_f32 v226, v146, v146
    v_add_f32 v218, v218, v146
    v_fmac_f32 v226, v147, v147
    v_add_f32 v218, v218, v147
    v_fmac_f32 v226, v176, v176
    v_add_f32 v218, v218, v176
    v_fmac_f32 v226, v177, v177
    v_add_f32 v218, v218, v177
    v_fmac_f32 v226, v178, v178
    v_add_f32 v218, v218, v178
    v_fmac_f32 v226, v179, v179
    v_add_f32 v218, v218, v179
    v_mul_f32 v227, v116, v116
    v_mov_b32 v219, v116
    v_fmac_f32 v227, v117, v117
    v_add_f32 v219, v219, v117
    v_fmac_f32 v227, v118, v118
    v_add_f32 v219, v219, v118
    v_fmac_f32 v227, v119, v119
    v_add_f32 v219, v219, v119
    v_fmac_f32 v227, v148, v148
    v_add_f32 v219, v219, v148
    v_fmac_f32 v227, v149, v149
    v_add_f32 v219, v219, v149
    v_fmac_f32 v227, v150, v150
    v_add_f32 v219, v219, v150
    v_fmac_f32 v227, v151, v151
    v_add_f32 v219, v219, v151
    v_fmac_f32 v227, v180, v180
    v_add_f32 v219, v219, v180
    v_fmac_f32 v227, v181, v181
    v_add_f32 v219, v219, v181
    v_fmac_f32 v227, v182, v182
    v_add_f32 v219, v219, v182
    v_fmac_f32 v227, v183, v183
    v_add_f32 v219, v219, v183
    v_mul_f32 v228, v120, v120
    v_mov_b32 v220, v120
    v_fmac_f32 v228, v121, v121
    v_add_f32 v220, v220, v121
    v_fmac_f32 v228, v122, v122
    v_add_f32 v220, v220, v122
    v_fmac_f32 v228, v123, v123
    v_add_f32 v220, v220, v123
    v_fmac_f32 v228, v152, v152
    v_add_f32 v220, v220, v152
    v_fmac_f32 v228, v153, v153
    v_add_f32 v220, v220, v153
    v_fmac_f32 v228, v154, v154
    v_add_f32 v220, v220, v154
    v_fmac_f32 v228, v155, v155
    v_add_f32 v220, v220, v155
    v_fmac_f32 v228, v184, v184
    v_add_f32 v220, v220, v184
    v_fmac_f32 v228, v185, v185
    v_add_f32 v220, v220, v185
    v_fmac_f32 v228, v186, v186
    v_add_f32 v220, v220, v186
    v_fmac_f32 v228, v187, v187
    v_add_f32 v220, v220, v187
    v_mul_f32 v229, v124, v124
    v_mov_b32 v221, v124
    v_fmac_f32 v229, v125, v125
    v_add_f32 v221, v221, v125
    v_fmac_f32 v229, v126, v126
    v_add_f32 v221, v221, v126
    v_fmac_f32 v229, v127, v127
    v_add_f32 v221, v221, v127
    v_fmac_f32 v229, v156, v156
    v_add_f32 v221, v221, v156
    v_fmac_f32 v229, v157, v157
    v_add_f32 v221, v221, v157
    v_fmac_f32 v229, v158, v158
    v_add_f32 v221, v221, v158
    v_fmac_f32 v229, v159, v159
    v_add_f32 v221, v221, v159
    v_fmac_f32 v229, v188, v188
    v_add_f32 v221, v221, v188
    v_fmac_f32 v229, v189, v189
    v_add_f32 v221, v221, v189
    v_fmac_f32 v229, v190, v190
    v_add_f32 v221, v221, v190
    v_fmac_f32 v229, v191, v191
    v_add_f32 v221, v221, v191
    v_mul_f32 v230, v128, v128
    v_mov_b32 v222, v128
    v_fmac_f32 v230, v129, v129
    v_add_f32 v222, v222, v129
    v_fmac_f32 v230, v130, v130
    v_add_f32 v222, v222, v130
    v_fmac_f32 v230, v131, v131
    v_add_f32 v222, v222, v131
    v_fmac_f32 v230, v160, v160
    v_add_f32 v222, v222, v160
    v_fmac_f32 v230, v161, v161
    v_add_f32 v222, v222, v161
    v_fmac_f32 v230, v162, v162
    v_add_f32 v222, v222, v162
    v_fmac_f32 v230, v163, v163
    v_add_f32 v222, v222, v163
    v_fmac_f32 v230, v192, v192
    v_add_f32 v222, v222, v192
    v_fmac_f32 v230, v193, v193
    v_add_f32 v222, v222, v193
    v_fmac_f32 v230, v194, v194
    v_add_f32 v222, v222, v194
    v_fmac_f32 v230, v195, v195
    v_add_f32 v222, v222, v195
    v_mul_f32 v231, v132, v132
    v_mov_b32 v223, v132
    v_fmac_f32 v231, v133, v133
    v_add_f32 v223, v223, v133
    v_fmac_f32 v231, v134, v134
    v_add_f32 v223, v223, v134
    v_fmac_f32 v231, v135, v135
    v_add_f32 v223, v223, v135
    v_fmac_f32 v231, v164, v164
    v_add_f32 v223, v223, v164
    v_fmac_f32 v231, v165, v165
    v_add_f32 v223, v223, v165
    v_fmac_f32 v231, v166, v166
    v_add_f32 v223, v223, v166
    v_fmac_f32 v231, v167, v167
    v_add_f32 v223, v223, v167
    v_fmac_f32 v231, v196, v196
    v_add_f32 v223, v223, v196
    v_fmac_f32 v231, v197, v197
    v_add_f32 v223, v223, v197
    v_fmac_f32 v231, v198, v198
    v_add_f32 v223, v223, v198
    v_fmac_f32 v231, v199, v199
    v_add_f32 v223, v223, v199
    s_branch L_k45_red
L_k45_zero:
    s_waitcnt vmcnt(0) lgkmcnt(0)
    v_mov_b32 v216, 0
    v_mov_b32 v224, 0
    v_mov_b32 v217, 0
    v_mov_b32 v225, 0
    v_mov_b32 v218, 0
    v_mov_b32 v226, 0
    v_mov_b32 v219, 0
    v_mov_b32 v227, 0
    v_mov_b32 v220, 0
    v_mov_b32 v228, 0
    v_mov_b32 v221, 0
    v_mov_b32 v229, 0
    v_mov_b32 v222, 0
    v_mov_b32 v230, 0
    v_mov_b32 v223, 0
    v_mov_b32 v231, 0
L_k45_red:
    s_lshl_b32 s25, s10, 12
    v_lshlrev_b32 v204, 10, v202
    v_lshl_add_u32 v204, v201, 5, v204
    v_add_u32 v204, s25, v204
    ds_write_b128 v204, v[216:219] offset:8192
    ds_write_b128 v204, v[220:223] offset:8208
    ds_write_b128 v204, v[224:227] offset:8704
    ds_write_b128 v204, v[228:231] offset:8720
L_k45_red2:
    s_waitcnt lgkmcnt(0)
    s_barrier
    s_mul_i32 s24, s11, 112
    s_mul_i32 s25, s13, 28
    s_add_u32 s24, s24, s25
    s_lshl_b32 s26, s24, 10
    s_add_u32 s26, s26, 146800640
    s_cmp_ge_u32 s10, 6
    s_cbranch_scc1 L_k45_sumdone
    s_cmp_lt_u32 s10, 4
    s_cbranch_scc1 L_k45_red4
    s_lshl_b32 s25, s10, 13
    v_lshlrev_b32 v205, 4, v200
    v_add_u32 v205, s25, v205
    ds_write_b32 v205, v107 offset:33792
    ds_write_b32 v205, v139 offset:33796
    ds_write_b32 v205, v171 offset:33800
    ds_write_b32 v205, v111 offset:34816
    ds_write_b32 v205, v143 offset:34820
    ds_write_b32 v205, v175 offset:34824
    ds_write_b32 v205, v115 offset:35840
    ds_write_b32 v205, v147 offset:35844
    ds_write_b32 v205, v179 offset:35848
    ds_write_b32 v205, v119 offset:36864
    ds_write_b32 v205, v151 offset:36868
    ds_write_b32 v205, v183 offset:36872
    ds_write_b32 v205, v123 offset:37888
    ds_write_b32 v205, v155 offset:37892
    ds_write_b32 v205, v187 offset:37896
    ds_write_b32 v205, v127 offset:38912
    ds_write_b32 v205, v159 offset:38916
    ds_write_b32 v205, v191 offset:38920
    ds_write_b32 v205, v131 offset:39936
    ds_write_b32 v205, v163 offset:39940
    ds_write_b32 v205, v195 offset:39944
    ds_write_b32 v205, v135 offset:40960
    ds_write_b32 v205, v167 offset:40964
    ds_write_b32 v205, v199 offset:40968
    s_branch L_k45_sumdone
L_k45_red4:
    ds_read_b32 v16, v214 offset:8192
    ds_read_b32 v17, v214 offset:9216
    ds_read_b32 v18, v214 offset:10240
    ds_read_b32 v19, v214 offset:11264
    ds_read_b32 v20, v214 offset:12288
    ds_read_b32 v21, v214 offset:13312
    ds_read_b32 v22, v214 offset:14336
    ds_read_b32 v23, v214 offset:15360
    ds_read_b32 v24, v214 offset:16384
    ds_read_b32 v25, v214 offset:17408
    ds_read_b32 v26, v214 offset:18432
    ds_read_b32 v27, v214 offset:19456
    ds_read_b32 v28, v214 offset:20480
    ds_read_b32 v29, v214 offset:21504
    ds_read_b32 v30, v214 offset:22528
    ds_read_b32 v31, v214 offset:23552
    ds_read_b32 v32, v214 offset:24576
    ds_read_b32 v33, v214 offset:25600
    ds_read_b32 v34, v214 offset:26624
    ds_read_b32 v35, v214 offset:27648
    ds_read_b32 v36, v214 offset:28672
    ds_read_b32 v37, v214 offset:29696
    ds_read_b32 v38, v214 offset:30720
    ds_read_b32 v39, v214 offset:31744
    s_waitcnt lgkmcnt(0)
    v_add_f32 v16, v16, v17
    v_add_f32 v18, v18, v19
    v_add_f32 v20, v20, v21
    v_add_f32 v22, v22, v23
    v_add_f32 v24, v24, v25
    v_add_f32 v26, v26, v27
    v_add_f32 v28, v28, v29
    v_add_f32 v30, v30, v31
    v_add_f32 v32, v32, v33
    v_add_f32 v34, v34, v35
    v_add_f32 v36, v36, v37
    v_add_f32 v38, v38, v39
    v_add_f32 v16, v16, v18
    v_add_f32 v20, v20, v22
    v_add_f32 v24, v24, v26
    v_add_f32 v28, v28, v30
    v_add_f32 v32, v32, v34
    v_add_f32 v36, v36, v38
    v_add_f32 v16, v16, v20
    v_add_f32 v24, v24, v28
    v_add_f32 v32, v32, v36
    v_add_f32 v16, v16, v24
    v_add_f32 v16, v16, v32
    s_lshl_b32 s24, s12, 10
    s_add_u32 s24, s24, s26
    buffer_store_dword v16, v214, s[16:19], s24 offen sc1
    s_lshl_b32 s25, s10, 13
    v_lshlrev_b32 v205, 4, v200
    v_add_u32 v205, s25, v205
    ds_write_b32 v205, v107 offset:33792
    ds_write_b32 v205, v139 offset:33796
    ds_write_b32 v205, v171 offset:33800
    ds_write_b32 v205, v111 offset:34816
    ds_write_b32 v205, v143 offset:34820
    ds_write_b32 v205, v175 offset:34824
    ds_write_b32 v205, v115 offset:35840
    ds_write_b32 v205, v147 offset:35844
    ds_write_b32 v205, v179 offset:35848
    ds_write_b32 v205, v119 offset:36864
    ds_write_b32 v205, v151 offset:36868
    ds_write_b32 v205, v183 offset:36872
    ds_write_b32 v205, v123 offset:37888
    ds_write_b32 v205, v155 offset:37892
    ds_write_b32 v205, v187 offset:37896
    ds_write_b32 v205, v127 offset:38912
    ds_write_b32 v205, v159 offset:38916
    ds_write_b32 v205, v191 offset:38920
    ds_write_b32 v205, v131 offset:39936
    ds_write_b32 v205, v163 offset:39940
    ds_write_b32 v205, v195 offset:39944
    ds_write_b32 v205, v135 offset:40960
    ds_write_b32 v205, v167 offset:40964
    ds_write_b32 v205, v199 offset:40968
    s_mov_b32 s33, 16384
L_k45_poll:
    s_mov_b32 s27, s26
    buffer_load_dword v0, v214, s[16:19], s27 offen offset:0 sc1
    buffer_load_dword v1, v214, s[16:19], s27 offen offset:1024 sc1
    buffer_load_dword v2, v214, s[16:19], s27 offen offset:2048 sc1
    buffer_load_dword v3, v214, s[16:19], s27 offen offset:3072 sc1
    s_add_u32 s27, s27, 4096
    buffer_load_dword v4, v214, s[16:19], s27 offen offset:0 sc1
    buffer_load_dword v5, v214, s[16:19], s27 offen offset:1024 sc1
    buffer_load_dword v6, v214, s[16:19], s27 offen offset:2048 sc1
    buffer_load_dword v7, v214, s[16:19], s27 offen offset:3072 sc1
    s_add_u32 s27, s27, 4096
    buffer_load_dword v8, v214, s[16:19], s27 offen offset:0 sc1
    buffer_load_dword v9, v214, s[16:19], s27 offen offset:1024 sc1
    buffer_load_dword v10, v214, s[16:19], s27 offen offset:2048 sc1
    buffer_load_dword v11, v214, s[16:19], s27 offen offset:3072 sc1
    s_add_u32 s27, s27, 4096
    buffer_load_dword v12, v214, s[16:19], s27 offen offset:0 sc1
    buffer_load_dword v13, v214, s[16:19], s27 offen offset:1024 sc1
    buffer_load_dword v14, v214, s[16:19], s27 offen offset:2048 sc1
    buffer_load_dword v15, v214, s[16:19], s27 offen offset:3072 sc1
    s_add_u32 s27, s27, 4096
    buffer_load_dword v16, v214, s[16:19], s27 offen offset:0 sc1
    buffer_load_dword v17, v214, s[16:19], s27 offen offset:1024 sc1
    buffer_load_dword v18, v214, s[16:19], s27 offen offset:2048 sc1
    buffer_load_dword v19, v214, s[16:19], s27 offen offset:3072 sc1
    s_add_u32 s27, s27, 4096
    buffer_load_dword v20, v214, s[16:19], s27 offen offset:0 sc1
    buffer_load_dword v21, v214, s[16:19], s27 offen offset:1024 sc1
    buffer_load_dword v22, v214, s[16:19], s27 offen offset:2048 sc1
    buffer_load_dword v23, v214, s[16:19], s27 offen offset:3072 sc1
    s_add_u32 s27, s27, 4096
    buffer_load_dword v24, v214, s[16:19], s27 offen offset:0 sc1
    buffer_load_dword v25, v214, s[16:19], s27 offen offset:1024 sc1
    buffer_load_dword v26, v214, s[16:19], s27 offen offset:2048 sc1
    buffer_load_dword v27, v214, s[16:19], s27 offen offset:3072 sc1
    s_waitcnt vmcnt(0)
    v_max3_u32 v32, v0, v1, v2
    v_max3_u32 v32, v32, v3, v4
    v_max3_u32 v32, v32, v5, v6
    v_max3_u32 v32, v32, v7, v8
    v_max3_u32 v32, v32, v9, v10
    v_max3_u32 v32, v32, v11, v12
    v_max3_u32 v32, v32, v13, v14
    v_max3_u32 v32, v32, v15, v16
    v_max3_u32 v32, v32, v17, v18
    v_max3_u32 v32, v32, v19, v20
    v_max3_u32 v32, v32, v21, v22
    v_max3_u32 v32, v32, v23, v24
    v_max3_u32 v32, v32, v25, v26
    v_max_u32 v32, v32, v27
    v_cmp_eq_u32 vcc, -1, v32
    s_nop 3
    s_cmp_eq_u64 vcc, 0
    s_cbranch_scc1 L_k45_got
    s_sub_u32 s33, s33, 1
    s_cmp_eq_u32 s33, 0
    s_cbranch_scc1 L_k45_got
    s_sleep 2
    s_branch L_k45_poll
L_k45_got:
    v_add_f32 v0, v0, v1
    v_add_f32 v2, v2, v3
    v_add_f32 v4, v4, v5
    v_add_f32 v6, v6, v7
    v_add_f32 v8, v8, v9
    v_add_f32 v10, v10, v11
    v_add_f32 v12, v12, v13
    v_add_f32 v14, v14, v15
    v_add_f32 v16, v16, v17
    v_add_f32 v18, v18, v19
    v_add_f32 v20, v20, v21
    v_add_f32 v22, v22, v23
    v_add_f32 v24, v24, v25
    v_add_f32 v26, v26, v27
    v_add_f32 v0, v0, v2
    v_add_f32 v4, v4, v6
    v_add_f32 v8, v8, v10
    v_add_f32 v12, v12, v14
    v_add_f32 v16, v16, v18
    v_add_f32 v20, v20, v22
    v_add_f32 v24, v24, v26
    v_add_f32 v0, v0, v4
    v_add_f32 v8, v8, v12
    v_add_f32 v16, v16, v20
    v_add_f32 v0, v0, v8
    v_add_f32 v16, v16, v24
    v_add_f32 v0, v0, v16
    ds_write_b32 v214, v0 offset:32768
L_k45_sumdone:
    s_waitcnt lgkmcnt(0)
    s_barrier
    s_cmp_lt_u32 s10, 6
    s_cbranch_scc1 L_k45_nohread
    s_waitcnt vmcnt(0)
    s_sub_u32 s25, s10, 6
    s_mul_i32 s25, s25, 3
    s_lshl_b32 s25, s25, 13
    v_lshlrev_b32 v205, 4, v200
    v_add_u32 v205, s25, v205
    ds_read_b96 v[104:106], v205 offset:33792
    ds_read_b96 v[108:110], v205 offset:34816
    ds_read_b96 v[112:114], v205 offset:35840
    ds_read_b96 v[116:118], v205 offset:36864
    ds_read_b96 v[120:122], v205 offset:37888
    ds_read_b96 v[124:126], v205 offset:38912
    ds_read_b96 v[128:130], v205 offset:39936
    ds_read_b96 v[132:134], v205 offset:40960
    s_waitcnt lgkmcnt(0)
    ds_read_b96 v[136:138], v205 offset:41984
    ds_read_b96 v[140:142], v205 offset:43008
    ds_read_b96 v[144:146], v205 offset:44032
    ds_read_b96 v[148:150], v205 offset:45056
    ds_read_b96 v[152:154], v205 offset:46080
    ds_read_b96 v[156:158], v205 offset:47104
    ds_read_b96 v[160:162], v205 offset:48128
    ds_read_b96 v[164:166], v205 offset:49152
    s_waitcnt lgkmcnt(0)
    ds_read_b96 v[168:170], v205 offset:50176
    ds_read_b96 v[172:174], v205 offset:51200
    ds_read_b96 v[176:178], v205 offset:52224
    ds_read_b96 v[180:182], v205 offset:53248
    ds_read_b96 v[184:186], v205 offset:54272
    ds_read_b96 v[188:190], v205 offset:55296
    ds_read_b96 v[192:194], v205 offset:56320
    ds_read_b96 v[196:198], v205 offset:57344
L_k45_nohread:
    v_lshlrev_b32 v210, 5, v201
    ds_read_b128 v[44:47], v210 offset:32768
    ds_read_b128 v[48:51], v210 offset:32784
    ds_read_b128 v[52:55], v210 offset:33280
    ds_read_b128 v[56:59], v210 offset:33296
    s_mov_b32 s24, 0x39035177
    s_mov_b32 s25, 0x3727c5ac
    s_waitcnt vmcnt(0) lgkmcnt(0)
    v_mul_f32 v44, s24, v44
    v_mul_f32 v52, s24, v52
    v_fma_f32 v52, -v44, v44, v52
    v_max_f32 v52, 0, v52
    v_add_f32 v52, s25, v52
    v_rsq_f32 v52, v52
    v_lshlrev_b32 v216, 16, v232
    v_lshlrev_b32 v224, 16, v236
    v_mul_f32 v216, v216, v52
    v_fma_f32 v224, -v44, v216, v224
    v_mul_f32 v45, s24, v45
    v_mul_f32 v53, s24, v53
    v_fma_f32 v53, -v45, v45, v53
    v_max_f32 v53, 0, v53
    v_add_f32 v53, s25, v53
    v_rsq_f32 v53, v53
    v_and_b32 v217, 0xffff0000, v232
    v_and_b32 v225, 0xffff0000, v236
    v_mul_f32 v217, v217, v53
    v_fma_f32 v225, -v45, v217, v225
    v_mul_f32 v46, s24, v46
    v_mul_f32 v54, s24, v54
    v_fma_f32 v54, -v46, v46, v54
    v_max_f32 v54, 0, v54
    v_add_f32 v54, s25, v54
    v_rsq_f32 v54, v54
    v_lshlrev_b32 v218, 16, v233
    v_lshlrev_b32 v226, 16, v237
    v_mul_f32 v218, v218, v54
    v_fma_f32 v226, -v46, v218, v226
    v_mul_f32 v47, s24, v47
    v_mul_f32 v55, s24, v55
    v_fma_f32 v55, -v47, v47, v55
    v_max_f32 v55, 0, v55
    v_add_f32 v55, s25, v55
    v_rsq_f32 v55, v55
    v_and_b32 v219, 0xffff0000, v233
    v_and_b32 v227, 0xffff0000, v237
    v_mul_f32 v219, v219, v55
    v_fma_f32 v227, -v47, v219, v227
    v_mul_f32 v48, s24, v48
    v_mul_f32 v56, s24, v56
    v_fma_f32 v56, -v48, v48, v56
    v_max_f32 v56, 0, v56
    v_add_f32 v56, s25, v56
    v_rsq_f32 v56, v56
    v_lshlrev_b32 v220, 16, v234
    v_lshlrev_b32 v228, 16, v238
    v_mul_f32 v220, v220, v56
    v_fma_f32 v228, -v48, v220, v228
    v_mul_f32 v49, s24, v49
    v_mul_f32 v57, s24, v57
    v_fma_f32 v57, -v49, v49, v57
    v_max_f32 v57, 0, v57
    v_add_f32 v57, s25, v57
    v_rsq_f32 v57, v57
    v_and_b32 v221, 0xffff0000, v234
    v_and_b32 v229, 0xffff0000, v238
    v_mul_f32 v221, v221, v57
    v_fma_f32 v229, -v49, v221, v229
    v_mul_f32 v50, s24, v50
    v_mul_f32 v58, s24, v58
    v_fma_f32 v58, -v50, v50, v58
    v_max_f32 v58, 0, v58
    v_add_f32 v58, s25, v58
    v_rsq_f32 v58, v58
    v_lshlrev_b32 v222, 16, v235
    v_lshlrev_b32 v230, 16, v239
    v_mul_f32 v222, v222, v58
    v_fma_f32 v230, -v50, v222, v230
    v_mul_f32 v51, s24, v51
    v_mul_f32 v59, s24, v59
    v_fma_f32 v59, -v51, v51, v59
    v_max_f32 v59, 0, v59
    v_add_f32 v59, s25, v59
    v_rsq_f32 v59, v59
    v_and_b32 v223, 0xffff0000, v235
    v_and_b32 v231, 0xffff0000, v239
    v_mul_f32 v223, v223, v59
    v_fma_f32 v231, -v51, v223, v231
    s_mul_i32 s24, s11, 8176640
    s_add_u32 s28, s28, s24
    s_addc_u32 s29, s29, 0
    s_mov_b32 s32, s28
    s_and_b32 s33, s29, 0xffff
    s_mov_b32 s34, 8176640
    s_mov_b32 s35, 0x00020000
    s_lshl_b32 s25, s13, 8
    v_lshlrev_b32 v210, 12, v202
    v_lshl_add_u32 v210, v201, 4, v210
    v_add_u32 v210, s25, v210
    s_mov_b32 s26, 0xbdd2d3e8
    v_mov_b32 v211, 0xc0135761
    s_cmp_ge_u32 s10, 6
    s_cbranch_scc1 L_k45_hoff
    s_cmp_ge_u32 s14, 167
    s_cbranch_scc1 L_k45_fin
    s_mul_i32 s24, s14, 49152
    s_add_u32 s52, s24, 0
    s_add_u32 s53, s24, 1024
    s_add_u32 s54, s24, 2048
    s_add_u32 s55, s24, 16384
    s_add_u32 s56, s24, 17408
    s_add_u32 s57, s24, 18432
    s_add_u32 s58, s24, 32768
    s_add_u32 s59, s24, 33792
    s_add_u32 s60, s24, 34816
    s_branch L_k45_gelu
L_k45_hoff:
    s_sub_u32 s25, s10, 6
    s_mul_i32 s25, s25, 3
    s_mul_i32 s24, s12, 6
    s_add_u32 s24, s24, s25
    s_mul_i32 s24, s24, 49152
    s_add_u32 s52, s24, 3072
    s_add_u32 s53, s24, 19456
    s_add_u32 s54, s24, 35840
    s_add_u32 s55, s24, 52224
    s_add_u32 s56, s24, 68608
    s_add_u32 s57, s24, 84992
    s_add_u32 s58, s24, 101376
    s_add_u32 s59, s24, 117760
    s_add_u32 s60, s24, 134144
L_k45_gelu:
    v_fma_f32 v104, v104, v216, v224
    v_fma_f32 v108, v108, v217, v225
    v_fma_f32 v112, v112, v218, v226
    v_fma_f32 v116, v116, v219, v227
    v_fma_f32 v120, v120, v220, v228
    v_fma_f32 v124, v124, v221, v229
    v_fma_f32 v128, v128, v222, v230
    v_fma_f32 v132, v132, v223, v231
    v_mul_f32 v0, v104, v104
    v_mul_f32 v1, v108, v108
    v_mul_f32 v2, v112, v112
    v_mul_f32 v3, v116, v116
    v_mul_f32 v4, v120, v120
    v_mul_f32 v5, v124, v124
    v_mul_f32 v6, v128, v128
    v_mul_f32 v7, v132, v132
    v_fma_f32 v0, v0, s26, v211
    v_fma_f32 v1, v1, s26, v211
    v_fma_f32 v2, v2, s26, v211
    v_fma_f32 v3, v3, s26, v211
    v_fma_f32 v4, v4, s26, v211
    v_fma_f32 v5, v5, s26, v211
    v_fma_f32 v6, v6, s26, v211
    v_fma_f32 v7, v7, s26, v211
    v_mul_f32 v0, v0, v104
    v_mul_f32 v1, v1, v108
    v_mul_f32 v2, v2, v112
    v_mul_f32 v3, v3, v116
    v_mul_f32 v4, v4, v120
    v_mul_f32 v5, v5, v124
    v_mul_f32 v6, v6, v128
    v_mul_f32 v7, v7, v132
    v_exp_f32 v0, v0
    v_exp_f32 v1, v1
    v_exp_f32 v2, v2
    v_exp_f32 v3, v3
    v_exp_f32 v4, v4
    v_exp_f32 v5, v5
    v_exp_f32 v6, v6
    v_exp_f32 v7, v7
    v_add_f32 v0, 1.0, v0
    v_add_f32 v1, 1.0, v1
    v_add_f32 v2, 1.0, v2
    v_add_f32 v3, 1.0, v3
    v_add_f32 v4, 1.0, v4
    v_add_f32 v5, 1.0, v5
    v_add_f32 v6, 1.0, v6
    v_add_f32 v7, 1.0, v7
    v_rcp_f32 v0, v0
    v_rcp_f32 v1, v1
    v_rcp_f32 v2, v2
    v_rcp_f32 v3, v3
    v_rcp_f32 v4, v4
    v_rcp_f32 v5, v5
    v_rcp_f32 v6, v6
    v_rcp_f32 v7, v7
    v_mul_f32 v0, v0, v104
    v_mul_f32 v1, v1, v108
    v_mul_f32 v2, v2, v112
    v_mul_f32 v3, v3, v116
    v_mul_f32 v4, v4, v120
    v_mul_f32 v5, v5, v124
    v_mul_f32 v6, v6, v128
    v_mul_f32 v7, v7, v132
    v_cvt_pk_bf16_f32 v16, v0, v1
    v_cvt_pk_bf16_f32 v17, v2, v3
    v_cvt_pk_bf16_f32 v18, v4, v5
    v_cvt_pk_bf16_f32 v19, v6, v7
    buffer_store_dwordx4 v[16:19], v210, s[32:35], s52 offen sc1
    v_fma_f32 v105, v105, v216, v224
    v_fma_f32 v109, v109, v217, v225
    v_fma_f32 v113, v113, v218, v226
    v_fma_f32 v117, v117, v219, v227
    v_fma_f32 v121, v121, v220, v228
    v_fma_f32 v125, v125, v221, v229
    v_fma_f32 v129, v129, v222, v230
    v_fma_f32 v133, v133, v223, v231
    v_mul_f32 v0, v105, v105
    v_mul_f32 v1, v109, v109
    v_mul_f32 v2, v113, v113
    v_mul_f32 v3, v117, v117
    v_mul_f32 v4, v121, v121
    v_mul_f32 v5, v125, v125
    v_mul_f32 v6, v129, v129
    v_mul_f32 v7, v133, v133
    v_fma_f32 v0, v0, s26, v211
    v_fma_f32 v1, v1, s26, v211
    v_fma_f32 v2, v2, s26, v211
    v_fma_f32 v3, v3, s26, v211
    v_fma_f32 v4, v4, s26, v211
    v_fma_f32 v5, v5, s26, v211
    v_fma_f32 v6, v6, s26, v211
    v_fma_f32 v7, v7, s26, v211
    v_mul_f32 v0, v0, v105
    v_mul_f32 v1, v1, v109
    v_mul_f32 v2, v2, v113
    v_mul_f32 v3, v3, v117
    v_mul_f32 v4, v4, v121
    v_mul_f32 v5, v5, v125
    v_mul_f32 v6, v6, v129
    v_mul_f32 v7, v7, v133
    v_exp_f32 v0, v0
    v_exp_f32 v1, v1
    v_exp_f32 v2, v2
    v_exp_f32 v3, v3
    v_exp_f32 v4, v4
    v_exp_f32 v5, v5
    v_exp_f32 v6, v6
    v_exp_f32 v7, v7
    v_add_f32 v0, 1.0, v0
    v_add_f32 v1, 1.0, v1
    v_add_f32 v2, 1.0, v2
    v_add_f32 v3, 1.0, v3
    v_add_f32 v4, 1.0, v4
    v_add_f32 v5, 1.0, v5
    v_add_f32 v6, 1.0, v6
    v_add_f32 v7, 1.0, v7
    v_rcp_f32 v0, v0
    v_rcp_f32 v1, v1
    v_rcp_f32 v2, v2
    v_rcp_f32 v3, v3
    v_rcp_f32 v4, v4
    v_rcp_f32 v5, v5
    v_rcp_f32 v6, v6
    v_rcp_f32 v7, v7
    v_mul_f32 v0, v0, v105
    v_mul_f32 v1, v1, v109
    v_mul_f32 v2, v2, v113
    v_mul_f32 v3, v3, v117
    v_mul_f32 v4, v4, v121
    v_mul_f32 v5, v5, v125
    v_mul_f32 v6, v6, v129
    v_mul_f32 v7, v7, v133
    v_cvt_pk_bf16_f32 v20, v0, v1
    v_cvt_pk_bf16_f32 v21, v2, v3
    v_cvt_pk_bf16_f32 v22, v4, v5
    v_cvt_pk_bf16_f32 v23, v6, v7
    buffer_store_dwordx4 v[20:23], v210, s[32:35], s53 offen sc1
    v_fma_f32 v106, v106, v216, v224
    v_fma_f32 v110, v110, v217, v225
    v_fma_f32 v114, v114, v218, v226
    v_fma_f32 v118, v118, v219, v227
    v_fma_f32 v122, v122, v220, v228
    v_fma_f32 v126, v126, v221, v229
    v_fma_f32 v130, v130, v222, v230
    v_fma_f32 v134, v134, v223, v231
    v_mul_f32 v0, v106, v106
    v_mul_f32 v1, v110, v110
    v_mul_f32 v2, v114, v114
    v_mul_f32 v3, v118, v118
    v_mul_f32 v4, v122, v122
    v_mul_f32 v5, v126, v126
    v_mul_f32 v6, v130, v130
    v_mul_f32 v7, v134, v134
    v_fma_f32 v0, v0, s26, v211
    v_fma_f32 v1, v1, s26, v211
    v_fma_f32 v2, v2, s26, v211
    v_fma_f32 v3, v3, s26, v211
    v_fma_f32 v4, v4, s26, v211
    v_fma_f32 v5, v5, s26, v211
    v_fma_f32 v6, v6, s26, v211
    v_fma_f32 v7, v7, s26, v211
    v_mul_f32 v0, v0, v106
    v_mul_f32 v1, v1, v110
    v_mul_f32 v2, v2, v114
    v_mul_f32 v3, v3, v118
    v_mul_f32 v4, v4, v122
    v_mul_f32 v5, v5, v126
    v_mul_f32 v6, v6, v130
    v_mul_f32 v7, v7, v134
    v_exp_f32 v0, v0
    v_exp_f32 v1, v1
    v_exp_f32 v2, v2
    v_exp_f32 v3, v3
    v_exp_f32 v4, v4
    v_exp_f32 v5, v5
    v_exp_f32 v6, v6
    v_exp_f32 v7, v7
    v_add_f32 v0, 1.0, v0
    v_add_f32 v1, 1.0, v1
    v_add_f32 v2, 1.0, v2
    v_add_f32 v3, 1.0, v3
    v_add_f32 v4, 1.0, v4
    v_add_f32 v5, 1.0, v5
    v_add_f32 v6, 1.0, v6
    v_add_f32 v7, 1.0, v7
    v_rcp_f32 v0, v0
    v_rcp_f32 v1, v1
    v_rcp_f32 v2, v2
    v_rcp_f32 v3, v3
    v_rcp_f32 v4, v4
    v_rcp_f32 v5, v5
    v_rcp_f32 v6, v6
    v_rcp_f32 v7, v7
    v_mul_f32 v0, v0, v106
    v_mul_f32 v1, v1, v110
    v_mul_f32 v2, v2, v114
    v_mul_f32 v3, v3, v118
    v_mul_f32 v4, v4, v122
    v_mul_f32 v5, v5, v126
    v_mul_f32 v6, v6, v130
    v_mul_f32 v7, v7, v134
    v_cvt_pk_bf16_f32 v24, v0, v1
    v_cvt_pk_bf16_f32 v25, v2, v3
    v_cvt_pk_bf16_f32 v26, v4, v5
    v_cvt_pk_bf16_f32 v27, v6, v7
    buffer_store_dwordx4 v[24:27], v210, s[32:35], s54 offen sc1
    v_fma_f32 v136, v136, v216, v224
    v_fma_f32 v140, v140, v217, v225
    v_fma_f32 v144, v144, v218, v226
    v_fma_f32 v148, v148, v219, v227
    v_fma_f32 v152, v152, v220, v228
    v_fma_f32 v156, v156, v221, v229
    v_fma_f32 v160, v160, v222, v230
    v_fma_f32 v164, v164, v223, v231
    v_mul_f32 v0, v136, v136
    v_mul_f32 v1, v140, v140
    v_mul_f32 v2, v144, v144
    v_mul_f32 v3, v148, v148
    v_mul_f32 v4, v152, v152
    v_mul_f32 v5, v156, v156
    v_mul_f32 v6, v160, v160
    v_mul_f32 v7, v164, v164
    v_fma_f32 v0, v0, s26, v211
    v_fma_f32 v1, v1, s26, v211
    v_fma_f32 v2, v2, s26, v211
    v_fma_f32 v3, v3, s26, v211
    v_fma_f32 v4, v4, s26, v211
    v_fma_f32 v5, v5, s26, v211
    v_fma_f32 v6, v6, s26, v211
    v_fma_f32 v7, v7, s26, v211
    v_mul_f32 v0, v0, v136
    v_mul_f32 v1, v1, v140
    v_mul_f32 v2, v2, v144
    v_mul_f32 v3, v3, v148
    v_mul_f32 v4, v4, v152
    v_mul_f32 v5, v5, v156
    v_mul_f32 v6, v6, v160
    v_mul_f32 v7, v7, v164
    v_exp_f32 v0, v0
    v_exp_f32 v1, v1
    v_exp_f32 v2, v2
    v_exp_f32 v3, v3
    v_exp_f32 v4, v4
    v_exp_f32 v5, v5
    v_exp_f32 v6, v6
    v_exp_f32 v7, v7
    v_add_f32 v0, 1.0, v0
    v_add_f32 v1, 1.0, v1
    v_add_f32 v2, 1.0, v2
    v_add_f32 v3, 1.0, v3
    v_add_f32 v4, 1.0, v4
    v_add_f32 v5, 1.0, v5
    v_add_f32 v6, 1.0, v6
    v_add_f32 v7, 1.0, v7
    v_rcp_f32 v0, v0
    v_rcp_f32 v1, v1
    v_rcp_f32 v2, v2
    v_rcp_f32 v3, v3
    v_rcp_f32 v4, v4
    v_rcp_f32 v5, v5
    v_rcp_f32 v6, v6
    v_rcp_f32 v7, v7
    v_mul_f32 v0, v0, v136
    v_mul_f32 v1, v1, v140
    v_mul_f32 v2, v2, v144
    v_mul_f32 v3, v3, v148
    v_mul_f32 v4, v4, v152
    v_mul_f32 v5, v5, v156
    v_mul_f32 v6, v6, v160
    v_mul_f32 v7, v7, v164
    v_cvt_pk_bf16_f32 v28, v0, v1
    v_cvt_pk_bf16_f32 v29, v2, v3
    v_cvt_pk_bf16_f32 v30, v4, v5
    v_cvt_pk_bf16_f32 v31, v6, v7
    buffer_store_dwordx4 v[28:31], v210, s[32:35], s55 offen sc1
    v_fma_f32 v137, v137, v216, v224
    v_fma_f32 v141, v141, v217, v225
    v_fma_f32 v145, v145, v218, v226
    v_fma_f32 v149, v149, v219, v227
    v_fma_f32 v153, v153, v220, v228
    v_fma_f32 v157, v157, v221, v229
    v_fma_f32 v161, v161, v222, v230
    v_fma_f32 v165, v165, v223, v231
    v_mul_f32 v0, v137, v137
    v_mul_f32 v1, v141, v141
    v_mul_f32 v2, v145, v145
    v_mul_f32 v3, v149, v149
    v_mul_f32 v4, v153, v153
    v_mul_f32 v5, v157, v157
    v_mul_f32 v6, v161, v161
    v_mul_f32 v7, v165, v165
    v_fma_f32 v0, v0, s26, v211
    v_fma_f32 v1, v1, s26, v211
    v_fma_f32 v2, v2, s26, v211
    v_fma_f32 v3, v3, s26, v211
    v_fma_f32 v4, v4, s26, v211
    v_fma_f32 v5, v5, s26, v211
    v_fma_f32 v6, v6, s26, v211
    v_fma_f32 v7, v7, s26, v211
    v_mul_f32 v0, v0, v137
    v_mul_f32 v1, v1, v141
    v_mul_f32 v2, v2, v145
    v_mul_f32 v3, v3, v149
    v_mul_f32 v4, v4, v153
    v_mul_f32 v5, v5, v157
    v_mul_f32 v6, v6, v161
    v_mul_f32 v7, v7, v165
    v_exp_f32 v0, v0
    v_exp_f32 v1, v1
    v_exp_f32 v2, v2
    v_exp_f32 v3, v3
    v_exp_f32 v4, v4
    v_exp_f32 v5, v5
    v_exp_f32 v6, v6
    v_exp_f32 v7, v7
    v_add_f32 v0, 1.0, v0
    v_add_f32 v1, 1.0, v1
    v_add_f32 v2, 1.0, v2
    v_add_f32 v3, 1.0, v3
    v_add_f32 v4, 1.0, v4
    v_add_f32 v5, 1.0, v5
    v_add_f32 v6, 1.0, v6
    v_add_f32 v7, 1.0, v7
    v_rcp_f32 v0, v0
    v_rcp_f32 v1, v1
    v_rcp_f32 v2, v2
    v_rcp_f32 v3, v3
    v_rcp_f32 v4, v4
    v_rcp_f32 v5, v5
    v_rcp_f32 v6, v6
    v_rcp_f32 v7, v7
    v_mul_f32 v0, v0, v137
    v_mul_f32 v1, v1, v141
    v_mul_f32 v2, v2, v145
    v_mul_f32 v3, v3, v149
    v_mul_f32 v4, v4, v153
    v_mul_f32 v5, v5, v157
    v_mul_f32 v6, v6, v161
    v_mul_f32 v7, v7, v165
    v_cvt_pk_bf16_f32 v32, v0, v1
    v_cvt_pk_bf16_f32 v33, v2, v3
    v_cvt_pk_bf16_f32 v34, v4, v5
    v_cvt_pk_bf16_f32 v35, v6, v7
    buffer_store_dwordx4 v[32:35], v210, s[32:35], s56 offen sc1
    v_fma_f32 v138, v138, v216, v224
    v_fma_f32 v142, v142, v217, v225
    v_fma_f32 v146, v146, v218, v226
    v_fma_f32 v150, v150, v219, v227
    v_fma_f32 v154, v154, v220, v228
    v_fma_f32 v158, v158, v221, v229
    v_fma_f32 v162, v162, v222, v230
    v_fma_f32 v166, v166, v223, v231
    v_mul_f32 v0, v138, v138
    v_mul_f32 v1, v142, v142
    v_mul_f32 v2, v146, v146
    v_mul_f32 v3, v150, v150
    v_mul_f32 v4, v154, v154
    v_mul_f32 v5, v158, v158
    v_mul_f32 v6, v162, v162
    v_mul_f32 v7, v166, v166
    v_fma_f32 v0, v0, s26, v211
    v_fma_f32 v1, v1, s26, v211
    v_fma_f32 v2, v2, s26, v211
    v_fma_f32 v3, v3, s26, v211
    v_fma_f32 v4, v4, s26, v211
    v_fma_f32 v5, v5, s26, v211
    v_fma_f32 v6, v6, s26, v211
    v_fma_f32 v7, v7, s26, v211
    v_mul_f32 v0, v0, v138
    v_mul_f32 v1, v1, v142
    v_mul_f32 v2, v2, v146
    v_mul_f32 v3, v3, v150
    v_mul_f32 v4, v4, v154
    v_mul_f32 v5, v5, v158
    v_mul_f32 v6, v6, v162
    v_mul_f32 v7, v7, v166
    v_exp_f32 v0, v0
    v_exp_f32 v1, v1
    v_exp_f32 v2, v2
    v_exp_f32 v3, v3
    v_exp_f32 v4, v4
    v_exp_f32 v5, v5
    v_exp_f32 v6, v6
    v_exp_f32 v7, v7
    v_add_f32 v0, 1.0, v0
    v_add_f32 v1, 1.0, v1
    v_add_f32 v2, 1.0, v2
    v_add_f32 v3, 1.0, v3
    v_add_f32 v4, 1.0, v4
    v_add_f32 v5, 1.0, v5
    v_add_f32 v6, 1.0, v6
    v_add_f32 v7, 1.0, v7
    v_rcp_f32 v0, v0
    v_rcp_f32 v1, v1
    v_rcp_f32 v2, v2
    v_rcp_f32 v3, v3
    v_rcp_f32 v4, v4
    v_rcp_f32 v5, v5
    v_rcp_f32 v6, v6
    v_rcp_f32 v7, v7
    v_mul_f32 v0, v0, v138
    v_mul_f32 v1, v1, v142
    v_mul_f32 v2, v2, v146
    v_mul_f32 v3, v3, v150
    v_mul_f32 v4, v4, v154
    v_mul_f32 v5, v5, v158
    v_mul_f32 v6, v6, v162
    v_mul_f32 v7, v7, v166
    v_cvt_pk_bf16_f32 v36, v0, v1
    v_cvt_pk_bf16_f32 v37, v2, v3
    v_cvt_pk_bf16_f32 v38, v4, v5
    v_cvt_pk_bf16_f32 v39, v6, v7
    buffer_store_dwordx4 v[36:39], v210, s[32:35], s57 offen sc1
    v_fma_f32 v168, v168, v216, v224
    v_fma_f32 v172, v172, v217, v225
    v_fma_f32 v176, v176, v218, v226
    v_fma_f32 v180, v180, v219, v227
    v_fma_f32 v184, v184, v220, v228
    v_fma_f32 v188, v188, v221, v229
    v_fma_f32 v192, v192, v222, v230
    v_fma_f32 v196, v196, v223, v231
    v_mul_f32 v0, v168, v168
    v_mul_f32 v1, v172, v172
    v_mul_f32 v2, v176, v176
    v_mul_f32 v3, v180, v180
    v_mul_f32 v4, v184, v184
    v_mul_f32 v5, v188, v188
    v_mul_f32 v6, v192, v192
    v_mul_f32 v7, v196, v196
    v_fma_f32 v0, v0, s26, v211
    v_fma_f32 v1, v1, s26, v211
    v_fma_f32 v2, v2, s26, v211
    v_fma_f32 v3, v3, s26, v211
    v_fma_f32 v4, v4, s26, v211
    v_fma_f32 v5, v5, s26, v211
    v_fma_f32 v6, v6, s26, v211
    v_fma_f32 v7, v7, s26, v211
    v_mul_f32 v0, v0, v168
    v_mul_f32 v1, v1, v172
    v_mul_f32 v2, v2, v176
    v_mul_f32 v3, v3, v180
    v_mul_f32 v4, v4, v184
    v_mul_f32 v5, v5, v188
    v_mul_f32 v6, v6, v192
    v_mul_f32 v7, v7, v196
    v_exp_f32 v0, v0
    v_exp_f32 v1, v1
    v_exp_f32 v2, v2
    v_exp_f32 v3, v3
    v_exp_f32 v4, v4
    v_exp_f32 v5, v5
    v_exp_f32 v6, v6
    v_exp_f32 v7, v7
    v_add_f32 v0, 1.0, v0
    v_add_f32 v1, 1.0, v1
    v_add_f32 v2, 1.0, v2
    v_add_f32 v3, 1.0, v3
    v_add_f32 v4, 1.0, v4
    v_add_f32 v5, 1.0, v5
    v_add_f32 v6, 1.0, v6
    v_add_f32 v7, 1.0, v7
    v_rcp_f32 v0, v0
    v_rcp_f32 v1, v1
    v_rcp_f32 v2, v2
    v_rcp_f32 v3, v3
    v_rcp_f32 v4, v4
    v_rcp_f32 v5, v5
    v_rcp_f32 v6, v6
    v_rcp_f32 v7, v7
    v_mul_f32 v0, v0, v168
    v_mul_f32 v1, v1, v172
    v_mul_f32 v2, v2, v176
    v_mul_f32 v3, v3, v180
    v_mul_f32 v4, v4, v184
    v_mul_f32 v5, v5, v188
    v_mul_f32 v6, v6, v192
    v_mul_f32 v7, v7, v196
    v_cvt_pk_bf16_f32 v40, v0, v1
    v_cvt_pk_bf16_f32 v41, v2, v3
    v_cvt_pk_bf16_f32 v42, v4, v5
    v_cvt_pk_bf16_f32 v43, v6, v7
    buffer_store_dwordx4 v[40:43], v210, s[32:35], s58 offen sc1
    v_fma_f32 v169, v169, v216, v224
    v_fma_f32 v173, v173, v217, v225
    v_fma_f32 v177, v177, v218, v226
    v_fma_f32 v181, v181, v219, v227
    v_fma_f32 v185, v185, v220, v228
    v_fma_f32 v189, v189, v221, v229
    v_fma_f32 v193, v193, v222, v230
    v_fma_f32 v197, v197, v223, v231
    v_mul_f32 v0, v169, v169
    v_mul_f32 v1, v173, v173
    v_mul_f32 v2, v177, v177
    v_mul_f32 v3, v181, v181
    v_mul_f32 v4, v185, v185
    v_mul_f32 v5, v189, v189
    v_mul_f32 v6, v193, v193
    v_mul_f32 v7, v197, v197
    v_fma_f32 v0, v0, s26, v211
    v_fma_f32 v1, v1, s26, v211
    v_fma_f32 v2, v2, s26, v211
    v_fma_f32 v3, v3, s26, v211
    v_fma_f32 v4, v4, s26, v211
    v_fma_f32 v5, v5, s26, v211
    v_fma_f32 v6, v6, s26, v211
    v_fma_f32 v7, v7, s26, v211
    v_mul_f32 v0, v0, v169
    v_mul_f32 v1, v1, v173
    v_mul_f32 v2, v2, v177
    v_mul_f32 v3, v3, v181
    v_mul_f32 v4, v4, v185
    v_mul_f32 v5, v5, v189
    v_mul_f32 v6, v6, v193
    v_mul_f32 v7, v7, v197
    v_exp_f32 v0, v0
    v_exp_f32 v1, v1
    v_exp_f32 v2, v2
    v_exp_f32 v3, v3
    v_exp_f32 v4, v4
    v_exp_f32 v5, v5
    v_exp_f32 v6, v6
    v_exp_f32 v7, v7
    v_add_f32 v0, 1.0, v0
    v_add_f32 v1, 1.0, v1
    v_add_f32 v2, 1.0, v2
    v_add_f32 v3, 1.0, v3
    v_add_f32 v4, 1.0, v4
    v_add_f32 v5, 1.0, v5
    v_add_f32 v6, 1.0, v6
    v_add_f32 v7, 1.0, v7
    v_rcp_f32 v0, v0
    v_rcp_f32 v1, v1
    v_rcp_f32 v2, v2
    v_rcp_f32 v3, v3
    v_rcp_f32 v4, v4
    v_rcp_f32 v5, v5
    v_rcp_f32 v6, v6
    v_rcp_f32 v7, v7
    v_mul_f32 v0, v0, v169
    v_mul_f32 v1, v1, v173
    v_mul_f32 v2, v2, v177
    v_mul_f32 v3, v3, v181
    v_mul_f32 v4, v4, v185
    v_mul_f32 v5, v5, v189
    v_mul_f32 v6, v6, v193
    v_mul_f32 v7, v7, v197
    v_cvt_pk_bf16_f32 v44, v0, v1
    v_cvt_pk_bf16_f32 v45, v2, v3
    v_cvt_pk_bf16_f32 v46, v4, v5
    v_cvt_pk_bf16_f32 v47, v6, v7
    buffer_store_dwordx4 v[44:47], v210, s[32:35], s59 offen sc1
    v_fma_f32 v170, v170, v216, v224
    v_fma_f32 v174, v174, v217, v225
    v_fma_f32 v178, v178, v218, v226
    v_fma_f32 v182, v182, v219, v227
    v_fma_f32 v186, v186, v220, v228
    v_fma_f32 v190, v190, v221, v229
    v_fma_f32 v194, v194, v222, v230
    v_fma_f32 v198, v198, v223, v231
    v_mul_f32 v0, v170, v170
    v_mul_f32 v1, v174, v174
    v_mul_f32 v2, v178, v178
    v_mul_f32 v3, v182, v182
    v_mul_f32 v4, v186, v186
    v_mul_f32 v5, v190, v190
    v_mul_f32 v6, v194, v194
    v_mul_f32 v7, v198, v198
    v_fma_f32 v0, v0, s26, v211
    v_fma_f32 v1, v1, s26, v211
    v_fma_f32 v2, v2, s26, v211
    v_fma_f32 v3, v3, s26, v211
    v_fma_f32 v4, v4, s26, v211
    v_fma_f32 v5, v5, s26, v211
    v_fma_f32 v6, v6, s26, v211
    v_fma_f32 v7, v7, s26, v211
    v_mul_f32 v0, v0, v170
    v_mul_f32 v1, v1, v174
    v_mul_f32 v2, v2, v178
    v_mul_f32 v3, v3, v182
    v_mul_f32 v4, v4, v186
    v_mul_f32 v5, v5, v190
    v_mul_f32 v6, v6, v194
    v_mul_f32 v7, v7, v198
    v_exp_f32 v0, v0
    v_exp_f32 v1, v1
    v_exp_f32 v2, v2
    v_exp_f32 v3, v3
    v_exp_f32 v4, v4
    v_exp_f32 v5, v5
    v_exp_f32 v6, v6
    v_exp_f32 v7, v7
    v_add_f32 v0, 1.0, v0
    v_add_f32 v1, 1.0, v1
    v_add_f32 v2, 1.0, v2
    v_add_f32 v3, 1.0, v3
    v_add_f32 v4, 1.0, v4
    v_add_f32 v5, 1.0, v5
    v_add_f32 v6, 1.0, v6
    v_add_f32 v7, 1.0, v7
    v_rcp_f32 v0, v0
    v_rcp_f32 v1, v1
    v_rcp_f32 v2, v2
    v_rcp_f32 v3, v3
    v_rcp_f32 v4, v4
    v_rcp_f32 v5, v5
    v_rcp_f32 v6, v6
    v_rcp_f32 v7, v7
    v_mul_f32 v0, v0, v170
    v_mul_f32 v1, v1, v174
    v_mul_f32 v2, v2, v178
    v_mul_f32 v3, v3, v182
    v_mul_f32 v4, v4, v186
    v_mul_f32 v5, v5, v190
    v_mul_f32 v6, v6, v194
    v_mul_f32 v7, v7, v198
    v_cvt_pk_bf16_f32 v16, v0, v1
    v_cvt_pk_bf16_f32 v17, v2, v3
    v_cvt_pk_bf16_f32 v18, v4, v5
    v_cvt_pk_bf16_f32 v19, v6, v7
    buffer_store_dwordx4 v[16:19], v210, s[32:35], s60 offen sc1
L_k45_fin:
L_k45_end:
    s_endpgm
L_code_end:
    s_endpgm
.section .rodata,"a"
.p2align 6
.amdhsa_kernel xform_kernel
  .amdhsa_next_free_vgpr 232
  .amdhsa_next_free_sgpr 96
  .amdhsa_accum_offset 232
  .amdhsa_group_segment_fixed_size 0
  .amdhsa_kernarg_size 56
  .amdhsa_user_sgpr_count 2
  .amdhsa_user_sgpr_kernarg_segment_ptr 1
  .amdhsa_system_sgpr_workgroup_id_x 1
  .amdhsa_float_denorm_mode_32 3
.end_amdhsa_kernel

.p2align 6
.amdhsa_kernel gemm_kernel
  .amdhsa_next_free_vgpr 256
  .amdhsa_next_free_sgpr 96
  .amdhsa_accum_offset 256
  .amdhsa_group_segment_fixed_size 0
  .amdhsa_kernarg_size 56
  .amdhsa_user_sgpr_count 2
  .amdhsa_user_sgpr_kernarg_segment_ptr 1
  .amdhsa_system_sgpr_workgroup_id_x 1
  .amdhsa_float_denorm_mode_32 3
.end_amdhsa_kernel

.p2align 6
.amdhsa_kernel final_kernel
  .amdhsa_next_free_vgpr 240
  .amdhsa_next_free_sgpr 96
  .amdhsa_accum_offset 240
  .amdhsa_group_segment_fixed_size 0
  .amdhsa_kernarg_size 56
  .amdhsa_user_sgpr_count 2
  .amdhsa_user_sgpr_kernarg_segment_ptr 1
  .amdhsa_system_sgpr_workgroup_id_x 1
  .amdhsa_float_denorm_mode_32 3
.end_amdhsa_kernel
```

```asm
; @launch kernel=xform_kernel grid=(256,1,1) block=(256,1,1) lds=12352
; @launch kernel=gemm_kernel grid=(256,1,1) block=(512,1,1) lds=155648
; @launch kernel=final_kernel grid=(224,1,1) block=(512,1,1) lds=82944
.amdgcn_target "amdgcn-amd-amdhsa--gfx950"
.text
.globl xform_kernel
.p2align 8
.type xform_kernel,@function
xform_kernel:
    s_cmp_ge_u32 s2, 256
    s_cbranch_scc1 L_k12_end
    s_load_dwordx4 s[4:7], s[0:1], 0
    s_load_dwordx4 s[36:39], s[0:1], 40
    v_lshrrev_b32 v213, 6, v0
    s_cmp_ge_u32 s2, 8
    s_cbranch_scc1 L_nopf12
    v_readfirstlane_b32 s10, v213
    s_nop 3
    s_cmp_lg_u32 s10, 3
    s_cbranch_scc1 L_nopf12
    s_getpc_b64 s[60:61]
L_pf_k12:
    s_sub_u32 s60, s60, L_pf_k12-xform_kernel
    s_subb_u32 s61, s61, 0
    v_mbcnt_lo_u32_b32 v184, -1, 0
    v_mbcnt_hi_u32_b32 v184, -1, v184
    v_lshlrev_b32 v184, 6, v184
    v_add_u32 v185, 0, v184
    v_min_u32 v185, L_code_end-xform_kernel-4, v185
    v_mov_b32 v187, s61
    v_add_co_u32 v186, vcc, s60, v185
    s_nop 1
    v_addc_co_u32 v187, vcc, 0, v187, vcc
    global_load_dword v188, v[186:187], off
    v_add_u32 v185, 4096, v184
    v_min_u32 v185, L_code_end-xform_kernel-4, v185
    v_mov_b32 v187, s61
    v_add_co_u32 v186, vcc, s60, v185
    s_nop 1
    v_addc_co_u32 v187, vcc, 0, v187, vcc
    global_load_dword v188, v[186:187], off
    v_add_u32 v185, 8192, v184
    v_min_u32 v185, L_code_end-xform_kernel-4, v185
    v_mov_b32 v187, s61
    v_add_co_u32 v186, vcc, s60, v185
    s_nop 1
    v_addc_co_u32 v187, vcc, 0, v187, vcc
    global_load_dword v188, v[186:187], off
    v_add_u32 v185, 12288, v184
    v_min_u32 v185, L_code_end-xform_kernel-4, v185
    v_mov_b32 v187, s61
    v_add_co_u32 v186, vcc, s60, v185
    s_nop 1
    v_addc_co_u32 v187, vcc, 0, v187, vcc
    global_load_dword v188, v[186:187], off
    v_add_u32 v185, 16384, v184
    v_min_u32 v185, L_code_end-xform_kernel-4, v185
    v_mov_b32 v187, s61
    v_add_co_u32 v186, vcc, s60, v185
    s_nop 1
    v_addc_co_u32 v187, vcc, 0, v187, vcc
    global_load_dword v188, v[186:187], off
    v_add_u32 v185, 20480, v184
    v_min_u32 v185, L_code_end-xform_kernel-4, v185
    v_mov_b32 v187, s61
    v_add_co_u32 v186, vcc, s60, v185
    s_nop 1
    v_addc_co_u32 v187, vcc, 0, v187, vcc
    global_load_dword v188, v[186:187], off
    v_add_u32 v185, 24576, v184
    v_min_u32 v185, L_code_end-xform_kernel-4, v185
    v_mov_b32 v187, s61
    v_add_co_u32 v186, vcc, s60, v185
    s_nop 1
    v_addc_co_u32 v187, vcc, 0, v187, vcc
    global_load_dword v188, v[186:187], off
    v_add_u32 v185, 28672, v184
    v_min_u32 v185, L_code_end-xform_kernel-4, v185
    v_mov_b32 v187, s61
    v_add_co_u32 v186, vcc, s60, v185
    s_nop 1
    v_addc_co_u32 v187, vcc, 0, v187, vcc
    global_load_dword v188, v[186:187], off
    v_add_u32 v185, 32768, v184
    v_min_u32 v185, L_code_end-xform_kernel-4, v185
    v_mov_b32 v187, s61
    v_add_co_u32 v186, vcc, s60, v185
    s_nop 1
    v_addc_co_u32 v187, vcc, 0, v187, vcc
    global_load_dword v188, v[186:187], off
    v_add_u32 v185, 36864, v184
    v_min_u32 v185, L_code_end-xform_kernel-4, v185
    v_mov_b32 v187, s61
    v_add_co_u32 v186, vcc, s60, v185
    s_nop 1
    v_addc_co_u32 v187, vcc, 0, v187, vcc
    global_load_dword v188, v[186:187], off
L_nopf12:
    v_and_b32 v208, 63, v0
    v_lshrrev_b32 v213, 6, v0
    v_and_b32 v209, 15, v208
    v_readfirstlane_b32 s10, v213
    v_lshrrev_b32 v210, 4, v208
    v_lshlrev_b32 v223, 4, v208
    v_mov_b32 v222, 0
    s_mov_b32 s30, 0x05040100
    s_mov_b32 s31, 0x07060302
    s_mov_b32 s32, 0x01000100
    s_mov_b32 s33, 0x03020302
    s_mov_b32 s40, s2
    s_add_u32 s42, s2, 256
    s_mov_b32 s41, 0
    s_mov_b32 s43, 0
    v_lshlrev_b32 v224, 14, v210
    v_lshl_add_u32 v224, v209, 4, v224
    v_lshlrev_b32 v225, 22, v210
    v_lshrrev_b32 v213, 2, v209
    v_lshl_add_u32 v225, v213, 6, v225
    v_and_b32 v213, 1, v209
    v_lshl_add_u32 v225, v213, 5, v225
    v_bfe_u32 v213, v209, 1, 1
    v_lshl_add_u32 v225, v213, 3, v225
    v_lshrrev_b32 v213, 2, v209
    s_mov_b32 s24, 688128
    v_mul_u32_u24 v226, s24, v213
    s_mov_b32 s24, 43008
    v_mad_u32_u24 v226, v210, s24, v226
    s_mov_b32 s24, 32768
    v_mul_u32_u24 v227, s24, v210
    s_waitcnt lgkmcnt(0)
    s_mov_b32 s16, s38
    s_and_b32 s17, s39, 0xffff
    s_mov_b32 s18, 268435456
    s_mov_b32 s19, 0x00020000
    s_mov_b32 s44, s36
    s_and_b32 s45, s37, 0xffff
    s_mov_b32 s46, 256
    s_mov_b32 s47, 0x00020000
    s_cmp_ge_u32 s40, 768
    s_cbranch_scc1 L_rm0
    s_sub_u32 s28, s40, 96
    s_add_u32 s29, s40, 672
    s_cmp_ge_u32 s40, 96
    s_cselect_b32 s40, s28, s29
L_rm0:
    s_cmp_ge_u32 s42, 768
    s_cbranch_scc1 L_rm1
    s_sub_u32 s28, s42, 96
    s_add_u32 s29, s42, 672
    s_cmp_ge_u32 s42, 96
    s_cselect_b32 s42, s28, s29
L_rm1:
    s_cmp_ge_u32 s40, 1696
    s_cbranch_scc1 L_ld_done2
    s_cmp_ge_u32 s40, 672
    s_cbranch_scc1 L_ld_w2
    s_cmp_ge_u32 s40, 336
    s_cselect_b32 s11, 1, 0
    s_mul_i32 s12, s11, 336
    s_sub_u32 s12, s40, s12
    s_and_b32 s13, s12, 7
    s_lshr_b32 s14, s12, 3
    s_lshl_b32 s14, s14, 2
    s_add_u32 s14, s14, s10
    s_mul_i32 s15, s11, 16384000
    s_add_u32 s34, s4, s15
    s_addc_u32 s35, s5, 0
    s_mov_b32 s20, s34
    s_and_b32 s21, s35, 0xffff
    s_mov_b32 s22, 16384000
    s_mov_b32 s23, 0x00020000
    s_mul_i32 s15, s14, 98304
    s_lshl_b32 s24, s13, 8
    s_add_u32 s15, s15, s24
    s_add_u32 s25, s15, 0
    buffer_load_dwordx4 v[0:3], v224, s[20:23], s25 offen
    s_add_u32 s25, s15, 2048
    buffer_load_dwordx4 v[4:7], v224, s[20:23], s25 offen
    s_add_u32 s25, s15, 4096
    buffer_load_dwordx4 v[8:11], v224, s[20:23], s25 offen
    s_add_u32 s25, s15, 6144
    buffer_load_dwordx4 v[12:15], v224, s[20:23], s25 offen
    s_add_u32 s25, s15, 8192
    buffer_load_dwordx4 v[16:19], v224, s[20:23], s25 offen
    s_add_u32 s25, s15, 10240
    buffer_load_dwordx4 v[20:23], v224, s[20:23], s25 offen
    s_add_u32 s25, s15, 12288
    buffer_load_dwordx4 v[24:27], v224, s[20:23], s25 offen
    s_add_u32 s25, s15, 14336
    buffer_load_dwordx4 v[28:31], v224, s[20:23], s25 offen
    s_add_u32 s25, s15, 65536
    buffer_load_dwordx4 v[32:35], v224, s[20:23], s25 offen
    s_add_u32 s25, s15, 67584
    buffer_load_dwordx4 v[36:39], v224, s[20:23], s25 offen
    s_add_u32 s25, s15, 69632
    buffer_load_dwordx4 v[40:43], v224, s[20:23], s25 offen
    s_add_u32 s25, s15, 71680
    buffer_load_dwordx4 v[44:47], v224, s[20:23], s25 offen
    s_add_u32 s25, s15, 73728
    buffer_load_dwordx4 v[48:51], v224, s[20:23], s25 offen
    s_add_u32 s25, s15, 75776
    buffer_load_dwordx4 v[52:55], v224, s[20:23], s25 offen
    s_add_u32 s25, s15, 77824
    buffer_load_dwordx4 v[56:59], v224, s[20:23], s25 offen
    s_add_u32 s25, s15, 79872
    buffer_load_dwordx4 v[60:63], v224, s[20:23], s25 offen
    s_branch L_ld_done2
L_ld_w2:
    s_sub_u32 s12, s40, 672
    s_and_b32 s13, s12, 3
    s_lshr_b32 s14, s12, 2
    s_lshl_b32 s14, s14, 2
    s_add_u32 s14, s14, s10
    s_mov_b32 s20, s6
    s_and_b32 s21, s7, 0xffff
    s_mov_b32 s22, 16252928
    s_mov_b32 s23, 0x00020000
    s_lshl_b32 s15, s14, 10
    s_lshl_b32 s24, s13, 8
    s_add_u32 s15, s15, s24
    s_add_u32 s25, s15, 0
    buffer_load_dwordx2 v[0:1], v225, s[20:23], s25 offen
    buffer_load_dwordx2 v[2:3], v225, s[20:23], s25 offen offset:16
    s_add_u32 s25, s15, 1048576
    buffer_load_dwordx2 v[4:5], v225, s[20:23], s25 offen
    buffer_load_dwordx2 v[6:7], v225, s[20:23], s25 offen offset:16
    s_add_u32 s25, s15, 2097152
    buffer_load_dwordx2 v[8:9], v225, s[20:23], s25 offen
    buffer_load_dwordx2 v[10:11], v225, s[20:23], s25 offen offset:16
    s_add_u32 s25, s15, 3145728
    buffer_load_dwordx2 v[12:13], v225, s[20:23], s25 offen
    buffer_load_dwordx2 v[14:15], v225, s[20:23], s25 offen offset:16
L_ld_done2:
    v_lshrrev_b32 v213, 2, v209
    v_lshlrev_b32 v213, 1, v213
    v_bfe_u32 v214, v209, 1, 1
    v_add_u32 v213, v213, v214
    s_lshl_b32 s24, s10, 3
    v_add_u32 v213, s24, v213
    v_lshl_add_u32 v213, v213, 1, 1
    v_and_b32 v214, 1, v209
    v_lshlrev_b32 v214, 5, v214
    v_lshlrev_b32 v215, 3, v210
    v_mad_u32_u24 v160, v213, v215, v214
    v_add_u32 v161, v160, v213
    v_add_u32 v162, v161, v213
    v_add_u32 v163, v162, v213
    v_add_u32 v164, v163, v213
    v_add_u32 v165, v164, v213
    v_add_u32 v166, v165, v213
    v_add_u32 v167, v166, v213
    v_and_b32 v160, 127, v160
    v_cvt_f32_u32 v160, v160
    v_mul_f32 v160, 0x3c000000, v160
    v_cos_f32 v160, v160
    v_and_b32 v161, 127, v161
    v_cvt_f32_u32 v161, v161
    v_mul_f32 v161, 0x3c000000, v161
    v_cos_f32 v161, v161
    v_and_b32 v162, 127, v162
    v_cvt_f32_u32 v162, v162
    v_mul_f32 v162, 0x3c000000, v162
    v_cos_f32 v162, v162
    v_and_b32 v163, 127, v163
    v_cvt_f32_u32 v163, v163
    v_mul_f32 v163, 0x3c000000, v163
    v_cos_f32 v163, v163
    v_and_b32 v164, 127, v164
    v_cvt_f32_u32 v164, v164
    v_mul_f32 v164, 0x3c000000, v164
    v_cos_f32 v164, v164
    v_and_b32 v165, 127, v165
    v_cvt_f32_u32 v165, v165
    v_mul_f32 v165, 0x3c000000, v165
    v_cos_f32 v165, v165
    v_and_b32 v166, 127, v166
    v_cvt_f32_u32 v166, v166
    v_mul_f32 v166, 0x3c000000, v166
    v_cos_f32 v166, v166
    v_and_b32 v167, 127, v167
    v_cvt_f32_u32 v167, v167
    v_mul_f32 v167, 0x3c000000, v167
    v_cos_f32 v167, v167
    v_cvt_pk_bf16_f32 v176, v160, v161
    v_cvt_pk_bf16_f32 v177, v162, v163
    v_cvt_pk_bf16_f32 v178, v164, v165
    v_cvt_pk_bf16_f32 v179, v166, v167
    s_lshl_b32 s24, s10, 11
    v_add_u32 v216, s24, v223
    ds_write_b128 v216, v[176:179] offset:0
    v_lshlrev_b32 v215, 3, v210
    v_add_u32 v215, 32, v215
    v_mad_u32_u24 v160, v213, v215, v214
    v_add_u32 v161, v160, v213
    v_add_u32 v162, v161, v213
    v_add_u32 v163, v162, v213
    v_add_u32 v164, v163, v213
    v_add_u32 v165, v164, v213
    v_add_u32 v166, v165, v213
    v_add_u32 v167, v166, v213
    v_and_b32 v160, 127, v160
    v_cvt_f32_u32 v160, v160
    v_mul_f32 v160, 0x3c000000, v160
    v_cos_f32 v160, v160
    v_and_b32 v161, 127, v161
    v_cvt_f32_u32 v161, v161
    v_mul_f32 v161, 0x3c000000, v161
    v_cos_f32 v161, v161
    v_and_b32 v162, 127, v162
    v_cvt_f32_u32 v162, v162
    v_mul_f32 v162, 0x3c000000, v162
    v_cos_f32 v162, v162
    v_and_b32 v163, 127, v163
    v_cvt_f32_u32 v163, v163
    v_mul_f32 v163, 0x3c000000, v163
    v_cos_f32 v163, v163
    v_and_b32 v164, 127, v164
    v_cvt_f32_u32 v164, v164
    v_mul_f32 v164, 0x3c000000, v164
    v_cos_f32 v164, v164
    v_and_b32 v165, 127, v165
    v_cvt_f32_u32 v165, v165
    v_mul_f32 v165, 0x3c000000, v165
    v_cos_f32 v165, v165
    v_and_b32 v166, 127, v166
    v_cvt_f32_u32 v166, v166
    v_mul_f32 v166, 0x3c000000, v166
    v_cos_f32 v166, v166
    v_and_b32 v167, 127, v167
    v_cvt_f32_u32 v167, v167
    v_mul_f32 v167, 0x3c000000, v167
    v_cos_f32 v167, v167
    v_cvt_pk_bf16_f32 v176, v160, v161
    v_cvt_pk_bf16_f32 v177, v162, v163
    v_cvt_pk_bf16_f32 v178, v164, v165
    v_cvt_pk_bf16_f32 v179, v166, v167
    s_lshl_b32 s24, s10, 11
    v_add_u32 v216, s24, v223
    ds_write_b128 v216, v[176:179] offset:1024
    v_lshlrev_b32 v215, 2, v210
    v_mad_u32_u24 v160, v213, v215, v214
    v_add_u32 v161, v160, v213
    v_add_u32 v162, v161, v213
    v_add_u32 v163, v162, v213
    v_and_b32 v160, 127, v160
    v_cvt_f32_u32 v160, v160
    v_mul_f32 v160, 0x3c000000, v160
    v_cos_f32 v160, v160
    v_and_b32 v161, 127, v161
    v_cvt_f32_u32 v161, v161
    v_mul_f32 v161, 0x3c000000, v161
    v_cos_f32 v161, v161
    v_and_b32 v162, 127, v162
    v_cvt_f32_u32 v162, v162
    v_mul_f32 v162, 0x3c000000, v162
    v_cos_f32 v162, v162
    v_and_b32 v163, 127, v163
    v_cvt_f32_u32 v163, v163
    v_mul_f32 v163, 0x3c000000, v163
    v_cos_f32 v163, v163
    v_cvt_pk_bf16_f32 v180, v160, v160
    v_lshlrev_b32 v181, 16, v180
    v_sub_f32 v181, v160, v181
    v_cvt_pk_bf16_f32 v181, v181, v181
    v_perm_b32 v176, v181, v180, s30
    v_cvt_pk_bf16_f32 v180, v161, v161
    v_lshlrev_b32 v181, 16, v180
    v_sub_f32 v181, v161, v181
    v_cvt_pk_bf16_f32 v181, v181, v181
    v_perm_b32 v177, v181, v180, s30
    v_cvt_pk_bf16_f32 v180, v162, v162
    v_lshlrev_b32 v181, 16, v180
    v_sub_f32 v181, v162, v181
    v_cvt_pk_bf16_f32 v181, v181, v181
    v_perm_b32 v178, v181, v180, s30
    v_cvt_pk_bf16_f32 v180, v163, v163
    v_lshlrev_b32 v181, 16, v180
    v_sub_f32 v181, v163, v181
    v_cvt_pk_bf16_f32 v181, v181, v181
    v_perm_b32 v179, v181, v180, s30
    s_lshl_b32 s24, s10, 10
    v_add_u32 v216, s24, v223
    ds_write_b128 v216, v[176:179] offset:8192
    s_waitcnt lgkmcnt(0)
    s_barrier
L_k12_loop:
    s_cmp_lg_u32 s10, 0
    s_cbranch_scc1 L_nofetch0
    v_mov_b32 v221, 1
    s_mov_b64 exec, 1
    buffer_atomic_add v221, v222, s[44:47], 0 offen sc0 sc1
    s_mov_b64 exec, -1
L_nofetch0:
    s_cmp_ge_u32 s42, 1696
    s_cbranch_scc1 L_ld_done3
    s_cmp_ge_u32 s42, 672
    s_cbranch_scc1 L_ld_w3
    s_cmp_ge_u32 s42, 336
    s_cselect_b32 s11, 1, 0
    s_mul_i32 s12, s11, 336
    s_sub_u32 s12, s42, s12
    s_and_b32 s13, s12, 7
    s_lshr_b32 s14, s12, 3
    s_lshl_b32 s14, s14, 2
    s_add_u32 s14, s14, s10
    s_mul_i32 s15, s11, 16384000
    s_add_u32 s34, s4, s15
    s_addc_u32 s35, s5, 0
    s_mov_b32 s20, s34
    s_and_b32 s21, s35, 0xffff
    s_mov_b32 s22, 16384000
    s_mov_b32 s23, 0x00020000
    s_mul_i32 s15, s14, 98304
    s_lshl_b32 s24, s13, 8
    s_add_u32 s15, s15, s24
    s_add_u32 s25, s15, 0
    buffer_load_dwordx4 v[64:67], v224, s[20:23], s25 offen
    s_add_u32 s25, s15, 2048
    buffer_load_dwordx4 v[68:71], v224, s[20:23], s25 offen
    s_add_u32 s25, s15, 4096
    buffer_load_dwordx4 v[72:75], v224, s[20:23], s25 offen
    s_add_u32 s25, s15, 6144
    buffer_load_dwordx4 v[76:79], v224, s[20:23], s25 offen
    s_add_u32 s25, s15, 8192
    buffer_load_dwordx4 v[80:83], v224, s[20:23], s25 offen
    s_add_u32 s25, s15, 10240
    buffer_load_dwordx4 v[84:87], v224, s[20:23], s25 offen
    s_add_u32 s25, s15, 12288
    buffer_load_dwordx4 v[88:91], v224, s[20:23], s25 offen
    s_add_u32 s25, s15, 14336
    buffer_load_dwordx4 v[92:95], v224, s[20:23], s25 offen
    s_add_u32 s25, s15, 65536
    buffer_load_dwordx4 v[96:99], v224, s[20:23], s25 offen
    s_add_u32 s25, s15, 67584
    buffer_load_dwordx4 v[100:103], v224, s[20:23], s25 offen
    s_add_u32 s25, s15, 69632
    buffer_load_dwordx4 v[104:107], v224, s[20:23], s25 offen
    s_add_u32 s25, s15, 71680
    buffer_load_dwordx4 v[108:111], v224, s[20:23], s25 offen
    s_add_u32 s25, s15, 73728
    buffer_load_dwordx4 v[112:115], v224, s[20:23], s25 offen
    s_add_u32 s25, s15, 75776
    buffer_load_dwordx4 v[116:119], v224, s[20:23], s25 offen
    s_add_u32 s25, s15, 77824
    buffer_load_dwordx4 v[120:123], v224, s[20:23], s25 offen
    s_add_u32 s25, s15, 79872
    buffer_load_dwordx4 v[124:127], v224, s[20:23], s25 offen
    s_branch L_ld_done3
L_ld_w3:
    s_sub_u32 s12, s42, 672
    s_and_b32 s13, s12, 3
    s_lshr_b32 s14, s12, 2
    s_lshl_b32 s14, s14, 2
    s_add_u32 s14, s14, s10
    s_mov_b32 s20, s6
    s_and_b32 s21, s7, 0xffff
    s_mov_b32 s22, 16252928
    s_mov_b32 s23, 0x00020000
    s_lshl_b32 s15, s14, 10
    s_lshl_b32 s24, s13, 8
    s_add_u32 s15, s15, s24
    s_add_u32 s25, s15, 0
    buffer_load_dwordx2 v[64:65], v225, s[20:23], s25 offen
    buffer_load_dwordx2 v[66:67], v225, s[20:23], s25 offen offset:16
    s_add_u32 s25, s15, 1048576
    buffer_load_dwordx2 v[68:69], v225, s[20:23], s25 offen
    buffer_load_dwordx2 v[70:71], v225, s[20:23], s25 offen offset:16
    s_add_u32 s25, s15, 2097152
    buffer_load_dwordx2 v[72:73], v225, s[20:23], s25 offen
    buffer_load_dwordx2 v[74:75], v225, s[20:23], s25 offen offset:16
    s_add_u32 s25, s15, 3145728
    buffer_load_dwordx2 v[76:77], v225, s[20:23], s25 offen
    buffer_load_dwordx2 v[78:79], v225, s[20:23], s25 offen offset:16
L_ld_done3:
    s_cmp_lg_u32 s43, 0
    s_cbranch_scc1 L_notfirst
    s_cmp_ge_u32 s42, 1696
    s_cbranch_scc1 L_w0_f
    s_cmp_ge_u32 s42, 672
    s_cbranch_scc1 L_w8_f
    s_waitcnt vmcnt(16)
    s_branch L_wd_f
L_w8_f:
    s_waitcnt vmcnt(8)
    s_branch L_wd_f
L_w0_f:
    s_waitcnt vmcnt(0)
L_wd_f:
    s_mov_b32 s43, 1
    s_branch L_wfin
L_notfirst:
    s_cmp_ge_u32 s42, 1696
    s_cbranch_scc1 L_w0_a0
    s_cmp_ge_u32 s42, 672
    s_cbranch_scc1 L_w8_a0
    s_waitcnt vmcnt(32)
    s_branch L_wd_a0
L_w8_a0:
    s_waitcnt vmcnt(24)
    s_branch L_wd_a0
L_w0_a0:
    s_waitcnt vmcnt(16)
L_wd_a0:
L_wfin:
    s_cmp_ge_u32 s40, 672
    s_cbranch_scc1 L_cw0
    s_cmp_ge_u32 s40, 336
    s_cselect_b32 s11, 1, 0
    s_mul_i32 s12, s11, 336
    s_sub_u32 s12, s40, s12
    s_and_b32 s13, s12, 7
    s_lshr_b32 s14, s12, 3
    s_lshl_b32 s14, s14, 2
    s_add_u32 s14, s14, s10
    ds_read_b128 v[128:131], v223 offset:0
    ds_read_b128 v[132:135], v223 offset:1024
    ds_read_b128 v[136:139], v223 offset:2048
    ds_read_b128 v[140:143], v223 offset:3072
    ds_read_b128 v[144:147], v223 offset:4096
    ds_read_b128 v[148:151], v223 offset:5120
    ds_read_b128 v[152:155], v223 offset:6144
    ds_read_b128 v[156:159], v223 offset:7168
    s_bfe_u32 s24, s14, 0x10003
    s_mul_i32 s24, s24, 3
    v_and_b32 v213, 3, v209
    v_xor_b32 v213, s24, v213
    v_lshl_add_u32 v212, v213, 4, v226
    s_mul_i32 s24, s11, 22020096
    s_mul_i32 s25, s13, 2752512
    s_add_u32 s24, s24, s25
    s_lshl_b32 s25, s14, 6
    s_add_u32 s24, s24, s25
    s_add_u32 s24, s24, 67108864
    v_perm_b32 v160, v4, v0, s30
    v_perm_b32 v161, v12, v8, s30
    v_perm_b32 v162, v20, v16, s30
    v_perm_b32 v163, v28, v24, s30
    v_perm_b32 v164, v4, v0, s31
    v_perm_b32 v165, v12, v8, s31
    v_perm_b32 v166, v20, v16, s31
    v_perm_b32 v167, v28, v24, s31
    v_perm_b32 v168, v36, v32, s30
    v_perm_b32 v169, v44, v40, s30
    v_perm_b32 v170, v52, v48, s30
    v_perm_b32 v171, v60, v56, s30
    v_perm_b32 v172, v36, v32, s31
    v_perm_b32 v173, v44, v40, s31
    v_perm_b32 v174, v52, v48, s31
    v_perm_b32 v175, v60, v56, s31
    s_waitcnt lgkmcnt(0)
    v_mfma_f32_16x16x32_bf16 v[176:179], v[128:131], v[160:163], 0
    v_mfma_f32_16x16x32_bf16 v[180:183], v[128:131], v[164:167], 0
    v_mfma_f32_16x16x32_bf16 v[184:187], v[136:139], v[160:163], 0
    v_mfma_f32_16x16x32_bf16 v[188:191], v[136:139], v[164:167], 0
    v_mfma_f32_16x16x32_bf16 v[192:195], v[144:147], v[160:163], 0
    v_mfma_f32_16x16x32_bf16 v[196:199], v[144:147], v[164:167], 0
    v_mfma_f32_16x16x32_bf16 v[200:203], v[152:155], v[160:163], 0
    v_mfma_f32_16x16x32_bf16 v[204:207], v[152:155], v[164:167], 0
    v_mfma_f32_16x16x32_bf16 v[176:179], v[132:135], v[168:171], v[176:179]
    v_mfma_f32_16x16x32_bf16 v[180:183], v[132:135], v[172:175], v[180:183]
    v_mfma_f32_16x16x32_bf16 v[184:187], v[140:143], v[168:171], v[184:187]
    v_mfma_f32_16x16x32_bf16 v[188:191], v[140:143], v[172:175], v[188:191]
    v_mfma_f32_16x16x32_bf16 v[192:195], v[148:151], v[168:171], v[192:195]
    v_mfma_f32_16x16x32_bf16 v[196:199], v[148:151], v[172:175], v[196:199]
    v_mfma_f32_16x16x32_bf16 v[200:203], v[156:159], v[168:171], v[200:203]
    v_mfma_f32_16x16x32_bf16 v[204:207], v[156:159], v[172:175], v[204:207]
    v_perm_b32 v160, v5, v1, s30
    v_perm_b32 v161, v13, v9, s30
    v_perm_b32 v162, v21, v17, s30
    v_perm_b32 v163, v29, v25, s30
    v_perm_b32 v164, v5, v1, s31
    v_perm_b32 v165, v13, v9, s31
    v_perm_b32 v166, v21, v17, s31
    v_perm_b32 v167, v29, v25, s31
    v_perm_b32 v168, v37, v33, s30
    v_perm_b32 v169, v45, v41, s30
    v_perm_b32 v170, v53, v49, s30
    v_perm_b32 v171, v61, v57, s30
    v_perm_b32 v172, v37, v33, s31
    v_perm_b32 v173, v45, v41, s31
    v_perm_b32 v174, v53, v49, s31
    v_perm_b32 v175, v61, v57, s31
    v_cvt_pk_bf16_f32 v0, v176, v180
    v_cvt_pk_bf16_f32 v4, v177, v181
    v_cvt_pk_bf16_f32 v8, v178, v182
    v_cvt_pk_bf16_f32 v12, v179, v183
    v_cvt_pk_bf16_f32 v16, v184, v188
    v_cvt_pk_bf16_f32 v20, v185, v189
    v_cvt_pk_bf16_f32 v24, v186, v190
    v_cvt_pk_bf16_f32 v28, v187, v191
    v_cvt_pk_bf16_f32 v32, v192, v196
    v_cvt_pk_bf16_f32 v36, v193, v197
    v_cvt_pk_bf16_f32 v40, v194, v198
    v_cvt_pk_bf16_f32 v44, v195, v199
    v_cvt_pk_bf16_f32 v48, v200, v204
    v_cvt_pk_bf16_f32 v52, v201, v205
    v_cvt_pk_bf16_f32 v56, v202, v206
    v_cvt_pk_bf16_f32 v60, v203, v207
    v_mfma_f32_16x16x32_bf16 v[176:179], v[128:131], v[160:163], 0
    v_mfma_f32_16x16x32_bf16 v[180:183], v[128:131], v[164:167], 0
    v_mfma_f32_16x16x32_bf16 v[184:187], v[136:139], v[160:163], 0
    v_mfma_f32_16x16x32_bf16 v[188:191], v[136:139], v[164:167], 0
    v_mfma_f32_16x16x32_bf16 v[192:195], v[144:147], v[160:163], 0
    v_mfma_f32_16x16x32_bf16 v[196:199], v[144:147], v[164:167], 0
    v_mfma_f32_16x16x32_bf16 v[200:203], v[152:155], v[160:163], 0
    v_mfma_f32_16x16x32_bf16 v[204:207], v[152:155], v[164:167], 0
    v_mfma_f32_16x16x32_bf16 v[176:179], v[132:135], v[168:171], v[176:179]
    v_mfma_f32_16x16x32_bf16 v[180:183], v[132:135], v[172:175], v[180:183]
    v_mfma_f32_16x16x32_bf16 v[184:187], v[140:143], v[168:171], v[184:187]
    v_mfma_f32_16x16x32_bf16 v[188:191], v[140:143], v[172:175], v[188:191]
    v_mfma_f32_16x16x32_bf16 v[192:195], v[148:151], v[168:171], v[192:195]
    v_mfma_f32_16x16x32_bf16 v[196:199], v[148:151], v[172:175], v[196:199]
    v_mfma_f32_16x16x32_bf16 v[200:203], v[156:159], v[168:171], v[200:203]
    v_mfma_f32_16x16x32_bf16 v[204:207], v[156:159], v[172:175], v[204:207]
    v_perm_b32 v160, v6, v2, s30
    v_perm_b32 v161, v14, v10, s30
    v_perm_b32 v162, v22, v18, s30
    v_perm_b32 v163, v30, v26, s30
    v_perm_b32 v164, v6, v2, s31
    v_perm_b32 v165, v14, v10, s31
    v_perm_b32 v166, v22, v18, s31
    v_perm_b32 v167, v30, v26, s31
    v_perm_b32 v168, v38, v34, s30
    v_perm_b32 v169, v46, v42, s30
    v_perm_b32 v170, v54, v50, s30
    v_perm_b32 v171, v62, v58, s30
    v_perm_b32 v172, v38, v34, s31
    v_perm_b32 v173, v46, v42, s31
    v_perm_b32 v174, v54, v50, s31
    v_perm_b32 v175, v62, v58, s31
    v_cvt_pk_bf16_f32 v1, v176, v180
    v_cvt_pk_bf16_f32 v5, v177, v181
    v_cvt_pk_bf16_f32 v9, v178, v182
    v_cvt_pk_bf16_f32 v13, v179, v183
    v_cvt_pk_bf16_f32 v17, v184, v188
    v_cvt_pk_bf16_f32 v21, v185, v189
    v_cvt_pk_bf16_f32 v25, v186, v190
    v_cvt_pk_bf16_f32 v29, v187, v191
    v_cvt_pk_bf16_f32 v33, v192, v196
    v_cvt_pk_bf16_f32 v37, v193, v197
    v_cvt_pk_bf16_f32 v41, v194, v198
    v_cvt_pk_bf16_f32 v45, v195, v199
    v_cvt_pk_bf16_f32 v49, v200, v204
    v_cvt_pk_bf16_f32 v53, v201, v205
    v_cvt_pk_bf16_f32 v57, v202, v206
    v_cvt_pk_bf16_f32 v61, v203, v207
    v_mfma_f32_16x16x32_bf16 v[176:179], v[128:131], v[160:163], 0
    v_mfma_f32_16x16x32_bf16 v[180:183], v[128:131], v[164:167], 0
    v_mfma_f32_16x16x32_bf16 v[184:187], v[136:139], v[160:163], 0
    v_mfma_f32_16x16x32_bf16 v[188:191], v[136:139], v[164:167], 0
    v_mfma_f32_16x16x32_bf16 v[192:195], v[144:147], v[160:163], 0
    v_mfma_f32_16x16x32_bf16 v[196:199], v[144:147], v[164:167], 0
    v_mfma_f32_16x16x32_bf16 v[200:203], v[152:155], v[160:163], 0
    v_mfma_f32_16x16x32_bf16 v[204:207], v[152:155], v[164:167], 0
    v_mfma_f32_16x16x32_bf16 v[176:179], v[132:135], v[168:171], v[176:179]
    v_mfma_f32_16x16x32_bf16 v[180:183], v[132:135], v[172:175], v[180:183]
    v_mfma_f32_16x16x32_bf16 v[184:187], v[140:143], v[168:171], v[184:187]
    v_mfma_f32_16x16x32_bf16 v[188:191], v[140:143], v[172:175], v[188:191]
    v_mfma_f32_16x16x32_bf16 v[192:195], v[148:151], v[168:171], v[192:195]
    v_mfma_f32_16x16x32_bf16 v[196:199], v[148:151], v[172:175], v[196:199]
    v_mfma_f32_16x16x32_bf16 v[200:203], v[156:159], v[168:171], v[200:203]
    v_mfma_f32_16x16x32_bf16 v[204:207], v[156:159], v[172:175], v[204:207]
    v_perm_b32 v160, v7, v3, s30
    v_perm_b32 v161, v15, v11, s30
    v_perm_b32 v162, v23, v19, s30
    v_perm_b32 v163, v31, v27, s30
    v_perm_b32 v164, v7, v3, s31
    v_perm_b32 v165, v15, v11, s31
    v_perm_b32 v166, v23, v19, s31
    v_perm_b32 v167, v31, v27, s31
    v_perm_b32 v168, v39, v35, s30
    v_perm_b32 v169, v47, v43, s30
    v_perm_b32 v170, v55, v51, s30
    v_perm_b32 v171, v63, v59, s30
    v_perm_b32 v172, v39, v35, s31
    v_perm_b32 v173, v47, v43, s31
    v_perm_b32 v174, v55, v51, s31
    v_perm_b32 v175, v63, v59, s31
    v_cvt_pk_bf16_f32 v2, v176, v180
    v_cvt_pk_bf16_f32 v6, v177, v181
    v_cvt_pk_bf16_f32 v10, v178, v182
    v_cvt_pk_bf16_f32 v14, v179, v183
    v_cvt_pk_bf16_f32 v18, v184, v188
    v_cvt_pk_bf16_f32 v22, v185, v189
    v_cvt_pk_bf16_f32 v26, v186, v190
    v_cvt_pk_bf16_f32 v30, v187, v191
    v_cvt_pk_bf16_f32 v34, v192, v196
    v_cvt_pk_bf16_f32 v38, v193, v197
    v_cvt_pk_bf16_f32 v42, v194, v198
    v_cvt_pk_bf16_f32 v46, v195, v199
    v_cvt_pk_bf16_f32 v50, v200, v204
    v_cvt_pk_bf16_f32 v54, v201, v205
    v_cvt_pk_bf16_f32 v58, v202, v206
    v_cvt_pk_bf16_f32 v62, v203, v207
    v_mfma_f32_16x16x32_bf16 v[176:179], v[128:131], v[160:163], 0
    v_mfma_f32_16x16x32_bf16 v[180:183], v[128:131], v[164:167], 0
    v_mfma_f32_16x16x32_bf16 v[184:187], v[136:139], v[160:163], 0
    v_mfma_f32_16x16x32_bf16 v[188:191], v[136:139], v[164:167], 0
    v_mfma_f32_16x16x32_bf16 v[192:195], v[144:147], v[160:163], 0
    v_mfma_f32_16x16x32_bf16 v[196:199], v[144:147], v[164:167], 0
    v_mfma_f32_16x16x32_bf16 v[200:203], v[152:155], v[160:163], 0
    v_mfma_f32_16x16x32_bf16 v[204:207], v[152:155], v[164:167], 0
    v_mfma_f32_16x16x32_bf16 v[176:179], v[132:135], v[168:171], v[176:179]
    v_mfma_f32_16x16x32_bf16 v[180:183], v[132:135], v[172:175], v[180:183]
    v_mfma_f32_16x16x32_bf16 v[184:187], v[140:143], v[168:171], v[184:187]
    v_mfma_f32_16x16x32_bf16 v[188:191], v[140:143], v[172:175], v[188:191]
    v_mfma_f32_16x16x32_bf16 v[192:195], v[148:151], v[168:171], v[192:195]
    v_mfma_f32_16x16x32_bf16 v[196:199], v[148:151], v[172:175], v[196:199]
    v_mfma_f32_16x16x32_bf16 v[200:203], v[156:159], v[168:171], v[200:203]
    v_mfma_f32_16x16x32_bf16 v[204:207], v[156:159], v[172:175], v[204:207]
    s_nop 1
    v_cvt_pk_bf16_f32 v3, v176, v180
    v_cvt_pk_bf16_f32 v7, v177, v181
    v_cvt_pk_bf16_f32 v11, v178, v182
    v_cvt_pk_bf16_f32 v15, v179, v183
    v_cvt_pk_bf16_f32 v19, v184, v188
    v_cvt_pk_bf16_f32 v23, v185, v189
    v_cvt_pk_bf16_f32 v27, v186, v190
    v_cvt_pk_bf16_f32 v31, v187, v191
    v_cvt_pk_bf16_f32 v35, v192, v196
    v_cvt_pk_bf16_f32 v39, v193, v197
    v_cvt_pk_bf16_f32 v43, v194, v198
    v_cvt_pk_bf16_f32 v47, v195, v199
    v_cvt_pk_bf16_f32 v51, v200, v204
    v_cvt_pk_bf16_f32 v55, v201, v205
    v_cvt_pk_bf16_f32 v59, v202, v206
    v_cvt_pk_bf16_f32 v63, v203, v207
    s_add_u32 s25, s24, 0
    buffer_store_dwordx4 v[0:3], v212, s[16:19], s25 offen sc1
    s_add_u32 s25, s24, 10752
    buffer_store_dwordx4 v[4:7], v212, s[16:19], s25 offen sc1
    s_add_u32 s25, s24, 21504
    buffer_store_dwordx4 v[8:11], v212, s[16:19], s25 offen sc1
    s_add_u32 s25, s24, 32256
    buffer_store_dwordx4 v[12:15], v212, s[16:19], s25 offen sc1
    s_add_u32 s25, s24, 172032
    buffer_store_dwordx4 v[16:19], v212, s[16:19], s25 offen sc1
    s_add_u32 s25, s24, 182784
    buffer_store_dwordx4 v[20:23], v212, s[16:19], s25 offen sc1
    s_add_u32 s25, s24, 193536
    buffer_store_dwordx4 v[24:27], v212, s[16:19], s25 offen sc1
    s_add_u32 s25, s24, 204288
    buffer_store_dwordx4 v[28:31], v212, s[16:19], s25 offen sc1
    s_add_u32 s25, s24, 344064
    buffer_store_dwordx4 v[32:35], v212, s[16:19], s25 offen sc1
    s_add_u32 s25, s24, 354816
    buffer_store_dwordx4 v[36:39], v212, s[16:19], s25 offen sc1
    s_add_u32 s25, s24, 365568
    buffer_store_dwordx4 v[40:43], v212, s[16:19], s25 offen sc1
    s_add_u32 s25, s24, 376320
    buffer_store_dwordx4 v[44:47], v212, s[16:19], s25 offen sc1
    s_add_u32 s25, s24, 516096
    buffer_store_dwordx4 v[48:51], v212, s[16:19], s25 offen sc1
    s_add_u32 s25, s24, 526848
    buffer_store_dwordx4 v[52:55], v212, s[16:19], s25 offen sc1
    s_add_u32 s25, s24, 537600
    buffer_store_dwordx4 v[56:59], v212, s[16:19], s25 offen sc1
    s_add_u32 s25, s24, 548352
    buffer_store_dwordx4 v[60:63], v212, s[16:19], s25 offen sc1
    s_branch L_next0
L_cw0:
    s_sub_u32 s12, s40, 672
    s_and_b32 s13, s12, 3
    s_lshr_b32 s14, s12, 2
    s_lshl_b32 s14, s14, 2
    s_add_u32 s14, s14, s10
    ds_read_b128 v[128:131], v223 offset:8192
    ds_read_b128 v[132:135], v223 offset:9216
    ds_read_b128 v[136:139], v223 offset:10240
    ds_read_b128 v[140:143], v223 offset:11264
    s_and_b32 s24, s14, 3
    s_bfe_u32 s25, s14, 0x10003
    s_lshl_b32 s25, s25, 2
    s_or_b32 s24, s24, s25
    s_lshl_b32 s24, s24, 1
    v_xor_b32 v213, s24, v209
    v_lshl_add_u32 v212, v213, 4, v227
    s_mul_i32 s24, s13, 16777216
    s_lshr_b32 s25, s14, 5
    s_mul_i32 s25, s25, 524288
    s_add_u32 s24, s24, s25
    s_and_b32 s25, s14, 31
    s_lshl_b32 s25, s25, 8
    s_add_u32 s24, s24, s25
    v_perm_b32 v16, v0, v0, s32
    v_perm_b32 v17, v4, v4, s32
    v_perm_b32 v18, v8, v8, s32
    v_perm_b32 v19, v12, v12, s32
    v_perm_b32 v20, v0, v0, s33
    v_perm_b32 v21, v4, v4, s33
    v_perm_b32 v22, v8, v8, s33
    v_perm_b32 v23, v12, v12, s33
    v_perm_b32 v24, v1, v1, s32
    v_perm_b32 v25, v5, v5, s32
    v_perm_b32 v26, v9, v9, s32
    v_perm_b32 v27, v13, v13, s32
    v_perm_b32 v28, v1, v1, s33
    v_perm_b32 v29, v5, v5, s33
    v_perm_b32 v30, v9, v9, s33
    v_perm_b32 v31, v13, v13, s33
    v_perm_b32 v32, v2, v2, s32
    v_perm_b32 v33, v6, v6, s32
    v_perm_b32 v34, v10, v10, s32
    v_perm_b32 v35, v14, v14, s32
    v_perm_b32 v36, v2, v2, s33
    v_perm_b32 v37, v6, v6, s33
    v_perm_b32 v38, v10, v10, s33
    v_perm_b32 v39, v14, v14, s33
    v_perm_b32 v40, v3, v3, s32
    v_perm_b32 v41, v7, v7, s32
    v_perm_b32 v42, v11, v11, s32
    v_perm_b32 v43, v15, v15, s32
    v_perm_b32 v44, v3, v3, s33
    v_perm_b32 v45, v7, v7, s33
    v_perm_b32 v46, v11, v11, s33
    v_perm_b32 v47, v15, v15, s33
    s_waitcnt lgkmcnt(0)
    v_mfma_f32_16x16x32_bf16 v[176:179], v[128:131], v[16:19], 0
    v_mfma_f32_16x16x32_bf16 v[180:183], v[128:131], v[20:23], 0
    v_mfma_f32_16x16x32_bf16 v[184:187], v[128:131], v[24:27], 0
    v_mfma_f32_16x16x32_bf16 v[188:191], v[128:131], v[28:31], 0
    v_mfma_f32_16x16x32_bf16 v[192:195], v[128:131], v[32:35], 0
    v_mfma_f32_16x16x32_bf16 v[196:199], v[128:131], v[36:39], 0
    v_mfma_f32_16x16x32_bf16 v[200:203], v[128:131], v[40:43], 0
    v_mfma_f32_16x16x32_bf16 v[204:207], v[128:131], v[44:47], 0
    s_nop 1
    v_cvt_pk_bf16_f32 v0, v176, v180
    s_nop 0
    v_cvt_pk_bf16_f32 v1, v184, v188
    s_nop 0
    v_cvt_pk_bf16_f32 v2, v192, v196
    s_nop 0
    v_cvt_pk_bf16_f32 v3, v200, v204
    v_cvt_pk_bf16_f32 v4, v177, v181
    v_cvt_pk_bf16_f32 v5, v185, v189
    v_cvt_pk_bf16_f32 v6, v193, v197
    v_cvt_pk_bf16_f32 v7, v201, v205
    v_cvt_pk_bf16_f32 v8, v178, v182
    v_cvt_pk_bf16_f32 v9, v186, v190
    v_cvt_pk_bf16_f32 v10, v194, v198
    v_cvt_pk_bf16_f32 v11, v202, v206
    v_cvt_pk_bf16_f32 v12, v179, v183
    v_cvt_pk_bf16_f32 v13, v187, v191
    v_cvt_pk_bf16_f32 v14, v195, v199
    v_cvt_pk_bf16_f32 v15, v203, v207
    s_add_u32 s25, s24, 0
    buffer_store_dwordx4 v[0:3], v212, s[16:19], s25 offen sc1
    s_add_u32 s25, s24, 8192
    buffer_store_dwordx4 v[4:7], v212, s[16:19], s25 offen sc1
    s_add_u32 s25, s24, 16384
    buffer_store_dwordx4 v[8:11], v212, s[16:19], s25 offen sc1
    s_add_u32 s25, s24, 24576
    buffer_store_dwordx4 v[12:15], v212, s[16:19], s25 offen sc1
    v_mfma_f32_16x16x32_bf16 v[176:179], v[132:135], v[16:19], 0
    v_mfma_f32_16x16x32_bf16 v[180:183], v[132:135], v[20:23], 0
    v_mfma_f32_16x16x32_bf16 v[184:187], v[132:135], v[24:27], 0
    v_mfma_f32_16x16x32_bf16 v[188:191], v[132:135], v[28:31], 0
    v_mfma_f32_16x16x32_bf16 v[192:195], v[132:135], v[32:35], 0
    v_mfma_f32_16x16x32_bf16 v[196:199], v[132:135], v[36:39], 0
    v_mfma_f32_16x16x32_bf16 v[200:203], v[132:135], v[40:43], 0
    v_mfma_f32_16x16x32_bf16 v[204:207], v[132:135], v[44:47], 0
    s_nop 1
    v_cvt_pk_bf16_f32 v48, v176, v180
    s_nop 0
    v_cvt_pk_bf16_f32 v49, v184, v188
    s_nop 0
    v_cvt_pk_bf16_f32 v50, v192, v196
    s_nop 0
    v_cvt_pk_bf16_f32 v51, v200, v204
    v_cvt_pk_bf16_f32 v52, v177, v181
    v_cvt_pk_bf16_f32 v53, v185, v189
    v_cvt_pk_bf16_f32 v54, v193, v197
    v_cvt_pk_bf16_f32 v55, v201, v205
    v_cvt_pk_bf16_f32 v56, v178, v182
    v_cvt_pk_bf16_f32 v57, v186, v190
    v_cvt_pk_bf16_f32 v58, v194, v198
    v_cvt_pk_bf16_f32 v59, v202, v206
    v_cvt_pk_bf16_f32 v60, v179, v183
    v_cvt_pk_bf16_f32 v61, v187, v191
    v_cvt_pk_bf16_f32 v62, v195, v199
    v_cvt_pk_bf16_f32 v63, v203, v207
    s_add_u32 s25, s24, 131072
    buffer_store_dwordx4 v[48:51], v212, s[16:19], s25 offen sc1
    s_add_u32 s25, s24, 139264
    buffer_store_dwordx4 v[52:55], v212, s[16:19], s25 offen sc1
    s_add_u32 s25, s24, 147456
    buffer_store_dwordx4 v[56:59], v212, s[16:19], s25 offen sc1
    s_add_u32 s25, s24, 155648
    buffer_store_dwordx4 v[60:63], v212, s[16:19], s25 offen sc1
    v_mfma_f32_16x16x32_bf16 v[176:179], v[136:139], v[16:19], 0
    v_mfma_f32_16x16x32_bf16 v[180:183], v[136:139], v[20:23], 0
    v_mfma_f32_16x16x32_bf16 v[184:187], v[136:139], v[24:27], 0
    v_mfma_f32_16x16x32_bf16 v[188:191], v[136:139], v[28:31], 0
    v_mfma_f32_16x16x32_bf16 v[192:195], v[136:139], v[32:35], 0
    v_mfma_f32_16x16x32_bf16 v[196:199], v[136:139], v[36:39], 0
    v_mfma_f32_16x16x32_bf16 v[200:203], v[136:139], v[40:43], 0
    v_mfma_f32_16x16x32_bf16 v[204:207], v[136:139], v[44:47], 0
    s_nop 1
    v_cvt_pk_bf16_f32 v0, v176, v180
    s_nop 0
    v_cvt_pk_bf16_f32 v1, v184, v188
    s_nop 0
    v_cvt_pk_bf16_f32 v2, v192, v196
    s_nop 0
    v_cvt_pk_bf16_f32 v3, v200, v204
    v_cvt_pk_bf16_f32 v4, v177, v181
    v_cvt_pk_bf16_f32 v5, v185, v189
    v_cvt_pk_bf16_f32 v6, v193, v197
    v_cvt_pk_bf16_f32 v7, v201, v205
    v_cvt_pk_bf16_f32 v8, v178, v182
    v_cvt_pk_bf16_f32 v9, v186, v190
    v_cvt_pk_bf16_f32 v10, v194, v198
    v_cvt_pk_bf16_f32 v11, v202, v206
    v_cvt_pk_bf16_f32 v12, v179, v183
    v_cvt_pk_bf16_f32 v13, v187, v191
    v_cvt_pk_bf16_f32 v14, v195, v199
    v_cvt_pk_bf16_f32 v15, v203, v207
    s_add_u32 s25, s24, 262144
    buffer_store_dwordx4 v[0:3], v212, s[16:19], s25 offen sc1
    s_add_u32 s25, s24, 270336
    buffer_store_dwordx4 v[4:7], v212, s[16:19], s25 offen sc1
    s_add_u32 s25, s24, 278528
    buffer_store_dwordx4 v[8:11], v212, s[16:19], s25 offen sc1
    s_add_u32 s25, s24, 286720
    buffer_store_dwordx4 v[12:15], v212, s[16:19], s25 offen sc1
    v_mfma_f32_16x16x32_bf16 v[176:179], v[140:143], v[16:19], 0
    v_mfma_f32_16x16x32_bf16 v[180:183], v[140:143], v[20:23], 0
    v_mfma_f32_16x16x32_bf16 v[184:187], v[140:143], v[24:27], 0
    v_mfma_f32_16x16x32_bf16 v[188:191], v[140:143], v[28:31], 0
    v_mfma_f32_16x16x32_bf16 v[192:195], v[140:143], v[32:35], 0
    v_mfma_f32_16x16x32_bf16 v[196:199], v[140:143], v[36:39], 0
    v_mfma_f32_16x16x32_bf16 v[200:203], v[140:143], v[40:43], 0
    v_mfma_f32_16x16x32_bf16 v[204:207], v[140:143], v[44:47], 0
    s_nop 1
    v_cvt_pk_bf16_f32 v48, v176, v180
    s_nop 0
    v_cvt_pk_bf16_f32 v49, v184, v188
    s_nop 0
    v_cvt_pk_bf16_f32 v50, v192, v196
    s_nop 0
    v_cvt_pk_bf16_f32 v51, v200, v204
    v_cvt_pk_bf16_f32 v52, v177, v181
    v_cvt_pk_bf16_f32 v53, v185, v189
    v_cvt_pk_bf16_f32 v54, v193, v197
    v_cvt_pk_bf16_f32 v55, v201, v205
    v_cvt_pk_bf16_f32 v56, v178, v182
    v_cvt_pk_bf16_f32 v57, v186, v190
    v_cvt_pk_bf16_f32 v58, v194, v198
    v_cvt_pk_bf16_f32 v59, v202, v206
    v_cvt_pk_bf16_f32 v60, v179, v183
    v_cvt_pk_bf16_f32 v61, v187, v191
    v_cvt_pk_bf16_f32 v62, v195, v199
    v_cvt_pk_bf16_f32 v63, v203, v207
    s_add_u32 s25, s24, 393216
    buffer_store_dwordx4 v[48:51], v212, s[16:19], s25 offen sc1
    s_add_u32 s25, s24, 401408
    buffer_store_dwordx4 v[52:55], v212, s[16:19], s25 offen sc1
    s_add_u32 s25, s24, 409600
    buffer_store_dwordx4 v[56:59], v212, s[16:19], s25 offen sc1
    s_add_u32 s25, s24, 417792
    buffer_store_dwordx4 v[60:63], v212, s[16:19], s25 offen sc1
L_next0:
    s_cmp_lg_u32 s10, 0
    s_cbranch_scc1 L_pub0
    s_cmp_ge_u32 s42, 1696
    s_cbranch_scc1 L_w0_p0
    s_cmp_ge_u32 s42, 672
    s_cbranch_scc1 L_w8_p0
    s_waitcnt vmcnt(32)
    s_branch L_wd_p0
L_w8_p0:
    s_waitcnt vmcnt(24)
    s_branch L_wd_p0
L_w0_p0:
    s_waitcnt vmcnt(16)
L_wd_p0:
    v_add_u32 v221, 512, v221
    v_mov_b32 v213, s41
    s_mov_b64 exec, 1
    ds_write_b32 v213, v221 offset:12288
    s_mov_b64 exec, -1
L_pub0:
    s_waitcnt lgkmcnt(0)
    s_barrier
    v_mov_b32 v213, s41
    ds_read_b32 v214, v213 offset:12288
    s_xor_b32 s41, s41, 4
    s_mov_b32 s40, s42
    s_waitcnt lgkmcnt(0)
    v_readfirstlane_b32 s42, v214
    s_nop 3
    s_cmp_ge_u32 s42, 768
    s_cbranch_scc1 L_rm4
    s_sub_u32 s28, s42, 96
    s_add_u32 s29, s42, 672
    s_cmp_ge_u32 s42, 96
    s_cselect_b32 s42, s28, s29
L_rm4:
    s_cmp_ge_u32 s40, 1696
    s_cbranch_scc1 L_k12_fin
    s_cmp_lg_u32 s10, 0
    s_cbranch_scc1 L_nofetch1
    v_mov_b32 v221, 1
    s_mov_b64 exec, 1
    buffer_atomic_add v221, v222, s[44:47], 0 offen sc0 sc1
    s_mov_b64 exec, -1
L_nofetch1:
    s_cmp_ge_u32 s42, 1696
    s_cbranch_scc1 L_ld_done5
    s_cmp_ge_u32 s42, 672
    s_cbranch_scc1 L_ld_w5
    s_cmp_ge_u32 s42, 336
    s_cselect_b32 s11, 1, 0
    s_mul_i32 s12, s11, 336
    s_sub_u32 s12, s42, s12
    s_and_b32 s13, s12, 7
    s_lshr_b32 s14, s12, 3
    s_lshl_b32 s14, s14, 2
    s_add_u32 s14, s14, s10
    s_mul_i32 s15, s11, 16384000
    s_add_u32 s34, s4, s15
    s_addc_u32 s35, s5, 0
    s_mov_b32 s20, s34
    s_and_b32 s21, s35, 0xffff
    s_mov_b32 s22, 16384000
    s_mov_b32 s23, 0x00020000
    s_mul_i32 s15, s14, 98304
    s_lshl_b32 s24, s13, 8
    s_add_u32 s15, s15, s24
    s_add_u32 s25, s15, 0
    buffer_load_dwordx4 v[0:3], v224, s[20:23], s25 offen
    s_add_u32 s25, s15, 2048
    buffer_load_dwordx4 v[4:7], v224, s[20:23], s25 offen
    s_add_u32 s25, s15, 4096
    buffer_load_dwordx4 v[8:11], v224, s[20:23], s25 offen
    s_add_u32 s25, s15, 6144
    buffer_load_dwordx4 v[12:15], v224, s[20:23], s25 offen
    s_add_u32 s25, s15, 8192
    buffer_load_dwordx4 v[16:19], v224, s[20:23], s25 offen
    s_add_u32 s25, s15, 10240
    buffer_load_dwordx4 v[20:23], v224, s[20:23], s25 offen
    s_add_u32 s25, s15, 12288
    buffer_load_dwordx4 v[24:27], v224, s[20:23], s25 offen
    s_add_u32 s25, s15, 14336
    buffer_load_dwordx4 v[28:31], v224, s[20:23], s25 offen
    s_add_u32 s25, s15, 65536
    buffer_load_dwordx4 v[32:35], v224, s[20:23], s25 offen
    s_add_u32 s25, s15, 67584
    buffer_load_dwordx4 v[36:39], v224, s[20:23], s25 offen
    s_add_u32 s25, s15, 69632
    buffer_load_dwordx4 v[40:43], v224, s[20:23], s25 offen
    s_add_u32 s25, s15, 71680
    buffer_load_dwordx4 v[44:47], v224, s[20:23], s25 offen
    s_add_u32 s25, s15, 73728
    buffer_load_dwordx4 v[48:51], v224, s[20:23], s25 offen
    s_add_u32 s25, s15, 75776
    buffer_load_dwordx4 v[52:55], v224, s[20:23], s25 offen
    s_add_u32 s25, s15, 77824
    buffer_load_dwordx4 v[56:59], v224, s[20:23], s25 offen
    s_add_u32 s25, s15, 79872
    buffer_load_dwordx4 v[60:63], v224, s[20:23], s25 offen
    s_branch L_ld_done5
L_ld_w5:
    s_sub_u32 s12, s42, 672
    s_and_b32 s13, s12, 3
    s_lshr_b32 s14, s12, 2
    s_lshl_b32 s14, s14, 2
    s_add_u32 s14, s14, s10
    s_mov_b32 s20, s6
    s_and_b32 s21, s7, 0xffff
    s_mov_b32 s22, 16252928
    s_mov_b32 s23, 0x00020000
    s_lshl_b32 s15, s14, 10
    s_lshl_b32 s24, s13, 8
    s_add_u32 s15, s15, s24
    s_add_u32 s25, s15, 0
    buffer_load_dwordx2 v[0:1], v225, s[20:23], s25 offen
    buffer_load_dwordx2 v[2:3], v225, s[20:23], s25 offen offset:16
    s_add_u32 s25, s15, 1048576
    buffer_load_dwordx2 v[4:5], v225, s[20:23], s25 offen
    buffer_load_dwordx2 v[6:7], v225, s[20:23], s25 offen offset:16
    s_add_u32 s25, s15, 2097152
    buffer_load_dwordx2 v[8:9], v225, s[20:23], s25 offen
    buffer_load_dwordx2 v[10:11], v225, s[20:23], s25 offen offset:16
    s_add_u32 s25, s15, 3145728
    buffer_load_dwordx2 v[12:13], v225, s[20:23], s25 offen
    buffer_load_dwordx2 v[14:15], v225, s[20:23], s25 offen offset:16
L_ld_done5:
    s_cmp_ge_u32 s42, 1696
    s_cbranch_scc1 L_w0_a1
    s_cmp_ge_u32 s42, 672
    s_cbranch_scc1 L_w8_a1
    s_waitcnt vmcnt(32)
    s_branch L_wd_a1
L_w8_a1:
    s_waitcnt vmcnt(24)
    s_branch L_wd_a1
L_w0_a1:
    s_waitcnt vmcnt(16)
L_wd_a1:
    s_cmp_ge_u32 s40, 672
    s_cbranch_scc1 L_cw1
    s_cmp_ge_u32 s40, 336
    s_cselect_b32 s11, 1, 0
    s_mul_i32 s12, s11, 336
    s_sub_u32 s12, s40, s12
    s_and_b32 s13, s12, 7
    s_lshr_b32 s14, s12, 3
    s_lshl_b32 s14, s14, 2
    s_add_u32 s14, s14, s10
    ds_read_b128 v[128:131], v223 offset:0
    ds_read_b128 v[132:135], v223 offset:1024
    ds_read_b128 v[136:139], v223 offset:2048
    ds_read_b128 v[140:143], v223 offset:3072
    ds_read_b128 v[144:147], v223 offset:4096
    ds_read_b128 v[148:151], v223 offset:5120
    ds_read_b128 v[152:155], v223 offset:6144
    ds_read_b128 v[156:159], v223 offset:7168
    s_bfe_u32 s24, s14, 0x10003
    s_mul_i32 s24, s24, 3
    v_and_b32 v213, 3, v209
    v_xor_b32 v213, s24, v213
    v_lshl_add_u32 v212, v213, 4, v226
    s_mul_i32 s24, s11, 22020096
    s_mul_i32 s25, s13, 2752512
    s_add_u32 s24, s24, s25
    s_lshl_b32 s25, s14, 6
    s_add_u32 s24, s24, s25
    s_add_u32 s24, s24, 67108864
    v_perm_b32 v160, v68, v64, s30
    v_perm_b32 v161, v76, v72, s30
    v_perm_b32 v162, v84, v80, s30
    v_perm_b32 v163, v92, v88, s30
    v_perm_b32 v164, v68, v64, s31
    v_perm_b32 v165, v76, v72, s31
    v_perm_b32 v166, v84, v80, s31
    v_perm_b32 v167, v92, v88, s31
    v_perm_b32 v168, v100, v96, s30
    v_perm_b32 v169, v108, v104, s30
    v_perm_b32 v170, v116, v112, s30
    v_perm_b32 v171, v124, v120, s30
    v_perm_b32 v172, v100, v96, s31
    v_perm_b32 v173, v108, v104, s31
    v_perm_b32 v174, v116, v112, s31
    v_perm_b32 v175, v124, v120, s31
    s_waitcnt lgkmcnt(0)
    v_mfma_f32_16x16x32_bf16 v[176:179], v[128:131], v[160:163], 0
    v_mfma_f32_16x16x32_bf16 v[180:183], v[128:131], v[164:167], 0
    v_mfma_f32_16x16x32_bf16 v[184:187], v[136:139], v[160:163], 0
    v_mfma_f32_16x16x32_bf16 v[188:191], v[136:139], v[164:167], 0
    v_mfma_f32_16x16x32_bf16 v[192:195], v[144:147], v[160:163], 0
    v_mfma_f32_16x16x32_bf16 v[196:199], v[144:147], v[164:167], 0
    v_mfma_f32_16x16x32_bf16 v[200:203], v[152:155], v[160:163], 0
    v_mfma_f32_16x16x32_bf16 v[204:207], v[152:155], v[164:167], 0
    v_mfma_f32_16x16x32_bf16 v[176:179], v[132:135], v[168:171], v[176:179]
    v_mfma_f32_16x16x32_bf16 v[180:183], v[132:135], v[172:175], v[180:183]
    v_mfma_f32_16x16x32_bf16 v[184:187], v[140:143], v[168:171], v[184:187]
    v_mfma_f32_16x16x32_bf16 v[188:191], v[140:143], v[172:175], v[188:191]
    v_mfma_f32_16x16x32_bf16 v[192:195], v[148:151], v[168:171], v[192:195]
    v_mfma_f32_16x16x32_bf16 v[196:199], v[148:151], v[172:175], v[196:199]
    v_mfma_f32_16x16x32_bf16 v[200:203], v[156:159], v[168:171], v[200:203]
    v_mfma_f32_16x16x32_bf16 v[204:207], v[156:159], v[172:175], v[204:207]
    v_perm_b32 v160, v69, v65, s30
    v_perm_b32 v161, v77, v73, s30
    v_perm_b32 v162, v85, v81, s30
    v_perm_b32 v163, v93, v89, s30
    v_perm_b32 v164, v69, v65, s31
    v_perm_b32 v165, v77, v73, s31
    v_perm_b32 v166, v85, v81, s31
    v_perm_b32 v167, v93, v89, s31
    v_perm_b32 v168, v101, v97, s30
    v_perm_b32 v169, v109, v105, s30
    v_perm_b32 v170, v117, v113, s30
    v_perm_b32 v171, v125, v121, s30
    v_perm_b32 v172, v101, v97, s31
    v_perm_b32 v173, v109, v105, s31
    v_perm_b32 v174, v117, v113, s31
    v_perm_b32 v175, v125, v121, s31
    v_cvt_pk_bf16_f32 v64, v176, v180
    v_cvt_pk_bf16_f32 v68, v177, v181
    v_cvt_pk_bf16_f32 v72, v178, v182
    v_cvt_pk_bf16_f32 v76, v179, v183
    v_cvt_pk_bf16_f32 v80, v184, v188
    v_cvt_pk_bf16_f32 v84, v185, v189
    v_cvt_pk_bf16_f32 v88, v186, v190
    v_cvt_pk_bf16_f32 v92, v187, v191
    v_cvt_pk_bf16_f32 v96, v192, v196
    v_cvt_pk_bf16_f32 v100, v193, v197
    v_cvt_pk_bf16_f32 v104, v194, v198
    v_cvt_pk_bf16_f32 v108, v195, v199
    v_cvt_pk_bf16_f32 v112, v200, v204
    v_cvt_pk_bf16_f32 v116, v201, v205
    v_cvt_pk_bf16_f32 v120, v202, v206
    v_cvt_pk_bf16_f32 v124, v203, v207
    v_mfma_f32_16x16x32_bf16 v[176:179], v[128:131], v[160:163], 0
    v_mfma_f32_16x16x32_bf16 v[180:183], v[128:131], v[164:167], 0
    v_mfma_f32_16x16x32_bf16 v[184:187], v[136:139], v[160:163], 0
    v_mfma_f32_16x16x32_bf16 v[188:191], v[136:139], v[164:167], 0
    v_mfma_f32_16x16x32_bf16 v[192:195], v[144:147], v[160:163], 0
    v_mfma_f32_16x16x32_bf16 v[196:199], v[144:147], v[164:167], 0
    v_mfma_f32_16x16x32_bf16 v[200:203], v[152:155], v[160:163], 0
    v_mfma_f32_16x16x32_bf16 v[204:207], v[152:155], v[164:167], 0
    v_mfma_f32_16x16x32_bf16 v[176:179], v[132:135], v[168:171], v[176:179]
    v_mfma_f32_16x16x32_bf16 v[180:183], v[132:135], v[172:175], v[180:183]
    v_mfma_f32_16x16x32_bf16 v[184:187], v[140:143], v[168:171], v[184:187]
    v_mfma_f32_16x16x32_bf16 v[188:191], v[140:143], v[172:175], v[188:191]
    v_mfma_f32_16x16x32_bf16 v[192:195], v[148:151], v[168:171], v[192:195]
    v_mfma_f32_16x16x32_bf16 v[196:199], v[148:151], v[172:175], v[196:199]
    v_mfma_f32_16x16x32_bf16 v[200:203], v[156:159], v[168:171], v[200:203]
    v_mfma_f32_16x16x32_bf16 v[204:207], v[156:159], v[172:175], v[204:207]
    v_perm_b32 v160, v70, v66, s30
    v_perm_b32 v161, v78, v74, s30
    v_perm_b32 v162, v86, v82, s30
    v_perm_b32 v163, v94, v90, s30
    v_perm_b32 v164, v70, v66, s31
    v_perm_b32 v165, v78, v74, s31
    v_perm_b32 v166, v86, v82, s31
    v_perm_b32 v167, v94, v90, s31
    v_perm_b32 v168, v102, v98, s30
    v_perm_b32 v169, v110, v106, s30
    v_perm_b32 v170, v118, v114, s30
    v_perm_b32 v171, v126, v122, s30
    v_perm_b32 v172, v102, v98, s31
    v_perm_b32 v173, v110, v106, s31
    v_perm_b32 v174, v118, v114, s31
    v_perm_b32 v175, v126, v122, s31
    v_cvt_pk_bf16_f32 v65, v176, v180
    v_cvt_pk_bf16_f32 v69, v177, v181
    v_cvt_pk_bf16_f32 v73, v178, v182
    v_cvt_pk_bf16_f32 v77, v179, v183
    v_cvt_pk_bf16_f32 v81, v184, v188
    v_cvt_pk_bf16_f32 v85, v185, v189
    v_cvt_pk_bf16_f32 v89, v186, v190
    v_cvt_pk_bf16_f32 v93, v187, v191
    v_cvt_pk_bf16_f32 v97, v192, v196
    v_cvt_pk_bf16_f32 v101, v193, v197
    v_cvt_pk_bf16_f32 v105, v194, v198
    v_cvt_pk_bf16_f32 v109, v195, v199
    v_cvt_pk_bf16_f32 v113, v200, v204
    v_cvt_pk_bf16_f32 v117, v201, v205
    v_cvt_pk_bf16_f32 v121, v202, v206
    v_cvt_pk_bf16_f32 v125, v203, v207
    v_mfma_f32_16x16x32_bf16 v[176:179], v[128:131], v[160:163], 0
    v_mfma_f32_16x16x32_bf16 v[180:183], v[128:131], v[164:167], 0
    v_mfma_f32_16x16x32_bf16 v[184:187], v[136:139], v[160:163], 0
    v_mfma_f32_16x16x32_bf16 v[188:191], v[136:139], v[164:167], 0
    v_mfma_f32_16x16x32_bf16 v[192:195], v[144:147], v[160:163], 0
    v_mfma_f32_16x16x32_bf16 v[196:199], v[144:147], v[164:167], 0
    v_mfma_f32_16x16x32_bf16 v[200:203], v[152:155], v[160:163], 0
    v_mfma_f32_16x16x32_bf16 v[204:207], v[152:155], v[164:167], 0
    v_mfma_f32_16x16x32_bf16 v[176:179], v[132:135], v[168:171], v[176:179]
    v_mfma_f32_16x16x32_bf16 v[180:183], v[132:135], v[172:175], v[180:183]
    v_mfma_f32_16x16x32_bf16 v[184:187], v[140:143], v[168:171], v[184:187]
    v_mfma_f32_16x16x32_bf16 v[188:191], v[140:143], v[172:175], v[188:191]
    v_mfma_f32_16x16x32_bf16 v[192:195], v[148:151], v[168:171], v[192:195]
    v_mfma_f32_16x16x32_bf16 v[196:199], v[148:151], v[172:175], v[196:199]
    v_mfma_f32_16x16x32_bf16 v[200:203], v[156:159], v[168:171], v[200:203]
    v_mfma_f32_16x16x32_bf16 v[204:207], v[156:159], v[172:175], v[204:207]
    v_perm_b32 v160, v71, v67, s30
    v_perm_b32 v161, v79, v75, s30
    v_perm_b32 v162, v87, v83, s30
    v_perm_b32 v163, v95, v91, s30
    v_perm_b32 v164, v71, v67, s31
    v_perm_b32 v165, v79, v75, s31
    v_perm_b32 v166, v87, v83, s31
    v_perm_b32 v167, v95, v91, s31
    v_perm_b32 v168, v103, v99, s30
    v_perm_b32 v169, v111, v107, s30
    v_perm_b32 v170, v119, v115, s30
    v_perm_b32 v171, v127, v123, s30
    v_perm_b32 v172, v103, v99, s31
    v_perm_b32 v173, v111, v107, s31
    v_perm_b32 v174, v119, v115, s31
    v_perm_b32 v175, v127, v123, s31
    v_cvt_pk_bf16_f32 v66, v176, v180
    v_cvt_pk_bf16_f32 v70, v177, v181
    v_cvt_pk_bf16_f32 v74, v178, v182
    v_cvt_pk_bf16_f32 v78, v179, v183
    v_cvt_pk_bf16_f32 v82, v184, v188
    v_cvt_pk_bf16_f32 v86, v185, v189
    v_cvt_pk_bf16_f32 v90, v186, v190
    v_cvt_pk_bf16_f32 v94, v187, v191
    v_cvt_pk_bf16_f32 v98, v192, v196
    v_cvt_pk_bf16_f32 v102, v193, v197
    v_cvt_pk_bf16_f32 v106, v194, v198
    v_cvt_pk_bf16_f32 v110, v195, v199
    v_cvt_pk_bf16_f32 v114, v200, v204
    v_cvt_pk_bf16_f32 v118, v201, v205
    v_cvt_pk_bf16_f32 v122, v202, v206
    v_cvt_pk_bf16_f32 v126, v203, v207
    v_mfma_f32_16x16x32_bf16 v[176:179], v[128:131], v[160:163], 0
    v_mfma_f32_16x16x32_bf16 v[180:183], v[128:131], v[164:167], 0
    v_mfma_f32_16x16x32_bf16 v[184:187], v[136:139], v[160:163], 0
    v_mfma_f32_16x16x32_bf16 v[188:191], v[136:139], v[164:167], 0
    v_mfma_f32_16x16x32_bf16 v[192:195], v[144:147], v[160:163], 0
    v_mfma_f32_16x16x32_bf16 v[196:199], v[144:147], v[164:167], 0
    v_mfma_f32_16x16x32_bf16 v[200:203], v[152:155], v[160:163], 0
    v_mfma_f32_16x16x32_bf16 v[204:207], v[152:155], v[164:167], 0
    v_mfma_f32_16x16x32_bf16 v[176:179], v[132:135], v[168:171], v[176:179]
    v_mfma_f32_16x16x32_bf16 v[180:183], v[132:135], v[172:175], v[180:183]
    v_mfma_f32_16x16x32_bf16 v[184:187], v[140:143], v[168:171], v[184:187]
    v_mfma_f32_16x16x32_bf16 v[188:191], v[140:143], v[172:175], v[188:191]
    v_mfma_f32_16x16x32_bf16 v[192:195], v[148:151], v[168:171], v[192:195]
    v_mfma_f32_16x16x32_bf16 v[196:199], v[148:151], v[172:175], v[196:199]
    v_mfma_f32_16x16x32_bf16 v[200:203], v[156:159], v[168:171], v[200:203]
    v_mfma_f32_16x16x32_bf16 v[204:207], v[156:159], v[172:175], v[204:207]
    s_nop 1
    v_cvt_pk_bf16_f32 v67, v176, v180
    v_cvt_pk_bf16_f32 v71, v177, v181
    v_cvt_pk_bf16_f32 v75, v178, v182
    v_cvt_pk_bf16_f32 v79, v179, v183
    v_cvt_pk_bf16_f32 v83, v184, v188
    v_cvt_pk_bf16_f32 v87, v185, v189
    v_cvt_pk_bf16_f32 v91, v186, v190
    v_cvt_pk_bf16_f32 v95, v187, v191
    v_cvt_pk_bf16_f32 v99, v192, v196
    v_cvt_pk_bf16_f32 v103, v193, v197
    v_cvt_pk_bf16_f32 v107, v194, v198
    v_cvt_pk_bf16_f32 v111, v195, v199
    v_cvt_pk_bf16_f32 v115, v200, v204
    v_cvt_pk_bf16_f32 v119, v201, v205
    v_cvt_pk_bf16_f32 v123, v202, v206
    v_cvt_pk_bf16_f32 v127, v203, v207
    s_add_u32 s25, s24, 0
    buffer_store_dwordx4 v[64:67], v212, s[16:19], s25 offen sc1
    s_add_u32 s25, s24, 10752
    buffer_store_dwordx4 v[68:71], v212, s[16:19], s25 offen sc1
    s_add_u32 s25, s24, 21504
    buffer_store_dwordx4 v[72:75], v212, s[16:19], s25 offen sc1
    s_add_u32 s25, s24, 32256
    buffer_store_dwordx4 v[76:79], v212, s[16:19], s25 offen sc1
    s_add_u32 s25, s24, 172032
    buffer_store_dwordx4 v[80:83], v212, s[16:19], s25 offen sc1
    s_add_u32 s25, s24, 182784
    buffer_store_dwordx4 v[84:87], v212, s[16:19], s25 offen sc1
    s_add_u32 s25, s24, 193536
    buffer_store_dwordx4 v[88:91], v212, s[16:19], s25 offen sc1
    s_add_u32 s25, s24, 204288
    buffer_store_dwordx4 v[92:95], v212, s[16:19], s25 offen sc1
    s_add_u32 s25, s24, 344064
    buffer_store_dwordx4 v[96:99], v212, s[16:19], s25 offen sc1
    s_add_u32 s25, s24, 354816
    buffer_store_dwordx4 v[100:103], v212, s[16:19], s25 offen sc1
    s_add_u32 s25, s24, 365568
    buffer_store_dwordx4 v[104:107], v212, s[16:19], s25 offen sc1
    s_add_u32 s25, s24, 376320
    buffer_store_dwordx4 v[108:111], v212, s[16:19], s25 offen sc1
    s_add_u32 s25, s24, 516096
    buffer_store_dwordx4 v[112:115], v212, s[16:19], s25 offen sc1
    s_add_u32 s25, s24, 526848
    buffer_store_dwordx4 v[116:119], v212, s[16:19], s25 offen sc1
    s_add_u32 s25, s24, 537600
    buffer_store_dwordx4 v[120:123], v212, s[16:19], s25 offen sc1
    s_add_u32 s25, s24, 548352
    buffer_store_dwordx4 v[124:127], v212, s[16:19], s25 offen sc1
    s_branch L_next1
L_cw1:
    s_sub_u32 s12, s40, 672
    s_and_b32 s13, s12, 3
    s_lshr_b32 s14, s12, 2
    s_lshl_b32 s14, s14, 2
    s_add_u32 s14, s14, s10
    ds_read_b128 v[128:131], v223 offset:8192
    ds_read_b128 v[132:135], v223 offset:9216
    ds_read_b128 v[136:139], v223 offset:10240
    ds_read_b128 v[140:143], v223 offset:11264
    s_and_b32 s24, s14, 3
    s_bfe_u32 s25, s14, 0x10003
    s_lshl_b32 s25, s25, 2
    s_or_b32 s24, s24, s25
    s_lshl_b32 s24, s24, 1
    v_xor_b32 v213, s24, v209
    v_lshl_add_u32 v212, v213, 4, v227
    s_mul_i32 s24, s13, 16777216
    s_lshr_b32 s25, s14, 5
    s_mul_i32 s25, s25, 524288
    s_add_u32 s24, s24, s25
    s_and_b32 s25, s14, 31
    s_lshl_b32 s25, s25, 8
    s_add_u32 s24, s24, s25
    v_perm_b32 v80, v64, v64, s32
    v_perm_b32 v81, v68, v68, s32
    v_perm_b32 v82, v72, v72, s32
    v_perm_b32 v83, v76, v76, s32
    v_perm_b32 v84, v64, v64, s33
    v_perm_b32 v85, v68, v68, s33
    v_perm_b32 v86, v72, v72, s33
    v_perm_b32 v87, v76, v76, s33
    v_perm_b32 v88, v65, v65, s32
    v_perm_b32 v89, v69, v69, s32
    v_perm_b32 v90, v73, v73, s32
    v_perm_b32 v91, v77, v77, s32
    v_perm_b32 v92, v65, v65, s33
    v_perm_b32 v93, v69, v69, s33
    v_perm_b32 v94, v73, v73, s33
    v_perm_b32 v95, v77, v77, s33
    v_perm_b32 v96, v66, v66, s32
    v_perm_b32 v97, v70, v70, s32
    v_perm_b32 v98, v74, v74, s32
    v_perm_b32 v99, v78, v78, s32
    v_perm_b32 v100, v66, v66, s33
    v_perm_b32 v101, v70, v70, s33
    v_perm_b32 v102, v74, v74, s33
    v_perm_b32 v103, v78, v78, s33
    v_perm_b32 v104, v67, v67, s32
    v_perm_b32 v105, v71, v71, s32
    v_perm_b32 v106, v75, v75, s32
    v_perm_b32 v107, v79, v79, s32
    v_perm_b32 v108, v67, v67, s33
    v_perm_b32 v109, v71, v71, s33
    v_perm_b32 v110, v75, v75, s33
    v_perm_b32 v111, v79, v79, s33
    s_waitcnt lgkmcnt(0)
    v_mfma_f32_16x16x32_bf16 v[176:179], v[128:131], v[80:83], 0
    v_mfma_f32_16x16x32_bf16 v[180:183], v[128:131], v[84:87], 0
    v_mfma_f32_16x16x32_bf16 v[184:187], v[128:131], v[88:91], 0
    v_mfma_f32_16x16x32_bf16 v[188:191], v[128:131], v[92:95], 0
    v_mfma_f32_16x16x32_bf16 v[192:195], v[128:131], v[96:99], 0
    v_mfma_f32_16x16x32_bf16 v[196:199], v[128:131], v[100:103], 0
    v_mfma_f32_16x16x32_bf16 v[200:203], v[128:131], v[104:107], 0
    v_mfma_f32_16x16x32_bf16 v[204:207], v[128:131], v[108:111], 0
    s_nop 1
    v_cvt_pk_bf16_f32 v64, v176, v180
    s_nop 0
    v_cvt_pk_bf16_f32 v65, v184, v188
    s_nop 0
    v_cvt_pk_bf16_f32 v66, v192, v196
    s_nop 0
    v_cvt_pk_bf16_f32 v67, v200, v204
    v_cvt_pk_bf16_f32 v68, v177, v181
    v_cvt_pk_bf16_f32 v69, v185, v189
    v_cvt_pk_bf16_f32 v70, v193, v197
    v_cvt_pk_bf16_f32 v71, v201, v205
    v_cvt_pk_bf16_f32 v72, v178, v182
    v_cvt_pk_bf16_f32 v73, v186, v190
    v_cvt_pk_bf16_f32 v74, v194, v198
    v_cvt_pk_bf16_f32 v75, v202, v206
    v_cvt_pk_bf16_f32 v76, v179, v183
    v_cvt_pk_bf16_f32 v77, v187, v191
    v_cvt_pk_bf16_f32 v78, v195, v199
    v_cvt_pk_bf16_f32 v79, v203, v207
    s_add_u32 s25, s24, 0
    buffer_store_dwordx4 v[64:67], v212, s[16:19], s25 offen sc1
    s_add_u32 s25, s24, 8192
    buffer_store_dwordx4 v[68:71], v212, s[16:19], s25 offen sc1
    s_add_u32 s25, s24, 16384
    buffer_store_dwordx4 v[72:75], v212, s[16:19], s25 offen sc1
    s_add_u32 s25, s24, 24576
    buffer_store_dwordx4 v[76:79], v212, s[16:19], s25 offen sc1
    v_mfma_f32_16x16x32_bf16 v[176:179], v[132:135], v[80:83], 0
    v_mfma_f32_16x16x32_bf16 v[180:183], v[132:135], v[84:87], 0
    v_mfma_f32_16x16x32_bf16 v[184:187], v[132:135], v[88:91], 0
    v_mfma_f32_16x16x32_bf16 v[188:191], v[132:135], v[92:95], 0
    v_mfma_f32_16x16x32_bf16 v[192:195], v[132:135], v[96:99], 0
    v_mfma_f32_16x16x32_bf16 v[196:199], v[132:135], v[100:103], 0
    v_mfma_f32_16x16x32_bf16 v[200:203], v[132:135], v[104:107], 0
    v_mfma_f32_16x16x32_bf16 v[204:207], v[132:135], v[108:111], 0
    s_nop 1
    v_cvt_pk_bf16_f32 v112, v176, v180
    s_nop 0
    v_cvt_pk_bf16_f32 v113, v184, v188
    s_nop 0
    v_cvt_pk_bf16_f32 v114, v192, v196
    s_nop 0
    v_cvt_pk_bf16_f32 v115, v200, v204
    v_cvt_pk_bf16_f32 v116, v177, v181
    v_cvt_pk_bf16_f32 v117, v185, v189
    v_cvt_pk_bf16_f32 v118, v193, v197
    v_cvt_pk_bf16_f32 v119, v201, v205
    v_cvt_pk_bf16_f32 v120, v178, v182
    v_cvt_pk_bf16_f32 v121, v186, v190
    v_cvt_pk_bf16_f32 v122, v194, v198
    v_cvt_pk_bf16_f32 v123, v202, v206
    v_cvt_pk_bf16_f32 v124, v179, v183
    v_cvt_pk_bf16_f32 v125, v187, v191
    v_cvt_pk_bf16_f32 v126, v195, v199
    v_cvt_pk_bf16_f32 v127, v203, v207
    s_add_u32 s25, s24, 131072
    buffer_store_dwordx4 v[112:115], v212, s[16:19], s25 offen sc1
    s_add_u32 s25, s24, 139264
    buffer_store_dwordx4 v[116:119], v212, s[16:19], s25 offen sc1
    s_add_u32 s25, s24, 147456
    buffer_store_dwordx4 v[120:123], v212, s[16:19], s25 offen sc1
    s_add_u32 s25, s24, 155648
    buffer_store_dwordx4 v[124:127], v212, s[16:19], s25 offen sc1
    v_mfma_f32_16x16x32_bf16 v[176:179], v[136:139], v[80:83], 0
    v_mfma_f32_16x16x32_bf16 v[180:183], v[136:139], v[84:87], 0
    v_mfma_f32_16x16x32_bf16 v[184:187], v[136:139], v[88:91], 0
    v_mfma_f32_16x16x32_bf16 v[188:191], v[136:139], v[92:95], 0
    v_mfma_f32_16x16x32_bf16 v[192:195], v[136:139], v[96:99], 0
    v_mfma_f32_16x16x32_bf16 v[196:199], v[136:139], v[100:103], 0
    v_mfma_f32_16x16x32_bf16 v[200:203], v[136:139], v[104:107], 0
    v_mfma_f32_16x16x32_bf16 v[204:207], v[136:139], v[108:111], 0
    s_nop 1
    v_cvt_pk_bf16_f32 v64, v176, v180
    s_nop 0
    v_cvt_pk_bf16_f32 v65, v184, v188
    s_nop 0
    v_cvt_pk_bf16_f32 v66, v192, v196
    s_nop 0
    v_cvt_pk_bf16_f32 v67, v200, v204
    v_cvt_pk_bf16_f32 v68, v177, v181
    v_cvt_pk_bf16_f32 v69, v185, v189
    v_cvt_pk_bf16_f32 v70, v193, v197
    v_cvt_pk_bf16_f32 v71, v201, v205
    v_cvt_pk_bf16_f32 v72, v178, v182
    v_cvt_pk_bf16_f32 v73, v186, v190
    v_cvt_pk_bf16_f32 v74, v194, v198
    v_cvt_pk_bf16_f32 v75, v202, v206
    v_cvt_pk_bf16_f32 v76, v179, v183
    v_cvt_pk_bf16_f32 v77, v187, v191
    v_cvt_pk_bf16_f32 v78, v195, v199
    v_cvt_pk_bf16_f32 v79, v203, v207
    s_add_u32 s25, s24, 262144
    buffer_store_dwordx4 v[64:67], v212, s[16:19], s25 offen sc1
    s_add_u32 s25, s24, 270336
    buffer_store_dwordx4 v[68:71], v212, s[16:19], s25 offen sc1
    s_add_u32 s25, s24, 278528
    buffer_store_dwordx4 v[72:75], v212, s[16:19], s25 offen sc1
    s_add_u32 s25, s24, 286720
    buffer_store_dwordx4 v[76:79], v212, s[16:19], s25 offen sc1
    v_mfma_f32_16x16x32_bf16 v[176:179], v[140:143], v[80:83], 0
    v_mfma_f32_16x16x32_bf16 v[180:183], v[140:143], v[84:87], 0
    v_mfma_f32_16x16x32_bf16 v[184:187], v[140:143], v[88:91], 0
    v_mfma_f32_16x16x32_bf16 v[188:191], v[140:143], v[92:95], 0
    v_mfma_f32_16x16x32_bf16 v[192:195], v[140:143], v[96:99], 0
    v_mfma_f32_16x16x32_bf16 v[196:199], v[140:143], v[100:103], 0
    v_mfma_f32_16x16x32_bf16 v[200:203], v[140:143], v[104:107], 0
    v_mfma_f32_16x16x32_bf16 v[204:207], v[140:143], v[108:111], 0
    s_nop 1
    v_cvt_pk_bf16_f32 v112, v176, v180
    s_nop 0
    v_cvt_pk_bf16_f32 v113, v184, v188
    s_nop 0
    v_cvt_pk_bf16_f32 v114, v192, v196
    s_nop 0
    v_cvt_pk_bf16_f32 v115, v200, v204
    v_cvt_pk_bf16_f32 v116, v177, v181
    v_cvt_pk_bf16_f32 v117, v185, v189
    v_cvt_pk_bf16_f32 v118, v193, v197
    v_cvt_pk_bf16_f32 v119, v201, v205
    v_cvt_pk_bf16_f32 v120, v178, v182
    v_cvt_pk_bf16_f32 v121, v186, v190
    v_cvt_pk_bf16_f32 v122, v194, v198
    v_cvt_pk_bf16_f32 v123, v202, v206
    v_cvt_pk_bf16_f32 v124, v179, v183
    v_cvt_pk_bf16_f32 v125, v187, v191
    v_cvt_pk_bf16_f32 v126, v195, v199
    v_cvt_pk_bf16_f32 v127, v203, v207
    s_add_u32 s25, s24, 393216
    buffer_store_dwordx4 v[112:115], v212, s[16:19], s25 offen sc1
    s_add_u32 s25, s24, 401408
    buffer_store_dwordx4 v[116:119], v212, s[16:19], s25 offen sc1
    s_add_u32 s25, s24, 409600
    buffer_store_dwordx4 v[120:123], v212, s[16:19], s25 offen sc1
    s_add_u32 s25, s24, 417792
    buffer_store_dwordx4 v[124:127], v212, s[16:19], s25 offen sc1
L_next1:
    s_cmp_lg_u32 s10, 0
    s_cbranch_scc1 L_pub1
    s_cmp_ge_u32 s42, 1696
    s_cbranch_scc1 L_w0_p1
    s_cmp_ge_u32 s42, 672
    s_cbranch_scc1 L_w8_p1
    s_waitcnt vmcnt(32)
    s_branch L_wd_p1
L_w8_p1:
    s_waitcnt vmcnt(24)
    s_branch L_wd_p1
L_w0_p1:
    s_waitcnt vmcnt(16)
L_wd_p1:
    v_add_u32 v221, 512, v221
    v_mov_b32 v213, s41
    s_mov_b64 exec, 1
    ds_write_b32 v213, v221 offset:12288
    s_mov_b64 exec, -1
L_pub1:
    s_waitcnt lgkmcnt(0)
    s_barrier
    v_mov_b32 v213, s41
    ds_read_b32 v214, v213 offset:12288
    s_xor_b32 s41, s41, 4
    s_mov_b32 s40, s42
    s_waitcnt lgkmcnt(0)
    v_readfirstlane_b32 s42, v214
    s_nop 3
    s_cmp_ge_u32 s42, 768
    s_cbranch_scc1 L_rm6
    s_sub_u32 s28, s42, 96
    s_add_u32 s29, s42, 672
    s_cmp_ge_u32 s42, 96
    s_cselect_b32 s42, s28, s29
L_rm6:
    s_cmp_ge_u32 s40, 1696
    s_cbranch_scc1 L_k12_fin
    s_branch L_k12_loop
L_k12_fin:
L_k12_end:
    s_endpgm
.globl gemm_kernel
.p2align 8
.type gemm_kernel,@function
gemm_kernel:
    s_cmp_ge_u32 s2, 256
    s_cbranch_scc1 L_k3_end
    s_load_dwordx2 s[8:9], s[0:1], 48
    v_lshrrev_b32 v253, 6, v0
    v_and_b32 v0, 63, v0
    v_readfirstlane_b32 s10, v253
    s_cmp_ge_u32 s2, 8
    s_cbranch_scc1 L_nopf3
    s_nop 1
    s_cmp_lg_u32 s10, 7
    s_cbranch_scc1 L_nopf3
    s_getpc_b64 s[60:61]
L_pf_k3:
    s_sub_u32 s60, s60, L_pf_k3-gemm_kernel
    s_subb_u32 s61, s61, 0
    v_mbcnt_lo_u32_b32 v12, -1, 0
    v_mbcnt_hi_u32_b32 v12, -1, v12
    v_lshlrev_b32 v12, 6, v12
    v_add_u32 v13, 0, v12
    v_min_u32 v13, final_kernel-gemm_kernel-4, v13
    v_mov_b32 v15, s61
    v_add_co_u32 v14, vcc, s60, v13
    s_nop 1
    v_addc_co_u32 v15, vcc, 0, v15, vcc
    global_load_dword v16, v[14:15], off
    v_add_u32 v13, 4096, v12
    v_min_u32 v13, final_kernel-gemm_kernel-4, v13
    v_mov_b32 v15, s61
    v_add_co_u32 v14, vcc, s60, v13
    s_nop 1
    v_addc_co_u32 v15, vcc, 0, v15, vcc
    global_load_dword v16, v[14:15], off
    v_add_u32 v13, 8192, v12
    v_min_u32 v13, final_kernel-gemm_kernel-4, v13
    v_mov_b32 v15, s61
    v_add_co_u32 v14, vcc, s60, v13
    s_nop 1
    v_addc_co_u32 v15, vcc, 0, v15, vcc
    global_load_dword v16, v[14:15], off
    v_add_u32 v13, 12288, v12
    v_min_u32 v13, final_kernel-gemm_kernel-4, v13
    v_mov_b32 v15, s61
    v_add_co_u32 v14, vcc, s60, v13
    s_nop 1
    v_addc_co_u32 v15, vcc, 0, v15, vcc
    global_load_dword v16, v[14:15], off
L_nopf3:
    s_and_b32 s11, s2, 7
    s_lshr_b32 s12, s2, 3
    s_lshr_b32 s13, s12, 3
    s_lshl_b32 s11, s11, 2
    s_add_u32 s11, s11, s13
    s_bfe_u32 s13, s12, 0x10002
    s_and_b32 s14, s12, 3
    s_and_b32 s15, s10, 3
    s_cmp_ge_u32 s10, 4
    s_cbranch_scc1 L_k3_helper
    v_lshrrev_b32 v253, 4, v0
    v_and_b32 v254, 15, v0
    v_bfe_u32 v255, v254, 3, 1
    v_mul_u32_u24 v255, 3, v255
    v_xor_b32 v255, v255, v253
    v_lshlrev_b32 v255, 4, v255
    v_lshl_add_u32 v250, v254, 6, v255
    v_lshrrev_b32 v255, 2, v254
    v_and_b32 v216, 1, v253
    v_lshl_or_b32 v216, v216, 2, v255
    v_lshl_add_u32 v255, v253, 3, v255
    v_lshlrev_b32 v255, 8, v255
    v_and_b32 v217, 3, v254
    v_lshl_add_u32 v255, v217, 3, v255
    s_lshl_b32 s20, s15, 1
    s_add_u32 s20, s20, s13
    v_xor_b32 v217, s20, v216
    v_lshl_add_u32 v248, v217, 5, v255
    s_xor_b32 s20, s20, 1
    v_xor_b32 v217, s20, v216
    v_lshl_add_u32 v249, v217, 5, v255
    v_lshlrev_b32 v251, 6, v254
    v_lshl_add_u32 v251, v253, 4, v251
    v_and_b32 v255, 7, v254
    v_lshlrev_b32 v252, 6, v255
    v_lshrrev_b32 v216, 3, v254
    v_xor_b32 v216, s13, v216
    s_mov_b32 s22, 11534336
    v_mul_lo_u32 v216, v216, s22
    v_add_u32 v252, v252, v216
    v_lshl_add_u32 v252, v253, 4, v252
    s_lshl_b32 s22, s13, 3
    v_add_u32 v252, s22, v252
    v_cmp_gt_u32 vcc, 7, v255
    v_mov_b32 v216, 0x80000000
    s_nop 0
    v_cndmask_b32 v252, v216, v252, vcc
    s_lshl_b32 s20, s14, 2
    s_add_u32 s20, s20, s15
    s_mul_i32 s48, s20, 720896
    s_mul_i32 s20, s11, 22528
    s_add_u32 s48, s48, s20
    s_add_u32 s48, s48, 117440512
    s_add_u32 s49, s48, 10240
    s_mul_i32 s20, s13, 11534336
    s_add_u32 s48, s48, s20
    s_waitcnt lgkmcnt(0)
    s_mov_b32 s16, s8
    s_and_b32 s17, s9, 0xffff
    s_mov_b32 s18, 268435456
    s_mov_b32 s19, 0x00020000
    v_mov_b32 v0, 0
    v_mov_b32 v1, 0
    v_mov_b32 v2, 0
    v_mov_b32 v3, 0
    v_mov_b32 v4, 0
    v_mov_b32 v5, 0
    v_mov_b32 v6, 0
    v_mov_b32 v7, 0
    v_mov_b32 v8, 0
    v_mov_b32 v9, 0
    v_mov_b32 v10, 0
    v_mov_b32 v11, 0
    v_mov_b32 v12, 0
    v_mov_b32 v13, 0
    v_mov_b32 v14, 0
    v_mov_b32 v15, 0
    v_mov_b32 v16, 0
    v_mov_b32 v17, 0
    v_mov_b32 v18, 0
    v_mov_b32 v19, 0
    v_mov_b32 v20, 0
    v_mov_b32 v21, 0
    v_mov_b32 v22, 0
    v_mov_b32 v23, 0
    v_mov_b32 v24, 0
    v_mov_b32 v25, 0
    v_mov_b32 v26, 0
    v_mov_b32 v27, 0
    v_mov_b32 v28, 0
    v_mov_b32 v29, 0
    v_mov_b32 v30, 0
    v_mov_b32 v31, 0
    v_mov_b32 v32, 0
    v_mov_b32 v33, 0
    v_mov_b32 v34, 0
    v_mov_b32 v35, 0
    v_mov_b32 v36, 0
    v_mov_b32 v37, 0
    v_mov_b32 v38, 0
    v_mov_b32 v39, 0
    v_mov_b32 v40, 0
    v_mov_b32 v41, 0
    v_mov_b32 v42, 0
    v_mov_b32 v43, 0
    v_mov_b32 v44, 0
    v_mov_b32 v45, 0
    v_mov_b32 v46, 0
    v_mov_b32 v47, 0
    v_mov_b32 v48, 0
    v_mov_b32 v49, 0
    v_mov_b32 v50, 0
    v_mov_b32 v51, 0
    v_mov_b32 v52, 0
    v_mov_b32 v53, 0
    v_mov_b32 v54, 0
    v_mov_b32 v55, 0
    v_mov_b32 v56, 0
    v_mov_b32 v57, 0
    v_mov_b32 v58, 0
    v_mov_b32 v59, 0
    v_mov_b32 v60, 0
    v_mov_b32 v61, 0
    v_mov_b32 v62, 0
    v_mov_b32 v63, 0
    v_mov_b32 v64, 0
    v_mov_b32 v65, 0
    v_mov_b32 v66, 0
    v_mov_b32 v67, 0
    v_mov_b32 v68, 0
    v_mov_b32 v69, 0
    v_mov_b32 v70, 0
    v_mov_b32 v71, 0
    v_mov_b32 v72, 0
    v_mov_b32 v73, 0
    v_mov_b32 v74, 0
    v_mov_b32 v75, 0
    v_mov_b32 v76, 0
    v_mov_b32 v77, 0
    v_mov_b32 v78, 0
    v_mov_b32 v79, 0
    v_mov_b32 v80, 0
    v_mov_b32 v81, 0
    v_mov_b32 v82, 0
    v_mov_b32 v83, 0
    v_mov_b32 v84, 0
    v_mov_b32 v85, 0
    v_mov_b32 v86, 0
    v_mov_b32 v87, 0
    v_mov_b32 v88, 0
    v_mov_b32 v89, 0
    v_mov_b32 v90, 0
    v_mov_b32 v91, 0
    v_mov_b32 v92, 0
    v_mov_b32 v93, 0
    v_mov_b32 v94, 0
    v_mov_b32 v95, 0
    v_mov_b32 v96, 0
    v_mov_b32 v97, 0
    v_mov_b32 v98, 0
    v_mov_b32 v99, 0
    v_mov_b32 v100, 0
    v_mov_b32 v101, 0
    v_mov_b32 v102, 0
    v_mov_b32 v103, 0
    v_mov_b32 v104, 0
    v_mov_b32 v105, 0
    v_mov_b32 v106, 0
    v_mov_b32 v107, 0
    v_mov_b32 v108, 0
    v_mov_b32 v109, 0
    v_mov_b32 v110, 0
    v_mov_b32 v111, 0
    v_mov_b32 v112, 0
    v_mov_b32 v113, 0
    v_mov_b32 v114, 0
    v_mov_b32 v115, 0
    v_mov_b32 v116, 0
    v_mov_b32 v117, 0
    v_mov_b32 v118, 0
    v_mov_b32 v119, 0
    v_mov_b32 v120, 0
    v_mov_b32 v121, 0
    v_mov_b32 v122, 0
    v_mov_b32 v123, 0
    v_mov_b32 v124, 0
    v_mov_b32 v125, 0
    v_mov_b32 v126, 0
    v_mov_b32 v127, 0
    v_mov_b32 v128, 0
    v_mov_b32 v129, 0
    v_mov_b32 v130, 0
    v_mov_b32 v131, 0
    v_mov_b32 v132, 0
    v_mov_b32 v133, 0
    v_mov_b32 v134, 0
    v_mov_b32 v135, 0
    v_mov_b32 v136, 0
    v_mov_b32 v137, 0
    v_mov_b32 v138, 0
    v_mov_b32 v139, 0
    v_mov_b32 v140, 0
    v_mov_b32 v141, 0
    v_mov_b32 v142, 0
    v_mov_b32 v143, 0
    v_mov_b32 v144, 0
    v_mov_b32 v145, 0
    v_mov_b32 v146, 0
    v_mov_b32 v147, 0
    v_mov_b32 v148, 0
    v_mov_b32 v149, 0
    v_mov_b32 v150, 0
    v_mov_b32 v151, 0
    v_mov_b32 v152, 0
    v_mov_b32 v153, 0
    v_mov_b32 v154, 0
    v_mov_b32 v155, 0
    v_mov_b32 v156, 0
    v_mov_b32 v157, 0
    v_mov_b32 v158, 0
    v_mov_b32 v159, 0
    v_mov_b32 v160, 0
    v_mov_b32 v161, 0
    v_mov_b32 v162, 0
    v_mov_b32 v163, 0
    v_mov_b32 v164, 0
    v_mov_b32 v165, 0
    v_mov_b32 v166, 0
    v_mov_b32 v167, 0
    s_barrier
    ds_read_b64_tr_b16 v[176:177], v248 offset:0
    ds_read_b64_tr_b16 v[178:179], v248 offset:1024
    ds_read_b64_tr_b16 v[180:181], v249 offset:0
    ds_read_b64_tr_b16 v[182:183], v249 offset:1024
    ds_read_b64_tr_b16 v[184:185], v248 offset:8192
    ds_read_b64_tr_b16 v[186:187], v248 offset:9216
    ds_read_b64_tr_b16 v[188:189], v249 offset:8192
    ds_read_b64_tr_b16 v[190:191], v249 offset:9216
    ds_read_b128 v[216:219], v250 offset:16384
    ds_read_b128 v[220:223], v250 offset:27648
    ds_read_b128 v[224:227], v250 offset:17408
    ds_read_b128 v[228:231], v250 offset:28672
    s_waitcnt lgkmcnt(4)
    v_xor_b32 v208, 0x80008000, v184
    v_xor_b32 v209, 0x80008000, v185
    v_xor_b32 v210, 0x80008000, v186
    v_xor_b32 v211, 0x80008000, v187
    v_xor_b32 v212, 0x80008000, v188
    v_xor_b32 v213, 0x80008000, v189
    v_xor_b32 v214, 0x80008000, v190
    v_xor_b32 v215, 0x80008000, v191
    s_mov_b32 s46, 7
L_g_loop:
    s_barrier
    s_waitcnt lgkmcnt(2)
    v_mfma_f32_16x16x32_bf16 v[0:3], v[176:179], v[216:219], v[0:3]
    ds_read_b128 v[232:235], v250 offset:18432
    ds_read_b128 v[236:239], v250 offset:29696
    v_mfma_f32_16x16x32_bf16 v[4:7], v[180:183], v[216:219], v[4:7]
    v_mfma_f32_16x16x32_bf16 v[8:11], v[208:211], v[216:219], v[8:11]
    v_mfma_f32_16x16x32_bf16 v[12:15], v[212:215], v[216:219], v[12:15]
    v_mfma_f32_16x16x32_bf16 v[0:3], v[184:187], v[220:223], v[0:3]
    v_mfma_f32_16x16x32_bf16 v[4:7], v[188:191], v[220:223], v[4:7]
    v_mfma_f32_16x16x32_bf16 v[8:11], v[176:179], v[220:223], v[8:11]
    v_mfma_f32_16x16x32_bf16 v[12:15], v[180:183], v[220:223], v[12:15]
    s_waitcnt lgkmcnt(2)
    v_mfma_f32_16x16x32_bf16 v[16:19], v[176:179], v[224:227], v[16:19]
    ds_read_b128 v[240:243], v250 offset:19456
    ds_read_b128 v[244:247], v250 offset:30720
    v_mfma_f32_16x16x32_bf16 v[20:23], v[180:183], v[224:227], v[20:23]
    v_mfma_f32_16x16x32_bf16 v[24:27], v[208:211], v[224:227], v[24:27]
    v_mfma_f32_16x16x32_bf16 v[28:31], v[212:215], v[224:227], v[28:31]
    v_mfma_f32_16x16x32_bf16 v[16:19], v[184:187], v[228:231], v[16:19]
    v_mfma_f32_16x16x32_bf16 v[20:23], v[188:191], v[228:231], v[20:23]
    v_mfma_f32_16x16x32_bf16 v[24:27], v[176:179], v[228:231], v[24:27]
    v_mfma_f32_16x16x32_bf16 v[28:31], v[180:183], v[228:231], v[28:31]
    s_waitcnt lgkmcnt(2)
    v_mfma_f32_16x16x32_bf16 v[32:35], v[176:179], v[232:235], v[32:35]
    ds_read_b128 v[216:219], v250 offset:20480
    ds_read_b128 v[220:223], v250 offset:31744
    v_mfma_f32_16x16x32_bf16 v[36:39], v[180:183], v[232:235], v[36:39]
    v_mfma_f32_16x16x32_bf16 v[40:43], v[208:211], v[232:235], v[40:43]
    v_mfma_f32_16x16x32_bf16 v[44:47], v[212:215], v[232:235], v[44:47]
    v_mfma_f32_16x16x32_bf16 v[32:35], v[184:187], v[236:239], v[32:35]
    v_mfma_f32_16x16x32_bf16 v[36:39], v[188:191], v[236:239], v[36:39]
    v_mfma_f32_16x16x32_bf16 v[40:43], v[176:179], v[236:239], v[40:43]
    v_mfma_f32_16x16x32_bf16 v[44:47], v[180:183], v[236:239], v[44:47]
    s_waitcnt lgkmcnt(2)
    v_mfma_f32_16x16x32_bf16 v[48:51], v[176:179], v[240:243], v[48:51]
    ds_read_b128 v[224:227], v250 offset:21504
    ds_read_b128 v[228:231], v250 offset:32768
    v_mfma_f32_16x16x32_bf16 v[52:55], v[180:183], v[240:243], v[52:55]
    v_mfma_f32_16x16x32_bf16 v[56:59], v[208:211], v[240:243], v[56:59]
    v_mfma_f32_16x16x32_bf16 v[60:63], v[212:215], v[240:243], v[60:63]
    v_mfma_f32_16x16x32_bf16 v[48:51], v[184:187], v[244:247], v[48:51]
    v_mfma_f32_16x16x32_bf16 v[52:55], v[188:191], v[244:247], v[52:55]
    v_mfma_f32_16x16x32_bf16 v[56:59], v[176:179], v[244:247], v[56:59]
    v_mfma_f32_16x16x32_bf16 v[60:63], v[180:183], v[244:247], v[60:63]
    s_waitcnt lgkmcnt(2)
    v_mfma_f32_16x16x32_bf16 v[64:67], v[176:179], v[216:219], v[64:67]
    ds_read_b128 v[232:235], v250 offset:22528
    ds_read_b128 v[236:239], v250 offset:33792
    v_mfma_f32_16x16x32_bf16 v[68:71], v[180:183], v[216:219], v[68:71]
    v_mfma_f32_16x16x32_bf16 v[72:75], v[208:211], v[216:219], v[72:75]
    v_mfma_f32_16x16x32_bf16 v[76:79], v[212:215], v[216:219], v[76:79]
    v_mfma_f32_16x16x32_bf16 v[64:67], v[184:187], v[220:223], v[64:67]
    v_mfma_f32_16x16x32_bf16 v[68:71], v[188:191], v[220:223], v[68:71]
    v_mfma_f32_16x16x32_bf16 v[72:75], v[176:179], v[220:223], v[72:75]
    v_mfma_f32_16x16x32_bf16 v[76:79], v[180:183], v[220:223], v[76:79]
    s_waitcnt lgkmcnt(2)
    v_mfma_f32_16x16x32_bf16 v[80:83], v[176:179], v[224:227], v[80:83]
    ds_read_b128 v[240:243], v250 offset:23552
    ds_read_b128 v[244:247], v250 offset:34816
    v_mfma_f32_16x16x32_bf16 v[84:87], v[180:183], v[224:227], v[84:87]
    v_mfma_f32_16x16x32_bf16 v[88:91], v[208:211], v[224:227], v[88:91]
    v_mfma_f32_16x16x32_bf16 v[92:95], v[212:215], v[224:227], v[92:95]
    v_mfma_f32_16x16x32_bf16 v[80:83], v[184:187], v[228:231], v[80:83]
    v_add_u32 v248, 0x9800, v248
    v_add_u32 v249, 0x9800, v249
    v_mfma_f32_16x16x32_bf16 v[84:87], v[188:191], v[228:231], v[84:87]
    v_mfma_f32_16x16x32_bf16 v[88:91], v[176:179], v[228:231], v[88:91]
    v_mfma_f32_16x16x32_bf16 v[92:95], v[180:183], v[228:231], v[92:95]
    s_waitcnt lgkmcnt(2)
    v_mfma_f32_16x16x32_bf16 v[96:99], v[176:179], v[232:235], v[96:99]
    ds_read_b128 v[216:219], v250 offset:24576
    ds_read_b128 v[220:223], v250 offset:35840
    v_mfma_f32_16x16x32_bf16 v[100:103], v[180:183], v[232:235], v[100:103]
    v_mfma_f32_16x16x32_bf16 v[104:107], v[208:211], v[232:235], v[104:107]
    v_mfma_f32_16x16x32_bf16 v[108:111], v[212:215], v[232:235], v[108:111]
    ds_read_b64_tr_b16 v[192:193], v248 offset:0
    ds_read_b64_tr_b16 v[194:195], v248 offset:1024
    ds_read_b64_tr_b16 v[196:197], v249 offset:0
    ds_read_b64_tr_b16 v[198:199], v249 offset:1024
    v_mfma_f32_16x16x32_bf16 v[96:99], v[184:187], v[236:239], v[96:99]
    v_mfma_f32_16x16x32_bf16 v[100:103], v[188:191], v[236:239], v[100:103]
    v_mfma_f32_16x16x32_bf16 v[104:107], v[176:179], v[236:239], v[104:107]
    v_mfma_f32_16x16x32_bf16 v[108:111], v[180:183], v[236:239], v[108:111]
    s_waitcnt lgkmcnt(6)
    v_mfma_f32_16x16x32_bf16 v[112:115], v[176:179], v[240:243], v[112:115]
    ds_read_b128 v[224:227], v250 offset:25600
    ds_read_b128 v[228:231], v250 offset:36864
    v_mfma_f32_16x16x32_bf16 v[116:119], v[180:183], v[240:243], v[116:119]
    v_mfma_f32_16x16x32_bf16 v[120:123], v[208:211], v[240:243], v[120:123]
    v_mfma_f32_16x16x32_bf16 v[124:127], v[212:215], v[240:243], v[124:127]
    ds_read_b64_tr_b16 v[200:201], v248 offset:8192
    ds_read_b64_tr_b16 v[202:203], v248 offset:9216
    ds_read_b64_tr_b16 v[204:205], v249 offset:8192
    ds_read_b64_tr_b16 v[206:207], v249 offset:9216
    v_mfma_f32_16x16x32_bf16 v[112:115], v[184:187], v[244:247], v[112:115]
    v_mfma_f32_16x16x32_bf16 v[116:119], v[188:191], v[244:247], v[116:119]
    v_mfma_f32_16x16x32_bf16 v[120:123], v[176:179], v[244:247], v[120:123]
    v_mfma_f32_16x16x32_bf16 v[124:127], v[180:183], v[244:247], v[124:127]
    s_waitcnt lgkmcnt(10)
    v_mfma_f32_16x16x32_bf16 v[128:131], v[176:179], v[216:219], v[128:131]
    ds_read_b128 v[232:235], v250 offset:26624
    ds_read_b128 v[236:239], v250 offset:37888
    v_mfma_f32_16x16x32_bf16 v[132:135], v[180:183], v[216:219], v[132:135]
    v_mfma_f32_16x16x32_bf16 v[136:139], v[208:211], v[216:219], v[136:139]
    v_mfma_f32_16x16x32_bf16 v[140:143], v[212:215], v[216:219], v[140:143]
    v_mfma_f32_16x16x32_bf16 v[128:131], v[184:187], v[220:223], v[128:131]
    v_mfma_f32_16x16x32_bf16 v[132:135], v[188:191], v[220:223], v[132:135]
    v_mfma_f32_16x16x32_bf16 v[136:139], v[176:179], v[220:223], v[136:139]
    v_mfma_f32_16x16x32_bf16 v[140:143], v[180:183], v[220:223], v[140:143]
    s_waitcnt lgkmcnt(6)
    v_mfma_f32_16x16x32_bf16 v[144:147], v[176:179], v[224:227], v[144:147]
    v_add_u32 v250, 0x9800, v250
    ds_read_b128 v[240:243], v250 offset:16384
    ds_read_b128 v[244:247], v250 offset:27648
    v_mfma_f32_16x16x32_bf16 v[148:151], v[180:183], v[224:227], v[148:151]
    v_mfma_f32_16x16x32_bf16 v[152:155], v[208:211], v[224:227], v[152:155]
    v_mfma_f32_16x16x32_bf16 v[156:159], v[212:215], v[224:227], v[156:159]
    v_mfma_f32_16x16x32_bf16 v[144:147], v[184:187], v[228:231], v[144:147]
    s_waitcnt lgkmcnt(4)
    v_xor_b32 v212, 0x80008000, v204
    v_xor_b32 v213, 0x80008000, v205
    v_mfma_f32_16x16x32_bf16 v[148:151], v[188:191], v[228:231], v[148:151]
    v_xor_b32 v214, 0x80008000, v206
    v_xor_b32 v215, 0x80008000, v207
    v_mfma_f32_16x16x32_bf16 v[152:155], v[176:179], v[228:231], v[152:155]
    v_mfma_f32_16x16x32_bf16 v[156:159], v[180:183], v[228:231], v[156:159]
    s_waitcnt lgkmcnt(2)
    v_mfma_f32_16x16x32_bf16 v[160:163], v[176:179], v[232:235], v[160:163]
    ds_read_b128 v[216:219], v250 offset:17408
    ds_read_b128 v[220:223], v250 offset:28672
    v_mfma_f32_16x16x32_bf16 v[164:167], v[208:211], v[232:235], v[164:167]
    v_xor_b32 v208, 0x80008000, v200
    v_xor_b32 v209, 0x80008000, v201
    v_mfma_f32_16x16x32_bf16 v[160:163], v[184:187], v[236:239], v[160:163]
    v_xor_b32 v210, 0x80008000, v202
    v_xor_b32 v211, 0x80008000, v203
    v_mfma_f32_16x16x32_bf16 v[164:167], v[176:179], v[236:239], v[164:167]
    s_barrier
    s_waitcnt lgkmcnt(2)
    v_mfma_f32_16x16x32_bf16 v[0:3], v[192:195], v[240:243], v[0:3]
    ds_read_b128 v[224:227], v250 offset:18432
    ds_read_b128 v[228:231], v250 offset:29696
    v_mfma_f32_16x16x32_bf16 v[4:7], v[196:199], v[240:243], v[4:7]
    v_mfma_f32_16x16x32_bf16 v[8:11], v[208:211], v[240:243], v[8:11]
    v_mfma_f32_16x16x32_bf16 v[12:15], v[212:215], v[240:243], v[12:15]
    v_mfma_f32_16x16x32_bf16 v[0:3], v[200:203], v[244:247], v[0:3]
    v_mfma_f32_16x16x32_bf16 v[4:7], v[204:207], v[244:247], v[4:7]
    v_mfma_f32_16x16x32_bf16 v[8:11], v[192:195], v[244:247], v[8:11]
    v_mfma_f32_16x16x32_bf16 v[12:15], v[196:199], v[244:247], v[12:15]
    s_waitcnt lgkmcnt(2)
    v_mfma_f32_16x16x32_bf16 v[16:19], v[192:195], v[216:219], v[16:19]
    ds_read_b128 v[232:235], v250 offset:19456
    ds_read_b128 v[236:239], v250 offset:30720
    v_mfma_f32_16x16x32_bf16 v[20:23], v[196:199], v[216:219], v[20:23]
    v_mfma_f32_16x16x32_bf16 v[24:27], v[208:211], v[216:219], v[24:27]
    v_mfma_f32_16x16x32_bf16 v[28:31], v[212:215], v[216:219], v[28:31]
    v_mfma_f32_16x16x32_bf16 v[16:19], v[200:203], v[220:223], v[16:19]
    v_mfma_f32_16x16x32_bf16 v[20:23], v[204:207], v[220:223], v[20:23]
    v_mfma_f32_16x16x32_bf16 v[24:27], v[192:195], v[220:223], v[24:27]
    v_mfma_f32_16x16x32_bf16 v[28:31], v[196:199], v[220:223], v[28:31]
    s_waitcnt lgkmcnt(2)
    v_mfma_f32_16x16x32_bf16 v[32:35], v[192:195], v[224:227], v[32:35]
    ds_read_b128 v[240:243], v250 offset:20480
    ds_read_b128 v[244:247], v250 offset:31744
    v_mfma_f32_16x16x32_bf16 v[36:39], v[196:199], v[224:227], v[36:39]
    v_mfma_f32_16x16x32_bf16 v[40:43], v[208:211], v[224:227], v[40:43]
    v_mfma_f32_16x16x32_bf16 v[44:47], v[212:215], v[224:227], v[44:47]
    v_mfma_f32_16x16x32_bf16 v[32:35], v[200:203], v[228:231], v[32:35]
    v_mfma_f32_16x16x32_bf16 v[36:39], v[204:207], v[228:231], v[36:39]
    v_mfma_f32_16x16x32_bf16 v[40:43], v[192:195], v[228:231], v[40:43]
    v_mfma_f32_16x16x32_bf16 v[44:47], v[196:199], v[228:231], v[44:47]
    s_waitcnt lgkmcnt(2)
    v_mfma_f32_16x16x32_bf16 v[48:51], v[192:195], v[232:235], v[48:51]
    ds_read_b128 v[216:219], v250 offset:21504
    ds_read_b128 v[220:223], v250 offset:32768
    v_mfma_f32_16x16x32_bf16 v[52:55], v[196:199], v[232:235], v[52:55]
    v_mfma_f32_16x16x32_bf16 v[56:59], v[208:211], v[232:235], v[56:59]
    v_mfma_f32_16x16x32_bf16 v[60:63], v[212:215], v[232:235], v[60:63]
    v_mfma_f32_16x16x32_bf16 v[48:51], v[200:203], v[236:239], v[48:51]
    v_mfma_f32_16x16x32_bf16 v[52:55], v[204:207], v[236:239], v[52:55]
    v_mfma_f32_16x16x32_bf16 v[56:59], v[192:195], v[236:239], v[56:59]
    v_mfma_f32_16x16x32_bf16 v[60:63], v[196:199], v[236:239], v[60:63]
    s_waitcnt lgkmcnt(2)
    v_mfma_f32_16x16x32_bf16 v[64:67], v[192:195], v[240:243], v[64:67]
    ds_read_b128 v[224:227], v250 offset:22528
    ds_read_b128 v[228:231], v250 offset:33792
    v_mfma_f32_16x16x32_bf16 v[68:71], v[196:199], v[240:243], v[68:71]
    v_mfma_f32_16x16x32_bf16 v[72:75], v[208:211], v[240:243], v[72:75]
    v_mfma_f32_16x16x32_bf16 v[76:79], v[212:215], v[240:243], v[76:79]
    v_mfma_f32_16x16x32_bf16 v[64:67], v[200:203], v[244:247], v[64:67]
    v_mfma_f32_16x16x32_bf16 v[68:71], v[204:207], v[244:247], v[68:71]
    v_mfma_f32_16x16x32_bf16 v[72:75], v[192:195], v[244:247], v[72:75]
    v_mfma_f32_16x16x32_bf16 v[76:79], v[196:199], v[244:247], v[76:79]
    s_waitcnt lgkmcnt(2)
    v_mfma_f32_16x16x32_bf16 v[80:83], v[192:195], v[216:219], v[80:83]
    ds_read_b128 v[232:235], v250 offset:23552
    ds_read_b128 v[236:239], v250 offset:34816
    v_mfma_f32_16x16x32_bf16 v[84:87], v[196:199], v[216:219], v[84:87]
    v_mfma_f32_16x16x32_bf16 v[88:91], v[208:211], v[216:219], v[88:91]
    v_mfma_f32_16x16x32_bf16 v[92:95], v[212:215], v[216:219], v[92:95]
    v_mfma_f32_16x16x32_bf16 v[80:83], v[200:203], v[220:223], v[80:83]
    v_add_u32 v248, 0x9800, v248
    v_add_u32 v249, 0x9800, v249
    v_mfma_f32_16x16x32_bf16 v[84:87], v[204:207], v[220:223], v[84:87]
    v_mfma_f32_16x16x32_bf16 v[88:91], v[192:195], v[220:223], v[88:91]
    v_mfma_f32_16x16x32_bf16 v[92:95], v[196:199], v[220:223], v[92:95]
    s_waitcnt lgkmcnt(2)
    v_mfma_f32_16x16x32_bf16 v[96:99], v[192:195], v[224:227], v[96:99]
    ds_read_b128 v[240:243], v250 offset:24576
    ds_read_b128 v[244:247], v250 offset:35840
    v_mfma_f32_16x16x32_bf16 v[100:103], v[196:199], v[224:227], v[100:103]
    v_mfma_f32_16x16x32_bf16 v[104:107], v[208:211], v[224:227], v[104:107]
    v_mfma_f32_16x16x32_bf16 v[108:111], v[212:215], v[224:227], v[108:111]
    ds_read_b64_tr_b16 v[176:177], v248 offset:0
    ds_read_b64_tr_b16 v[178:179], v248 offset:1024
    ds_read_b64_tr_b16 v[180:181], v249 offset:0
    ds_read_b64_tr_b16 v[182:183], v249 offset:1024
    v_mfma_f32_16x16x32_bf16 v[96:99], v[200:203], v[228:231], v[96:99]
    v_mfma_f32_16x16x32_bf16 v[100:103], v[204:207], v[228:231], v[100:103]
    v_mfma_f32_16x16x32_bf16 v[104:107], v[192:195], v[228:231], v[104:107]
    v_mfma_f32_16x16x32_bf16 v[108:111], v[196:199], v[228:231], v[108:111]
    s_waitcnt lgkmcnt(6)
    v_mfma_f32_16x16x32_bf16 v[112:115], v[192:195], v[232:235], v[112:115]
    ds_read_b128 v[216:219], v250 offset:25600
    ds_read_b128 v[220:223], v250 offset:36864
    v_mfma_f32_16x16x32_bf16 v[116:119], v[196:199], v[232:235], v[116:119]
    v_mfma_f32_16x16x32_bf16 v[120:123], v[208:211], v[232:235], v[120:123]
    v_mfma_f32_16x16x32_bf16 v[124:127], v[212:215], v[232:235], v[124:127]
    ds_read_b64_tr_b16 v[184:185], v248 offset:8192
    ds_read_b64_tr_b16 v[186:187], v248 offset:9216
    ds_read_b64_tr_b16 v[188:189], v249 offset:8192
    ds_read_b64_tr_b16 v[190:191], v249 offset:9216
    v_mfma_f32_16x16x32_bf16 v[112:115], v[200:203], v[236:239], v[112:115]
    v_mfma_f32_16x16x32_bf16 v[116:119], v[204:207], v[236:239], v[116:119]
    v_mfma_f32_16x16x32_bf16 v[120:123], v[192:195], v[236:239], v[120:123]
    v_mfma_f32_16x16x32_bf16 v[124:127], v[196:199], v[236:239], v[124:127]
    s_waitcnt lgkmcnt(10)
    v_mfma_f32_16x16x32_bf16 v[128:131], v[192:195], v[240:243], v[128:131]
    ds_read_b128 v[224:227], v250 offset:26624
    ds_read_b128 v[228:231], v250 offset:37888
    v_mfma_f32_16x16x32_bf16 v[132:135], v[196:199], v[240:243], v[132:135]
    v_mfma_f32_16x16x32_bf16 v[136:139], v[208:211], v[240:243], v[136:139]
    v_mfma_f32_16x16x32_bf16 v[140:143], v[212:215], v[240:243], v[140:143]
    v_mfma_f32_16x16x32_bf16 v[128:131], v[200:203], v[244:247], v[128:131]
    v_mfma_f32_16x16x32_bf16 v[132:135], v[204:207], v[244:247], v[132:135]
    v_mfma_f32_16x16x32_bf16 v[136:139], v[192:195], v[244:247], v[136:139]
    v_mfma_f32_16x16x32_bf16 v[140:143], v[196:199], v[244:247], v[140:143]
    s_waitcnt lgkmcnt(6)
    v_mfma_f32_16x16x32_bf16 v[144:147], v[192:195], v[216:219], v[144:147]
    v_add_u32 v250, 0x9800, v250
    ds_read_b128 v[232:235], v250 offset:16384
    ds_read_b128 v[236:239], v250 offset:27648
    v_mfma_f32_16x16x32_bf16 v[148:151], v[196:199], v[216:219], v[148:151]
    v_mfma_f32_16x16x32_bf16 v[152:155], v[208:211], v[216:219], v[152:155]
    v_mfma_f32_16x16x32_bf16 v[156:159], v[212:215], v[216:219], v[156:159]
    v_mfma_f32_16x16x32_bf16 v[144:147], v[200:203], v[220:223], v[144:147]
    s_waitcnt lgkmcnt(4)
    v_xor_b32 v212, 0x80008000, v188
    v_xor_b32 v213, 0x80008000, v189
    v_mfma_f32_16x16x32_bf16 v[148:151], v[204:207], v[220:223], v[148:151]
    v_xor_b32 v214, 0x80008000, v190
    v_xor_b32 v215, 0x80008000, v191
    v_mfma_f32_16x16x32_bf16 v[152:155], v[192:195], v[220:223], v[152:155]
    v_mfma_f32_16x16x32_bf16 v[156:159], v[196:199], v[220:223], v[156:159]
    s_waitcnt lgkmcnt(2)
    v_mfma_f32_16x16x32_bf16 v[160:163], v[192:195], v[224:227], v[160:163]
    ds_read_b128 v[240:243], v250 offset:17408
    ds_read_b128 v[244:247], v250 offset:28672
    v_mfma_f32_16x16x32_bf16 v[164:167], v[208:211], v[224:227], v[164:167]
    v_xor_b32 v208, 0x80008000, v184
    v_xor_b32 v209, 0x80008000, v185
    v_mfma_f32_16x16x32_bf16 v[160:163], v[200:203], v[228:231], v[160:163]
    v_xor_b32 v210, 0x80008000, v186
    v_xor_b32 v211, 0x80008000, v187
    v_mfma_f32_16x16x32_bf16 v[164:167], v[192:195], v[228:231], v[164:167]
    s_barrier
    s_waitcnt lgkmcnt(2)
    v_mfma_f32_16x16x32_bf16 v[0:3], v[176:179], v[232:235], v[0:3]
    ds_read_b128 v[216:219], v250 offset:18432
    ds_read_b128 v[220:223], v250 offset:29696
    v_mfma_f32_16x16x32_bf16 v[4:7], v[180:183], v[232:235], v[4:7]
    v_mfma_f32_16x16x32_bf16 v[8:11], v[208:211], v[232:235], v[8:11]
    v_mfma_f32_16x16x32_bf16 v[12:15], v[212:215], v[232:235], v[12:15]
    v_mfma_f32_16x16x32_bf16 v[0:3], v[184:187], v[236:239], v[0:3]
    v_mfma_f32_16x16x32_bf16 v[4:7], v[188:191], v[236:239], v[4:7]
    v_mfma_f32_16x16x32_bf16 v[8:11], v[176:179], v[236:239], v[8:11]
    v_mfma_f32_16x16x32_bf16 v[12:15], v[180:183], v[236:239], v[12:15]
    s_waitcnt lgkmcnt(2)
    v_mfma_f32_16x16x32_bf16 v[16:19], v[176:179], v[240:243], v[16:19]
    ds_read_b128 v[224:227], v250 offset:19456
    ds_read_b128 v[228:231], v250 offset:30720
    v_mfma_f32_16x16x32_bf16 v[20:23], v[180:183], v[240:243], v[20:23]
    v_mfma_f32_16x16x32_bf16 v[24:27], v[208:211], v[240:243], v[24:27]
    v_mfma_f32_16x16x32_bf16 v[28:31], v[212:215], v[240:243], v[28:31]
    v_mfma_f32_16x16x32_bf16 v[16:19], v[184:187], v[244:247], v[16:19]
    v_mfma_f32_16x16x32_bf16 v[20:23], v[188:191], v[244:247], v[20:23]
    v_mfma_f32_16x16x32_bf16 v[24:27], v[176:179], v[244:247], v[24:27]
    v_mfma_f32_16x16x32_bf16 v[28:31], v[180:183], v[244:247], v[28:31]
    s_waitcnt lgkmcnt(2)
    v_mfma_f32_16x16x32_bf16 v[32:35], v[176:179], v[216:219], v[32:35]
    ds_read_b128 v[232:235], v250 offset:20480
    ds_read_b128 v[236:239], v250 offset:31744
    v_mfma_f32_16x16x32_bf16 v[36:39], v[180:183], v[216:219], v[36:39]
    v_mfma_f32_16x16x32_bf16 v[40:43], v[208:211], v[216:219], v[40:43]
    v_mfma_f32_16x16x32_bf16 v[44:47], v[212:215], v[216:219], v[44:47]
    v_mfma_f32_16x16x32_bf16 v[32:35], v[184:187], v[220:223], v[32:35]
    v_mfma_f32_16x16x32_bf16 v[36:39], v[188:191], v[220:223], v[36:39]
    v_mfma_f32_16x16x32_bf16 v[40:43], v[176:179], v[220:223], v[40:43]
    v_mfma_f32_16x16x32_bf16 v[44:47], v[180:183], v[220:223], v[44:47]
    s_waitcnt lgkmcnt(2)
    v_mfma_f32_16x16x32_bf16 v[48:51], v[176:179], v[224:227], v[48:51]
    ds_read_b128 v[240:243], v250 offset:21504
    ds_read_b128 v[244:247], v250 offset:32768
    v_mfma_f32_16x16x32_bf16 v[52:55], v[180:183], v[224:227], v[52:55]
    v_mfma_f32_16x16x32_bf16 v[56:59], v[208:211], v[224:227], v[56:59]
    v_mfma_f32_16x16x32_bf16 v[60:63], v[212:215], v[224:227], v[60:63]
    v_mfma_f32_16x16x32_bf16 v[48:51], v[184:187], v[228:231], v[48:51]
    v_mfma_f32_16x16x32_bf16 v[52:55], v[188:191], v[228:231], v[52:55]
    v_mfma_f32_16x16x32_bf16 v[56:59], v[176:179], v[228:231], v[56:59]
    v_mfma_f32_16x16x32_bf16 v[60:63], v[180:183], v[228:231], v[60:63]
    s_waitcnt lgkmcnt(2)
    v_mfma_f32_16x16x32_bf16 v[64:67], v[176:179], v[232:235], v[64:67]
    ds_read_b128 v[216:219], v250 offset:22528
    ds_read_b128 v[220:223], v250 offset:33792
    v_mfma_f32_16x16x32_bf16 v[68:71], v[180:183], v[232:235], v[68:71]
    v_mfma_f32_16x16x32_bf16 v[72:75], v[208:211], v[232:235], v[72:75]
    v_mfma_f32_16x16x32_bf16 v[76:79], v[212:215], v[232:235], v[76:79]
    v_mfma_f32_16x16x32_bf16 v[64:67], v[184:187], v[236:239], v[64:67]
    v_mfma_f32_16x16x32_bf16 v[68:71], v[188:191], v[236:239], v[68:71]
    v_mfma_f32_16x16x32_bf16 v[72:75], v[176:179], v[236:239], v[72:75]
    v_mfma_f32_16x16x32_bf16 v[76:79], v[180:183], v[236:239], v[76:79]
    s_waitcnt lgkmcnt(2)
    v_mfma_f32_16x16x32_bf16 v[80:83], v[176:179], v[240:243], v[80:83]
    ds_read_b128 v[224:227], v250 offset:23552
    ds_read_b128 v[228:231], v250 offset:34816
    v_mfma_f32_16x16x32_bf16 v[84:87], v[180:183], v[240:243], v[84:87]
    v_mfma_f32_16x16x32_bf16 v[88:91], v[208:211], v[240:243], v[88:91]
    v_mfma_f32_16x16x32_bf16 v[92:95], v[212:215], v[240:243], v[92:95]
    v_mfma_f32_16x16x32_bf16 v[80:83], v[184:187], v[244:247], v[80:83]
    v_add_u32 v248, 0x9800, v248
    v_add_u32 v249, 0x9800, v249
    v_mfma_f32_16x16x32_bf16 v[84:87], v[188:191], v[244:247], v[84:87]
    v_mfma_f32_16x16x32_bf16 v[88:91], v[176:179], v[244:247], v[88:91]
    v_mfma_f32_16x16x32_bf16 v[92:95], v[180:183], v[244:247], v[92:95]
    s_waitcnt lgkmcnt(2)
    v_mfma_f32_16x16x32_bf16 v[96:99], v[176:179], v[216:219], v[96:99]
    ds_read_b128 v[232:235], v250 offset:24576
    ds_read_b128 v[236:239], v250 offset:35840
    v_mfma_f32_16x16x32_bf16 v[100:103], v[180:183], v[216:219], v[100:103]
    v_mfma_f32_16x16x32_bf16 v[104:107], v[208:211], v[216:219], v[104:107]
    v_mfma_f32_16x16x32_bf16 v[108:111], v[212:215], v[216:219], v[108:111]
    ds_read_b64_tr_b16 v[192:193], v248 offset:0
    ds_read_b64_tr_b16 v[194:195], v248 offset:1024
    ds_read_b64_tr_b16 v[196:197], v249 offset:0
    ds_read_b64_tr_b16 v[198:199], v249 offset:1024
    v_mfma_f32_16x16x32_bf16 v[96:99], v[184:187], v[220:223], v[96:99]
    v_mfma_f32_16x16x32_bf16 v[100:103], v[188:191], v[220:223], v[100:103]
    v_mfma_f32_16x16x32_bf16 v[104:107], v[176:179], v[220:223], v[104:107]
    v_mfma_f32_16x16x32_bf16 v[108:111], v[180:183], v[220:223], v[108:111]
    s_waitcnt lgkmcnt(6)
    v_mfma_f32_16x16x32_bf16 v[112:115], v[176:179], v[224:227], v[112:115]
    ds_read_b128 v[240:243], v250 offset:25600
    ds_read_b128 v[244:247], v250 offset:36864
    v_mfma_f32_16x16x32_bf16 v[116:119], v[180:183], v[224:227], v[116:119]
    v_mfma_f32_16x16x32_bf16 v[120:123], v[208:211], v[224:227], v[120:123]
    v_mfma_f32_16x16x32_bf16 v[124:127], v[212:215], v[224:227], v[124:127]
    ds_read_b64_tr_b16 v[200:201], v248 offset:8192
    ds_read_b64_tr_b16 v[202:203], v248 offset:9216
    ds_read_b64_tr_b16 v[204:205], v249 offset:8192
    ds_read_b64_tr_b16 v[206:207], v249 offset:9216
    v_mfma_f32_16x16x32_bf16 v[112:115], v[184:187], v[228:231], v[112:115]
    v_mfma_f32_16x16x32_bf16 v[116:119], v[188:191], v[228:231], v[116:119]
    v_mfma_f32_16x16x32_bf16 v[120:123], v[176:179], v[228:231], v[120:123]
    v_mfma_f32_16x16x32_bf16 v[124:127], v[180:183], v[228:231], v[124:127]
    s_waitcnt lgkmcnt(10)
    v_mfma_f32_16x16x32_bf16 v[128:131], v[176:179], v[232:235], v[128:131]
    ds_read_b128 v[216:219], v250 offset:26624
    ds_read_b128 v[220:223], v250 offset:37888
    v_mfma_f32_16x16x32_bf16 v[132:135], v[180:183], v[232:235], v[132:135]
    v_mfma_f32_16x16x32_bf16 v[136:139], v[208:211], v[232:235], v[136:139]
    v_mfma_f32_16x16x32_bf16 v[140:143], v[212:215], v[232:235], v[140:143]
    v_mfma_f32_16x16x32_bf16 v[128:131], v[184:187], v[236:239], v[128:131]
    v_mfma_f32_16x16x32_bf16 v[132:135], v[188:191], v[236:239], v[132:135]
    v_mfma_f32_16x16x32_bf16 v[136:139], v[176:179], v[236:239], v[136:139]
    v_mfma_f32_16x16x32_bf16 v[140:143], v[180:183], v[236:239], v[140:143]
    s_waitcnt lgkmcnt(6)
    v_mfma_f32_16x16x32_bf16 v[144:147], v[176:179], v[240:243], v[144:147]
    v_add_u32 v250, 0x9800, v250
    ds_read_b128 v[224:227], v250 offset:16384
    ds_read_b128 v[228:231], v250 offset:27648
    v_mfma_f32_16x16x32_bf16 v[148:151], v[180:183], v[240:243], v[148:151]
    v_mfma_f32_16x16x32_bf16 v[152:155], v[208:211], v[240:243], v[152:155]
    v_mfma_f32_16x16x32_bf16 v[156:159], v[212:215], v[240:243], v[156:159]
    v_mfma_f32_16x16x32_bf16 v[144:147], v[184:187], v[244:247], v[144:147]
    s_waitcnt lgkmcnt(4)
    v_xor_b32 v212, 0x80008000, v204
    v_xor_b32 v213, 0x80008000, v205
    v_mfma_f32_16x16x32_bf16 v[148:151], v[188:191], v[244:247], v[148:151]
    v_xor_b32 v214, 0x80008000, v206
    v_xor_b32 v215, 0x80008000, v207
    v_mfma_f32_16x16x32_bf16 v[152:155], v[176:179], v[244:247], v[152:155]
    v_mfma_f32_16x16x32_bf16 v[156:159], v[180:183], v[244:247], v[156:159]
    s_waitcnt lgkmcnt(2)
    v_mfma_f32_16x16x32_bf16 v[160:163], v[176:179], v[216:219], v[160:163]
    ds_read_b128 v[232:235], v250 offset:17408
    ds_read_b128 v[236:239], v250 offset:28672
    v_mfma_f32_16x16x32_bf16 v[164:167], v[208:211], v[216:219], v[164:167]
    v_xor_b32 v208, 0x80008000, v200
    v_xor_b32 v209, 0x80008000, v201
    v_mfma_f32_16x16x32_bf16 v[160:163], v[184:187], v[220:223], v[160:163]
    v_xor_b32 v210, 0x80008000, v202
    v_xor_b32 v211, 0x80008000, v203
    v_mfma_f32_16x16x32_bf16 v[164:167], v[176:179], v[220:223], v[164:167]
    s_barrier
    s_waitcnt lgkmcnt(2)
    v_mfma_f32_16x16x32_bf16 v[0:3], v[192:195], v[224:227], v[0:3]
    ds_read_b128 v[240:243], v250 offset:18432
    ds_read_b128 v[244:247], v250 offset:29696
    v_mfma_f32_16x16x32_bf16 v[4:7], v[196:199], v[224:227], v[4:7]
    v_mfma_f32_16x16x32_bf16 v[8:11], v[208:211], v[224:227], v[8:11]
    v_mfma_f32_16x16x32_bf16 v[12:15], v[212:215], v[224:227], v[12:15]
    v_mfma_f32_16x16x32_bf16 v[0:3], v[200:203], v[228:231], v[0:3]
    v_mfma_f32_16x16x32_bf16 v[4:7], v[204:207], v[228:231], v[4:7]
    v_mfma_f32_16x16x32_bf16 v[8:11], v[192:195], v[228:231], v[8:11]
    v_mfma_f32_16x16x32_bf16 v[12:15], v[196:199], v[228:231], v[12:15]
    s_waitcnt lgkmcnt(2)
    v_mfma_f32_16x16x32_bf16 v[16:19], v[192:195], v[232:235], v[16:19]
    ds_read_b128 v[216:219], v250 offset:19456
    ds_read_b128 v[220:223], v250 offset:30720
    v_mfma_f32_16x16x32_bf16 v[20:23], v[196:199], v[232:235], v[20:23]
    v_mfma_f32_16x16x32_bf16 v[24:27], v[208:211], v[232:235], v[24:27]
    v_mfma_f32_16x16x32_bf16 v[28:31], v[212:215], v[232:235], v[28:31]
    v_mfma_f32_16x16x32_bf16 v[16:19], v[200:203], v[236:239], v[16:19]
    v_mfma_f32_16x16x32_bf16 v[20:23], v[204:207], v[236:239], v[20:23]
    v_mfma_f32_16x16x32_bf16 v[24:27], v[192:195], v[236:239], v[24:27]
    v_mfma_f32_16x16x32_bf16 v[28:31], v[196:199], v[236:239], v[28:31]
    s_waitcnt lgkmcnt(2)
    v_mfma_f32_16x16x32_bf16 v[32:35], v[192:195], v[240:243], v[32:35]
    ds_read_b128 v[224:227], v250 offset:20480
    ds_read_b128 v[228:231], v250 offset:31744
    v_mfma_f32_16x16x32_bf16 v[36:39], v[196:199], v[240:243], v[36:39]
    v_mfma_f32_16x16x32_bf16 v[40:43], v[208:211], v[240:243], v[40:43]
    v_mfma_f32_16x16x32_bf16 v[44:47], v[212:215], v[240:243], v[44:47]
    v_mfma_f32_16x16x32_bf16 v[32:35], v[200:203], v[244:247], v[32:35]
    v_mfma_f32_16x16x32_bf16 v[36:39], v[204:207], v[244:247], v[36:39]
    v_mfma_f32_16x16x32_bf16 v[40:43], v[192:195], v[244:247], v[40:43]
    v_mfma_f32_16x16x32_bf16 v[44:47], v[196:199], v[244:247], v[44:47]
    s_waitcnt lgkmcnt(2)
    v_mfma_f32_16x16x32_bf16 v[48:51], v[192:195], v[216:219], v[48:51]
    ds_read_b128 v[232:235], v250 offset:21504
    ds_read_b128 v[236:239], v250 offset:32768
    v_mfma_f32_16x16x32_bf16 v[52:55], v[196:199], v[216:219], v[52:55]
    v_mfma_f32_16x16x32_bf16 v[56:59], v[208:211], v[216:219], v[56:59]
    v_mfma_f32_16x16x32_bf16 v[60:63], v[212:215], v[216:219], v[60:63]
    v_mfma_f32_16x16x32_bf16 v[48:51], v[200:203], v[220:223], v[48:51]
    v_mfma_f32_16x16x32_bf16 v[52:55], v[204:207], v[220:223], v[52:55]
    v_mfma_f32_16x16x32_bf16 v[56:59], v[192:195], v[220:223], v[56:59]
    v_mfma_f32_16x16x32_bf16 v[60:63], v[196:199], v[220:223], v[60:63]
    s_waitcnt lgkmcnt(2)
    v_mfma_f32_16x16x32_bf16 v[64:67], v[192:195], v[224:227], v[64:67]
    ds_read_b128 v[240:243], v250 offset:22528
    ds_read_b128 v[244:247], v250 offset:33792
    v_mfma_f32_16x16x32_bf16 v[68:71], v[196:199], v[224:227], v[68:71]
    v_mfma_f32_16x16x32_bf16 v[72:75], v[208:211], v[224:227], v[72:75]
    v_mfma_f32_16x16x32_bf16 v[76:79], v[212:215], v[224:227], v[76:79]
    v_mfma_f32_16x16x32_bf16 v[64:67], v[200:203], v[228:231], v[64:67]
    v_mfma_f32_16x16x32_bf16 v[68:71], v[204:207], v[228:231], v[68:71]
    v_mfma_f32_16x16x32_bf16 v[72:75], v[192:195], v[228:231], v[72:75]
    v_mfma_f32_16x16x32_bf16 v[76:79], v[196:199], v[228:231], v[76:79]
    s_waitcnt lgkmcnt(2)
    v_mfma_f32_16x16x32_bf16 v[80:83], v[192:195], v[232:235], v[80:83]
    ds_read_b128 v[216:219], v250 offset:23552
    ds_read_b128 v[220:223], v250 offset:34816
    v_mfma_f32_16x16x32_bf16 v[84:87], v[196:199], v[232:235], v[84:87]
    v_mfma_f32_16x16x32_bf16 v[88:91], v[208:211], v[232:235], v[88:91]
    v_mfma_f32_16x16x32_bf16 v[92:95], v[212:215], v[232:235], v[92:95]
    v_mfma_f32_16x16x32_bf16 v[80:83], v[200:203], v[236:239], v[80:83]
    v_add_u32 v248, 0xfffe3800, v248
    v_add_u32 v249, 0xfffe3800, v249
    v_mfma_f32_16x16x32_bf16 v[84:87], v[204:207], v[236:239], v[84:87]
    v_mfma_f32_16x16x32_bf16 v[88:91], v[192:195], v[236:239], v[88:91]
    v_mfma_f32_16x16x32_bf16 v[92:95], v[196:199], v[236:239], v[92:95]
    s_waitcnt lgkmcnt(2)
    v_mfma_f32_16x16x32_bf16 v[96:99], v[192:195], v[240:243], v[96:99]
    ds_read_b128 v[224:227], v250 offset:24576
    ds_read_b128 v[228:231], v250 offset:35840
    v_mfma_f32_16x16x32_bf16 v[100:103], v[196:199], v[240:243], v[100:103]
    v_mfma_f32_16x16x32_bf16 v[104:107], v[208:211], v[240:243], v[104:107]
    v_mfma_f32_16x16x32_bf16 v[108:111], v[212:215], v[240:243], v[108:111]
    ds_read_b64_tr_b16 v[176:177], v248 offset:0
    ds_read_b64_tr_b16 v[178:179], v248 offset:1024
    ds_read_b64_tr_b16 v[180:181], v249 offset:0
    ds_read_b64_tr_b16 v[182:183], v249 offset:1024
    v_mfma_f32_16x16x32_bf16 v[96:99], v[200:203], v[244:247], v[96:99]
    v_mfma_f32_16x16x32_bf16 v[100:103], v[204:207], v[244:247], v[100:103]
    v_mfma_f32_16x16x32_bf16 v[104:107], v[192:195], v[244:247], v[104:107]
    v_mfma_f32_16x16x32_bf16 v[108:111], v[196:199], v[244:247], v[108:111]
    s_waitcnt lgkmcnt(6)
    v_mfma_f32_16x16x32_bf16 v[112:115], v[192:195], v[216:219], v[112:115]
    ds_read_b128 v[232:235], v250 offset:25600
    ds_read_b128 v[236:239], v250 offset:36864
    v_mfma_f32_16x16x32_bf16 v[116:119], v[196:199], v[216:219], v[116:119]
    v_mfma_f32_16x16x32_bf16 v[120:123], v[208:211], v[216:219], v[120:123]
    v_mfma_f32_16x16x32_bf16 v[124:127], v[212:215], v[216:219], v[124:127]
    ds_read_b64_tr_b16 v[184:185], v248 offset:8192
    ds_read_b64_tr_b16 v[186:187], v248 offset:9216
    ds_read_b64_tr_b16 v[188:189], v249 offset:8192
    ds_read_b64_tr_b16 v[190:191], v249 offset:9216
    v_mfma_f32_16x16x32_bf16 v[112:115], v[200:203], v[220:223], v[112:115]
    v_mfma_f32_16x16x32_bf16 v[116:119], v[204:207], v[220:223], v[116:119]
    v_mfma_f32_16x16x32_bf16 v[120:123], v[192:195], v[220:223], v[120:123]
    v_mfma_f32_16x16x32_bf16 v[124:127], v[196:199], v[220:223], v[124:127]
    s_waitcnt lgkmcnt(10)
    v_mfma_f32_16x16x32_bf16 v[128:131], v[192:195], v[224:227], v[128:131]
    ds_read_b128 v[240:243], v250 offset:26624
    ds_read_b128 v[244:247], v250 offset:37888
    v_mfma_f32_16x16x32_bf16 v[132:135], v[196:199], v[224:227], v[132:135]
    v_mfma_f32_16x16x32_bf16 v[136:139], v[208:211], v[224:227], v[136:139]
    v_mfma_f32_16x16x32_bf16 v[140:143], v[212:215], v[224:227], v[140:143]
    v_mfma_f32_16x16x32_bf16 v[128:131], v[200:203], v[228:231], v[128:131]
    v_mfma_f32_16x16x32_bf16 v[132:135], v[204:207], v[228:231], v[132:135]
    v_mfma_f32_16x16x32_bf16 v[136:139], v[192:195], v[228:231], v[136:139]
    v_mfma_f32_16x16x32_bf16 v[140:143], v[196:199], v[228:231], v[140:143]
    s_waitcnt lgkmcnt(6)
    v_mfma_f32_16x16x32_bf16 v[144:147], v[192:195], v[232:235], v[144:147]
    v_add_u32 v250, 0xfffe3800, v250
    ds_read_b128 v[216:219], v250 offset:16384
    ds_read_b128 v[220:223], v250 offset:27648
    v_mfma_f32_16x16x32_bf16 v[148:151], v[196:199], v[232:235], v[148:151]
    v_mfma_f32_16x16x32_bf16 v[152:155], v[208:211], v[232:235], v[152:155]
    v_mfma_f32_16x16x32_bf16 v[156:159], v[212:215], v[232:235], v[156:159]
    v_mfma_f32_16x16x32_bf16 v[144:147], v[200:203], v[236:239], v[144:147]
    s_waitcnt lgkmcnt(4)
    v_xor_b32 v212, 0x80008000, v188
    v_xor_b32 v213, 0x80008000, v189
    v_mfma_f32_16x16x32_bf16 v[148:151], v[204:207], v[236:239], v[148:151]
    v_xor_b32 v214, 0x80008000, v190
    v_xor_b32 v215, 0x80008000, v191
    v_mfma_f32_16x16x32_bf16 v[152:155], v[192:195], v[236:239], v[152:155]
    v_mfma_f32_16x16x32_bf16 v[156:159], v[196:199], v[236:239], v[156:159]
    s_waitcnt lgkmcnt(2)
    v_mfma_f32_16x16x32_bf16 v[160:163], v[192:195], v[240:243], v[160:163]
    ds_read_b128 v[224:227], v250 offset:17408
    ds_read_b128 v[228:231], v250 offset:28672
    v_mfma_f32_16x16x32_bf16 v[164:167], v[208:211], v[240:243], v[164:167]
    v_xor_b32 v208, 0x80008000, v184
    v_xor_b32 v209, 0x80008000, v185
    v_mfma_f32_16x16x32_bf16 v[160:163], v[200:203], v[244:247], v[160:163]
    v_xor_b32 v210, 0x80008000, v186
    v_xor_b32 v211, 0x80008000, v187
    v_mfma_f32_16x16x32_bf16 v[164:167], v[192:195], v[244:247], v[164:167]
    s_sub_u32 s46, s46, 1
    s_cmp_lg_u32 s46, 0
    s_cbranch_scc1 L_g_loop
    s_barrier
    s_waitcnt lgkmcnt(2)
    v_mfma_f32_16x16x32_bf16 v[0:3], v[176:179], v[216:219], v[0:3]
    ds_read_b128 v[232:235], v250 offset:18432
    ds_read_b128 v[236:239], v250 offset:29696
    v_mfma_f32_16x16x32_bf16 v[4:7], v[180:183], v[216:219], v[4:7]
    v_mfma_f32_16x16x32_bf16 v[8:11], v[208:211], v[216:219], v[8:11]
    v_mfma_f32_16x16x32_bf16 v[12:15], v[212:215], v[216:219], v[12:15]
    v_mfma_f32_16x16x32_bf16 v[0:3], v[184:187], v[220:223], v[0:3]
    v_mfma_f32_16x16x32_bf16 v[4:7], v[188:191], v[220:223], v[4:7]
    v_mfma_f32_16x16x32_bf16 v[8:11], v[176:179], v[220:223], v[8:11]
    v_mfma_f32_16x16x32_bf16 v[12:15], v[180:183], v[220:223], v[12:15]
    s_waitcnt lgkmcnt(2)
    v_mfma_f32_16x16x32_bf16 v[16:19], v[176:179], v[224:227], v[16:19]
    ds_read_b128 v[240:243], v250 offset:19456
    ds_read_b128 v[244:247], v250 offset:30720
    v_mfma_f32_16x16x32_bf16 v[20:23], v[180:183], v[224:227], v[20:23]
    v_mfma_f32_16x16x32_bf16 v[24:27], v[208:211], v[224:227], v[24:27]
    v_mfma_f32_16x16x32_bf16 v[28:31], v[212:215], v[224:227], v[28:31]
    v_mfma_f32_16x16x32_bf16 v[16:19], v[184:187], v[228:231], v[16:19]
    v_mfma_f32_16x16x32_bf16 v[20:23], v[188:191], v[228:231], v[20:23]
    v_mfma_f32_16x16x32_bf16 v[24:27], v[176:179], v[228:231], v[24:27]
    v_mfma_f32_16x16x32_bf16 v[28:31], v[180:183], v[228:231], v[28:31]
    s_waitcnt lgkmcnt(2)
    v_mfma_f32_16x16x32_bf16 v[32:35], v[176:179], v[232:235], v[32:35]
    ds_read_b128 v[216:219], v250 offset:20480
    ds_read_b128 v[220:223], v250 offset:31744
    v_mfma_f32_16x16x32_bf16 v[36:39], v[180:183], v[232:235], v[36:39]
    v_mfma_f32_16x16x32_bf16 v[40:43], v[208:211], v[232:235], v[40:43]
    v_mfma_f32_16x16x32_bf16 v[44:47], v[212:215], v[232:235], v[44:47]
    v_mfma_f32_16x16x32_bf16 v[32:35], v[184:187], v[236:239], v[32:35]
    v_mfma_f32_16x16x32_bf16 v[36:39], v[188:191], v[236:239], v[36:39]
    v_mfma_f32_16x16x32_bf16 v[40:43], v[176:179], v[236:239], v[40:43]
    v_mfma_f32_16x16x32_bf16 v[44:47], v[180:183], v[236:239], v[44:47]
    s_waitcnt lgkmcnt(2)
    v_mfma_f32_16x16x32_bf16 v[48:51], v[176:179], v[240:243], v[48:51]
    ds_read_b128 v[224:227], v250 offset:21504
    ds_read_b128 v[228:231], v250 offset:32768
    v_mfma_f32_16x16x32_bf16 v[52:55], v[180:183], v[240:243], v[52:55]
    v_mfma_f32_16x16x32_bf16 v[56:59], v[208:211], v[240:243], v[56:59]
    v_mfma_f32_16x16x32_bf16 v[60:63], v[212:215], v[240:243], v[60:63]
    v_mfma_f32_16x16x32_bf16 v[48:51], v[184:187], v[244:247], v[48:51]
    v_mfma_f32_16x16x32_bf16 v[52:55], v[188:191], v[244:247], v[52:55]
    v_mfma_f32_16x16x32_bf16 v[56:59], v[176:179], v[244:247], v[56:59]
    v_mfma_f32_16x16x32_bf16 v[60:63], v[180:183], v[244:247], v[60:63]
    s_waitcnt lgkmcnt(2)
    v_mfma_f32_16x16x32_bf16 v[64:67], v[176:179], v[216:219], v[64:67]
    ds_read_b128 v[232:235], v250 offset:22528
    ds_read_b128 v[236:239], v250 offset:33792
    v_mfma_f32_16x16x32_bf16 v[68:71], v[180:183], v[216:219], v[68:71]
    v_mfma_f32_16x16x32_bf16 v[72:75], v[208:211], v[216:219], v[72:75]
    v_mfma_f32_16x16x32_bf16 v[76:79], v[212:215], v[216:219], v[76:79]
    v_mfma_f32_16x16x32_bf16 v[64:67], v[184:187], v[220:223], v[64:67]
    v_mfma_f32_16x16x32_bf16 v[68:71], v[188:191], v[220:223], v[68:71]
    v_mfma_f32_16x16x32_bf16 v[72:75], v[176:179], v[220:223], v[72:75]
    v_mfma_f32_16x16x32_bf16 v[76:79], v[180:183], v[220:223], v[76:79]
    s_waitcnt lgkmcnt(2)
    v_mfma_f32_16x16x32_bf16 v[80:83], v[176:179], v[224:227], v[80:83]
    ds_read_b128 v[240:243], v250 offset:23552
    ds_read_b128 v[244:247], v250 offset:34816
    v_mfma_f32_16x16x32_bf16 v[84:87], v[180:183], v[224:227], v[84:87]
    v_mfma_f32_16x16x32_bf16 v[88:91], v[208:211], v[224:227], v[88:91]
    v_mfma_f32_16x16x32_bf16 v[92:95], v[212:215], v[224:227], v[92:95]
    v_mfma_f32_16x16x32_bf16 v[80:83], v[184:187], v[228:231], v[80:83]
    v_add_u32 v248, 0x9800, v248
    v_add_u32 v249, 0x9800, v249
    v_mfma_f32_16x16x32_bf16 v[84:87], v[188:191], v[228:231], v[84:87]
    v_mfma_f32_16x16x32_bf16 v[88:91], v[176:179], v[228:231], v[88:91]
    v_mfma_f32_16x16x32_bf16 v[92:95], v[180:183], v[228:231], v[92:95]
    s_waitcnt lgkmcnt(2)
    v_mfma_f32_16x16x32_bf16 v[96:99], v[176:179], v[232:235], v[96:99]
    ds_read_b128 v[216:219], v250 offset:24576
    ds_read_b128 v[220:223], v250 offset:35840
    v_mfma_f32_16x16x32_bf16 v[100:103], v[180:183], v[232:235], v[100:103]
    v_mfma_f32_16x16x32_bf16 v[104:107], v[208:211], v[232:235], v[104:107]
    v_mfma_f32_16x16x32_bf16 v[108:111], v[212:215], v[232:235], v[108:111]
    ds_read_b64_tr_b16 v[192:193], v248 offset:0
    ds_read_b64_tr_b16 v[194:195], v248 offset:1024
    ds_read_b64_tr_b16 v[196:197], v249 offset:0
    ds_read_b64_tr_b16 v[198:199], v249 offset:1024
    v_mfma_f32_16x16x32_bf16 v[96:99], v[184:187], v[236:239], v[96:99]
    v_mfma_f32_16x16x32_bf16 v[100:103], v[188:191], v[236:239], v[100:103]
    v_mfma_f32_16x16x32_bf16 v[104:107], v[176:179], v[236:239], v[104:107]
    v_mfma_f32_16x16x32_bf16 v[108:111], v[180:183], v[236:239], v[108:111]
    s_waitcnt lgkmcnt(6)
    v_mfma_f32_16x16x32_bf16 v[112:115], v[176:179], v[240:243], v[112:115]
    ds_read_b128 v[224:227], v250 offset:25600
    ds_read_b128 v[228:231], v250 offset:36864
    v_mfma_f32_16x16x32_bf16 v[116:119], v[180:183], v[240:243], v[116:119]
    v_mfma_f32_16x16x32_bf16 v[120:123], v[208:211], v[240:243], v[120:123]
    v_mfma_f32_16x16x32_bf16 v[124:127], v[212:215], v[240:243], v[124:127]
    ds_read_b64_tr_b16 v[200:201], v248 offset:8192
    ds_read_b64_tr_b16 v[202:203], v248 offset:9216
    ds_read_b64_tr_b16 v[204:205], v249 offset:8192
    ds_read_b64_tr_b16 v[206:207], v249 offset:9216
    v_mfma_f32_16x16x32_bf16 v[112:115], v[184:187], v[244:247], v[112:115]
    v_mfma_f32_16x16x32_bf16 v[116:119], v[188:191], v[244:247], v[116:119]
    v_mfma_f32_16x16x32_bf16 v[120:123], v[176:179], v[244:247], v[120:123]
    v_mfma_f32_16x16x32_bf16 v[124:127], v[180:183], v[244:247], v[124:127]
    s_waitcnt lgkmcnt(10)
    v_mfma_f32_16x16x32_bf16 v[128:131], v[176:179], v[216:219], v[128:131]
    ds_read_b128 v[232:235], v250 offset:26624
    ds_read_b128 v[236:239], v250 offset:37888
    v_mfma_f32_16x16x32_bf16 v[132:135], v[180:183], v[216:219], v[132:135]
    v_mfma_f32_16x16x32_bf16 v[136:139], v[208:211], v[216:219], v[136:139]
    v_mfma_f32_16x16x32_bf16 v[140:143], v[212:215], v[216:219], v[140:143]
    v_mfma_f32_16x16x32_bf16 v[128:131], v[184:187], v[220:223], v[128:131]
    v_mfma_f32_16x16x32_bf16 v[132:135], v[188:191], v[220:223], v[132:135]
    v_mfma_f32_16x16x32_bf16 v[136:139], v[176:179], v[220:223], v[136:139]
    v_mfma_f32_16x16x32_bf16 v[140:143], v[180:183], v[220:223], v[140:143]
    s_waitcnt lgkmcnt(6)
    v_mfma_f32_16x16x32_bf16 v[144:147], v[176:179], v[224:227], v[144:147]
    v_add_u32 v250, 0x9800, v250
    ds_read_b128 v[240:243], v250 offset:16384
    ds_read_b128 v[244:247], v250 offset:27648
    v_mfma_f32_16x16x32_bf16 v[148:151], v[180:183], v[224:227], v[148:151]
    v_mfma_f32_16x16x32_bf16 v[152:155], v[208:211], v[224:227], v[152:155]
    v_mfma_f32_16x16x32_bf16 v[156:159], v[212:215], v[224:227], v[156:159]
    v_mfma_f32_16x16x32_bf16 v[144:147], v[184:187], v[228:231], v[144:147]
    s_waitcnt lgkmcnt(4)
    v_xor_b32 v212, 0x80008000, v204
    v_xor_b32 v213, 0x80008000, v205
    v_mfma_f32_16x16x32_bf16 v[148:151], v[188:191], v[228:231], v[148:151]
    v_xor_b32 v214, 0x80008000, v206
    v_xor_b32 v215, 0x80008000, v207
    v_mfma_f32_16x16x32_bf16 v[152:155], v[176:179], v[228:231], v[152:155]
    v_mfma_f32_16x16x32_bf16 v[156:159], v[180:183], v[228:231], v[156:159]
    s_waitcnt lgkmcnt(2)
    v_mfma_f32_16x16x32_bf16 v[160:163], v[176:179], v[232:235], v[160:163]
    ds_read_b128 v[216:219], v250 offset:17408
    ds_read_b128 v[220:223], v250 offset:28672
    v_mfma_f32_16x16x32_bf16 v[164:167], v[208:211], v[232:235], v[164:167]
    v_xor_b32 v208, 0x80008000, v200
    v_xor_b32 v209, 0x80008000, v201
    v_mfma_f32_16x16x32_bf16 v[160:163], v[184:187], v[236:239], v[160:163]
    v_xor_b32 v210, 0x80008000, v202
    v_xor_b32 v211, 0x80008000, v203
    v_mfma_f32_16x16x32_bf16 v[164:167], v[176:179], v[236:239], v[164:167]
    s_barrier
    s_waitcnt lgkmcnt(2)
    v_mfma_f32_16x16x32_bf16 v[0:3], v[192:195], v[240:243], v[0:3]
    ds_read_b128 v[224:227], v250 offset:18432
    ds_read_b128 v[228:231], v250 offset:29696
    v_mfma_f32_16x16x32_bf16 v[4:7], v[196:199], v[240:243], v[4:7]
    v_mfma_f32_16x16x32_bf16 v[8:11], v[208:211], v[240:243], v[8:11]
    v_mfma_f32_16x16x32_bf16 v[12:15], v[212:215], v[240:243], v[12:15]
    v_mfma_f32_16x16x32_bf16 v[0:3], v[200:203], v[244:247], v[0:3]
    v_mfma_f32_16x16x32_bf16 v[4:7], v[204:207], v[244:247], v[4:7]
    v_mfma_f32_16x16x32_bf16 v[8:11], v[192:195], v[244:247], v[8:11]
    v_mfma_f32_16x16x32_bf16 v[12:15], v[196:199], v[244:247], v[12:15]
    s_waitcnt lgkmcnt(2)
    v_mfma_f32_16x16x32_bf16 v[16:19], v[192:195], v[216:219], v[16:19]
    ds_read_b128 v[232:235], v250 offset:19456
    ds_read_b128 v[236:239], v250 offset:30720
    v_mfma_f32_16x16x32_bf16 v[20:23], v[196:199], v[216:219], v[20:23]
    v_mfma_f32_16x16x32_bf16 v[24:27], v[208:211], v[216:219], v[24:27]
    v_mfma_f32_16x16x32_bf16 v[28:31], v[212:215], v[216:219], v[28:31]
    v_mfma_f32_16x16x32_bf16 v[16:19], v[200:203], v[220:223], v[16:19]
    v_mfma_f32_16x16x32_bf16 v[20:23], v[204:207], v[220:223], v[20:23]
    v_mfma_f32_16x16x32_bf16 v[24:27], v[192:195], v[220:223], v[24:27]
    v_mfma_f32_16x16x32_bf16 v[28:31], v[196:199], v[220:223], v[28:31]
    s_waitcnt lgkmcnt(2)
    v_mfma_f32_16x16x32_bf16 v[32:35], v[192:195], v[224:227], v[32:35]
    ds_read_b128 v[240:243], v250 offset:20480
    ds_read_b128 v[244:247], v250 offset:31744
    v_mfma_f32_16x16x32_bf16 v[36:39], v[196:199], v[224:227], v[36:39]
    v_mfma_f32_16x16x32_bf16 v[40:43], v[208:211], v[224:227], v[40:43]
    v_mfma_f32_16x16x32_bf16 v[44:47], v[212:215], v[224:227], v[44:47]
    v_mfma_f32_16x16x32_bf16 v[32:35], v[200:203], v[228:231], v[32:35]
    v_mfma_f32_16x16x32_bf16 v[36:39], v[204:207], v[228:231], v[36:39]
    v_mfma_f32_16x16x32_bf16 v[40:43], v[192:195], v[228:231], v[40:43]
    v_mfma_f32_16x16x32_bf16 v[44:47], v[196:199], v[228:231], v[44:47]
    s_waitcnt lgkmcnt(2)
    v_mfma_f32_16x16x32_bf16 v[48:51], v[192:195], v[232:235], v[48:51]
    ds_read_b128 v[216:219], v250 offset:21504
    ds_read_b128 v[220:223], v250 offset:32768
    v_mfma_f32_16x16x32_bf16 v[52:55], v[196:199], v[232:235], v[52:55]
    v_mfma_f32_16x16x32_bf16 v[56:59], v[208:211], v[232:235], v[56:59]
    v_mfma_f32_16x16x32_bf16 v[60:63], v[212:215], v[232:235], v[60:63]
    v_mfma_f32_16x16x32_bf16 v[48:51], v[200:203], v[236:239], v[48:51]
    v_mfma_f32_16x16x32_bf16 v[52:55], v[204:207], v[236:239], v[52:55]
    v_mfma_f32_16x16x32_bf16 v[56:59], v[192:195], v[236:239], v[56:59]
    v_mfma_f32_16x16x32_bf16 v[60:63], v[196:199], v[236:239], v[60:63]
    s_waitcnt lgkmcnt(2)
    v_mfma_f32_16x16x32_bf16 v[64:67], v[192:195], v[240:243], v[64:67]
    ds_read_b128 v[224:227], v250 offset:22528
    ds_read_b128 v[228:231], v250 offset:33792
    v_mfma_f32_16x16x32_bf16 v[68:71], v[196:199], v[240:243], v[68:71]
    v_mfma_f32_16x16x32_bf16 v[72:75], v[208:211], v[240:243], v[72:75]
    v_mfma_f32_16x16x32_bf16 v[76:79], v[212:215], v[240:243], v[76:79]
    v_mfma_f32_16x16x32_bf16 v[64:67], v[200:203], v[244:247], v[64:67]
    v_mfma_f32_16x16x32_bf16 v[68:71], v[204:207], v[244:247], v[68:71]
    v_mfma_f32_16x16x32_bf16 v[72:75], v[192:195], v[244:247], v[72:75]
    v_mfma_f32_16x16x32_bf16 v[76:79], v[196:199], v[244:247], v[76:79]
    s_waitcnt lgkmcnt(2)
    v_mfma_f32_16x16x32_bf16 v[80:83], v[192:195], v[216:219], v[80:83]
    ds_read_b128 v[232:235], v250 offset:23552
    ds_read_b128 v[236:239], v250 offset:34816
    v_mfma_f32_16x16x32_bf16 v[84:87], v[196:199], v[216:219], v[84:87]
    v_mfma_f32_16x16x32_bf16 v[88:91], v[208:211], v[216:219], v[88:91]
    v_mfma_f32_16x16x32_bf16 v[92:95], v[212:215], v[216:219], v[92:95]
    v_mfma_f32_16x16x32_bf16 v[80:83], v[200:203], v[220:223], v[80:83]
    v_add_u32 v248, 0x9800, v248
    v_add_u32 v249, 0x9800, v249
    v_mfma_f32_16x16x32_bf16 v[84:87], v[204:207], v[220:223], v[84:87]
    v_mfma_f32_16x16x32_bf16 v[88:91], v[192:195], v[220:223], v[88:91]
    v_mfma_f32_16x16x32_bf16 v[92:95], v[196:199], v[220:223], v[92:95]
    s_waitcnt lgkmcnt(2)
    v_mfma_f32_16x16x32_bf16 v[96:99], v[192:195], v[224:227], v[96:99]
    ds_read_b128 v[240:243], v250 offset:24576
    ds_read_b128 v[244:247], v250 offset:35840
    v_mfma_f32_16x16x32_bf16 v[100:103], v[196:199], v[224:227], v[100:103]
    v_mfma_f32_16x16x32_bf16 v[104:107], v[208:211], v[224:227], v[104:107]
    v_mfma_f32_16x16x32_bf16 v[108:111], v[212:215], v[224:227], v[108:111]
    ds_read_b64_tr_b16 v[176:177], v248 offset:0
    ds_read_b64_tr_b16 v[178:179], v248 offset:1024
    ds_read_b64_tr_b16 v[180:181], v249 offset:0
    ds_read_b64_tr_b16 v[182:183], v249 offset:1024
    v_mfma_f32_16x16x32_bf16 v[96:99], v[200:203], v[228:231], v[96:99]
    v_mfma_f32_16x16x32_bf16 v[100:103], v[204:207], v[228:231], v[100:103]
    v_mfma_f32_16x16x32_bf16 v[104:107], v[192:195], v[228:231], v[104:107]
    v_mfma_f32_16x16x32_bf16 v[108:111], v[196:199], v[228:231], v[108:111]
    s_waitcnt lgkmcnt(6)
    v_mfma_f32_16x16x32_bf16 v[112:115], v[192:195], v[232:235], v[112:115]
    ds_read_b128 v[216:219], v250 offset:25600
    ds_read_b128 v[220:223], v250 offset:36864
    v_mfma_f32_16x16x32_bf16 v[116:119], v[196:199], v[232:235], v[116:119]
    v_mfma_f32_16x16x32_bf16 v[120:123], v[208:211], v[232:235], v[120:123]
    v_mfma_f32_16x16x32_bf16 v[124:127], v[212:215], v[232:235], v[124:127]
    ds_read_b64_tr_b16 v[184:185], v248 offset:8192
    ds_read_b64_tr_b16 v[186:187], v248 offset:9216
    ds_read_b64_tr_b16 v[188:189], v249 offset:8192
    ds_read_b64_tr_b16 v[190:191], v249 offset:9216
    v_mfma_f32_16x16x32_bf16 v[112:115], v[200:203], v[236:239], v[112:115]
    v_mfma_f32_16x16x32_bf16 v[116:119], v[204:207], v[236:239], v[116:119]
    v_mfma_f32_16x16x32_bf16 v[120:123], v[192:195], v[236:239], v[120:123]
    v_mfma_f32_16x16x32_bf16 v[124:127], v[196:199], v[236:239], v[124:127]
    s_waitcnt lgkmcnt(10)
    v_mfma_f32_16x16x32_bf16 v[128:131], v[192:195], v[240:243], v[128:131]
    ds_read_b128 v[224:227], v250 offset:26624
    ds_read_b128 v[228:231], v250 offset:37888
    v_mfma_f32_16x16x32_bf16 v[132:135], v[196:199], v[240:243], v[132:135]
    v_mfma_f32_16x16x32_bf16 v[136:139], v[208:211], v[240:243], v[136:139]
    v_mfma_f32_16x16x32_bf16 v[140:143], v[212:215], v[240:243], v[140:143]
    v_mfma_f32_16x16x32_bf16 v[128:131], v[200:203], v[244:247], v[128:131]
    v_mfma_f32_16x16x32_bf16 v[132:135], v[204:207], v[244:247], v[132:135]
    v_mfma_f32_16x16x32_bf16 v[136:139], v[192:195], v[244:247], v[136:139]
    v_mfma_f32_16x16x32_bf16 v[140:143], v[196:199], v[244:247], v[140:143]
    s_waitcnt lgkmcnt(6)
    v_mfma_f32_16x16x32_bf16 v[144:147], v[192:195], v[216:219], v[144:147]
    v_add_u32 v250, 0x9800, v250
    ds_read_b128 v[232:235], v250 offset:16384
    ds_read_b128 v[236:239], v250 offset:27648
    v_mfma_f32_16x16x32_bf16 v[148:151], v[196:199], v[216:219], v[148:151]
    v_mfma_f32_16x16x32_bf16 v[152:155], v[208:211], v[216:219], v[152:155]
    v_mfma_f32_16x16x32_bf16 v[156:159], v[212:215], v[216:219], v[156:159]
    v_mfma_f32_16x16x32_bf16 v[144:147], v[200:203], v[220:223], v[144:147]
    s_waitcnt lgkmcnt(4)
    v_xor_b32 v212, 0x80008000, v188
    v_xor_b32 v213, 0x80008000, v189
    v_mfma_f32_16x16x32_bf16 v[148:151], v[204:207], v[220:223], v[148:151]
    v_xor_b32 v214, 0x80008000, v190
    v_xor_b32 v215, 0x80008000, v191
    v_mfma_f32_16x16x32_bf16 v[152:155], v[192:195], v[220:223], v[152:155]
    v_mfma_f32_16x16x32_bf16 v[156:159], v[196:199], v[220:223], v[156:159]
    s_waitcnt lgkmcnt(2)
    v_mfma_f32_16x16x32_bf16 v[160:163], v[192:195], v[224:227], v[160:163]
    ds_read_b128 v[240:243], v250 offset:17408
    ds_read_b128 v[244:247], v250 offset:28672
    v_mfma_f32_16x16x32_bf16 v[164:167], v[208:211], v[224:227], v[164:167]
    v_xor_b32 v208, 0x80008000, v184
    v_xor_b32 v209, 0x80008000, v185
    v_mfma_f32_16x16x32_bf16 v[160:163], v[200:203], v[228:231], v[160:163]
    v_xor_b32 v210, 0x80008000, v186
    v_xor_b32 v211, 0x80008000, v187
    v_mfma_f32_16x16x32_bf16 v[164:167], v[192:195], v[228:231], v[164:167]
    s_barrier
    s_cmp_lg_u32 s13, 0
    s_cbranch_scc1 L_epi_b1
    v_add_u32 v248, 0x9800, v248
    v_add_u32 v249, 0x9800, v249
    v_add_u32 v253, 38912, v250
    ds_read_b64_tr_b16 v[192:193], v248 offset:0
    ds_read_b64_tr_b16 v[194:195], v248 offset:1024
    ds_read_b64_tr_b16 v[196:197], v249 offset:0
    ds_read_b64_tr_b16 v[198:199], v249 offset:1024
    ds_read_b64_tr_b16 v[200:201], v248 offset:8192
    ds_read_b64_tr_b16 v[202:203], v248 offset:9216
    ds_read_b64_tr_b16 v[204:205], v249 offset:8192
    ds_read_b64_tr_b16 v[206:207], v249 offset:9216
    s_waitcnt lgkmcnt(10)
    v_mfma_f32_16x16x32_bf16 v[0:3], v[176:179], v[232:235], v[0:3]
    ds_read_b128 v[216:219], v250 offset:18432
    ds_read_b128 v[220:223], v250 offset:29696
    v_mfma_f32_16x16x32_bf16 v[4:7], v[180:183], v[232:235], v[4:7]
    v_mfma_f32_16x16x32_bf16 v[8:11], v[208:211], v[232:235], v[8:11]
    v_mfma_f32_16x16x32_bf16 v[12:15], v[212:215], v[232:235], v[12:15]
    v_mfma_f32_16x16x32_bf16 v[0:3], v[184:187], v[236:239], v[0:3]
    v_mfma_f32_16x16x32_bf16 v[4:7], v[188:191], v[236:239], v[4:7]
    v_mfma_f32_16x16x32_bf16 v[8:11], v[176:179], v[236:239], v[8:11]
    v_mfma_f32_16x16x32_bf16 v[12:15], v[180:183], v[236:239], v[12:15]
    s_waitcnt lgkmcnt(10)
    v_mfma_f32_16x16x32_bf16 v[16:19], v[176:179], v[240:243], v[16:19]
    ds_read_b128 v[224:227], v253 offset:16384
    ds_read_b128 v[228:231], v253 offset:27648
    v_mfma_f32_16x16x32_bf16 v[20:23], v[180:183], v[240:243], v[20:23]
    v_mfma_f32_16x16x32_bf16 v[24:27], v[208:211], v[240:243], v[24:27]
    v_mfma_f32_16x16x32_bf16 v[28:31], v[212:215], v[240:243], v[28:31]
    v_mfma_f32_16x16x32_bf16 v[16:19], v[184:187], v[244:247], v[16:19]
    v_mfma_f32_16x16x32_bf16 v[20:23], v[188:191], v[244:247], v[20:23]
    v_mfma_f32_16x16x32_bf16 v[24:27], v[176:179], v[244:247], v[24:27]
    v_mfma_f32_16x16x32_bf16 v[28:31], v[180:183], v[244:247], v[28:31]
    s_waitcnt lgkmcnt(2)
    v_mfma_f32_16x16x32_bf16 v[32:35], v[176:179], v[216:219], v[32:35]
    ds_read_b128 v[232:235], v250 offset:19456
    ds_read_b128 v[236:239], v250 offset:30720
    v_mfma_f32_16x16x32_bf16 v[36:39], v[180:183], v[216:219], v[36:39]
    v_mfma_f32_16x16x32_bf16 v[40:43], v[208:211], v[216:219], v[40:43]
    v_mfma_f32_16x16x32_bf16 v[44:47], v[212:215], v[216:219], v[44:47]
    v_mfma_f32_16x16x32_bf16 v[32:35], v[184:187], v[220:223], v[32:35]
    v_mfma_f32_16x16x32_bf16 v[36:39], v[188:191], v[220:223], v[36:39]
    v_mfma_f32_16x16x32_bf16 v[40:43], v[176:179], v[220:223], v[40:43]
    v_mfma_f32_16x16x32_bf16 v[44:47], v[180:183], v[220:223], v[44:47]
    v_xor_b32 v168, 0x80008000, v200
    v_xor_b32 v169, 0x80008000, v201
    v_xor_b32 v170, 0x80008000, v202
    v_xor_b32 v171, 0x80008000, v203
    v_xor_b32 v172, 0x80008000, v204
    v_xor_b32 v173, 0x80008000, v205
    v_xor_b32 v174, 0x80008000, v206
    v_xor_b32 v175, 0x80008000, v207
    s_waitcnt lgkmcnt(2)
    v_mfma_f32_16x16x32_bf16 v[0:3], v[192:195], v[224:227], v[0:3]
    ds_read_b128 v[240:243], v253 offset:17408
    ds_read_b128 v[244:247], v253 offset:28672
    v_mfma_f32_16x16x32_bf16 v[4:7], v[196:199], v[224:227], v[4:7]
    v_mfma_f32_16x16x32_bf16 v[8:11], v[168:171], v[224:227], v[8:11]
    v_mfma_f32_16x16x32_bf16 v[12:15], v[172:175], v[224:227], v[12:15]
    v_mfma_f32_16x16x32_bf16 v[0:3], v[200:203], v[228:231], v[0:3]
    v_mfma_f32_16x16x32_bf16 v[4:7], v[204:207], v[228:231], v[4:7]
    v_mfma_f32_16x16x32_bf16 v[8:11], v[192:195], v[228:231], v[8:11]
    v_mfma_f32_16x16x32_bf16 v[12:15], v[196:199], v[228:231], v[12:15]
    s_waitcnt lgkmcnt(2)
    v_mfma_f32_16x16x32_bf16 v[48:51], v[176:179], v[232:235], v[48:51]
    ds_read_b128 v[216:219], v250 offset:20480
    ds_read_b128 v[220:223], v250 offset:31744
    v_mfma_f32_16x16x32_bf16 v[52:55], v[180:183], v[232:235], v[52:55]
    v_mfma_f32_16x16x32_bf16 v[56:59], v[208:211], v[232:235], v[56:59]
    v_mfma_f32_16x16x32_bf16 v[60:63], v[212:215], v[232:235], v[60:63]
    v_mfma_f32_16x16x32_bf16 v[48:51], v[184:187], v[236:239], v[48:51]
    v_mfma_f32_16x16x32_bf16 v[52:55], v[188:191], v[236:239], v[52:55]
    v_mfma_f32_16x16x32_bf16 v[56:59], v[176:179], v[236:239], v[56:59]
    v_mfma_f32_16x16x32_bf16 v[60:63], v[180:183], v[236:239], v[60:63]
    s_waitcnt lgkmcnt(2)
    v_mfma_f32_16x16x32_bf16 v[16:19], v[192:195], v[240:243], v[16:19]
    ds_read_b128 v[224:227], v253 offset:18432
    ds_read_b128 v[228:231], v253 offset:29696
    v_mfma_f32_16x16x32_bf16 v[20:23], v[196:199], v[240:243], v[20:23]
    v_cvt_pk_bf16_f32 v0, v0, v1
    v_cvt_pk_bf16_f32 v1, v2, v3
    v_mfma_f32_16x16x32_bf16 v[24:27], v[168:171], v[240:243], v[24:27]
    v_cvt_pk_bf16_f32 v2, v4, v5
    v_cvt_pk_bf16_f32 v3, v6, v7
    v_mfma_f32_16x16x32_bf16 v[28:31], v[172:175], v[240:243], v[28:31]
    s_add_u32 s47, s48, 0
    buffer_store_dwordx4 v[0:3], v251, s[16:19], s47 offen sc1
    v_mfma_f32_16x16x32_bf16 v[16:19], v[200:203], v[244:247], v[16:19]
    v_cvt_pk_bf16_f32 v8, v8, v9
    v_cvt_pk_bf16_f32 v9, v10, v11
    v_mfma_f32_16x16x32_bf16 v[20:23], v[204:207], v[244:247], v[20:23]
    v_cvt_pk_bf16_f32 v10, v12, v13
    v_cvt_pk_bf16_f32 v11, v14, v15
    v_mfma_f32_16x16x32_bf16 v[24:27], v[192:195], v[244:247], v[24:27]
    s_add_u32 s47, s48, 11264
    buffer_store_dwordx4 v[8:11], v251, s[16:19], s47 offen sc1
    v_mfma_f32_16x16x32_bf16 v[28:31], v[196:199], v[244:247], v[28:31]
    s_waitcnt lgkmcnt(2)
    v_mfma_f32_16x16x32_bf16 v[64:67], v[176:179], v[216:219], v[64:67]
    ds_read_b128 v[232:235], v250 offset:21504
    ds_read_b128 v[236:239], v250 offset:32768
    v_mfma_f32_16x16x32_bf16 v[68:71], v[180:183], v[216:219], v[68:71]
    v_mfma_f32_16x16x32_bf16 v[72:75], v[208:211], v[216:219], v[72:75]
    v_mfma_f32_16x16x32_bf16 v[76:79], v[212:215], v[216:219], v[76:79]
    v_mfma_f32_16x16x32_bf16 v[64:67], v[184:187], v[220:223], v[64:67]
    v_mfma_f32_16x16x32_bf16 v[68:71], v[188:191], v[220:223], v[68:71]
    v_mfma_f32_16x16x32_bf16 v[72:75], v[176:179], v[220:223], v[72:75]
    v_mfma_f32_16x16x32_bf16 v[76:79], v[180:183], v[220:223], v[76:79]
    s_waitcnt lgkmcnt(2)
    v_mfma_f32_16x16x32_bf16 v[32:35], v[192:195], v[224:227], v[32:35]
    ds_read_b128 v[240:243], v253 offset:19456
    ds_read_b128 v[244:247], v253 offset:30720
    v_mfma_f32_16x16x32_bf16 v[36:39], v[196:199], v[224:227], v[36:39]
    v_cvt_pk_bf16_f32 v16, v16, v17
    v_cvt_pk_bf16_f32 v17, v18, v19
    v_mfma_f32_16x16x32_bf16 v[40:43], v[168:171], v[224:227], v[40:43]
    v_cvt_pk_bf16_f32 v18, v20, v21
    v_cvt_pk_bf16_f32 v19, v22, v23
    v_mfma_f32_16x16x32_bf16 v[44:47], v[172:175], v[224:227], v[44:47]
    s_add_u32 s47, s48, 1024
    buffer_store_dwordx4 v[16:19], v251, s[16:19], s47 offen sc1
    v_mfma_f32_16x16x32_bf16 v[32:35], v[200:203], v[228:231], v[32:35]
    v_cvt_pk_bf16_f32 v24, v24, v25
    v_cvt_pk_bf16_f32 v25, v26, v27
    v_mfma_f32_16x16x32_bf16 v[36:39], v[204:207], v[228:231], v[36:39]
    v_cvt_pk_bf16_f32 v26, v28, v29
    v_cvt_pk_bf16_f32 v27, v30, v31
    v_mfma_f32_16x16x32_bf16 v[40:43], v[192:195], v[228:231], v[40:43]
    s_add_u32 s47, s48, 12288
    buffer_store_dwordx4 v[24:27], v251, s[16:19], s47 offen sc1
    v_mfma_f32_16x16x32_bf16 v[44:47], v[196:199], v[228:231], v[44:47]
    s_waitcnt lgkmcnt(2)
    v_mfma_f32_16x16x32_bf16 v[80:83], v[176:179], v[232:235], v[80:83]
    ds_read_b128 v[216:219], v250 offset:22528
    ds_read_b128 v[220:223], v250 offset:33792
    v_mfma_f32_16x16x32_bf16 v[84:87], v[180:183], v[232:235], v[84:87]
    v_mfma_f32_16x16x32_bf16 v[88:91], v[208:211], v[232:235], v[88:91]
    v_mfma_f32_16x16x32_bf16 v[92:95], v[212:215], v[232:235], v[92:95]
    v_mfma_f32_16x16x32_bf16 v[80:83], v[184:187], v[236:239], v[80:83]
    v_mfma_f32_16x16x32_bf16 v[84:87], v[188:191], v[236:239], v[84:87]
    v_mfma_f32_16x16x32_bf16 v[88:91], v[176:179], v[236:239], v[88:91]
    v_mfma_f32_16x16x32_bf16 v[92:95], v[180:183], v[236:239], v[92:95]
    s_waitcnt lgkmcnt(2)
    v_mfma_f32_16x16x32_bf16 v[48:51], v[192:195], v[240:243], v[48:51]
    ds_read_b128 v[224:227], v253 offset:20480
    ds_read_b128 v[228:231], v253 offset:31744
    v_mfma_f32_16x16x32_bf16 v[52:55], v[196:199], v[240:243], v[52:55]
    v_cvt_pk_bf16_f32 v32, v32, v33
    v_cvt_pk_bf16_f32 v33, v34, v35
    v_mfma_f32_16x16x32_bf16 v[56:59], v[168:171], v[240:243], v[56:59]
    v_cvt_pk_bf16_f32 v34, v36, v37
    v_cvt_pk_bf16_f32 v35, v38, v39
    v_mfma_f32_16x16x32_bf16 v[60:63], v[172:175], v[240:243], v[60:63]
    s_add_u32 s47, s48, 2048
    buffer_store_dwordx4 v[32:35], v251, s[16:19], s47 offen sc1
    v_mfma_f32_16x16x32_bf16 v[48:51], v[200:203], v[244:247], v[48:51]
    v_cvt_pk_bf16_f32 v40, v40, v41
    v_cvt_pk_bf16_f32 v41, v42, v43
    v_mfma_f32_16x16x32_bf16 v[52:55], v[204:207], v[244:247], v[52:55]
    v_cvt_pk_bf16_f32 v42, v44, v45
    v_cvt_pk_bf16_f32 v43, v46, v47
    v_mfma_f32_16x16x32_bf16 v[56:59], v[192:195], v[244:247], v[56:59]
    s_add_u32 s47, s48, 13312
    buffer_store_dwordx4 v[40:43], v251, s[16:19], s47 offen sc1
    v_mfma_f32_16x16x32_bf16 v[60:63], v[196:199], v[244:247], v[60:63]
    s_waitcnt lgkmcnt(2)
    v_mfma_f32_16x16x32_bf16 v[96:99], v[176:179], v[216:219], v[96:99]
    ds_read_b128 v[232:235], v250 offset:23552
    ds_read_b128 v[236:239], v250 offset:34816
    v_mfma_f32_16x16x32_bf16 v[100:103], v[180:183], v[216:219], v[100:103]
    v_mfma_f32_16x16x32_bf16 v[104:107], v[208:211], v[216:219], v[104:107]
    v_mfma_f32_16x16x32_bf16 v[108:111], v[212:215], v[216:219], v[108:111]
    v_mfma_f32_16x16x32_bf16 v[96:99], v[184:187], v[220:223], v[96:99]
    v_mfma_f32_16x16x32_bf16 v[100:103], v[188:191], v[220:223], v[100:103]
    v_mfma_f32_16x16x32_bf16 v[104:107], v[176:179], v[220:223], v[104:107]
    v_mfma_f32_16x16x32_bf16 v[108:111], v[180:183], v[220:223], v[108:111]
    s_waitcnt lgkmcnt(2)
    v_mfma_f32_16x16x32_bf16 v[64:67], v[192:195], v[224:227], v[64:67]
    ds_read_b128 v[240:243], v253 offset:21504
    ds_read_b128 v[244:247], v253 offset:32768
    v_mfma_f32_16x16x32_bf16 v[68:71], v[196:199], v[224:227], v[68:71]
    v_cvt_pk_bf16_f32 v48, v48, v49
    v_cvt_pk_bf16_f32 v49, v50, v51
    v_mfma_f32_16x16x32_bf16 v[72:75], v[168:171], v[224:227], v[72:75]
    v_cvt_pk_bf16_f32 v50, v52, v53
    v_cvt_pk_bf16_f32 v51, v54, v55
    v_mfma_f32_16x16x32_bf16 v[76:79], v[172:175], v[224:227], v[76:79]
    s_add_u32 s47, s48, 3072
    buffer_store_dwordx4 v[48:51], v251, s[16:19], s47 offen sc1
    v_mfma_f32_16x16x32_bf16 v[64:67], v[200:203], v[228:231], v[64:67]
    v_cvt_pk_bf16_f32 v56, v56, v57
    v_cvt_pk_bf16_f32 v57, v58, v59
    v_mfma_f32_16x16x32_bf16 v[68:71], v[204:207], v[228:231], v[68:71]
    v_cvt_pk_bf16_f32 v58, v60, v61
    v_cvt_pk_bf16_f32 v59, v62, v63
    v_mfma_f32_16x16x32_bf16 v[72:75], v[192:195], v[228:231], v[72:75]
    s_add_u32 s47, s48, 14336
    buffer_store_dwordx4 v[56:59], v251, s[16:19], s47 offen sc1
    v_mfma_f32_16x16x32_bf16 v[76:79], v[196:199], v[228:231], v[76:79]
    s_waitcnt lgkmcnt(2)
    v_mfma_f32_16x16x32_bf16 v[112:115], v[176:179], v[232:235], v[112:115]
    ds_read_b128 v[216:219], v250 offset:24576
    ds_read_b128 v[220:223], v250 offset:35840
    v_mfma_f32_16x16x32_bf16 v[116:119], v[180:183], v[232:235], v[116:119]
    v_mfma_f32_16x16x32_bf16 v[120:123], v[208:211], v[232:235], v[120:123]
    v_mfma_f32_16x16x32_bf16 v[124:127], v[212:215], v[232:235], v[124:127]
    v_mfma_f32_16x16x32_bf16 v[112:115], v[184:187], v[236:239], v[112:115]
    v_mfma_f32_16x16x32_bf16 v[116:119], v[188:191], v[236:239], v[116:119]
    v_mfma_f32_16x16x32_bf16 v[120:123], v[176:179], v[236:239], v[120:123]
    v_mfma_f32_16x16x32_bf16 v[124:127], v[180:183], v[236:239], v[124:127]
    s_waitcnt lgkmcnt(2)
    v_mfma_f32_16x16x32_bf16 v[80:83], v[192:195], v[240:243], v[80:83]
    ds_read_b128 v[224:227], v253 offset:22528
    ds_read_b128 v[228:231], v253 offset:33792
    v_mfma_f32_16x16x32_bf16 v[84:87], v[196:199], v[240:243], v[84:87]
    v_cvt_pk_bf16_f32 v64, v64, v65
    v_cvt_pk_bf16_f32 v65, v66, v67
    v_mfma_f32_16x16x32_bf16 v[88:91], v[168:171], v[240:243], v[88:91]
    v_cvt_pk_bf16_f32 v66, v68, v69
    v_cvt_pk_bf16_f32 v67, v70, v71
    v_mfma_f32_16x16x32_bf16 v[92:95], v[172:175], v[240:243], v[92:95]
    s_add_u32 s47, s48, 4096
    buffer_store_dwordx4 v[64:67], v251, s[16:19], s47 offen sc1
    v_mfma_f32_16x16x32_bf16 v[80:83], v[200:203], v[244:247], v[80:83]
    v_cvt_pk_bf16_f32 v72, v72, v73
    v_cvt_pk_bf16_f32 v73, v74, v75
    v_mfma_f32_16x16x32_bf16 v[84:87], v[204:207], v[244:247], v[84:87]
    v_cvt_pk_bf16_f32 v74, v76, v77
    v_cvt_pk_bf16_f32 v75, v78, v79
    v_mfma_f32_16x16x32_bf16 v[88:91], v[192:195], v[244:247], v[88:91]
    s_add_u32 s47, s48, 15360
    buffer_store_dwordx4 v[72:75], v251, s[16:19], s47 offen sc1
    v_mfma_f32_16x16x32_bf16 v[92:95], v[196:199], v[244:247], v[92:95]
    s_waitcnt lgkmcnt(2)
    v_mfma_f32_16x16x32_bf16 v[128:131], v[176:179], v[216:219], v[128:131]
    ds_read_b128 v[232:235], v250 offset:25600
    ds_read_b128 v[236:239], v250 offset:36864
    v_mfma_f32_16x16x32_bf16 v[132:135], v[180:183], v[216:219], v[132:135]
    v_mfma_f32_16x16x32_bf16 v[136:139], v[208:211], v[216:219], v[136:139]
    v_mfma_f32_16x16x32_bf16 v[140:143], v[212:215], v[216:219], v[140:143]
    v_mfma_f32_16x16x32_bf16 v[128:131], v[184:187], v[220:223], v[128:131]
    v_mfma_f32_16x16x32_bf16 v[132:135], v[188:191], v[220:223], v[132:135]
    v_mfma_f32_16x16x32_bf16 v[136:139], v[176:179], v[220:223], v[136:139]
    v_mfma_f32_16x16x32_bf16 v[140:143], v[180:183], v[220:223], v[140:143]
    s_waitcnt lgkmcnt(2)
    v_mfma_f32_16x16x32_bf16 v[96:99], v[192:195], v[224:227], v[96:99]
    ds_read_b128 v[240:243], v253 offset:23552
    ds_read_b128 v[244:247], v253 offset:34816
    v_mfma_f32_16x16x32_bf16 v[100:103], v[196:199], v[224:227], v[100:103]
    v_cvt_pk_bf16_f32 v80, v80, v81
    v_cvt_pk_bf16_f32 v81, v82, v83
    v_mfma_f32_16x16x32_bf16 v[104:107], v[168:171], v[224:227], v[104:107]
    v_cvt_pk_bf16_f32 v82, v84, v85
    v_cvt_pk_bf16_f32 v83, v86, v87
    v_mfma_f32_16x16x32_bf16 v[108:111], v[172:175], v[224:227], v[108:111]
    s_add_u32 s47, s48, 5120
    buffer_store_dwordx4 v[80:83], v251, s[16:19], s47 offen sc1
    v_mfma_f32_16x16x32_bf16 v[96:99], v[200:203], v[228:231], v[96:99]
    v_cvt_pk_bf16_f32 v88, v88, v89
    v_cvt_pk_bf16_f32 v89, v90, v91
    v_mfma_f32_16x16x32_bf16 v[100:103], v[204:207], v[228:231], v[100:103]
    v_cvt_pk_bf16_f32 v90, v92, v93
    v_cvt_pk_bf16_f32 v91, v94, v95
    v_mfma_f32_16x16x32_bf16 v[104:107], v[192:195], v[228:231], v[104:107]
    s_add_u32 s47, s48, 16384
    buffer_store_dwordx4 v[88:91], v251, s[16:19], s47 offen sc1
    v_mfma_f32_16x16x32_bf16 v[108:111], v[196:199], v[228:231], v[108:111]
    s_waitcnt lgkmcnt(2)
    v_mfma_f32_16x16x32_bf16 v[144:147], v[176:179], v[232:235], v[144:147]
    ds_read_b128 v[216:219], v250 offset:26624
    ds_read_b128 v[220:223], v250 offset:37888
    v_mfma_f32_16x16x32_bf16 v[148:151], v[180:183], v[232:235], v[148:151]
    v_mfma_f32_16x16x32_bf16 v[152:155], v[208:211], v[232:235], v[152:155]
    v_mfma_f32_16x16x32_bf16 v[156:159], v[212:215], v[232:235], v[156:159]
    v_mfma_f32_16x16x32_bf16 v[144:147], v[184:187], v[236:239], v[144:147]
    v_mfma_f32_16x16x32_bf16 v[148:151], v[188:191], v[236:239], v[148:151]
    v_mfma_f32_16x16x32_bf16 v[152:155], v[176:179], v[236:239], v[152:155]
    v_mfma_f32_16x16x32_bf16 v[156:159], v[180:183], v[236:239], v[156:159]
    s_waitcnt lgkmcnt(2)
    v_mfma_f32_16x16x32_bf16 v[112:115], v[192:195], v[240:243], v[112:115]
    ds_read_b128 v[224:227], v253 offset:24576
    ds_read_b128 v[228:231], v253 offset:35840
    v_mfma_f32_16x16x32_bf16 v[116:119], v[196:199], v[240:243], v[116:119]
    v_cvt_pk_bf16_f32 v96, v96, v97
    v_cvt_pk_bf16_f32 v97, v98, v99
    v_mfma_f32_16x16x32_bf16 v[120:123], v[168:171], v[240:243], v[120:123]
    v_cvt_pk_bf16_f32 v98, v100, v101
    v_cvt_pk_bf16_f32 v99, v102, v103
    v_mfma_f32_16x16x32_bf16 v[124:127], v[172:175], v[240:243], v[124:127]
    s_add_u32 s47, s48, 6144
    buffer_store_dwordx4 v[96:99], v251, s[16:19], s47 offen sc1
    v_mfma_f32_16x16x32_bf16 v[112:115], v[200:203], v[244:247], v[112:115]
    v_cvt_pk_bf16_f32 v104, v104, v105
    v_cvt_pk_bf16_f32 v105, v106, v107
    v_mfma_f32_16x16x32_bf16 v[116:119], v[204:207], v[244:247], v[116:119]
    v_cvt_pk_bf16_f32 v106, v108, v109
    v_cvt_pk_bf16_f32 v107, v110, v111
    v_mfma_f32_16x16x32_bf16 v[120:123], v[192:195], v[244:247], v[120:123]
    s_add_u32 s47, s48, 17408
    buffer_store_dwordx4 v[104:107], v251, s[16:19], s47 offen sc1
    v_mfma_f32_16x16x32_bf16 v[124:127], v[196:199], v[244:247], v[124:127]
    s_waitcnt lgkmcnt(2)
    v_mfma_f32_16x16x32_bf16 v[160:163], v[176:179], v[216:219], v[160:163]
    ds_read_b128 v[232:235], v253 offset:25600
    ds_read_b128 v[236:239], v253 offset:36864
    v_mfma_f32_16x16x32_bf16 v[164:167], v[208:211], v[216:219], v[164:167]
    v_mfma_f32_16x16x32_bf16 v[160:163], v[184:187], v[220:223], v[160:163]
    v_mfma_f32_16x16x32_bf16 v[164:167], v[176:179], v[220:223], v[164:167]
    s_waitcnt lgkmcnt(2)
    v_mfma_f32_16x16x32_bf16 v[128:131], v[192:195], v[224:227], v[128:131]
    ds_read_b128 v[240:243], v253 offset:26624
    ds_read_b128 v[244:247], v253 offset:37888
    v_mfma_f32_16x16x32_bf16 v[132:135], v[196:199], v[224:227], v[132:135]
    v_cvt_pk_bf16_f32 v112, v112, v113
    v_cvt_pk_bf16_f32 v113, v114, v115
    v_mfma_f32_16x16x32_bf16 v[136:139], v[168:171], v[224:227], v[136:139]
    v_cvt_pk_bf16_f32 v114, v116, v117
    v_cvt_pk_bf16_f32 v115, v118, v119
    v_mfma_f32_16x16x32_bf16 v[140:143], v[172:175], v[224:227], v[140:143]
    s_add_u32 s47, s48, 7168
    buffer_store_dwordx4 v[112:115], v251, s[16:19], s47 offen sc1
    v_mfma_f32_16x16x32_bf16 v[128:131], v[200:203], v[228:231], v[128:131]
    v_cvt_pk_bf16_f32 v120, v120, v121
    v_cvt_pk_bf16_f32 v121, v122, v123
    v_mfma_f32_16x16x32_bf16 v[132:135], v[204:207], v[228:231], v[132:135]
    v_cvt_pk_bf16_f32 v122, v124, v125
    v_cvt_pk_bf16_f32 v123, v126, v127
    v_mfma_f32_16x16x32_bf16 v[136:139], v[192:195], v[228:231], v[136:139]
    s_add_u32 s47, s48, 18432
    buffer_store_dwordx4 v[120:123], v251, s[16:19], s47 offen sc1
    v_mfma_f32_16x16x32_bf16 v[140:143], v[196:199], v[228:231], v[140:143]
    s_waitcnt lgkmcnt(2)
    v_mfma_f32_16x16x32_bf16 v[144:147], v[192:195], v[232:235], v[144:147]
    v_mfma_f32_16x16x32_bf16 v[148:151], v[196:199], v[232:235], v[148:151]
    v_mfma_f32_16x16x32_bf16 v[152:155], v[168:171], v[232:235], v[152:155]
    v_mfma_f32_16x16x32_bf16 v[156:159], v[172:175], v[232:235], v[156:159]
    v_mfma_f32_16x16x32_bf16 v[144:147], v[200:203], v[236:239], v[144:147]
    v_mfma_f32_16x16x32_bf16 v[148:151], v[204:207], v[236:239], v[148:151]
    v_mfma_f32_16x16x32_bf16 v[152:155], v[192:195], v[236:239], v[152:155]
    v_mfma_f32_16x16x32_bf16 v[156:159], v[196:199], v[236:239], v[156:159]
    s_waitcnt lgkmcnt(0)
    v_mfma_f32_16x16x32_bf16 v[160:163], v[192:195], v[240:243], v[160:163]
    v_mfma_f32_16x16x32_bf16 v[164:167], v[168:171], v[240:243], v[164:167]
    v_cvt_pk_bf16_f32 v128, v128, v129
    v_cvt_pk_bf16_f32 v129, v130, v131
    v_mfma_f32_16x16x32_bf16 v[160:163], v[200:203], v[244:247], v[160:163]
    v_cvt_pk_bf16_f32 v130, v132, v133
    v_cvt_pk_bf16_f32 v131, v134, v135
    v_mfma_f32_16x16x32_bf16 v[164:167], v[192:195], v[244:247], v[164:167]
    s_add_u32 s47, s48, 8192
    buffer_store_dwordx4 v[128:131], v251, s[16:19], s47 offen sc1
    s_nop 7
    v_cvt_pk_bf16_f32 v136, v136, v137
    v_cvt_pk_bf16_f32 v137, v138, v139
    v_cvt_pk_bf16_f32 v138, v140, v141
    v_cvt_pk_bf16_f32 v139, v142, v143
    s_add_u32 s47, s48, 19456
    buffer_store_dwordx4 v[136:139], v251, s[16:19], s47 offen sc1
    v_cvt_pk_bf16_f32 v144, v144, v145
    v_cvt_pk_bf16_f32 v145, v146, v147
    v_cvt_pk_bf16_f32 v146, v148, v149
    v_cvt_pk_bf16_f32 v147, v150, v151
    s_add_u32 s47, s48, 9216
    buffer_store_dwordx4 v[144:147], v251, s[16:19], s47 offen sc1
    v_cvt_pk_bf16_f32 v152, v152, v153
    v_cvt_pk_bf16_f32 v153, v154, v155
    v_cvt_pk_bf16_f32 v154, v156, v157
    v_cvt_pk_bf16_f32 v155, v158, v159
    s_add_u32 s47, s48, 20480
    buffer_store_dwordx4 v[152:155], v251, s[16:19], s47 offen sc1
    v_cvt_pk_bf16_f32 v160, v160, v161
    v_cvt_pk_bf16_f32 v161, v162, v163
    s_add_u32 s47, s49, 0
    buffer_store_dwordx2 v[160:161], v252, s[16:19], s47 offen sc1
    v_cvt_pk_bf16_f32 v164, v164, v165
    v_cvt_pk_bf16_f32 v165, v166, v167
    s_add_u32 s47, s49, 11264
    buffer_store_dwordx2 v[164:165], v252, s[16:19], s47 offen sc1
    s_branch L_epi_done
L_epi_b1:
    v_add_u32 v248, 0x9800, v248
    v_add_u32 v249, 0x9800, v249
    v_add_u32 v253, 38912, v250
    ds_read_b64_tr_b16 v[192:193], v248 offset:0
    ds_read_b64_tr_b16 v[194:195], v248 offset:1024
    ds_read_b64_tr_b16 v[196:197], v249 offset:0
    ds_read_b64_tr_b16 v[198:199], v249 offset:1024
    ds_read_b64_tr_b16 v[200:201], v248 offset:8192
    ds_read_b64_tr_b16 v[202:203], v248 offset:9216
    ds_read_b64_tr_b16 v[204:205], v249 offset:8192
    ds_read_b64_tr_b16 v[206:207], v249 offset:9216
    s_waitcnt lgkmcnt(10)
    v_mfma_f32_16x16x32_bf16 v[0:3], v[176:179], v[232:235], v[0:3]
    ds_read_b128 v[216:219], v250 offset:18432
    ds_read_b128 v[220:223], v250 offset:29696
    v_mfma_f32_16x16x32_bf16 v[4:7], v[180:183], v[232:235], v[4:7]
    v_mfma_f32_16x16x32_bf16 v[8:11], v[208:211], v[232:235], v[8:11]
    v_mfma_f32_16x16x32_bf16 v[12:15], v[212:215], v[232:235], v[12:15]
    v_mfma_f32_16x16x32_bf16 v[0:3], v[184:187], v[236:239], v[0:3]
    v_mfma_f32_16x16x32_bf16 v[4:7], v[188:191], v[236:239], v[4:7]
    v_mfma_f32_16x16x32_bf16 v[8:11], v[176:179], v[236:239], v[8:11]
    v_mfma_f32_16x16x32_bf16 v[12:15], v[180:183], v[236:239], v[12:15]
    s_waitcnt lgkmcnt(10)
    v_mfma_f32_16x16x32_bf16 v[16:19], v[176:179], v[240:243], v[16:19]
    ds_read_b128 v[224:227], v253 offset:16384
    ds_read_b128 v[228:231], v253 offset:27648
    v_mfma_f32_16x16x32_bf16 v[20:23], v[180:183], v[240:243], v[20:23]
    v_mfma_f32_16x16x32_bf16 v[24:27], v[208:211], v[240:243], v[24:27]
    v_mfma_f32_16x16x32_bf16 v[28:31], v[212:215], v[240:243], v[28:31]
    v_mfma_f32_16x16x32_bf16 v[16:19], v[184:187], v[244:247], v[16:19]
    v_mfma_f32_16x16x32_bf16 v[20:23], v[188:191], v[244:247], v[20:23]
    v_mfma_f32_16x16x32_bf16 v[24:27], v[176:179], v[244:247], v[24:27]
    v_mfma_f32_16x16x32_bf16 v[28:31], v[180:183], v[244:247], v[28:31]
    s_waitcnt lgkmcnt(2)
    v_mfma_f32_16x16x32_bf16 v[32:35], v[176:179], v[216:219], v[32:35]
    ds_read_b128 v[232:235], v250 offset:19456
    ds_read_b128 v[236:239], v250 offset:30720
    v_mfma_f32_16x16x32_bf16 v[36:39], v[180:183], v[216:219], v[36:39]
    v_mfma_f32_16x16x32_bf16 v[40:43], v[208:211], v[216:219], v[40:43]
    v_mfma_f32_16x16x32_bf16 v[44:47], v[212:215], v[216:219], v[44:47]
    v_mfma_f32_16x16x32_bf16 v[32:35], v[184:187], v[220:223], v[32:35]
    v_mfma_f32_16x16x32_bf16 v[36:39], v[188:191], v[220:223], v[36:39]
    v_mfma_f32_16x16x32_bf16 v[40:43], v[176:179], v[220:223], v[40:43]
    v_mfma_f32_16x16x32_bf16 v[44:47], v[180:183], v[220:223], v[44:47]
    v_xor_b32 v168, 0x80008000, v200
    v_xor_b32 v169, 0x80008000, v201
    v_xor_b32 v170, 0x80008000, v202
    v_xor_b32 v171, 0x80008000, v203
    v_xor_b32 v172, 0x80008000, v204
    v_xor_b32 v173, 0x80008000, v205
    v_xor_b32 v174, 0x80008000, v206
    v_xor_b32 v175, 0x80008000, v207
    s_waitcnt lgkmcnt(2)
    v_mfma_f32_16x16x32_bf16 v[0:3], v[192:195], v[224:227], v[0:3]
    ds_read_b128 v[240:243], v253 offset:17408
    ds_read_b128 v[244:247], v253 offset:28672
    v_mfma_f32_16x16x32_bf16 v[4:7], v[196:199], v[224:227], v[4:7]
    v_mfma_f32_16x16x32_bf16 v[8:11], v[168:171], v[224:227], v[8:11]
    v_mfma_f32_16x16x32_bf16 v[12:15], v[172:175], v[224:227], v[12:15]
    v_mfma_f32_16x16x32_bf16 v[0:3], v[200:203], v[228:231], v[0:3]
    v_mfma_f32_16x16x32_bf16 v[4:7], v[204:207], v[228:231], v[4:7]
    v_mfma_f32_16x16x32_bf16 v[8:11], v[192:195], v[228:231], v[8:11]
    v_mfma_f32_16x16x32_bf16 v[12:15], v[196:199], v[228:231], v[12:15]
    s_waitcnt lgkmcnt(2)
    v_mfma_f32_16x16x32_bf16 v[48:51], v[176:179], v[232:235], v[48:51]
    ds_read_b128 v[216:219], v250 offset:20480
    ds_read_b128 v[220:223], v250 offset:31744
    v_mfma_f32_16x16x32_bf16 v[52:55], v[180:183], v[232:235], v[52:55]
    v_mfma_f32_16x16x32_bf16 v[56:59], v[208:211], v[232:235], v[56:59]
    v_mfma_f32_16x16x32_bf16 v[60:63], v[212:215], v[232:235], v[60:63]
    v_mfma_f32_16x16x32_bf16 v[48:51], v[184:187], v[236:239], v[48:51]
    v_mfma_f32_16x16x32_bf16 v[52:55], v[188:191], v[236:239], v[52:55]
    v_mfma_f32_16x16x32_bf16 v[56:59], v[176:179], v[236:239], v[56:59]
    v_mfma_f32_16x16x32_bf16 v[60:63], v[180:183], v[236:239], v[60:63]
    s_waitcnt lgkmcnt(2)
    v_mfma_f32_16x16x32_bf16 v[16:19], v[192:195], v[240:243], v[16:19]
    ds_read_b128 v[224:227], v253 offset:18432
    ds_read_b128 v[228:231], v253 offset:29696
    v_mfma_f32_16x16x32_bf16 v[20:23], v[196:199], v[240:243], v[20:23]
    v_cvt_pk_bf16_f32 v4, v4, v5
    v_cvt_pk_bf16_f32 v5, v6, v7
    v_mfma_f32_16x16x32_bf16 v[24:27], v[168:171], v[240:243], v[24:27]
    v_cvt_pk_bf16_f32 v6, v0, v1
    v_cvt_pk_bf16_f32 v7, v2, v3
    v_mfma_f32_16x16x32_bf16 v[28:31], v[172:175], v[240:243], v[28:31]
    s_add_u32 s47, s48, 0
    buffer_store_dwordx4 v[4:7], v251, s[16:19], s47 offen sc1
    v_mfma_f32_16x16x32_bf16 v[16:19], v[200:203], v[244:247], v[16:19]
    v_cvt_pk_bf16_f32 v12, v12, v13
    v_cvt_pk_bf16_f32 v13, v14, v15
    v_mfma_f32_16x16x32_bf16 v[20:23], v[204:207], v[244:247], v[20:23]
    v_cvt_pk_bf16_f32 v14, v8, v9
    v_cvt_pk_bf16_f32 v15, v10, v11
    v_mfma_f32_16x16x32_bf16 v[24:27], v[192:195], v[244:247], v[24:27]
    s_add_u32 s47, s48, 11264
    buffer_store_dwordx4 v[12:15], v251, s[16:19], s47 offen sc1
    v_mfma_f32_16x16x32_bf16 v[28:31], v[196:199], v[244:247], v[28:31]
    s_waitcnt lgkmcnt(2)
    v_mfma_f32_16x16x32_bf16 v[64:67], v[176:179], v[216:219], v[64:67]
    ds_read_b128 v[232:235], v250 offset:21504
    ds_read_b128 v[236:239], v250 offset:32768
    v_mfma_f32_16x16x32_bf16 v[68:71], v[180:183], v[216:219], v[68:71]
    v_mfma_f32_16x16x32_bf16 v[72:75], v[208:211], v[216:219], v[72:75]
    v_mfma_f32_16x16x32_bf16 v[76:79], v[212:215], v[216:219], v[76:79]
    v_mfma_f32_16x16x32_bf16 v[64:67], v[184:187], v[220:223], v[64:67]
    v_mfma_f32_16x16x32_bf16 v[68:71], v[188:191], v[220:223], v[68:71]
    v_mfma_f32_16x16x32_bf16 v[72:75], v[176:179], v[220:223], v[72:75]
    v_mfma_f32_16x16x32_bf16 v[76:79], v[180:183], v[220:223], v[76:79]
    s_waitcnt lgkmcnt(2)
    v_mfma_f32_16x16x32_bf16 v[32:35], v[192:195], v[224:227], v[32:35]
    ds_read_b128 v[240:243], v253 offset:19456
    ds_read_b128 v[244:247], v253 offset:30720
    v_mfma_f32_16x16x32_bf16 v[36:39], v[196:199], v[224:227], v[36:39]
    v_cvt_pk_bf16_f32 v20, v20, v21
    v_cvt_pk_bf16_f32 v21, v22, v23
    v_mfma_f32_16x16x32_bf16 v[40:43], v[168:171], v[224:227], v[40:43]
    v_cvt_pk_bf16_f32 v22, v16, v17
    v_cvt_pk_bf16_f32 v23, v18, v19
    v_mfma_f32_16x16x32_bf16 v[44:47], v[172:175], v[224:227], v[44:47]
    s_add_u32 s47, s48, 1024
    buffer_store_dwordx4 v[20:23], v251, s[16:19], s47 offen sc1
    v_mfma_f32_16x16x32_bf16 v[32:35], v[200:203], v[228:231], v[32:35]
    v_cvt_pk_bf16_f32 v28, v28, v29
    v_cvt_pk_bf16_f32 v29, v30, v31
    v_mfma_f32_16x16x32_bf16 v[36:39], v[204:207], v[228:231], v[36:39]
    v_cvt_pk_bf16_f32 v30, v24, v25
    v_cvt_pk_bf16_f32 v31, v26, v27
    v_mfma_f32_16x16x32_bf16 v[40:43], v[192:195], v[228:231], v[40:43]
    s_add_u32 s47, s48, 12288
    buffer_store_dwordx4 v[28:31], v251, s[16:19], s47 offen sc1
    v_mfma_f32_16x16x32_bf16 v[44:47], v[196:199], v[228:231], v[44:47]
    s_waitcnt lgkmcnt(2)
    v_mfma_f32_16x16x32_bf16 v[80:83], v[176:179], v[232:235], v[80:83]
    ds_read_b128 v[216:219], v250 offset:22528
    ds_read_b128 v[220:223], v250 offset:33792
    v_mfma_f32_16x16x32_bf16 v[84:87], v[180:183], v[232:235], v[84:87]
    v_mfma_f32_16x16x32_bf16 v[88:91], v[208:211], v[232:235], v[88:91]
    v_mfma_f32_16x16x32_bf16 v[92:95], v[212:215], v[232:235], v[92:95]
    v_mfma_f32_16x16x32_bf16 v[80:83], v[184:187], v[236:239], v[80:83]
    v_mfma_f32_16x16x32_bf16 v[84:87], v[188:191], v[236:239], v[84:87]
    v_mfma_f32_16x16x32_bf16 v[88:91], v[176:179], v[236:239], v[88:91]
    v_mfma_f32_16x16x32_bf16 v[92:95], v[180:183], v[236:239], v[92:95]
    s_waitcnt lgkmcnt(2)
    v_mfma_f32_16x16x32_bf16 v[48:51], v[192:195], v[240:243], v[48:51]
    ds_read_b128 v[224:227], v253 offset:20480
    ds_read_b128 v[228:231], v253 offset:31744
    v_mfma_f32_16x16x32_bf16 v[52:55], v[196:199], v[240:243], v[52:55]
    v_cvt_pk_bf16_f32 v36, v36, v37
    v_cvt_pk_bf16_f32 v37, v38, v39
    v_mfma_f32_16x16x32_bf16 v[56:59], v[168:171], v[240:243], v[56:59]
    v_cvt_pk_bf16_f32 v38, v32, v33
    v_cvt_pk_bf16_f32 v39, v34, v35
    v_mfma_f32_16x16x32_bf16 v[60:63], v[172:175], v[240:243], v[60:63]
    s_add_u32 s47, s48, 2048
    buffer_store_dwordx4 v[36:39], v251, s[16:19], s47 offen sc1
    v_mfma_f32_16x16x32_bf16 v[48:51], v[200:203], v[244:247], v[48:51]
    v_cvt_pk_bf16_f32 v44, v44, v45
    v_cvt_pk_bf16_f32 v45, v46, v47
    v_mfma_f32_16x16x32_bf16 v[52:55], v[204:207], v[244:247], v[52:55]
    v_cvt_pk_bf16_f32 v46, v40, v41
    v_cvt_pk_bf16_f32 v47, v42, v43
    v_mfma_f32_16x16x32_bf16 v[56:59], v[192:195], v[244:247], v[56:59]
    s_add_u32 s47, s48, 13312
    buffer_store_dwordx4 v[44:47], v251, s[16:19], s47 offen sc1
    v_mfma_f32_16x16x32_bf16 v[60:63], v[196:199], v[244:247], v[60:63]
    s_waitcnt lgkmcnt(2)
    v_mfma_f32_16x16x32_bf16 v[96:99], v[176:179], v[216:219], v[96:99]
    ds_read_b128 v[232:235], v250 offset:23552
    ds_read_b128 v[236:239], v250 offset:34816
    v_mfma_f32_16x16x32_bf16 v[100:103], v[180:183], v[216:219], v[100:103]
    v_mfma_f32_16x16x32_bf16 v[104:107], v[208:211], v[216:219], v[104:107]
    v_mfma_f32_16x16x32_bf16 v[108:111], v[212:215], v[216:219], v[108:111]
    v_mfma_f32_16x16x32_bf16 v[96:99], v[184:187], v[220:223], v[96:99]
    v_mfma_f32_16x16x32_bf16 v[100:103], v[188:191], v[220:223], v[100:103]
    v_mfma_f32_16x16x32_bf16 v[104:107], v[176:179], v[220:223], v[104:107]
    v_mfma_f32_16x16x32_bf16 v[108:111], v[180:183], v[220:223], v[108:111]
    s_waitcnt lgkmcnt(2)
    v_mfma_f32_16x16x32_bf16 v[64:67], v[192:195], v[224:227], v[64:67]
    ds_read_b128 v[240:243], v253 offset:21504
    ds_read_b128 v[244:247], v253 offset:32768
    v_mfma_f32_16x16x32_bf16 v[68:71], v[196:199], v[224:227], v[68:71]
    v_cvt_pk_bf16_f32 v52, v52, v53
    v_cvt_pk_bf16_f32 v53, v54, v55
    v_mfma_f32_16x16x32_bf16 v[72:75], v[168:171], v[224:227], v[72:75]
    v_cvt_pk_bf16_f32 v54, v48, v49
    v_cvt_pk_bf16_f32 v55, v50, v51
    v_mfma_f32_16x16x32_bf16 v[76:79], v[172:175], v[224:227], v[76:79]
    s_add_u32 s47, s48, 3072
    buffer_store_dwordx4 v[52:55], v251, s[16:19], s47 offen sc1
    v_mfma_f32_16x16x32_bf16 v[64:67], v[200:203], v[228:231], v[64:67]
    v_cvt_pk_bf16_f32 v60, v60, v61
    v_cvt_pk_bf16_f32 v61, v62, v63
    v_mfma_f32_16x16x32_bf16 v[68:71], v[204:207], v[228:231], v[68:71]
    v_cvt_pk_bf16_f32 v62, v56, v57
    v_cvt_pk_bf16_f32 v63, v58, v59
    v_mfma_f32_16x16x32_bf16 v[72:75], v[192:195], v[228:231], v[72:75]
    s_add_u32 s47, s48, 14336
    buffer_store_dwordx4 v[60:63], v251, s[16:19], s47 offen sc1
    v_mfma_f32_16x16x32_bf16 v[76:79], v[196:199], v[228:231], v[76:79]
    s_waitcnt lgkmcnt(2)
    v_mfma_f32_16x16x32_bf16 v[112:115], v[176:179], v[232:235], v[112:115]
    ds_read_b128 v[216:219], v250 offset:24576
    ds_read_b128 v[220:223], v250 offset:35840
    v_mfma_f32_16x16x32_bf16 v[116:119], v[180:183], v[232:235], v[116:119]
    v_mfma_f32_16x16x32_bf16 v[120:123], v[208:211], v[232:235], v[120:123]
    v_mfma_f32_16x16x32_bf16 v[124:127], v[212:215], v[232:235], v[124:127]
    v_mfma_f32_16x16x32_bf16 v[112:115], v[184:187], v[236:239], v[112:115]
    v_mfma_f32_16x16x32_bf16 v[116:119], v[188:191], v[236:239], v[116:119]
    v_mfma_f32_16x16x32_bf16 v[120:123], v[176:179], v[236:239], v[120:123]
    v_mfma_f32_16x16x32_bf16 v[124:127], v[180:183], v[236:239], v[124:127]
    s_waitcnt lgkmcnt(2)
    v_mfma_f32_16x16x32_bf16 v[80:83], v[192:195], v[240:243], v[80:83]
    ds_read_b128 v[224:227], v253 offset:22528
    ds_read_b128 v[228:231], v253 offset:33792
    v_mfma_f32_16x16x32_bf16 v[84:87], v[196:199], v[240:243], v[84:87]
    v_cvt_pk_bf16_f32 v68, v68, v69
    v_cvt_pk_bf16_f32 v69, v70, v71
    v_mfma_f32_16x16x32_bf16 v[88:91], v[168:171], v[240:243], v[88:91]
    v_cvt_pk_bf16_f32 v70, v64, v65
    v_cvt_pk_bf16_f32 v71, v66, v67
    v_mfma_f32_16x16x32_bf16 v[92:95], v[172:175], v[240:243], v[92:95]
    s_add_u32 s47, s48, 4096
    buffer_store_dwordx4 v[68:71], v251, s[16:19], s47 offen sc1
    v_mfma_f32_16x16x32_bf16 v[80:83], v[200:203], v[244:247], v[80:83]
    v_cvt_pk_bf16_f32 v76, v76, v77
    v_cvt_pk_bf16_f32 v77, v78, v79
    v_mfma_f32_16x16x32_bf16 v[84:87], v[204:207], v[244:247], v[84:87]
    v_cvt_pk_bf16_f32 v78, v72, v73
    v_cvt_pk_bf16_f32 v79, v74, v75
    v_mfma_f32_16x16x32_bf16 v[88:91], v[192:195], v[244:247], v[88:91]
    s_add_u32 s47, s48, 15360
    buffer_store_dwordx4 v[76:79], v251, s[16:19], s47 offen sc1
    v_mfma_f32_16x16x32_bf16 v[92:95], v[196:199], v[244:247], v[92:95]
    s_waitcnt lgkmcnt(2)
    v_mfma_f32_16x16x32_bf16 v[128:131], v[176:179], v[216:219], v[128:131]
    ds_read_b128 v[232:235], v250 offset:25600
    ds_read_b128 v[236:239], v250 offset:36864
    v_mfma_f32_16x16x32_bf16 v[132:135], v[180:183], v[216:219], v[132:135]
    v_mfma_f32_16x16x32_bf16 v[136:139], v[208:211], v[216:219], v[136:139]
    v_mfma_f32_16x16x32_bf16 v[140:143], v[212:215], v[216:219], v[140:143]
    v_mfma_f32_16x16x32_bf16 v[128:131], v[184:187], v[220:223], v[128:131]
    v_mfma_f32_16x16x32_bf16 v[132:135], v[188:191], v[220:223], v[132:135]
    v_mfma_f32_16x16x32_bf16 v[136:139], v[176:179], v[220:223], v[136:139]
    v_mfma_f32_16x16x32_bf16 v[140:143], v[180:183], v[220:223], v[140:143]
    s_waitcnt lgkmcnt(2)
    v_mfma_f32_16x16x32_bf16 v[96:99], v[192:195], v[224:227], v[96:99]
    ds_read_b128 v[240:243], v253 offset:23552
    ds_read_b128 v[244:247], v253 offset:34816
    v_mfma_f32_16x16x32_bf16 v[100:103], v[196:199], v[224:227], v[100:103]
    v_cvt_pk_bf16_f32 v84, v84, v85
    v_cvt_pk_bf16_f32 v85, v86, v87
    v_mfma_f32_16x16x32_bf16 v[104:107], v[168:171], v[224:227], v[104:107]
    v_cvt_pk_bf16_f32 v86, v80, v81
    v_cvt_pk_bf16_f32 v87, v82, v83
    v_mfma_f32_16x16x32_bf16 v[108:111], v[172:175], v[224:227], v[108:111]
    s_add_u32 s47, s48, 5120
    buffer_store_dwordx4 v[84:87], v251, s[16:19], s47 offen sc1
    v_mfma_f32_16x16x32_bf16 v[96:99], v[200:203], v[228:231], v[96:99]
    v_cvt_pk_bf16_f32 v92, v92, v93
    v_cvt_pk_bf16_f32 v93, v94, v95
    v_mfma_f32_16x16x32_bf16 v[100:103], v[204:207], v[228:231], v[100:103]
    v_cvt_pk_bf16_f32 v94, v88, v89
    v_cvt_pk_bf16_f32 v95, v90, v91
    v_mfma_f32_16x16x32_bf16 v[104:107], v[192:195], v[228:231], v[104:107]
    s_add_u32 s47, s48, 16384
    buffer_store_dwordx4 v[92:95], v251, s[16:19], s47 offen sc1
    v_mfma_f32_16x16x32_bf16 v[108:111], v[196:199], v[228:231], v[108:111]
    s_waitcnt lgkmcnt(2)
    v_mfma_f32_16x16x32_bf16 v[144:147], v[176:179], v[232:235], v[144:147]
    ds_read_b128 v[216:219], v250 offset:26624
    ds_read_b128 v[220:223], v250 offset:37888
    v_mfma_f32_16x16x32_bf16 v[148:151], v[180:183], v[232:235], v[148:151]
    v_mfma_f32_16x16x32_bf16 v[152:155], v[208:211], v[232:235], v[152:155]
    v_mfma_f32_16x16x32_bf16 v[156:159], v[212:215], v[232:235], v[156:159]
    v_mfma_f32_16x16x32_bf16 v[144:147], v[184:187], v[236:239], v[144:147]
    v_mfma_f32_16x16x32_bf16 v[148:151], v[188:191], v[236:239], v[148:151]
    v_mfma_f32_16x16x32_bf16 v[152:155], v[176:179], v[236:239], v[152:155]
    v_mfma_f32_16x16x32_bf16 v[156:159], v[180:183], v[236:239], v[156:159]
    s_waitcnt lgkmcnt(2)
    v_mfma_f32_16x16x32_bf16 v[112:115], v[192:195], v[240:243], v[112:115]
    ds_read_b128 v[224:227], v253 offset:24576
    ds_read_b128 v[228:231], v253 offset:35840
    v_mfma_f32_16x16x32_bf16 v[116:119], v[196:199], v[240:243], v[116:119]
    v_cvt_pk_bf16_f32 v100, v100, v101
    v_cvt_pk_bf16_f32 v101, v102, v103
    v_mfma_f32_16x16x32_bf16 v[120:123], v[168:171], v[240:243], v[120:123]
    v_cvt_pk_bf16_f32 v102, v96, v97
    v_cvt_pk_bf16_f32 v103, v98, v99
    v_mfma_f32_16x16x32_bf16 v[124:127], v[172:175], v[240:243], v[124:127]
    s_add_u32 s47, s48, 6144
    buffer_store_dwordx4 v[100:103], v251, s[16:19], s47 offen sc1
    v_mfma_f32_16x16x32_bf16 v[112:115], v[200:203], v[244:247], v[112:115]
    v_cvt_pk_bf16_f32 v108, v108, v109
    v_cvt_pk_bf16_f32 v109, v110, v111
    v_mfma_f32_16x16x32_bf16 v[116:119], v[204:207], v[244:247], v[116:119]
    v_cvt_pk_bf16_f32 v110, v104, v105
    v_cvt_pk_bf16_f32 v111, v106, v107
    v_mfma_f32_16x16x32_bf16 v[120:123], v[192:195], v[244:247], v[120:123]
    s_add_u32 s47, s48, 17408
    buffer_store_dwordx4 v[108:111], v251, s[16:19], s47 offen sc1
    v_mfma_f32_16x16x32_bf16 v[124:127], v[196:199], v[244:247], v[124:127]
    s_waitcnt lgkmcnt(2)
    v_mfma_f32_16x16x32_bf16 v[160:163], v[176:179], v[216:219], v[160:163]
    ds_read_b128 v[232:235], v253 offset:25600
    ds_read_b128 v[236:239], v253 offset:36864
    v_mfma_f32_16x16x32_bf16 v[164:167], v[208:211], v[216:219], v[164:167]
    v_mfma_f32_16x16x32_bf16 v[160:163], v[184:187], v[220:223], v[160:163]
    v_mfma_f32_16x16x32_bf16 v[164:167], v[176:179], v[220:223], v[164:167]
    s_waitcnt lgkmcnt(2)
    v_mfma_f32_16x16x32_bf16 v[128:131], v[192:195], v[224:227], v[128:131]
    ds_read_b128 v[240:243], v253 offset:26624
    ds_read_b128 v[244:247], v253 offset:37888
    v_mfma_f32_16x16x32_bf16 v[132:135], v[196:199], v[224:227], v[132:135]
    v_cvt_pk_bf16_f32 v116, v116, v117
    v_cvt_pk_bf16_f32 v117, v118, v119
    v_mfma_f32_16x16x32_bf16 v[136:139], v[168:171], v[224:227], v[136:139]
    v_cvt_pk_bf16_f32 v118, v112, v113
    v_cvt_pk_bf16_f32 v119, v114, v115
    v_mfma_f32_16x16x32_bf16 v[140:143], v[172:175], v[224:227], v[140:143]
    s_add_u32 s47, s48, 7168
    buffer_store_dwordx4 v[116:119], v251, s[16:19], s47 offen sc1
    v_mfma_f32_16x16x32_bf16 v[128:131], v[200:203], v[228:231], v[128:131]
    v_cvt_pk_bf16_f32 v124, v124, v125
    v_cvt_pk_bf16_f32 v125, v126, v127
    v_mfma_f32_16x16x32_bf16 v[132:135], v[204:207], v[228:231], v[132:135]
    v_cvt_pk_bf16_f32 v126, v120, v121
    v_cvt_pk_bf16_f32 v127, v122, v123
    v_mfma_f32_16x16x32_bf16 v[136:139], v[192:195], v[228:231], v[136:139]
    s_add_u32 s47, s48, 18432
    buffer_store_dwordx4 v[124:127], v251, s[16:19], s47 offen sc1
    v_mfma_f32_16x16x32_bf16 v[140:143], v[196:199], v[228:231], v[140:143]
    s_waitcnt lgkmcnt(2)
    v_mfma_f32_16x16x32_bf16 v[144:147], v[192:195], v[232:235], v[144:147]
    v_mfma_f32_16x16x32_bf16 v[148:151], v[196:199], v[232:235], v[148:151]
    v_mfma_f32_16x16x32_bf16 v[152:155], v[168:171], v[232:235], v[152:155]
    v_mfma_f32_16x16x32_bf16 v[156:159], v[172:175], v[232:235], v[156:159]
    v_mfma_f32_16x16x32_bf16 v[144:147], v[200:203], v[236:239], v[144:147]
    v_mfma_f32_16x16x32_bf16 v[148:151], v[204:207], v[236:239], v[148:151]
    v_mfma_f32_16x16x32_bf16 v[152:155], v[192:195], v[236:239], v[152:155]
    v_mfma_f32_16x16x32_bf16 v[156:159], v[196:199], v[236:239], v[156:159]
    s_waitcnt lgkmcnt(0)
    v_mfma_f32_16x16x32_bf16 v[160:163], v[192:195], v[240:243], v[160:163]
    v_mfma_f32_16x16x32_bf16 v[164:167], v[168:171], v[240:243], v[164:167]
    v_cvt_pk_bf16_f32 v132, v132, v133
    v_cvt_pk_bf16_f32 v133, v134, v135
    v_mfma_f32_16x16x32_bf16 v[160:163], v[200:203], v[244:247], v[160:163]
    v_cvt_pk_bf16_f32 v134, v128, v129
    v_cvt_pk_bf16_f32 v135, v130, v131
    v_mfma_f32_16x16x32_bf16 v[164:167], v[192:195], v[244:247], v[164:167]
    s_add_u32 s47, s48, 8192
    buffer_store_dwordx4 v[132:135], v251, s[16:19], s47 offen sc1
    s_nop 7
    v_cvt_pk_bf16_f32 v140, v140, v141
    v_cvt_pk_bf16_f32 v141, v142, v143
    v_cvt_pk_bf16_f32 v142, v136, v137
    v_cvt_pk_bf16_f32 v143, v138, v139
    s_add_u32 s47, s48, 19456
    buffer_store_dwordx4 v[140:143], v251, s[16:19], s47 offen sc1
    v_cvt_pk_bf16_f32 v148, v148, v149
    v_cvt_pk_bf16_f32 v149, v150, v151
    v_cvt_pk_bf16_f32 v150, v144, v145
    v_cvt_pk_bf16_f32 v151, v146, v147
    s_add_u32 s47, s48, 9216
    buffer_store_dwordx4 v[148:151], v251, s[16:19], s47 offen sc1
    v_cvt_pk_bf16_f32 v156, v156, v157
    v_cvt_pk_bf16_f32 v157, v158, v159
    v_cvt_pk_bf16_f32 v158, v152, v153
    v_cvt_pk_bf16_f32 v159, v154, v155
    s_add_u32 s47, s48, 20480
    buffer_store_dwordx4 v[156:159], v251, s[16:19], s47 offen sc1
    v_cvt_pk_bf16_f32 v160, v160, v161
    v_cvt_pk_bf16_f32 v161, v162, v163
    s_add_u32 s47, s49, 0
    buffer_store_dwordx2 v[160:161], v252, s[16:19], s47 offen sc1
    v_cvt_pk_bf16_f32 v164, v164, v165
    v_cvt_pk_bf16_f32 v165, v166, v167
    s_add_u32 s47, s49, 11264
    buffer_store_dwordx2 v[164:165], v252, s[16:19], s47 offen sc1
L_epi_done:
    s_endpgm
L_k3_helper:
    s_mul_i32 s40, s11, 16384
    s_mul_i32 s20, s14, 16777216
    s_add_u32 s40, s40, s20
    s_mul_i32 s41, s11, 21504
    s_mul_i32 s20, s13, 22020096
    s_add_u32 s41, s41, s20
    s_add_u32 s41, s41, 67108864
    s_lshl_b32 s42, s15, 12
    s_mul_i32 s43, s15, 5632
    s_lshr_b32 s20, s15, 1
    s_lshl_b32 s21, s20, 9
    s_sub_u32 s21, s43, s21
    v_lshlrev_b32 v1, 4, v0
    v_lshlrev_b32 v1, 4, v0
    v_add_u32 v2, s21, v1
    s_add_u32 s22, s21, 4096
    v_add_u32 v5, s22, v1
    s_mov_b32 s44, s41
    s_bitcmp1_b32 s15, 0
    s_cbranch_scc0 L_six_even
    s_mul_i32 s22, s20, 10752
    s_add_u32 s22, s22, 9216
    v_lshrrev_b32 v5, 2, v0
    v_lshlrev_b32 v5, 6, v5
    v_and_b32 v3, 3, v0
    v_xor_b32 v3, 3, v3
    v_lshl_add_u32 v5, v3, 4, v5
    v_add_u32 v5, s22, v5
    s_mul_i32 s44, s11, 21504
    s_xor_b32 s22, s13, 1
    s_mul_i32 s22, s22, 22020096
    s_add_u32 s44, s44, s22
    s_add_u32 s44, s44, 67108864
L_six_even:
    s_mov_b32 s50, -1
    s_mov_b32 s51, 0
    v_add_u32 v1, s42, v1
    s_add_u32 s43, s43, 16384
    s_waitcnt lgkmcnt(0)
    s_mov_b32 s16, s8
    s_and_b32 s17, s9, 0xffff
    s_mov_b32 s18, 268435456
    s_mov_b32 s19, 0x00020000
    s_add_u32 m0, s42, 0
    s_nop 0
    buffer_load_dwordx4 v1, s[16:19], s40 offen offset:0 lds
    buffer_load_dwordx4 v1, s[16:19], s40 offen offset:1024 lds
    buffer_load_dwordx4 v1, s[16:19], s40 offen offset:2048 lds
    buffer_load_dwordx4 v1, s[16:19], s40 offen offset:3072 lds
    s_add_u32 s40, s40, 524288
    s_add_u32 m0, s43, 0
    s_nop 0
    buffer_load_dwordx4 v2, s[16:19], s41 offen offset:0 lds
    buffer_load_dwordx4 v2, s[16:19], s41 offen offset:1024 lds
    buffer_load_dwordx4 v2, s[16:19], s41 offen offset:2048 lds
    buffer_load_dwordx4 v2, s[16:19], s41 offen offset:3072 lds
    s_add_u32 m0, s43, 4096
    s_add_u32 s49, s41, 4096
    buffer_load_dwordx4 v2, s[16:19], s49 offen lds
    s_mov_b64 exec, s[50:51]
    buffer_load_dwordx4 v5, s[16:19], s44 offen offset:1024 lds
    s_mov_b64 exec, -1
    s_add_u32 s41, s41, 688128
    s_add_u32 s44, s44, 688128
    s_add_u32 m0, s42, 38912
    s_nop 0
    buffer_load_dwordx4 v1, s[16:19], s40 offen offset:0 lds
    buffer_load_dwordx4 v1, s[16:19], s40 offen offset:1024 lds
    buffer_load_dwordx4 v1, s[16:19], s40 offen offset:2048 lds
    buffer_load_dwordx4 v1, s[16:19], s40 offen offset:3072 lds
    s_add_u32 s40, s40, 524288
    s_add_u32 m0, s43, 38912
    s_nop 0
    buffer_load_dwordx4 v2, s[16:19], s41 offen offset:0 lds
    buffer_load_dwordx4 v2, s[16:19], s41 offen offset:1024 lds
    buffer_load_dwordx4 v2, s[16:19], s41 offen offset:2048 lds
    buffer_load_dwordx4 v2, s[16:19], s41 offen offset:3072 lds
    s_add_u32 m0, s43, 43008
    s_add_u32 s49, s41, 4096
    buffer_load_dwordx4 v2, s[16:19], s49 offen lds
    s_mov_b64 exec, s[50:51]
    buffer_load_dwordx4 v5, s[16:19], s44 offen offset:1024 lds
    s_mov_b64 exec, -1
    s_add_u32 s41, s41, 688128
    s_add_u32 s44, s44, 688128
    s_add_u32 m0, s42, 77824
    s_nop 0
    buffer_load_dwordx4 v1, s[16:19], s40 offen offset:0 lds
    buffer_load_dwordx4 v1, s[16:19], s40 offen offset:1024 lds
    buffer_load_dwordx4 v1, s[16:19], s40 offen offset:2048 lds
    buffer_load_dwordx4 v1, s[16:19], s40 offen offset:3072 lds
    s_add_u32 s40, s40, 524288
    s_add_u32 m0, s43, 77824
    s_nop 0
    buffer_load_dwordx4 v2, s[16:19], s41 offen offset:0 lds
    buffer_load_dwordx4 v2, s[16:19], s41 offen offset:1024 lds
    buffer_load_dwordx4 v2, s[16:19], s41 offen offset:2048 lds
    buffer_load_dwordx4 v2, s[16:19], s41 offen offset:3072 lds
    s_add_u32 m0, s43, 81920
    s_add_u32 s49, s41, 4096
    buffer_load_dwordx4 v2, s[16:19], s49 offen lds
    s_mov_b64 exec, s[50:51]
    buffer_load_dwordx4 v5, s[16:19], s44 offen offset:1024 lds
    s_mov_b64 exec, -1
    s_add_u32 s41, s41, 688128
    s_add_u32 s44, s44, 688128
    s_waitcnt vmcnt(20)
    s_barrier
    s_mov_b32 s46, 7
L_h_loop:
    s_waitcnt vmcnt(10)
    s_barrier
    s_add_u32 m0, s42, 116736
    s_nop 0
    buffer_load_dwordx4 v1, s[16:19], s40 offen offset:0 lds
    buffer_load_dwordx4 v1, s[16:19], s40 offen offset:1024 lds
    buffer_load_dwordx4 v1, s[16:19], s40 offen offset:2048 lds
    buffer_load_dwordx4 v1, s[16:19], s40 offen offset:3072 lds
    s_add_u32 s40, s40, 524288
    s_add_u32 m0, s43, 116736
    s_nop 0
    buffer_load_dwordx4 v2, s[16:19], s41 offen offset:0 lds
    buffer_load_dwordx4 v2, s[16:19], s41 offen offset:1024 lds
    buffer_load_dwordx4 v2, s[16:19], s41 offen offset:2048 lds
    buffer_load_dwordx4 v2, s[16:19], s41 offen offset:3072 lds
    s_add_u32 m0, s43, 120832
    s_add_u32 s49, s41, 4096
    buffer_load_dwordx4 v2, s[16:19], s49 offen lds
    s_mov_b64 exec, s[50:51]
    buffer_load_dwordx4 v5, s[16:19], s44 offen offset:1024 lds
    s_mov_b64 exec, -1
    s_add_u32 s41, s41, 688128
    s_add_u32 s44, s44, 688128
    s_waitcnt vmcnt(10)
    s_barrier
    s_add_u32 m0, s42, 0
    s_nop 0
    buffer_load_dwordx4 v1, s[16:19], s40 offen offset:0 lds
    buffer_load_dwordx4 v1, s[16:19], s40 offen offset:1024 lds
    buffer_load_dwordx4 v1, s[16:19], s40 offen offset:2048 lds
    buffer_load_dwordx4 v1, s[16:19], s40 offen offset:3072 lds
    s_add_u32 s40, s40, 524288
    s_add_u32 m0, s43, 0
    s_nop 0
    buffer_load_dwordx4 v2, s[16:19], s41 offen offset:0 lds
    buffer_load_dwordx4 v2, s[16:19], s41 offen offset:1024 lds
    buffer_load_dwordx4 v2, s[16:19], s41 offen offset:2048 lds
    buffer_load_dwordx4 v2, s[16:19], s41 offen offset:3072 lds
    s_add_u32 m0, s43, 4096
    s_add_u32 s49, s41, 4096
    buffer_load_dwordx4 v2, s[16:19], s49 offen lds
    s_mov_b64 exec, s[50:51]
    buffer_load_dwordx4 v5, s[16:19], s44 offen offset:1024 lds
    s_mov_b64 exec, -1
    s_add_u32 s41, s41, 688128
    s_add_u32 s44, s44, 688128
    s_waitcnt vmcnt(10)
    s_barrier
    s_add_u32 m0, s42, 38912
    s_nop 0
    buffer_load_dwordx4 v1, s[16:19], s40 offen offset:0 lds
    buffer_load_dwordx4 v1, s[16:19], s40 offen offset:1024 lds
    buffer_load_dwordx4 v1, s[16:19], s40 offen offset:2048 lds
    buffer_load_dwordx4 v1, s[16:19], s40 offen offset:3072 lds
    s_add_u32 s40, s40, 524288
    s_add_u32 m0, s43, 38912
    s_nop 0
    buffer_load_dwordx4 v2, s[16:19], s41 offen offset:0 lds
    buffer_load_dwordx4 v2, s[16:19], s41 offen offset:1024 lds
    buffer_load_dwordx4 v2, s[16:19], s41 offen offset:2048 lds
    buffer_load_dwordx4 v2, s[16:19], s41 offen offset:3072 lds
    s_add_u32 m0, s43, 43008
    s_add_u32 s49, s41, 4096
    buffer_load_dwordx4 v2, s[16:19], s49 offen lds
    s_mov_b64 exec, s[50:51]
    buffer_load_dwordx4 v5, s[16:19], s44 offen offset:1024 lds
    s_mov_b64 exec, -1
    s_add_u32 s41, s41, 688128
    s_add_u32 s44, s44, 688128
    s_waitcnt vmcnt(10)
    s_barrier
    s_add_u32 m0, s42, 77824
    s_nop 0
    buffer_load_dwordx4 v1, s[16:19], s40 offen offset:0 lds
    buffer_load_dwordx4 v1, s[16:19], s40 offen offset:1024 lds
    buffer_load_dwordx4 v1, s[16:19], s40 offen offset:2048 lds
    buffer_load_dwordx4 v1, s[16:19], s40 offen offset:3072 lds
    s_add_u32 s40, s40, 524288
    s_add_u32 m0, s43, 77824
    s_nop 0
    buffer_load_dwordx4 v2, s[16:19], s41 offen offset:0 lds
    buffer_load_dwordx4 v2, s[16:19], s41 offen offset:1024 lds
    buffer_load_dwordx4 v2, s[16:19], s41 offen offset:2048 lds
    buffer_load_dwordx4 v2, s[16:19], s41 offen offset:3072 lds
    s_add_u32 m0, s43, 81920
    s_add_u32 s49, s41, 4096
    buffer_load_dwordx4 v2, s[16:19], s49 offen lds
    s_mov_b64 exec, s[50:51]
    buffer_load_dwordx4 v5, s[16:19], s44 offen offset:1024 lds
    s_mov_b64 exec, -1
    s_add_u32 s41, s41, 688128
    s_add_u32 s44, s44, 688128
    s_sub_u32 s46, s46, 1
    s_cmp_lg_u32 s46, 0
    s_cbranch_scc1 L_h_loop
    s_waitcnt vmcnt(10)
    s_barrier
    s_add_u32 m0, s42, 116736
    s_nop 0
    buffer_load_dwordx4 v1, s[16:19], s40 offen offset:0 lds
    buffer_load_dwordx4 v1, s[16:19], s40 offen offset:1024 lds
    buffer_load_dwordx4 v1, s[16:19], s40 offen offset:2048 lds
    buffer_load_dwordx4 v1, s[16:19], s40 offen offset:3072 lds
    s_add_u32 s40, s40, 524288
    s_add_u32 m0, s43, 116736
    s_nop 0
    buffer_load_dwordx4 v2, s[16:19], s41 offen offset:0 lds
    buffer_load_dwordx4 v2, s[16:19], s41 offen offset:1024 lds
    buffer_load_dwordx4 v2, s[16:19], s41 offen offset:2048 lds
    buffer_load_dwordx4 v2, s[16:19], s41 offen offset:3072 lds
    s_add_u32 m0, s43, 120832
    s_add_u32 s49, s41, 4096
    buffer_load_dwordx4 v2, s[16:19], s49 offen lds
    s_mov_b64 exec, s[50:51]
    buffer_load_dwordx4 v5, s[16:19], s44 offen offset:1024 lds
    s_mov_b64 exec, -1
    s_add_u32 s41, s41, 688128
    s_add_u32 s44, s44, 688128
    s_waitcnt vmcnt(10)
    s_barrier
    s_waitcnt vmcnt(0)
    s_barrier
    s_cmp_ge_u32 s2, 224
    s_cbranch_scc1 L_nofill
    s_cmp_lg_u32 s15, 1
    s_cbranch_scc1 L_nofill
    s_lshl_b32 s20, s2, 10
    s_add_u32 s20, s20, 146800640
    v_mov_b32 v8, -1
    v_mov_b32 v9, -1
    v_mov_b32 v10, -1
    v_mov_b32 v11, -1
    v_lshlrev_b32 v4, 4, v0
    buffer_store_dwordx4 v[8:11], v4, s[16:19], s20 offen
L_nofill:
    s_endpgm
L_k3_end:
    s_endpgm
.globl final_kernel
.p2align 8
.type final_kernel,@function
final_kernel:
    s_cmp_ge_u32 s2, 224
    s_cbranch_scc1 L_k45_end
    s_load_dwordx2 s[8:9], s[0:1], 48
    s_load_dwordx4 s[4:7], s[0:1], 16
    s_load_dwordx2 s[28:29], s[0:1], 32
    v_lshrrev_b32 v204, 6, v0
    v_and_b32 v200, 63, v0
    v_readfirstlane_b32 s10, v204
    s_cmp_ge_u32 s2, 8
    s_cbranch_scc1 L_nopf45
    s_nop 1
    s_cmp_lg_u32 s10, 7
    s_cbranch_scc1 L_nopf45
    s_getpc_b64 s[60:61]
L_pf_k45:
    s_sub_u32 s60, s60, L_pf_k45-final_kernel
    s_subb_u32 s61, s61, 0
    v_mbcnt_lo_u32_b32 v112, -1, 0
    v_mbcnt_hi_u32_b32 v112, -1, v112
    v_lshlrev_b32 v112, 6, v112
    v_add_u32 v113, 0, v112
    v_min_u32 v113, L_code_end-final_kernel-4, v113
    v_mov_b32 v115, s61
    v_add_co_u32 v114, vcc, s60, v113
    s_nop 1
    v_addc_co_u32 v115, vcc, 0, v115, vcc
    global_load_dword v116, v[114:115], off
    v_add_u32 v113, 4096, v112
    v_min_u32 v113, L_code_end-final_kernel-4, v113
    v_mov_b32 v115, s61
    v_add_co_u32 v114, vcc, s60, v113
    s_nop 1
    v_addc_co_u32 v115, vcc, 0, v115, vcc
    global_load_dword v116, v[114:115], off
    v_add_u32 v113, 8192, v112
    v_min_u32 v113, L_code_end-final_kernel-4, v113
    v_mov_b32 v115, s61
    v_add_co_u32 v114, vcc, s60, v113
    s_nop 1
    v_addc_co_u32 v115, vcc, 0, v115, vcc
    global_load_dword v116, v[114:115], off
L_nopf45:
    v_lshlrev_b32 v214, 2, v0
    v_and_b32 v201, 15, v200
    v_lshrrev_b32 v202, 4, v200
    s_and_b32 s13, s2, 3
    s_lshr_b32 s12, s2, 2
    s_cmp_ge_u32 s12, 28
    s_cselect_b32 s11, 1, 0
    s_mul_i32 s15, s11, 28
    s_sub_u32 s12, s12, s15
    s_mul_i32 s14, s12, 6
    s_add_u32 s14, s14, s10
    s_mov_b32 s24, 90112
    v_mul_u32_u24 v203, s24, v202
    v_lshrrev_b32 v205, 2, v201
    s_mov_b32 s24, 720896
    v_mad_u32_u24 v203, v205, s24, v203
    v_and_b32 v205, 3, v201
    v_lshl_add_u32 v203, v205, 4, v203
    s_mul_i32 s24, s11, 11534336
    s_mul_i32 s25, s13, 2883584
    s_add_u32 s24, s24, s25
    s_lshl_b32 s25, s14, 6
    s_add_u32 s24, s24, s25
    s_add_u32 s24, s24, 117440512
    s_mov_b32 s30, 0x05040100
    s_mov_b32 s31, 0x07060302
    s_waitcnt lgkmcnt(0)
    s_mov_b32 s16, s8
    s_and_b32 s17, s9, 0xffff
    s_mov_b32 s18, 268435456
    s_mov_b32 s19, 0x00020000
    s_cmp_ge_u32 s10, 6
    s_cbranch_scc1 L_k45_gb
    s_add_u32 s25, s24, 0
    buffer_load_dwordx4 v[0:3], v203, s[16:19], s25 offen
    s_add_u32 s25, s24, 11264
    buffer_load_dwordx4 v[4:7], v203, s[16:19], s25 offen
    s_add_u32 s25, s24, 22528
    buffer_load_dwordx4 v[8:11], v203, s[16:19], s25 offen
    s_add_u32 s25, s24, 33792
    buffer_load_dwordx4 v[12:15], v203, s[16:19], s25 offen
    s_add_u32 s25, s24, 45056
    buffer_load_dwordx4 v[16:19], v203, s[16:19], s25 offen
    s_add_u32 s25, s24, 56320
    buffer_load_dwordx4 v[20:23], v203, s[16:19], s25 offen
    s_add_u32 s25, s24, 67584
    buffer_load_dwordx4 v[24:27], v203, s[16:19], s25 offen
    s_add_u32 s25, s24, 78848
    buffer_load_dwordx4 v[28:31], v203, s[16:19], s25 offen
    s_add_u32 s25, s24, 360448
    buffer_load_dwordx4 v[32:35], v203, s[16:19], s25 offen
    s_add_u32 s25, s24, 371712
    buffer_load_dwordx4 v[36:39], v203, s[16:19], s25 offen
    s_add_u32 s25, s24, 382976
    buffer_load_dwordx4 v[40:43], v203, s[16:19], s25 offen
    s_add_u32 s25, s24, 394240
    buffer_load_dwordx4 v[44:47], v203, s[16:19], s25 offen
    s_add_u32 s25, s24, 405504
    buffer_load_dwordx4 v[48:51], v203, s[16:19], s25 offen
    s_add_u32 s25, s24, 416768
    buffer_load_dwordx4 v[52:55], v203, s[16:19], s25 offen
    s_add_u32 s25, s24, 428032
    buffer_load_dwordx4 v[56:59], v203, s[16:19], s25 offen
    s_add_u32 s25, s24, 439296
    buffer_load_dwordx4 v[60:63], v203, s[16:19], s25 offen
    s_lshr_b32 s27, s10, 1
    s_and_b32 s33, s10, 1
    s_lshl_b32 s27, s27, 4
    v_add_u32 v204, s27, v201
    s_lshl_b32 s33, s33, 5
    s_add_u32 s33, s33, 1
    v_lshlrev_b32 v205, 3, v202
    v_add_u32 v205, s33, v205
    v_mul_u32_u24 v88, v205, v204
    v_add_u32 v89, 32, v88
    v_add_u32 v205, 2, v205
    v_mul_u32_u24 v90, v205, v204
    v_add_u32 v91, 32, v90
    v_add_u32 v205, 2, v205
    v_mul_u32_u24 v92, v205, v204
    v_add_u32 v93, 32, v92
    v_add_u32 v205, 2, v205
    v_mul_u32_u24 v94, v205, v204
    v_add_u32 v95, 32, v94
    v_and_b32 v88, 127, v88
    v_cvt_f32_u32 v88, v88
    v_mul_f32 v88, 0x3c000000, v88
    v_cos_f32 v88, v88
    v_and_b32 v89, 127, v89
    v_cvt_f32_u32 v89, v89
    v_mul_f32 v89, 0x3c000000, v89
    v_cos_f32 v89, v89
    v_and_b32 v90, 127, v90
    v_cvt_f32_u32 v90, v90
    v_mul_f32 v90, 0x3c000000, v90
    v_cos_f32 v90, v90
    v_and_b32 v91, 127, v91
    v_cvt_f32_u32 v91, v91
    v_mul_f32 v91, 0x3c000000, v91
    v_cos_f32 v91, v91
    v_and_b32 v92, 127, v92
    v_cvt_f32_u32 v92, v92
    v_mul_f32 v92, 0x3c000000, v92
    v_cos_f32 v92, v92
    v_and_b32 v93, 127, v93
    v_cvt_f32_u32 v93, v93
    v_mul_f32 v93, 0x3c000000, v93
    v_cos_f32 v93, v93
    v_and_b32 v94, 127, v94
    v_cvt_f32_u32 v94, v94
    v_mul_f32 v94, 0x3c000000, v94
    v_cos_f32 v94, v94
    v_and_b32 v95, 127, v95
    v_cvt_f32_u32 v95, v95
    v_mul_f32 v95, 0x3c000000, v95
    v_cos_f32 v95, v95
    v_mul_f32 v88, 0x3d000000, v88
    v_mul_f32 v89, 0x3d000000, v89
    v_mul_f32 v90, 0x3d000000, v90
    v_mul_f32 v91, 0x3d000000, v91
    v_mul_f32 v92, 0x3d000000, v92
    v_mul_f32 v93, 0x3d000000, v93
    v_mul_f32 v94, 0x3d000000, v94
    v_mul_f32 v95, 0x3d000000, v95
    v_cvt_pk_bf16_f32 v104, v88, v89
    v_cvt_pk_bf16_f32 v105, v90, v91
    v_cvt_pk_bf16_f32 v106, v92, v93
    v_cvt_pk_bf16_f32 v107, v94, v95
    s_lshl_b32 s26, s10, 10
    v_lshlrev_b32 v207, 4, v200
    v_add_u32 v207, s26, v207
    ds_write_b128 v207, v[104:107] offset:0
L_k45_gb:
    s_mov_b32 s20, s4
    s_and_b32 s21, s5, 0xffff
    s_mov_b32 s22, 1024
    s_mov_b32 s23, 0x00020000
    s_mov_b32 s36, s6
    s_and_b32 s37, s7, 0xffff
    s_mov_b32 s38, 1024
    s_mov_b32 s39, 0x00020000
    v_lshlrev_b32 v210, 4, v201
    s_lshl_b32 s25, s13, 8
    buffer_load_dwordx4 v[232:235], v210, s[20:23], s25 offen
    buffer_load_dwordx4 v[236:239], v210, s[36:39], s25 offen
    s_waitcnt lgkmcnt(0)
    s_barrier
    s_cmp_ge_u32 s10, 6
    s_cbranch_scc1 L_k45_red2
    v_lshlrev_b32 v207, 4, v200
    ds_read_b128 v[64:67], v207 offset:0
    ds_read_b128 v[68:71], v207 offset:1024
    ds_read_b128 v[72:75], v207 offset:2048
    ds_read_b128 v[76:79], v207 offset:3072
    ds_read_b128 v[80:83], v207 offset:4096
    ds_read_b128 v[84:87], v207 offset:5120
    s_cmp_ge_u32 s14, 167
    s_cbranch_scc1 L_k45_zero
    s_waitcnt lgkmcnt(0)
    s_cmp_lg_u32 s14, 166
    s_cbranch_scc1 L_k45_full
    v_cmp_gt_i32 vcc, 17, v201
    s_nop 1
    v_cndmask_b32 v64, 0, v64, vcc
    v_cndmask_b32 v65, 0, v65, vcc
    v_cndmask_b32 v66, 0, v66, vcc
    v_cndmask_b32 v67, 0, v67, vcc
    v_cndmask_b32 v68, 0, v68, vcc
    v_cndmask_b32 v69, 0, v69, vcc
    v_cndmask_b32 v70, 0, v70, vcc
    v_cndmask_b32 v71, 0, v71, vcc
    v_cmp_gt_i32 vcc, 1, v201
    s_nop 1
    v_cndmask_b32 v72, 0, v72, vcc
    v_cndmask_b32 v73, 0, v73, vcc
    v_cndmask_b32 v74, 0, v74, vcc
    v_cndmask_b32 v75, 0, v75, vcc
    v_cndmask_b32 v76, 0, v76, vcc
    v_cndmask_b32 v77, 0, v77, vcc
    v_cndmask_b32 v78, 0, v78, vcc
    v_cndmask_b32 v79, 0, v79, vcc
    v_cmp_gt_i32 vcc, 0, v201
    s_nop 1
    v_cndmask_b32 v80, 0, v80, vcc
    v_cndmask_b32 v81, 0, v81, vcc
    v_cndmask_b32 v82, 0, v82, vcc
    v_cndmask_b32 v83, 0, v83, vcc
    v_cndmask_b32 v84, 0, v84, vcc
    v_cndmask_b32 v85, 0, v85, vcc
    v_cndmask_b32 v86, 0, v86, vcc
    v_cndmask_b32 v87, 0, v87, vcc
L_k45_full:
    s_waitcnt vmcnt(2)
    v_perm_b32 v88, v4, v0, s30
    v_perm_b32 v89, v12, v8, s30
    v_perm_b32 v90, v20, v16, s30
    v_perm_b32 v91, v28, v24, s30
    v_perm_b32 v92, v4, v0, s31
    v_perm_b32 v93, v12, v8, s31
    v_perm_b32 v94, v20, v16, s31
    v_perm_b32 v95, v28, v24, s31
    v_perm_b32 v96, v36, v32, s30
    v_perm_b32 v97, v44, v40, s30
    v_perm_b32 v98, v52, v48, s30
    v_perm_b32 v99, v60, v56, s30
    v_perm_b32 v100, v36, v32, s31
    v_perm_b32 v101, v44, v40, s31
    v_perm_b32 v102, v52, v48, s31
    v_perm_b32 v103, v60, v56, s31
    v_mfma_f32_16x16x32_bf16 v[104:107], v[64:67], v[88:91], 0
    v_mfma_f32_16x16x32_bf16 v[108:111], v[64:67], v[92:95], 0
    v_mfma_f32_16x16x32_bf16 v[136:139], v[72:75], v[88:91], 0
    v_mfma_f32_16x16x32_bf16 v[140:143], v[72:75], v[92:95], 0
    v_mfma_f32_16x16x32_bf16 v[168:171], v[80:83], v[88:91], 0
    v_mfma_f32_16x16x32_bf16 v[172:175], v[80:83], v[92:95], 0
    v_mfma_f32_16x16x32_bf16 v[104:107], v[68:71], v[96:99], v[104:107]
    v_mfma_f32_16x16x32_bf16 v[108:111], v[68:71], v[100:103], v[108:111]
    v_mfma_f32_16x16x32_bf16 v[136:139], v[76:79], v[96:99], v[136:139]
    v_mfma_f32_16x16x32_bf16 v[140:143], v[76:79], v[100:103], v[140:143]
    v_mfma_f32_16x16x32_bf16 v[168:171], v[84:87], v[96:99], v[168:171]
    v_mfma_f32_16x16x32_bf16 v[172:175], v[84:87], v[100:103], v[172:175]
    v_perm_b32 v88, v5, v1, s30
    v_perm_b32 v89, v13, v9, s30
    v_perm_b32 v90, v21, v17, s30
    v_perm_b32 v91, v29, v25, s30
    v_perm_b32 v92, v5, v1, s31
    v_perm_b32 v93, v13, v9, s31
    v_perm_b32 v94, v21, v17, s31
    v_perm_b32 v95, v29, v25, s31
    v_perm_b32 v96, v37, v33, s30
    v_perm_b32 v97, v45, v41, s30
    v_perm_b32 v98, v53, v49, s30
    v_perm_b32 v99, v61, v57, s30
    v_perm_b32 v100, v37, v33, s31
    v_perm_b32 v101, v45, v41, s31
    v_perm_b32 v102, v53, v49, s31
    v_perm_b32 v103, v61, v57, s31
    v_mfma_f32_16x16x32_bf16 v[112:115], v[64:67], v[88:91], 0
    v_mfma_f32_16x16x32_bf16 v[116:119], v[64:67], v[92:95], 0
    v_mfma_f32_16x16x32_bf16 v[144:147], v[72:75], v[88:91], 0
    v_mfma_f32_16x16x32_bf16 v[148:151], v[72:75], v[92:95], 0
    v_mfma_f32_16x16x32_bf16 v[176:179], v[80:83], v[88:91], 0
    v_mfma_f32_16x16x32_bf16 v[180:183], v[80:83], v[92:95], 0
    v_mfma_f32_16x16x32_bf16 v[112:115], v[68:71], v[96:99], v[112:115]
    v_mfma_f32_16x16x32_bf16 v[116:119], v[68:71], v[100:103], v[116:119]
    v_mfma_f32_16x16x32_bf16 v[144:147], v[76:79], v[96:99], v[144:147]
    v_mfma_f32_16x16x32_bf16 v[148:151], v[76:79], v[100:103], v[148:151]
    v_mfma_f32_16x16x32_bf16 v[176:179], v[84:87], v[96:99], v[176:179]
    v_mfma_f32_16x16x32_bf16 v[180:183], v[84:87], v[100:103], v[180:183]
    v_perm_b32 v88, v6, v2, s30
    v_perm_b32 v89, v14, v10, s30
    v_perm_b32 v90, v22, v18, s30
    v_perm_b32 v91, v30, v26, s30
    v_perm_b32 v92, v6, v2, s31
    v_perm_b32 v93, v14, v10, s31
    v_perm_b32 v94, v22, v18, s31
    v_perm_b32 v95, v30, v26, s31
    v_perm_b32 v96, v38, v34, s30
    v_perm_b32 v97, v46, v42, s30
    v_perm_b32 v98, v54, v50, s30
    v_perm_b32 v99, v62, v58, s30
    v_perm_b32 v100, v38, v34, s31
    v_perm_b32 v101, v46, v42, s31
    v_perm_b32 v102, v54, v50, s31
    v_perm_b32 v103, v62, v58, s31
    v_mfma_f32_16x16x32_bf16 v[120:123], v[64:67], v[88:91], 0
    v_mfma_f32_16x16x32_bf16 v[124:127], v[64:67], v[92:95], 0
    v_mfma_f32_16x16x32_bf16 v[152:155], v[72:75], v[88:91], 0
    v_mfma_f32_16x16x32_bf16 v[156:159], v[72:75], v[92:95], 0
    v_mfma_f32_16x16x32_bf16 v[184:187], v[80:83], v[88:91], 0
    v_mfma_f32_16x16x32_bf16 v[188:191], v[80:83], v[92:95], 0
    v_mfma_f32_16x16x32_bf16 v[120:123], v[68:71], v[96:99], v[120:123]
    v_mfma_f32_16x16x32_bf16 v[124:127], v[68:71], v[100:103], v[124:127]
    v_mfma_f32_16x16x32_bf16 v[152:155], v[76:79], v[96:99], v[152:155]
    v_mfma_f32_16x16x32_bf16 v[156:159], v[76:79], v[100:103], v[156:159]
    v_mfma_f32_16x16x32_bf16 v[184:187], v[84:87], v[96:99], v[184:187]
    v_mfma_f32_16x16x32_bf16 v[188:191], v[84:87], v[100:103], v[188:191]
    v_perm_b32 v88, v7, v3, s30
    v_perm_b32 v89, v15, v11, s30
    v_perm_b32 v90, v23, v19, s30
    v_perm_b32 v91, v31, v27, s30
    v_perm_b32 v92, v7, v3, s31
    v_perm_b32 v93, v15, v11, s31
    v_perm_b32 v94, v23, v19, s31
    v_perm_b32 v95, v31, v27, s31
    v_perm_b32 v96, v39, v35, s30
    v_perm_b32 v97, v47, v43, s30
    v_perm_b32 v98, v55, v51, s30
    v_perm_b32 v99, v63, v59, s30
    v_perm_b32 v100, v39, v35, s31
    v_perm_b32 v101, v47, v43, s31
    v_perm_b32 v102, v55, v51, s31
    v_perm_b32 v103, v63, v59, s31
    v_mfma_f32_16x16x32_bf16 v[128:131], v[64:67], v[88:91], 0
    v_mfma_f32_16x16x32_bf16 v[132:135], v[64:67], v[92:95], 0
    v_mfma_f32_16x16x32_bf16 v[160:163], v[72:75], v[88:91], 0
    v_mfma_f32_16x16x32_bf16 v[164:167], v[72:75], v[92:95], 0
    v_mfma_f32_16x16x32_bf16 v[192:195], v[80:83], v[88:91], 0
    v_mfma_f32_16x16x32_bf16 v[196:199], v[80:83], v[92:95], 0
    v_mfma_f32_16x16x32_bf16 v[128:131], v[68:71], v[96:99], v[128:131]
    v_mfma_f32_16x16x32_bf16 v[132:135], v[68:71], v[100:103], v[132:135]
    v_mfma_f32_16x16x32_bf16 v[160:163], v[76:79], v[96:99], v[160:163]
    v_mfma_f32_16x16x32_bf16 v[164:167], v[76:79], v[100:103], v[164:167]
    v_mfma_f32_16x16x32_bf16 v[192:195], v[84:87], v[96:99], v[192:195]
    v_mfma_f32_16x16x32_bf16 v[196:199], v[84:87], v[100:103], v[196:199]
    s_nop 7
    v_mul_f32 v224, v104, v104
    v_mov_b32 v216, v104
    v_fmac_f32 v224, v105, v105
    v_add_f32 v216, v216, v105
    v_fmac_f32 v224, v106, v106
    v_add_f32 v216, v216, v106
    v_fmac_f32 v224, v107, v107
    v_add_f32 v216, v216, v107
    v_fmac_f32 v224, v136, v136
    v_add_f32 v216, v216, v136
    v_fmac_f32 v224, v137, v137
    v_add_f32 v216, v216, v137
    v_fmac_f32 v224, v138, v138
    v_add_f32 v216, v216, v138
    v_fmac_f32 v224, v139, v139
    v_add_f32 v216, v216, v139
    v_fmac_f32 v224, v168, v168
    v_add_f32 v216, v216, v168
    v_fmac_f32 v224, v169, v169
    v_add_f32 v216, v216, v169
    v_fmac_f32 v224, v170, v170
    v_add_f32 v216, v216, v170
    v_fmac_f32 v224, v171, v171
    v_add_f32 v216, v216, v171
    v_mul_f32 v225, v108, v108
    v_mov_b32 v217, v108
    v_fmac_f32 v225, v109, v109
    v_add_f32 v217, v217, v109
    v_fmac_f32 v225, v110, v110
    v_add_f32 v217, v217, v110
    v_fmac_f32 v225, v111, v111
    v_add_f32 v217, v217, v111
    v_fmac_f32 v225, v140, v140
    v_add_f32 v217, v217, v140
    v_fmac_f32 v225, v141, v141
    v_add_f32 v217, v217, v141
    v_fmac_f32 v225, v142, v142
    v_add_f32 v217, v217, v142
    v_fmac_f32 v225, v143, v143
    v_add_f32 v217, v217, v143
    v_fmac_f32 v225, v172, v172
    v_add_f32 v217, v217, v172
    v_fmac_f32 v225, v173, v173
    v_add_f32 v217, v217, v173
    v_fmac_f32 v225, v174, v174
    v_add_f32 v217, v217, v174
    v_fmac_f32 v225, v175, v175
    v_add_f32 v217, v217, v175
    v_mul_f32 v226, v112, v112
    v_mov_b32 v218, v112
    v_fmac_f32 v226, v113, v113
    v_add_f32 v218, v218, v113
    v_fmac_f32 v226, v114, v114
    v_add_f32 v218, v218, v114
    v_fmac_f32 v226, v115, v115
    v_add_f32 v218, v218, v115
    v_fmac_f32 v226, v144, v144
    v_add_f32 v218, v218, v144
    v_fmac_f32 v226, v145, v145
    v_add_f32 v218, v218, v145
    v_fmac_f32 v226, v146, v146
    v_add_f32 v218, v218, v146
    v_fmac_f32 v226, v147, v147
    v_add_f32 v218, v218, v147
    v_fmac_f32 v226, v176, v176
    v_add_f32 v218, v218, v176
    v_fmac_f32 v226, v177, v177
    v_add_f32 v218, v218, v177
    v_fmac_f32 v226, v178, v178
    v_add_f32 v218, v218, v178
    v_fmac_f32 v226, v179, v179
    v_add_f32 v218, v218, v179
    v_mul_f32 v227, v116, v116
    v_mov_b32 v219, v116
    v_fmac_f32 v227, v117, v117
    v_add_f32 v219, v219, v117
    v_fmac_f32 v227, v118, v118
    v_add_f32 v219, v219, v118
    v_fmac_f32 v227, v119, v119
    v_add_f32 v219, v219, v119
    v_fmac_f32 v227, v148, v148
    v_add_f32 v219, v219, v148
    v_fmac_f32 v227, v149, v149
    v_add_f32 v219, v219, v149
    v_fmac_f32 v227, v150, v150
    v_add_f32 v219, v219, v150
    v_fmac_f32 v227, v151, v151
    v_add_f32 v219, v219, v151
    v_fmac_f32 v227, v180, v180
    v_add_f32 v219, v219, v180
    v_fmac_f32 v227, v181, v181
    v_add_f32 v219, v219, v181
    v_fmac_f32 v227, v182, v182
    v_add_f32 v219, v219, v182
    v_fmac_f32 v227, v183, v183
    v_add_f32 v219, v219, v183
    v_mul_f32 v228, v120, v120
    v_mov_b32 v220, v120
    v_fmac_f32 v228, v121, v121
    v_add_f32 v220, v220, v121
    v_fmac_f32 v228, v122, v122
    v_add_f32 v220, v220, v122
    v_fmac_f32 v228, v123, v123
    v_add_f32 v220, v220, v123
    v_fmac_f32 v228, v152, v152
    v_add_f32 v220, v220, v152
    v_fmac_f32 v228, v153, v153
    v_add_f32 v220, v220, v153
    v_fmac_f32 v228, v154, v154
    v_add_f32 v220, v220, v154
    v_fmac_f32 v228, v155, v155
    v_add_f32 v220, v220, v155
    v_fmac_f32 v228, v184, v184
    v_add_f32 v220, v220, v184
    v_fmac_f32 v228, v185, v185
    v_add_f32 v220, v220, v185
    v_fmac_f32 v228, v186, v186
    v_add_f32 v220, v220, v186
    v_fmac_f32 v228, v187, v187
    v_add_f32 v220, v220, v187
    v_mul_f32 v229, v124, v124
    v_mov_b32 v221, v124
    v_fmac_f32 v229, v125, v125
    v_add_f32 v221, v221, v125
    v_fmac_f32 v229, v126, v126
    v_add_f32 v221, v221, v126
    v_fmac_f32 v229, v127, v127
    v_add_f32 v221, v221, v127
    v_fmac_f32 v229, v156, v156
    v_add_f32 v221, v221, v156
    v_fmac_f32 v229, v157, v157
    v_add_f32 v221, v221, v157
    v_fmac_f32 v229, v158, v158
    v_add_f32 v221, v221, v158
    v_fmac_f32 v229, v159, v159
    v_add_f32 v221, v221, v159
    v_fmac_f32 v229, v188, v188
    v_add_f32 v221, v221, v188
    v_fmac_f32 v229, v189, v189
    v_add_f32 v221, v221, v189
    v_fmac_f32 v229, v190, v190
    v_add_f32 v221, v221, v190
    v_fmac_f32 v229, v191, v191
    v_add_f32 v221, v221, v191
    v_mul_f32 v230, v128, v128
    v_mov_b32 v222, v128
    v_fmac_f32 v230, v129, v129
    v_add_f32 v222, v222, v129
    v_fmac_f32 v230, v130, v130
    v_add_f32 v222, v222, v130
    v_fmac_f32 v230, v131, v131
    v_add_f32 v222, v222, v131
    v_fmac_f32 v230, v160, v160
    v_add_f32 v222, v222, v160
    v_fmac_f32 v230, v161, v161
    v_add_f32 v222, v222, v161
    v_fmac_f32 v230, v162, v162
    v_add_f32 v222, v222, v162
    v_fmac_f32 v230, v163, v163
    v_add_f32 v222, v222, v163
    v_fmac_f32 v230, v192, v192
    v_add_f32 v222, v222, v192
    v_fmac_f32 v230, v193, v193
    v_add_f32 v222, v222, v193
    v_fmac_f32 v230, v194, v194
    v_add_f32 v222, v222, v194
    v_fmac_f32 v230, v195, v195
    v_add_f32 v222, v222, v195
    v_mul_f32 v231, v132, v132
    v_mov_b32 v223, v132
    v_fmac_f32 v231, v133, v133
    v_add_f32 v223, v223, v133
    v_fmac_f32 v231, v134, v134
    v_add_f32 v223, v223, v134
    v_fmac_f32 v231, v135, v135
    v_add_f32 v223, v223, v135
    v_fmac_f32 v231, v164, v164
    v_add_f32 v223, v223, v164
    v_fmac_f32 v231, v165, v165
    v_add_f32 v223, v223, v165
    v_fmac_f32 v231, v166, v166
    v_add_f32 v223, v223, v166
    v_fmac_f32 v231, v167, v167
    v_add_f32 v223, v223, v167
    v_fmac_f32 v231, v196, v196
    v_add_f32 v223, v223, v196
    v_fmac_f32 v231, v197, v197
    v_add_f32 v223, v223, v197
    v_fmac_f32 v231, v198, v198
    v_add_f32 v223, v223, v198
    v_fmac_f32 v231, v199, v199
    v_add_f32 v223, v223, v199
    s_branch L_k45_red
L_k45_zero:
    s_waitcnt vmcnt(0) lgkmcnt(0)
    v_mov_b32 v216, 0
    v_mov_b32 v224, 0
    v_mov_b32 v217, 0
    v_mov_b32 v225, 0
    v_mov_b32 v218, 0
    v_mov_b32 v226, 0
    v_mov_b32 v219, 0
    v_mov_b32 v227, 0
    v_mov_b32 v220, 0
    v_mov_b32 v228, 0
    v_mov_b32 v221, 0
    v_mov_b32 v229, 0
    v_mov_b32 v222, 0
    v_mov_b32 v230, 0
    v_mov_b32 v223, 0
    v_mov_b32 v231, 0
L_k45_red:
    s_lshl_b32 s25, s10, 12
    v_lshlrev_b32 v204, 10, v202
    v_lshl_add_u32 v204, v201, 5, v204
    v_add_u32 v204, s25, v204
    ds_write_b128 v204, v[216:219] offset:8192
    ds_write_b128 v204, v[220:223] offset:8208
    ds_write_b128 v204, v[224:227] offset:8704
    ds_write_b128 v204, v[228:231] offset:8720
L_k45_red2:
    s_waitcnt lgkmcnt(0)
    s_barrier
    s_mul_i32 s24, s11, 112
    s_mul_i32 s25, s13, 28
    s_add_u32 s24, s24, s25
    s_lshl_b32 s26, s24, 10
    s_add_u32 s26, s26, 146800640
    s_cmp_ge_u32 s10, 6
    s_cbranch_scc1 L_k45_sumdone
    s_cmp_lt_u32 s10, 4
    s_cbranch_scc1 L_k45_red4
    s_lshl_b32 s25, s10, 13
    v_lshlrev_b32 v205, 4, v200
    v_add_u32 v205, s25, v205
    ds_write_b32 v205, v107 offset:33792
    ds_write_b32 v205, v139 offset:33796
    ds_write_b32 v205, v171 offset:33800
    ds_write_b32 v205, v111 offset:34816
    ds_write_b32 v205, v143 offset:34820
    ds_write_b32 v205, v175 offset:34824
    ds_write_b32 v205, v115 offset:35840
    ds_write_b32 v205, v147 offset:35844
    ds_write_b32 v205, v179 offset:35848
    ds_write_b32 v205, v119 offset:36864
    ds_write_b32 v205, v151 offset:36868
    ds_write_b32 v205, v183 offset:36872
    ds_write_b32 v205, v123 offset:37888
    ds_write_b32 v205, v155 offset:37892
    ds_write_b32 v205, v187 offset:37896
    ds_write_b32 v205, v127 offset:38912
    ds_write_b32 v205, v159 offset:38916
    ds_write_b32 v205, v191 offset:38920
    ds_write_b32 v205, v131 offset:39936
    ds_write_b32 v205, v163 offset:39940
    ds_write_b32 v205, v195 offset:39944
    ds_write_b32 v205, v135 offset:40960
    ds_write_b32 v205, v167 offset:40964
    ds_write_b32 v205, v199 offset:40968
    s_branch L_k45_sumdone
L_k45_red4:
    ds_read_b32 v16, v214 offset:8192
    ds_read_b32 v17, v214 offset:9216
    ds_read_b32 v18, v214 offset:10240
    ds_read_b32 v19, v214 offset:11264
    ds_read_b32 v20, v214 offset:12288
    ds_read_b32 v21, v214 offset:13312
    ds_read_b32 v22, v214 offset:14336
    ds_read_b32 v23, v214 offset:15360
    ds_read_b32 v24, v214 offset:16384
    ds_read_b32 v25, v214 offset:17408
    ds_read_b32 v26, v214 offset:18432
    ds_read_b32 v27, v214 offset:19456
    ds_read_b32 v28, v214 offset:20480
    ds_read_b32 v29, v214 offset:21504
    ds_read_b32 v30, v214 offset:22528
    ds_read_b32 v31, v214 offset:23552
    ds_read_b32 v32, v214 offset:24576
    ds_read_b32 v33, v214 offset:25600
    ds_read_b32 v34, v214 offset:26624
    ds_read_b32 v35, v214 offset:27648
    ds_read_b32 v36, v214 offset:28672
    ds_read_b32 v37, v214 offset:29696
    ds_read_b32 v38, v214 offset:30720
    ds_read_b32 v39, v214 offset:31744
    s_waitcnt lgkmcnt(0)
    v_add_f32 v16, v16, v17
    v_add_f32 v18, v18, v19
    v_add_f32 v20, v20, v21
    v_add_f32 v22, v22, v23
    v_add_f32 v24, v24, v25
    v_add_f32 v26, v26, v27
    v_add_f32 v28, v28, v29
    v_add_f32 v30, v30, v31
    v_add_f32 v32, v32, v33
    v_add_f32 v34, v34, v35
    v_add_f32 v36, v36, v37
    v_add_f32 v38, v38, v39
    v_add_f32 v16, v16, v18
    v_add_f32 v20, v20, v22
    v_add_f32 v24, v24, v26
    v_add_f32 v28, v28, v30
    v_add_f32 v32, v32, v34
    v_add_f32 v36, v36, v38
    v_add_f32 v16, v16, v20
    v_add_f32 v24, v24, v28
    v_add_f32 v32, v32, v36
    v_add_f32 v16, v16, v24
    v_add_f32 v16, v16, v32
    s_lshl_b32 s24, s12, 10
    s_add_u32 s24, s24, s26
    buffer_store_dword v16, v214, s[16:19], s24 offen sc1
    s_lshl_b32 s25, s10, 13
    v_lshlrev_b32 v205, 4, v200
    v_add_u32 v205, s25, v205
    ds_write_b32 v205, v107 offset:33792
    ds_write_b32 v205, v139 offset:33796
    ds_write_b32 v205, v171 offset:33800
    ds_write_b32 v205, v111 offset:34816
    ds_write_b32 v205, v143 offset:34820
    ds_write_b32 v205, v175 offset:34824
    ds_write_b32 v205, v115 offset:35840
    ds_write_b32 v205, v147 offset:35844
    ds_write_b32 v205, v179 offset:35848
    ds_write_b32 v205, v119 offset:36864
    ds_write_b32 v205, v151 offset:36868
    ds_write_b32 v205, v183 offset:36872
    ds_write_b32 v205, v123 offset:37888
    ds_write_b32 v205, v155 offset:37892
    ds_write_b32 v205, v187 offset:37896
    ds_write_b32 v205, v127 offset:38912
    ds_write_b32 v205, v159 offset:38916
    ds_write_b32 v205, v191 offset:38920
    ds_write_b32 v205, v131 offset:39936
    ds_write_b32 v205, v163 offset:39940
    ds_write_b32 v205, v195 offset:39944
    ds_write_b32 v205, v135 offset:40960
    ds_write_b32 v205, v167 offset:40964
    ds_write_b32 v205, v199 offset:40968
    s_mov_b32 s33, 16384
L_k45_poll:
    s_mov_b32 s27, s26
    buffer_load_dword v0, v214, s[16:19], s27 offen offset:0 sc1
    buffer_load_dword v1, v214, s[16:19], s27 offen offset:1024 sc1
    buffer_load_dword v2, v214, s[16:19], s27 offen offset:2048 sc1
    buffer_load_dword v3, v214, s[16:19], s27 offen offset:3072 sc1
    s_add_u32 s27, s27, 4096
    buffer_load_dword v4, v214, s[16:19], s27 offen offset:0 sc1
    buffer_load_dword v5, v214, s[16:19], s27 offen offset:1024 sc1
    buffer_load_dword v6, v214, s[16:19], s27 offen offset:2048 sc1
    buffer_load_dword v7, v214, s[16:19], s27 offen offset:3072 sc1
    s_add_u32 s27, s27, 4096
    buffer_load_dword v8, v214, s[16:19], s27 offen offset:0 sc1
    buffer_load_dword v9, v214, s[16:19], s27 offen offset:1024 sc1
    buffer_load_dword v10, v214, s[16:19], s27 offen offset:2048 sc1
    buffer_load_dword v11, v214, s[16:19], s27 offen offset:3072 sc1
    s_add_u32 s27, s27, 4096
    buffer_load_dword v12, v214, s[16:19], s27 offen offset:0 sc1
    buffer_load_dword v13, v214, s[16:19], s27 offen offset:1024 sc1
    buffer_load_dword v14, v214, s[16:19], s27 offen offset:2048 sc1
    buffer_load_dword v15, v214, s[16:19], s27 offen offset:3072 sc1
    s_add_u32 s27, s27, 4096
    buffer_load_dword v16, v214, s[16:19], s27 offen offset:0 sc1
    buffer_load_dword v17, v214, s[16:19], s27 offen offset:1024 sc1
    buffer_load_dword v18, v214, s[16:19], s27 offen offset:2048 sc1
    buffer_load_dword v19, v214, s[16:19], s27 offen offset:3072 sc1
    s_add_u32 s27, s27, 4096
    buffer_load_dword v20, v214, s[16:19], s27 offen offset:0 sc1
    buffer_load_dword v21, v214, s[16:19], s27 offen offset:1024 sc1
    buffer_load_dword v22, v214, s[16:19], s27 offen offset:2048 sc1
    buffer_load_dword v23, v214, s[16:19], s27 offen offset:3072 sc1
    s_add_u32 s27, s27, 4096
    buffer_load_dword v24, v214, s[16:19], s27 offen offset:0 sc1
    buffer_load_dword v25, v214, s[16:19], s27 offen offset:1024 sc1
    buffer_load_dword v26, v214, s[16:19], s27 offen offset:2048 sc1
    buffer_load_dword v27, v214, s[16:19], s27 offen offset:3072 sc1
    s_waitcnt vmcnt(0)
    v_max3_u32 v32, v0, v1, v2
    v_max3_u32 v32, v32, v3, v4
    v_max3_u32 v32, v32, v5, v6
    v_max3_u32 v32, v32, v7, v8
    v_max3_u32 v32, v32, v9, v10
    v_max3_u32 v32, v32, v11, v12
    v_max3_u32 v32, v32, v13, v14
    v_max3_u32 v32, v32, v15, v16
    v_max3_u32 v32, v32, v17, v18
    v_max3_u32 v32, v32, v19, v20
    v_max3_u32 v32, v32, v21, v22
    v_max3_u32 v32, v32, v23, v24
    v_max3_u32 v32, v32, v25, v26
    v_max_u32 v32, v32, v27
    v_cmp_eq_u32 vcc, -1, v32
    s_nop 3
    s_cmp_eq_u64 vcc, 0
    s_cbranch_scc1 L_k45_got
    s_sub_u32 s33, s33, 1
    s_cmp_eq_u32 s33, 0
    s_cbranch_scc1 L_k45_got
    s_sleep 2
    s_branch L_k45_poll
L_k45_got:
    v_add_f32 v0, v0, v1
    v_add_f32 v2, v2, v3
    v_add_f32 v4, v4, v5
    v_add_f32 v6, v6, v7
    v_add_f32 v8, v8, v9
    v_add_f32 v10, v10, v11
    v_add_f32 v12, v12, v13
    v_add_f32 v14, v14, v15
    v_add_f32 v16, v16, v17
    v_add_f32 v18, v18, v19
    v_add_f32 v20, v20, v21
    v_add_f32 v22, v22, v23
    v_add_f32 v24, v24, v25
    v_add_f32 v26, v26, v27
    v_add_f32 v0, v0, v2
    v_add_f32 v4, v4, v6
    v_add_f32 v8, v8, v10
    v_add_f32 v12, v12, v14
    v_add_f32 v16, v16, v18
    v_add_f32 v20, v20, v22
    v_add_f32 v24, v24, v26
    v_add_f32 v0, v0, v4
    v_add_f32 v8, v8, v12
    v_add_f32 v16, v16, v20
    v_add_f32 v0, v0, v8
    v_add_f32 v16, v16, v24
    v_add_f32 v0, v0, v16
    ds_write_b32 v214, v0 offset:32768
L_k45_sumdone:
    s_waitcnt lgkmcnt(0)
    s_barrier
    s_cmp_lt_u32 s10, 6
    s_cbranch_scc1 L_k45_nohread
    s_waitcnt vmcnt(0)
    s_sub_u32 s25, s10, 6
    s_mul_i32 s25, s25, 3
    s_lshl_b32 s25, s25, 13
    v_lshlrev_b32 v205, 4, v200
    v_add_u32 v205, s25, v205
    ds_read_b96 v[104:106], v205 offset:33792
    ds_read_b96 v[108:110], v205 offset:34816
    ds_read_b96 v[112:114], v205 offset:35840
    ds_read_b96 v[116:118], v205 offset:36864
    ds_read_b96 v[120:122], v205 offset:37888
    ds_read_b96 v[124:126], v205 offset:38912
    ds_read_b96 v[128:130], v205 offset:39936
    ds_read_b96 v[132:134], v205 offset:40960
    s_waitcnt lgkmcnt(0)
    ds_read_b96 v[136:138], v205 offset:41984
    ds_read_b96 v[140:142], v205 offset:43008
    ds_read_b96 v[144:146], v205 offset:44032
    ds_read_b96 v[148:150], v205 offset:45056
    ds_read_b96 v[152:154], v205 offset:46080
    ds_read_b96 v[156:158], v205 offset:47104
    ds_read_b96 v[160:162], v205 offset:48128
    ds_read_b96 v[164:166], v205 offset:49152
    s_waitcnt lgkmcnt(0)
    ds_read_b96 v[168:170], v205 offset:50176
    ds_read_b96 v[172:174], v205 offset:51200
    ds_read_b96 v[176:178], v205 offset:52224
    ds_read_b96 v[180:182], v205 offset:53248
    ds_read_b96 v[184:186], v205 offset:54272
    ds_read_b96 v[188:190], v205 offset:55296
    ds_read_b96 v[192:194], v205 offset:56320
    ds_read_b96 v[196:198], v205 offset:57344
L_k45_nohread:
    v_lshlrev_b32 v210, 5, v201
    ds_read_b128 v[44:47], v210 offset:32768
    ds_read_b128 v[48:51], v210 offset:32784
    ds_read_b128 v[52:55], v210 offset:33280
    ds_read_b128 v[56:59], v210 offset:33296
    s_mov_b32 s24, 0x39035177
    s_mov_b32 s25, 0x3727c5ac
    s_waitcnt vmcnt(0) lgkmcnt(0)
    v_mul_f32 v44, s24, v44
    v_mul_f32 v52, s24, v52
    v_fma_f32 v52, -v44, v44, v52
    v_max_f32 v52, 0, v52
    v_add_f32 v52, s25, v52
    v_rsq_f32 v52, v52
    v_lshlrev_b32 v216, 16, v232
    v_lshlrev_b32 v224, 16, v236
    v_mul_f32 v216, v216, v52
    v_fma_f32 v224, -v44, v216, v224
    v_mul_f32 v45, s24, v45
    v_mul_f32 v53, s24, v53
    v_fma_f32 v53, -v45, v45, v53
    v_max_f32 v53, 0, v53
    v_add_f32 v53, s25, v53
    v_rsq_f32 v53, v53
    v_and_b32 v217, 0xffff0000, v232
    v_and_b32 v225, 0xffff0000, v236
    v_mul_f32 v217, v217, v53
    v_fma_f32 v225, -v45, v217, v225
    v_mul_f32 v46, s24, v46
    v_mul_f32 v54, s24, v54
    v_fma_f32 v54, -v46, v46, v54
    v_max_f32 v54, 0, v54
    v_add_f32 v54, s25, v54
    v_rsq_f32 v54, v54
    v_lshlrev_b32 v218, 16, v233
    v_lshlrev_b32 v226, 16, v237
    v_mul_f32 v218, v218, v54
    v_fma_f32 v226, -v46, v218, v226
    v_mul_f32 v47, s24, v47
    v_mul_f32 v55, s24, v55
    v_fma_f32 v55, -v47, v47, v55
    v_max_f32 v55, 0, v55
    v_add_f32 v55, s25, v55
    v_rsq_f32 v55, v55
    v_and_b32 v219, 0xffff0000, v233
    v_and_b32 v227, 0xffff0000, v237
    v_mul_f32 v219, v219, v55
    v_fma_f32 v227, -v47, v219, v227
    v_mul_f32 v48, s24, v48
    v_mul_f32 v56, s24, v56
    v_fma_f32 v56, -v48, v48, v56
    v_max_f32 v56, 0, v56
    v_add_f32 v56, s25, v56
    v_rsq_f32 v56, v56
    v_lshlrev_b32 v220, 16, v234
    v_lshlrev_b32 v228, 16, v238
    v_mul_f32 v220, v220, v56
    v_fma_f32 v228, -v48, v220, v228
    v_mul_f32 v49, s24, v49
    v_mul_f32 v57, s24, v57
    v_fma_f32 v57, -v49, v49, v57
    v_max_f32 v57, 0, v57
    v_add_f32 v57, s25, v57
    v_rsq_f32 v57, v57
    v_and_b32 v221, 0xffff0000, v234
    v_and_b32 v229, 0xffff0000, v238
    v_mul_f32 v221, v221, v57
    v_fma_f32 v229, -v49, v221, v229
    v_mul_f32 v50, s24, v50
    v_mul_f32 v58, s24, v58
    v_fma_f32 v58, -v50, v50, v58
    v_max_f32 v58, 0, v58
    v_add_f32 v58, s25, v58
    v_rsq_f32 v58, v58
    v_lshlrev_b32 v222, 16, v235
    v_lshlrev_b32 v230, 16, v239
    v_mul_f32 v222, v222, v58
    v_fma_f32 v230, -v50, v222, v230
    v_mul_f32 v51, s24, v51
    v_mul_f32 v59, s24, v59
    v_fma_f32 v59, -v51, v51, v59
    v_max_f32 v59, 0, v59
    v_add_f32 v59, s25, v59
    v_rsq_f32 v59, v59
    v_and_b32 v223, 0xffff0000, v235
    v_and_b32 v231, 0xffff0000, v239
    v_mul_f32 v223, v223, v59
    v_fma_f32 v231, -v51, v223, v231
    s_mul_i32 s24, s11, 8176640
    s_add_u32 s28, s28, s24
    s_addc_u32 s29, s29, 0
    s_mov_b32 s32, s28
    s_and_b32 s33, s29, 0xffff
    s_mov_b32 s34, 8176640
    s_mov_b32 s35, 0x00020000
    s_lshl_b32 s25, s13, 8
    v_lshlrev_b32 v210, 12, v202
    v_lshl_add_u32 v210, v201, 4, v210
    v_add_u32 v210, s25, v210
    s_mov_b32 s26, 0xbdd2d3e8
    v_mov_b32 v211, 0xc0135761
    s_cmp_ge_u32 s10, 6
    s_cbranch_scc1 L_k45_hoff
    s_cmp_ge_u32 s14, 167
    s_cbranch_scc1 L_k45_fin
    s_mul_i32 s24, s14, 49152
    s_add_u32 s52, s24, 0
    s_add_u32 s53, s24, 1024
    s_add_u32 s54, s24, 2048
    s_add_u32 s55, s24, 16384
    s_add_u32 s56, s24, 17408
    s_add_u32 s57, s24, 18432
    s_add_u32 s58, s24, 32768
    s_add_u32 s59, s24, 33792
    s_add_u32 s60, s24, 34816
    s_branch L_k45_gelu
L_k45_hoff:
    s_sub_u32 s25, s10, 6
    s_mul_i32 s25, s25, 3
    s_mul_i32 s24, s12, 6
    s_add_u32 s24, s24, s25
    s_mul_i32 s24, s24, 49152
    s_add_u32 s52, s24, 3072
    s_add_u32 s53, s24, 19456
    s_add_u32 s54, s24, 35840
    s_add_u32 s55, s24, 52224
    s_add_u32 s56, s24, 68608
    s_add_u32 s57, s24, 84992
    s_add_u32 s58, s24, 101376
    s_add_u32 s59, s24, 117760
    s_add_u32 s60, s24, 134144
L_k45_gelu:
    v_fma_f32 v104, v104, v216, v224
    v_fma_f32 v108, v108, v217, v225
    v_fma_f32 v112, v112, v218, v226
    v_fma_f32 v116, v116, v219, v227
    v_fma_f32 v120, v120, v220, v228
    v_fma_f32 v124, v124, v221, v229
    v_fma_f32 v128, v128, v222, v230
    v_fma_f32 v132, v132, v223, v231
    v_mul_f32 v0, v104, v104
    v_mul_f32 v1, v108, v108
    v_mul_f32 v2, v112, v112
    v_mul_f32 v3, v116, v116
    v_mul_f32 v4, v120, v120
    v_mul_f32 v5, v124, v124
    v_mul_f32 v6, v128, v128
    v_mul_f32 v7, v132, v132
    v_fma_f32 v0, v0, s26, v211
    v_fma_f32 v1, v1, s26, v211
    v_fma_f32 v2, v2, s26, v211
    v_fma_f32 v3, v3, s26, v211
    v_fma_f32 v4, v4, s26, v211
    v_fma_f32 v5, v5, s26, v211
    v_fma_f32 v6, v6, s26, v211
    v_fma_f32 v7, v7, s26, v211
    v_mul_f32 v0, v0, v104
    v_mul_f32 v1, v1, v108
    v_mul_f32 v2, v2, v112
    v_mul_f32 v3, v3, v116
    v_mul_f32 v4, v4, v120
    v_mul_f32 v5, v5, v124
    v_mul_f32 v6, v6, v128
    v_mul_f32 v7, v7, v132
    v_exp_f32 v0, v0
    v_exp_f32 v1, v1
    v_exp_f32 v2, v2
    v_exp_f32 v3, v3
    v_exp_f32 v4, v4
    v_exp_f32 v5, v5
    v_exp_f32 v6, v6
    v_exp_f32 v7, v7
    v_add_f32 v0, 1.0, v0
    v_add_f32 v1, 1.0, v1
    v_add_f32 v2, 1.0, v2
    v_add_f32 v3, 1.0, v3
    v_add_f32 v4, 1.0, v4
    v_add_f32 v5, 1.0, v5
    v_add_f32 v6, 1.0, v6
    v_add_f32 v7, 1.0, v7
    v_rcp_f32 v0, v0
    v_rcp_f32 v1, v1
    v_rcp_f32 v2, v2
    v_rcp_f32 v3, v3
    v_rcp_f32 v4, v4
    v_rcp_f32 v5, v5
    v_rcp_f32 v6, v6
    v_rcp_f32 v7, v7
    v_mul_f32 v0, v0, v104
    v_mul_f32 v1, v1, v108
    v_mul_f32 v2, v2, v112
    v_mul_f32 v3, v3, v116
    v_mul_f32 v4, v4, v120
    v_mul_f32 v5, v5, v124
    v_mul_f32 v6, v6, v128
    v_mul_f32 v7, v7, v132
    v_cvt_pk_bf16_f32 v16, v0, v1
    v_cvt_pk_bf16_f32 v17, v2, v3
    v_cvt_pk_bf16_f32 v18, v4, v5
    v_cvt_pk_bf16_f32 v19, v6, v7
    buffer_store_dwordx4 v[16:19], v210, s[32:35], s52 offen sc1
    v_fma_f32 v105, v105, v216, v224
    v_fma_f32 v109, v109, v217, v225
    v_fma_f32 v113, v113, v218, v226
    v_fma_f32 v117, v117, v219, v227
    v_fma_f32 v121, v121, v220, v228
    v_fma_f32 v125, v125, v221, v229
    v_fma_f32 v129, v129, v222, v230
    v_fma_f32 v133, v133, v223, v231
    v_mul_f32 v0, v105, v105
    v_mul_f32 v1, v109, v109
    v_mul_f32 v2, v113, v113
    v_mul_f32 v3, v117, v117
    v_mul_f32 v4, v121, v121
    v_mul_f32 v5, v125, v125
    v_mul_f32 v6, v129, v129
    v_mul_f32 v7, v133, v133
    v_fma_f32 v0, v0, s26, v211
    v_fma_f32 v1, v1, s26, v211
    v_fma_f32 v2, v2, s26, v211
    v_fma_f32 v3, v3, s26, v211
    v_fma_f32 v4, v4, s26, v211
    v_fma_f32 v5, v5, s26, v211
    v_fma_f32 v6, v6, s26, v211
    v_fma_f32 v7, v7, s26, v211
    v_mul_f32 v0, v0, v105
    v_mul_f32 v1, v1, v109
    v_mul_f32 v2, v2, v113
    v_mul_f32 v3, v3, v117
    v_mul_f32 v4, v4, v121
    v_mul_f32 v5, v5, v125
    v_mul_f32 v6, v6, v129
    v_mul_f32 v7, v7, v133
    v_exp_f32 v0, v0
    v_exp_f32 v1, v1
    v_exp_f32 v2, v2
    v_exp_f32 v3, v3
    v_exp_f32 v4, v4
    v_exp_f32 v5, v5
    v_exp_f32 v6, v6
    v_exp_f32 v7, v7
    v_add_f32 v0, 1.0, v0
    v_add_f32 v1, 1.0, v1
    v_add_f32 v2, 1.0, v2
    v_add_f32 v3, 1.0, v3
    v_add_f32 v4, 1.0, v4
    v_add_f32 v5, 1.0, v5
    v_add_f32 v6, 1.0, v6
    v_add_f32 v7, 1.0, v7
    v_rcp_f32 v0, v0
    v_rcp_f32 v1, v1
    v_rcp_f32 v2, v2
    v_rcp_f32 v3, v3
    v_rcp_f32 v4, v4
    v_rcp_f32 v5, v5
    v_rcp_f32 v6, v6
    v_rcp_f32 v7, v7
    v_mul_f32 v0, v0, v105
    v_mul_f32 v1, v1, v109
    v_mul_f32 v2, v2, v113
    v_mul_f32 v3, v3, v117
    v_mul_f32 v4, v4, v121
    v_mul_f32 v5, v5, v125
    v_mul_f32 v6, v6, v129
    v_mul_f32 v7, v7, v133
    v_cvt_pk_bf16_f32 v20, v0, v1
    v_cvt_pk_bf16_f32 v21, v2, v3
    v_cvt_pk_bf16_f32 v22, v4, v5
    v_cvt_pk_bf16_f32 v23, v6, v7
    buffer_store_dwordx4 v[20:23], v210, s[32:35], s53 offen sc1
    v_fma_f32 v106, v106, v216, v224
    v_fma_f32 v110, v110, v217, v225
    v_fma_f32 v114, v114, v218, v226
    v_fma_f32 v118, v118, v219, v227
    v_fma_f32 v122, v122, v220, v228
    v_fma_f32 v126, v126, v221, v229
    v_fma_f32 v130, v130, v222, v230
    v_fma_f32 v134, v134, v223, v231
    v_mul_f32 v0, v106, v106
    v_mul_f32 v1, v110, v110
    v_mul_f32 v2, v114, v114
    v_mul_f32 v3, v118, v118
    v_mul_f32 v4, v122, v122
    v_mul_f32 v5, v126, v126
    v_mul_f32 v6, v130, v130
    v_mul_f32 v7, v134, v134
    v_fma_f32 v0, v0, s26, v211
    v_fma_f32 v1, v1, s26, v211
    v_fma_f32 v2, v2, s26, v211
    v_fma_f32 v3, v3, s26, v211
    v_fma_f32 v4, v4, s26, v211
    v_fma_f32 v5, v5, s26, v211
    v_fma_f32 v6, v6, s26, v211
    v_fma_f32 v7, v7, s26, v211
    v_mul_f32 v0, v0, v106
    v_mul_f32 v1, v1, v110
    v_mul_f32 v2, v2, v114
    v_mul_f32 v3, v3, v118
    v_mul_f32 v4, v4, v122
    v_mul_f32 v5, v5, v126
    v_mul_f32 v6, v6, v130
    v_mul_f32 v7, v7, v134
    v_exp_f32 v0, v0
    v_exp_f32 v1, v1
    v_exp_f32 v2, v2
    v_exp_f32 v3, v3
    v_exp_f32 v4, v4
    v_exp_f32 v5, v5
    v_exp_f32 v6, v6
    v_exp_f32 v7, v7
    v_add_f32 v0, 1.0, v0
    v_add_f32 v1, 1.0, v1
    v_add_f32 v2, 1.0, v2
    v_add_f32 v3, 1.0, v3
    v_add_f32 v4, 1.0, v4
    v_add_f32 v5, 1.0, v5
    v_add_f32 v6, 1.0, v6
    v_add_f32 v7, 1.0, v7
    v_rcp_f32 v0, v0
    v_rcp_f32 v1, v1
    v_rcp_f32 v2, v2
    v_rcp_f32 v3, v3
    v_rcp_f32 v4, v4
    v_rcp_f32 v5, v5
    v_rcp_f32 v6, v6
    v_rcp_f32 v7, v7
    v_mul_f32 v0, v0, v106
    v_mul_f32 v1, v1, v110
    v_mul_f32 v2, v2, v114
    v_mul_f32 v3, v3, v118
    v_mul_f32 v4, v4, v122
    v_mul_f32 v5, v5, v126
    v_mul_f32 v6, v6, v130
    v_mul_f32 v7, v7, v134
    v_cvt_pk_bf16_f32 v24, v0, v1
    v_cvt_pk_bf16_f32 v25, v2, v3
    v_cvt_pk_bf16_f32 v26, v4, v5
    v_cvt_pk_bf16_f32 v27, v6, v7
    buffer_store_dwordx4 v[24:27], v210, s[32:35], s54 offen sc1
    v_fma_f32 v136, v136, v216, v224
    v_fma_f32 v140, v140, v217, v225
    v_fma_f32 v144, v144, v218, v226
    v_fma_f32 v148, v148, v219, v227
    v_fma_f32 v152, v152, v220, v228
    v_fma_f32 v156, v156, v221, v229
    v_fma_f32 v160, v160, v222, v230
    v_fma_f32 v164, v164, v223, v231
    v_mul_f32 v0, v136, v136
    v_mul_f32 v1, v140, v140
    v_mul_f32 v2, v144, v144
    v_mul_f32 v3, v148, v148
    v_mul_f32 v4, v152, v152
    v_mul_f32 v5, v156, v156
    v_mul_f32 v6, v160, v160
    v_mul_f32 v7, v164, v164
    v_fma_f32 v0, v0, s26, v211
    v_fma_f32 v1, v1, s26, v211
    v_fma_f32 v2, v2, s26, v211
    v_fma_f32 v3, v3, s26, v211
    v_fma_f32 v4, v4, s26, v211
    v_fma_f32 v5, v5, s26, v211
    v_fma_f32 v6, v6, s26, v211
    v_fma_f32 v7, v7, s26, v211
    v_mul_f32 v0, v0, v136
    v_mul_f32 v1, v1, v140
    v_mul_f32 v2, v2, v144
    v_mul_f32 v3, v3, v148
    v_mul_f32 v4, v4, v152
    v_mul_f32 v5, v5, v156
    v_mul_f32 v6, v6, v160
    v_mul_f32 v7, v7, v164
    v_exp_f32 v0, v0
    v_exp_f32 v1, v1
    v_exp_f32 v2, v2
    v_exp_f32 v3, v3
    v_exp_f32 v4, v4
    v_exp_f32 v5, v5
    v_exp_f32 v6, v6
    v_exp_f32 v7, v7
    v_add_f32 v0, 1.0, v0
    v_add_f32 v1, 1.0, v1
    v_add_f32 v2, 1.0, v2
    v_add_f32 v3, 1.0, v3
    v_add_f32 v4, 1.0, v4
    v_add_f32 v5, 1.0, v5
    v_add_f32 v6, 1.0, v6
    v_add_f32 v7, 1.0, v7
    v_rcp_f32 v0, v0
    v_rcp_f32 v1, v1
    v_rcp_f32 v2, v2
    v_rcp_f32 v3, v3
    v_rcp_f32 v4, v4
    v_rcp_f32 v5, v5
    v_rcp_f32 v6, v6
    v_rcp_f32 v7, v7
    v_mul_f32 v0, v0, v136
    v_mul_f32 v1, v1, v140
    v_mul_f32 v2, v2, v144
    v_mul_f32 v3, v3, v148
    v_mul_f32 v4, v4, v152
    v_mul_f32 v5, v5, v156
    v_mul_f32 v6, v6, v160
    v_mul_f32 v7, v7, v164
    v_cvt_pk_bf16_f32 v28, v0, v1
    v_cvt_pk_bf16_f32 v29, v2, v3
    v_cvt_pk_bf16_f32 v30, v4, v5
    v_cvt_pk_bf16_f32 v31, v6, v7
    buffer_store_dwordx4 v[28:31], v210, s[32:35], s55 offen sc1
    v_fma_f32 v137, v137, v216, v224
    v_fma_f32 v141, v141, v217, v225
    v_fma_f32 v145, v145, v218, v226
    v_fma_f32 v149, v149, v219, v227
    v_fma_f32 v153, v153, v220, v228
    v_fma_f32 v157, v157, v221, v229
    v_fma_f32 v161, v161, v222, v230
    v_fma_f32 v165, v165, v223, v231
    v_mul_f32 v0, v137, v137
    v_mul_f32 v1, v141, v141
    v_mul_f32 v2, v145, v145
    v_mul_f32 v3, v149, v149
    v_mul_f32 v4, v153, v153
    v_mul_f32 v5, v157, v157
    v_mul_f32 v6, v161, v161
    v_mul_f32 v7, v165, v165
    v_fma_f32 v0, v0, s26, v211
    v_fma_f32 v1, v1, s26, v211
    v_fma_f32 v2, v2, s26, v211
    v_fma_f32 v3, v3, s26, v211
    v_fma_f32 v4, v4, s26, v211
    v_fma_f32 v5, v5, s26, v211
    v_fma_f32 v6, v6, s26, v211
    v_fma_f32 v7, v7, s26, v211
    v_mul_f32 v0, v0, v137
    v_mul_f32 v1, v1, v141
    v_mul_f32 v2, v2, v145
    v_mul_f32 v3, v3, v149
    v_mul_f32 v4, v4, v153
    v_mul_f32 v5, v5, v157
    v_mul_f32 v6, v6, v161
    v_mul_f32 v7, v7, v165
    v_exp_f32 v0, v0
    v_exp_f32 v1, v1
    v_exp_f32 v2, v2
    v_exp_f32 v3, v3
    v_exp_f32 v4, v4
    v_exp_f32 v5, v5
    v_exp_f32 v6, v6
    v_exp_f32 v7, v7
    v_add_f32 v0, 1.0, v0
    v_add_f32 v1, 1.0, v1
    v_add_f32 v2, 1.0, v2
    v_add_f32 v3, 1.0, v3
    v_add_f32 v4, 1.0, v4
    v_add_f32 v5, 1.0, v5
    v_add_f32 v6, 1.0, v6
    v_add_f32 v7, 1.0, v7
    v_rcp_f32 v0, v0
    v_rcp_f32 v1, v1
    v_rcp_f32 v2, v2
    v_rcp_f32 v3, v3
    v_rcp_f32 v4, v4
    v_rcp_f32 v5, v5
    v_rcp_f32 v6, v6
    v_rcp_f32 v7, v7
    v_mul_f32 v0, v0, v137
    v_mul_f32 v1, v1, v141
    v_mul_f32 v2, v2, v145
    v_mul_f32 v3, v3, v149
    v_mul_f32 v4, v4, v153
    v_mul_f32 v5, v5, v157
    v_mul_f32 v6, v6, v161
    v_mul_f32 v7, v7, v165
    v_cvt_pk_bf16_f32 v32, v0, v1
    v_cvt_pk_bf16_f32 v33, v2, v3
    v_cvt_pk_bf16_f32 v34, v4, v5
    v_cvt_pk_bf16_f32 v35, v6, v7
    buffer_store_dwordx4 v[32:35], v210, s[32:35], s56 offen sc1
    v_fma_f32 v138, v138, v216, v224
    v_fma_f32 v142, v142, v217, v225
    v_fma_f32 v146, v146, v218, v226
    v_fma_f32 v150, v150, v219, v227
    v_fma_f32 v154, v154, v220, v228
    v_fma_f32 v158, v158, v221, v229
    v_fma_f32 v162, v162, v222, v230
    v_fma_f32 v166, v166, v223, v231
    v_mul_f32 v0, v138, v138
    v_mul_f32 v1, v142, v142
    v_mul_f32 v2, v146, v146
    v_mul_f32 v3, v150, v150
    v_mul_f32 v4, v154, v154
    v_mul_f32 v5, v158, v158
    v_mul_f32 v6, v162, v162
    v_mul_f32 v7, v166, v166
    v_fma_f32 v0, v0, s26, v211
    v_fma_f32 v1, v1, s26, v211
    v_fma_f32 v2, v2, s26, v211
    v_fma_f32 v3, v3, s26, v211
    v_fma_f32 v4, v4, s26, v211
    v_fma_f32 v5, v5, s26, v211
    v_fma_f32 v6, v6, s26, v211
    v_fma_f32 v7, v7, s26, v211
    v_mul_f32 v0, v0, v138
    v_mul_f32 v1, v1, v142
    v_mul_f32 v2, v2, v146
    v_mul_f32 v3, v3, v150
    v_mul_f32 v4, v4, v154
    v_mul_f32 v5, v5, v158
    v_mul_f32 v6, v6, v162
    v_mul_f32 v7, v7, v166
    v_exp_f32 v0, v0
    v_exp_f32 v1, v1
    v_exp_f32 v2, v2
    v_exp_f32 v3, v3
    v_exp_f32 v4, v4
    v_exp_f32 v5, v5
    v_exp_f32 v6, v6
    v_exp_f32 v7, v7
    v_add_f32 v0, 1.0, v0
    v_add_f32 v1, 1.0, v1
    v_add_f32 v2, 1.0, v2
    v_add_f32 v3, 1.0, v3
    v_add_f32 v4, 1.0, v4
    v_add_f32 v5, 1.0, v5
    v_add_f32 v6, 1.0, v6
    v_add_f32 v7, 1.0, v7
    v_rcp_f32 v0, v0
    v_rcp_f32 v1, v1
    v_rcp_f32 v2, v2
    v_rcp_f32 v3, v3
    v_rcp_f32 v4, v4
    v_rcp_f32 v5, v5
    v_rcp_f32 v6, v6
    v_rcp_f32 v7, v7
    v_mul_f32 v0, v0, v138
    v_mul_f32 v1, v1, v142
    v_mul_f32 v2, v2, v146
    v_mul_f32 v3, v3, v150
    v_mul_f32 v4, v4, v154
    v_mul_f32 v5, v5, v158
    v_mul_f32 v6, v6, v162
    v_mul_f32 v7, v7, v166
    v_cvt_pk_bf16_f32 v36, v0, v1
    v_cvt_pk_bf16_f32 v37, v2, v3
    v_cvt_pk_bf16_f32 v38, v4, v5
    v_cvt_pk_bf16_f32 v39, v6, v7
    buffer_store_dwordx4 v[36:39], v210, s[32:35], s57 offen sc1
    v_fma_f32 v168, v168, v216, v224
    v_fma_f32 v172, v172, v217, v225
    v_fma_f32 v176, v176, v218, v226
    v_fma_f32 v180, v180, v219, v227
    v_fma_f32 v184, v184, v220, v228
    v_fma_f32 v188, v188, v221, v229
    v_fma_f32 v192, v192, v222, v230
    v_fma_f32 v196, v196, v223, v231
    v_mul_f32 v0, v168, v168
    v_mul_f32 v1, v172, v172
    v_mul_f32 v2, v176, v176
    v_mul_f32 v3, v180, v180
    v_mul_f32 v4, v184, v184
    v_mul_f32 v5, v188, v188
    v_mul_f32 v6, v192, v192
    v_mul_f32 v7, v196, v196
    v_fma_f32 v0, v0, s26, v211
    v_fma_f32 v1, v1, s26, v211
    v_fma_f32 v2, v2, s26, v211
    v_fma_f32 v3, v3, s26, v211
    v_fma_f32 v4, v4, s26, v211
    v_fma_f32 v5, v5, s26, v211
    v_fma_f32 v6, v6, s26, v211
    v_fma_f32 v7, v7, s26, v211
    v_mul_f32 v0, v0, v168
    v_mul_f32 v1, v1, v172
    v_mul_f32 v2, v2, v176
    v_mul_f32 v3, v3, v180
    v_mul_f32 v4, v4, v184
    v_mul_f32 v5, v5, v188
    v_mul_f32 v6, v6, v192
    v_mul_f32 v7, v7, v196
    v_exp_f32 v0, v0
    v_exp_f32 v1, v1
    v_exp_f32 v2, v2
    v_exp_f32 v3, v3
    v_exp_f32 v4, v4
    v_exp_f32 v5, v5
    v_exp_f32 v6, v6
    v_exp_f32 v7, v7
    v_add_f32 v0, 1.0, v0
    v_add_f32 v1, 1.0, v1
    v_add_f32 v2, 1.0, v2
    v_add_f32 v3, 1.0, v3
    v_add_f32 v4, 1.0, v4
    v_add_f32 v5, 1.0, v5
    v_add_f32 v6, 1.0, v6
    v_add_f32 v7, 1.0, v7
    v_rcp_f32 v0, v0
    v_rcp_f32 v1, v1
    v_rcp_f32 v2, v2
    v_rcp_f32 v3, v3
    v_rcp_f32 v4, v4
    v_rcp_f32 v5, v5
    v_rcp_f32 v6, v6
    v_rcp_f32 v7, v7
    v_mul_f32 v0, v0, v168
    v_mul_f32 v1, v1, v172
    v_mul_f32 v2, v2, v176
    v_mul_f32 v3, v3, v180
    v_mul_f32 v4, v4, v184
    v_mul_f32 v5, v5, v188
    v_mul_f32 v6, v6, v192
    v_mul_f32 v7, v7, v196
    v_cvt_pk_bf16_f32 v40, v0, v1
    v_cvt_pk_bf16_f32 v41, v2, v3
    v_cvt_pk_bf16_f32 v42, v4, v5
    v_cvt_pk_bf16_f32 v43, v6, v7
    buffer_store_dwordx4 v[40:43], v210, s[32:35], s58 offen sc1
    v_fma_f32 v169, v169, v216, v224
    v_fma_f32 v173, v173, v217, v225
    v_fma_f32 v177, v177, v218, v226
    v_fma_f32 v181, v181, v219, v227
    v_fma_f32 v185, v185, v220, v228
    v_fma_f32 v189, v189, v221, v229
    v_fma_f32 v193, v193, v222, v230
    v_fma_f32 v197, v197, v223, v231
    v_mul_f32 v0, v169, v169
    v_mul_f32 v1, v173, v173
    v_mul_f32 v2, v177, v177
    v_mul_f32 v3, v181, v181
    v_mul_f32 v4, v185, v185
    v_mul_f32 v5, v189, v189
    v_mul_f32 v6, v193, v193
    v_mul_f32 v7, v197, v197
    v_fma_f32 v0, v0, s26, v211
    v_fma_f32 v1, v1, s26, v211
    v_fma_f32 v2, v2, s26, v211
    v_fma_f32 v3, v3, s26, v211
    v_fma_f32 v4, v4, s26, v211
    v_fma_f32 v5, v5, s26, v211
    v_fma_f32 v6, v6, s26, v211
    v_fma_f32 v7, v7, s26, v211
    v_mul_f32 v0, v0, v169
    v_mul_f32 v1, v1, v173
    v_mul_f32 v2, v2, v177
    v_mul_f32 v3, v3, v181
    v_mul_f32 v4, v4, v185
    v_mul_f32 v5, v5, v189
    v_mul_f32 v6, v6, v193
    v_mul_f32 v7, v7, v197
    v_exp_f32 v0, v0
    v_exp_f32 v1, v1
    v_exp_f32 v2, v2
    v_exp_f32 v3, v3
    v_exp_f32 v4, v4
    v_exp_f32 v5, v5
    v_exp_f32 v6, v6
    v_exp_f32 v7, v7
    v_add_f32 v0, 1.0, v0
    v_add_f32 v1, 1.0, v1
    v_add_f32 v2, 1.0, v2
    v_add_f32 v3, 1.0, v3
    v_add_f32 v4, 1.0, v4
    v_add_f32 v5, 1.0, v5
    v_add_f32 v6, 1.0, v6
    v_add_f32 v7, 1.0, v7
    v_rcp_f32 v0, v0
    v_rcp_f32 v1, v1
    v_rcp_f32 v2, v2
    v_rcp_f32 v3, v3
    v_rcp_f32 v4, v4
    v_rcp_f32 v5, v5
    v_rcp_f32 v6, v6
    v_rcp_f32 v7, v7
    v_mul_f32 v0, v0, v169
    v_mul_f32 v1, v1, v173
    v_mul_f32 v2, v2, v177
    v_mul_f32 v3, v3, v181
    v_mul_f32 v4, v4, v185
    v_mul_f32 v5, v5, v189
    v_mul_f32 v6, v6, v193
    v_mul_f32 v7, v7, v197
    v_cvt_pk_bf16_f32 v44, v0, v1
    v_cvt_pk_bf16_f32 v45, v2, v3
    v_cvt_pk_bf16_f32 v46, v4, v5
    v_cvt_pk_bf16_f32 v47, v6, v7
    buffer_store_dwordx4 v[44:47], v210, s[32:35], s59 offen sc1
    v_fma_f32 v170, v170, v216, v224
    v_fma_f32 v174, v174, v217, v225
    v_fma_f32 v178, v178, v218, v226
    v_fma_f32 v182, v182, v219, v227
    v_fma_f32 v186, v186, v220, v228
    v_fma_f32 v190, v190, v221, v229
    v_fma_f32 v194, v194, v222, v230
    v_fma_f32 v198, v198, v223, v231
    v_mul_f32 v0, v170, v170
    v_mul_f32 v1, v174, v174
    v_mul_f32 v2, v178, v178
    v_mul_f32 v3, v182, v182
    v_mul_f32 v4, v186, v186
    v_mul_f32 v5, v190, v190
    v_mul_f32 v6, v194, v194
    v_mul_f32 v7, v198, v198
    v_fma_f32 v0, v0, s26, v211
    v_fma_f32 v1, v1, s26, v211
    v_fma_f32 v2, v2, s26, v211
    v_fma_f32 v3, v3, s26, v211
    v_fma_f32 v4, v4, s26, v211
    v_fma_f32 v5, v5, s26, v211
    v_fma_f32 v6, v6, s26, v211
    v_fma_f32 v7, v7, s26, v211
    v_mul_f32 v0, v0, v170
    v_mul_f32 v1, v1, v174
    v_mul_f32 v2, v2, v178
    v_mul_f32 v3, v3, v182
    v_mul_f32 v4, v4, v186
    v_mul_f32 v5, v5, v190
    v_mul_f32 v6, v6, v194
    v_mul_f32 v7, v7, v198
    v_exp_f32 v0, v0
    v_exp_f32 v1, v1
    v_exp_f32 v2, v2
    v_exp_f32 v3, v3
    v_exp_f32 v4, v4
    v_exp_f32 v5, v5
    v_exp_f32 v6, v6
    v_exp_f32 v7, v7
    v_add_f32 v0, 1.0, v0
    v_add_f32 v1, 1.0, v1
    v_add_f32 v2, 1.0, v2
    v_add_f32 v3, 1.0, v3
    v_add_f32 v4, 1.0, v4
    v_add_f32 v5, 1.0, v5
    v_add_f32 v6, 1.0, v6
    v_add_f32 v7, 1.0, v7
    v_rcp_f32 v0, v0
    v_rcp_f32 v1, v1
    v_rcp_f32 v2, v2
    v_rcp_f32 v3, v3
    v_rcp_f32 v4, v4
    v_rcp_f32 v5, v5
    v_rcp_f32 v6, v6
    v_rcp_f32 v7, v7
    v_mul_f32 v0, v0, v170
    v_mul_f32 v1, v1, v174
    v_mul_f32 v2, v2, v178
    v_mul_f32 v3, v3, v182
    v_mul_f32 v4, v4, v186
    v_mul_f32 v5, v5, v190
    v_mul_f32 v6, v6, v194
    v_mul_f32 v7, v7, v198
    v_cvt_pk_bf16_f32 v16, v0, v1
    v_cvt_pk_bf16_f32 v17, v2, v3
    v_cvt_pk_bf16_f32 v18, v4, v5
    v_cvt_pk_bf16_f32 v19, v6, v7
    buffer_store_dwordx4 v[16:19], v210, s[32:35], s60 offen sc1
L_k45_fin:
L_k45_end:
    s_endpgm
L_code_end:
    s_endpgm
.section .rodata,"a"
.p2align 6
.amdhsa_kernel xform_kernel
  .amdhsa_next_free_vgpr 232
  .amdhsa_next_free_sgpr 96
  .amdhsa_accum_offset 232
  .amdhsa_group_segment_fixed_size 0
  .amdhsa_kernarg_size 56
  .amdhsa_user_sgpr_count 2
  .amdhsa_user_sgpr_kernarg_segment_ptr 1
  .amdhsa_system_sgpr_workgroup_id_x 1
  .amdhsa_float_denorm_mode_32 3
.end_amdhsa_kernel

.p2align 6
.amdhsa_kernel gemm_kernel
  .amdhsa_next_free_vgpr 256
  .amdhsa_next_free_sgpr 96
  .amdhsa_accum_offset 256
  .amdhsa_group_segment_fixed_size 0
  .amdhsa_kernarg_size 56
  .amdhsa_user_sgpr_count 2
  .amdhsa_user_sgpr_kernarg_segment_ptr 1
  .amdhsa_system_sgpr_workgroup_id_x 1
  .amdhsa_float_denorm_mode_32 3
.end_amdhsa_kernel

.p2align 6
.amdhsa_kernel final_kernel
  .amdhsa_next_free_vgpr 240
  .amdhsa_next_free_sgpr 96
  .amdhsa_accum_offset 240
  .amdhsa_group_segment_fixed_size 0
  .amdhsa_kernarg_size 56
  .amdhsa_user_sgpr_count 2
  .amdhsa_user_sgpr_kernarg_segment_ptr 1
  .amdhsa_system_sgpr_workgroup_id_x 1
  .amdhsa_float_denorm_mode_32 3
.end_amdhsa_kernel
```

```asm
; @launch kernel=conv_kernel grid=(256,1,1) block=(512,1,1) lds=155648
; @launch kernel=final_kernel grid=(224,1,1) block=(512,1,1) lds=82944
.amdgcn_target "amdgcn-amd-amdhsa--gfx950"
.text
.globl conv_kernel
.p2align 8
.type conv_kernel,@function
conv_kernel:
    s_cmp_ge_u32 s2, 256
    s_cbranch_scc1 L_fz_end
    s_load_dwordx4 s[4:7], s[0:1], 0
    s_load_dwordx4 s[36:39], s[0:1], 40
    v_lshrrev_b32 v253, 6, v0
    v_and_b32 v0, 63, v0
    v_readfirstlane_b32 s10, v253
    s_nop 3
    s_cmp_ge_u32 s10, 4
    s_cbranch_scc1 L_fz_helper
    s_cmp_ge_u32 s2, 8
    s_cbranch_scc1 L_nopf
    s_cmp_lg_u32 s10, 3
    s_cbranch_scc1 L_nopf
    s_getpc_b64 s[60:61]
L_pf_fz:
    s_sub_u32 s60, s60, L_pf_fz-conv_kernel
    s_subb_u32 s61, s61, 0
    v_mbcnt_lo_u32_b32 v200, -1, 0
    v_mbcnt_hi_u32_b32 v200, -1, v200
    v_lshlrev_b32 v200, 6, v200
    v_add_u32 v201, 0, v200
    v_min_u32 v201, L_code_end-conv_kernel-4, v201
    v_mov_b32 v203, s61
    v_add_co_u32 v202, vcc, s60, v201
    s_nop 1
    v_addc_co_u32 v203, vcc, 0, v203, vcc
    global_load_dword v204, v[202:203], off
    v_add_u32 v201, 4096, v200
    v_min_u32 v201, L_code_end-conv_kernel-4, v201
    v_mov_b32 v203, s61
    v_add_co_u32 v202, vcc, s60, v201
    s_nop 1
    v_addc_co_u32 v203, vcc, 0, v203, vcc
    global_load_dword v204, v[202:203], off
    v_add_u32 v201, 8192, v200
    v_min_u32 v201, L_code_end-conv_kernel-4, v201
    v_mov_b32 v203, s61
    v_add_co_u32 v202, vcc, s60, v201
    s_nop 1
    v_addc_co_u32 v203, vcc, 0, v203, vcc
    global_load_dword v204, v[202:203], off
    v_add_u32 v201, 12288, v200
    v_min_u32 v201, L_code_end-conv_kernel-4, v201
    v_mov_b32 v203, s61
    v_add_co_u32 v202, vcc, s60, v201
    s_nop 1
    v_addc_co_u32 v203, vcc, 0, v203, vcc
    global_load_dword v204, v[202:203], off
    v_add_u32 v201, 16384, v200
    v_min_u32 v201, L_code_end-conv_kernel-4, v201
    v_mov_b32 v203, s61
    v_add_co_u32 v202, vcc, s60, v201
    s_nop 1
    v_addc_co_u32 v203, vcc, 0, v203, vcc
    global_load_dword v204, v[202:203], off
    v_add_u32 v201, 20480, v200
    v_min_u32 v201, L_code_end-conv_kernel-4, v201
    v_mov_b32 v203, s61
    v_add_co_u32 v202, vcc, s60, v201
    s_nop 1
    v_addc_co_u32 v203, vcc, 0, v203, vcc
    global_load_dword v204, v[202:203], off
    v_add_u32 v201, 24576, v200
    v_min_u32 v201, L_code_end-conv_kernel-4, v201
    v_mov_b32 v203, s61
    v_add_co_u32 v202, vcc, s60, v201
    s_nop 1
    v_addc_co_u32 v203, vcc, 0, v203, vcc
    global_load_dword v204, v[202:203], off
    v_add_u32 v201, 28672, v200
    v_min_u32 v201, L_code_end-conv_kernel-4, v201
    v_mov_b32 v203, s61
    v_add_co_u32 v202, vcc, s60, v201
    s_nop 1
    v_addc_co_u32 v203, vcc, 0, v203, vcc
    global_load_dword v204, v[202:203], off
    v_add_u32 v201, 32768, v200
    v_min_u32 v201, L_code_end-conv_kernel-4, v201
    v_mov_b32 v203, s61
    v_add_co_u32 v202, vcc, s60, v201
    s_nop 1
    v_addc_co_u32 v203, vcc, 0, v203, vcc
    global_load_dword v204, v[202:203], off
    v_add_u32 v201, 36864, v200
    v_min_u32 v201, L_code_end-conv_kernel-4, v201
    v_mov_b32 v203, s61
    v_add_co_u32 v202, vcc, s60, v201
    s_nop 1
    v_addc_co_u32 v203, vcc, 0, v203, vcc
    global_load_dword v204, v[202:203], off
    v_add_u32 v201, 40960, v200
    v_min_u32 v201, L_code_end-conv_kernel-4, v201
    v_mov_b32 v203, s61
    v_add_co_u32 v202, vcc, s60, v201
    s_nop 1
    v_addc_co_u32 v203, vcc, 0, v203, vcc
    global_load_dword v204, v[202:203], off
L_nopf:
    s_and_b32 s11, s2, 7
    s_lshr_b32 s12, s2, 3
    s_lshr_b32 s13, s12, 3
    s_lshl_b32 s11, s11, 2
    s_add_u32 s11, s11, s13
    s_bfe_u32 s13, s12, 0x10002
    s_and_b32 s14, s12, 3
    s_and_b32 s15, s10, 3
    v_lshrrev_b32 v253, 4, v0
    v_and_b32 v254, 15, v0
    v_bfe_u32 v255, v254, 3, 1
    v_mul_u32_u24 v255, 3, v255
    v_xor_b32 v255, v255, v253
    v_lshlrev_b32 v255, 4, v255
    v_lshl_add_u32 v250, v254, 6, v255
    v_lshrrev_b32 v255, 2, v254
    v_and_b32 v216, 1, v253
    v_lshl_or_b32 v216, v216, 2, v255
    v_lshl_add_u32 v255, v253, 3, v255
    v_lshlrev_b32 v255, 8, v255
    v_and_b32 v217, 3, v254
    v_lshl_add_u32 v255, v217, 3, v255
    s_lshl_b32 s20, s15, 1
    s_add_u32 s20, s20, s13
    v_xor_b32 v217, s20, v216
    v_lshl_add_u32 v248, v217, 5, v255
    s_xor_b32 s20, s20, 1
    v_xor_b32 v217, s20, v216
    v_lshl_add_u32 v249, v217, 5, v255
    v_lshlrev_b32 v251, 6, v254
    v_lshl_add_u32 v251, v253, 4, v251
    v_and_b32 v255, 7, v254
    v_lshlrev_b32 v252, 6, v255
    v_lshrrev_b32 v216, 3, v254
    v_xor_b32 v216, s13, v216
    s_mov_b32 s22, 11534336
    v_mul_lo_u32 v216, v216, s22
    v_add_u32 v252, v252, v216
    v_lshl_add_u32 v252, v253, 4, v252
    s_lshl_b32 s22, s13, 3
    v_add_u32 v252, s22, v252
    v_cmp_gt_u32 vcc, 7, v255
    v_mov_b32 v216, 0x80000000
    s_nop 0
    v_cndmask_b32 v252, v216, v252, vcc
    s_lshl_b32 s20, s14, 2
    s_add_u32 s20, s20, s15
    s_mul_i32 s48, s20, 720896
    s_mul_i32 s20, s11, 22528
    s_add_u32 s48, s48, s20
    s_add_u32 s48, s48, 117440512
    s_add_u32 s49, s48, 10240
    s_mul_i32 s20, s13, 11534336
    s_add_u32 s48, s48, s20
    s_waitcnt vmcnt(0) lgkmcnt(0)
    s_mov_b32 s16, s38
    s_and_b32 s17, s39, 0xffff
    s_mov_b32 s18, 268435456
    s_mov_b32 s19, 0x00020000
    v_mov_b32 v0, 0
    v_mov_b32 v1, 0
    v_mov_b32 v2, 0
    v_mov_b32 v3, 0
    v_mov_b32 v4, 0
    v_mov_b32 v5, 0
    v_mov_b32 v6, 0
    v_mov_b32 v7, 0
    v_mov_b32 v8, 0
    v_mov_b32 v9, 0
    v_mov_b32 v10, 0
    v_mov_b32 v11, 0
    v_mov_b32 v12, 0
    v_mov_b32 v13, 0
    v_mov_b32 v14, 0
    v_mov_b32 v15, 0
    v_mov_b32 v16, 0
    v_mov_b32 v17, 0
    v_mov_b32 v18, 0
    v_mov_b32 v19, 0
    v_mov_b32 v20, 0
    v_mov_b32 v21, 0
    v_mov_b32 v22, 0
    v_mov_b32 v23, 0
    v_mov_b32 v24, 0
    v_mov_b32 v25, 0
    v_mov_b32 v26, 0
    v_mov_b32 v27, 0
    v_mov_b32 v28, 0
    v_mov_b32 v29, 0
    v_mov_b32 v30, 0
    v_mov_b32 v31, 0
    v_mov_b32 v32, 0
    v_mov_b32 v33, 0
    v_mov_b32 v34, 0
    v_mov_b32 v35, 0
    v_mov_b32 v36, 0
    v_mov_b32 v37, 0
    v_mov_b32 v38, 0
    v_mov_b32 v39, 0
    v_mov_b32 v40, 0
    v_mov_b32 v41, 0
    v_mov_b32 v42, 0
    v_mov_b32 v43, 0
    v_mov_b32 v44, 0
    v_mov_b32 v45, 0
    v_mov_b32 v46, 0
    v_mov_b32 v47, 0
    v_mov_b32 v48, 0
    v_mov_b32 v49, 0
    v_mov_b32 v50, 0
    v_mov_b32 v51, 0
    v_mov_b32 v52, 0
    v_mov_b32 v53, 0
    v_mov_b32 v54, 0
    v_mov_b32 v55, 0
    v_mov_b32 v56, 0
    v_mov_b32 v57, 0
    v_mov_b32 v58, 0
    v_mov_b32 v59, 0
    v_mov_b32 v60, 0
    v_mov_b32 v61, 0
    v_mov_b32 v62, 0
    v_mov_b32 v63, 0
    v_mov_b32 v64, 0
    v_mov_b32 v65, 0
    v_mov_b32 v66, 0
    v_mov_b32 v67, 0
    v_mov_b32 v68, 0
    v_mov_b32 v69, 0
    v_mov_b32 v70, 0
    v_mov_b32 v71, 0
    v_mov_b32 v72, 0
    v_mov_b32 v73, 0
    v_mov_b32 v74, 0
    v_mov_b32 v75, 0
    v_mov_b32 v76, 0
    v_mov_b32 v77, 0
    v_mov_b32 v78, 0
    v_mov_b32 v79, 0
    v_mov_b32 v80, 0
    v_mov_b32 v81, 0
    v_mov_b32 v82, 0
    v_mov_b32 v83, 0
    v_mov_b32 v84, 0
    v_mov_b32 v85, 0
    v_mov_b32 v86, 0
    v_mov_b32 v87, 0
    v_mov_b32 v88, 0
    v_mov_b32 v89, 0
    v_mov_b32 v90, 0
    v_mov_b32 v91, 0
    v_mov_b32 v92, 0
    v_mov_b32 v93, 0
    v_mov_b32 v94, 0
    v_mov_b32 v95, 0
    v_mov_b32 v96, 0
    v_mov_b32 v97, 0
    v_mov_b32 v98, 0
    v_mov_b32 v99, 0
    v_mov_b32 v100, 0
    v_mov_b32 v101, 0
    v_mov_b32 v102, 0
    v_mov_b32 v103, 0
    v_mov_b32 v104, 0
    v_mov_b32 v105, 0
    v_mov_b32 v106, 0
    v_mov_b32 v107, 0
    v_mov_b32 v108, 0
    v_mov_b32 v109, 0
    v_mov_b32 v110, 0
    v_mov_b32 v111, 0
    v_mov_b32 v112, 0
    v_mov_b32 v113, 0
    v_mov_b32 v114, 0
    v_mov_b32 v115, 0
    v_mov_b32 v116, 0
    v_mov_b32 v117, 0
    v_mov_b32 v118, 0
    v_mov_b32 v119, 0
    v_mov_b32 v120, 0
    v_mov_b32 v121, 0
    v_mov_b32 v122, 0
    v_mov_b32 v123, 0
    v_mov_b32 v124, 0
    v_mov_b32 v125, 0
    v_mov_b32 v126, 0
    v_mov_b32 v127, 0
    v_mov_b32 v128, 0
    v_mov_b32 v129, 0
    v_mov_b32 v130, 0
    v_mov_b32 v131, 0
    v_mov_b32 v132, 0
    v_mov_b32 v133, 0
    v_mov_b32 v134, 0
    v_mov_b32 v135, 0
    v_mov_b32 v136, 0
    v_mov_b32 v137, 0
    v_mov_b32 v138, 0
    v_mov_b32 v139, 0
    v_mov_b32 v140, 0
    v_mov_b32 v141, 0
    v_mov_b32 v142, 0
    v_mov_b32 v143, 0
    v_mov_b32 v144, 0
    v_mov_b32 v145, 0
    v_mov_b32 v146, 0
    v_mov_b32 v147, 0
    v_mov_b32 v148, 0
    v_mov_b32 v149, 0
    v_mov_b32 v150, 0
    v_mov_b32 v151, 0
    v_mov_b32 v152, 0
    v_mov_b32 v153, 0
    v_mov_b32 v154, 0
    v_mov_b32 v155, 0
    v_mov_b32 v156, 0
    v_mov_b32 v157, 0
    v_mov_b32 v158, 0
    v_mov_b32 v159, 0
    v_mov_b32 v160, 0
    v_mov_b32 v161, 0
    v_mov_b32 v162, 0
    v_mov_b32 v163, 0
    v_mov_b32 v164, 0
    v_mov_b32 v165, 0
    v_mov_b32 v166, 0
    v_mov_b32 v167, 0
    s_mov_b32 s40, s2
    s_add_u32 s42, s2, 256
    s_mov_b32 s41, 129024
    s_barrier
L_f_loop:
    s_barrier
    v_mov_b32 v254, s41
    ds_read_b32 v255, v254
    s_xor_b32 s41, s41, 4
    s_mov_b32 s40, s42
    s_waitcnt lgkmcnt(0)
    v_readfirstlane_b32 s42, v255
    s_cmp_lt_u32 s40, 1696
    s_cbranch_scc1 L_f_loop
    s_barrier
    s_barrier
    ds_read_b64_tr_b16 v[176:177], v248 offset:0
    ds_read_b64_tr_b16 v[178:179], v248 offset:1024
    ds_read_b64_tr_b16 v[180:181], v249 offset:0
    ds_read_b64_tr_b16 v[182:183], v249 offset:1024
    ds_read_b64_tr_b16 v[184:185], v248 offset:8192
    ds_read_b64_tr_b16 v[186:187], v248 offset:9216
    ds_read_b64_tr_b16 v[188:189], v249 offset:8192
    ds_read_b64_tr_b16 v[190:191], v249 offset:9216
    ds_read_b128 v[216:219], v250 offset:16384
    ds_read_b128 v[220:223], v250 offset:27648
    ds_read_b128 v[224:227], v250 offset:17408
    ds_read_b128 v[228:231], v250 offset:28672
    s_waitcnt lgkmcnt(4)
    v_xor_b32 v208, 0x80008000, v184
    v_xor_b32 v209, 0x80008000, v185
    v_xor_b32 v210, 0x80008000, v186
    v_xor_b32 v211, 0x80008000, v187
    v_xor_b32 v212, 0x80008000, v188
    v_xor_b32 v213, 0x80008000, v189
    v_xor_b32 v214, 0x80008000, v190
    v_xor_b32 v215, 0x80008000, v191
    s_mov_b32 s46, 7
L_g_loop:
    s_barrier
    s_waitcnt lgkmcnt(2)
    v_mfma_f32_16x16x32_bf16 v[0:3], v[176:179], v[216:219], v[0:3]
    ds_read_b128 v[232:235], v250 offset:18432
    ds_read_b128 v[236:239], v250 offset:29696
    v_mfma_f32_16x16x32_bf16 v[4:7], v[180:183], v[216:219], v[4:7]
    v_mfma_f32_16x16x32_bf16 v[8:11], v[208:211], v[216:219], v[8:11]
    v_mfma_f32_16x16x32_bf16 v[12:15], v[212:215], v[216:219], v[12:15]
    v_mfma_f32_16x16x32_bf16 v[0:3], v[184:187], v[220:223], v[0:3]
    v_mfma_f32_16x16x32_bf16 v[4:7], v[188:191], v[220:223], v[4:7]
    v_mfma_f32_16x16x32_bf16 v[8:11], v[176:179], v[220:223], v[8:11]
    v_mfma_f32_16x16x32_bf16 v[12:15], v[180:183], v[220:223], v[12:15]
    s_waitcnt lgkmcnt(2)
    v_mfma_f32_16x16x32_bf16 v[16:19], v[176:179], v[224:227], v[16:19]
    ds_read_b128 v[240:243], v250 offset:19456
    ds_read_b128 v[244:247], v250 offset:30720
    v_mfma_f32_16x16x32_bf16 v[20:23], v[180:183], v[224:227], v[20:23]
    v_mfma_f32_16x16x32_bf16 v[24:27], v[208:211], v[224:227], v[24:27]
    v_mfma_f32_16x16x32_bf16 v[28:31], v[212:215], v[224:227], v[28:31]
    v_mfma_f32_16x16x32_bf16 v[16:19], v[184:187], v[228:231], v[16:19]
    v_mfma_f32_16x16x32_bf16 v[20:23], v[188:191], v[228:231], v[20:23]
    v_mfma_f32_16x16x32_bf16 v[24:27], v[176:179], v[228:231], v[24:27]
    v_mfma_f32_16x16x32_bf16 v[28:31], v[180:183], v[228:231], v[28:31]
    s_waitcnt lgkmcnt(2)
    v_mfma_f32_16x16x32_bf16 v[32:35], v[176:179], v[232:235], v[32:35]
    ds_read_b128 v[216:219], v250 offset:20480
    ds_read_b128 v[220:223], v250 offset:31744
    v_mfma_f32_16x16x32_bf16 v[36:39], v[180:183], v[232:235], v[36:39]
    v_mfma_f32_16x16x32_bf16 v[40:43], v[208:211], v[232:235], v[40:43]
    v_mfma_f32_16x16x32_bf16 v[44:47], v[212:215], v[232:235], v[44:47]
    v_mfma_f32_16x16x32_bf16 v[32:35], v[184:187], v[236:239], v[32:35]
    v_mfma_f32_16x16x32_bf16 v[36:39], v[188:191], v[236:239], v[36:39]
    v_mfma_f32_16x16x32_bf16 v[40:43], v[176:179], v[236:239], v[40:43]
    v_mfma_f32_16x16x32_bf16 v[44:47], v[180:183], v[236:239], v[44:47]
    s_waitcnt lgkmcnt(2)
    v_mfma_f32_16x16x32_bf16 v[48:51], v[176:179], v[240:243], v[48:51]
    ds_read_b128 v[224:227], v250 offset:21504
    ds_read_b128 v[228:231], v250 offset:32768
    v_mfma_f32_16x16x32_bf16 v[52:55], v[180:183], v[240:243], v[52:55]
    v_mfma_f32_16x16x32_bf16 v[56:59], v[208:211], v[240:243], v[56:59]
    v_mfma_f32_16x16x32_bf16 v[60:63], v[212:215], v[240:243], v[60:63]
    v_mfma_f32_16x16x32_bf16 v[48:51], v[184:187], v[244:247], v[48:51]
    v_mfma_f32_16x16x32_bf16 v[52:55], v[188:191], v[244:247], v[52:55]
    v_mfma_f32_16x16x32_bf16 v[56:59], v[176:179], v[244:247], v[56:59]
    v_mfma_f32_16x16x32_bf16 v[60:63], v[180:183], v[244:247], v[60:63]
    s_waitcnt lgkmcnt(2)
    v_mfma_f32_16x16x32_bf16 v[64:67], v[176:179], v[216:219], v[64:67]
    ds_read_b128 v[232:235], v250 offset:22528
    ds_read_b128 v[236:239], v250 offset:33792
    v_mfma_f32_16x16x32_bf16 v[68:71], v[180:183], v[216:219], v[68:71]
    v_mfma_f32_16x16x32_bf16 v[72:75], v[208:211], v[216:219], v[72:75]
    v_mfma_f32_16x16x32_bf16 v[76:79], v[212:215], v[216:219], v[76:79]
    v_mfma_f32_16x16x32_bf16 v[64:67], v[184:187], v[220:223], v[64:67]
    v_mfma_f32_16x16x32_bf16 v[68:71], v[188:191], v[220:223], v[68:71]
    v_mfma_f32_16x16x32_bf16 v[72:75], v[176:179], v[220:223], v[72:75]
    v_mfma_f32_16x16x32_bf16 v[76:79], v[180:183], v[220:223], v[76:79]
    s_waitcnt lgkmcnt(2)
    v_mfma_f32_16x16x32_bf16 v[80:83], v[176:179], v[224:227], v[80:83]
    ds_read_b128 v[240:243], v250 offset:23552
    ds_read_b128 v[244:247], v250 offset:34816
    v_mfma_f32_16x16x32_bf16 v[84:87], v[180:183], v[224:227], v[84:87]
    v_mfma_f32_16x16x32_bf16 v[88:91], v[208:211], v[224:227], v[88:91]
    v_mfma_f32_16x16x32_bf16 v[92:95], v[212:215], v[224:227], v[92:95]
    v_mfma_f32_16x16x32_bf16 v[80:83], v[184:187], v[228:231], v[80:83]
    v_add_u32 v248, 0x9800, v248
    v_add_u32 v249, 0x9800, v249
    v_mfma_f32_16x16x32_bf16 v[84:87], v[188:191], v[228:231], v[84:87]
    v_mfma_f32_16x16x32_bf16 v[88:91], v[176:179], v[228:231], v[88:91]
    v_mfma_f32_16x16x32_bf16 v[92:95], v[180:183], v[228:231], v[92:95]
    s_waitcnt lgkmcnt(2)
    v_mfma_f32_16x16x32_bf16 v[96:99], v[176:179], v[232:235], v[96:99]
    ds_read_b128 v[216:219], v250 offset:24576
    ds_read_b128 v[220:223], v250 offset:35840
    v_mfma_f32_16x16x32_bf16 v[100:103], v[180:183], v[232:235], v[100:103]
    v_mfma_f32_16x16x32_bf16 v[104:107], v[208:211], v[232:235], v[104:107]
    v_mfma_f32_16x16x32_bf16 v[108:111], v[212:215], v[232:235], v[108:111]
    ds_read_b64_tr_b16 v[192:193], v248 offset:0
    ds_read_b64_tr_b16 v[194:195], v248 offset:1024
    ds_read_b64_tr_b16 v[196:197], v249 offset:0
    ds_read_b64_tr_b16 v[198:199], v249 offset:1024
    v_mfma_f32_16x16x32_bf16 v[96:99], v[184:187], v[236:239], v[96:99]
    v_mfma_f32_16x16x32_bf16 v[100:103], v[188:191], v[236:239], v[100:103]
    v_mfma_f32_16x16x32_bf16 v[104:107], v[176:179], v[236:239], v[104:107]
    v_mfma_f32_16x16x32_bf16 v[108:111], v[180:183], v[236:239], v[108:111]
    s_waitcnt lgkmcnt(6)
    v_mfma_f32_16x16x32_bf16 v[112:115], v[176:179], v[240:243], v[112:115]
    ds_read_b128 v[224:227], v250 offset:25600
    ds_read_b128 v[228:231], v250 offset:36864
    v_mfma_f32_16x16x32_bf16 v[116:119], v[180:183], v[240:243], v[116:119]
    v_mfma_f32_16x16x32_bf16 v[120:123], v[208:211], v[240:243], v[120:123]
    v_mfma_f32_16x16x32_bf16 v[124:127], v[212:215], v[240:243], v[124:127]
    ds_read_b64_tr_b16 v[200:201], v248 offset:8192
    ds_read_b64_tr_b16 v[202:203], v248 offset:9216
    ds_read_b64_tr_b16 v[204:205], v249 offset:8192
    ds_read_b64_tr_b16 v[206:207], v249 offset:9216
    v_mfma_f32_16x16x32_bf16 v[112:115], v[184:187], v[244:247], v[112:115]
    v_mfma_f32_16x16x32_bf16 v[116:119], v[188:191], v[244:247], v[116:119]
    v_mfma_f32_16x16x32_bf16 v[120:123], v[176:179], v[244:247], v[120:123]
    v_mfma_f32_16x16x32_bf16 v[124:127], v[180:183], v[244:247], v[124:127]
    s_waitcnt lgkmcnt(10)
    v_mfma_f32_16x16x32_bf16 v[128:131], v[176:179], v[216:219], v[128:131]
    ds_read_b128 v[232:235], v250 offset:26624
    ds_read_b128 v[236:239], v250 offset:37888
    v_mfma_f32_16x16x32_bf16 v[132:135], v[180:183], v[216:219], v[132:135]
    v_mfma_f32_16x16x32_bf16 v[136:139], v[208:211], v[216:219], v[136:139]
    v_mfma_f32_16x16x32_bf16 v[140:143], v[212:215], v[216:219], v[140:143]
    v_mfma_f32_16x16x32_bf16 v[128:131], v[184:187], v[220:223], v[128:131]
    v_mfma_f32_16x16x32_bf16 v[132:135], v[188:191], v[220:223], v[132:135]
    v_mfma_f32_16x16x32_bf16 v[136:139], v[176:179], v[220:223], v[136:139]
    v_mfma_f32_16x16x32_bf16 v[140:143], v[180:183], v[220:223], v[140:143]
    s_waitcnt lgkmcnt(6)
    v_mfma_f32_16x16x32_bf16 v[144:147], v[176:179], v[224:227], v[144:147]
    v_add_u32 v250, 0x9800, v250
    ds_read_b128 v[240:243], v250 offset:16384
    ds_read_b128 v[244:247], v250 offset:27648
    v_mfma_f32_16x16x32_bf16 v[148:151], v[180:183], v[224:227], v[148:151]
    v_mfma_f32_16x16x32_bf16 v[152:155], v[208:211], v[224:227], v[152:155]
    v_mfma_f32_16x16x32_bf16 v[156:159], v[212:215], v[224:227], v[156:159]
    v_mfma_f32_16x16x32_bf16 v[144:147], v[184:187], v[228:231], v[144:147]
    s_waitcnt lgkmcnt(4)
    v_xor_b32 v212, 0x80008000, v204
    v_xor_b32 v213, 0x80008000, v205
    v_mfma_f32_16x16x32_bf16 v[148:151], v[188:191], v[228:231], v[148:151]
    v_xor_b32 v214, 0x80008000, v206
    v_xor_b32 v215, 0x80008000, v207
    v_mfma_f32_16x16x32_bf16 v[152:155], v[176:179], v[228:231], v[152:155]
    v_mfma_f32_16x16x32_bf16 v[156:159], v[180:183], v[228:231], v[156:159]
    s_waitcnt lgkmcnt(2)
    v_mfma_f32_16x16x32_bf16 v[160:163], v[176:179], v[232:235], v[160:163]
    ds_read_b128 v[216:219], v250 offset:17408
    ds_read_b128 v[220:223], v250 offset:28672
    v_mfma_f32_16x16x32_bf16 v[164:167], v[208:211], v[232:235], v[164:167]
    v_xor_b32 v208, 0x80008000, v200
    v_xor_b32 v209, 0x80008000, v201
    v_mfma_f32_16x16x32_bf16 v[160:163], v[184:187], v[236:239], v[160:163]
    v_xor_b32 v210, 0x80008000, v202
    v_xor_b32 v211, 0x80008000, v203
    v_mfma_f32_16x16x32_bf16 v[164:167], v[176:179], v[236:239], v[164:167]
    s_barrier
    s_waitcnt lgkmcnt(2)
    v_mfma_f32_16x16x32_bf16 v[0:3], v[192:195], v[240:243], v[0:3]
    ds_read_b128 v[224:227], v250 offset:18432
    ds_read_b128 v[228:231], v250 offset:29696
    v_mfma_f32_16x16x32_bf16 v[4:7], v[196:199], v[240:243], v[4:7]
    v_mfma_f32_16x16x32_bf16 v[8:11], v[208:211], v[240:243], v[8:11]
    v_mfma_f32_16x16x32_bf16 v[12:15], v[212:215], v[240:243], v[12:15]
    v_mfma_f32_16x16x32_bf16 v[0:3], v[200:203], v[244:247], v[0:3]
    v_mfma_f32_16x16x32_bf16 v[4:7], v[204:207], v[244:247], v[4:7]
    v_mfma_f32_16x16x32_bf16 v[8:11], v[192:195], v[244:247], v[8:11]
    v_mfma_f32_16x16x32_bf16 v[12:15], v[196:199], v[244:247], v[12:15]
    s_waitcnt lgkmcnt(2)
    v_mfma_f32_16x16x32_bf16 v[16:19], v[192:195], v[216:219], v[16:19]
    ds_read_b128 v[232:235], v250 offset:19456
    ds_read_b128 v[236:239], v250 offset:30720
    v_mfma_f32_16x16x32_bf16 v[20:23], v[196:199], v[216:219], v[20:23]
    v_mfma_f32_16x16x32_bf16 v[24:27], v[208:211], v[216:219], v[24:27]
    v_mfma_f32_16x16x32_bf16 v[28:31], v[212:215], v[216:219], v[28:31]
    v_mfma_f32_16x16x32_bf16 v[16:19], v[200:203], v[220:223], v[16:19]
    v_mfma_f32_16x16x32_bf16 v[20:23], v[204:207], v[220:223], v[20:23]
    v_mfma_f32_16x16x32_bf16 v[24:27], v[192:195], v[220:223], v[24:27]
    v_mfma_f32_16x16x32_bf16 v[28:31], v[196:199], v[220:223], v[28:31]
    s_waitcnt lgkmcnt(2)
    v_mfma_f32_16x16x32_bf16 v[32:35], v[192:195], v[224:227], v[32:35]
    ds_read_b128 v[240:243], v250 offset:20480
    ds_read_b128 v[244:247], v250 offset:31744
    v_mfma_f32_16x16x32_bf16 v[36:39], v[196:199], v[224:227], v[36:39]
    v_mfma_f32_16x16x32_bf16 v[40:43], v[208:211], v[224:227], v[40:43]
    v_mfma_f32_16x16x32_bf16 v[44:47], v[212:215], v[224:227], v[44:47]
    v_mfma_f32_16x16x32_bf16 v[32:35], v[200:203], v[228:231], v[32:35]
    v_mfma_f32_16x16x32_bf16 v[36:39], v[204:207], v[228:231], v[36:39]
    v_mfma_f32_16x16x32_bf16 v[40:43], v[192:195], v[228:231], v[40:43]
    v_mfma_f32_16x16x32_bf16 v[44:47], v[196:199], v[228:231], v[44:47]
    s_waitcnt lgkmcnt(2)
    v_mfma_f32_16x16x32_bf16 v[48:51], v[192:195], v[232:235], v[48:51]
    ds_read_b128 v[216:219], v250 offset:21504
    ds_read_b128 v[220:223], v250 offset:32768
    v_mfma_f32_16x16x32_bf16 v[52:55], v[196:199], v[232:235], v[52:55]
    v_mfma_f32_16x16x32_bf16 v[56:59], v[208:211], v[232:235], v[56:59]
    v_mfma_f32_16x16x32_bf16 v[60:63], v[212:215], v[232:235], v[60:63]
    v_mfma_f32_16x16x32_bf16 v[48:51], v[200:203], v[236:239], v[48:51]
    v_mfma_f32_16x16x32_bf16 v[52:55], v[204:207], v[236:239], v[52:55]
    v_mfma_f32_16x16x32_bf16 v[56:59], v[192:195], v[236:239], v[56:59]
    v_mfma_f32_16x16x32_bf16 v[60:63], v[196:199], v[236:239], v[60:63]
    s_waitcnt lgkmcnt(2)
    v_mfma_f32_16x16x32_bf16 v[64:67], v[192:195], v[240:243], v[64:67]
    ds_read_b128 v[224:227], v250 offset:22528
    ds_read_b128 v[228:231], v250 offset:33792
    v_mfma_f32_16x16x32_bf16 v[68:71], v[196:199], v[240:243], v[68:71]
    v_mfma_f32_16x16x32_bf16 v[72:75], v[208:211], v[240:243], v[72:75]
    v_mfma_f32_16x16x32_bf16 v[76:79], v[212:215], v[240:243], v[76:79]
    v_mfma_f32_16x16x32_bf16 v[64:67], v[200:203], v[244:247], v[64:67]
    v_mfma_f32_16x16x32_bf16 v[68:71], v[204:207], v[244:247], v[68:71]
    v_mfma_f32_16x16x32_bf16 v[72:75], v[192:195], v[244:247], v[72:75]
    v_mfma_f32_16x16x32_bf16 v[76:79], v[196:199], v[244:247], v[76:79]
    s_waitcnt lgkmcnt(2)
    v_mfma_f32_16x16x32_bf16 v[80:83], v[192:195], v[216:219], v[80:83]
    ds_read_b128 v[232:235], v250 offset:23552
    ds_read_b128 v[236:239], v250 offset:34816
    v_mfma_f32_16x16x32_bf16 v[84:87], v[196:199], v[216:219], v[84:87]
    v_mfma_f32_16x16x32_bf16 v[88:91], v[208:211], v[216:219], v[88:91]
    v_mfma_f32_16x16x32_bf16 v[92:95], v[212:215], v[216:219], v[92:95]
    v_mfma_f32_16x16x32_bf16 v[80:83], v[200:203], v[220:223], v[80:83]
    v_add_u32 v248, 0x9800, v248
    v_add_u32 v249, 0x9800, v249
    v_mfma_f32_16x16x32_bf16 v[84:87], v[204:207], v[220:223], v[84:87]
    v_mfma_f32_16x16x32_bf16 v[88:91], v[192:195], v[220:223], v[88:91]
    v_mfma_f32_16x16x32_bf16 v[92:95], v[196:199], v[220:223], v[92:95]
    s_waitcnt lgkmcnt(2)
    v_mfma_f32_16x16x32_bf16 v[96:99], v[192:195], v[224:227], v[96:99]
    ds_read_b128 v[240:243], v250 offset:24576
    ds_read_b128 v[244:247], v250 offset:35840
    v_mfma_f32_16x16x32_bf16 v[100:103], v[196:199], v[224:227], v[100:103]
    v_mfma_f32_16x16x32_bf16 v[104:107], v[208:211], v[224:227], v[104:107]
    v_mfma_f32_16x16x32_bf16 v[108:111], v[212:215], v[224:227], v[108:111]
    ds_read_b64_tr_b16 v[176:177], v248 offset:0
    ds_read_b64_tr_b16 v[178:179], v248 offset:1024
    ds_read_b64_tr_b16 v[180:181], v249 offset:0
    ds_read_b64_tr_b16 v[182:183], v249 offset:1024
    v_mfma_f32_16x16x32_bf16 v[96:99], v[200:203], v[228:231], v[96:99]
    v_mfma_f32_16x16x32_bf16 v[100:103], v[204:207], v[228:231], v[100:103]
    v_mfma_f32_16x16x32_bf16 v[104:107], v[192:195], v[228:231], v[104:107]
    v_mfma_f32_16x16x32_bf16 v[108:111], v[196:199], v[228:231], v[108:111]
    s_waitcnt lgkmcnt(6)
    v_mfma_f32_16x16x32_bf16 v[112:115], v[192:195], v[232:235], v[112:115]
    ds_read_b128 v[216:219], v250 offset:25600
    ds_read_b128 v[220:223], v250 offset:36864
    v_mfma_f32_16x16x32_bf16 v[116:119], v[196:199], v[232:235], v[116:119]
    v_mfma_f32_16x16x32_bf16 v[120:123], v[208:211], v[232:235], v[120:123]
    v_mfma_f32_16x16x32_bf16 v[124:127], v[212:215], v[232:235], v[124:127]
    ds_read_b64_tr_b16 v[184:185], v248 offset:8192
    ds_read_b64_tr_b16 v[186:187], v248 offset:9216
    ds_read_b64_tr_b16 v[188:189], v249 offset:8192
    ds_read_b64_tr_b16 v[190:191], v249 offset:9216
    v_mfma_f32_16x16x32_bf16 v[112:115], v[200:203], v[236:239], v[112:115]
    v_mfma_f32_16x16x32_bf16 v[116:119], v[204:207], v[236:239], v[116:119]
    v_mfma_f32_16x16x32_bf16 v[120:123], v[192:195], v[236:239], v[120:123]
    v_mfma_f32_16x16x32_bf16 v[124:127], v[196:199], v[236:239], v[124:127]
    s_waitcnt lgkmcnt(10)
    v_mfma_f32_16x16x32_bf16 v[128:131], v[192:195], v[240:243], v[128:131]
    ds_read_b128 v[224:227], v250 offset:26624
    ds_read_b128 v[228:231], v250 offset:37888
    v_mfma_f32_16x16x32_bf16 v[132:135], v[196:199], v[240:243], v[132:135]
    v_mfma_f32_16x16x32_bf16 v[136:139], v[208:211], v[240:243], v[136:139]
    v_mfma_f32_16x16x32_bf16 v[140:143], v[212:215], v[240:243], v[140:143]
    v_mfma_f32_16x16x32_bf16 v[128:131], v[200:203], v[244:247], v[128:131]
    v_mfma_f32_16x16x32_bf16 v[132:135], v[204:207], v[244:247], v[132:135]
    v_mfma_f32_16x16x32_bf16 v[136:139], v[192:195], v[244:247], v[136:139]
    v_mfma_f32_16x16x32_bf16 v[140:143], v[196:199], v[244:247], v[140:143]
    s_waitcnt lgkmcnt(6)
    v_mfma_f32_16x16x32_bf16 v[144:147], v[192:195], v[216:219], v[144:147]
    v_add_u32 v250, 0x9800, v250
    ds_read_b128 v[232:235], v250 offset:16384
    ds_read_b128 v[236:239], v250 offset:27648
    v_mfma_f32_16x16x32_bf16 v[148:151], v[196:199], v[216:219], v[148:151]
    v_mfma_f32_16x16x32_bf16 v[152:155], v[208:211], v[216:219], v[152:155]
    v_mfma_f32_16x16x32_bf16 v[156:159], v[212:215], v[216:219], v[156:159]
    v_mfma_f32_16x16x32_bf16 v[144:147], v[200:203], v[220:223], v[144:147]
    s_waitcnt lgkmcnt(4)
    v_xor_b32 v212, 0x80008000, v188
    v_xor_b32 v213, 0x80008000, v189
    v_mfma_f32_16x16x32_bf16 v[148:151], v[204:207], v[220:223], v[148:151]
    v_xor_b32 v214, 0x80008000, v190
    v_xor_b32 v215, 0x80008000, v191
    v_mfma_f32_16x16x32_bf16 v[152:155], v[192:195], v[220:223], v[152:155]
    v_mfma_f32_16x16x32_bf16 v[156:159], v[196:199], v[220:223], v[156:159]
    s_waitcnt lgkmcnt(2)
    v_mfma_f32_16x16x32_bf16 v[160:163], v[192:195], v[224:227], v[160:163]
    ds_read_b128 v[240:243], v250 offset:17408
    ds_read_b128 v[244:247], v250 offset:28672
    v_mfma_f32_16x16x32_bf16 v[164:167], v[208:211], v[224:227], v[164:167]
    v_xor_b32 v208, 0x80008000, v184
    v_xor_b32 v209, 0x80008000, v185
    v_mfma_f32_16x16x32_bf16 v[160:163], v[200:203], v[228:231], v[160:163]
    v_xor_b32 v210, 0x80008000, v186
    v_xor_b32 v211, 0x80008000, v187
    v_mfma_f32_16x16x32_bf16 v[164:167], v[192:195], v[228:231], v[164:167]
    s_barrier
    s_waitcnt lgkmcnt(2)
    v_mfma_f32_16x16x32_bf16 v[0:3], v[176:179], v[232:235], v[0:3]
    ds_read_b128 v[216:219], v250 offset:18432
    ds_read_b128 v[220:223], v250 offset:29696
    v_mfma_f32_16x16x32_bf16 v[4:7], v[180:183], v[232:235], v[4:7]
    v_mfma_f32_16x16x32_bf16 v[8:11], v[208:211], v[232:235], v[8:11]
    v_mfma_f32_16x16x32_bf16 v[12:15], v[212:215], v[232:235], v[12:15]
    v_mfma_f32_16x16x32_bf16 v[0:3], v[184:187], v[236:239], v[0:3]
    v_mfma_f32_16x16x32_bf16 v[4:7], v[188:191], v[236:239], v[4:7]
    v_mfma_f32_16x16x32_bf16 v[8:11], v[176:179], v[236:239], v[8:11]
    v_mfma_f32_16x16x32_bf16 v[12:15], v[180:183], v[236:239], v[12:15]
    s_waitcnt lgkmcnt(2)
    v_mfma_f32_16x16x32_bf16 v[16:19], v[176:179], v[240:243], v[16:19]
    ds_read_b128 v[224:227], v250 offset:19456
    ds_read_b128 v[228:231], v250 offset:30720
    v_mfma_f32_16x16x32_bf16 v[20:23], v[180:183], v[240:243], v[20:23]
    v_mfma_f32_16x16x32_bf16 v[24:27], v[208:211], v[240:243], v[24:27]
    v_mfma_f32_16x16x32_bf16 v[28:31], v[212:215], v[240:243], v[28:31]
    v_mfma_f32_16x16x32_bf16 v[16:19], v[184:187], v[244:247], v[16:19]
    v_mfma_f32_16x16x32_bf16 v[20:23], v[188:191], v[244:247], v[20:23]
    v_mfma_f32_16x16x32_bf16 v[24:27], v[176:179], v[244:247], v[24:27]
    v_mfma_f32_16x16x32_bf16 v[28:31], v[180:183], v[244:247], v[28:31]
    s_waitcnt lgkmcnt(2)
    v_mfma_f32_16x16x32_bf16 v[32:35], v[176:179], v[216:219], v[32:35]
    ds_read_b128 v[232:235], v250 offset:20480
    ds_read_b128 v[236:239], v250 offset:31744
    v_mfma_f32_16x16x32_bf16 v[36:39], v[180:183], v[216:219], v[36:39]
    v_mfma_f32_16x16x32_bf16 v[40:43], v[208:211], v[216:219], v[40:43]
    v_mfma_f32_16x16x32_bf16 v[44:47], v[212:215], v[216:219], v[44:47]
    v_mfma_f32_16x16x32_bf16 v[32:35], v[184:187], v[220:223], v[32:35]
    v_mfma_f32_16x16x32_bf16 v[36:39], v[188:191], v[220:223], v[36:39]
    v_mfma_f32_16x16x32_bf16 v[40:43], v[176:179], v[220:223], v[40:43]
    v_mfma_f32_16x16x32_bf16 v[44:47], v[180:183], v[220:223], v[44:47]
    s_waitcnt lgkmcnt(2)
    v_mfma_f32_16x16x32_bf16 v[48:51], v[176:179], v[224:227], v[48:51]
    ds_read_b128 v[240:243], v250 offset:21504
    ds_read_b128 v[244:247], v250 offset:32768
    v_mfma_f32_16x16x32_bf16 v[52:55], v[180:183], v[224:227], v[52:55]
    v_mfma_f32_16x16x32_bf16 v[56:59], v[208:211], v[224:227], v[56:59]
    v_mfma_f32_16x16x32_bf16 v[60:63], v[212:215], v[224:227], v[60:63]
    v_mfma_f32_16x16x32_bf16 v[48:51], v[184:187], v[228:231], v[48:51]
    v_mfma_f32_16x16x32_bf16 v[52:55], v[188:191], v[228:231], v[52:55]
    v_mfma_f32_16x16x32_bf16 v[56:59], v[176:179], v[228:231], v[56:59]
    v_mfma_f32_16x16x32_bf16 v[60:63], v[180:183], v[228:231], v[60:63]
    s_waitcnt lgkmcnt(2)
    v_mfma_f32_16x16x32_bf16 v[64:67], v[176:179], v[232:235], v[64:67]
    ds_read_b128 v[216:219], v250 offset:22528
    ds_read_b128 v[220:223], v250 offset:33792
    v_mfma_f32_16x16x32_bf16 v[68:71], v[180:183], v[232:235], v[68:71]
    v_mfma_f32_16x16x32_bf16 v[72:75], v[208:211], v[232:235], v[72:75]
    v_mfma_f32_16x16x32_bf16 v[76:79], v[212:215], v[232:235], v[76:79]
    v_mfma_f32_16x16x32_bf16 v[64:67], v[184:187], v[236:239], v[64:67]
    v_mfma_f32_16x16x32_bf16 v[68:71], v[188:191], v[236:239], v[68:71]
    v_mfma_f32_16x16x32_bf16 v[72:75], v[176:179], v[236:239], v[72:75]
    v_mfma_f32_16x16x32_bf16 v[76:79], v[180:183], v[236:239], v[76:79]
    s_waitcnt lgkmcnt(2)
    v_mfma_f32_16x16x32_bf16 v[80:83], v[176:179], v[240:243], v[80:83]
    ds_read_b128 v[224:227], v250 offset:23552
    ds_read_b128 v[228:231], v250 offset:34816
    v_mfma_f32_16x16x32_bf16 v[84:87], v[180:183], v[240:243], v[84:87]
    v_mfma_f32_16x16x32_bf16 v[88:91], v[208:211], v[240:243], v[88:91]
    v_mfma_f32_16x16x32_bf16 v[92:95], v[212:215], v[240:243], v[92:95]
    v_mfma_f32_16x16x32_bf16 v[80:83], v[184:187], v[244:247], v[80:83]
    v_add_u32 v248, 0x9800, v248
    v_add_u32 v249, 0x9800, v249
    v_mfma_f32_16x16x32_bf16 v[84:87], v[188:191], v[244:247], v[84:87]
    v_mfma_f32_16x16x32_bf16 v[88:91], v[176:179], v[244:247], v[88:91]
    v_mfma_f32_16x16x32_bf16 v[92:95], v[180:183], v[244:247], v[92:95]
    s_waitcnt lgkmcnt(2)
    v_mfma_f32_16x16x32_bf16 v[96:99], v[176:179], v[216:219], v[96:99]
    ds_read_b128 v[232:235], v250 offset:24576
    ds_read_b128 v[236:239], v250 offset:35840
    v_mfma_f32_16x16x32_bf16 v[100:103], v[180:183], v[216:219], v[100:103]
    v_mfma_f32_16x16x32_bf16 v[104:107], v[208:211], v[216:219], v[104:107]
    v_mfma_f32_16x16x32_bf16 v[108:111], v[212:215], v[216:219], v[108:111]
    ds_read_b64_tr_b16 v[192:193], v248 offset:0
    ds_read_b64_tr_b16 v[194:195], v248 offset:1024
    ds_read_b64_tr_b16 v[196:197], v249 offset:0
    ds_read_b64_tr_b16 v[198:199], v249 offset:1024
    v_mfma_f32_16x16x32_bf16 v[96:99], v[184:187], v[220:223], v[96:99]
    v_mfma_f32_16x16x32_bf16 v[100:103], v[188:191], v[220:223], v[100:103]
    v_mfma_f32_16x16x32_bf16 v[104:107], v[176:179], v[220:223], v[104:107]
    v_mfma_f32_16x16x32_bf16 v[108:111], v[180:183], v[220:223], v[108:111]
    s_waitcnt lgkmcnt(6)
    v_mfma_f32_16x16x32_bf16 v[112:115], v[176:179], v[224:227], v[112:115]
    ds_read_b128 v[240:243], v250 offset:25600
    ds_read_b128 v[244:247], v250 offset:36864
    v_mfma_f32_16x16x32_bf16 v[116:119], v[180:183], v[224:227], v[116:119]
    v_mfma_f32_16x16x32_bf16 v[120:123], v[208:211], v[224:227], v[120:123]
    v_mfma_f32_16x16x32_bf16 v[124:127], v[212:215], v[224:227], v[124:127]
    ds_read_b64_tr_b16 v[200:201], v248 offset:8192
    ds_read_b64_tr_b16 v[202:203], v248 offset:9216
    ds_read_b64_tr_b16 v[204:205], v249 offset:8192
    ds_read_b64_tr_b16 v[206:207], v249 offset:9216
    v_mfma_f32_16x16x32_bf16 v[112:115], v[184:187], v[228:231], v[112:115]
    v_mfma_f32_16x16x32_bf16 v[116:119], v[188:191], v[228:231], v[116:119]
    v_mfma_f32_16x16x32_bf16 v[120:123], v[176:179], v[228:231], v[120:123]
    v_mfma_f32_16x16x32_bf16 v[124:127], v[180:183], v[228:231], v[124:127]
    s_waitcnt lgkmcnt(10)
    v_mfma_f32_16x16x32_bf16 v[128:131], v[176:179], v[232:235], v[128:131]
    ds_read_b128 v[216:219], v250 offset:26624
    ds_read_b128 v[220:223], v250 offset:37888
    v_mfma_f32_16x16x32_bf16 v[132:135], v[180:183], v[232:235], v[132:135]
    v_mfma_f32_16x16x32_bf16 v[136:139], v[208:211], v[232:235], v[136:139]
    v_mfma_f32_16x16x32_bf16 v[140:143], v[212:215], v[232:235], v[140:143]
    v_mfma_f32_16x16x32_bf16 v[128:131], v[184:187], v[236:239], v[128:131]
    v_mfma_f32_16x16x32_bf16 v[132:135], v[188:191], v[236:239], v[132:135]
    v_mfma_f32_16x16x32_bf16 v[136:139], v[176:179], v[236:239], v[136:139]
    v_mfma_f32_16x16x32_bf16 v[140:143], v[180:183], v[236:239], v[140:143]
    s_waitcnt lgkmcnt(6)
    v_mfma_f32_16x16x32_bf16 v[144:147], v[176:179], v[240:243], v[144:147]
    v_add_u32 v250, 0x9800, v250
    ds_read_b128 v[224:227], v250 offset:16384
    ds_read_b128 v[228:231], v250 offset:27648
    v_mfma_f32_16x16x32_bf16 v[148:151], v[180:183], v[240:243], v[148:151]
    v_mfma_f32_16x16x32_bf16 v[152:155], v[208:211], v[240:243], v[152:155]
    v_mfma_f32_16x16x32_bf16 v[156:159], v[212:215], v[240:243], v[156:159]
    v_mfma_f32_16x16x32_bf16 v[144:147], v[184:187], v[244:247], v[144:147]
    s_waitcnt lgkmcnt(4)
    v_xor_b32 v212, 0x80008000, v204
    v_xor_b32 v213, 0x80008000, v205
    v_mfma_f32_16x16x32_bf16 v[148:151], v[188:191], v[244:247], v[148:151]
    v_xor_b32 v214, 0x80008000, v206
    v_xor_b32 v215, 0x80008000, v207
    v_mfma_f32_16x16x32_bf16 v[152:155], v[176:179], v[244:247], v[152:155]
    v_mfma_f32_16x16x32_bf16 v[156:159], v[180:183], v[244:247], v[156:159]
    s_waitcnt lgkmcnt(2)
    v_mfma_f32_16x16x32_bf16 v[160:163], v[176:179], v[216:219], v[160:163]
    ds_read_b128 v[232:235], v250 offset:17408
    ds_read_b128 v[236:239], v250 offset:28672
    v_mfma_f32_16x16x32_bf16 v[164:167], v[208:211], v[216:219], v[164:167]
    v_xor_b32 v208, 0x80008000, v200
    v_xor_b32 v209, 0x80008000, v201
    v_mfma_f32_16x16x32_bf16 v[160:163], v[184:187], v[220:223], v[160:163]
    v_xor_b32 v210, 0x80008000, v202
    v_xor_b32 v211, 0x80008000, v203
    v_mfma_f32_16x16x32_bf16 v[164:167], v[176:179], v[220:223], v[164:167]
    s_barrier
    s_waitcnt lgkmcnt(2)
    v_mfma_f32_16x16x32_bf16 v[0:3], v[192:195], v[224:227], v[0:3]
    ds_read_b128 v[240:243], v250 offset:18432
    ds_read_b128 v[244:247], v250 offset:29696
    v_mfma_f32_16x16x32_bf16 v[4:7], v[196:199], v[224:227], v[4:7]
    v_mfma_f32_16x16x32_bf16 v[8:11], v[208:211], v[224:227], v[8:11]
    v_mfma_f32_16x16x32_bf16 v[12:15], v[212:215], v[224:227], v[12:15]
    v_mfma_f32_16x16x32_bf16 v[0:3], v[200:203], v[228:231], v[0:3]
    v_mfma_f32_16x16x32_bf16 v[4:7], v[204:207], v[228:231], v[4:7]
    v_mfma_f32_16x16x32_bf16 v[8:11], v[192:195], v[228:231], v[8:11]
    v_mfma_f32_16x16x32_bf16 v[12:15], v[196:199], v[228:231], v[12:15]
    s_waitcnt lgkmcnt(2)
    v_mfma_f32_16x16x32_bf16 v[16:19], v[192:195], v[232:235], v[16:19]
    ds_read_b128 v[216:219], v250 offset:19456
    ds_read_b128 v[220:223], v250 offset:30720
    v_mfma_f32_16x16x32_bf16 v[20:23], v[196:199], v[232:235], v[20:23]
    v_mfma_f32_16x16x32_bf16 v[24:27], v[208:211], v[232:235], v[24:27]
    v_mfma_f32_16x16x32_bf16 v[28:31], v[212:215], v[232:235], v[28:31]
    v_mfma_f32_16x16x32_bf16 v[16:19], v[200:203], v[236:239], v[16:19]
    v_mfma_f32_16x16x32_bf16 v[20:23], v[204:207], v[236:239], v[20:23]
    v_mfma_f32_16x16x32_bf16 v[24:27], v[192:195], v[236:239], v[24:27]
    v_mfma_f32_16x16x32_bf16 v[28:31], v[196:199], v[236:239], v[28:31]
    s_waitcnt lgkmcnt(2)
    v_mfma_f32_16x16x32_bf16 v[32:35], v[192:195], v[240:243], v[32:35]
    ds_read_b128 v[224:227], v250 offset:20480
    ds_read_b128 v[228:231], v250 offset:31744
    v_mfma_f32_16x16x32_bf16 v[36:39], v[196:199], v[240:243], v[36:39]
    v_mfma_f32_16x16x32_bf16 v[40:43], v[208:211], v[240:243], v[40:43]
    v_mfma_f32_16x16x32_bf16 v[44:47], v[212:215], v[240:243], v[44:47]
    v_mfma_f32_16x16x32_bf16 v[32:35], v[200:203], v[244:247], v[32:35]
    v_mfma_f32_16x16x32_bf16 v[36:39], v[204:207], v[244:247], v[36:39]
    v_mfma_f32_16x16x32_bf16 v[40:43], v[192:195], v[244:247], v[40:43]
    v_mfma_f32_16x16x32_bf16 v[44:47], v[196:199], v[244:247], v[44:47]
    s_waitcnt lgkmcnt(2)
    v_mfma_f32_16x16x32_bf16 v[48:51], v[192:195], v[216:219], v[48:51]
    ds_read_b128 v[232:235], v250 offset:21504
    ds_read_b128 v[236:239], v250 offset:32768
    v_mfma_f32_16x16x32_bf16 v[52:55], v[196:199], v[216:219], v[52:55]
    v_mfma_f32_16x16x32_bf16 v[56:59], v[208:211], v[216:219], v[56:59]
    v_mfma_f32_16x16x32_bf16 v[60:63], v[212:215], v[216:219], v[60:63]
    v_mfma_f32_16x16x32_bf16 v[48:51], v[200:203], v[220:223], v[48:51]
    v_mfma_f32_16x16x32_bf16 v[52:55], v[204:207], v[220:223], v[52:55]
    v_mfma_f32_16x16x32_bf16 v[56:59], v[192:195], v[220:223], v[56:59]
    v_mfma_f32_16x16x32_bf16 v[60:63], v[196:199], v[220:223], v[60:63]
    s_waitcnt lgkmcnt(2)
    v_mfma_f32_16x16x32_bf16 v[64:67], v[192:195], v[224:227], v[64:67]
    ds_read_b128 v[240:243], v250 offset:22528
    ds_read_b128 v[244:247], v250 offset:33792
    v_mfma_f32_16x16x32_bf16 v[68:71], v[196:199], v[224:227], v[68:71]
    v_mfma_f32_16x16x32_bf16 v[72:75], v[208:211], v[224:227], v[72:75]
    v_mfma_f32_16x16x32_bf16 v[76:79], v[212:215], v[224:227], v[76:79]
    v_mfma_f32_16x16x32_bf16 v[64:67], v[200:203], v[228:231], v[64:67]
    v_mfma_f32_16x16x32_bf16 v[68:71], v[204:207], v[228:231], v[68:71]
    v_mfma_f32_16x16x32_bf16 v[72:75], v[192:195], v[228:231], v[72:75]
    v_mfma_f32_16x16x32_bf16 v[76:79], v[196:199], v[228:231], v[76:79]
    s_waitcnt lgkmcnt(2)
    v_mfma_f32_16x16x32_bf16 v[80:83], v[192:195], v[232:235], v[80:83]
    ds_read_b128 v[216:219], v250 offset:23552
    ds_read_b128 v[220:223], v250 offset:34816
    v_mfma_f32_16x16x32_bf16 v[84:87], v[196:199], v[232:235], v[84:87]
    v_mfma_f32_16x16x32_bf16 v[88:91], v[208:211], v[232:235], v[88:91]
    v_mfma_f32_16x16x32_bf16 v[92:95], v[212:215], v[232:235], v[92:95]
    v_mfma_f32_16x16x32_bf16 v[80:83], v[200:203], v[236:239], v[80:83]
    v_add_u32 v248, 0xfffe3800, v248
    v_add_u32 v249, 0xfffe3800, v249
    v_mfma_f32_16x16x32_bf16 v[84:87], v[204:207], v[236:239], v[84:87]
    v_mfma_f32_16x16x32_bf16 v[88:91], v[192:195], v[236:239], v[88:91]
    v_mfma_f32_16x16x32_bf16 v[92:95], v[196:199], v[236:239], v[92:95]
    s_waitcnt lgkmcnt(2)
    v_mfma_f32_16x16x32_bf16 v[96:99], v[192:195], v[240:243], v[96:99]
    ds_read_b128 v[224:227], v250 offset:24576
    ds_read_b128 v[228:231], v250 offset:35840
    v_mfma_f32_16x16x32_bf16 v[100:103], v[196:199], v[240:243], v[100:103]
    v_mfma_f32_16x16x32_bf16 v[104:107], v[208:211], v[240:243], v[104:107]
    v_mfma_f32_16x16x32_bf16 v[108:111], v[212:215], v[240:243], v[108:111]
    ds_read_b64_tr_b16 v[176:177], v248 offset:0
    ds_read_b64_tr_b16 v[178:179], v248 offset:1024
    ds_read_b64_tr_b16 v[180:181], v249 offset:0
    ds_read_b64_tr_b16 v[182:183], v249 offset:1024
    v_mfma_f32_16x16x32_bf16 v[96:99], v[200:203], v[244:247], v[96:99]
    v_mfma_f32_16x16x32_bf16 v[100:103], v[204:207], v[244:247], v[100:103]
    v_mfma_f32_16x16x32_bf16 v[104:107], v[192:195], v[244:247], v[104:107]
    v_mfma_f32_16x16x32_bf16 v[108:111], v[196:199], v[244:247], v[108:111]
    s_waitcnt lgkmcnt(6)
    v_mfma_f32_16x16x32_bf16 v[112:115], v[192:195], v[216:219], v[112:115]
    ds_read_b128 v[232:235], v250 offset:25600
    ds_read_b128 v[236:239], v250 offset:36864
    v_mfma_f32_16x16x32_bf16 v[116:119], v[196:199], v[216:219], v[116:119]
    v_mfma_f32_16x16x32_bf16 v[120:123], v[208:211], v[216:219], v[120:123]
    v_mfma_f32_16x16x32_bf16 v[124:127], v[212:215], v[216:219], v[124:127]
    ds_read_b64_tr_b16 v[184:185], v248 offset:8192
    ds_read_b64_tr_b16 v[186:187], v248 offset:9216
    ds_read_b64_tr_b16 v[188:189], v249 offset:8192
    ds_read_b64_tr_b16 v[190:191], v249 offset:9216
    v_mfma_f32_16x16x32_bf16 v[112:115], v[200:203], v[220:223], v[112:115]
    v_mfma_f32_16x16x32_bf16 v[116:119], v[204:207], v[220:223], v[116:119]
    v_mfma_f32_16x16x32_bf16 v[120:123], v[192:195], v[220:223], v[120:123]
    v_mfma_f32_16x16x32_bf16 v[124:127], v[196:199], v[220:223], v[124:127]
    s_waitcnt lgkmcnt(10)
    v_mfma_f32_16x16x32_bf16 v[128:131], v[192:195], v[224:227], v[128:131]
    ds_read_b128 v[240:243], v250 offset:26624
    ds_read_b128 v[244:247], v250 offset:37888
    v_mfma_f32_16x16x32_bf16 v[132:135], v[196:199], v[224:227], v[132:135]
    v_mfma_f32_16x16x32_bf16 v[136:139], v[208:211], v[224:227], v[136:139]
    v_mfma_f32_16x16x32_bf16 v[140:143], v[212:215], v[224:227], v[140:143]
    v_mfma_f32_16x16x32_bf16 v[128:131], v[200:203], v[228:231], v[128:131]
    v_mfma_f32_16x16x32_bf16 v[132:135], v[204:207], v[228:231], v[132:135]
    v_mfma_f32_16x16x32_bf16 v[136:139], v[192:195], v[228:231], v[136:139]
    v_mfma_f32_16x16x32_bf16 v[140:143], v[196:199], v[228:231], v[140:143]
    s_waitcnt lgkmcnt(6)
    v_mfma_f32_16x16x32_bf16 v[144:147], v[192:195], v[232:235], v[144:147]
    v_add_u32 v250, 0xfffe3800, v250
    ds_read_b128 v[216:219], v250 offset:16384
    ds_read_b128 v[220:223], v250 offset:27648
    v_mfma_f32_16x16x32_bf16 v[148:151], v[196:199], v[232:235], v[148:151]
    v_mfma_f32_16x16x32_bf16 v[152:155], v[208:211], v[232:235], v[152:155]
    v_mfma_f32_16x16x32_bf16 v[156:159], v[212:215], v[232:235], v[156:159]
    v_mfma_f32_16x16x32_bf16 v[144:147], v[200:203], v[236:239], v[144:147]
    s_waitcnt lgkmcnt(4)
    v_xor_b32 v212, 0x80008000, v188
    v_xor_b32 v213, 0x80008000, v189
    v_mfma_f32_16x16x32_bf16 v[148:151], v[204:207], v[236:239], v[148:151]
    v_xor_b32 v214, 0x80008000, v190
    v_xor_b32 v215, 0x80008000, v191
    v_mfma_f32_16x16x32_bf16 v[152:155], v[192:195], v[236:239], v[152:155]
    v_mfma_f32_16x16x32_bf16 v[156:159], v[196:199], v[236:239], v[156:159]
    s_waitcnt lgkmcnt(2)
    v_mfma_f32_16x16x32_bf16 v[160:163], v[192:195], v[240:243], v[160:163]
    ds_read_b128 v[224:227], v250 offset:17408
    ds_read_b128 v[228:231], v250 offset:28672
    v_mfma_f32_16x16x32_bf16 v[164:167], v[208:211], v[240:243], v[164:167]
    v_xor_b32 v208, 0x80008000, v184
    v_xor_b32 v209, 0x80008000, v185
    v_mfma_f32_16x16x32_bf16 v[160:163], v[200:203], v[244:247], v[160:163]
    v_xor_b32 v210, 0x80008000, v186
    v_xor_b32 v211, 0x80008000, v187
    v_mfma_f32_16x16x32_bf16 v[164:167], v[192:195], v[244:247], v[164:167]
    s_sub_u32 s46, s46, 1
    s_cmp_lg_u32 s46, 0
    s_cbranch_scc1 L_g_loop
    s_barrier
    s_waitcnt lgkmcnt(2)
    v_mfma_f32_16x16x32_bf16 v[0:3], v[176:179], v[216:219], v[0:3]
    ds_read_b128 v[232:235], v250 offset:18432
    ds_read_b128 v[236:239], v250 offset:29696
    v_mfma_f32_16x16x32_bf16 v[4:7], v[180:183], v[216:219], v[4:7]
    v_mfma_f32_16x16x32_bf16 v[8:11], v[208:211], v[216:219], v[8:11]
    v_mfma_f32_16x16x32_bf16 v[12:15], v[212:215], v[216:219], v[12:15]
    v_mfma_f32_16x16x32_bf16 v[0:3], v[184:187], v[220:223], v[0:3]
    v_mfma_f32_16x16x32_bf16 v[4:7], v[188:191], v[220:223], v[4:7]
    v_mfma_f32_16x16x32_bf16 v[8:11], v[176:179], v[220:223], v[8:11]
    v_mfma_f32_16x16x32_bf16 v[12:15], v[180:183], v[220:223], v[12:15]
    s_waitcnt lgkmcnt(2)
    v_mfma_f32_16x16x32_bf16 v[16:19], v[176:179], v[224:227], v[16:19]
    ds_read_b128 v[240:243], v250 offset:19456
    ds_read_b128 v[244:247], v250 offset:30720
    v_mfma_f32_16x16x32_bf16 v[20:23], v[180:183], v[224:227], v[20:23]
    v_mfma_f32_16x16x32_bf16 v[24:27], v[208:211], v[224:227], v[24:27]
    v_mfma_f32_16x16x32_bf16 v[28:31], v[212:215], v[224:227], v[28:31]
    v_mfma_f32_16x16x32_bf16 v[16:19], v[184:187], v[228:231], v[16:19]
    v_mfma_f32_16x16x32_bf16 v[20:23], v[188:191], v[228:231], v[20:23]
    v_mfma_f32_16x16x32_bf16 v[24:27], v[176:179], v[228:231], v[24:27]
    v_mfma_f32_16x16x32_bf16 v[28:31], v[180:183], v[228:231], v[28:31]
    s_waitcnt lgkmcnt(2)
    v_mfma_f32_16x16x32_bf16 v[32:35], v[176:179], v[232:235], v[32:35]
    ds_read_b128 v[216:219], v250 offset:20480
    ds_read_b128 v[220:223], v250 offset:31744
    v_mfma_f32_16x16x32_bf16 v[36:39], v[180:183], v[232:235], v[36:39]
    v_mfma_f32_16x16x32_bf16 v[40:43], v[208:211], v[232:235], v[40:43]
    v_mfma_f32_16x16x32_bf16 v[44:47], v[212:215], v[232:235], v[44:47]
    v_mfma_f32_16x16x32_bf16 v[32:35], v[184:187], v[236:239], v[32:35]
    v_mfma_f32_16x16x32_bf16 v[36:39], v[188:191], v[236:239], v[36:39]
    v_mfma_f32_16x16x32_bf16 v[40:43], v[176:179], v[236:239], v[40:43]
    v_mfma_f32_16x16x32_bf16 v[44:47], v[180:183], v[236:239], v[44:47]
    s_waitcnt lgkmcnt(2)
    v_mfma_f32_16x16x32_bf16 v[48:51], v[176:179], v[240:243], v[48:51]
    ds_read_b128 v[224:227], v250 offset:21504
    ds_read_b128 v[228:231], v250 offset:32768
    v_mfma_f32_16x16x32_bf16 v[52:55], v[180:183], v[240:243], v[52:55]
    v_mfma_f32_16x16x32_bf16 v[56:59], v[208:211], v[240:243], v[56:59]
    v_mfma_f32_16x16x32_bf16 v[60:63], v[212:215], v[240:243], v[60:63]
    v_mfma_f32_16x16x32_bf16 v[48:51], v[184:187], v[244:247], v[48:51]
    v_mfma_f32_16x16x32_bf16 v[52:55], v[188:191], v[244:247], v[52:55]
    v_mfma_f32_16x16x32_bf16 v[56:59], v[176:179], v[244:247], v[56:59]
    v_mfma_f32_16x16x32_bf16 v[60:63], v[180:183], v[244:247], v[60:63]
    s_waitcnt lgkmcnt(2)
    v_mfma_f32_16x16x32_bf16 v[64:67], v[176:179], v[216:219], v[64:67]
    ds_read_b128 v[232:235], v250 offset:22528
    ds_read_b128 v[236:239], v250 offset:33792
    v_mfma_f32_16x16x32_bf16 v[68:71], v[180:183], v[216:219], v[68:71]
    v_mfma_f32_16x16x32_bf16 v[72:75], v[208:211], v[216:219], v[72:75]
    v_mfma_f32_16x16x32_bf16 v[76:79], v[212:215], v[216:219], v[76:79]
    v_mfma_f32_16x16x32_bf16 v[64:67], v[184:187], v[220:223], v[64:67]
    v_mfma_f32_16x16x32_bf16 v[68:71], v[188:191], v[220:223], v[68:71]
    v_mfma_f32_16x16x32_bf16 v[72:75], v[176:179], v[220:223], v[72:75]
    v_mfma_f32_16x16x32_bf16 v[76:79], v[180:183], v[220:223], v[76:79]
    s_waitcnt lgkmcnt(2)
    v_mfma_f32_16x16x32_bf16 v[80:83], v[176:179], v[224:227], v[80:83]
    ds_read_b128 v[240:243], v250 offset:23552
    ds_read_b128 v[244:247], v250 offset:34816
    v_mfma_f32_16x16x32_bf16 v[84:87], v[180:183], v[224:227], v[84:87]
    v_mfma_f32_16x16x32_bf16 v[88:91], v[208:211], v[224:227], v[88:91]
    v_mfma_f32_16x16x32_bf16 v[92:95], v[212:215], v[224:227], v[92:95]
    v_mfma_f32_16x16x32_bf16 v[80:83], v[184:187], v[228:231], v[80:83]
    v_add_u32 v248, 0x9800, v248
    v_add_u32 v249, 0x9800, v249
    v_mfma_f32_16x16x32_bf16 v[84:87], v[188:191], v[228:231], v[84:87]
    v_mfma_f32_16x16x32_bf16 v[88:91], v[176:179], v[228:231], v[88:91]
    v_mfma_f32_16x16x32_bf16 v[92:95], v[180:183], v[228:231], v[92:95]
    s_waitcnt lgkmcnt(2)
    v_mfma_f32_16x16x32_bf16 v[96:99], v[176:179], v[232:235], v[96:99]
    ds_read_b128 v[216:219], v250 offset:24576
    ds_read_b128 v[220:223], v250 offset:35840
    v_mfma_f32_16x16x32_bf16 v[100:103], v[180:183], v[232:235], v[100:103]
    v_mfma_f32_16x16x32_bf16 v[104:107], v[208:211], v[232:235], v[104:107]
    v_mfma_f32_16x16x32_bf16 v[108:111], v[212:215], v[232:235], v[108:111]
    ds_read_b64_tr_b16 v[192:193], v248 offset:0
    ds_read_b64_tr_b16 v[194:195], v248 offset:1024
    ds_read_b64_tr_b16 v[196:197], v249 offset:0
    ds_read_b64_tr_b16 v[198:199], v249 offset:1024
    v_mfma_f32_16x16x32_bf16 v[96:99], v[184:187], v[236:239], v[96:99]
    v_mfma_f32_16x16x32_bf16 v[100:103], v[188:191], v[236:239], v[100:103]
    v_mfma_f32_16x16x32_bf16 v[104:107], v[176:179], v[236:239], v[104:107]
    v_mfma_f32_16x16x32_bf16 v[108:111], v[180:183], v[236:239], v[108:111]
    s_waitcnt lgkmcnt(6)
    v_mfma_f32_16x16x32_bf16 v[112:115], v[176:179], v[240:243], v[112:115]
    ds_read_b128 v[224:227], v250 offset:25600
    ds_read_b128 v[228:231], v250 offset:36864
    v_mfma_f32_16x16x32_bf16 v[116:119], v[180:183], v[240:243], v[116:119]
    v_mfma_f32_16x16x32_bf16 v[120:123], v[208:211], v[240:243], v[120:123]
    v_mfma_f32_16x16x32_bf16 v[124:127], v[212:215], v[240:243], v[124:127]
    ds_read_b64_tr_b16 v[200:201], v248 offset:8192
    ds_read_b64_tr_b16 v[202:203], v248 offset:9216
    ds_read_b64_tr_b16 v[204:205], v249 offset:8192
    ds_read_b64_tr_b16 v[206:207], v249 offset:9216
    v_mfma_f32_16x16x32_bf16 v[112:115], v[184:187], v[244:247], v[112:115]
    v_mfma_f32_16x16x32_bf16 v[116:119], v[188:191], v[244:247], v[116:119]
    v_mfma_f32_16x16x32_bf16 v[120:123], v[176:179], v[244:247], v[120:123]
    v_mfma_f32_16x16x32_bf16 v[124:127], v[180:183], v[244:247], v[124:127]
    s_waitcnt lgkmcnt(10)
    v_mfma_f32_16x16x32_bf16 v[128:131], v[176:179], v[216:219], v[128:131]
    ds_read_b128 v[232:235], v250 offset:26624
    ds_read_b128 v[236:239], v250 offset:37888
    v_mfma_f32_16x16x32_bf16 v[132:135], v[180:183], v[216:219], v[132:135]
    v_mfma_f32_16x16x32_bf16 v[136:139], v[208:211], v[216:219], v[136:139]
    v_mfma_f32_16x16x32_bf16 v[140:143], v[212:215], v[216:219], v[140:143]
    v_mfma_f32_16x16x32_bf16 v[128:131], v[184:187], v[220:223], v[128:131]
    v_mfma_f32_16x16x32_bf16 v[132:135], v[188:191], v[220:223], v[132:135]
    v_mfma_f32_16x16x32_bf16 v[136:139], v[176:179], v[220:223], v[136:139]
    v_mfma_f32_16x16x32_bf16 v[140:143], v[180:183], v[220:223], v[140:143]
    s_waitcnt lgkmcnt(6)
    v_mfma_f32_16x16x32_bf16 v[144:147], v[176:179], v[224:227], v[144:147]
    v_add_u32 v250, 0x9800, v250
    ds_read_b128 v[240:243], v250 offset:16384
    ds_read_b128 v[244:247], v250 offset:27648
    v_mfma_f32_16x16x32_bf16 v[148:151], v[180:183], v[224:227], v[148:151]
    v_mfma_f32_16x16x32_bf16 v[152:155], v[208:211], v[224:227], v[152:155]
    v_mfma_f32_16x16x32_bf16 v[156:159], v[212:215], v[224:227], v[156:159]
    v_mfma_f32_16x16x32_bf16 v[144:147], v[184:187], v[228:231], v[144:147]
    s_waitcnt lgkmcnt(4)
    v_xor_b32 v212, 0x80008000, v204
    v_xor_b32 v213, 0x80008000, v205
    v_mfma_f32_16x16x32_bf16 v[148:151], v[188:191], v[228:231], v[148:151]
    v_xor_b32 v214, 0x80008000, v206
    v_xor_b32 v215, 0x80008000, v207
    v_mfma_f32_16x16x32_bf16 v[152:155], v[176:179], v[228:231], v[152:155]
    v_mfma_f32_16x16x32_bf16 v[156:159], v[180:183], v[228:231], v[156:159]
    s_waitcnt lgkmcnt(2)
    v_mfma_f32_16x16x32_bf16 v[160:163], v[176:179], v[232:235], v[160:163]
    ds_read_b128 v[216:219], v250 offset:17408
    ds_read_b128 v[220:223], v250 offset:28672
    v_mfma_f32_16x16x32_bf16 v[164:167], v[208:211], v[232:235], v[164:167]
    v_xor_b32 v208, 0x80008000, v200
    v_xor_b32 v209, 0x80008000, v201
    v_mfma_f32_16x16x32_bf16 v[160:163], v[184:187], v[236:239], v[160:163]
    v_xor_b32 v210, 0x80008000, v202
    v_xor_b32 v211, 0x80008000, v203
    v_mfma_f32_16x16x32_bf16 v[164:167], v[176:179], v[236:239], v[164:167]
    s_barrier
    s_waitcnt lgkmcnt(2)
    v_mfma_f32_16x16x32_bf16 v[0:3], v[192:195], v[240:243], v[0:3]
    ds_read_b128 v[224:227], v250 offset:18432
    ds_read_b128 v[228:231], v250 offset:29696
    v_mfma_f32_16x16x32_bf16 v[4:7], v[196:199], v[240:243], v[4:7]
    v_mfma_f32_16x16x32_bf16 v[8:11], v[208:211], v[240:243], v[8:11]
    v_mfma_f32_16x16x32_bf16 v[12:15], v[212:215], v[240:243], v[12:15]
    v_mfma_f32_16x16x32_bf16 v[0:3], v[200:203], v[244:247], v[0:3]
    v_mfma_f32_16x16x32_bf16 v[4:7], v[204:207], v[244:247], v[4:7]
    v_mfma_f32_16x16x32_bf16 v[8:11], v[192:195], v[244:247], v[8:11]
    v_mfma_f32_16x16x32_bf16 v[12:15], v[196:199], v[244:247], v[12:15]
    s_waitcnt lgkmcnt(2)
    v_mfma_f32_16x16x32_bf16 v[16:19], v[192:195], v[216:219], v[16:19]
    ds_read_b128 v[232:235], v250 offset:19456
    ds_read_b128 v[236:239], v250 offset:30720
    v_mfma_f32_16x16x32_bf16 v[20:23], v[196:199], v[216:219], v[20:23]
    v_mfma_f32_16x16x32_bf16 v[24:27], v[208:211], v[216:219], v[24:27]
    v_mfma_f32_16x16x32_bf16 v[28:31], v[212:215], v[216:219], v[28:31]
    v_mfma_f32_16x16x32_bf16 v[16:19], v[200:203], v[220:223], v[16:19]
    v_mfma_f32_16x16x32_bf16 v[20:23], v[204:207], v[220:223], v[20:23]
    v_mfma_f32_16x16x32_bf16 v[24:27], v[192:195], v[220:223], v[24:27]
    v_mfma_f32_16x16x32_bf16 v[28:31], v[196:199], v[220:223], v[28:31]
    s_waitcnt lgkmcnt(2)
    v_mfma_f32_16x16x32_bf16 v[32:35], v[192:195], v[224:227], v[32:35]
    ds_read_b128 v[240:243], v250 offset:20480
    ds_read_b128 v[244:247], v250 offset:31744
    v_mfma_f32_16x16x32_bf16 v[36:39], v[196:199], v[224:227], v[36:39]
    v_mfma_f32_16x16x32_bf16 v[40:43], v[208:211], v[224:227], v[40:43]
    v_mfma_f32_16x16x32_bf16 v[44:47], v[212:215], v[224:227], v[44:47]
    v_mfma_f32_16x16x32_bf16 v[32:35], v[200:203], v[228:231], v[32:35]
    v_mfma_f32_16x16x32_bf16 v[36:39], v[204:207], v[228:231], v[36:39]
    v_mfma_f32_16x16x32_bf16 v[40:43], v[192:195], v[228:231], v[40:43]
    v_mfma_f32_16x16x32_bf16 v[44:47], v[196:199], v[228:231], v[44:47]
    s_waitcnt lgkmcnt(2)
    v_mfma_f32_16x16x32_bf16 v[48:51], v[192:195], v[232:235], v[48:51]
    ds_read_b128 v[216:219], v250 offset:21504
    ds_read_b128 v[220:223], v250 offset:32768
    v_mfma_f32_16x16x32_bf16 v[52:55], v[196:199], v[232:235], v[52:55]
    v_mfma_f32_16x16x32_bf16 v[56:59], v[208:211], v[232:235], v[56:59]
    v_mfma_f32_16x16x32_bf16 v[60:63], v[212:215], v[232:235], v[60:63]
    v_mfma_f32_16x16x32_bf16 v[48:51], v[200:203], v[236:239], v[48:51]
    v_mfma_f32_16x16x32_bf16 v[52:55], v[204:207], v[236:239], v[52:55]
    v_mfma_f32_16x16x32_bf16 v[56:59], v[192:195], v[236:239], v[56:59]
    v_mfma_f32_16x16x32_bf16 v[60:63], v[196:199], v[236:239], v[60:63]
    s_waitcnt lgkmcnt(2)
    v_mfma_f32_16x16x32_bf16 v[64:67], v[192:195], v[240:243], v[64:67]
    ds_read_b128 v[224:227], v250 offset:22528
    ds_read_b128 v[228:231], v250 offset:33792
    v_mfma_f32_16x16x32_bf16 v[68:71], v[196:199], v[240:243], v[68:71]
    v_mfma_f32_16x16x32_bf16 v[72:75], v[208:211], v[240:243], v[72:75]
    v_mfma_f32_16x16x32_bf16 v[76:79], v[212:215], v[240:243], v[76:79]
    v_mfma_f32_16x16x32_bf16 v[64:67], v[200:203], v[244:247], v[64:67]
    v_mfma_f32_16x16x32_bf16 v[68:71], v[204:207], v[244:247], v[68:71]
    v_mfma_f32_16x16x32_bf16 v[72:75], v[192:195], v[244:247], v[72:75]
    v_mfma_f32_16x16x32_bf16 v[76:79], v[196:199], v[244:247], v[76:79]
    s_waitcnt lgkmcnt(2)
    v_mfma_f32_16x16x32_bf16 v[80:83], v[192:195], v[216:219], v[80:83]
    ds_read_b128 v[232:235], v250 offset:23552
    ds_read_b128 v[236:239], v250 offset:34816
    v_mfma_f32_16x16x32_bf16 v[84:87], v[196:199], v[216:219], v[84:87]
    v_mfma_f32_16x16x32_bf16 v[88:91], v[208:211], v[216:219], v[88:91]
    v_mfma_f32_16x16x32_bf16 v[92:95], v[212:215], v[216:219], v[92:95]
    v_mfma_f32_16x16x32_bf16 v[80:83], v[200:203], v[220:223], v[80:83]
    v_add_u32 v248, 0x9800, v248
    v_add_u32 v249, 0x9800, v249
    v_mfma_f32_16x16x32_bf16 v[84:87], v[204:207], v[220:223], v[84:87]
    v_mfma_f32_16x16x32_bf16 v[88:91], v[192:195], v[220:223], v[88:91]
    v_mfma_f32_16x16x32_bf16 v[92:95], v[196:199], v[220:223], v[92:95]
    s_waitcnt lgkmcnt(2)
    v_mfma_f32_16x16x32_bf16 v[96:99], v[192:195], v[224:227], v[96:99]
    ds_read_b128 v[240:243], v250 offset:24576
    ds_read_b128 v[244:247], v250 offset:35840
    v_mfma_f32_16x16x32_bf16 v[100:103], v[196:199], v[224:227], v[100:103]
    v_mfma_f32_16x16x32_bf16 v[104:107], v[208:211], v[224:227], v[104:107]
    v_mfma_f32_16x16x32_bf16 v[108:111], v[212:215], v[224:227], v[108:111]
    ds_read_b64_tr_b16 v[176:177], v248 offset:0
    ds_read_b64_tr_b16 v[178:179], v248 offset:1024
    ds_read_b64_tr_b16 v[180:181], v249 offset:0
    ds_read_b64_tr_b16 v[182:183], v249 offset:1024
    v_mfma_f32_16x16x32_bf16 v[96:99], v[200:203], v[228:231], v[96:99]
    v_mfma_f32_16x16x32_bf16 v[100:103], v[204:207], v[228:231], v[100:103]
    v_mfma_f32_16x16x32_bf16 v[104:107], v[192:195], v[228:231], v[104:107]
    v_mfma_f32_16x16x32_bf16 v[108:111], v[196:199], v[228:231], v[108:111]
    s_waitcnt lgkmcnt(6)
    v_mfma_f32_16x16x32_bf16 v[112:115], v[192:195], v[232:235], v[112:115]
    ds_read_b128 v[216:219], v250 offset:25600
    ds_read_b128 v[220:223], v250 offset:36864
    v_mfma_f32_16x16x32_bf16 v[116:119], v[196:199], v[232:235], v[116:119]
    v_mfma_f32_16x16x32_bf16 v[120:123], v[208:211], v[232:235], v[120:123]
    v_mfma_f32_16x16x32_bf16 v[124:127], v[212:215], v[232:235], v[124:127]
    ds_read_b64_tr_b16 v[184:185], v248 offset:8192
    ds_read_b64_tr_b16 v[186:187], v248 offset:9216
    ds_read_b64_tr_b16 v[188:189], v249 offset:8192
    ds_read_b64_tr_b16 v[190:191], v249 offset:9216
    v_mfma_f32_16x16x32_bf16 v[112:115], v[200:203], v[236:239], v[112:115]
    v_mfma_f32_16x16x32_bf16 v[116:119], v[204:207], v[236:239], v[116:119]
    v_mfma_f32_16x16x32_bf16 v[120:123], v[192:195], v[236:239], v[120:123]
    v_mfma_f32_16x16x32_bf16 v[124:127], v[196:199], v[236:239], v[124:127]
    s_waitcnt lgkmcnt(10)
    v_mfma_f32_16x16x32_bf16 v[128:131], v[192:195], v[240:243], v[128:131]
    ds_read_b128 v[224:227], v250 offset:26624
    ds_read_b128 v[228:231], v250 offset:37888
    v_mfma_f32_16x16x32_bf16 v[132:135], v[196:199], v[240:243], v[132:135]
    v_mfma_f32_16x16x32_bf16 v[136:139], v[208:211], v[240:243], v[136:139]
    v_mfma_f32_16x16x32_bf16 v[140:143], v[212:215], v[240:243], v[140:143]
    v_mfma_f32_16x16x32_bf16 v[128:131], v[200:203], v[244:247], v[128:131]
    v_mfma_f32_16x16x32_bf16 v[132:135], v[204:207], v[244:247], v[132:135]
    v_mfma_f32_16x16x32_bf16 v[136:139], v[192:195], v[244:247], v[136:139]
    v_mfma_f32_16x16x32_bf16 v[140:143], v[196:199], v[244:247], v[140:143]
    s_waitcnt lgkmcnt(6)
    v_mfma_f32_16x16x32_bf16 v[144:147], v[192:195], v[216:219], v[144:147]
    v_add_u32 v250, 0x9800, v250
    ds_read_b128 v[232:235], v250 offset:16384
    ds_read_b128 v[236:239], v250 offset:27648
    v_mfma_f32_16x16x32_bf16 v[148:151], v[196:199], v[216:219], v[148:151]
    v_mfma_f32_16x16x32_bf16 v[152:155], v[208:211], v[216:219], v[152:155]
    v_mfma_f32_16x16x32_bf16 v[156:159], v[212:215], v[216:219], v[156:159]
    v_mfma_f32_16x16x32_bf16 v[144:147], v[200:203], v[220:223], v[144:147]
    s_waitcnt lgkmcnt(4)
    v_xor_b32 v212, 0x80008000, v188
    v_xor_b32 v213, 0x80008000, v189
    v_mfma_f32_16x16x32_bf16 v[148:151], v[204:207], v[220:223], v[148:151]
    v_xor_b32 v214, 0x80008000, v190
    v_xor_b32 v215, 0x80008000, v191
    v_mfma_f32_16x16x32_bf16 v[152:155], v[192:195], v[220:223], v[152:155]
    v_mfma_f32_16x16x32_bf16 v[156:159], v[196:199], v[220:223], v[156:159]
    s_waitcnt lgkmcnt(2)
    v_mfma_f32_16x16x32_bf16 v[160:163], v[192:195], v[224:227], v[160:163]
    ds_read_b128 v[240:243], v250 offset:17408
    ds_read_b128 v[244:247], v250 offset:28672
    v_mfma_f32_16x16x32_bf16 v[164:167], v[208:211], v[224:227], v[164:167]
    v_xor_b32 v208, 0x80008000, v184
    v_xor_b32 v209, 0x80008000, v185
    v_mfma_f32_16x16x32_bf16 v[160:163], v[200:203], v[228:231], v[160:163]
    v_xor_b32 v210, 0x80008000, v186
    v_xor_b32 v211, 0x80008000, v187
    v_mfma_f32_16x16x32_bf16 v[164:167], v[192:195], v[228:231], v[164:167]
    s_barrier
    s_cmp_lg_u32 s13, 0
    s_cbranch_scc1 L_epi_b1
    v_add_u32 v248, 0x9800, v248
    v_add_u32 v249, 0x9800, v249
    v_add_u32 v253, 38912, v250
    ds_read_b64_tr_b16 v[192:193], v248 offset:0
    ds_read_b64_tr_b16 v[194:195], v248 offset:1024
    ds_read_b64_tr_b16 v[196:197], v249 offset:0
    ds_read_b64_tr_b16 v[198:199], v249 offset:1024
    ds_read_b64_tr_b16 v[200:201], v248 offset:8192
    ds_read_b64_tr_b16 v[202:203], v248 offset:9216
    ds_read_b64_tr_b16 v[204:205], v249 offset:8192
    ds_read_b64_tr_b16 v[206:207], v249 offset:9216
    s_waitcnt lgkmcnt(10)
    v_mfma_f32_16x16x32_bf16 v[0:3], v[176:179], v[232:235], v[0:3]
    ds_read_b128 v[216:219], v250 offset:18432
    ds_read_b128 v[220:223], v250 offset:29696
    v_mfma_f32_16x16x32_bf16 v[4:7], v[180:183], v[232:235], v[4:7]
    v_mfma_f32_16x16x32_bf16 v[8:11], v[208:211], v[232:235], v[8:11]
    v_mfma_f32_16x16x32_bf16 v[12:15], v[212:215], v[232:235], v[12:15]
    v_mfma_f32_16x16x32_bf16 v[0:3], v[184:187], v[236:239], v[0:3]
    v_mfma_f32_16x16x32_bf16 v[4:7], v[188:191], v[236:239], v[4:7]
    v_mfma_f32_16x16x32_bf16 v[8:11], v[176:179], v[236:239], v[8:11]
    v_mfma_f32_16x16x32_bf16 v[12:15], v[180:183], v[236:239], v[12:15]
    s_waitcnt lgkmcnt(10)
    v_mfma_f32_16x16x32_bf16 v[16:19], v[176:179], v[240:243], v[16:19]
    ds_read_b128 v[224:227], v253 offset:16384
    ds_read_b128 v[228:231], v253 offset:27648
    v_mfma_f32_16x16x32_bf16 v[20:23], v[180:183], v[240:243], v[20:23]
    v_mfma_f32_16x16x32_bf16 v[24:27], v[208:211], v[240:243], v[24:27]
    v_mfma_f32_16x16x32_bf16 v[28:31], v[212:215], v[240:243], v[28:31]
    v_mfma_f32_16x16x32_bf16 v[16:19], v[184:187], v[244:247], v[16:19]
    v_mfma_f32_16x16x32_bf16 v[20:23], v[188:191], v[244:247], v[20:23]
    v_mfma_f32_16x16x32_bf16 v[24:27], v[176:179], v[244:247], v[24:27]
    v_mfma_f32_16x16x32_bf16 v[28:31], v[180:183], v[244:247], v[28:31]
    s_waitcnt lgkmcnt(2)
    v_mfma_f32_16x16x32_bf16 v[32:35], v[176:179], v[216:219], v[32:35]
    ds_read_b128 v[232:235], v250 offset:19456
    ds_read_b128 v[236:239], v250 offset:30720
    v_mfma_f32_16x16x32_bf16 v[36:39], v[180:183], v[216:219], v[36:39]
    v_mfma_f32_16x16x32_bf16 v[40:43], v[208:211], v[216:219], v[40:43]
    v_mfma_f32_16x16x32_bf16 v[44:47], v[212:215], v[216:219], v[44:47]
    v_mfma_f32_16x16x32_bf16 v[32:35], v[184:187], v[220:223], v[32:35]
    v_mfma_f32_16x16x32_bf16 v[36:39], v[188:191], v[220:223], v[36:39]
    v_mfma_f32_16x16x32_bf16 v[40:43], v[176:179], v[220:223], v[40:43]
    v_mfma_f32_16x16x32_bf16 v[44:47], v[180:183], v[220:223], v[44:47]
    v_xor_b32 v168, 0x80008000, v200
    v_xor_b32 v169, 0x80008000, v201
    v_xor_b32 v170, 0x80008000, v202
    v_xor_b32 v171, 0x80008000, v203
    v_xor_b32 v172, 0x80008000, v204
    v_xor_b32 v173, 0x80008000, v205
    v_xor_b32 v174, 0x80008000, v206
    v_xor_b32 v175, 0x80008000, v207
    s_waitcnt lgkmcnt(2)
    v_mfma_f32_16x16x32_bf16 v[0:3], v[192:195], v[224:227], v[0:3]
    ds_read_b128 v[240:243], v253 offset:17408
    ds_read_b128 v[244:247], v253 offset:28672
    v_mfma_f32_16x16x32_bf16 v[4:7], v[196:199], v[224:227], v[4:7]
    v_mfma_f32_16x16x32_bf16 v[8:11], v[168:171], v[224:227], v[8:11]
    v_mfma_f32_16x16x32_bf16 v[12:15], v[172:175], v[224:227], v[12:15]
    v_mfma_f32_16x16x32_bf16 v[0:3], v[200:203], v[228:231], v[0:3]
    v_mfma_f32_16x16x32_bf16 v[4:7], v[204:207], v[228:231], v[4:7]
    v_mfma_f32_16x16x32_bf16 v[8:11], v[192:195], v[228:231], v[8:11]
    v_mfma_f32_16x16x32_bf16 v[12:15], v[196:199], v[228:231], v[12:15]
    s_waitcnt lgkmcnt(2)
    v_mfma_f32_16x16x32_bf16 v[48:51], v[176:179], v[232:235], v[48:51]
    ds_read_b128 v[216:219], v250 offset:20480
    ds_read_b128 v[220:223], v250 offset:31744
    v_mfma_f32_16x16x32_bf16 v[52:55], v[180:183], v[232:235], v[52:55]
    v_mfma_f32_16x16x32_bf16 v[56:59], v[208:211], v[232:235], v[56:59]
    v_mfma_f32_16x16x32_bf16 v[60:63], v[212:215], v[232:235], v[60:63]
    v_mfma_f32_16x16x32_bf16 v[48:51], v[184:187], v[236:239], v[48:51]
    v_mfma_f32_16x16x32_bf16 v[52:55], v[188:191], v[236:239], v[52:55]
    v_mfma_f32_16x16x32_bf16 v[56:59], v[176:179], v[236:239], v[56:59]
    v_mfma_f32_16x16x32_bf16 v[60:63], v[180:183], v[236:239], v[60:63]
    s_waitcnt lgkmcnt(2)
    v_mfma_f32_16x16x32_bf16 v[16:19], v[192:195], v[240:243], v[16:19]
    ds_read_b128 v[224:227], v253 offset:18432
    ds_read_b128 v[228:231], v253 offset:29696
    v_mfma_f32_16x16x32_bf16 v[20:23], v[196:199], v[240:243], v[20:23]
    v_cvt_pk_bf16_f32 v0, v0, v1
    v_cvt_pk_bf16_f32 v1, v2, v3
    v_mfma_f32_16x16x32_bf16 v[24:27], v[168:171], v[240:243], v[24:27]
    v_cvt_pk_bf16_f32 v2, v4, v5
    v_cvt_pk_bf16_f32 v3, v6, v7
    v_mfma_f32_16x16x32_bf16 v[28:31], v[172:175], v[240:243], v[28:31]
    s_add_u32 s47, s48, 0
    buffer_store_dwordx4 v[0:3], v251, s[16:19], s47 offen sc1
    v_mfma_f32_16x16x32_bf16 v[16:19], v[200:203], v[244:247], v[16:19]
    v_cvt_pk_bf16_f32 v8, v8, v9
    v_cvt_pk_bf16_f32 v9, v10, v11
    v_mfma_f32_16x16x32_bf16 v[20:23], v[204:207], v[244:247], v[20:23]
    v_cvt_pk_bf16_f32 v10, v12, v13
    v_cvt_pk_bf16_f32 v11, v14, v15
    v_mfma_f32_16x16x32_bf16 v[24:27], v[192:195], v[244:247], v[24:27]
    s_add_u32 s47, s48, 11264
    buffer_store_dwordx4 v[8:11], v251, s[16:19], s47 offen sc1
    v_mfma_f32_16x16x32_bf16 v[28:31], v[196:199], v[244:247], v[28:31]
    s_waitcnt lgkmcnt(2)
    v_mfma_f32_16x16x32_bf16 v[64:67], v[176:179], v[216:219], v[64:67]
    ds_read_b128 v[232:235], v250 offset:21504
    ds_read_b128 v[236:239], v250 offset:32768
    v_mfma_f32_16x16x32_bf16 v[68:71], v[180:183], v[216:219], v[68:71]
    v_mfma_f32_16x16x32_bf16 v[72:75], v[208:211], v[216:219], v[72:75]
    v_mfma_f32_16x16x32_bf16 v[76:79], v[212:215], v[216:219], v[76:79]
    v_mfma_f32_16x16x32_bf16 v[64:67], v[184:187], v[220:223], v[64:67]
    v_mfma_f32_16x16x32_bf16 v[68:71], v[188:191], v[220:223], v[68:71]
    v_mfma_f32_16x16x32_bf16 v[72:75], v[176:179], v[220:223], v[72:75]
    v_mfma_f32_16x16x32_bf16 v[76:79], v[180:183], v[220:223], v[76:79]
    s_waitcnt lgkmcnt(2)
    v_mfma_f32_16x16x32_bf16 v[32:35], v[192:195], v[224:227], v[32:35]
    ds_read_b128 v[240:243], v253 offset:19456
    ds_read_b128 v[244:247], v253 offset:30720
    v_mfma_f32_16x16x32_bf16 v[36:39], v[196:199], v[224:227], v[36:39]
    v_cvt_pk_bf16_f32 v16, v16, v17
    v_cvt_pk_bf16_f32 v17, v18, v19
    v_mfma_f32_16x16x32_bf16 v[40:43], v[168:171], v[224:227], v[40:43]
    v_cvt_pk_bf16_f32 v18, v20, v21
    v_cvt_pk_bf16_f32 v19, v22, v23
    v_mfma_f32_16x16x32_bf16 v[44:47], v[172:175], v[224:227], v[44:47]
    s_add_u32 s47, s48, 1024
    buffer_store_dwordx4 v[16:19], v251, s[16:19], s47 offen sc1
    v_mfma_f32_16x16x32_bf16 v[32:35], v[200:203], v[228:231], v[32:35]
    v_cvt_pk_bf16_f32 v24, v24, v25
    v_cvt_pk_bf16_f32 v25, v26, v27
    v_mfma_f32_16x16x32_bf16 v[36:39], v[204:207], v[228:231], v[36:39]
    v_cvt_pk_bf16_f32 v26, v28, v29
    v_cvt_pk_bf16_f32 v27, v30, v31
    v_mfma_f32_16x16x32_bf16 v[40:43], v[192:195], v[228:231], v[40:43]
    s_add_u32 s47, s48, 12288
    buffer_store_dwordx4 v[24:27], v251, s[16:19], s47 offen sc1
    v_mfma_f32_16x16x32_bf16 v[44:47], v[196:199], v[228:231], v[44:47]
    s_waitcnt lgkmcnt(2)
    v_mfma_f32_16x16x32_bf16 v[80:83], v[176:179], v[232:235], v[80:83]
    ds_read_b128 v[216:219], v250 offset:22528
    ds_read_b128 v[220:223], v250 offset:33792
    v_mfma_f32_16x16x32_bf16 v[84:87], v[180:183], v[232:235], v[84:87]
    v_mfma_f32_16x16x32_bf16 v[88:91], v[208:211], v[232:235], v[88:91]
    v_mfma_f32_16x16x32_bf16 v[92:95], v[212:215], v[232:235], v[92:95]
    v_mfma_f32_16x16x32_bf16 v[80:83], v[184:187], v[236:239], v[80:83]
    v_mfma_f32_16x16x32_bf16 v[84:87], v[188:191], v[236:239], v[84:87]
    v_mfma_f32_16x16x32_bf16 v[88:91], v[176:179], v[236:239], v[88:91]
    v_mfma_f32_16x16x32_bf16 v[92:95], v[180:183], v[236:239], v[92:95]
    s_waitcnt lgkmcnt(2)
    v_mfma_f32_16x16x32_bf16 v[48:51], v[192:195], v[240:243], v[48:51]
    ds_read_b128 v[224:227], v253 offset:20480
    ds_read_b128 v[228:231], v253 offset:31744
    v_mfma_f32_16x16x32_bf16 v[52:55], v[196:199], v[240:243], v[52:55]
    v_cvt_pk_bf16_f32 v32, v32, v33
    v_cvt_pk_bf16_f32 v33, v34, v35
    v_mfma_f32_16x16x32_bf16 v[56:59], v[168:171], v[240:243], v[56:59]
    v_cvt_pk_bf16_f32 v34, v36, v37
    v_cvt_pk_bf16_f32 v35, v38, v39
    v_mfma_f32_16x16x32_bf16 v[60:63], v[172:175], v[240:243], v[60:63]
    s_add_u32 s47, s48, 2048
    buffer_store_dwordx4 v[32:35], v251, s[16:19], s47 offen sc1
    v_mfma_f32_16x16x32_bf16 v[48:51], v[200:203], v[244:247], v[48:51]
    v_cvt_pk_bf16_f32 v40, v40, v41
    v_cvt_pk_bf16_f32 v41, v42, v43
    v_mfma_f32_16x16x32_bf16 v[52:55], v[204:207], v[244:247], v[52:55]
    v_cvt_pk_bf16_f32 v42, v44, v45
    v_cvt_pk_bf16_f32 v43, v46, v47
    v_mfma_f32_16x16x32_bf16 v[56:59], v[192:195], v[244:247], v[56:59]
    s_add_u32 s47, s48, 13312
    buffer_store_dwordx4 v[40:43], v251, s[16:19], s47 offen sc1
    v_mfma_f32_16x16x32_bf16 v[60:63], v[196:199], v[244:247], v[60:63]
    s_waitcnt lgkmcnt(2)
    v_mfma_f32_16x16x32_bf16 v[96:99], v[176:179], v[216:219], v[96:99]
    ds_read_b128 v[232:235], v250 offset:23552
    ds_read_b128 v[236:239], v250 offset:34816
    v_mfma_f32_16x16x32_bf16 v[100:103], v[180:183], v[216:219], v[100:103]
    v_mfma_f32_16x16x32_bf16 v[104:107], v[208:211], v[216:219], v[104:107]
    v_mfma_f32_16x16x32_bf16 v[108:111], v[212:215], v[216:219], v[108:111]
    v_mfma_f32_16x16x32_bf16 v[96:99], v[184:187], v[220:223], v[96:99]
    v_mfma_f32_16x16x32_bf16 v[100:103], v[188:191], v[220:223], v[100:103]
    v_mfma_f32_16x16x32_bf16 v[104:107], v[176:179], v[220:223], v[104:107]
    v_mfma_f32_16x16x32_bf16 v[108:111], v[180:183], v[220:223], v[108:111]
    s_waitcnt lgkmcnt(2)
    v_mfma_f32_16x16x32_bf16 v[64:67], v[192:195], v[224:227], v[64:67]
    ds_read_b128 v[240:243], v253 offset:21504
    ds_read_b128 v[244:247], v253 offset:32768
    v_mfma_f32_16x16x32_bf16 v[68:71], v[196:199], v[224:227], v[68:71]
    v_cvt_pk_bf16_f32 v48, v48, v49
    v_cvt_pk_bf16_f32 v49, v50, v51
    v_mfma_f32_16x16x32_bf16 v[72:75], v[168:171], v[224:227], v[72:75]
    v_cvt_pk_bf16_f32 v50, v52, v53
    v_cvt_pk_bf16_f32 v51, v54, v55
    v_mfma_f32_16x16x32_bf16 v[76:79], v[172:175], v[224:227], v[76:79]
    s_add_u32 s47, s48, 3072
    buffer_store_dwordx4 v[48:51], v251, s[16:19], s47 offen sc1
    v_mfma_f32_16x16x32_bf16 v[64:67], v[200:203], v[228:231], v[64:67]
    v_cvt_pk_bf16_f32 v56, v56, v57
    v_cvt_pk_bf16_f32 v57, v58, v59
    v_mfma_f32_16x16x32_bf16 v[68:71], v[204:207], v[228:231], v[68:71]
    v_cvt_pk_bf16_f32 v58, v60, v61
    v_cvt_pk_bf16_f32 v59, v62, v63
    v_mfma_f32_16x16x32_bf16 v[72:75], v[192:195], v[228:231], v[72:75]
    s_add_u32 s47, s48, 14336
    buffer_store_dwordx4 v[56:59], v251, s[16:19], s47 offen sc1
    v_mfma_f32_16x16x32_bf16 v[76:79], v[196:199], v[228:231], v[76:79]
    s_waitcnt lgkmcnt(2)
    v_mfma_f32_16x16x32_bf16 v[112:115], v[176:179], v[232:235], v[112:115]
    ds_read_b128 v[216:219], v250 offset:24576
    ds_read_b128 v[220:223], v250 offset:35840
    v_mfma_f32_16x16x32_bf16 v[116:119], v[180:183], v[232:235], v[116:119]
    v_mfma_f32_16x16x32_bf16 v[120:123], v[208:211], v[232:235], v[120:123]
    v_mfma_f32_16x16x32_bf16 v[124:127], v[212:215], v[232:235], v[124:127]
    v_mfma_f32_16x16x32_bf16 v[112:115], v[184:187], v[236:239], v[112:115]
    v_mfma_f32_16x16x32_bf16 v[116:119], v[188:191], v[236:239], v[116:119]
    v_mfma_f32_16x16x32_bf16 v[120:123], v[176:179], v[236:239], v[120:123]
    v_mfma_f32_16x16x32_bf16 v[124:127], v[180:183], v[236:239], v[124:127]
    s_waitcnt lgkmcnt(2)
    v_mfma_f32_16x16x32_bf16 v[80:83], v[192:195], v[240:243], v[80:83]
    ds_read_b128 v[224:227], v253 offset:22528
    ds_read_b128 v[228:231], v253 offset:33792
    v_mfma_f32_16x16x32_bf16 v[84:87], v[196:199], v[240:243], v[84:87]
    v_cvt_pk_bf16_f32 v64, v64, v65
    v_cvt_pk_bf16_f32 v65, v66, v67
    v_mfma_f32_16x16x32_bf16 v[88:91], v[168:171], v[240:243], v[88:91]
    v_cvt_pk_bf16_f32 v66, v68, v69
    v_cvt_pk_bf16_f32 v67, v70, v71
    v_mfma_f32_16x16x32_bf16 v[92:95], v[172:175], v[240:243], v[92:95]
    s_add_u32 s47, s48, 4096
    buffer_store_dwordx4 v[64:67], v251, s[16:19], s47 offen sc1
    v_mfma_f32_16x16x32_bf16 v[80:83], v[200:203], v[244:247], v[80:83]
    v_cvt_pk_bf16_f32 v72, v72, v73
    v_cvt_pk_bf16_f32 v73, v74, v75
    v_mfma_f32_16x16x32_bf16 v[84:87], v[204:207], v[244:247], v[84:87]
    v_cvt_pk_bf16_f32 v74, v76, v77
    v_cvt_pk_bf16_f32 v75, v78, v79
    v_mfma_f32_16x16x32_bf16 v[88:91], v[192:195], v[244:247], v[88:91]
    s_add_u32 s47, s48, 15360
    buffer_store_dwordx4 v[72:75], v251, s[16:19], s47 offen sc1
    v_mfma_f32_16x16x32_bf16 v[92:95], v[196:199], v[244:247], v[92:95]
    s_waitcnt lgkmcnt(2)
    v_mfma_f32_16x16x32_bf16 v[128:131], v[176:179], v[216:219], v[128:131]
    ds_read_b128 v[232:235], v250 offset:25600
    ds_read_b128 v[236:239], v250 offset:36864
    v_mfma_f32_16x16x32_bf16 v[132:135], v[180:183], v[216:219], v[132:135]
    v_mfma_f32_16x16x32_bf16 v[136:139], v[208:211], v[216:219], v[136:139]
    v_mfma_f32_16x16x32_bf16 v[140:143], v[212:215], v[216:219], v[140:143]
    v_mfma_f32_16x16x32_bf16 v[128:131], v[184:187], v[220:223], v[128:131]
    v_mfma_f32_16x16x32_bf16 v[132:135], v[188:191], v[220:223], v[132:135]
    v_mfma_f32_16x16x32_bf16 v[136:139], v[176:179], v[220:223], v[136:139]
    v_mfma_f32_16x16x32_bf16 v[140:143], v[180:183], v[220:223], v[140:143]
    s_waitcnt lgkmcnt(2)
    v_mfma_f32_16x16x32_bf16 v[96:99], v[192:195], v[224:227], v[96:99]
    ds_read_b128 v[240:243], v253 offset:23552
    ds_read_b128 v[244:247], v253 offset:34816
    v_mfma_f32_16x16x32_bf16 v[100:103], v[196:199], v[224:227], v[100:103]
    v_cvt_pk_bf16_f32 v80, v80, v81
    v_cvt_pk_bf16_f32 v81, v82, v83
    v_mfma_f32_16x16x32_bf16 v[104:107], v[168:171], v[224:227], v[104:107]
    v_cvt_pk_bf16_f32 v82, v84, v85
    v_cvt_pk_bf16_f32 v83, v86, v87
    v_mfma_f32_16x16x32_bf16 v[108:111], v[172:175], v[224:227], v[108:111]
    s_add_u32 s47, s48, 5120
    buffer_store_dwordx4 v[80:83], v251, s[16:19], s47 offen sc1
    v_mfma_f32_16x16x32_bf16 v[96:99], v[200:203], v[228:231], v[96:99]
    v_cvt_pk_bf16_f32 v88, v88, v89
    v_cvt_pk_bf16_f32 v89, v90, v91
    v_mfma_f32_16x16x32_bf16 v[100:103], v[204:207], v[228:231], v[100:103]
    v_cvt_pk_bf16_f32 v90, v92, v93
    v_cvt_pk_bf16_f32 v91, v94, v95
    v_mfma_f32_16x16x32_bf16 v[104:107], v[192:195], v[228:231], v[104:107]
    s_add_u32 s47, s48, 16384
    buffer_store_dwordx4 v[88:91], v251, s[16:19], s47 offen sc1
    v_mfma_f32_16x16x32_bf16 v[108:111], v[196:199], v[228:231], v[108:111]
    s_waitcnt lgkmcnt(2)
    v_mfma_f32_16x16x32_bf16 v[144:147], v[176:179], v[232:235], v[144:147]
    ds_read_b128 v[216:219], v250 offset:26624
    ds_read_b128 v[220:223], v250 offset:37888
    v_mfma_f32_16x16x32_bf16 v[148:151], v[180:183], v[232:235], v[148:151]
    v_mfma_f32_16x16x32_bf16 v[152:155], v[208:211], v[232:235], v[152:155]
    v_mfma_f32_16x16x32_bf16 v[156:159], v[212:215], v[232:235], v[156:159]
    v_mfma_f32_16x16x32_bf16 v[144:147], v[184:187], v[236:239], v[144:147]
    v_mfma_f32_16x16x32_bf16 v[148:151], v[188:191], v[236:239], v[148:151]
    v_mfma_f32_16x16x32_bf16 v[152:155], v[176:179], v[236:239], v[152:155]
    v_mfma_f32_16x16x32_bf16 v[156:159], v[180:183], v[236:239], v[156:159]
    s_waitcnt lgkmcnt(2)
    v_mfma_f32_16x16x32_bf16 v[112:115], v[192:195], v[240:243], v[112:115]
    ds_read_b128 v[224:227], v253 offset:24576
    ds_read_b128 v[228:231], v253 offset:35840
    v_mfma_f32_16x16x32_bf16 v[116:119], v[196:199], v[240:243], v[116:119]
    v_cvt_pk_bf16_f32 v96, v96, v97
    v_cvt_pk_bf16_f32 v97, v98, v99
    v_mfma_f32_16x16x32_bf16 v[120:123], v[168:171], v[240:243], v[120:123]
    v_cvt_pk_bf16_f32 v98, v100, v101
    v_cvt_pk_bf16_f32 v99, v102, v103
    v_mfma_f32_16x16x32_bf16 v[124:127], v[172:175], v[240:243], v[124:127]
    s_add_u32 s47, s48, 6144
    buffer_store_dwordx4 v[96:99], v251, s[16:19], s47 offen sc1
    v_mfma_f32_16x16x32_bf16 v[112:115], v[200:203], v[244:247], v[112:115]
    v_cvt_pk_bf16_f32 v104, v104, v105
    v_cvt_pk_bf16_f32 v105, v106, v107
    v_mfma_f32_16x16x32_bf16 v[116:119], v[204:207], v[244:247], v[116:119]
    v_cvt_pk_bf16_f32 v106, v108, v109
    v_cvt_pk_bf16_f32 v107, v110, v111
    v_mfma_f32_16x16x32_bf16 v[120:123], v[192:195], v[244:247], v[120:123]
    s_add_u32 s47, s48, 17408
    buffer_store_dwordx4 v[104:107], v251, s[16:19], s47 offen sc1
    v_mfma_f32_16x16x32_bf16 v[124:127], v[196:199], v[244:247], v[124:127]
    s_waitcnt lgkmcnt(2)
    v_mfma_f32_16x16x32_bf16 v[160:163], v[176:179], v[216:219], v[160:163]
    ds_read_b128 v[232:235], v253 offset:25600
    ds_read_b128 v[236:239], v253 offset:36864
    v_mfma_f32_16x16x32_bf16 v[164:167], v[208:211], v[216:219], v[164:167]
    v_mfma_f32_16x16x32_bf16 v[160:163], v[184:187], v[220:223], v[160:163]
    v_mfma_f32_16x16x32_bf16 v[164:167], v[176:179], v[220:223], v[164:167]
    s_waitcnt lgkmcnt(2)
    v_mfma_f32_16x16x32_bf16 v[128:131], v[192:195], v[224:227], v[128:131]
    ds_read_b128 v[240:243], v253 offset:26624
    ds_read_b128 v[244:247], v253 offset:37888
    v_mfma_f32_16x16x32_bf16 v[132:135], v[196:199], v[224:227], v[132:135]
    v_cvt_pk_bf16_f32 v112, v112, v113
    v_cvt_pk_bf16_f32 v113, v114, v115
    v_mfma_f32_16x16x32_bf16 v[136:139], v[168:171], v[224:227], v[136:139]
    v_cvt_pk_bf16_f32 v114, v116, v117
    v_cvt_pk_bf16_f32 v115, v118, v119
    v_mfma_f32_16x16x32_bf16 v[140:143], v[172:175], v[224:227], v[140:143]
    s_add_u32 s47, s48, 7168
    buffer_store_dwordx4 v[112:115], v251, s[16:19], s47 offen sc1
    v_mfma_f32_16x16x32_bf16 v[128:131], v[200:203], v[228:231], v[128:131]
    v_cvt_pk_bf16_f32 v120, v120, v121
    v_cvt_pk_bf16_f32 v121, v122, v123
    v_mfma_f32_16x16x32_bf16 v[132:135], v[204:207], v[228:231], v[132:135]
    v_cvt_pk_bf16_f32 v122, v124, v125
    v_cvt_pk_bf16_f32 v123, v126, v127
    v_mfma_f32_16x16x32_bf16 v[136:139], v[192:195], v[228:231], v[136:139]
    s_add_u32 s47, s48, 18432
    buffer_store_dwordx4 v[120:123], v251, s[16:19], s47 offen sc1
    v_mfma_f32_16x16x32_bf16 v[140:143], v[196:199], v[228:231], v[140:143]
    s_waitcnt lgkmcnt(2)
    v_mfma_f32_16x16x32_bf16 v[144:147], v[192:195], v[232:235], v[144:147]
    v_mfma_f32_16x16x32_bf16 v[148:151], v[196:199], v[232:235], v[148:151]
    v_mfma_f32_16x16x32_bf16 v[152:155], v[168:171], v[232:235], v[152:155]
    v_mfma_f32_16x16x32_bf16 v[156:159], v[172:175], v[232:235], v[156:159]
    v_mfma_f32_16x16x32_bf16 v[144:147], v[200:203], v[236:239], v[144:147]
    v_mfma_f32_16x16x32_bf16 v[148:151], v[204:207], v[236:239], v[148:151]
    v_mfma_f32_16x16x32_bf16 v[152:155], v[192:195], v[236:239], v[152:155]
    v_mfma_f32_16x16x32_bf16 v[156:159], v[196:199], v[236:239], v[156:159]
    s_waitcnt lgkmcnt(0)
    v_mfma_f32_16x16x32_bf16 v[160:163], v[192:195], v[240:243], v[160:163]
    v_mfma_f32_16x16x32_bf16 v[164:167], v[168:171], v[240:243], v[164:167]
    v_cvt_pk_bf16_f32 v128, v128, v129
    v_cvt_pk_bf16_f32 v129, v130, v131
    v_mfma_f32_16x16x32_bf16 v[160:163], v[200:203], v[244:247], v[160:163]
    v_cvt_pk_bf16_f32 v130, v132, v133
    v_cvt_pk_bf16_f32 v131, v134, v135
    v_mfma_f32_16x16x32_bf16 v[164:167], v[192:195], v[244:247], v[164:167]
    s_add_u32 s47, s48, 8192
    buffer_store_dwordx4 v[128:131], v251, s[16:19], s47 offen sc1
    s_nop 7
    v_cvt_pk_bf16_f32 v136, v136, v137
    v_cvt_pk_bf16_f32 v137, v138, v139
    v_cvt_pk_bf16_f32 v138, v140, v141
    v_cvt_pk_bf16_f32 v139, v142, v143
    s_add_u32 s47, s48, 19456
    buffer_store_dwordx4 v[136:139], v251, s[16:19], s47 offen sc1
    v_cvt_pk_bf16_f32 v144, v144, v145
    v_cvt_pk_bf16_f32 v145, v146, v147
    v_cvt_pk_bf16_f32 v146, v148, v149
    v_cvt_pk_bf16_f32 v147, v150, v151
    s_add_u32 s47, s48, 9216
    buffer_store_dwordx4 v[144:147], v251, s[16:19], s47 offen sc1
    v_cvt_pk_bf16_f32 v152, v152, v153
    v_cvt_pk_bf16_f32 v153, v154, v155
    v_cvt_pk_bf16_f32 v154, v156, v157
    v_cvt_pk_bf16_f32 v155, v158, v159
    s_add_u32 s47, s48, 20480
    buffer_store_dwordx4 v[152:155], v251, s[16:19], s47 offen sc1
    v_cvt_pk_bf16_f32 v160, v160, v161
    v_cvt_pk_bf16_f32 v161, v162, v163
    s_add_u32 s47, s49, 0
    buffer_store_dwordx2 v[160:161], v252, s[16:19], s47 offen sc1
    v_cvt_pk_bf16_f32 v164, v164, v165
    v_cvt_pk_bf16_f32 v165, v166, v167
    s_add_u32 s47, s49, 11264
    buffer_store_dwordx2 v[164:165], v252, s[16:19], s47 offen sc1
    s_branch L_epi_done
L_epi_b1:
    v_add_u32 v248, 0x9800, v248
    v_add_u32 v249, 0x9800, v249
    v_add_u32 v253, 38912, v250
    ds_read_b64_tr_b16 v[192:193], v248 offset:0
    ds_read_b64_tr_b16 v[194:195], v248 offset:1024
    ds_read_b64_tr_b16 v[196:197], v249 offset:0
    ds_read_b64_tr_b16 v[198:199], v249 offset:1024
    ds_read_b64_tr_b16 v[200:201], v248 offset:8192
    ds_read_b64_tr_b16 v[202:203], v248 offset:9216
    ds_read_b64_tr_b16 v[204:205], v249 offset:8192
    ds_read_b64_tr_b16 v[206:207], v249 offset:9216
    s_waitcnt lgkmcnt(10)
    v_mfma_f32_16x16x32_bf16 v[0:3], v[176:179], v[232:235], v[0:3]
    ds_read_b128 v[216:219], v250 offset:18432
    ds_read_b128 v[220:223], v250 offset:29696
    v_mfma_f32_16x16x32_bf16 v[4:7], v[180:183], v[232:235], v[4:7]
    v_mfma_f32_16x16x32_bf16 v[8:11], v[208:211], v[232:235], v[8:11]
    v_mfma_f32_16x16x32_bf16 v[12:15], v[212:215], v[232:235], v[12:15]
    v_mfma_f32_16x16x32_bf16 v[0:3], v[184:187], v[236:239], v[0:3]
    v_mfma_f32_16x16x32_bf16 v[4:7], v[188:191], v[236:239], v[4:7]
    v_mfma_f32_16x16x32_bf16 v[8:11], v[176:179], v[236:239], v[8:11]
    v_mfma_f32_16x16x32_bf16 v[12:15], v[180:183], v[236:239], v[12:15]
    s_waitcnt lgkmcnt(10)
    v_mfma_f32_16x16x32_bf16 v[16:19], v[176:179], v[240:243], v[16:19]
    ds_read_b128 v[224:227], v253 offset:16384
    ds_read_b128 v[228:231], v253 offset:27648
    v_mfma_f32_16x16x32_bf16 v[20:23], v[180:183], v[240:243], v[20:23]
    v_mfma_f32_16x16x32_bf16 v[24:27], v[208:211], v[240:243], v[24:27]
    v_mfma_f32_16x16x32_bf16 v[28:31], v[212:215], v[240:243], v[28:31]
    v_mfma_f32_16x16x32_bf16 v[16:19], v[184:187], v[244:247], v[16:19]
    v_mfma_f32_16x16x32_bf16 v[20:23], v[188:191], v[244:247], v[20:23]
    v_mfma_f32_16x16x32_bf16 v[24:27], v[176:179], v[244:247], v[24:27]
    v_mfma_f32_16x16x32_bf16 v[28:31], v[180:183], v[244:247], v[28:31]
    s_waitcnt lgkmcnt(2)
    v_mfma_f32_16x16x32_bf16 v[32:35], v[176:179], v[216:219], v[32:35]
    ds_read_b128 v[232:235], v250 offset:19456
    ds_read_b128 v[236:239], v250 offset:30720
    v_mfma_f32_16x16x32_bf16 v[36:39], v[180:183], v[216:219], v[36:39]
    v_mfma_f32_16x16x32_bf16 v[40:43], v[208:211], v[216:219], v[40:43]
    v_mfma_f32_16x16x32_bf16 v[44:47], v[212:215], v[216:219], v[44:47]
    v_mfma_f32_16x16x32_bf16 v[32:35], v[184:187], v[220:223], v[32:35]
    v_mfma_f32_16x16x32_bf16 v[36:39], v[188:191], v[220:223], v[36:39]
    v_mfma_f32_16x16x32_bf16 v[40:43], v[176:179], v[220:223], v[40:43]
    v_mfma_f32_16x16x32_bf16 v[44:47], v[180:183], v[220:223], v[44:47]
    v_xor_b32 v168, 0x80008000, v200
    v_xor_b32 v169, 0x80008000, v201
    v_xor_b32 v170, 0x80008000, v202
    v_xor_b32 v171, 0x80008000, v203
    v_xor_b32 v172, 0x80008000, v204
    v_xor_b32 v173, 0x80008000, v205
    v_xor_b32 v174, 0x80008000, v206
    v_xor_b32 v175, 0x80008000, v207
    s_waitcnt lgkmcnt(2)
    v_mfma_f32_16x16x32_bf16 v[0:3], v[192:195], v[224:227], v[0:3]
    ds_read_b128 v[240:243], v253 offset:17408
    ds_read_b128 v[244:247], v253 offset:28672
    v_mfma_f32_16x16x32_bf16 v[4:7], v[196:199], v[224:227], v[4:7]
    v_mfma_f32_16x16x32_bf16 v[8:11], v[168:171], v[224:227], v[8:11]
    v_mfma_f32_16x16x32_bf16 v[12:15], v[172:175], v[224:227], v[12:15]
    v_mfma_f32_16x16x32_bf16 v[0:3], v[200:203], v[228:231], v[0:3]
    v_mfma_f32_16x16x32_bf16 v[4:7], v[204:207], v[228:231], v[4:7]
    v_mfma_f32_16x16x32_bf16 v[8:11], v[192:195], v[228:231], v[8:11]
    v_mfma_f32_16x16x32_bf16 v[12:15], v[196:199], v[228:231], v[12:15]
    s_waitcnt lgkmcnt(2)
    v_mfma_f32_16x16x32_bf16 v[48:51], v[176:179], v[232:235], v[48:51]
    ds_read_b128 v[216:219], v250 offset:20480
    ds_read_b128 v[220:223], v250 offset:31744
    v_mfma_f32_16x16x32_bf16 v[52:55], v[180:183], v[232:235], v[52:55]
    v_mfma_f32_16x16x32_bf16 v[56:59], v[208:211], v[232:235], v[56:59]
    v_mfma_f32_16x16x32_bf16 v[60:63], v[212:215], v[232:235], v[60:63]
    v_mfma_f32_16x16x32_bf16 v[48:51], v[184:187], v[236:239], v[48:51]
    v_mfma_f32_16x16x32_bf16 v[52:55], v[188:191], v[236:239], v[52:55]
    v_mfma_f32_16x16x32_bf16 v[56:59], v[176:179], v[236:239], v[56:59]
    v_mfma_f32_16x16x32_bf16 v[60:63], v[180:183], v[236:239], v[60:63]
    s_waitcnt lgkmcnt(2)
    v_mfma_f32_16x16x32_bf16 v[16:19], v[192:195], v[240:243], v[16:19]
    ds_read_b128 v[224:227], v253 offset:18432
    ds_read_b128 v[228:231], v253 offset:29696
    v_mfma_f32_16x16x32_bf16 v[20:23], v[196:199], v[240:243], v[20:23]
    v_cvt_pk_bf16_f32 v4, v4, v5
    v_cvt_pk_bf16_f32 v5, v6, v7
    v_mfma_f32_16x16x32_bf16 v[24:27], v[168:171], v[240:243], v[24:27]
    v_cvt_pk_bf16_f32 v6, v0, v1
    v_cvt_pk_bf16_f32 v7, v2, v3
    v_mfma_f32_16x16x32_bf16 v[28:31], v[172:175], v[240:243], v[28:31]
    s_add_u32 s47, s48, 0
    buffer_store_dwordx4 v[4:7], v251, s[16:19], s47 offen sc1
    v_mfma_f32_16x16x32_bf16 v[16:19], v[200:203], v[244:247], v[16:19]
    v_cvt_pk_bf16_f32 v12, v12, v13
    v_cvt_pk_bf16_f32 v13, v14, v15
    v_mfma_f32_16x16x32_bf16 v[20:23], v[204:207], v[244:247], v[20:23]
    v_cvt_pk_bf16_f32 v14, v8, v9
    v_cvt_pk_bf16_f32 v15, v10, v11
    v_mfma_f32_16x16x32_bf16 v[24:27], v[192:195], v[244:247], v[24:27]
    s_add_u32 s47, s48, 11264
    buffer_store_dwordx4 v[12:15], v251, s[16:19], s47 offen sc1
    v_mfma_f32_16x16x32_bf16 v[28:31], v[196:199], v[244:247], v[28:31]
    s_waitcnt lgkmcnt(2)
    v_mfma_f32_16x16x32_bf16 v[64:67], v[176:179], v[216:219], v[64:67]
    ds_read_b128 v[232:235], v250 offset:21504
    ds_read_b128 v[236:239], v250 offset:32768
    v_mfma_f32_16x16x32_bf16 v[68:71], v[180:183], v[216:219], v[68:71]
    v_mfma_f32_16x16x32_bf16 v[72:75], v[208:211], v[216:219], v[72:75]
    v_mfma_f32_16x16x32_bf16 v[76:79], v[212:215], v[216:219], v[76:79]
    v_mfma_f32_16x16x32_bf16 v[64:67], v[184:187], v[220:223], v[64:67]
    v_mfma_f32_16x16x32_bf16 v[68:71], v[188:191], v[220:223], v[68:71]
    v_mfma_f32_16x16x32_bf16 v[72:75], v[176:179], v[220:223], v[72:75]
    v_mfma_f32_16x16x32_bf16 v[76:79], v[180:183], v[220:223], v[76:79]
    s_waitcnt lgkmcnt(2)
    v_mfma_f32_16x16x32_bf16 v[32:35], v[192:195], v[224:227], v[32:35]
    ds_read_b128 v[240:243], v253 offset:19456
    ds_read_b128 v[244:247], v253 offset:30720
    v_mfma_f32_16x16x32_bf16 v[36:39], v[196:199], v[224:227], v[36:39]
    v_cvt_pk_bf16_f32 v20, v20, v21
    v_cvt_pk_bf16_f32 v21, v22, v23
    v_mfma_f32_16x16x32_bf16 v[40:43], v[168:171], v[224:227], v[40:43]
    v_cvt_pk_bf16_f32 v22, v16, v17
    v_cvt_pk_bf16_f32 v23, v18, v19
    v_mfma_f32_16x16x32_bf16 v[44:47], v[172:175], v[224:227], v[44:47]
    s_add_u32 s47, s48, 1024
    buffer_store_dwordx4 v[20:23], v251, s[16:19], s47 offen sc1
    v_mfma_f32_16x16x32_bf16 v[32:35], v[200:203], v[228:231], v[32:35]
    v_cvt_pk_bf16_f32 v28, v28, v29
    v_cvt_pk_bf16_f32 v29, v30, v31
    v_mfma_f32_16x16x32_bf16 v[36:39], v[204:207], v[228:231], v[36:39]
    v_cvt_pk_bf16_f32 v30, v24, v25
    v_cvt_pk_bf16_f32 v31, v26, v27
    v_mfma_f32_16x16x32_bf16 v[40:43], v[192:195], v[228:231], v[40:43]
    s_add_u32 s47, s48, 12288
    buffer_store_dwordx4 v[28:31], v251, s[16:19], s47 offen sc1
    v_mfma_f32_16x16x32_bf16 v[44:47], v[196:199], v[228:231], v[44:47]
    s_waitcnt lgkmcnt(2)
    v_mfma_f32_16x16x32_bf16 v[80:83], v[176:179], v[232:235], v[80:83]
    ds_read_b128 v[216:219], v250 offset:22528
    ds_read_b128 v[220:223], v250 offset:33792
    v_mfma_f32_16x16x32_bf16 v[84:87], v[180:183], v[232:235], v[84:87]
    v_mfma_f32_16x16x32_bf16 v[88:91], v[208:211], v[232:235], v[88:91]
    v_mfma_f32_16x16x32_bf16 v[92:95], v[212:215], v[232:235], v[92:95]
    v_mfma_f32_16x16x32_bf16 v[80:83], v[184:187], v[236:239], v[80:83]
    v_mfma_f32_16x16x32_bf16 v[84:87], v[188:191], v[236:239], v[84:87]
    v_mfma_f32_16x16x32_bf16 v[88:91], v[176:179], v[236:239], v[88:91]
    v_mfma_f32_16x16x32_bf16 v[92:95], v[180:183], v[236:239], v[92:95]
    s_waitcnt lgkmcnt(2)
    v_mfma_f32_16x16x32_bf16 v[48:51], v[192:195], v[240:243], v[48:51]
    ds_read_b128 v[224:227], v253 offset:20480
    ds_read_b128 v[228:231], v253 offset:31744
    v_mfma_f32_16x16x32_bf16 v[52:55], v[196:199], v[240:243], v[52:55]
    v_cvt_pk_bf16_f32 v36, v36, v37
    v_cvt_pk_bf16_f32 v37, v38, v39
    v_mfma_f32_16x16x32_bf16 v[56:59], v[168:171], v[240:243], v[56:59]
    v_cvt_pk_bf16_f32 v38, v32, v33
    v_cvt_pk_bf16_f32 v39, v34, v35
    v_mfma_f32_16x16x32_bf16 v[60:63], v[172:175], v[240:243], v[60:63]
    s_add_u32 s47, s48, 2048
    buffer_store_dwordx4 v[36:39], v251, s[16:19], s47 offen sc1
    v_mfma_f32_16x16x32_bf16 v[48:51], v[200:203], v[244:247], v[48:51]
    v_cvt_pk_bf16_f32 v44, v44, v45
    v_cvt_pk_bf16_f32 v45, v46, v47
    v_mfma_f32_16x16x32_bf16 v[52:55], v[204:207], v[244:247], v[52:55]
    v_cvt_pk_bf16_f32 v46, v40, v41
    v_cvt_pk_bf16_f32 v47, v42, v43
    v_mfma_f32_16x16x32_bf16 v[56:59], v[192:195], v[244:247], v[56:59]
    s_add_u32 s47, s48, 13312
    buffer_store_dwordx4 v[44:47], v251, s[16:19], s47 offen sc1
    v_mfma_f32_16x16x32_bf16 v[60:63], v[196:199], v[244:247], v[60:63]
    s_waitcnt lgkmcnt(2)
    v_mfma_f32_16x16x32_bf16 v[96:99], v[176:179], v[216:219], v[96:99]
    ds_read_b128 v[232:235], v250 offset:23552
    ds_read_b128 v[236:239], v250 offset:34816
    v_mfma_f32_16x16x32_bf16 v[100:103], v[180:183], v[216:219], v[100:103]
    v_mfma_f32_16x16x32_bf16 v[104:107], v[208:211], v[216:219], v[104:107]
    v_mfma_f32_16x16x32_bf16 v[108:111], v[212:215], v[216:219], v[108:111]
    v_mfma_f32_16x16x32_bf16 v[96:99], v[184:187], v[220:223], v[96:99]
    v_mfma_f32_16x16x32_bf16 v[100:103], v[188:191], v[220:223], v[100:103]
    v_mfma_f32_16x16x32_bf16 v[104:107], v[176:179], v[220:223], v[104:107]
    v_mfma_f32_16x16x32_bf16 v[108:111], v[180:183], v[220:223], v[108:111]
    s_waitcnt lgkmcnt(2)
    v_mfma_f32_16x16x32_bf16 v[64:67], v[192:195], v[224:227], v[64:67]
    ds_read_b128 v[240:243], v253 offset:21504
    ds_read_b128 v[244:247], v253 offset:32768
    v_mfma_f32_16x16x32_bf16 v[68:71], v[196:199], v[224:227], v[68:71]
    v_cvt_pk_bf16_f32 v52, v52, v53
    v_cvt_pk_bf16_f32 v53, v54, v55
    v_mfma_f32_16x16x32_bf16 v[72:75], v[168:171], v[224:227], v[72:75]
    v_cvt_pk_bf16_f32 v54, v48, v49
    v_cvt_pk_bf16_f32 v55, v50, v51
    v_mfma_f32_16x16x32_bf16 v[76:79], v[172:175], v[224:227], v[76:79]
    s_add_u32 s47, s48, 3072
    buffer_store_dwordx4 v[52:55], v251, s[16:19], s47 offen sc1
    v_mfma_f32_16x16x32_bf16 v[64:67], v[200:203], v[228:231], v[64:67]
    v_cvt_pk_bf16_f32 v60, v60, v61
    v_cvt_pk_bf16_f32 v61, v62, v63
    v_mfma_f32_16x16x32_bf16 v[68:71], v[204:207], v[228:231], v[68:71]
    v_cvt_pk_bf16_f32 v62, v56, v57
    v_cvt_pk_bf16_f32 v63, v58, v59
    v_mfma_f32_16x16x32_bf16 v[72:75], v[192:195], v[228:231], v[72:75]
    s_add_u32 s47, s48, 14336
    buffer_store_dwordx4 v[60:63], v251, s[16:19], s47 offen sc1
    v_mfma_f32_16x16x32_bf16 v[76:79], v[196:199], v[228:231], v[76:79]
    s_waitcnt lgkmcnt(2)
    v_mfma_f32_16x16x32_bf16 v[112:115], v[176:179], v[232:235], v[112:115]
    ds_read_b128 v[216:219], v250 offset:24576
    ds_read_b128 v[220:223], v250 offset:35840
    v_mfma_f32_16x16x32_bf16 v[116:119], v[180:183], v[232:235], v[116:119]
    v_mfma_f32_16x16x32_bf16 v[120:123], v[208:211], v[232:235], v[120:123]
    v_mfma_f32_16x16x32_bf16 v[124:127], v[212:215], v[232:235], v[124:127]
    v_mfma_f32_16x16x32_bf16 v[112:115], v[184:187], v[236:239], v[112:115]
    v_mfma_f32_16x16x32_bf16 v[116:119], v[188:191], v[236:239], v[116:119]
    v_mfma_f32_16x16x32_bf16 v[120:123], v[176:179], v[236:239], v[120:123]
    v_mfma_f32_16x16x32_bf16 v[124:127], v[180:183], v[236:239], v[124:127]
    s_waitcnt lgkmcnt(2)
    v_mfma_f32_16x16x32_bf16 v[80:83], v[192:195], v[240:243], v[80:83]
    ds_read_b128 v[224:227], v253 offset:22528
    ds_read_b128 v[228:231], v253 offset:33792
    v_mfma_f32_16x16x32_bf16 v[84:87], v[196:199], v[240:243], v[84:87]
    v_cvt_pk_bf16_f32 v68, v68, v69
    v_cvt_pk_bf16_f32 v69, v70, v71
    v_mfma_f32_16x16x32_bf16 v[88:91], v[168:171], v[240:243], v[88:91]
    v_cvt_pk_bf16_f32 v70, v64, v65
    v_cvt_pk_bf16_f32 v71, v66, v67
    v_mfma_f32_16x16x32_bf16 v[92:95], v[172:175], v[240:243], v[92:95]
    s_add_u32 s47, s48, 4096
    buffer_store_dwordx4 v[68:71], v251, s[16:19], s47 offen sc1
    v_mfma_f32_16x16x32_bf16 v[80:83], v[200:203], v[244:247], v[80:83]
    v_cvt_pk_bf16_f32 v76, v76, v77
    v_cvt_pk_bf16_f32 v77, v78, v79
    v_mfma_f32_16x16x32_bf16 v[84:87], v[204:207], v[244:247], v[84:87]
    v_cvt_pk_bf16_f32 v78, v72, v73
    v_cvt_pk_bf16_f32 v79, v74, v75
    v_mfma_f32_16x16x32_bf16 v[88:91], v[192:195], v[244:247], v[88:91]
    s_add_u32 s47, s48, 15360
    buffer_store_dwordx4 v[76:79], v251, s[16:19], s47 offen sc1
    v_mfma_f32_16x16x32_bf16 v[92:95], v[196:199], v[244:247], v[92:95]
    s_waitcnt lgkmcnt(2)
    v_mfma_f32_16x16x32_bf16 v[128:131], v[176:179], v[216:219], v[128:131]
    ds_read_b128 v[232:235], v250 offset:25600
    ds_read_b128 v[236:239], v250 offset:36864
    v_mfma_f32_16x16x32_bf16 v[132:135], v[180:183], v[216:219], v[132:135]
    v_mfma_f32_16x16x32_bf16 v[136:139], v[208:211], v[216:219], v[136:139]
    v_mfma_f32_16x16x32_bf16 v[140:143], v[212:215], v[216:219], v[140:143]
    v_mfma_f32_16x16x32_bf16 v[128:131], v[184:187], v[220:223], v[128:131]
    v_mfma_f32_16x16x32_bf16 v[132:135], v[188:191], v[220:223], v[132:135]
    v_mfma_f32_16x16x32_bf16 v[136:139], v[176:179], v[220:223], v[136:139]
    v_mfma_f32_16x16x32_bf16 v[140:143], v[180:183], v[220:223], v[140:143]
    s_waitcnt lgkmcnt(2)
    v_mfma_f32_16x16x32_bf16 v[96:99], v[192:195], v[224:227], v[96:99]
    ds_read_b128 v[240:243], v253 offset:23552
    ds_read_b128 v[244:247], v253 offset:34816
    v_mfma_f32_16x16x32_bf16 v[100:103], v[196:199], v[224:227], v[100:103]
    v_cvt_pk_bf16_f32 v84, v84, v85
    v_cvt_pk_bf16_f32 v85, v86, v87
    v_mfma_f32_16x16x32_bf16 v[104:107], v[168:171], v[224:227], v[104:107]
    v_cvt_pk_bf16_f32 v86, v80, v81
    v_cvt_pk_bf16_f32 v87, v82, v83
    v_mfma_f32_16x16x32_bf16 v[108:111], v[172:175], v[224:227], v[108:111]
    s_add_u32 s47, s48, 5120
    buffer_store_dwordx4 v[84:87], v251, s[16:19], s47 offen sc1
    v_mfma_f32_16x16x32_bf16 v[96:99], v[200:203], v[228:231], v[96:99]
    v_cvt_pk_bf16_f32 v92, v92, v93
    v_cvt_pk_bf16_f32 v93, v94, v95
    v_mfma_f32_16x16x32_bf16 v[100:103], v[204:207], v[228:231], v[100:103]
    v_cvt_pk_bf16_f32 v94, v88, v89
    v_cvt_pk_bf16_f32 v95, v90, v91
    v_mfma_f32_16x16x32_bf16 v[104:107], v[192:195], v[228:231], v[104:107]
    s_add_u32 s47, s48, 16384
    buffer_store_dwordx4 v[92:95], v251, s[16:19], s47 offen sc1
    v_mfma_f32_16x16x32_bf16 v[108:111], v[196:199], v[228:231], v[108:111]
    s_waitcnt lgkmcnt(2)
    v_mfma_f32_16x16x32_bf16 v[144:147], v[176:179], v[232:235], v[144:147]
    ds_read_b128 v[216:219], v250 offset:26624
    ds_read_b128 v[220:223], v250 offset:37888
    v_mfma_f32_16x16x32_bf16 v[148:151], v[180:183], v[232:235], v[148:151]
    v_mfma_f32_16x16x32_bf16 v[152:155], v[208:211], v[232:235], v[152:155]
    v_mfma_f32_16x16x32_bf16 v[156:159], v[212:215], v[232:235], v[156:159]
    v_mfma_f32_16x16x32_bf16 v[144:147], v[184:187], v[236:239], v[144:147]
    v_mfma_f32_16x16x32_bf16 v[148:151], v[188:191], v[236:239], v[148:151]
    v_mfma_f32_16x16x32_bf16 v[152:155], v[176:179], v[236:239], v[152:155]
    v_mfma_f32_16x16x32_bf16 v[156:159], v[180:183], v[236:239], v[156:159]
    s_waitcnt lgkmcnt(2)
    v_mfma_f32_16x16x32_bf16 v[112:115], v[192:195], v[240:243], v[112:115]
    ds_read_b128 v[224:227], v253 offset:24576
    ds_read_b128 v[228:231], v253 offset:35840
    v_mfma_f32_16x16x32_bf16 v[116:119], v[196:199], v[240:243], v[116:119]
    v_cvt_pk_bf16_f32 v100, v100, v101
    v_cvt_pk_bf16_f32 v101, v102, v103
    v_mfma_f32_16x16x32_bf16 v[120:123], v[168:171], v[240:243], v[120:123]
    v_cvt_pk_bf16_f32 v102, v96, v97
    v_cvt_pk_bf16_f32 v103, v98, v99
    v_mfma_f32_16x16x32_bf16 v[124:127], v[172:175], v[240:243], v[124:127]
    s_add_u32 s47, s48, 6144
    buffer_store_dwordx4 v[100:103], v251, s[16:19], s47 offen sc1
    v_mfma_f32_16x16x32_bf16 v[112:115], v[200:203], v[244:247], v[112:115]
    v_cvt_pk_bf16_f32 v108, v108, v109
    v_cvt_pk_bf16_f32 v109, v110, v111
    v_mfma_f32_16x16x32_bf16 v[116:119], v[204:207], v[244:247], v[116:119]
    v_cvt_pk_bf16_f32 v110, v104, v105
    v_cvt_pk_bf16_f32 v111, v106, v107
    v_mfma_f32_16x16x32_bf16 v[120:123], v[192:195], v[244:247], v[120:123]
    s_add_u32 s47, s48, 17408
    buffer_store_dwordx4 v[108:111], v251, s[16:19], s47 offen sc1
    v_mfma_f32_16x16x32_bf16 v[124:127], v[196:199], v[244:247], v[124:127]
    s_waitcnt lgkmcnt(2)
    v_mfma_f32_16x16x32_bf16 v[160:163], v[176:179], v[216:219], v[160:163]
    ds_read_b128 v[232:235], v253 offset:25600
    ds_read_b128 v[236:239], v253 offset:36864
    v_mfma_f32_16x16x32_bf16 v[164:167], v[208:211], v[216:219], v[164:167]
    v_mfma_f32_16x16x32_bf16 v[160:163], v[184:187], v[220:223], v[160:163]
    v_mfma_f32_16x16x32_bf16 v[164:167], v[176:179], v[220:223], v[164:167]
    s_waitcnt lgkmcnt(2)
    v_mfma_f32_16x16x32_bf16 v[128:131], v[192:195], v[224:227], v[128:131]
    ds_read_b128 v[240:243], v253 offset:26624
    ds_read_b128 v[244:247], v253 offset:37888
    v_mfma_f32_16x16x32_bf16 v[132:135], v[196:199], v[224:227], v[132:135]
    v_cvt_pk_bf16_f32 v116, v116, v117
    v_cvt_pk_bf16_f32 v117, v118, v119
    v_mfma_f32_16x16x32_bf16 v[136:139], v[168:171], v[224:227], v[136:139]
    v_cvt_pk_bf16_f32 v118, v112, v113
    v_cvt_pk_bf16_f32 v119, v114, v115
    v_mfma_f32_16x16x32_bf16 v[140:143], v[172:175], v[224:227], v[140:143]
    s_add_u32 s47, s48, 7168
    buffer_store_dwordx4 v[116:119], v251, s[16:19], s47 offen sc1
    v_mfma_f32_16x16x32_bf16 v[128:131], v[200:203], v[228:231], v[128:131]
    v_cvt_pk_bf16_f32 v124, v124, v125
    v_cvt_pk_bf16_f32 v125, v126, v127
    v_mfma_f32_16x16x32_bf16 v[132:135], v[204:207], v[228:231], v[132:135]
    v_cvt_pk_bf16_f32 v126, v120, v121
    v_cvt_pk_bf16_f32 v127, v122, v123
    v_mfma_f32_16x16x32_bf16 v[136:139], v[192:195], v[228:231], v[136:139]
    s_add_u32 s47, s48, 18432
    buffer_store_dwordx4 v[124:127], v251, s[16:19], s47 offen sc1
    v_mfma_f32_16x16x32_bf16 v[140:143], v[196:199], v[228:231], v[140:143]
    s_waitcnt lgkmcnt(2)
    v_mfma_f32_16x16x32_bf16 v[144:147], v[192:195], v[232:235], v[144:147]
    v_mfma_f32_16x16x32_bf16 v[148:151], v[196:199], v[232:235], v[148:151]
    v_mfma_f32_16x16x32_bf16 v[152:155], v[168:171], v[232:235], v[152:155]
    v_mfma_f32_16x16x32_bf16 v[156:159], v[172:175], v[232:235], v[156:159]
    v_mfma_f32_16x16x32_bf16 v[144:147], v[200:203], v[236:239], v[144:147]
    v_mfma_f32_16x16x32_bf16 v[148:151], v[204:207], v[236:239], v[148:151]
    v_mfma_f32_16x16x32_bf16 v[152:155], v[192:195], v[236:239], v[152:155]
    v_mfma_f32_16x16x32_bf16 v[156:159], v[196:199], v[236:239], v[156:159]
    s_waitcnt lgkmcnt(0)
    v_mfma_f32_16x16x32_bf16 v[160:163], v[192:195], v[240:243], v[160:163]
    v_mfma_f32_16x16x32_bf16 v[164:167], v[168:171], v[240:243], v[164:167]
    v_cvt_pk_bf16_f32 v132, v132, v133
    v_cvt_pk_bf16_f32 v133, v134, v135
    v_mfma_f32_16x16x32_bf16 v[160:163], v[200:203], v[244:247], v[160:163]
    v_cvt_pk_bf16_f32 v134, v128, v129
    v_cvt_pk_bf16_f32 v135, v130, v131
    v_mfma_f32_16x16x32_bf16 v[164:167], v[192:195], v[244:247], v[164:167]
    s_add_u32 s47, s48, 8192
    buffer_store_dwordx4 v[132:135], v251, s[16:19], s47 offen sc1
    s_nop 7
    v_cvt_pk_bf16_f32 v140, v140, v141
    v_cvt_pk_bf16_f32 v141, v142, v143
    v_cvt_pk_bf16_f32 v142, v136, v137
    v_cvt_pk_bf16_f32 v143, v138, v139
    s_add_u32 s47, s48, 19456
    buffer_store_dwordx4 v[140:143], v251, s[16:19], s47 offen sc1
    v_cvt_pk_bf16_f32 v148, v148, v149
    v_cvt_pk_bf16_f32 v149, v150, v151
    v_cvt_pk_bf16_f32 v150, v144, v145
    v_cvt_pk_bf16_f32 v151, v146, v147
    s_add_u32 s47, s48, 9216
    buffer_store_dwordx4 v[148:151], v251, s[16:19], s47 offen sc1
    v_cvt_pk_bf16_f32 v156, v156, v157
    v_cvt_pk_bf16_f32 v157, v158, v159
    v_cvt_pk_bf16_f32 v158, v152, v153
    v_cvt_pk_bf16_f32 v159, v154, v155
    s_add_u32 s47, s48, 20480
    buffer_store_dwordx4 v[156:159], v251, s[16:19], s47 offen sc1
    v_cvt_pk_bf16_f32 v160, v160, v161
    v_cvt_pk_bf16_f32 v161, v162, v163
    s_add_u32 s47, s49, 0
    buffer_store_dwordx2 v[160:161], v252, s[16:19], s47 offen sc1
    v_cvt_pk_bf16_f32 v164, v164, v165
    v_cvt_pk_bf16_f32 v165, v166, v167
    s_add_u32 s47, s49, 11264
    buffer_store_dwordx2 v[164:165], v252, s[16:19], s47 offen sc1
L_epi_done:
    s_endpgm
L_fz_helper:
    s_sub_u32 s10, s10, 4
    v_and_b32 v217, 15, v0
    v_lshrrev_b32 v218, 4, v0
    v_lshlrev_b32 v231, 4, v0
    v_add_u32 v231, 116736, v231
    v_mov_b32 v230, 0
    s_mov_b32 s30, 0x05040100
    s_mov_b32 s31, 0x07060302
    s_mov_b32 s32, 0x01000100
    s_mov_b32 s33, 0x03020302
    s_mov_b32 s40, s2
    s_add_u32 s42, s2, 256
    s_mov_b32 s55, -1
    s_mov_b32 s41, 129024
    s_mov_b32 s43, 0
    v_lshlrev_b32 v232, 14, v218
    v_lshl_add_u32 v232, v217, 4, v232
    v_lshlrev_b32 v233, 22, v218
    v_lshrrev_b32 v221, 2, v217
    v_lshl_add_u32 v233, v221, 6, v233
    v_and_b32 v221, 1, v217
    v_lshl_add_u32 v233, v221, 5, v233
    v_bfe_u32 v221, v217, 1, 1
    v_lshl_add_u32 v233, v221, 3, v233
    v_lshrrev_b32 v221, 2, v217
    s_mov_b32 s24, 688128
    v_mul_u32_u24 v234, s24, v221
    s_mov_b32 s24, 43008
    v_mad_u32_u24 v234, v218, s24, v234
    s_mov_b32 s24, 32768
    v_mul_u32_u24 v235, s24, v218
    s_cmp_ge_u32 s40, 736
    s_cbranch_scc1 L_rm0
    s_sub_u32 s28, s40, 64
    s_add_u32 s29, s40, 672
    s_cmp_ge_u32 s40, 64
    s_cselect_b32 s40, s28, s29
L_rm0:
    s_cmp_ge_u32 s42, 736
    s_cbranch_scc1 L_rm1
    s_sub_u32 s28, s42, 64
    s_add_u32 s29, s42, 672
    s_cmp_ge_u32 s42, 64
    s_cselect_b32 s42, s28, s29
L_rm1:
    s_waitcnt lgkmcnt(0)
    s_mov_b32 s16, s38
    s_and_b32 s17, s39, 0xffff
    s_mov_b32 s18, 268435456
    s_mov_b32 s19, 0x00020000
    s_mov_b32 s44, s36
    s_and_b32 s45, s37, 0xffff
    s_mov_b32 s46, 256
    s_mov_b32 s47, 0x00020000
    s_or_b32 s24, s2, s10
    s_cmp_lg_u32 s24, 0
    s_cbranch_scc1 L_nononce
    s_memrealtime s[24:25]
    s_waitcnt lgkmcnt(0)
    s_or_b32 s24, s24, 1
    v_mov_b32 v237, s24
    s_mov_b64 exec, 1
    buffer_store_dword v237, v230, s[44:47], 0 offen offset:128 sc1
    s_mov_b64 exec, -1
L_nononce:
    s_mov_b32 s54, 0
    s_cmp_ge_u32 s40, 1696
    s_cbranch_scc1 L_ld_done2
    s_cmp_ge_u32 s40, 672
    s_cbranch_scc1 L_ld_w2
    s_cmp_ge_u32 s40, 336
    s_cselect_b32 s11, 1, 0
    s_mul_i32 s12, s11, 336
    s_sub_u32 s12, s40, s12
    s_and_b32 s13, s12, 7
    s_lshr_b32 s14, s12, 3
    s_lshl_b32 s14, s14, 2
    s_add_u32 s14, s14, s10
    s_mul_i32 s15, s11, 16384000
    s_add_u32 s34, s4, s15
    s_addc_u32 s35, s5, 0
    s_mov_b32 s20, s34
    s_and_b32 s21, s35, 0xffff
    s_mov_b32 s22, 16384000
    s_mov_b32 s23, 0x00020000
    s_mul_i32 s15, s14, 98304
    s_lshl_b32 s24, s13, 8
    s_add_u32 s15, s15, s24
    s_add_u32 s25, s15, 0
    buffer_load_dwordx4 v[8:11], v232, s[20:23], s25 offen
    s_add_u32 s25, s15, 2048
    buffer_load_dwordx4 v[12:15], v232, s[20:23], s25 offen
    s_add_u32 s25, s15, 4096
    buffer_load_dwordx4 v[16:19], v232, s[20:23], s25 offen
    s_add_u32 s25, s15, 6144
    buffer_load_dwordx4 v[20:23], v232, s[20:23], s25 offen
    s_add_u32 s25, s15, 8192
    buffer_load_dwordx4 v[24:27], v232, s[20:23], s25 offen
    s_add_u32 s25, s15, 10240
    buffer_load_dwordx4 v[28:31], v232, s[20:23], s25 offen
    s_add_u32 s25, s15, 12288
    buffer_load_dwordx4 v[32:35], v232, s[20:23], s25 offen
    s_add_u32 s25, s15, 14336
    buffer_load_dwordx4 v[36:39], v232, s[20:23], s25 offen
    s_add_u32 s25, s15, 65536
    buffer_load_dwordx4 v[40:43], v232, s[20:23], s25 offen
    s_add_u32 s25, s15, 67584
    buffer_load_dwordx4 v[44:47], v232, s[20:23], s25 offen
    s_add_u32 s25, s15, 69632
    buffer_load_dwordx4 v[48:51], v232, s[20:23], s25 offen
    s_add_u32 s25, s15, 71680
    buffer_load_dwordx4 v[52:55], v232, s[20:23], s25 offen
    s_add_u32 s25, s15, 73728
    buffer_load_dwordx4 v[56:59], v232, s[20:23], s25 offen
    s_add_u32 s25, s15, 75776
    buffer_load_dwordx4 v[60:63], v232, s[20:23], s25 offen
    s_add_u32 s25, s15, 77824
    buffer_load_dwordx4 v[64:67], v232, s[20:23], s25 offen
    s_add_u32 s25, s15, 79872
    buffer_load_dwordx4 v[68:71], v232, s[20:23], s25 offen
    s_branch L_ld_done2
L_ld_w2:
    s_sub_u32 s12, s40, 672
    s_and_b32 s13, s12, 3
    s_lshr_b32 s14, s12, 2
    s_lshl_b32 s14, s14, 2
    s_add_u32 s14, s14, s10
    s_mov_b32 s20, s6
    s_and_b32 s21, s7, 0xffff
    s_mov_b32 s22, 16252928
    s_mov_b32 s23, 0x00020000
    s_lshl_b32 s15, s14, 10
    s_lshl_b32 s24, s13, 8
    s_add_u32 s15, s15, s24
    s_add_u32 s25, s15, 0
    buffer_load_dwordx2 v[8:9], v233, s[20:23], s25 offen
    buffer_load_dwordx2 v[10:11], v233, s[20:23], s25 offen offset:16
    s_add_u32 s25, s15, 1048576
    buffer_load_dwordx2 v[12:13], v233, s[20:23], s25 offen
    buffer_load_dwordx2 v[14:15], v233, s[20:23], s25 offen offset:16
    s_add_u32 s25, s15, 2097152
    buffer_load_dwordx2 v[16:17], v233, s[20:23], s25 offen
    buffer_load_dwordx2 v[18:19], v233, s[20:23], s25 offen offset:16
    s_add_u32 s25, s15, 3145728
    buffer_load_dwordx2 v[20:21], v233, s[20:23], s25 offen
    buffer_load_dwordx2 v[22:23], v233, s[20:23], s25 offen offset:16
L_ld_done2:
    v_lshrrev_b32 v221, 2, v217
    v_lshlrev_b32 v221, 1, v221
    v_bfe_u32 v222, v217, 1, 1
    v_add_u32 v221, v221, v222
    s_lshl_b32 s24, s10, 3
    v_add_u32 v221, s24, v221
    v_lshl_add_u32 v221, v221, 1, 1
    v_and_b32 v222, 1, v217
    v_lshlrev_b32 v222, 5, v222
    v_lshlrev_b32 v223, 3, v218
    v_mad_u32_u24 v168, v221, v223, v222
    v_add_u32 v169, v168, v221
    v_add_u32 v170, v169, v221
    v_add_u32 v171, v170, v221
    v_add_u32 v172, v171, v221
    v_add_u32 v173, v172, v221
    v_add_u32 v174, v173, v221
    v_add_u32 v175, v174, v221
    v_and_b32 v168, 127, v168
    v_cvt_f32_u32 v168, v168
    v_mul_f32 v168, 0x3c000000, v168
    v_cos_f32 v168, v168
    v_and_b32 v169, 127, v169
    v_cvt_f32_u32 v169, v169
    v_mul_f32 v169, 0x3c000000, v169
    v_cos_f32 v169, v169
    v_and_b32 v170, 127, v170
    v_cvt_f32_u32 v170, v170
    v_mul_f32 v170, 0x3c000000, v170
    v_cos_f32 v170, v170
    v_and_b32 v171, 127, v171
    v_cvt_f32_u32 v171, v171
    v_mul_f32 v171, 0x3c000000, v171
    v_cos_f32 v171, v171
    v_and_b32 v172, 127, v172
    v_cvt_f32_u32 v172, v172
    v_mul_f32 v172, 0x3c000000, v172
    v_cos_f32 v172, v172
    v_and_b32 v173, 127, v173
    v_cvt_f32_u32 v173, v173
    v_mul_f32 v173, 0x3c000000, v173
    v_cos_f32 v173, v173
    v_and_b32 v174, 127, v174
    v_cvt_f32_u32 v174, v174
    v_mul_f32 v174, 0x3c000000, v174
    v_cos_f32 v174, v174
    v_and_b32 v175, 127, v175
    v_cvt_f32_u32 v175, v175
    v_mul_f32 v175, 0x3c000000, v175
    v_cos_f32 v175, v175
    v_cvt_pk_bf16_f32 v184, v168, v169
    v_cvt_pk_bf16_f32 v185, v170, v171
    v_cvt_pk_bf16_f32 v186, v172, v173
    v_cvt_pk_bf16_f32 v187, v174, v175
    s_lshl_b32 s24, s10, 11
    v_add_u32 v224, s24, v231
    ds_write_b128 v224, v[184:187] offset:0
    v_lshlrev_b32 v223, 3, v218
    v_add_u32 v223, 32, v223
    v_mad_u32_u24 v168, v221, v223, v222
    v_add_u32 v169, v168, v221
    v_add_u32 v170, v169, v221
    v_add_u32 v171, v170, v221
    v_add_u32 v172, v171, v221
    v_add_u32 v173, v172, v221
    v_add_u32 v174, v173, v221
    v_add_u32 v175, v174, v221
    v_and_b32 v168, 127, v168
    v_cvt_f32_u32 v168, v168
    v_mul_f32 v168, 0x3c000000, v168
    v_cos_f32 v168, v168
    v_and_b32 v169, 127, v169
    v_cvt_f32_u32 v169, v169
    v_mul_f32 v169, 0x3c000000, v169
    v_cos_f32 v169, v169
    v_and_b32 v170, 127, v170
    v_cvt_f32_u32 v170, v170
    v_mul_f32 v170, 0x3c000000, v170
    v_cos_f32 v170, v170
    v_and_b32 v171, 127, v171
    v_cvt_f32_u32 v171, v171
    v_mul_f32 v171, 0x3c000000, v171
    v_cos_f32 v171, v171
    v_and_b32 v172, 127, v172
    v_cvt_f32_u32 v172, v172
    v_mul_f32 v172, 0x3c000000, v172
    v_cos_f32 v172, v172
    v_and_b32 v173, 127, v173
    v_cvt_f32_u32 v173, v173
    v_mul_f32 v173, 0x3c000000, v173
    v_cos_f32 v173, v173
    v_and_b32 v174, 127, v174
    v_cvt_f32_u32 v174, v174
    v_mul_f32 v174, 0x3c000000, v174
    v_cos_f32 v174, v174
    v_and_b32 v175, 127, v175
    v_cvt_f32_u32 v175, v175
    v_mul_f32 v175, 0x3c000000, v175
    v_cos_f32 v175, v175
    v_cvt_pk_bf16_f32 v184, v168, v169
    v_cvt_pk_bf16_f32 v185, v170, v171
    v_cvt_pk_bf16_f32 v186, v172, v173
    v_cvt_pk_bf16_f32 v187, v174, v175
    s_lshl_b32 s24, s10, 11
    v_add_u32 v224, s24, v231
    ds_write_b128 v224, v[184:187] offset:1024
    v_lshlrev_b32 v223, 2, v218
    v_mad_u32_u24 v168, v221, v223, v222
    v_add_u32 v169, v168, v221
    v_add_u32 v170, v169, v221
    v_add_u32 v171, v170, v221
    v_and_b32 v168, 127, v168
    v_cvt_f32_u32 v168, v168
    v_mul_f32 v168, 0x3c000000, v168
    v_cos_f32 v168, v168
    v_and_b32 v169, 127, v169
    v_cvt_f32_u32 v169, v169
    v_mul_f32 v169, 0x3c000000, v169
    v_cos_f32 v169, v169
    v_and_b32 v170, 127, v170
    v_cvt_f32_u32 v170, v170
    v_mul_f32 v170, 0x3c000000, v170
    v_cos_f32 v170, v170
    v_and_b32 v171, 127, v171
    v_cvt_f32_u32 v171, v171
    v_mul_f32 v171, 0x3c000000, v171
    v_cos_f32 v171, v171
    v_cvt_pk_bf16_f32 v188, v168, v168
    v_lshlrev_b32 v189, 16, v188
    v_sub_f32 v189, v168, v189
    v_cvt_pk_bf16_f32 v189, v189, v189
    v_perm_b32 v184, v189, v188, s30
    v_cvt_pk_bf16_f32 v188, v169, v169
    v_lshlrev_b32 v189, 16, v188
    v_sub_f32 v189, v169, v189
    v_cvt_pk_bf16_f32 v189, v189, v189
    v_perm_b32 v185, v189, v188, s30
    v_cvt_pk_bf16_f32 v188, v170, v170
    v_lshlrev_b32 v189, 16, v188
    v_sub_f32 v189, v170, v189
    v_cvt_pk_bf16_f32 v189, v189, v189
    v_perm_b32 v186, v189, v188, s30
    v_cvt_pk_bf16_f32 v188, v171, v171
    v_lshlrev_b32 v189, 16, v188
    v_sub_f32 v189, v171, v189
    v_cvt_pk_bf16_f32 v189, v189, v189
    v_perm_b32 v187, v189, v188, s30
    s_lshl_b32 s24, s10, 10
    v_add_u32 v224, s24, v231
    ds_write_b128 v224, v[184:187] offset:8192
    s_waitcnt lgkmcnt(0)
    s_barrier
L_x_loop:
    s_cmp_lg_u32 s10, 0
    s_cbranch_scc1 L_nofetch0
    v_mov_b32 v229, 1
    s_mov_b64 exec, 1
    buffer_atomic_add v229, v230, s[44:47], 0 offen sc0 sc1
    s_mov_b64 exec, -1
L_nofetch0:
    s_cmp_ge_u32 s42, 1696
    s_cbranch_scc1 L_ld_done3
    s_cmp_ge_u32 s42, 672
    s_cbranch_scc1 L_ld_w3
    s_cmp_ge_u32 s42, 336
    s_cselect_b32 s11, 1, 0
    s_mul_i32 s12, s11, 336
    s_sub_u32 s12, s42, s12
    s_and_b32 s13, s12, 7
    s_lshr_b32 s14, s12, 3
    s_lshl_b32 s14, s14, 2
    s_add_u32 s14, s14, s10
    s_mul_i32 s15, s11, 16384000
    s_add_u32 s34, s4, s15
    s_addc_u32 s35, s5, 0
    s_mov_b32 s20, s34
    s_and_b32 s21, s35, 0xffff
    s_mov_b32 s22, 16384000
    s_mov_b32 s23, 0x00020000
    s_mul_i32 s15, s14, 98304
    s_lshl_b32 s24, s13, 8
    s_add_u32 s15, s15, s24
    s_add_u32 s25, s15, 0
    buffer_load_dwordx4 v[72:75], v232, s[20:23], s25 offen
    s_add_u32 s25, s15, 2048
    buffer_load_dwordx4 v[76:79], v232, s[20:23], s25 offen
    s_add_u32 s25, s15, 4096
    buffer_load_dwordx4 v[80:83], v232, s[20:23], s25 offen
    s_add_u32 s25, s15, 6144
    buffer_load_dwordx4 v[84:87], v232, s[20:23], s25 offen
    s_add_u32 s25, s15, 8192
    buffer_load_dwordx4 v[88:91], v232, s[20:23], s25 offen
    s_add_u32 s25, s15, 10240
    buffer_load_dwordx4 v[92:95], v232, s[20:23], s25 offen
    s_add_u32 s25, s15, 12288
    buffer_load_dwordx4 v[96:99], v232, s[20:23], s25 offen
    s_add_u32 s25, s15, 14336
    buffer_load_dwordx4 v[100:103], v232, s[20:23], s25 offen
    s_add_u32 s25, s15, 65536
    buffer_load_dwordx4 v[104:107], v232, s[20:23], s25 offen
    s_add_u32 s25, s15, 67584
    buffer_load_dwordx4 v[108:111], v232, s[20:23], s25 offen
    s_add_u32 s25, s15, 69632
    buffer_load_dwordx4 v[112:115], v232, s[20:23], s25 offen
    s_add_u32 s25, s15, 71680
    buffer_load_dwordx4 v[116:119], v232, s[20:23], s25 offen
    s_add_u32 s25, s15, 73728
    buffer_load_dwordx4 v[120:123], v232, s[20:23], s25 offen
    s_add_u32 s25, s15, 75776
    buffer_load_dwordx4 v[124:127], v232, s[20:23], s25 offen
    s_add_u32 s25, s15, 77824
    buffer_load_dwordx4 v[128:131], v232, s[20:23], s25 offen
    s_add_u32 s25, s15, 79872
    buffer_load_dwordx4 v[132:135], v232, s[20:23], s25 offen
    s_branch L_ld_done3
L_ld_w3:
    s_sub_u32 s12, s42, 672
    s_and_b32 s13, s12, 3
    s_lshr_b32 s14, s12, 2
    s_lshl_b32 s14, s14, 2
    s_add_u32 s14, s14, s10
    s_mov_b32 s20, s6
    s_and_b32 s21, s7, 0xffff
    s_mov_b32 s22, 16252928
    s_mov_b32 s23, 0x00020000
    s_lshl_b32 s15, s14, 10
    s_lshl_b32 s24, s13, 8
    s_add_u32 s15, s15, s24
    s_add_u32 s25, s15, 0
    buffer_load_dwordx2 v[72:73], v233, s[20:23], s25 offen
    buffer_load_dwordx2 v[74:75], v233, s[20:23], s25 offen offset:16
    s_add_u32 s25, s15, 1048576
    buffer_load_dwordx2 v[76:77], v233, s[20:23], s25 offen
    buffer_load_dwordx2 v[78:79], v233, s[20:23], s25 offen offset:16
    s_add_u32 s25, s15, 2097152
    buffer_load_dwordx2 v[80:81], v233, s[20:23], s25 offen
    buffer_load_dwordx2 v[82:83], v233, s[20:23], s25 offen offset:16
    s_add_u32 s25, s15, 3145728
    buffer_load_dwordx2 v[84:85], v233, s[20:23], s25 offen
    buffer_load_dwordx2 v[86:87], v233, s[20:23], s25 offen offset:16
L_ld_done3:
    s_cmp_lg_u32 s43, 0
    s_cbranch_scc1 L_notfirst
    s_cmp_ge_u32 s42, 1696
    s_cbranch_scc1 L_w0_f
    s_cmp_ge_u32 s42, 672
    s_cbranch_scc1 L_w8_f
    s_waitcnt vmcnt(16)
    s_branch L_wd_f
L_w8_f:
    s_waitcnt vmcnt(8)
    s_branch L_wd_f
L_w0_f:
    s_waitcnt vmcnt(0)
L_wd_f:
    s_mov_b32 s43, 1
    s_branch L_wfin
L_notfirst:
    s_cmp_ge_u32 s42, 1696
    s_cbranch_scc1 L_w0_a0
    s_cmp_ge_u32 s42, 672
    s_cbranch_scc1 L_w8_a0
    s_waitcnt vmcnt(32)
    s_branch L_wd_a0
L_w8_a0:
    s_waitcnt vmcnt(24)
    s_branch L_wd_a0
L_w0_a0:
    s_waitcnt vmcnt(16)
L_wd_a0:
L_wfin:
    s_cmp_ge_u32 s40, 672
    s_cbranch_scc1 L_cw0
    s_cmp_ge_u32 s40, 336
    s_cselect_b32 s11, 1, 0
    s_mul_i32 s12, s11, 336
    s_sub_u32 s12, s40, s12
    s_and_b32 s13, s12, 7
    s_lshr_b32 s14, s12, 3
    s_lshl_b32 s14, s14, 2
    s_add_u32 s14, s14, s10
    ds_read_b128 v[136:139], v231 offset:0
    ds_read_b128 v[140:143], v231 offset:1024
    ds_read_b128 v[144:147], v231 offset:2048
    ds_read_b128 v[148:151], v231 offset:3072
    ds_read_b128 v[152:155], v231 offset:4096
    ds_read_b128 v[156:159], v231 offset:5120
    ds_read_b128 v[160:163], v231 offset:6144
    ds_read_b128 v[164:167], v231 offset:7168
    s_bfe_u32 s24, s14, 0x10003
    s_mul_i32 s24, s24, 3
    v_and_b32 v221, 3, v217
    v_xor_b32 v221, s24, v221
    v_lshl_add_u32 v220, v221, 4, v234
    s_mul_i32 s24, s11, 22020096
    s_mul_i32 s25, s13, 2752512
    s_add_u32 s24, s24, s25
    s_lshl_b32 s25, s14, 6
    s_add_u32 s24, s24, s25
    s_add_u32 s24, s24, 67108864
    v_perm_b32 v168, v12, v8, s30
    v_perm_b32 v169, v20, v16, s30
    v_perm_b32 v170, v28, v24, s30
    v_perm_b32 v171, v36, v32, s30
    v_perm_b32 v172, v12, v8, s31
    v_perm_b32 v173, v20, v16, s31
    v_perm_b32 v174, v28, v24, s31
    v_perm_b32 v175, v36, v32, s31
    v_perm_b32 v176, v44, v40, s30
    v_perm_b32 v177, v52, v48, s30
    v_perm_b32 v178, v60, v56, s30
    v_perm_b32 v179, v68, v64, s30
    v_perm_b32 v180, v44, v40, s31
    v_perm_b32 v181, v52, v48, s31
    v_perm_b32 v182, v60, v56, s31
    v_perm_b32 v183, v68, v64, s31
    s_waitcnt lgkmcnt(0)
    v_mfma_f32_16x16x32_bf16 v[184:187], v[136:139], v[168:171], 0
    v_mfma_f32_16x16x32_bf16 v[188:191], v[136:139], v[172:175], 0
    v_mfma_f32_16x16x32_bf16 v[192:195], v[144:147], v[168:171], 0
    v_mfma_f32_16x16x32_bf16 v[196:199], v[144:147], v[172:175], 0
    v_mfma_f32_16x16x32_bf16 v[200:203], v[152:155], v[168:171], 0
    v_mfma_f32_16x16x32_bf16 v[204:207], v[152:155], v[172:175], 0
    v_mfma_f32_16x16x32_bf16 v[208:211], v[160:163], v[168:171], 0
    v_mfma_f32_16x16x32_bf16 v[212:215], v[160:163], v[172:175], 0
    v_mfma_f32_16x16x32_bf16 v[184:187], v[140:143], v[176:179], v[184:187]
    v_mfma_f32_16x16x32_bf16 v[188:191], v[140:143], v[180:183], v[188:191]
    v_mfma_f32_16x16x32_bf16 v[192:195], v[148:151], v[176:179], v[192:195]
    v_mfma_f32_16x16x32_bf16 v[196:199], v[148:151], v[180:183], v[196:199]
    v_mfma_f32_16x16x32_bf16 v[200:203], v[156:159], v[176:179], v[200:203]
    v_mfma_f32_16x16x32_bf16 v[204:207], v[156:159], v[180:183], v[204:207]
    v_mfma_f32_16x16x32_bf16 v[208:211], v[164:167], v[176:179], v[208:211]
    v_mfma_f32_16x16x32_bf16 v[212:215], v[164:167], v[180:183], v[212:215]
    v_perm_b32 v168, v13, v9, s30
    v_perm_b32 v169, v21, v17, s30
    v_perm_b32 v170, v29, v25, s30
    v_perm_b32 v171, v37, v33, s30
    v_perm_b32 v172, v13, v9, s31
    v_perm_b32 v173, v21, v17, s31
    v_perm_b32 v174, v29, v25, s31
    v_perm_b32 v175, v37, v33, s31
    v_perm_b32 v176, v45, v41, s30
    v_perm_b32 v177, v53, v49, s30
    v_perm_b32 v178, v61, v57, s30
    v_perm_b32 v179, v69, v65, s30
    v_perm_b32 v180, v45, v41, s31
    v_perm_b32 v181, v53, v49, s31
    v_perm_b32 v182, v61, v57, s31
    v_perm_b32 v183, v69, v65, s31
    v_cvt_pk_bf16_f32 v8, v184, v188
    v_cvt_pk_bf16_f32 v12, v185, v189
    v_cvt_pk_bf16_f32 v16, v186, v190
    v_cvt_pk_bf16_f32 v20, v187, v191
    v_cvt_pk_bf16_f32 v24, v192, v196
    v_cvt_pk_bf16_f32 v28, v193, v197
    v_cvt_pk_bf16_f32 v32, v194, v198
    v_cvt_pk_bf16_f32 v36, v195, v199
    v_cvt_pk_bf16_f32 v40, v200, v204
    v_cvt_pk_bf16_f32 v44, v201, v205
    v_cvt_pk_bf16_f32 v48, v202, v206
    v_cvt_pk_bf16_f32 v52, v203, v207
    v_cvt_pk_bf16_f32 v56, v208, v212
    v_cvt_pk_bf16_f32 v60, v209, v213
    v_cvt_pk_bf16_f32 v64, v210, v214
    v_cvt_pk_bf16_f32 v68, v211, v215
    v_mfma_f32_16x16x32_bf16 v[184:187], v[136:139], v[168:171], 0
    v_mfma_f32_16x16x32_bf16 v[188:191], v[136:139], v[172:175], 0
    v_mfma_f32_16x16x32_bf16 v[192:195], v[144:147], v[168:171], 0
    v_mfma_f32_16x16x32_bf16 v[196:199], v[144:147], v[172:175], 0
    v_mfma_f32_16x16x32_bf16 v[200:203], v[152:155], v[168:171], 0
    v_mfma_f32_16x16x32_bf16 v[204:207], v[152:155], v[172:175], 0
    v_mfma_f32_16x16x32_bf16 v[208:211], v[160:163], v[168:171], 0
    v_mfma_f32_16x16x32_bf16 v[212:215], v[160:163], v[172:175], 0
    v_mfma_f32_16x16x32_bf16 v[184:187], v[140:143], v[176:179], v[184:187]
    v_mfma_f32_16x16x32_bf16 v[188:191], v[140:143], v[180:183], v[188:191]
    v_mfma_f32_16x16x32_bf16 v[192:195], v[148:151], v[176:179], v[192:195]
    v_mfma_f32_16x16x32_bf16 v[196:199], v[148:151], v[180:183], v[196:199]
    v_mfma_f32_16x16x32_bf16 v[200:203], v[156:159], v[176:179], v[200:203]
    v_mfma_f32_16x16x32_bf16 v[204:207], v[156:159], v[180:183], v[204:207]
    v_mfma_f32_16x16x32_bf16 v[208:211], v[164:167], v[176:179], v[208:211]
    v_mfma_f32_16x16x32_bf16 v[212:215], v[164:167], v[180:183], v[212:215]
    v_perm_b32 v168, v14, v10, s30
    v_perm_b32 v169, v22, v18, s30
    v_perm_b32 v170, v30, v26, s30
    v_perm_b32 v171, v38, v34, s30
    v_perm_b32 v172, v14, v10, s31
    v_perm_b32 v173, v22, v18, s31
    v_perm_b32 v174, v30, v26, s31
    v_perm_b32 v175, v38, v34, s31
    v_perm_b32 v176, v46, v42, s30
    v_perm_b32 v177, v54, v50, s30
    v_perm_b32 v178, v62, v58, s30
    v_perm_b32 v179, v70, v66, s30
    v_perm_b32 v180, v46, v42, s31
    v_perm_b32 v181, v54, v50, s31
    v_perm_b32 v182, v62, v58, s31
    v_perm_b32 v183, v70, v66, s31
    v_cvt_pk_bf16_f32 v9, v184, v188
    v_cvt_pk_bf16_f32 v13, v185, v189
    v_cvt_pk_bf16_f32 v17, v186, v190
    v_cvt_pk_bf16_f32 v21, v187, v191
    v_cvt_pk_bf16_f32 v25, v192, v196
    v_cvt_pk_bf16_f32 v29, v193, v197
    v_cvt_pk_bf16_f32 v33, v194, v198
    v_cvt_pk_bf16_f32 v37, v195, v199
    v_cvt_pk_bf16_f32 v41, v200, v204
    v_cvt_pk_bf16_f32 v45, v201, v205
    v_cvt_pk_bf16_f32 v49, v202, v206
    v_cvt_pk_bf16_f32 v53, v203, v207
    v_cvt_pk_bf16_f32 v57, v208, v212
    v_cvt_pk_bf16_f32 v61, v209, v213
    v_cvt_pk_bf16_f32 v65, v210, v214
    v_cvt_pk_bf16_f32 v69, v211, v215
    v_mfma_f32_16x16x32_bf16 v[184:187], v[136:139], v[168:171], 0
    v_mfma_f32_16x16x32_bf16 v[188:191], v[136:139], v[172:175], 0
    v_mfma_f32_16x16x32_bf16 v[192:195], v[144:147], v[168:171], 0
    v_mfma_f32_16x16x32_bf16 v[196:199], v[144:147], v[172:175], 0
    v_mfma_f32_16x16x32_bf16 v[200:203], v[152:155], v[168:171], 0
    v_mfma_f32_16x16x32_bf16 v[204:207], v[152:155], v[172:175], 0
    v_mfma_f32_16x16x32_bf16 v[208:211], v[160:163], v[168:171], 0
    v_mfma_f32_16x16x32_bf16 v[212:215], v[160:163], v[172:175], 0
    v_mfma_f32_16x16x32_bf16 v[184:187], v[140:143], v[176:179], v[184:187]
    v_mfma_f32_16x16x32_bf16 v[188:191], v[140:143], v[180:183], v[188:191]
    v_mfma_f32_16x16x32_bf16 v[192:195], v[148:151], v[176:179], v[192:195]
    v_mfma_f32_16x16x32_bf16 v[196:199], v[148:151], v[180:183], v[196:199]
    v_mfma_f32_16x16x32_bf16 v[200:203], v[156:159], v[176:179], v[200:203]
    v_mfma_f32_16x16x32_bf16 v[204:207], v[156:159], v[180:183], v[204:207]
    v_mfma_f32_16x16x32_bf16 v[208:211], v[164:167], v[176:179], v[208:211]
    v_mfma_f32_16x16x32_bf16 v[212:215], v[164:167], v[180:183], v[212:215]
    v_perm_b32 v168, v15, v11, s30
    v_perm_b32 v169, v23, v19, s30
    v_perm_b32 v170, v31, v27, s30
    v_perm_b32 v171, v39, v35, s30
    v_perm_b32 v172, v15, v11, s31
    v_perm_b32 v173, v23, v19, s31
    v_perm_b32 v174, v31, v27, s31
    v_perm_b32 v175, v39, v35, s31
    v_perm_b32 v176, v47, v43, s30
    v_perm_b32 v177, v55, v51, s30
    v_perm_b32 v178, v63, v59, s30
    v_perm_b32 v179, v71, v67, s30
    v_perm_b32 v180, v47, v43, s31
    v_perm_b32 v181, v55, v51, s31
    v_perm_b32 v182, v63, v59, s31
    v_perm_b32 v183, v71, v67, s31
    v_cvt_pk_bf16_f32 v10, v184, v188
    v_cvt_pk_bf16_f32 v14, v185, v189
    v_cvt_pk_bf16_f32 v18, v186, v190
    v_cvt_pk_bf16_f32 v22, v187, v191
    v_cvt_pk_bf16_f32 v26, v192, v196
    v_cvt_pk_bf16_f32 v30, v193, v197
    v_cvt_pk_bf16_f32 v34, v194, v198
    v_cvt_pk_bf16_f32 v38, v195, v199
    v_cvt_pk_bf16_f32 v42, v200, v204
    v_cvt_pk_bf16_f32 v46, v201, v205
    v_cvt_pk_bf16_f32 v50, v202, v206
    v_cvt_pk_bf16_f32 v54, v203, v207
    v_cvt_pk_bf16_f32 v58, v208, v212
    v_cvt_pk_bf16_f32 v62, v209, v213
    v_cvt_pk_bf16_f32 v66, v210, v214
    v_cvt_pk_bf16_f32 v70, v211, v215
    v_mfma_f32_16x16x32_bf16 v[184:187], v[136:139], v[168:171], 0
    v_mfma_f32_16x16x32_bf16 v[188:191], v[136:139], v[172:175], 0
    v_mfma_f32_16x16x32_bf16 v[192:195], v[144:147], v[168:171], 0
    v_mfma_f32_16x16x32_bf16 v[196:199], v[144:147], v[172:175], 0
    v_mfma_f32_16x16x32_bf16 v[200:203], v[152:155], v[168:171], 0
    v_mfma_f32_16x16x32_bf16 v[204:207], v[152:155], v[172:175], 0
    v_mfma_f32_16x16x32_bf16 v[208:211], v[160:163], v[168:171], 0
    v_mfma_f32_16x16x32_bf16 v[212:215], v[160:163], v[172:175], 0
    v_mfma_f32_16x16x32_bf16 v[184:187], v[140:143], v[176:179], v[184:187]
    v_mfma_f32_16x16x32_bf16 v[188:191], v[140:143], v[180:183], v[188:191]
    v_mfma_f32_16x16x32_bf16 v[192:195], v[148:151], v[176:179], v[192:195]
    v_mfma_f32_16x16x32_bf16 v[196:199], v[148:151], v[180:183], v[196:199]
    v_mfma_f32_16x16x32_bf16 v[200:203], v[156:159], v[176:179], v[200:203]
    v_mfma_f32_16x16x32_bf16 v[204:207], v[156:159], v[180:183], v[204:207]
    v_mfma_f32_16x16x32_bf16 v[208:211], v[164:167], v[176:179], v[208:211]
    v_mfma_f32_16x16x32_bf16 v[212:215], v[164:167], v[180:183], v[212:215]
    s_nop 1
    v_cvt_pk_bf16_f32 v11, v184, v188
    v_cvt_pk_bf16_f32 v15, v185, v189
    v_cvt_pk_bf16_f32 v19, v186, v190
    v_cvt_pk_bf16_f32 v23, v187, v191
    v_cvt_pk_bf16_f32 v27, v192, v196
    v_cvt_pk_bf16_f32 v31, v193, v197
    v_cvt_pk_bf16_f32 v35, v194, v198
    v_cvt_pk_bf16_f32 v39, v195, v199
    v_cvt_pk_bf16_f32 v43, v200, v204
    v_cvt_pk_bf16_f32 v47, v201, v205
    v_cvt_pk_bf16_f32 v51, v202, v206
    v_cvt_pk_bf16_f32 v55, v203, v207
    v_cvt_pk_bf16_f32 v59, v208, v212
    v_cvt_pk_bf16_f32 v63, v209, v213
    v_cvt_pk_bf16_f32 v67, v210, v214
    v_cvt_pk_bf16_f32 v71, v211, v215
    s_add_u32 s25, s24, 0
    buffer_store_dwordx4 v[8:11], v220, s[16:19], s25 offen sc1
    s_add_u32 s25, s24, 10752
    buffer_store_dwordx4 v[12:15], v220, s[16:19], s25 offen sc1
    s_add_u32 s25, s24, 21504
    buffer_store_dwordx4 v[16:19], v220, s[16:19], s25 offen sc1
    s_add_u32 s25, s24, 32256
    buffer_store_dwordx4 v[20:23], v220, s[16:19], s25 offen sc1
    s_add_u32 s25, s24, 172032
    buffer_store_dwordx4 v[24:27], v220, s[16:19], s25 offen sc1
    s_add_u32 s25, s24, 182784
    buffer_store_dwordx4 v[28:31], v220, s[16:19], s25 offen sc1
    s_add_u32 s25, s24, 193536
    buffer_store_dwordx4 v[32:35], v220, s[16:19], s25 offen sc1
    s_add_u32 s25, s24, 204288
    buffer_store_dwordx4 v[36:39], v220, s[16:19], s25 offen sc1
    s_add_u32 s25, s24, 344064
    buffer_store_dwordx4 v[40:43], v220, s[16:19], s25 offen sc1
    s_add_u32 s25, s24, 354816
    buffer_store_dwordx4 v[44:47], v220, s[16:19], s25 offen sc1
    s_add_u32 s25, s24, 365568
    buffer_store_dwordx4 v[48:51], v220, s[16:19], s25 offen sc1
    s_add_u32 s25, s24, 376320
    buffer_store_dwordx4 v[52:55], v220, s[16:19], s25 offen sc1
    s_add_u32 s25, s24, 516096
    buffer_store_dwordx4 v[56:59], v220, s[16:19], s25 offen sc1
    s_add_u32 s25, s24, 526848
    buffer_store_dwordx4 v[60:63], v220, s[16:19], s25 offen sc1
    s_add_u32 s25, s24, 537600
    buffer_store_dwordx4 v[64:67], v220, s[16:19], s25 offen sc1
    s_add_u32 s25, s24, 548352
    buffer_store_dwordx4 v[68:71], v220, s[16:19], s25 offen sc1
    s_branch L_next0
L_cw0:
    s_sub_u32 s12, s40, 672
    s_and_b32 s13, s12, 3
    s_lshr_b32 s14, s12, 2
    s_lshl_b32 s14, s14, 2
    s_add_u32 s14, s14, s10
    ds_read_b128 v[136:139], v231 offset:8192
    ds_read_b128 v[140:143], v231 offset:9216
    ds_read_b128 v[144:147], v231 offset:10240
    ds_read_b128 v[148:151], v231 offset:11264
    s_and_b32 s24, s14, 3
    s_bfe_u32 s25, s14, 0x10003
    s_lshl_b32 s25, s25, 2
    s_or_b32 s24, s24, s25
    s_lshl_b32 s24, s24, 1
    v_xor_b32 v221, s24, v217
    v_lshl_add_u32 v220, v221, 4, v235
    s_mul_i32 s24, s13, 16777216
    s_lshr_b32 s25, s14, 5
    s_mul_i32 s25, s25, 524288
    s_add_u32 s24, s24, s25
    s_and_b32 s25, s14, 31
    s_lshl_b32 s25, s25, 8
    s_add_u32 s24, s24, s25
    v_perm_b32 v24, v8, v8, s32
    v_perm_b32 v25, v12, v12, s32
    v_perm_b32 v26, v16, v16, s32
    v_perm_b32 v27, v20, v20, s32
    v_perm_b32 v28, v8, v8, s33
    v_perm_b32 v29, v12, v12, s33
    v_perm_b32 v30, v16, v16, s33
    v_perm_b32 v31, v20, v20, s33
    v_perm_b32 v32, v9, v9, s32
    v_perm_b32 v33, v13, v13, s32
    v_perm_b32 v34, v17, v17, s32
    v_perm_b32 v35, v21, v21, s32
    v_perm_b32 v36, v9, v9, s33
    v_perm_b32 v37, v13, v13, s33
    v_perm_b32 v38, v17, v17, s33
    v_perm_b32 v39, v21, v21, s33
    v_perm_b32 v40, v10, v10, s32
    v_perm_b32 v41, v14, v14, s32
    v_perm_b32 v42, v18, v18, s32
    v_perm_b32 v43, v22, v22, s32
    v_perm_b32 v44, v10, v10, s33
    v_perm_b32 v45, v14, v14, s33
    v_perm_b32 v46, v18, v18, s33
    v_perm_b32 v47, v22, v22, s33
    v_perm_b32 v48, v11, v11, s32
    v_perm_b32 v49, v15, v15, s32
    v_perm_b32 v50, v19, v19, s32
    v_perm_b32 v51, v23, v23, s32
    v_perm_b32 v52, v11, v11, s33
    v_perm_b32 v53, v15, v15, s33
    v_perm_b32 v54, v19, v19, s33
    v_perm_b32 v55, v23, v23, s33
    s_waitcnt lgkmcnt(0)
    v_mfma_f32_16x16x32_bf16 v[184:187], v[136:139], v[24:27], 0
    v_mfma_f32_16x16x32_bf16 v[188:191], v[136:139], v[28:31], 0
    v_mfma_f32_16x16x32_bf16 v[192:195], v[136:139], v[32:35], 0
    v_mfma_f32_16x16x32_bf16 v[196:199], v[136:139], v[36:39], 0
    v_mfma_f32_16x16x32_bf16 v[200:203], v[136:139], v[40:43], 0
    v_mfma_f32_16x16x32_bf16 v[204:207], v[136:139], v[44:47], 0
    v_mfma_f32_16x16x32_bf16 v[208:211], v[136:139], v[48:51], 0
    v_mfma_f32_16x16x32_bf16 v[212:215], v[136:139], v[52:55], 0
    s_nop 1
    v_cvt_pk_bf16_f32 v8, v184, v188
    s_nop 0
    v_cvt_pk_bf16_f32 v9, v192, v196
    s_nop 0
    v_cvt_pk_bf16_f32 v10, v200, v204
    s_nop 0
    v_cvt_pk_bf16_f32 v11, v208, v212
    v_cvt_pk_bf16_f32 v12, v185, v189
    v_cvt_pk_bf16_f32 v13, v193, v197
    v_cvt_pk_bf16_f32 v14, v201, v205
    v_cvt_pk_bf16_f32 v15, v209, v213
    v_cvt_pk_bf16_f32 v16, v186, v190
    v_cvt_pk_bf16_f32 v17, v194, v198
    v_cvt_pk_bf16_f32 v18, v202, v206
    v_cvt_pk_bf16_f32 v19, v210, v214
    v_cvt_pk_bf16_f32 v20, v187, v191
    v_cvt_pk_bf16_f32 v21, v195, v199
    v_cvt_pk_bf16_f32 v22, v203, v207
    v_cvt_pk_bf16_f32 v23, v211, v215
    s_add_u32 s25, s24, 0
    buffer_store_dwordx4 v[8:11], v220, s[16:19], s25 offen sc1
    s_add_u32 s25, s24, 8192
    buffer_store_dwordx4 v[12:15], v220, s[16:19], s25 offen sc1
    s_add_u32 s25, s24, 16384
    buffer_store_dwordx4 v[16:19], v220, s[16:19], s25 offen sc1
    s_add_u32 s25, s24, 24576
    buffer_store_dwordx4 v[20:23], v220, s[16:19], s25 offen sc1
    v_mfma_f32_16x16x32_bf16 v[184:187], v[140:143], v[24:27], 0
    v_mfma_f32_16x16x32_bf16 v[188:191], v[140:143], v[28:31], 0
    v_mfma_f32_16x16x32_bf16 v[192:195], v[140:143], v[32:35], 0
    v_mfma_f32_16x16x32_bf16 v[196:199], v[140:143], v[36:39], 0
    v_mfma_f32_16x16x32_bf16 v[200:203], v[140:143], v[40:43], 0
    v_mfma_f32_16x16x32_bf16 v[204:207], v[140:143], v[44:47], 0
    v_mfma_f32_16x16x32_bf16 v[208:211], v[140:143], v[48:51], 0
    v_mfma_f32_16x16x32_bf16 v[212:215], v[140:143], v[52:55], 0
    s_nop 1
    v_cvt_pk_bf16_f32 v56, v184, v188
    s_nop 0
    v_cvt_pk_bf16_f32 v57, v192, v196
    s_nop 0
    v_cvt_pk_bf16_f32 v58, v200, v204
    s_nop 0
    v_cvt_pk_bf16_f32 v59, v208, v212
    v_cvt_pk_bf16_f32 v60, v185, v189
    v_cvt_pk_bf16_f32 v61, v193, v197
    v_cvt_pk_bf16_f32 v62, v201, v205
    v_cvt_pk_bf16_f32 v63, v209, v213
    v_cvt_pk_bf16_f32 v64, v186, v190
    v_cvt_pk_bf16_f32 v65, v194, v198
    v_cvt_pk_bf16_f32 v66, v202, v206
    v_cvt_pk_bf16_f32 v67, v210, v214
    v_cvt_pk_bf16_f32 v68, v187, v191
    v_cvt_pk_bf16_f32 v69, v195, v199
    v_cvt_pk_bf16_f32 v70, v203, v207
    v_cvt_pk_bf16_f32 v71, v211, v215
    s_add_u32 s25, s24, 131072
    buffer_store_dwordx4 v[56:59], v220, s[16:19], s25 offen sc1
    s_add_u32 s25, s24, 139264
    buffer_store_dwordx4 v[60:63], v220, s[16:19], s25 offen sc1
    s_add_u32 s25, s24, 147456
    buffer_store_dwordx4 v[64:67], v220, s[16:19], s25 offen sc1
    s_add_u32 s25, s24, 155648
    buffer_store_dwordx4 v[68:71], v220, s[16:19], s25 offen sc1
    v_mfma_f32_16x16x32_bf16 v[184:187], v[144:147], v[24:27], 0
    v_mfma_f32_16x16x32_bf16 v[188:191], v[144:147], v[28:31], 0
    v_mfma_f32_16x16x32_bf16 v[192:195], v[144:147], v[32:35], 0
    v_mfma_f32_16x16x32_bf16 v[196:199], v[144:147], v[36:39], 0
    v_mfma_f32_16x16x32_bf16 v[200:203], v[144:147], v[40:43], 0
    v_mfma_f32_16x16x32_bf16 v[204:207], v[144:147], v[44:47], 0
    v_mfma_f32_16x16x32_bf16 v[208:211], v[144:147], v[48:51], 0
    v_mfma_f32_16x16x32_bf16 v[212:215], v[144:147], v[52:55], 0
    s_nop 1
    v_cvt_pk_bf16_f32 v8, v184, v188
    s_nop 0
    v_cvt_pk_bf16_f32 v9, v192, v196
    s_nop 0
    v_cvt_pk_bf16_f32 v10, v200, v204
    s_nop 0
    v_cvt_pk_bf16_f32 v11, v208, v212
    v_cvt_pk_bf16_f32 v12, v185, v189
    v_cvt_pk_bf16_f32 v13, v193, v197
    v_cvt_pk_bf16_f32 v14, v201, v205
    v_cvt_pk_bf16_f32 v15, v209, v213
    v_cvt_pk_bf16_f32 v16, v186, v190
    v_cvt_pk_bf16_f32 v17, v194, v198
    v_cvt_pk_bf16_f32 v18, v202, v206
    v_cvt_pk_bf16_f32 v19, v210, v214
    v_cvt_pk_bf16_f32 v20, v187, v191
    v_cvt_pk_bf16_f32 v21, v195, v199
    v_cvt_pk_bf16_f32 v22, v203, v207
    v_cvt_pk_bf16_f32 v23, v211, v215
    s_add_u32 s25, s24, 262144
    buffer_store_dwordx4 v[8:11], v220, s[16:19], s25 offen sc1
    s_add_u32 s25, s24, 270336
    buffer_store_dwordx4 v[12:15], v220, s[16:19], s25 offen sc1
    s_add_u32 s25, s24, 278528
    buffer_store_dwordx4 v[16:19], v220, s[16:19], s25 offen sc1
    s_add_u32 s25, s24, 286720
    buffer_store_dwordx4 v[20:23], v220, s[16:19], s25 offen sc1
    v_mfma_f32_16x16x32_bf16 v[184:187], v[148:151], v[24:27], 0
    v_mfma_f32_16x16x32_bf16 v[188:191], v[148:151], v[28:31], 0
    v_mfma_f32_16x16x32_bf16 v[192:195], v[148:151], v[32:35], 0
    v_mfma_f32_16x16x32_bf16 v[196:199], v[148:151], v[36:39], 0
    v_mfma_f32_16x16x32_bf16 v[200:203], v[148:151], v[40:43], 0
    v_mfma_f32_16x16x32_bf16 v[204:207], v[148:151], v[44:47], 0
    v_mfma_f32_16x16x32_bf16 v[208:211], v[148:151], v[48:51], 0
    v_mfma_f32_16x16x32_bf16 v[212:215], v[148:151], v[52:55], 0
    s_nop 1
    v_cvt_pk_bf16_f32 v56, v184, v188
    s_nop 0
    v_cvt_pk_bf16_f32 v57, v192, v196
    s_nop 0
    v_cvt_pk_bf16_f32 v58, v200, v204
    s_nop 0
    v_cvt_pk_bf16_f32 v59, v208, v212
    v_cvt_pk_bf16_f32 v60, v185, v189
    v_cvt_pk_bf16_f32 v61, v193, v197
    v_cvt_pk_bf16_f32 v62, v201, v205
    v_cvt_pk_bf16_f32 v63, v209, v213
    v_cvt_pk_bf16_f32 v64, v186, v190
    v_cvt_pk_bf16_f32 v65, v194, v198
    v_cvt_pk_bf16_f32 v66, v202, v206
    v_cvt_pk_bf16_f32 v67, v210, v214
    v_cvt_pk_bf16_f32 v68, v187, v191
    v_cvt_pk_bf16_f32 v69, v195, v199
    v_cvt_pk_bf16_f32 v70, v203, v207
    v_cvt_pk_bf16_f32 v71, v211, v215
    s_add_u32 s25, s24, 393216
    buffer_store_dwordx4 v[56:59], v220, s[16:19], s25 offen sc1
    s_add_u32 s25, s24, 401408
    buffer_store_dwordx4 v[60:63], v220, s[16:19], s25 offen sc1
    s_add_u32 s25, s24, 409600
    buffer_store_dwordx4 v[64:67], v220, s[16:19], s25 offen sc1
    s_add_u32 s25, s24, 417792
    buffer_store_dwordx4 v[68:71], v220, s[16:19], s25 offen sc1
L_next0:
    s_cmp_ge_u32 s42, 1696
    s_cbranch_scc1 L_w0_p0
    s_cmp_ge_u32 s42, 672
    s_cbranch_scc1 L_w8_p0
    s_waitcnt vmcnt(32)
    s_branch L_wd_p0
L_w8_p0:
    s_waitcnt vmcnt(24)
    s_branch L_wd_p0
L_w0_p0:
    s_waitcnt vmcnt(16)
L_wd_p0:
    s_cmp_lg_u32 s10, 0
    s_cbranch_scc1 L_pub0
    v_add_u32 v229, 512, v229
    v_mov_b32 v221, s41
    s_mov_b64 exec, 1
    ds_write_b32 v221, v229
    s_mov_b64 exec, -1
L_pub0:
    s_waitcnt lgkmcnt(0)
    s_barrier
    s_cmp_lg_u32 s10, 0
    s_cbranch_scc1 L_nofl0
    s_cmp_ge_u32 s55, 1696
    s_cbranch_scc1 L_nofl0
    s_lshl_b32 s24, s55, 2
    s_add_u32 s24, s24, 157286400
    v_mov_b32 v237, s54
    s_mov_b64 exec, 1
    buffer_store_dword v237, v230, s[16:19], s24 offen sc1
    s_mov_b64 exec, -1
L_nofl0:
    v_mov_b32 v221, s41
    ds_read_b32 v222, v221
    s_xor_b32 s41, s41, 4
    s_mov_b32 s55, s40
    s_mov_b32 s40, s42
    s_waitcnt lgkmcnt(0)
    v_readfirstlane_b32 s42, v222
    s_nop 3
    s_cmp_ge_u32 s42, 736
    s_cbranch_scc1 L_rm4
    s_sub_u32 s28, s42, 64
    s_add_u32 s29, s42, 672
    s_cmp_ge_u32 s42, 64
    s_cselect_b32 s42, s28, s29
L_rm4:
    s_cmp_ge_u32 s40, 1696
    s_cbranch_scc1 L_x_fin
    s_cmp_lg_u32 s43, 1
    s_cbranch_scc1 L_non_skip0
    buffer_load_dword v236, v230, s[44:47], 0 offen offset:128 sc1
L_non_skip0:
    s_cmp_lg_u32 s10, 0
    s_cbranch_scc1 L_nofetch1
    v_mov_b32 v229, 1
    s_mov_b64 exec, 1
    buffer_atomic_add v229, v230, s[44:47], 0 offen sc0 sc1
    s_mov_b64 exec, -1
L_nofetch1:
    s_cmp_ge_u32 s42, 1696
    s_cbranch_scc1 L_ld_done5
    s_cmp_ge_u32 s42, 672
    s_cbranch_scc1 L_ld_w5
    s_cmp_ge_u32 s42, 336
    s_cselect_b32 s11, 1, 0
    s_mul_i32 s12, s11, 336
    s_sub_u32 s12, s42, s12
    s_and_b32 s13, s12, 7
    s_lshr_b32 s14, s12, 3
    s_lshl_b32 s14, s14, 2
    s_add_u32 s14, s14, s10
    s_mul_i32 s15, s11, 16384000
    s_add_u32 s34, s4, s15
    s_addc_u32 s35, s5, 0
    s_mov_b32 s20, s34
    s_and_b32 s21, s35, 0xffff
    s_mov_b32 s22, 16384000
    s_mov_b32 s23, 0x00020000
    s_mul_i32 s15, s14, 98304
    s_lshl_b32 s24, s13, 8
    s_add_u32 s15, s15, s24
    s_add_u32 s25, s15, 0
    buffer_load_dwordx4 v[8:11], v232, s[20:23], s25 offen
    s_add_u32 s25, s15, 2048
    buffer_load_dwordx4 v[12:15], v232, s[20:23], s25 offen
    s_add_u32 s25, s15, 4096
    buffer_load_dwordx4 v[16:19], v232, s[20:23], s25 offen
    s_add_u32 s25, s15, 6144
    buffer_load_dwordx4 v[20:23], v232, s[20:23], s25 offen
    s_add_u32 s25, s15, 8192
    buffer_load_dwordx4 v[24:27], v232, s[20:23], s25 offen
    s_add_u32 s25, s15, 10240
    buffer_load_dwordx4 v[28:31], v232, s[20:23], s25 offen
    s_add_u32 s25, s15, 12288
    buffer_load_dwordx4 v[32:35], v232, s[20:23], s25 offen
    s_add_u32 s25, s15, 14336
    buffer_load_dwordx4 v[36:39], v232, s[20:23], s25 offen
    s_add_u32 s25, s15, 65536
    buffer_load_dwordx4 v[40:43], v232, s[20:23], s25 offen
    s_add_u32 s25, s15, 67584
    buffer_load_dwordx4 v[44:47], v232, s[20:23], s25 offen
    s_add_u32 s25, s15, 69632
    buffer_load_dwordx4 v[48:51], v232, s[20:23], s25 offen
    s_add_u32 s25, s15, 71680
    buffer_load_dwordx4 v[52:55], v232, s[20:23], s25 offen
    s_add_u32 s25, s15, 73728
    buffer_load_dwordx4 v[56:59], v232, s[20:23], s25 offen
    s_add_u32 s25, s15, 75776
    buffer_load_dwordx4 v[60:63], v232, s[20:23], s25 offen
    s_add_u32 s25, s15, 77824
    buffer_load_dwordx4 v[64:67], v232, s[20:23], s25 offen
    s_add_u32 s25, s15, 79872
    buffer_load_dwordx4 v[68:71], v232, s[20:23], s25 offen
    s_branch L_ld_done5
L_ld_w5:
    s_sub_u32 s12, s42, 672
    s_and_b32 s13, s12, 3
    s_lshr_b32 s14, s12, 2
    s_lshl_b32 s14, s14, 2
    s_add_u32 s14, s14, s10
    s_mov_b32 s20, s6
    s_and_b32 s21, s7, 0xffff
    s_mov_b32 s22, 16252928
    s_mov_b32 s23, 0x00020000
    s_lshl_b32 s15, s14, 10
    s_lshl_b32 s24, s13, 8
    s_add_u32 s15, s15, s24
    s_add_u32 s25, s15, 0
    buffer_load_dwordx2 v[8:9], v233, s[20:23], s25 offen
    buffer_load_dwordx2 v[10:11], v233, s[20:23], s25 offen offset:16
    s_add_u32 s25, s15, 1048576
    buffer_load_dwordx2 v[12:13], v233, s[20:23], s25 offen
    buffer_load_dwordx2 v[14:15], v233, s[20:23], s25 offen offset:16
    s_add_u32 s25, s15, 2097152
    buffer_load_dwordx2 v[16:17], v233, s[20:23], s25 offen
    buffer_load_dwordx2 v[18:19], v233, s[20:23], s25 offen offset:16
    s_add_u32 s25, s15, 3145728
    buffer_load_dwordx2 v[20:21], v233, s[20:23], s25 offen
    buffer_load_dwordx2 v[22:23], v233, s[20:23], s25 offen offset:16
L_ld_done5:
    s_cmp_ge_u32 s42, 1696
    s_cbranch_scc1 L_w0_a1
    s_cmp_ge_u32 s42, 672
    s_cbranch_scc1 L_w8_a1
    s_waitcnt vmcnt(32)
    s_branch L_wd_a1
L_w8_a1:
    s_waitcnt vmcnt(24)
    s_branch L_wd_a1
L_w0_a1:
    s_waitcnt vmcnt(16)
L_wd_a1:
    s_cmp_ge_u32 s40, 672
    s_cbranch_scc1 L_cw1
    s_cmp_ge_u32 s40, 336
    s_cselect_b32 s11, 1, 0
    s_mul_i32 s12, s11, 336
    s_sub_u32 s12, s40, s12
    s_and_b32 s13, s12, 7
    s_lshr_b32 s14, s12, 3
    s_lshl_b32 s14, s14, 2
    s_add_u32 s14, s14, s10
    ds_read_b128 v[136:139], v231 offset:0
    ds_read_b128 v[140:143], v231 offset:1024
    ds_read_b128 v[144:147], v231 offset:2048
    ds_read_b128 v[148:151], v231 offset:3072
    ds_read_b128 v[152:155], v231 offset:4096
    ds_read_b128 v[156:159], v231 offset:5120
    ds_read_b128 v[160:163], v231 offset:6144
    ds_read_b128 v[164:167], v231 offset:7168
    s_bfe_u32 s24, s14, 0x10003
    s_mul_i32 s24, s24, 3
    v_and_b32 v221, 3, v217
    v_xor_b32 v221, s24, v221
    v_lshl_add_u32 v220, v221, 4, v234
    s_mul_i32 s24, s11, 22020096
    s_mul_i32 s25, s13, 2752512
    s_add_u32 s24, s24, s25
    s_lshl_b32 s25, s14, 6
    s_add_u32 s24, s24, s25
    s_add_u32 s24, s24, 67108864
    v_perm_b32 v168, v76, v72, s30
    v_perm_b32 v169, v84, v80, s30
    v_perm_b32 v170, v92, v88, s30
    v_perm_b32 v171, v100, v96, s30
    v_perm_b32 v172, v76, v72, s31
    v_perm_b32 v173, v84, v80, s31
    v_perm_b32 v174, v92, v88, s31
    v_perm_b32 v175, v100, v96, s31
    v_perm_b32 v176, v108, v104, s30
    v_perm_b32 v177, v116, v112, s30
    v_perm_b32 v178, v124, v120, s30
    v_perm_b32 v179, v132, v128, s30
    v_perm_b32 v180, v108, v104, s31
    v_perm_b32 v181, v116, v112, s31
    v_perm_b32 v182, v124, v120, s31
    v_perm_b32 v183, v132, v128, s31
    s_waitcnt lgkmcnt(0)
    v_mfma_f32_16x16x32_bf16 v[184:187], v[136:139], v[168:171], 0
    v_mfma_f32_16x16x32_bf16 v[188:191], v[136:139], v[172:175], 0
    v_mfma_f32_16x16x32_bf16 v[192:195], v[144:147], v[168:171], 0
    v_mfma_f32_16x16x32_bf16 v[196:199], v[144:147], v[172:175], 0
    v_mfma_f32_16x16x32_bf16 v[200:203], v[152:155], v[168:171], 0
    v_mfma_f32_16x16x32_bf16 v[204:207], v[152:155], v[172:175], 0
    v_mfma_f32_16x16x32_bf16 v[208:211], v[160:163], v[168:171], 0
    v_mfma_f32_16x16x32_bf16 v[212:215], v[160:163], v[172:175], 0
    v_mfma_f32_16x16x32_bf16 v[184:187], v[140:143], v[176:179], v[184:187]
    v_mfma_f32_16x16x32_bf16 v[188:191], v[140:143], v[180:183], v[188:191]
    v_mfma_f32_16x16x32_bf16 v[192:195], v[148:151], v[176:179], v[192:195]
    v_mfma_f32_16x16x32_bf16 v[196:199], v[148:151], v[180:183], v[196:199]
    v_mfma_f32_16x16x32_bf16 v[200:203], v[156:159], v[176:179], v[200:203]
    v_mfma_f32_16x16x32_bf16 v[204:207], v[156:159], v[180:183], v[204:207]
    v_mfma_f32_16x16x32_bf16 v[208:211], v[164:167], v[176:179], v[208:211]
    v_mfma_f32_16x16x32_bf16 v[212:215], v[164:167], v[180:183], v[212:215]
    v_perm_b32 v168, v77, v73, s30
    v_perm_b32 v169, v85, v81, s30
    v_perm_b32 v170, v93, v89, s30
    v_perm_b32 v171, v101, v97, s30
    v_perm_b32 v172, v77, v73, s31
    v_perm_b32 v173, v85, v81, s31
    v_perm_b32 v174, v93, v89, s31
    v_perm_b32 v175, v101, v97, s31
    v_perm_b32 v176, v109, v105, s30
    v_perm_b32 v177, v117, v113, s30
    v_perm_b32 v178, v125, v121, s30
    v_perm_b32 v179, v133, v129, s30
    v_perm_b32 v180, v109, v105, s31
    v_perm_b32 v181, v117, v113, s31
    v_perm_b32 v182, v125, v121, s31
    v_perm_b32 v183, v133, v129, s31
    v_cvt_pk_bf16_f32 v72, v184, v188
    v_cvt_pk_bf16_f32 v76, v185, v189
    v_cvt_pk_bf16_f32 v80, v186, v190
    v_cvt_pk_bf16_f32 v84, v187, v191
    v_cvt_pk_bf16_f32 v88, v192, v196
    v_cvt_pk_bf16_f32 v92, v193, v197
    v_cvt_pk_bf16_f32 v96, v194, v198
    v_cvt_pk_bf16_f32 v100, v195, v199
    v_cvt_pk_bf16_f32 v104, v200, v204
    v_cvt_pk_bf16_f32 v108, v201, v205
    v_cvt_pk_bf16_f32 v112, v202, v206
    v_cvt_pk_bf16_f32 v116, v203, v207
    v_cvt_pk_bf16_f32 v120, v208, v212
    v_cvt_pk_bf16_f32 v124, v209, v213
    v_cvt_pk_bf16_f32 v128, v210, v214
    v_cvt_pk_bf16_f32 v132, v211, v215
    v_mfma_f32_16x16x32_bf16 v[184:187], v[136:139], v[168:171], 0
    v_mfma_f32_16x16x32_bf16 v[188:191], v[136:139], v[172:175], 0
    v_mfma_f32_16x16x32_bf16 v[192:195], v[144:147], v[168:171], 0
    v_mfma_f32_16x16x32_bf16 v[196:199], v[144:147], v[172:175], 0
    v_mfma_f32_16x16x32_bf16 v[200:203], v[152:155], v[168:171], 0
    v_mfma_f32_16x16x32_bf16 v[204:207], v[152:155], v[172:175], 0
    v_mfma_f32_16x16x32_bf16 v[208:211], v[160:163], v[168:171], 0
    v_mfma_f32_16x16x32_bf16 v[212:215], v[160:163], v[172:175], 0
    v_mfma_f32_16x16x32_bf16 v[184:187], v[140:143], v[176:179], v[184:187]
    v_mfma_f32_16x16x32_bf16 v[188:191], v[140:143], v[180:183], v[188:191]
    v_mfma_f32_16x16x32_bf16 v[192:195], v[148:151], v[176:179], v[192:195]
    v_mfma_f32_16x16x32_bf16 v[196:199], v[148:151], v[180:183], v[196:199]
    v_mfma_f32_16x16x32_bf16 v[200:203], v[156:159], v[176:179], v[200:203]
    v_mfma_f32_16x16x32_bf16 v[204:207], v[156:159], v[180:183], v[204:207]
    v_mfma_f32_16x16x32_bf16 v[208:211], v[164:167], v[176:179], v[208:211]
    v_mfma_f32_16x16x32_bf16 v[212:215], v[164:167], v[180:183], v[212:215]
    v_perm_b32 v168, v78, v74, s30
    v_perm_b32 v169, v86, v82, s30
    v_perm_b32 v170, v94, v90, s30
    v_perm_b32 v171, v102, v98, s30
    v_perm_b32 v172, v78, v74, s31
    v_perm_b32 v173, v86, v82, s31
    v_perm_b32 v174, v94, v90, s31
    v_perm_b32 v175, v102, v98, s31
    v_perm_b32 v176, v110, v106, s30
    v_perm_b32 v177, v118, v114, s30
    v_perm_b32 v178, v126, v122, s30
    v_perm_b32 v179, v134, v130, s30
    v_perm_b32 v180, v110, v106, s31
    v_perm_b32 v181, v118, v114, s31
    v_perm_b32 v182, v126, v122, s31
    v_perm_b32 v183, v134, v130, s31
    v_cvt_pk_bf16_f32 v73, v184, v188
    v_cvt_pk_bf16_f32 v77, v185, v189
    v_cvt_pk_bf16_f32 v81, v186, v190
    v_cvt_pk_bf16_f32 v85, v187, v191
    v_cvt_pk_bf16_f32 v89, v192, v196
    v_cvt_pk_bf16_f32 v93, v193, v197
    v_cvt_pk_bf16_f32 v97, v194, v198
    v_cvt_pk_bf16_f32 v101, v195, v199
    v_cvt_pk_bf16_f32 v105, v200, v204
    v_cvt_pk_bf16_f32 v109, v201, v205
    v_cvt_pk_bf16_f32 v113, v202, v206
    v_cvt_pk_bf16_f32 v117, v203, v207
    v_cvt_pk_bf16_f32 v121, v208, v212
    v_cvt_pk_bf16_f32 v125, v209, v213
    v_cvt_pk_bf16_f32 v129, v210, v214
    v_cvt_pk_bf16_f32 v133, v211, v215
    v_mfma_f32_16x16x32_bf16 v[184:187], v[136:139], v[168:171], 0
    v_mfma_f32_16x16x32_bf16 v[188:191], v[136:139], v[172:175], 0
    v_mfma_f32_16x16x32_bf16 v[192:195], v[144:147], v[168:171], 0
    v_mfma_f32_16x16x32_bf16 v[196:199], v[144:147], v[172:175], 0
    v_mfma_f32_16x16x32_bf16 v[200:203], v[152:155], v[168:171], 0
    v_mfma_f32_16x16x32_bf16 v[204:207], v[152:155], v[172:175], 0
    v_mfma_f32_16x16x32_bf16 v[208:211], v[160:163], v[168:171], 0
    v_mfma_f32_16x16x32_bf16 v[212:215], v[160:163], v[172:175], 0
    v_mfma_f32_16x16x32_bf16 v[184:187], v[140:143], v[176:179], v[184:187]
    v_mfma_f32_16x16x32_bf16 v[188:191], v[140:143], v[180:183], v[188:191]
    v_mfma_f32_16x16x32_bf16 v[192:195], v[148:151], v[176:179], v[192:195]
    v_mfma_f32_16x16x32_bf16 v[196:199], v[148:151], v[180:183], v[196:199]
    v_mfma_f32_16x16x32_bf16 v[200:203], v[156:159], v[176:179], v[200:203]
    v_mfma_f32_16x16x32_bf16 v[204:207], v[156:159], v[180:183], v[204:207]
    v_mfma_f32_16x16x32_bf16 v[208:211], v[164:167], v[176:179], v[208:211]
    v_mfma_f32_16x16x32_bf16 v[212:215], v[164:167], v[180:183], v[212:215]
    v_perm_b32 v168, v79, v75, s30
    v_perm_b32 v169, v87, v83, s30
    v_perm_b32 v170, v95, v91, s30
    v_perm_b32 v171, v103, v99, s30
    v_perm_b32 v172, v79, v75, s31
    v_perm_b32 v173, v87, v83, s31
    v_perm_b32 v174, v95, v91, s31
    v_perm_b32 v175, v103, v99, s31
    v_perm_b32 v176, v111, v107, s30
    v_perm_b32 v177, v119, v115, s30
    v_perm_b32 v178, v127, v123, s30
    v_perm_b32 v179, v135, v131, s30
    v_perm_b32 v180, v111, v107, s31
    v_perm_b32 v181, v119, v115, s31
    v_perm_b32 v182, v127, v123, s31
    v_perm_b32 v183, v135, v131, s31
    v_cvt_pk_bf16_f32 v74, v184, v188
    v_cvt_pk_bf16_f32 v78, v185, v189
    v_cvt_pk_bf16_f32 v82, v186, v190
    v_cvt_pk_bf16_f32 v86, v187, v191
    v_cvt_pk_bf16_f32 v90, v192, v196
    v_cvt_pk_bf16_f32 v94, v193, v197
    v_cvt_pk_bf16_f32 v98, v194, v198
    v_cvt_pk_bf16_f32 v102, v195, v199
    v_cvt_pk_bf16_f32 v106, v200, v204
    v_cvt_pk_bf16_f32 v110, v201, v205
    v_cvt_pk_bf16_f32 v114, v202, v206
    v_cvt_pk_bf16_f32 v118, v203, v207
    v_cvt_pk_bf16_f32 v122, v208, v212
    v_cvt_pk_bf16_f32 v126, v209, v213
    v_cvt_pk_bf16_f32 v130, v210, v214
    v_cvt_pk_bf16_f32 v134, v211, v215
    v_mfma_f32_16x16x32_bf16 v[184:187], v[136:139], v[168:171], 0
    v_mfma_f32_16x16x32_bf16 v[188:191], v[136:139], v[172:175], 0
    v_mfma_f32_16x16x32_bf16 v[192:195], v[144:147], v[168:171], 0
    v_mfma_f32_16x16x32_bf16 v[196:199], v[144:147], v[172:175], 0
    v_mfma_f32_16x16x32_bf16 v[200:203], v[152:155], v[168:171], 0
    v_mfma_f32_16x16x32_bf16 v[204:207], v[152:155], v[172:175], 0
    v_mfma_f32_16x16x32_bf16 v[208:211], v[160:163], v[168:171], 0
    v_mfma_f32_16x16x32_bf16 v[212:215], v[160:163], v[172:175], 0
    v_mfma_f32_16x16x32_bf16 v[184:187], v[140:143], v[176:179], v[184:187]
    v_mfma_f32_16x16x32_bf16 v[188:191], v[140:143], v[180:183], v[188:191]
    v_mfma_f32_16x16x32_bf16 v[192:195], v[148:151], v[176:179], v[192:195]
    v_mfma_f32_16x16x32_bf16 v[196:199], v[148:151], v[180:183], v[196:199]
    v_mfma_f32_16x16x32_bf16 v[200:203], v[156:159], v[176:179], v[200:203]
    v_mfma_f32_16x16x32_bf16 v[204:207], v[156:159], v[180:183], v[204:207]
    v_mfma_f32_16x16x32_bf16 v[208:211], v[164:167], v[176:179], v[208:211]
    v_mfma_f32_16x16x32_bf16 v[212:215], v[164:167], v[180:183], v[212:215]
    s_nop 1
    v_cvt_pk_bf16_f32 v75, v184, v188
    v_cvt_pk_bf16_f32 v79, v185, v189
    v_cvt_pk_bf16_f32 v83, v186, v190
    v_cvt_pk_bf16_f32 v87, v187, v191
    v_cvt_pk_bf16_f32 v91, v192, v196
    v_cvt_pk_bf16_f32 v95, v193, v197
    v_cvt_pk_bf16_f32 v99, v194, v198
    v_cvt_pk_bf16_f32 v103, v195, v199
    v_cvt_pk_bf16_f32 v107, v200, v204
    v_cvt_pk_bf16_f32 v111, v201, v205
    v_cvt_pk_bf16_f32 v115, v202, v206
    v_cvt_pk_bf16_f32 v119, v203, v207
    v_cvt_pk_bf16_f32 v123, v208, v212
    v_cvt_pk_bf16_f32 v127, v209, v213
    v_cvt_pk_bf16_f32 v131, v210, v214
    v_cvt_pk_bf16_f32 v135, v211, v215
    s_add_u32 s25, s24, 0
    buffer_store_dwordx4 v[72:75], v220, s[16:19], s25 offen sc1
    s_add_u32 s25, s24, 10752
    buffer_store_dwordx4 v[76:79], v220, s[16:19], s25 offen sc1
    s_add_u32 s25, s24, 21504
    buffer_store_dwordx4 v[80:83], v220, s[16:19], s25 offen sc1
    s_add_u32 s25, s24, 32256
    buffer_store_dwordx4 v[84:87], v220, s[16:19], s25 offen sc1
    s_add_u32 s25, s24, 172032
    buffer_store_dwordx4 v[88:91], v220, s[16:19], s25 offen sc1
    s_add_u32 s25, s24, 182784
    buffer_store_dwordx4 v[92:95], v220, s[16:19], s25 offen sc1
    s_add_u32 s25, s24, 193536
    buffer_store_dwordx4 v[96:99], v220, s[16:19], s25 offen sc1
    s_add_u32 s25, s24, 204288
    buffer_store_dwordx4 v[100:103], v220, s[16:19], s25 offen sc1
    s_add_u32 s25, s24, 344064
    buffer_store_dwordx4 v[104:107], v220, s[16:19], s25 offen sc1
    s_add_u32 s25, s24, 354816
    buffer_store_dwordx4 v[108:111], v220, s[16:19], s25 offen sc1
    s_add_u32 s25, s24, 365568
    buffer_store_dwordx4 v[112:115], v220, s[16:19], s25 offen sc1
    s_add_u32 s25, s24, 376320
    buffer_store_dwordx4 v[116:119], v220, s[16:19], s25 offen sc1
    s_add_u32 s25, s24, 516096
    buffer_store_dwordx4 v[120:123], v220, s[16:19], s25 offen sc1
    s_add_u32 s25, s24, 526848
    buffer_store_dwordx4 v[124:127], v220, s[16:19], s25 offen sc1
    s_add_u32 s25, s24, 537600
    buffer_store_dwordx4 v[128:131], v220, s[16:19], s25 offen sc1
    s_add_u32 s25, s24, 548352
    buffer_store_dwordx4 v[132:135], v220, s[16:19], s25 offen sc1
    s_branch L_next1
L_cw1:
    s_sub_u32 s12, s40, 672
    s_and_b32 s13, s12, 3
    s_lshr_b32 s14, s12, 2
    s_lshl_b32 s14, s14, 2
    s_add_u32 s14, s14, s10
    ds_read_b128 v[136:139], v231 offset:8192
    ds_read_b128 v[140:143], v231 offset:9216
    ds_read_b128 v[144:147], v231 offset:10240
    ds_read_b128 v[148:151], v231 offset:11264
    s_and_b32 s24, s14, 3
    s_bfe_u32 s25, s14, 0x10003
    s_lshl_b32 s25, s25, 2
    s_or_b32 s24, s24, s25
    s_lshl_b32 s24, s24, 1
    v_xor_b32 v221, s24, v217
    v_lshl_add_u32 v220, v221, 4, v235
    s_mul_i32 s24, s13, 16777216
    s_lshr_b32 s25, s14, 5
    s_mul_i32 s25, s25, 524288
    s_add_u32 s24, s24, s25
    s_and_b32 s25, s14, 31
    s_lshl_b32 s25, s25, 8
    s_add_u32 s24, s24, s25
    v_perm_b32 v88, v72, v72, s32
    v_perm_b32 v89, v76, v76, s32
    v_perm_b32 v90, v80, v80, s32
    v_perm_b32 v91, v84, v84, s32
    v_perm_b32 v92, v72, v72, s33
    v_perm_b32 v93, v76, v76, s33
    v_perm_b32 v94, v80, v80, s33
    v_perm_b32 v95, v84, v84, s33
    v_perm_b32 v96, v73, v73, s32
    v_perm_b32 v97, v77, v77, s32
    v_perm_b32 v98, v81, v81, s32
    v_perm_b32 v99, v85, v85, s32
    v_perm_b32 v100, v73, v73, s33
    v_perm_b32 v101, v77, v77, s33
    v_perm_b32 v102, v81, v81, s33
    v_perm_b32 v103, v85, v85, s33
    v_perm_b32 v104, v74, v74, s32
    v_perm_b32 v105, v78, v78, s32
    v_perm_b32 v106, v82, v82, s32
    v_perm_b32 v107, v86, v86, s32
    v_perm_b32 v108, v74, v74, s33
    v_perm_b32 v109, v78, v78, s33
    v_perm_b32 v110, v82, v82, s33
    v_perm_b32 v111, v86, v86, s33
    v_perm_b32 v112, v75, v75, s32
    v_perm_b32 v113, v79, v79, s32
    v_perm_b32 v114, v83, v83, s32
    v_perm_b32 v115, v87, v87, s32
    v_perm_b32 v116, v75, v75, s33
    v_perm_b32 v117, v79, v79, s33
    v_perm_b32 v118, v83, v83, s33
    v_perm_b32 v119, v87, v87, s33
    s_waitcnt lgkmcnt(0)
    v_mfma_f32_16x16x32_bf16 v[184:187], v[136:139], v[88:91], 0
    v_mfma_f32_16x16x32_bf16 v[188:191], v[136:139], v[92:95], 0
    v_mfma_f32_16x16x32_bf16 v[192:195], v[136:139], v[96:99], 0
    v_mfma_f32_16x16x32_bf16 v[196:199], v[136:139], v[100:103], 0
    v_mfma_f32_16x16x32_bf16 v[200:203], v[136:139], v[104:107], 0
    v_mfma_f32_16x16x32_bf16 v[204:207], v[136:139], v[108:111], 0
    v_mfma_f32_16x16x32_bf16 v[208:211], v[136:139], v[112:115], 0
    v_mfma_f32_16x16x32_bf16 v[212:215], v[136:139], v[116:119], 0
    s_nop 1
    v_cvt_pk_bf16_f32 v72, v184, v188
    s_nop 0
    v_cvt_pk_bf16_f32 v73, v192, v196
    s_nop 0
    v_cvt_pk_bf16_f32 v74, v200, v204
    s_nop 0
    v_cvt_pk_bf16_f32 v75, v208, v212
    v_cvt_pk_bf16_f32 v76, v185, v189
    v_cvt_pk_bf16_f32 v77, v193, v197
    v_cvt_pk_bf16_f32 v78, v201, v205
    v_cvt_pk_bf16_f32 v79, v209, v213
    v_cvt_pk_bf16_f32 v80, v186, v190
    v_cvt_pk_bf16_f32 v81, v194, v198
    v_cvt_pk_bf16_f32 v82, v202, v206
    v_cvt_pk_bf16_f32 v83, v210, v214
    v_cvt_pk_bf16_f32 v84, v187, v191
    v_cvt_pk_bf16_f32 v85, v195, v199
    v_cvt_pk_bf16_f32 v86, v203, v207
    v_cvt_pk_bf16_f32 v87, v211, v215
    s_add_u32 s25, s24, 0
    buffer_store_dwordx4 v[72:75], v220, s[16:19], s25 offen sc1
    s_add_u32 s25, s24, 8192
    buffer_store_dwordx4 v[76:79], v220, s[16:19], s25 offen sc1
    s_add_u32 s25, s24, 16384
    buffer_store_dwordx4 v[80:83], v220, s[16:19], s25 offen sc1
    s_add_u32 s25, s24, 24576
    buffer_store_dwordx4 v[84:87], v220, s[16:19], s25 offen sc1
    v_mfma_f32_16x16x32_bf16 v[184:187], v[140:143], v[88:91], 0
    v_mfma_f32_16x16x32_bf16 v[188:191], v[140:143], v[92:95], 0
    v_mfma_f32_16x16x32_bf16 v[192:195], v[140:143], v[96:99], 0
    v_mfma_f32_16x16x32_bf16 v[196:199], v[140:143], v[100:103], 0
    v_mfma_f32_16x16x32_bf16 v[200:203], v[140:143], v[104:107], 0
    v_mfma_f32_16x16x32_bf16 v[204:207], v[140:143], v[108:111], 0
    v_mfma_f32_16x16x32_bf16 v[208:211], v[140:143], v[112:115], 0
    v_mfma_f32_16x16x32_bf16 v[212:215], v[140:143], v[116:119], 0
    s_nop 1
    v_cvt_pk_bf16_f32 v120, v184, v188
    s_nop 0
    v_cvt_pk_bf16_f32 v121, v192, v196
    s_nop 0
    v_cvt_pk_bf16_f32 v122, v200, v204
    s_nop 0
    v_cvt_pk_bf16_f32 v123, v208, v212
    v_cvt_pk_bf16_f32 v124, v185, v189
    v_cvt_pk_bf16_f32 v125, v193, v197
    v_cvt_pk_bf16_f32 v126, v201, v205
    v_cvt_pk_bf16_f32 v127, v209, v213
    v_cvt_pk_bf16_f32 v128, v186, v190
    v_cvt_pk_bf16_f32 v129, v194, v198
    v_cvt_pk_bf16_f32 v130, v202, v206
    v_cvt_pk_bf16_f32 v131, v210, v214
    v_cvt_pk_bf16_f32 v132, v187, v191
    v_cvt_pk_bf16_f32 v133, v195, v199
    v_cvt_pk_bf16_f32 v134, v203, v207
    v_cvt_pk_bf16_f32 v135, v211, v215
    s_add_u32 s25, s24, 131072
    buffer_store_dwordx4 v[120:123], v220, s[16:19], s25 offen sc1
    s_add_u32 s25, s24, 139264
    buffer_store_dwordx4 v[124:127], v220, s[16:19], s25 offen sc1
    s_add_u32 s25, s24, 147456
    buffer_store_dwordx4 v[128:131], v220, s[16:19], s25 offen sc1
    s_add_u32 s25, s24, 155648
    buffer_store_dwordx4 v[132:135], v220, s[16:19], s25 offen sc1
    v_mfma_f32_16x16x32_bf16 v[184:187], v[144:147], v[88:91], 0
    v_mfma_f32_16x16x32_bf16 v[188:191], v[144:147], v[92:95], 0
    v_mfma_f32_16x16x32_bf16 v[192:195], v[144:147], v[96:99], 0
    v_mfma_f32_16x16x32_bf16 v[196:199], v[144:147], v[100:103], 0
    v_mfma_f32_16x16x32_bf16 v[200:203], v[144:147], v[104:107], 0
    v_mfma_f32_16x16x32_bf16 v[204:207], v[144:147], v[108:111], 0
    v_mfma_f32_16x16x32_bf16 v[208:211], v[144:147], v[112:115], 0
    v_mfma_f32_16x16x32_bf16 v[212:215], v[144:147], v[116:119], 0
    s_nop 1
    v_cvt_pk_bf16_f32 v72, v184, v188
    s_nop 0
    v_cvt_pk_bf16_f32 v73, v192, v196
    s_nop 0
    v_cvt_pk_bf16_f32 v74, v200, v204
    s_nop 0
    v_cvt_pk_bf16_f32 v75, v208, v212
    v_cvt_pk_bf16_f32 v76, v185, v189
    v_cvt_pk_bf16_f32 v77, v193, v197
    v_cvt_pk_bf16_f32 v78, v201, v205
    v_cvt_pk_bf16_f32 v79, v209, v213
    v_cvt_pk_bf16_f32 v80, v186, v190
    v_cvt_pk_bf16_f32 v81, v194, v198
    v_cvt_pk_bf16_f32 v82, v202, v206
    v_cvt_pk_bf16_f32 v83, v210, v214
    v_cvt_pk_bf16_f32 v84, v187, v191
    v_cvt_pk_bf16_f32 v85, v195, v199
    v_cvt_pk_bf16_f32 v86, v203, v207
    v_cvt_pk_bf16_f32 v87, v211, v215
    s_add_u32 s25, s24, 262144
    buffer_store_dwordx4 v[72:75], v220, s[16:19], s25 offen sc1
    s_add_u32 s25, s24, 270336
    buffer_store_dwordx4 v[76:79], v220, s[16:19], s25 offen sc1
    s_add_u32 s25, s24, 278528
    buffer_store_dwordx4 v[80:83], v220, s[16:19], s25 offen sc1
    s_add_u32 s25, s24, 286720
    buffer_store_dwordx4 v[84:87], v220, s[16:19], s25 offen sc1
    v_mfma_f32_16x16x32_bf16 v[184:187], v[148:151], v[88:91], 0
    v_mfma_f32_16x16x32_bf16 v[188:191], v[148:151], v[92:95], 0
    v_mfma_f32_16x16x32_bf16 v[192:195], v[148:151], v[96:99], 0
    v_mfma_f32_16x16x32_bf16 v[196:199], v[148:151], v[100:103], 0
    v_mfma_f32_16x16x32_bf16 v[200:203], v[148:151], v[104:107], 0
    v_mfma_f32_16x16x32_bf16 v[204:207], v[148:151], v[108:111], 0
    v_mfma_f32_16x16x32_bf16 v[208:211], v[148:151], v[112:115], 0
    v_mfma_f32_16x16x32_bf16 v[212:215], v[148:151], v[116:119], 0
    s_nop 1
    v_cvt_pk_bf16_f32 v120, v184, v188
    s_nop 0
    v_cvt_pk_bf16_f32 v121, v192, v196
    s_nop 0
    v_cvt_pk_bf16_f32 v122, v200, v204
    s_nop 0
    v_cvt_pk_bf16_f32 v123, v208, v212
    v_cvt_pk_bf16_f32 v124, v185, v189
    v_cvt_pk_bf16_f32 v125, v193, v197
    v_cvt_pk_bf16_f32 v126, v201, v205
    v_cvt_pk_bf16_f32 v127, v209, v213
    v_cvt_pk_bf16_f32 v128, v186, v190
    v_cvt_pk_bf16_f32 v129, v194, v198
    v_cvt_pk_bf16_f32 v130, v202, v206
    v_cvt_pk_bf16_f32 v131, v210, v214
    v_cvt_pk_bf16_f32 v132, v187, v191
    v_cvt_pk_bf16_f32 v133, v195, v199
    v_cvt_pk_bf16_f32 v134, v203, v207
    v_cvt_pk_bf16_f32 v135, v211, v215
    s_add_u32 s25, s24, 393216
    buffer_store_dwordx4 v[120:123], v220, s[16:19], s25 offen sc1
    s_add_u32 s25, s24, 401408
    buffer_store_dwordx4 v[124:127], v220, s[16:19], s25 offen sc1
    s_add_u32 s25, s24, 409600
    buffer_store_dwordx4 v[128:131], v220, s[16:19], s25 offen sc1
    s_add_u32 s25, s24, 417792
    buffer_store_dwordx4 v[132:135], v220, s[16:19], s25 offen sc1
L_next1:
    s_cmp_ge_u32 s42, 1696
    s_cbranch_scc1 L_w0_p1
    s_cmp_ge_u32 s42, 672
    s_cbranch_scc1 L_w8_p1
    s_waitcnt vmcnt(32)
    s_branch L_wd_p1
L_w8_p1:
    s_waitcnt vmcnt(24)
    s_branch L_wd_p1
L_w0_p1:
    s_waitcnt vmcnt(16)
L_wd_p1:
    s_cmp_lg_u32 s43, 1
    s_cbranch_scc1 L_nonok
    s_mov_b32 s43, 2
    s_mov_b32 s57, 32768
L_non:
    v_readfirstlane_b32 s54, v236
    s_nop 3
    s_cmp_lg_u32 s54, 0
    s_cbranch_scc1 L_nonok
    s_sub_u32 s57, s57, 1
    s_cmp_eq_u32 s57, 0
    s_cbranch_scc1 L_nonok
    buffer_load_dword v236, v230, s[44:47], 0 offen offset:128 sc1
    s_waitcnt vmcnt(0)
    s_branch L_non
L_nonok:
    s_cmp_lg_u32 s10, 0
    s_cbranch_scc1 L_pub1
    v_add_u32 v229, 512, v229
    v_mov_b32 v221, s41
    s_mov_b64 exec, 1
    ds_write_b32 v221, v229
    s_mov_b64 exec, -1
L_pub1:
    s_waitcnt lgkmcnt(0)
    s_barrier
    s_cmp_lg_u32 s10, 0
    s_cbranch_scc1 L_nofl1
    s_cmp_ge_u32 s55, 1696
    s_cbranch_scc1 L_nofl1
    s_lshl_b32 s24, s55, 2
    s_add_u32 s24, s24, 157286400
    v_mov_b32 v237, s54
    s_mov_b64 exec, 1
    buffer_store_dword v237, v230, s[16:19], s24 offen sc1
    s_mov_b64 exec, -1
L_nofl1:
    v_mov_b32 v221, s41
    ds_read_b32 v222, v221
    s_xor_b32 s41, s41, 4
    s_mov_b32 s55, s40
    s_mov_b32 s40, s42
    s_waitcnt lgkmcnt(0)
    v_readfirstlane_b32 s42, v222
    s_nop 3
    s_cmp_ge_u32 s42, 736
    s_cbranch_scc1 L_rm6
    s_sub_u32 s28, s42, 64
    s_add_u32 s29, s42, 672
    s_cmp_ge_u32 s42, 64
    s_cselect_b32 s42, s28, s29
L_rm6:
    s_cmp_ge_u32 s40, 1696
    s_cbranch_scc1 L_x_fin
    s_branch L_x_loop
L_x_fin:
    s_waitcnt vmcnt(0)
    s_barrier
    s_cmp_lg_u32 s10, 0
    s_cbranch_scc1 L_noflf
    s_cmp_ge_u32 s55, 1696
    s_cbranch_scc1 L_noflf
    s_lshl_b32 s24, s55, 2
    s_add_u32 s24, s24, 157286400
    v_mov_b32 v237, s54
    s_mov_b64 exec, 1
    buffer_store_dword v237, v230, s[16:19], s24 offen sc1
    s_mov_b64 exec, -1
L_noflf:
    s_add_u32 s10, s10, 4
    s_and_b32 s11, s2, 7
    s_lshr_b32 s12, s2, 3
    s_lshr_b32 s13, s12, 3
    s_lshl_b32 s11, s11, 2
    s_add_u32 s11, s11, s13
    s_bfe_u32 s13, s12, 0x10002
    s_and_b32 s14, s12, 3
    s_and_b32 s15, s10, 3
    s_mul_i32 s40, s11, 16384
    s_mul_i32 s20, s14, 16777216
    s_add_u32 s40, s40, s20
    s_mul_i32 s41, s11, 21504
    s_mul_i32 s20, s13, 22020096
    s_add_u32 s41, s41, s20
    s_add_u32 s41, s41, 67108864
    s_lshl_b32 s42, s15, 12
    s_mul_i32 s43, s15, 5632
    s_lshr_b32 s20, s15, 1
    s_lshl_b32 s21, s20, 9
    s_sub_u32 s21, s43, s21
    v_lshlrev_b32 v1, 4, v0
    v_lshlrev_b32 v1, 4, v0
    v_add_u32 v2, s21, v1
    s_add_u32 s22, s21, 4096
    v_add_u32 v5, s22, v1
    s_mov_b32 s44, s41
    s_bitcmp1_b32 s15, 0
    s_cbranch_scc0 L_six_even
    s_mul_i32 s22, s20, 10752
    s_add_u32 s22, s22, 9216
    v_lshrrev_b32 v5, 2, v0
    v_lshlrev_b32 v5, 6, v5
    v_and_b32 v3, 3, v0
    v_xor_b32 v3, 3, v3
    v_lshl_add_u32 v5, v3, 4, v5
    v_add_u32 v5, s22, v5
    s_mul_i32 s44, s11, 21504
    s_xor_b32 s22, s13, 1
    s_mul_i32 s22, s22, 22020096
    s_add_u32 s44, s44, s22
    s_add_u32 s44, s44, 67108864
L_six_even:
    s_mov_b32 s50, -1
    s_mov_b32 s51, 0
    v_add_u32 v1, s42, v1
    s_add_u32 s43, s43, 16384
    v_lshlrev_b32 v6, 4, v0
    v_min_u32 v7, 31, v0
    v_lshlrev_b32 v7, 4, v7
    s_mov_b32 s58, 157286400
    buffer_load_dwordx4 v[8:11], v6, s[16:19], s58 offen sc1
    s_mov_b32 s58, 157287424
    buffer_load_dwordx4 v[12:15], v6, s[16:19], s58 offen sc1
    s_mov_b32 s58, 157288448
    buffer_load_dwordx4 v[16:19], v6, s[16:19], s58 offen sc1
    s_mov_b32 s58, 157288576
    buffer_load_dwordx4 v[20:23], v6, s[16:19], s58 offen sc1
    s_waitcnt vmcnt(0)
    s_mov_b32 s57, 32768
L_chk0:
    v_xor_b32 v24, s54, v8
    v_xor_b32 v25, s54, v9
    v_xor_b32 v26, s54, v10
    v_xor_b32 v27, s54, v11
    v_xor_b32 v28, s54, v12
    v_xor_b32 v29, s54, v13
    v_xor_b32 v30, s54, v14
    v_xor_b32 v31, s54, v15
    v_xor_b32 v32, s54, v16
    v_xor_b32 v33, s54, v17
    v_xor_b32 v34, s54, v18
    v_xor_b32 v35, s54, v19
    v_xor_b32 v36, s54, v20
    v_xor_b32 v37, s54, v21
    v_xor_b32 v38, s54, v22
    v_xor_b32 v39, s54, v23
    v_or3_b32 v24, v24, v25, v26
    v_or3_b32 v24, v24, v27, v28
    v_or3_b32 v24, v24, v29, v30
    v_or3_b32 v24, v24, v31, v32
    v_or3_b32 v24, v24, v33, v34
    v_or3_b32 v24, v24, v35, v36
    v_or3_b32 v24, v24, v37, v38
    v_or_b32 v24, v24, v39
    v_cmp_ne_u32 vcc, 0, v24
    s_nop 3
    s_cmp_eq_u64 vcc, 0
    s_cbranch_scc1 L_ok0
    s_sub_u32 s57, s57, 1
    s_cmp_eq_u32 s57, 0
    s_cbranch_scc1 L_ok0
    s_sleep 2
    s_mov_b32 s58, 157286400
    buffer_load_dwordx4 v[8:11], v6, s[16:19], s58 offen sc1
    s_mov_b32 s58, 157287424
    buffer_load_dwordx4 v[12:15], v6, s[16:19], s58 offen sc1
    s_mov_b32 s58, 157288448
    buffer_load_dwordx4 v[16:19], v6, s[16:19], s58 offen sc1
    s_mov_b32 s58, 157288576
    buffer_load_dwordx4 v[20:23], v6, s[16:19], s58 offen sc1
    s_waitcnt vmcnt(0)
    s_branch L_chk0
L_ok0:
    s_add_u32 m0, s42, 0
    s_nop 0
    buffer_load_dwordx4 v1, s[16:19], s40 offen offset:0 lds
    buffer_load_dwordx4 v1, s[16:19], s40 offen offset:1024 lds
    buffer_load_dwordx4 v1, s[16:19], s40 offen offset:2048 lds
    buffer_load_dwordx4 v1, s[16:19], s40 offen offset:3072 lds
    s_add_u32 s40, s40, 524288
    s_add_u32 m0, s43, 0
    s_nop 0
    buffer_load_dwordx4 v2, s[16:19], s41 offen offset:0 lds
    buffer_load_dwordx4 v2, s[16:19], s41 offen offset:1024 lds
    buffer_load_dwordx4 v2, s[16:19], s41 offen offset:2048 lds
    buffer_load_dwordx4 v2, s[16:19], s41 offen offset:3072 lds
    s_add_u32 m0, s43, 4096
    s_add_u32 s49, s41, 4096
    buffer_load_dwordx4 v2, s[16:19], s49 offen lds
    s_mov_b64 exec, s[50:51]
    buffer_load_dwordx4 v5, s[16:19], s44 offen offset:1024 lds
    s_mov_b64 exec, -1
    s_add_u32 s41, s41, 688128
    s_add_u32 s44, s44, 688128
    s_add_u32 m0, s42, 38912
    s_nop 0
    buffer_load_dwordx4 v1, s[16:19], s40 offen offset:0 lds
    buffer_load_dwordx4 v1, s[16:19], s40 offen offset:1024 lds
    buffer_load_dwordx4 v1, s[16:19], s40 offen offset:2048 lds
    buffer_load_dwordx4 v1, s[16:19], s40 offen offset:3072 lds
    s_add_u32 s40, s40, 524288
    s_add_u32 m0, s43, 38912
    s_nop 0
    buffer_load_dwordx4 v2, s[16:19], s41 offen offset:0 lds
    buffer_load_dwordx4 v2, s[16:19], s41 offen offset:1024 lds
    buffer_load_dwordx4 v2, s[16:19], s41 offen offset:2048 lds
    buffer_load_dwordx4 v2, s[16:19], s41 offen offset:3072 lds
    s_add_u32 m0, s43, 43008
    s_add_u32 s49, s41, 4096
    buffer_load_dwordx4 v2, s[16:19], s49 offen lds
    s_mov_b64 exec, s[50:51]
    buffer_load_dwordx4 v5, s[16:19], s44 offen offset:1024 lds
    s_mov_b64 exec, -1
    s_add_u32 s41, s41, 688128
    s_add_u32 s44, s44, 688128
    s_add_u32 m0, s42, 77824
    s_nop 0
    buffer_load_dwordx4 v1, s[16:19], s40 offen offset:0 lds
    buffer_load_dwordx4 v1, s[16:19], s40 offen offset:1024 lds
    buffer_load_dwordx4 v1, s[16:19], s40 offen offset:2048 lds
    buffer_load_dwordx4 v1, s[16:19], s40 offen offset:3072 lds
    s_add_u32 s40, s40, 524288
    s_add_u32 m0, s43, 77824
    s_nop 0
    buffer_load_dwordx4 v2, s[16:19], s41 offen offset:0 lds
    buffer_load_dwordx4 v2, s[16:19], s41 offen offset:1024 lds
    buffer_load_dwordx4 v2, s[16:19], s41 offen offset:2048 lds
    buffer_load_dwordx4 v2, s[16:19], s41 offen offset:3072 lds
    s_add_u32 m0, s43, 81920
    s_add_u32 s49, s41, 4096
    buffer_load_dwordx4 v2, s[16:19], s49 offen lds
    s_mov_b64 exec, s[50:51]
    buffer_load_dwordx4 v5, s[16:19], s44 offen offset:1024 lds
    s_mov_b64 exec, -1
    s_add_u32 s41, s41, 688128
    s_add_u32 s44, s44, 688128
    s_mov_b32 s58, 157289600
    buffer_load_dwordx4 v[8:11], v7, s[16:19], s58 offen sc1
    s_waitcnt vmcnt(21)
    s_barrier
    s_waitcnt vmcnt(11)
    s_barrier
    s_add_u32 m0, s42, 116736
    s_nop 0
    buffer_load_dwordx4 v1, s[16:19], s40 offen offset:0 lds
    buffer_load_dwordx4 v1, s[16:19], s40 offen offset:1024 lds
    buffer_load_dwordx4 v1, s[16:19], s40 offen offset:2048 lds
    buffer_load_dwordx4 v1, s[16:19], s40 offen offset:3072 lds
    s_add_u32 s40, s40, 524288
    s_add_u32 m0, s43, 116736
    s_nop 0
    buffer_load_dwordx4 v2, s[16:19], s41 offen offset:0 lds
    buffer_load_dwordx4 v2, s[16:19], s41 offen offset:1024 lds
    buffer_load_dwordx4 v2, s[16:19], s41 offen offset:2048 lds
    buffer_load_dwordx4 v2, s[16:19], s41 offen offset:3072 lds
    s_add_u32 m0, s43, 120832
    s_add_u32 s49, s41, 4096
    buffer_load_dwordx4 v2, s[16:19], s49 offen lds
    s_mov_b64 exec, s[50:51]
    buffer_load_dwordx4 v5, s[16:19], s44 offen offset:1024 lds
    s_mov_b64 exec, -1
    s_add_u32 s41, s41, 688128
    s_add_u32 s44, s44, 688128
    s_waitcnt vmcnt(11)
    s_barrier
    s_waitcnt vmcnt(10)
    s_mov_b32 s57, 32768
L_chk1:
    v_xor_b32 v24, s54, v8
    v_xor_b32 v25, s54, v9
    v_xor_b32 v26, s54, v10
    v_xor_b32 v27, s54, v11
    v_or3_b32 v24, v24, v25, v26
    v_or_b32 v24, v24, v27
    v_cmp_ne_u32 vcc, 0, v24
    s_nop 3
    s_cmp_eq_u64 vcc, 0
    s_cbranch_scc1 L_ok1
    s_sub_u32 s57, s57, 1
    s_cmp_eq_u32 s57, 0
    s_cbranch_scc1 L_ok1
    s_sleep 2
    s_mov_b32 s58, 157289600
    buffer_load_dwordx4 v[8:11], v7, s[16:19], s58 offen sc1
    s_waitcnt vmcnt(0)
    s_branch L_chk1
L_ok1:
    s_add_u32 m0, s42, 0
    s_nop 0
    buffer_load_dwordx4 v1, s[16:19], s40 offen offset:0 lds
    buffer_load_dwordx4 v1, s[16:19], s40 offen offset:1024 lds
    buffer_load_dwordx4 v1, s[16:19], s40 offen offset:2048 lds
    buffer_load_dwordx4 v1, s[16:19], s40 offen offset:3072 lds
    s_add_u32 s40, s40, 524288
    s_add_u32 m0, s43, 0
    s_nop 0
    buffer_load_dwordx4 v2, s[16:19], s41 offen offset:0 lds
    buffer_load_dwordx4 v2, s[16:19], s41 offen offset:1024 lds
    buffer_load_dwordx4 v2, s[16:19], s41 offen offset:2048 lds
    buffer_load_dwordx4 v2, s[16:19], s41 offen offset:3072 lds
    s_add_u32 m0, s43, 4096
    s_add_u32 s49, s41, 4096
    buffer_load_dwordx4 v2, s[16:19], s49 offen lds
    s_mov_b64 exec, s[50:51]
    buffer_load_dwordx4 v5, s[16:19], s44 offen offset:1024 lds
    s_mov_b64 exec, -1
    s_add_u32 s41, s41, 688128
    s_add_u32 s44, s44, 688128
    s_waitcnt vmcnt(10)
    s_barrier
    s_add_u32 m0, s42, 38912
    s_nop 0
    buffer_load_dwordx4 v1, s[16:19], s40 offen offset:0 lds
    buffer_load_dwordx4 v1, s[16:19], s40 offen offset:1024 lds
    buffer_load_dwordx4 v1, s[16:19], s40 offen offset:2048 lds
    buffer_load_dwordx4 v1, s[16:19], s40 offen offset:3072 lds
    s_add_u32 s40, s40, 524288
    s_add_u32 m0, s43, 38912
    s_nop 0
    buffer_load_dwordx4 v2, s[16:19], s41 offen offset:0 lds
    buffer_load_dwordx4 v2, s[16:19], s41 offen offset:1024 lds
    buffer_load_dwordx4 v2, s[16:19], s41 offen offset:2048 lds
    buffer_load_dwordx4 v2, s[16:19], s41 offen offset:3072 lds
    s_add_u32 m0, s43, 43008
    s_add_u32 s49, s41, 4096
    buffer_load_dwordx4 v2, s[16:19], s49 offen lds
    s_mov_b64 exec, s[50:51]
    buffer_load_dwordx4 v5, s[16:19], s44 offen offset:1024 lds
    s_mov_b64 exec, -1
    s_add_u32 s41, s41, 688128
    s_add_u32 s44, s44, 688128
    s_waitcnt vmcnt(10)
    s_barrier
    s_add_u32 m0, s42, 77824
    s_nop 0
    buffer_load_dwordx4 v1, s[16:19], s40 offen offset:0 lds
    buffer_load_dwordx4 v1, s[16:19], s40 offen offset:1024 lds
    buffer_load_dwordx4 v1, s[16:19], s40 offen offset:2048 lds
    buffer_load_dwordx4 v1, s[16:19], s40 offen offset:3072 lds
    s_add_u32 s40, s40, 524288
    s_add_u32 m0, s43, 77824
    s_nop 0
    buffer_load_dwordx4 v2, s[16:19], s41 offen offset:0 lds
    buffer_load_dwordx4 v2, s[16:19], s41 offen offset:1024 lds
    buffer_load_dwordx4 v2, s[16:19], s41 offen offset:2048 lds
    buffer_load_dwordx4 v2, s[16:19], s41 offen offset:3072 lds
    s_add_u32 m0, s43, 81920
    s_add_u32 s49, s41, 4096
    buffer_load_dwordx4 v2, s[16:19], s49 offen lds
    s_mov_b64 exec, s[50:51]
    buffer_load_dwordx4 v5, s[16:19], s44 offen offset:1024 lds
    s_mov_b64 exec, -1
    s_add_u32 s41, s41, 688128
    s_add_u32 s44, s44, 688128
    s_waitcnt vmcnt(10)
    s_barrier
    s_add_u32 m0, s42, 116736
    s_nop 0
    buffer_load_dwordx4 v1, s[16:19], s40 offen offset:0 lds
    buffer_load_dwordx4 v1, s[16:19], s40 offen offset:1024 lds
    buffer_load_dwordx4 v1, s[16:19], s40 offen offset:2048 lds
    buffer_load_dwordx4 v1, s[16:19], s40 offen offset:3072 lds
    s_add_u32 s40, s40, 524288
    s_add_u32 m0, s43, 116736
    s_nop 0
    buffer_load_dwordx4 v2, s[16:19], s41 offen offset:0 lds
    buffer_load_dwordx4 v2, s[16:19], s41 offen offset:1024 lds
    buffer_load_dwordx4 v2, s[16:19], s41 offen offset:2048 lds
    buffer_load_dwordx4 v2, s[16:19], s41 offen offset:3072 lds
    s_add_u32 m0, s43, 120832
    s_add_u32 s49, s41, 4096
    buffer_load_dwordx4 v2, s[16:19], s49 offen lds
    s_mov_b64 exec, s[50:51]
    buffer_load_dwordx4 v5, s[16:19], s44 offen offset:1024 lds
    s_mov_b64 exec, -1
    s_add_u32 s41, s41, 688128
    s_add_u32 s44, s44, 688128
    s_mov_b32 s58, 157290112
    buffer_load_dwordx4 v[8:11], v7, s[16:19], s58 offen sc1
    s_waitcnt vmcnt(11)
    s_barrier
    s_waitcnt vmcnt(0)
    s_mov_b32 s57, 32768
L_chk2:
    v_xor_b32 v24, s54, v8
    v_xor_b32 v25, s54, v9
    v_xor_b32 v26, s54, v10
    v_xor_b32 v27, s54, v11
    v_or3_b32 v24, v24, v25, v26
    v_or_b32 v24, v24, v27
    v_cmp_ne_u32 vcc, 0, v24
    s_nop 3
    s_cmp_eq_u64 vcc, 0
    s_cbranch_scc1 L_ok2
    s_sub_u32 s57, s57, 1
    s_cmp_eq_u32 s57, 0
    s_cbranch_scc1 L_ok2
    s_sleep 2
    s_mov_b32 s58, 157290112
    buffer_load_dwordx4 v[8:11], v7, s[16:19], s58 offen sc1
    s_waitcnt vmcnt(0)
    s_branch L_chk2
L_ok2:
    s_add_u32 m0, s42, 0
    s_nop 0
    buffer_load_dwordx4 v1, s[16:19], s40 offen offset:0 lds
    buffer_load_dwordx4 v1, s[16:19], s40 offen offset:1024 lds
    buffer_load_dwordx4 v1, s[16:19], s40 offen offset:2048 lds
    buffer_load_dwordx4 v1, s[16:19], s40 offen offset:3072 lds
    s_add_u32 s40, s40, 524288
    s_add_u32 m0, s43, 0
    s_nop 0
    buffer_load_dwordx4 v2, s[16:19], s41 offen offset:0 lds
    buffer_load_dwordx4 v2, s[16:19], s41 offen offset:1024 lds
    buffer_load_dwordx4 v2, s[16:19], s41 offen offset:2048 lds
    buffer_load_dwordx4 v2, s[16:19], s41 offen offset:3072 lds
    s_add_u32 m0, s43, 4096
    s_add_u32 s49, s41, 4096
    buffer_load_dwordx4 v2, s[16:19], s49 offen lds
    s_mov_b64 exec, s[50:51]
    buffer_load_dwordx4 v5, s[16:19], s44 offen offset:1024 lds
    s_mov_b64 exec, -1
    s_add_u32 s41, s41, 688128
    s_add_u32 s44, s44, 688128
    s_waitcnt vmcnt(11)
    s_barrier
    s_add_u32 m0, s42, 38912
    s_nop 0
    buffer_load_dwordx4 v1, s[16:19], s40 offen offset:0 lds
    buffer_load_dwordx4 v1, s[16:19], s40 offen offset:1024 lds
    buffer_load_dwordx4 v1, s[16:19], s40 offen offset:2048 lds
    buffer_load_dwordx4 v1, s[16:19], s40 offen offset:3072 lds
    s_add_u32 s40, s40, 524288
    s_add_u32 m0, s43, 38912
    s_nop 0
    buffer_load_dwordx4 v2, s[16:19], s41 offen offset:0 lds
    buffer_load_dwordx4 v2, s[16:19], s41 offen offset:1024 lds
    buffer_load_dwordx4 v2, s[16:19], s41 offen offset:2048 lds
    buffer_load_dwordx4 v2, s[16:19], s41 offen offset:3072 lds
    s_add_u32 m0, s43, 43008
    s_add_u32 s49, s41, 4096
    buffer_load_dwordx4 v2, s[16:19], s49 offen lds
    s_mov_b64 exec, s[50:51]
    buffer_load_dwordx4 v5, s[16:19], s44 offen offset:1024 lds
    s_mov_b64 exec, -1
    s_add_u32 s41, s41, 688128
    s_add_u32 s44, s44, 688128
    s_waitcnt vmcnt(10)
    s_barrier
    s_add_u32 m0, s42, 77824
    s_nop 0
    buffer_load_dwordx4 v1, s[16:19], s40 offen offset:0 lds
    buffer_load_dwordx4 v1, s[16:19], s40 offen offset:1024 lds
    buffer_load_dwordx4 v1, s[16:19], s40 offen offset:2048 lds
    buffer_load_dwordx4 v1, s[16:19], s40 offen offset:3072 lds
    s_add_u32 s40, s40, 524288
    s_add_u32 m0, s43, 77824
    s_nop 0
    buffer_load_dwordx4 v2, s[16:19], s41 offen offset:0 lds
    buffer_load_dwordx4 v2, s[16:19], s41 offen offset:1024 lds
    buffer_load_dwordx4 v2, s[16:19], s41 offen offset:2048 lds
    buffer_load_dwordx4 v2, s[16:19], s41 offen offset:3072 lds
    s_add_u32 m0, s43, 81920
    s_add_u32 s49, s41, 4096
    buffer_load_dwordx4 v2, s[16:19], s49 offen lds
    s_mov_b64 exec, s[50:51]
    buffer_load_dwordx4 v5, s[16:19], s44 offen offset:1024 lds
    s_mov_b64 exec, -1
    s_add_u32 s41, s41, 688128
    s_add_u32 s44, s44, 688128
    s_waitcnt vmcnt(10)
    s_barrier
    s_add_u32 m0, s42, 116736
    s_nop 0
    buffer_load_dwordx4 v1, s[16:19], s40 offen offset:0 lds
    buffer_load_dwordx4 v1, s[16:19], s40 offen offset:1024 lds
    buffer_load_dwordx4 v1, s[16:19], s40 offen offset:2048 lds
    buffer_load_dwordx4 v1, s[16:19], s40 offen offset:3072 lds
    s_add_u32 s40, s40, 524288
    s_add_u32 m0, s43, 116736
    s_nop 0
    buffer_load_dwordx4 v2, s[16:19], s41 offen offset:0 lds
    buffer_load_dwordx4 v2, s[16:19], s41 offen offset:1024 lds
    buffer_load_dwordx4 v2, s[16:19], s41 offen offset:2048 lds
    buffer_load_dwordx4 v2, s[16:19], s41 offen offset:3072 lds
    s_add_u32 m0, s43, 120832
    s_add_u32 s49, s41, 4096
    buffer_load_dwordx4 v2, s[16:19], s49 offen lds
    s_mov_b64 exec, s[50:51]
    buffer_load_dwordx4 v5, s[16:19], s44 offen offset:1024 lds
    s_mov_b64 exec, -1
    s_add_u32 s41, s41, 688128
    s_add_u32 s44, s44, 688128
    s_mov_b32 s58, 157290624
    buffer_load_dwordx4 v[8:11], v7, s[16:19], s58 offen sc1
    s_waitcnt vmcnt(11)
    s_barrier
    s_waitcnt vmcnt(0)
    s_mov_b32 s57, 32768
L_chk3:
    v_xor_b32 v24, s54, v8
    v_xor_b32 v25, s54, v9
    v_xor_b32 v26, s54, v10
    v_xor_b32 v27, s54, v11
    v_or3_b32 v24, v24, v25, v26
    v_or_b32 v24, v24, v27
    v_cmp_ne_u32 vcc, 0, v24
    s_nop 3
    s_cmp_eq_u64 vcc, 0
    s_cbranch_scc1 L_ok3
    s_sub_u32 s57, s57, 1
    s_cmp_eq_u32 s57, 0
    s_cbranch_scc1 L_ok3
    s_sleep 2
    s_mov_b32 s58, 157290624
    buffer_load_dwordx4 v[8:11], v7, s[16:19], s58 offen sc1
    s_waitcnt vmcnt(0)
    s_branch L_chk3
L_ok3:
    s_add_u32 m0, s42, 0
    s_nop 0
    buffer_load_dwordx4 v1, s[16:19], s40 offen offset:0 lds
    buffer_load_dwordx4 v1, s[16:19], s40 offen offset:1024 lds
    buffer_load_dwordx4 v1, s[16:19], s40 offen offset:2048 lds
    buffer_load_dwordx4 v1, s[16:19], s40 offen offset:3072 lds
    s_add_u32 s40, s40, 524288
    s_add_u32 m0, s43, 0
    s_nop 0
    buffer_load_dwordx4 v2, s[16:19], s41 offen offset:0 lds
    buffer_load_dwordx4 v2, s[16:19], s41 offen offset:1024 lds
    buffer_load_dwordx4 v2, s[16:19], s41 offen offset:2048 lds
    buffer_load_dwordx4 v2, s[16:19], s41 offen offset:3072 lds
    s_add_u32 m0, s43, 4096
    s_add_u32 s49, s41, 4096
    buffer_load_dwordx4 v2, s[16:19], s49 offen lds
    s_mov_b64 exec, s[50:51]
    buffer_load_dwordx4 v5, s[16:19], s44 offen offset:1024 lds
    s_mov_b64 exec, -1
    s_add_u32 s41, s41, 688128
    s_add_u32 s44, s44, 688128
    s_waitcnt vmcnt(11)
    s_barrier
    s_add_u32 m0, s42, 38912
    s_nop 0
    buffer_load_dwordx4 v1, s[16:19], s40 offen offset:0 lds
    buffer_load_dwordx4 v1, s[16:19], s40 offen offset:1024 lds
    buffer_load_dwordx4 v1, s[16:19], s40 offen offset:2048 lds
    buffer_load_dwordx4 v1, s[16:19], s40 offen offset:3072 lds
    s_add_u32 s40, s40, 524288
    s_add_u32 m0, s43, 38912
    s_nop 0
    buffer_load_dwordx4 v2, s[16:19], s41 offen offset:0 lds
    buffer_load_dwordx4 v2, s[16:19], s41 offen offset:1024 lds
    buffer_load_dwordx4 v2, s[16:19], s41 offen offset:2048 lds
    buffer_load_dwordx4 v2, s[16:19], s41 offen offset:3072 lds
    s_add_u32 m0, s43, 43008
    s_add_u32 s49, s41, 4096
    buffer_load_dwordx4 v2, s[16:19], s49 offen lds
    s_mov_b64 exec, s[50:51]
    buffer_load_dwordx4 v5, s[16:19], s44 offen offset:1024 lds
    s_mov_b64 exec, -1
    s_add_u32 s41, s41, 688128
    s_add_u32 s44, s44, 688128
    s_waitcnt vmcnt(10)
    s_barrier
    s_add_u32 m0, s42, 77824
    s_nop 0
    buffer_load_dwordx4 v1, s[16:19], s40 offen offset:0 lds
    buffer_load_dwordx4 v1, s[16:19], s40 offen offset:1024 lds
    buffer_load_dwordx4 v1, s[16:19], s40 offen offset:2048 lds
    buffer_load_dwordx4 v1, s[16:19], s40 offen offset:3072 lds
    s_add_u32 s40, s40, 524288
    s_add_u32 m0, s43, 77824
    s_nop 0
    buffer_load_dwordx4 v2, s[16:19], s41 offen offset:0 lds
    buffer_load_dwordx4 v2, s[16:19], s41 offen offset:1024 lds
    buffer_load_dwordx4 v2, s[16:19], s41 offen offset:2048 lds
    buffer_load_dwordx4 v2, s[16:19], s41 offen offset:3072 lds
    s_add_u32 m0, s43, 81920
    s_add_u32 s49, s41, 4096
    buffer_load_dwordx4 v2, s[16:19], s49 offen lds
    s_mov_b64 exec, s[50:51]
    buffer_load_dwordx4 v5, s[16:19], s44 offen offset:1024 lds
    s_mov_b64 exec, -1
    s_add_u32 s41, s41, 688128
    s_add_u32 s44, s44, 688128
    s_waitcnt vmcnt(10)
    s_barrier
    s_add_u32 m0, s42, 116736
    s_nop 0
    buffer_load_dwordx4 v1, s[16:19], s40 offen offset:0 lds
    buffer_load_dwordx4 v1, s[16:19], s40 offen offset:1024 lds
    buffer_load_dwordx4 v1, s[16:19], s40 offen offset:2048 lds
    buffer_load_dwordx4 v1, s[16:19], s40 offen offset:3072 lds
    s_add_u32 s40, s40, 524288
    s_add_u32 m0, s43, 116736
    s_nop 0
    buffer_load_dwordx4 v2, s[16:19], s41 offen offset:0 lds
    buffer_load_dwordx4 v2, s[16:19], s41 offen offset:1024 lds
    buffer_load_dwordx4 v2, s[16:19], s41 offen offset:2048 lds
    buffer_load_dwordx4 v2, s[16:19], s41 offen offset:3072 lds
    s_add_u32 m0, s43, 120832
    s_add_u32 s49, s41, 4096
    buffer_load_dwordx4 v2, s[16:19], s49 offen lds
    s_mov_b64 exec, s[50:51]
    buffer_load_dwordx4 v5, s[16:19], s44 offen offset:1024 lds
    s_mov_b64 exec, -1
    s_add_u32 s41, s41, 688128
    s_add_u32 s44, s44, 688128
    s_mov_b32 s58, 157291136
    buffer_load_dwordx4 v[8:11], v7, s[16:19], s58 offen sc1
    s_waitcnt vmcnt(11)
    s_barrier
    s_waitcnt vmcnt(0)
    s_mov_b32 s57, 32768
L_chk4:
    v_xor_b32 v24, s54, v8
    v_xor_b32 v25, s54, v9
    v_xor_b32 v26, s54, v10
    v_xor_b32 v27, s54, v11
    v_or3_b32 v24, v24, v25, v26
    v_or_b32 v24, v24, v27
    v_cmp_ne_u32 vcc, 0, v24
    s_nop 3
    s_cmp_eq_u64 vcc, 0
    s_cbranch_scc1 L_ok4
    s_sub_u32 s57, s57, 1
    s_cmp_eq_u32 s57, 0
    s_cbranch_scc1 L_ok4
    s_sleep 2
    s_mov_b32 s58, 157291136
    buffer_load_dwordx4 v[8:11], v7, s[16:19], s58 offen sc1
    s_waitcnt vmcnt(0)
    s_branch L_chk4
L_ok4:
    s_add_u32 m0, s42, 0
    s_nop 0
    buffer_load_dwordx4 v1, s[16:19], s40 offen offset:0 lds
    buffer_load_dwordx4 v1, s[16:19], s40 offen offset:1024 lds
    buffer_load_dwordx4 v1, s[16:19], s40 offen offset:2048 lds
    buffer_load_dwordx4 v1, s[16:19], s40 offen offset:3072 lds
    s_add_u32 s40, s40, 524288
    s_add_u32 m0, s43, 0
    s_nop 0
    buffer_load_dwordx4 v2, s[16:19], s41 offen offset:0 lds
    buffer_load_dwordx4 v2, s[16:19], s41 offen offset:1024 lds
    buffer_load_dwordx4 v2, s[16:19], s41 offen offset:2048 lds
    buffer_load_dwordx4 v2, s[16:19], s41 offen offset:3072 lds
    s_add_u32 m0, s43, 4096
    s_add_u32 s49, s41, 4096
    buffer_load_dwordx4 v2, s[16:19], s49 offen lds
    s_mov_b64 exec, s[50:51]
    buffer_load_dwordx4 v5, s[16:19], s44 offen offset:1024 lds
    s_mov_b64 exec, -1
    s_add_u32 s41, s41, 688128
    s_add_u32 s44, s44, 688128
    s_waitcnt vmcnt(11)
    s_barrier
    s_add_u32 m0, s42, 38912
    s_nop 0
    buffer_load_dwordx4 v1, s[16:19], s40 offen offset:0 lds
    buffer_load_dwordx4 v1, s[16:19], s40 offen offset:1024 lds
    buffer_load_dwordx4 v1, s[16:19], s40 offen offset:2048 lds
    buffer_load_dwordx4 v1, s[16:19], s40 offen offset:3072 lds
    s_add_u32 s40, s40, 524288
    s_add_u32 m0, s43, 38912
    s_nop 0
    buffer_load_dwordx4 v2, s[16:19], s41 offen offset:0 lds
    buffer_load_dwordx4 v2, s[16:19], s41 offen offset:1024 lds
    buffer_load_dwordx4 v2, s[16:19], s41 offen offset:2048 lds
    buffer_load_dwordx4 v2, s[16:19], s41 offen offset:3072 lds
    s_add_u32 m0, s43, 43008
    s_add_u32 s49, s41, 4096
    buffer_load_dwordx4 v2, s[16:19], s49 offen lds
    s_mov_b64 exec, s[50:51]
    buffer_load_dwordx4 v5, s[16:19], s44 offen offset:1024 lds
    s_mov_b64 exec, -1
    s_add_u32 s41, s41, 688128
    s_add_u32 s44, s44, 688128
    s_waitcnt vmcnt(10)
    s_barrier
    s_add_u32 m0, s42, 77824
    s_nop 0
    buffer_load_dwordx4 v1, s[16:19], s40 offen offset:0 lds
    buffer_load_dwordx4 v1, s[16:19], s40 offen offset:1024 lds
    buffer_load_dwordx4 v1, s[16:19], s40 offen offset:2048 lds
    buffer_load_dwordx4 v1, s[16:19], s40 offen offset:3072 lds
    s_add_u32 s40, s40, 524288
    s_add_u32 m0, s43, 77824
    s_nop 0
    buffer_load_dwordx4 v2, s[16:19], s41 offen offset:0 lds
    buffer_load_dwordx4 v2, s[16:19], s41 offen offset:1024 lds
    buffer_load_dwordx4 v2, s[16:19], s41 offen offset:2048 lds
    buffer_load_dwordx4 v2, s[16:19], s41 offen offset:3072 lds
    s_add_u32 m0, s43, 81920
    s_add_u32 s49, s41, 4096
    buffer_load_dwordx4 v2, s[16:19], s49 offen lds
    s_mov_b64 exec, s[50:51]
    buffer_load_dwordx4 v5, s[16:19], s44 offen offset:1024 lds
    s_mov_b64 exec, -1
    s_add_u32 s41, s41, 688128
    s_add_u32 s44, s44, 688128
    s_waitcnt vmcnt(10)
    s_barrier
    s_add_u32 m0, s42, 116736
    s_nop 0
    buffer_load_dwordx4 v1, s[16:19], s40 offen offset:0 lds
    buffer_load_dwordx4 v1, s[16:19], s40 offen offset:1024 lds
    buffer_load_dwordx4 v1, s[16:19], s40 offen offset:2048 lds
    buffer_load_dwordx4 v1, s[16:19], s40 offen offset:3072 lds
    s_add_u32 s40, s40, 524288
    s_add_u32 m0, s43, 116736
    s_nop 0
    buffer_load_dwordx4 v2, s[16:19], s41 offen offset:0 lds
    buffer_load_dwordx4 v2, s[16:19], s41 offen offset:1024 lds
    buffer_load_dwordx4 v2, s[16:19], s41 offen offset:2048 lds
    buffer_load_dwordx4 v2, s[16:19], s41 offen offset:3072 lds
    s_add_u32 m0, s43, 120832
    s_add_u32 s49, s41, 4096
    buffer_load_dwordx4 v2, s[16:19], s49 offen lds
    s_mov_b64 exec, s[50:51]
    buffer_load_dwordx4 v5, s[16:19], s44 offen offset:1024 lds
    s_mov_b64 exec, -1
    s_add_u32 s41, s41, 688128
    s_add_u32 s44, s44, 688128
    s_mov_b32 s58, 157291648
    buffer_load_dwordx4 v[8:11], v7, s[16:19], s58 offen sc1
    s_waitcnt vmcnt(11)
    s_barrier
    s_waitcnt vmcnt(0)
    s_mov_b32 s57, 32768
L_chk5:
    v_xor_b32 v24, s54, v8
    v_xor_b32 v25, s54, v9
    v_xor_b32 v26, s54, v10
    v_xor_b32 v27, s54, v11
    v_or3_b32 v24, v24, v25, v26
    v_or_b32 v24, v24, v27
    v_cmp_ne_u32 vcc, 0, v24
    s_nop 3
    s_cmp_eq_u64 vcc, 0
    s_cbranch_scc1 L_ok5
    s_sub_u32 s57, s57, 1
    s_cmp_eq_u32 s57, 0
    s_cbranch_scc1 L_ok5
    s_sleep 2
    s_mov_b32 s58, 157291648
    buffer_load_dwordx4 v[8:11], v7, s[16:19], s58 offen sc1
    s_waitcnt vmcnt(0)
    s_branch L_chk5
L_ok5:
    s_add_u32 m0, s42, 0
    s_nop 0
    buffer_load_dwordx4 v1, s[16:19], s40 offen offset:0 lds
    buffer_load_dwordx4 v1, s[16:19], s40 offen offset:1024 lds
    buffer_load_dwordx4 v1, s[16:19], s40 offen offset:2048 lds
    buffer_load_dwordx4 v1, s[16:19], s40 offen offset:3072 lds
    s_add_u32 s40, s40, 524288
    s_add_u32 m0, s43, 0
    s_nop 0
    buffer_load_dwordx4 v2, s[16:19], s41 offen offset:0 lds
    buffer_load_dwordx4 v2, s[16:19], s41 offen offset:1024 lds
    buffer_load_dwordx4 v2, s[16:19], s41 offen offset:2048 lds
    buffer_load_dwordx4 v2, s[16:19], s41 offen offset:3072 lds
    s_add_u32 m0, s43, 4096
    s_add_u32 s49, s41, 4096
    buffer_load_dwordx4 v2, s[16:19], s49 offen lds
    s_mov_b64 exec, s[50:51]
    buffer_load_dwordx4 v5, s[16:19], s44 offen offset:1024 lds
    s_mov_b64 exec, -1
    s_add_u32 s41, s41, 688128
    s_add_u32 s44, s44, 688128
    s_waitcnt vmcnt(11)
    s_barrier
    s_add_u32 m0, s42, 38912
    s_nop 0
    buffer_load_dwordx4 v1, s[16:19], s40 offen offset:0 lds
    buffer_load_dwordx4 v1, s[16:19], s40 offen offset:1024 lds
    buffer_load_dwordx4 v1, s[16:19], s40 offen offset:2048 lds
    buffer_load_dwordx4 v1, s[16:19], s40 offen offset:3072 lds
    s_add_u32 s40, s40, 524288
    s_add_u32 m0, s43, 38912
    s_nop 0
    buffer_load_dwordx4 v2, s[16:19], s41 offen offset:0 lds
    buffer_load_dwordx4 v2, s[16:19], s41 offen offset:1024 lds
    buffer_load_dwordx4 v2, s[16:19], s41 offen offset:2048 lds
    buffer_load_dwordx4 v2, s[16:19], s41 offen offset:3072 lds
    s_add_u32 m0, s43, 43008
    s_add_u32 s49, s41, 4096
    buffer_load_dwordx4 v2, s[16:19], s49 offen lds
    s_mov_b64 exec, s[50:51]
    buffer_load_dwordx4 v5, s[16:19], s44 offen offset:1024 lds
    s_mov_b64 exec, -1
    s_add_u32 s41, s41, 688128
    s_add_u32 s44, s44, 688128
    s_waitcnt vmcnt(10)
    s_barrier
    s_add_u32 m0, s42, 77824
    s_nop 0
    buffer_load_dwordx4 v1, s[16:19], s40 offen offset:0 lds
    buffer_load_dwordx4 v1, s[16:19], s40 offen offset:1024 lds
    buffer_load_dwordx4 v1, s[16:19], s40 offen offset:2048 lds
    buffer_load_dwordx4 v1, s[16:19], s40 offen offset:3072 lds
    s_add_u32 s40, s40, 524288
    s_add_u32 m0, s43, 77824
    s_nop 0
    buffer_load_dwordx4 v2, s[16:19], s41 offen offset:0 lds
    buffer_load_dwordx4 v2, s[16:19], s41 offen offset:1024 lds
    buffer_load_dwordx4 v2, s[16:19], s41 offen offset:2048 lds
    buffer_load_dwordx4 v2, s[16:19], s41 offen offset:3072 lds
    s_add_u32 m0, s43, 81920
    s_add_u32 s49, s41, 4096
    buffer_load_dwordx4 v2, s[16:19], s49 offen lds
    s_mov_b64 exec, s[50:51]
    buffer_load_dwordx4 v5, s[16:19], s44 offen offset:1024 lds
    s_mov_b64 exec, -1
    s_add_u32 s41, s41, 688128
    s_add_u32 s44, s44, 688128
    s_waitcnt vmcnt(10)
    s_barrier
    s_add_u32 m0, s42, 116736
    s_nop 0
    buffer_load_dwordx4 v1, s[16:19], s40 offen offset:0 lds
    buffer_load_dwordx4 v1, s[16:19], s40 offen offset:1024 lds
    buffer_load_dwordx4 v1, s[16:19], s40 offen offset:2048 lds
    buffer_load_dwordx4 v1, s[16:19], s40 offen offset:3072 lds
    s_add_u32 s40, s40, 524288
    s_add_u32 m0, s43, 116736
    s_nop 0
    buffer_load_dwordx4 v2, s[16:19], s41 offen offset:0 lds
    buffer_load_dwordx4 v2, s[16:19], s41 offen offset:1024 lds
    buffer_load_dwordx4 v2, s[16:19], s41 offen offset:2048 lds
    buffer_load_dwordx4 v2, s[16:19], s41 offen offset:3072 lds
    s_add_u32 m0, s43, 120832
    s_add_u32 s49, s41, 4096
    buffer_load_dwordx4 v2, s[16:19], s49 offen lds
    s_mov_b64 exec, s[50:51]
    buffer_load_dwordx4 v5, s[16:19], s44 offen offset:1024 lds
    s_mov_b64 exec, -1
    s_add_u32 s41, s41, 688128
    s_add_u32 s44, s44, 688128
    s_mov_b32 s58, 157292160
    buffer_load_dwordx4 v[8:11], v7, s[16:19], s58 offen sc1
    s_waitcnt vmcnt(11)
    s_barrier
    s_waitcnt vmcnt(0)
    s_mov_b32 s57, 32768
L_chk6:
    v_xor_b32 v24, s54, v8
    v_xor_b32 v25, s54, v9
    v_xor_b32 v26, s54, v10
    v_xor_b32 v27, s54, v11
    v_or3_b32 v24, v24, v25, v26
    v_or_b32 v24, v24, v27
    v_cmp_ne_u32 vcc, 0, v24
    s_nop 3
    s_cmp_eq_u64 vcc, 0
    s_cbranch_scc1 L_ok6
    s_sub_u32 s57, s57, 1
    s_cmp_eq_u32 s57, 0
    s_cbranch_scc1 L_ok6
    s_sleep 2
    s_mov_b32 s58, 157292160
    buffer_load_dwordx4 v[8:11], v7, s[16:19], s58 offen sc1
    s_waitcnt vmcnt(0)
    s_branch L_chk6
L_ok6:
    s_add_u32 m0, s42, 0
    s_nop 0
    buffer_load_dwordx4 v1, s[16:19], s40 offen offset:0 lds
    buffer_load_dwordx4 v1, s[16:19], s40 offen offset:1024 lds
    buffer_load_dwordx4 v1, s[16:19], s40 offen offset:2048 lds
    buffer_load_dwordx4 v1, s[16:19], s40 offen offset:3072 lds
    s_add_u32 s40, s40, 524288
    s_add_u32 m0, s43, 0
    s_nop 0
    buffer_load_dwordx4 v2, s[16:19], s41 offen offset:0 lds
    buffer_load_dwordx4 v2, s[16:19], s41 offen offset:1024 lds
    buffer_load_dwordx4 v2, s[16:19], s41 offen offset:2048 lds
    buffer_load_dwordx4 v2, s[16:19], s41 offen offset:3072 lds
    s_add_u32 m0, s43, 4096
    s_add_u32 s49, s41, 4096
    buffer_load_dwordx4 v2, s[16:19], s49 offen lds
    s_mov_b64 exec, s[50:51]
    buffer_load_dwordx4 v5, s[16:19], s44 offen offset:1024 lds
    s_mov_b64 exec, -1
    s_add_u32 s41, s41, 688128
    s_add_u32 s44, s44, 688128
    s_waitcnt vmcnt(11)
    s_barrier
    s_add_u32 m0, s42, 38912
    s_nop 0
    buffer_load_dwordx4 v1, s[16:19], s40 offen offset:0 lds
    buffer_load_dwordx4 v1, s[16:19], s40 offen offset:1024 lds
    buffer_load_dwordx4 v1, s[16:19], s40 offen offset:2048 lds
    buffer_load_dwordx4 v1, s[16:19], s40 offen offset:3072 lds
    s_add_u32 s40, s40, 524288
    s_add_u32 m0, s43, 38912
    s_nop 0
    buffer_load_dwordx4 v2, s[16:19], s41 offen offset:0 lds
    buffer_load_dwordx4 v2, s[16:19], s41 offen offset:1024 lds
    buffer_load_dwordx4 v2, s[16:19], s41 offen offset:2048 lds
    buffer_load_dwordx4 v2, s[16:19], s41 offen offset:3072 lds
    s_add_u32 m0, s43, 43008
    s_add_u32 s49, s41, 4096
    buffer_load_dwordx4 v2, s[16:19], s49 offen lds
    s_mov_b64 exec, s[50:51]
    buffer_load_dwordx4 v5, s[16:19], s44 offen offset:1024 lds
    s_mov_b64 exec, -1
    s_add_u32 s41, s41, 688128
    s_add_u32 s44, s44, 688128
    s_waitcnt vmcnt(10)
    s_barrier
    s_add_u32 m0, s42, 77824
    s_nop 0
    buffer_load_dwordx4 v1, s[16:19], s40 offen offset:0 lds
    buffer_load_dwordx4 v1, s[16:19], s40 offen offset:1024 lds
    buffer_load_dwordx4 v1, s[16:19], s40 offen offset:2048 lds
    buffer_load_dwordx4 v1, s[16:19], s40 offen offset:3072 lds
    s_add_u32 s40, s40, 524288
    s_add_u32 m0, s43, 77824
    s_nop 0
    buffer_load_dwordx4 v2, s[16:19], s41 offen offset:0 lds
    buffer_load_dwordx4 v2, s[16:19], s41 offen offset:1024 lds
    buffer_load_dwordx4 v2, s[16:19], s41 offen offset:2048 lds
    buffer_load_dwordx4 v2, s[16:19], s41 offen offset:3072 lds
    s_add_u32 m0, s43, 81920
    s_add_u32 s49, s41, 4096
    buffer_load_dwordx4 v2, s[16:19], s49 offen lds
    s_mov_b64 exec, s[50:51]
    buffer_load_dwordx4 v5, s[16:19], s44 offen offset:1024 lds
    s_mov_b64 exec, -1
    s_add_u32 s41, s41, 688128
    s_add_u32 s44, s44, 688128
    s_waitcnt vmcnt(10)
    s_barrier
    s_add_u32 m0, s42, 116736
    s_nop 0
    buffer_load_dwordx4 v1, s[16:19], s40 offen offset:0 lds
    buffer_load_dwordx4 v1, s[16:19], s40 offen offset:1024 lds
    buffer_load_dwordx4 v1, s[16:19], s40 offen offset:2048 lds
    buffer_load_dwordx4 v1, s[16:19], s40 offen offset:3072 lds
    s_add_u32 s40, s40, 524288
    s_add_u32 m0, s43, 116736
    s_nop 0
    buffer_load_dwordx4 v2, s[16:19], s41 offen offset:0 lds
    buffer_load_dwordx4 v2, s[16:19], s41 offen offset:1024 lds
    buffer_load_dwordx4 v2, s[16:19], s41 offen offset:2048 lds
    buffer_load_dwordx4 v2, s[16:19], s41 offen offset:3072 lds
    s_add_u32 m0, s43, 120832
    s_add_u32 s49, s41, 4096
    buffer_load_dwordx4 v2, s[16:19], s49 offen lds
    s_mov_b64 exec, s[50:51]
    buffer_load_dwordx4 v5, s[16:19], s44 offen offset:1024 lds
    s_mov_b64 exec, -1
    s_add_u32 s41, s41, 688128
    s_add_u32 s44, s44, 688128
    s_mov_b32 s58, 157292672
    buffer_load_dwordx4 v[8:11], v7, s[16:19], s58 offen sc1
    s_waitcnt vmcnt(11)
    s_barrier
    s_waitcnt vmcnt(0)
    s_mov_b32 s57, 32768
L_chk7:
    v_xor_b32 v24, s54, v8
    v_xor_b32 v25, s54, v9
    v_xor_b32 v26, s54, v10
    v_xor_b32 v27, s54, v11
    v_or3_b32 v24, v24, v25, v26
    v_or_b32 v24, v24, v27
    v_cmp_ne_u32 vcc, 0, v24
    s_nop 3
    s_cmp_eq_u64 vcc, 0
    s_cbranch_scc1 L_ok7
    s_sub_u32 s57, s57, 1
    s_cmp_eq_u32 s57, 0
    s_cbranch_scc1 L_ok7
    s_sleep 2
    s_mov_b32 s58, 157292672
    buffer_load_dwordx4 v[8:11], v7, s[16:19], s58 offen sc1
    s_waitcnt vmcnt(0)
    s_branch L_chk7
L_ok7:
    s_add_u32 m0, s42, 0
    s_nop 0
    buffer_load_dwordx4 v1, s[16:19], s40 offen offset:0 lds
    buffer_load_dwordx4 v1, s[16:19], s40 offen offset:1024 lds
    buffer_load_dwordx4 v1, s[16:19], s40 offen offset:2048 lds
    buffer_load_dwordx4 v1, s[16:19], s40 offen offset:3072 lds
    s_add_u32 s40, s40, 524288
    s_add_u32 m0, s43, 0
    s_nop 0
    buffer_load_dwordx4 v2, s[16:19], s41 offen offset:0 lds
    buffer_load_dwordx4 v2, s[16:19], s41 offen offset:1024 lds
    buffer_load_dwordx4 v2, s[16:19], s41 offen offset:2048 lds
    buffer_load_dwordx4 v2, s[16:19], s41 offen offset:3072 lds
    s_add_u32 m0, s43, 4096
    s_add_u32 s49, s41, 4096
    buffer_load_dwordx4 v2, s[16:19], s49 offen lds
    s_mov_b64 exec, s[50:51]
    buffer_load_dwordx4 v5, s[16:19], s44 offen offset:1024 lds
    s_mov_b64 exec, -1
    s_add_u32 s41, s41, 688128
    s_add_u32 s44, s44, 688128
    s_waitcnt vmcnt(11)
    s_barrier
    s_add_u32 m0, s42, 38912
    s_nop 0
    buffer_load_dwordx4 v1, s[16:19], s40 offen offset:0 lds
    buffer_load_dwordx4 v1, s[16:19], s40 offen offset:1024 lds
    buffer_load_dwordx4 v1, s[16:19], s40 offen offset:2048 lds
    buffer_load_dwordx4 v1, s[16:19], s40 offen offset:3072 lds
    s_add_u32 s40, s40, 524288
    s_add_u32 m0, s43, 38912
    s_nop 0
    buffer_load_dwordx4 v2, s[16:19], s41 offen offset:0 lds
    buffer_load_dwordx4 v2, s[16:19], s41 offen offset:1024 lds
    buffer_load_dwordx4 v2, s[16:19], s41 offen offset:2048 lds
    buffer_load_dwordx4 v2, s[16:19], s41 offen offset:3072 lds
    s_add_u32 m0, s43, 43008
    s_add_u32 s49, s41, 4096
    buffer_load_dwordx4 v2, s[16:19], s49 offen lds
    s_mov_b64 exec, s[50:51]
    buffer_load_dwordx4 v5, s[16:19], s44 offen offset:1024 lds
    s_mov_b64 exec, -1
    s_add_u32 s41, s41, 688128
    s_add_u32 s44, s44, 688128
    s_waitcnt vmcnt(10)
    s_barrier
    s_add_u32 m0, s42, 77824
    s_nop 0
    buffer_load_dwordx4 v1, s[16:19], s40 offen offset:0 lds
    buffer_load_dwordx4 v1, s[16:19], s40 offen offset:1024 lds
    buffer_load_dwordx4 v1, s[16:19], s40 offen offset:2048 lds
    buffer_load_dwordx4 v1, s[16:19], s40 offen offset:3072 lds
    s_add_u32 s40, s40, 524288
    s_add_u32 m0, s43, 77824
    s_nop 0
    buffer_load_dwordx4 v2, s[16:19], s41 offen offset:0 lds
    buffer_load_dwordx4 v2, s[16:19], s41 offen offset:1024 lds
    buffer_load_dwordx4 v2, s[16:19], s41 offen offset:2048 lds
    buffer_load_dwordx4 v2, s[16:19], s41 offen offset:3072 lds
    s_add_u32 m0, s43, 81920
    s_add_u32 s49, s41, 4096
    buffer_load_dwordx4 v2, s[16:19], s49 offen lds
    s_mov_b64 exec, s[50:51]
    buffer_load_dwordx4 v5, s[16:19], s44 offen offset:1024 lds
    s_mov_b64 exec, -1
    s_add_u32 s41, s41, 688128
    s_add_u32 s44, s44, 688128
    s_waitcnt vmcnt(10)
    s_barrier
    s_add_u32 m0, s42, 116736
    s_nop 0
    buffer_load_dwordx4 v1, s[16:19], s40 offen offset:0 lds
    buffer_load_dwordx4 v1, s[16:19], s40 offen offset:1024 lds
    buffer_load_dwordx4 v1, s[16:19], s40 offen offset:2048 lds
    buffer_load_dwordx4 v1, s[16:19], s40 offen offset:3072 lds
    s_add_u32 s40, s40, 524288
    s_add_u32 m0, s43, 116736
    s_nop 0
    buffer_load_dwordx4 v2, s[16:19], s41 offen offset:0 lds
    buffer_load_dwordx4 v2, s[16:19], s41 offen offset:1024 lds
    buffer_load_dwordx4 v2, s[16:19], s41 offen offset:2048 lds
    buffer_load_dwordx4 v2, s[16:19], s41 offen offset:3072 lds
    s_add_u32 m0, s43, 120832
    s_add_u32 s49, s41, 4096
    buffer_load_dwordx4 v2, s[16:19], s49 offen lds
    s_mov_b64 exec, s[50:51]
    buffer_load_dwordx4 v5, s[16:19], s44 offen offset:1024 lds
    s_mov_b64 exec, -1
    s_add_u32 s41, s41, 688128
    s_add_u32 s44, s44, 688128
    s_waitcnt vmcnt(10)
    s_barrier
    s_waitcnt vmcnt(0)
    s_barrier
    s_cmp_ge_u32 s2, 224
    s_cbranch_scc1 L_nofill
    s_cmp_lg_u32 s15, 1
    s_cbranch_scc1 L_nofill
    s_lshl_b32 s20, s2, 10
    s_add_u32 s20, s20, 146800640
    v_mov_b32 v8, -1
    v_mov_b32 v9, -1
    v_mov_b32 v10, -1
    v_mov_b32 v11, -1
    v_lshlrev_b32 v4, 4, v0
    buffer_store_dwordx4 v[8:11], v4, s[16:19], s20 offen
L_nofill:
L_fz_end:
    s_endpgm
.globl final_kernel
.p2align 8
.type final_kernel,@function
final_kernel:
    s_cmp_ge_u32 s2, 224
    s_cbranch_scc1 L_k45_end
    s_load_dwordx2 s[8:9], s[0:1], 48
    s_load_dwordx4 s[4:7], s[0:1], 16
    s_load_dwordx2 s[28:29], s[0:1], 32
    v_lshrrev_b32 v204, 6, v0
    v_and_b32 v200, 63, v0
    v_readfirstlane_b32 s10, v204
    s_cmp_ge_u32 s2, 8
    s_cbranch_scc1 L_nopf45
    s_nop 1
    s_cmp_lg_u32 s10, 7
    s_cbranch_scc1 L_nopf45
    s_getpc_b64 s[60:61]
L_pf_k45:
    s_sub_u32 s60, s60, L_pf_k45-final_kernel
    s_subb_u32 s61, s61, 0
    v_mbcnt_lo_u32_b32 v112, -1, 0
    v_mbcnt_hi_u32_b32 v112, -1, v112
    v_lshlrev_b32 v112, 6, v112
    v_add_u32 v113, 0, v112
    v_min_u32 v113, L_code_end-final_kernel-4, v113
    v_mov_b32 v115, s61
    v_add_co_u32 v114, vcc, s60, v113
    s_nop 1
    v_addc_co_u32 v115, vcc, 0, v115, vcc
    global_load_dword v116, v[114:115], off
    v_add_u32 v113, 4096, v112
    v_min_u32 v113, L_code_end-final_kernel-4, v113
    v_mov_b32 v115, s61
    v_add_co_u32 v114, vcc, s60, v113
    s_nop 1
    v_addc_co_u32 v115, vcc, 0, v115, vcc
    global_load_dword v116, v[114:115], off
    v_add_u32 v113, 8192, v112
    v_min_u32 v113, L_code_end-final_kernel-4, v113
    v_mov_b32 v115, s61
    v_add_co_u32 v114, vcc, s60, v113
    s_nop 1
    v_addc_co_u32 v115, vcc, 0, v115, vcc
    global_load_dword v116, v[114:115], off
L_nopf45:
    v_lshlrev_b32 v214, 2, v0
    v_and_b32 v201, 15, v200
    v_lshrrev_b32 v202, 4, v200
    s_and_b32 s13, s2, 3
    s_lshr_b32 s12, s2, 2
    s_cmp_ge_u32 s12, 28
    s_cselect_b32 s11, 1, 0
    s_mul_i32 s15, s11, 28
    s_sub_u32 s12, s12, s15
    s_mul_i32 s14, s12, 6
    s_add_u32 s14, s14, s10
    s_mov_b32 s24, 90112
    v_mul_u32_u24 v203, s24, v202
    v_lshrrev_b32 v205, 2, v201
    s_mov_b32 s24, 720896
    v_mad_u32_u24 v203, v205, s24, v203
    v_and_b32 v205, 3, v201
    v_lshl_add_u32 v203, v205, 4, v203
    s_mul_i32 s24, s11, 11534336
    s_mul_i32 s25, s13, 2883584
    s_add_u32 s24, s24, s25
    s_lshl_b32 s25, s14, 6
    s_add_u32 s24, s24, s25
    s_add_u32 s24, s24, 117440512
    s_mov_b32 s30, 0x05040100
    s_mov_b32 s31, 0x07060302
    s_waitcnt lgkmcnt(0)
    s_mov_b32 s16, s8
    s_and_b32 s17, s9, 0xffff
    s_mov_b32 s18, 268435456
    s_mov_b32 s19, 0x00020000
    s_cmp_ge_u32 s10, 6
    s_cbranch_scc1 L_k45_gb
    s_add_u32 s25, s24, 0
    buffer_load_dwordx4 v[0:3], v203, s[16:19], s25 offen
    s_add_u32 s25, s24, 11264
    buffer_load_dwordx4 v[4:7], v203, s[16:19], s25 offen
    s_add_u32 s25, s24, 22528
    buffer_load_dwordx4 v[8:11], v203, s[16:19], s25 offen
    s_add_u32 s25, s24, 33792
    buffer_load_dwordx4 v[12:15], v203, s[16:19], s25 offen
    s_add_u32 s25, s24, 45056
    buffer_load_dwordx4 v[16:19], v203, s[16:19], s25 offen
    s_add_u32 s25, s24, 56320
    buffer_load_dwordx4 v[20:23], v203, s[16:19], s25 offen
    s_add_u32 s25, s24, 67584
    buffer_load_dwordx4 v[24:27], v203, s[16:19], s25 offen
    s_add_u32 s25, s24, 78848
    buffer_load_dwordx4 v[28:31], v203, s[16:19], s25 offen
    s_add_u32 s25, s24, 360448
    buffer_load_dwordx4 v[32:35], v203, s[16:19], s25 offen
    s_add_u32 s25, s24, 371712
    buffer_load_dwordx4 v[36:39], v203, s[16:19], s25 offen
    s_add_u32 s25, s24, 382976
    buffer_load_dwordx4 v[40:43], v203, s[16:19], s25 offen
    s_add_u32 s25, s24, 394240
    buffer_load_dwordx4 v[44:47], v203, s[16:19], s25 offen
    s_add_u32 s25, s24, 405504
    buffer_load_dwordx4 v[48:51], v203, s[16:19], s25 offen
    s_add_u32 s25, s24, 416768
    buffer_load_dwordx4 v[52:55], v203, s[16:19], s25 offen
    s_add_u32 s25, s24, 428032
    buffer_load_dwordx4 v[56:59], v203, s[16:19], s25 offen
    s_add_u32 s25, s24, 439296
    buffer_load_dwordx4 v[60:63], v203, s[16:19], s25 offen
    s_lshr_b32 s27, s10, 1
    s_and_b32 s33, s10, 1
    s_lshl_b32 s27, s27, 4
    v_add_u32 v204, s27, v201
    s_lshl_b32 s33, s33, 5
    s_add_u32 s33, s33, 1
    v_lshlrev_b32 v205, 3, v202
    v_add_u32 v205, s33, v205
    v_mul_u32_u24 v88, v205, v204
    v_add_u32 v89, 32, v88
    v_add_u32 v205, 2, v205
    v_mul_u32_u24 v90, v205, v204
    v_add_u32 v91, 32, v90
    v_add_u32 v205, 2, v205
    v_mul_u32_u24 v92, v205, v204
    v_add_u32 v93, 32, v92
    v_add_u32 v205, 2, v205
    v_mul_u32_u24 v94, v205, v204
    v_add_u32 v95, 32, v94
    v_and_b32 v88, 127, v88
    v_cvt_f32_u32 v88, v88
    v_mul_f32 v88, 0x3c000000, v88
    v_cos_f32 v88, v88
    v_and_b32 v89, 127, v89
    v_cvt_f32_u32 v89, v89
    v_mul_f32 v89, 0x3c000000, v89
    v_cos_f32 v89, v89
    v_and_b32 v90, 127, v90
    v_cvt_f32_u32 v90, v90
    v_mul_f32 v90, 0x3c000000, v90
    v_cos_f32 v90, v90
    v_and_b32 v91, 127, v91
    v_cvt_f32_u32 v91, v91
    v_mul_f32 v91, 0x3c000000, v91
    v_cos_f32 v91, v91
    v_and_b32 v92, 127, v92
    v_cvt_f32_u32 v92, v92
    v_mul_f32 v92, 0x3c000000, v92
    v_cos_f32 v92, v92
    v_and_b32 v93, 127, v93
    v_cvt_f32_u32 v93, v93
    v_mul_f32 v93, 0x3c000000, v93
    v_cos_f32 v93, v93
    v_and_b32 v94, 127, v94
    v_cvt_f32_u32 v94, v94
    v_mul_f32 v94, 0x3c000000, v94
    v_cos_f32 v94, v94
    v_and_b32 v95, 127, v95
    v_cvt_f32_u32 v95, v95
    v_mul_f32 v95, 0x3c000000, v95
    v_cos_f32 v95, v95
    v_mul_f32 v88, 0x3d000000, v88
    v_mul_f32 v89, 0x3d000000, v89
    v_mul_f32 v90, 0x3d000000, v90
    v_mul_f32 v91, 0x3d000000, v91
    v_mul_f32 v92, 0x3d000000, v92
    v_mul_f32 v93, 0x3d000000, v93
    v_mul_f32 v94, 0x3d000000, v94
    v_mul_f32 v95, 0x3d000000, v95
    v_cvt_pk_bf16_f32 v104, v88, v89
    v_cvt_pk_bf16_f32 v105, v90, v91
    v_cvt_pk_bf16_f32 v106, v92, v93
    v_cvt_pk_bf16_f32 v107, v94, v95
    s_lshl_b32 s26, s10, 10
    v_lshlrev_b32 v207, 4, v200
    v_add_u32 v207, s26, v207
    ds_write_b128 v207, v[104:107] offset:0
L_k45_gb:
    s_mov_b32 s20, s4
    s_and_b32 s21, s5, 0xffff
    s_mov_b32 s22, 1024
    s_mov_b32 s23, 0x00020000
    s_mov_b32 s36, s6
    s_and_b32 s37, s7, 0xffff
    s_mov_b32 s38, 1024
    s_mov_b32 s39, 0x00020000
    v_lshlrev_b32 v210, 4, v201
    s_lshl_b32 s25, s13, 8
    buffer_load_dwordx4 v[232:235], v210, s[20:23], s25 offen
    buffer_load_dwordx4 v[236:239], v210, s[36:39], s25 offen
    s_waitcnt lgkmcnt(0)
    s_barrier
    s_cmp_ge_u32 s10, 6
    s_cbranch_scc1 L_k45_red2
    v_lshlrev_b32 v207, 4, v200
    ds_read_b128 v[64:67], v207 offset:0
    ds_read_b128 v[68:71], v207 offset:1024
    ds_read_b128 v[72:75], v207 offset:2048
    ds_read_b128 v[76:79], v207 offset:3072
    ds_read_b128 v[80:83], v207 offset:4096
    ds_read_b128 v[84:87], v207 offset:5120
    s_cmp_ge_u32 s14, 167
    s_cbranch_scc1 L_k45_zero
    s_waitcnt lgkmcnt(0)
    s_cmp_lg_u32 s14, 166
    s_cbranch_scc1 L_k45_full
    v_cmp_gt_i32 vcc, 17, v201
    s_nop 1
    v_cndmask_b32 v64, 0, v64, vcc
    v_cndmask_b32 v65, 0, v65, vcc
    v_cndmask_b32 v66, 0, v66, vcc
    v_cndmask_b32 v67, 0, v67, vcc
    v_cndmask_b32 v68, 0, v68, vcc
    v_cndmask_b32 v69, 0, v69, vcc
    v_cndmask_b32 v70, 0, v70, vcc
    v_cndmask_b32 v71, 0, v71, vcc
    v_cmp_gt_i32 vcc, 1, v201
    s_nop 1
    v_cndmask_b32 v72, 0, v72, vcc
    v_cndmask_b32 v73, 0, v73, vcc
    v_cndmask_b32 v74, 0, v74, vcc
    v_cndmask_b32 v75, 0, v75, vcc
    v_cndmask_b32 v76, 0, v76, vcc
    v_cndmask_b32 v77, 0, v77, vcc
    v_cndmask_b32 v78, 0, v78, vcc
    v_cndmask_b32 v79, 0, v79, vcc
    v_cmp_gt_i32 vcc, 0, v201
    s_nop 1
    v_cndmask_b32 v80, 0, v80, vcc
    v_cndmask_b32 v81, 0, v81, vcc
    v_cndmask_b32 v82, 0, v82, vcc
    v_cndmask_b32 v83, 0, v83, vcc
    v_cndmask_b32 v84, 0, v84, vcc
    v_cndmask_b32 v85, 0, v85, vcc
    v_cndmask_b32 v86, 0, v86, vcc
    v_cndmask_b32 v87, 0, v87, vcc
L_k45_full:
    s_waitcnt vmcnt(2)
    v_perm_b32 v88, v4, v0, s30
    v_perm_b32 v89, v12, v8, s30
    v_perm_b32 v90, v20, v16, s30
    v_perm_b32 v91, v28, v24, s30
    v_perm_b32 v92, v4, v0, s31
    v_perm_b32 v93, v12, v8, s31
    v_perm_b32 v94, v20, v16, s31
    v_perm_b32 v95, v28, v24, s31
    v_perm_b32 v96, v36, v32, s30
    v_perm_b32 v97, v44, v40, s30
    v_perm_b32 v98, v52, v48, s30
    v_perm_b32 v99, v60, v56, s30
    v_perm_b32 v100, v36, v32, s31
    v_perm_b32 v101, v44, v40, s31
    v_perm_b32 v102, v52, v48, s31
    v_perm_b32 v103, v60, v56, s31
    v_mfma_f32_16x16x32_bf16 v[104:107], v[64:67], v[88:91], 0
    v_mfma_f32_16x16x32_bf16 v[108:111], v[64:67], v[92:95], 0
    v_mfma_f32_16x16x32_bf16 v[136:139], v[72:75], v[88:91], 0
    v_mfma_f32_16x16x32_bf16 v[140:143], v[72:75], v[92:95], 0
    v_mfma_f32_16x16x32_bf16 v[168:171], v[80:83], v[88:91], 0
    v_mfma_f32_16x16x32_bf16 v[172:175], v[80:83], v[92:95], 0
    v_mfma_f32_16x16x32_bf16 v[104:107], v[68:71], v[96:99], v[104:107]
    v_mfma_f32_16x16x32_bf16 v[108:111], v[68:71], v[100:103], v[108:111]
    v_mfma_f32_16x16x32_bf16 v[136:139], v[76:79], v[96:99], v[136:139]
    v_mfma_f32_16x16x32_bf16 v[140:143], v[76:79], v[100:103], v[140:143]
    v_mfma_f32_16x16x32_bf16 v[168:171], v[84:87], v[96:99], v[168:171]
    v_mfma_f32_16x16x32_bf16 v[172:175], v[84:87], v[100:103], v[172:175]
    v_perm_b32 v88, v5, v1, s30
    v_perm_b32 v89, v13, v9, s30
    v_perm_b32 v90, v21, v17, s30
    v_perm_b32 v91, v29, v25, s30
    v_perm_b32 v92, v5, v1, s31
    v_perm_b32 v93, v13, v9, s31
    v_perm_b32 v94, v21, v17, s31
    v_perm_b32 v95, v29, v25, s31
    v_perm_b32 v96, v37, v33, s30
    v_perm_b32 v97, v45, v41, s30
    v_perm_b32 v98, v53, v49, s30
    v_perm_b32 v99, v61, v57, s30
    v_perm_b32 v100, v37, v33, s31
    v_perm_b32 v101, v45, v41, s31
    v_perm_b32 v102, v53, v49, s31
    v_perm_b32 v103, v61, v57, s31
    v_mfma_f32_16x16x32_bf16 v[112:115], v[64:67], v[88:91], 0
    v_mfma_f32_16x16x32_bf16 v[116:119], v[64:67], v[92:95], 0
    v_mfma_f32_16x16x32_bf16 v[144:147], v[72:75], v[88:91], 0
    v_mfma_f32_16x16x32_bf16 v[148:151], v[72:75], v[92:95], 0
    v_mfma_f32_16x16x32_bf16 v[176:179], v[80:83], v[88:91], 0
    v_mfma_f32_16x16x32_bf16 v[180:183], v[80:83], v[92:95], 0
    v_mfma_f32_16x16x32_bf16 v[112:115], v[68:71], v[96:99], v[112:115]
    v_mfma_f32_16x16x32_bf16 v[116:119], v[68:71], v[100:103], v[116:119]
    v_mfma_f32_16x16x32_bf16 v[144:147], v[76:79], v[96:99], v[144:147]
    v_mfma_f32_16x16x32_bf16 v[148:151], v[76:79], v[100:103], v[148:151]
    v_mfma_f32_16x16x32_bf16 v[176:179], v[84:87], v[96:99], v[176:179]
    v_mfma_f32_16x16x32_bf16 v[180:183], v[84:87], v[100:103], v[180:183]
    v_perm_b32 v88, v6, v2, s30
    v_perm_b32 v89, v14, v10, s30
    v_perm_b32 v90, v22, v18, s30
    v_perm_b32 v91, v30, v26, s30
    v_perm_b32 v92, v6, v2, s31
    v_perm_b32 v93, v14, v10, s31
    v_perm_b32 v94, v22, v18, s31
    v_perm_b32 v95, v30, v26, s31
    v_perm_b32 v96, v38, v34, s30
    v_perm_b32 v97, v46, v42, s30
    v_perm_b32 v98, v54, v50, s30
    v_perm_b32 v99, v62, v58, s30
    v_perm_b32 v100, v38, v34, s31
    v_perm_b32 v101, v46, v42, s31
    v_perm_b32 v102, v54, v50, s31
    v_perm_b32 v103, v62, v58, s31
    v_mfma_f32_16x16x32_bf16 v[120:123], v[64:67], v[88:91], 0
    v_mfma_f32_16x16x32_bf16 v[124:127], v[64:67], v[92:95], 0
    v_mfma_f32_16x16x32_bf16 v[152:155], v[72:75], v[88:91], 0
    v_mfma_f32_16x16x32_bf16 v[156:159], v[72:75], v[92:95], 0
    v_mfma_f32_16x16x32_bf16 v[184:187], v[80:83], v[88:91], 0
    v_mfma_f32_16x16x32_bf16 v[188:191], v[80:83], v[92:95], 0
    v_mfma_f32_16x16x32_bf16 v[120:123], v[68:71], v[96:99], v[120:123]
    v_mfma_f32_16x16x32_bf16 v[124:127], v[68:71], v[100:103], v[124:127]
    v_mfma_f32_16x16x32_bf16 v[152:155], v[76:79], v[96:99], v[152:155]
    v_mfma_f32_16x16x32_bf16 v[156:159], v[76:79], v[100:103], v[156:159]
    v_mfma_f32_16x16x32_bf16 v[184:187], v[84:87], v[96:99], v[184:187]
    v_mfma_f32_16x16x32_bf16 v[188:191], v[84:87], v[100:103], v[188:191]
    v_perm_b32 v88, v7, v3, s30
    v_perm_b32 v89, v15, v11, s30
    v_perm_b32 v90, v23, v19, s30
    v_perm_b32 v91, v31, v27, s30
    v_perm_b32 v92, v7, v3, s31
    v_perm_b32 v93, v15, v11, s31
    v_perm_b32 v94, v23, v19, s31
    v_perm_b32 v95, v31, v27, s31
    v_perm_b32 v96, v39, v35, s30
    v_perm_b32 v97, v47, v43, s30
    v_perm_b32 v98, v55, v51, s30
    v_perm_b32 v99, v63, v59, s30
    v_perm_b32 v100, v39, v35, s31
    v_perm_b32 v101, v47, v43, s31
    v_perm_b32 v102, v55, v51, s31
    v_perm_b32 v103, v63, v59, s31
    v_mfma_f32_16x16x32_bf16 v[128:131], v[64:67], v[88:91], 0
    v_mfma_f32_16x16x32_bf16 v[132:135], v[64:67], v[92:95], 0
    v_mfma_f32_16x16x32_bf16 v[160:163], v[72:75], v[88:91], 0
    v_mfma_f32_16x16x32_bf16 v[164:167], v[72:75], v[92:95], 0
    v_mfma_f32_16x16x32_bf16 v[192:195], v[80:83], v[88:91], 0
    v_mfma_f32_16x16x32_bf16 v[196:199], v[80:83], v[92:95], 0
    v_mfma_f32_16x16x32_bf16 v[128:131], v[68:71], v[96:99], v[128:131]
    v_mfma_f32_16x16x32_bf16 v[132:135], v[68:71], v[100:103], v[132:135]
    v_mfma_f32_16x16x32_bf16 v[160:163], v[76:79], v[96:99], v[160:163]
    v_mfma_f32_16x16x32_bf16 v[164:167], v[76:79], v[100:103], v[164:167]
    v_mfma_f32_16x16x32_bf16 v[192:195], v[84:87], v[96:99], v[192:195]
    v_mfma_f32_16x16x32_bf16 v[196:199], v[84:87], v[100:103], v[196:199]
    s_nop 7
    v_mul_f32 v224, v104, v104
    v_mov_b32 v216, v104
    v_fmac_f32 v224, v105, v105
    v_add_f32 v216, v216, v105
    v_fmac_f32 v224, v106, v106
    v_add_f32 v216, v216, v106
    v_fmac_f32 v224, v107, v107
    v_add_f32 v216, v216, v107
    v_fmac_f32 v224, v136, v136
    v_add_f32 v216, v216, v136
    v_fmac_f32 v224, v137, v137
    v_add_f32 v216, v216, v137
    v_fmac_f32 v224, v138, v138
    v_add_f32 v216, v216, v138
    v_fmac_f32 v224, v139, v139
    v_add_f32 v216, v216, v139
    v_fmac_f32 v224, v168, v168
    v_add_f32 v216, v216, v168
    v_fmac_f32 v224, v169, v169
    v_add_f32 v216, v216, v169
    v_fmac_f32 v224, v170, v170
    v_add_f32 v216, v216, v170
    v_fmac_f32 v224, v171, v171
    v_add_f32 v216, v216, v171
    v_mul_f32 v225, v108, v108
    v_mov_b32 v217, v108
    v_fmac_f32 v225, v109, v109
    v_add_f32 v217, v217, v109
    v_fmac_f32 v225, v110, v110
    v_add_f32 v217, v217, v110
    v_fmac_f32 v225, v111, v111
    v_add_f32 v217, v217, v111
    v_fmac_f32 v225, v140, v140
    v_add_f32 v217, v217, v140
    v_fmac_f32 v225, v141, v141
    v_add_f32 v217, v217, v141
    v_fmac_f32 v225, v142, v142
    v_add_f32 v217, v217, v142
    v_fmac_f32 v225, v143, v143
    v_add_f32 v217, v217, v143
    v_fmac_f32 v225, v172, v172
    v_add_f32 v217, v217, v172
    v_fmac_f32 v225, v173, v173
    v_add_f32 v217, v217, v173
    v_fmac_f32 v225, v174, v174
    v_add_f32 v217, v217, v174
    v_fmac_f32 v225, v175, v175
    v_add_f32 v217, v217, v175
    v_mul_f32 v226, v112, v112
    v_mov_b32 v218, v112
    v_fmac_f32 v226, v113, v113
    v_add_f32 v218, v218, v113
    v_fmac_f32 v226, v114, v114
    v_add_f32 v218, v218, v114
    v_fmac_f32 v226, v115, v115
    v_add_f32 v218, v218, v115
    v_fmac_f32 v226, v144, v144
    v_add_f32 v218, v218, v144
    v_fmac_f32 v226, v145, v145
    v_add_f32 v218, v218, v145
    v_fmac_f32 v226, v146, v146
    v_add_f32 v218, v218, v146
    v_fmac_f32 v226, v147, v147
    v_add_f32 v218, v218, v147
    v_fmac_f32 v226, v176, v176
    v_add_f32 v218, v218, v176
    v_fmac_f32 v226, v177, v177
    v_add_f32 v218, v218, v177
    v_fmac_f32 v226, v178, v178
    v_add_f32 v218, v218, v178
    v_fmac_f32 v226, v179, v179
    v_add_f32 v218, v218, v179
    v_mul_f32 v227, v116, v116
    v_mov_b32 v219, v116
    v_fmac_f32 v227, v117, v117
    v_add_f32 v219, v219, v117
    v_fmac_f32 v227, v118, v118
    v_add_f32 v219, v219, v118
    v_fmac_f32 v227, v119, v119
    v_add_f32 v219, v219, v119
    v_fmac_f32 v227, v148, v148
    v_add_f32 v219, v219, v148
    v_fmac_f32 v227, v149, v149
    v_add_f32 v219, v219, v149
    v_fmac_f32 v227, v150, v150
    v_add_f32 v219, v219, v150
    v_fmac_f32 v227, v151, v151
    v_add_f32 v219, v219, v151
    v_fmac_f32 v227, v180, v180
    v_add_f32 v219, v219, v180
    v_fmac_f32 v227, v181, v181
    v_add_f32 v219, v219, v181
    v_fmac_f32 v227, v182, v182
    v_add_f32 v219, v219, v182
    v_fmac_f32 v227, v183, v183
    v_add_f32 v219, v219, v183
    v_mul_f32 v228, v120, v120
    v_mov_b32 v220, v120
    v_fmac_f32 v228, v121, v121
    v_add_f32 v220, v220, v121
    v_fmac_f32 v228, v122, v122
    v_add_f32 v220, v220, v122
    v_fmac_f32 v228, v123, v123
    v_add_f32 v220, v220, v123
    v_fmac_f32 v228, v152, v152
    v_add_f32 v220, v220, v152
    v_fmac_f32 v228, v153, v153
    v_add_f32 v220, v220, v153
    v_fmac_f32 v228, v154, v154
    v_add_f32 v220, v220, v154
    v_fmac_f32 v228, v155, v155
    v_add_f32 v220, v220, v155
    v_fmac_f32 v228, v184, v184
    v_add_f32 v220, v220, v184
    v_fmac_f32 v228, v185, v185
    v_add_f32 v220, v220, v185
    v_fmac_f32 v228, v186, v186
    v_add_f32 v220, v220, v186
    v_fmac_f32 v228, v187, v187
    v_add_f32 v220, v220, v187
    v_mul_f32 v229, v124, v124
    v_mov_b32 v221, v124
    v_fmac_f32 v229, v125, v125
    v_add_f32 v221, v221, v125
    v_fmac_f32 v229, v126, v126
    v_add_f32 v221, v221, v126
    v_fmac_f32 v229, v127, v127
    v_add_f32 v221, v221, v127
    v_fmac_f32 v229, v156, v156
    v_add_f32 v221, v221, v156
    v_fmac_f32 v229, v157, v157
    v_add_f32 v221, v221, v157
    v_fmac_f32 v229, v158, v158
    v_add_f32 v221, v221, v158
    v_fmac_f32 v229, v159, v159
    v_add_f32 v221, v221, v159
    v_fmac_f32 v229, v188, v188
    v_add_f32 v221, v221, v188
    v_fmac_f32 v229, v189, v189
    v_add_f32 v221, v221, v189
    v_fmac_f32 v229, v190, v190
    v_add_f32 v221, v221, v190
    v_fmac_f32 v229, v191, v191
    v_add_f32 v221, v221, v191
    v_mul_f32 v230, v128, v128
    v_mov_b32 v222, v128
    v_fmac_f32 v230, v129, v129
    v_add_f32 v222, v222, v129
    v_fmac_f32 v230, v130, v130
    v_add_f32 v222, v222, v130
    v_fmac_f32 v230, v131, v131
    v_add_f32 v222, v222, v131
    v_fmac_f32 v230, v160, v160
    v_add_f32 v222, v222, v160
    v_fmac_f32 v230, v161, v161
    v_add_f32 v222, v222, v161
    v_fmac_f32 v230, v162, v162
    v_add_f32 v222, v222, v162
    v_fmac_f32 v230, v163, v163
    v_add_f32 v222, v222, v163
    v_fmac_f32 v230, v192, v192
    v_add_f32 v222, v222, v192
    v_fmac_f32 v230, v193, v193
    v_add_f32 v222, v222, v193
    v_fmac_f32 v230, v194, v194
    v_add_f32 v222, v222, v194
    v_fmac_f32 v230, v195, v195
    v_add_f32 v222, v222, v195
    v_mul_f32 v231, v132, v132
    v_mov_b32 v223, v132
    v_fmac_f32 v231, v133, v133
    v_add_f32 v223, v223, v133
    v_fmac_f32 v231, v134, v134
    v_add_f32 v223, v223, v134
    v_fmac_f32 v231, v135, v135
    v_add_f32 v223, v223, v135
    v_fmac_f32 v231, v164, v164
    v_add_f32 v223, v223, v164
    v_fmac_f32 v231, v165, v165
    v_add_f32 v223, v223, v165
    v_fmac_f32 v231, v166, v166
    v_add_f32 v223, v223, v166
    v_fmac_f32 v231, v167, v167
    v_add_f32 v223, v223, v167
    v_fmac_f32 v231, v196, v196
    v_add_f32 v223, v223, v196
    v_fmac_f32 v231, v197, v197
    v_add_f32 v223, v223, v197
    v_fmac_f32 v231, v198, v198
    v_add_f32 v223, v223, v198
    v_fmac_f32 v231, v199, v199
    v_add_f32 v223, v223, v199
    s_branch L_k45_red
L_k45_zero:
    s_waitcnt vmcnt(0) lgkmcnt(0)
    v_mov_b32 v216, 0
    v_mov_b32 v224, 0
    v_mov_b32 v217, 0
    v_mov_b32 v225, 0
    v_mov_b32 v218, 0
    v_mov_b32 v226, 0
    v_mov_b32 v219, 0
    v_mov_b32 v227, 0
    v_mov_b32 v220, 0
    v_mov_b32 v228, 0
    v_mov_b32 v221, 0
    v_mov_b32 v229, 0
    v_mov_b32 v222, 0
    v_mov_b32 v230, 0
    v_mov_b32 v223, 0
    v_mov_b32 v231, 0
L_k45_red:
    s_lshl_b32 s25, s10, 12
    v_lshlrev_b32 v204, 10, v202
    v_lshl_add_u32 v204, v201, 5, v204
    v_add_u32 v204, s25, v204
    ds_write_b128 v204, v[216:219] offset:8192
    ds_write_b128 v204, v[220:223] offset:8208
    ds_write_b128 v204, v[224:227] offset:8704
    ds_write_b128 v204, v[228:231] offset:8720
L_k45_red2:
    s_waitcnt lgkmcnt(0)
    s_barrier
    s_mul_i32 s24, s11, 112
    s_mul_i32 s25, s13, 28
    s_add_u32 s24, s24, s25
    s_lshl_b32 s26, s24, 10
    s_add_u32 s26, s26, 146800640
    s_cmp_ge_u32 s10, 6
    s_cbranch_scc1 L_k45_sumdone
    s_cmp_lt_u32 s10, 4
    s_cbranch_scc1 L_k45_red4
    s_lshl_b32 s25, s10, 13
    v_lshlrev_b32 v205, 4, v200
    v_add_u32 v205, s25, v205
    ds_write_b32 v205, v107 offset:33792
    ds_write_b32 v205, v139 offset:33796
    ds_write_b32 v205, v171 offset:33800
    ds_write_b32 v205, v111 offset:34816
    ds_write_b32 v205, v143 offset:34820
    ds_write_b32 v205, v175 offset:34824
    ds_write_b32 v205, v115 offset:35840
    ds_write_b32 v205, v147 offset:35844
    ds_write_b32 v205, v179 offset:35848
    ds_write_b32 v205, v119 offset:36864
    ds_write_b32 v205, v151 offset:36868
    ds_write_b32 v205, v183 offset:36872
    ds_write_b32 v205, v123 offset:37888
    ds_write_b32 v205, v155 offset:37892
    ds_write_b32 v205, v187 offset:37896
    ds_write_b32 v205, v127 offset:38912
    ds_write_b32 v205, v159 offset:38916
    ds_write_b32 v205, v191 offset:38920
    ds_write_b32 v205, v131 offset:39936
    ds_write_b32 v205, v163 offset:39940
    ds_write_b32 v205, v195 offset:39944
    ds_write_b32 v205, v135 offset:40960
    ds_write_b32 v205, v167 offset:40964
    ds_write_b32 v205, v199 offset:40968
    s_branch L_k45_sumdone
L_k45_red4:
    ds_read_b32 v16, v214 offset:8192
    ds_read_b32 v17, v214 offset:9216
    ds_read_b32 v18, v214 offset:10240
    ds_read_b32 v19, v214 offset:11264
    ds_read_b32 v20, v214 offset:12288
    ds_read_b32 v21, v214 offset:13312
    ds_read_b32 v22, v214 offset:14336
    ds_read_b32 v23, v214 offset:15360
    ds_read_b32 v24, v214 offset:16384
    ds_read_b32 v25, v214 offset:17408
    ds_read_b32 v26, v214 offset:18432
    ds_read_b32 v27, v214 offset:19456
    ds_read_b32 v28, v214 offset:20480
    ds_read_b32 v29, v214 offset:21504
    ds_read_b32 v30, v214 offset:22528
    ds_read_b32 v31, v214 offset:23552
    ds_read_b32 v32, v214 offset:24576
    ds_read_b32 v33, v214 offset:25600
    ds_read_b32 v34, v214 offset:26624
    ds_read_b32 v35, v214 offset:27648
    ds_read_b32 v36, v214 offset:28672
    ds_read_b32 v37, v214 offset:29696
    ds_read_b32 v38, v214 offset:30720
    ds_read_b32 v39, v214 offset:31744
    s_waitcnt lgkmcnt(0)
    v_add_f32 v16, v16, v17
    v_add_f32 v18, v18, v19
    v_add_f32 v20, v20, v21
    v_add_f32 v22, v22, v23
    v_add_f32 v24, v24, v25
    v_add_f32 v26, v26, v27
    v_add_f32 v28, v28, v29
    v_add_f32 v30, v30, v31
    v_add_f32 v32, v32, v33
    v_add_f32 v34, v34, v35
    v_add_f32 v36, v36, v37
    v_add_f32 v38, v38, v39
    v_add_f32 v16, v16, v18
    v_add_f32 v20, v20, v22
    v_add_f32 v24, v24, v26
    v_add_f32 v28, v28, v30
    v_add_f32 v32, v32, v34
    v_add_f32 v36, v36, v38
    v_add_f32 v16, v16, v20
    v_add_f32 v24, v24, v28
    v_add_f32 v32, v32, v36
    v_add_f32 v16, v16, v24
    v_add_f32 v16, v16, v32
    s_lshl_b32 s24, s12, 10
    s_add_u32 s24, s24, s26
    buffer_store_dword v16, v214, s[16:19], s24 offen sc1
    s_lshl_b32 s25, s10, 13
    v_lshlrev_b32 v205, 4, v200
    v_add_u32 v205, s25, v205
    ds_write_b32 v205, v107 offset:33792
    ds_write_b32 v205, v139 offset:33796
    ds_write_b32 v205, v171 offset:33800
    ds_write_b32 v205, v111 offset:34816
    ds_write_b32 v205, v143 offset:34820
    ds_write_b32 v205, v175 offset:34824
    ds_write_b32 v205, v115 offset:35840
    ds_write_b32 v205, v147 offset:35844
    ds_write_b32 v205, v179 offset:35848
    ds_write_b32 v205, v119 offset:36864
    ds_write_b32 v205, v151 offset:36868
    ds_write_b32 v205, v183 offset:36872
    ds_write_b32 v205, v123 offset:37888
    ds_write_b32 v205, v155 offset:37892
    ds_write_b32 v205, v187 offset:37896
    ds_write_b32 v205, v127 offset:38912
    ds_write_b32 v205, v159 offset:38916
    ds_write_b32 v205, v191 offset:38920
    ds_write_b32 v205, v131 offset:39936
    ds_write_b32 v205, v163 offset:39940
    ds_write_b32 v205, v195 offset:39944
    ds_write_b32 v205, v135 offset:40960
    ds_write_b32 v205, v167 offset:40964
    ds_write_b32 v205, v199 offset:40968
    s_mov_b32 s33, 16384
L_k45_poll:
    s_mov_b32 s27, s26
    buffer_load_dword v0, v214, s[16:19], s27 offen offset:0 sc1
    buffer_load_dword v1, v214, s[16:19], s27 offen offset:1024 sc1
    buffer_load_dword v2, v214, s[16:19], s27 offen offset:2048 sc1
    buffer_load_dword v3, v214, s[16:19], s27 offen offset:3072 sc1
    s_add_u32 s27, s27, 4096
    buffer_load_dword v4, v214, s[16:19], s27 offen offset:0 sc1
    buffer_load_dword v5, v214, s[16:19], s27 offen offset:1024 sc1
    buffer_load_dword v6, v214, s[16:19], s27 offen offset:2048 sc1
    buffer_load_dword v7, v214, s[16:19], s27 offen offset:3072 sc1
    s_add_u32 s27, s27, 4096
    buffer_load_dword v8, v214, s[16:19], s27 offen offset:0 sc1
    buffer_load_dword v9, v214, s[16:19], s27 offen offset:1024 sc1
    buffer_load_dword v10, v214, s[16:19], s27 offen offset:2048 sc1
    buffer_load_dword v11, v214, s[16:19], s27 offen offset:3072 sc1
    s_add_u32 s27, s27, 4096
    buffer_load_dword v12, v214, s[16:19], s27 offen offset:0 sc1
    buffer_load_dword v13, v214, s[16:19], s27 offen offset:1024 sc1
    buffer_load_dword v14, v214, s[16:19], s27 offen offset:2048 sc1
    buffer_load_dword v15, v214, s[16:19], s27 offen offset:3072 sc1
    s_add_u32 s27, s27, 4096
    buffer_load_dword v16, v214, s[16:19], s27 offen offset:0 sc1
    buffer_load_dword v17, v214, s[16:19], s27 offen offset:1024 sc1
    buffer_load_dword v18, v214, s[16:19], s27 offen offset:2048 sc1
    buffer_load_dword v19, v214, s[16:19], s27 offen offset:3072 sc1
    s_add_u32 s27, s27, 4096
    buffer_load_dword v20, v214, s[16:19], s27 offen offset:0 sc1
    buffer_load_dword v21, v214, s[16:19], s27 offen offset:1024 sc1
    buffer_load_dword v22, v214, s[16:19], s27 offen offset:2048 sc1
    buffer_load_dword v23, v214, s[16:19], s27 offen offset:3072 sc1
    s_add_u32 s27, s27, 4096
    buffer_load_dword v24, v214, s[16:19], s27 offen offset:0 sc1
    buffer_load_dword v25, v214, s[16:19], s27 offen offset:1024 sc1
    buffer_load_dword v26, v214, s[16:19], s27 offen offset:2048 sc1
    buffer_load_dword v27, v214, s[16:19], s27 offen offset:3072 sc1
    s_waitcnt vmcnt(0)
    v_max3_u32 v32, v0, v1, v2
    v_max3_u32 v32, v32, v3, v4
    v_max3_u32 v32, v32, v5, v6
    v_max3_u32 v32, v32, v7, v8
    v_max3_u32 v32, v32, v9, v10
    v_max3_u32 v32, v32, v11, v12
    v_max3_u32 v32, v32, v13, v14
    v_max3_u32 v32, v32, v15, v16
    v_max3_u32 v32, v32, v17, v18
    v_max3_u32 v32, v32, v19, v20
    v_max3_u32 v32, v32, v21, v22
    v_max3_u32 v32, v32, v23, v24
    v_max3_u32 v32, v32, v25, v26
    v_max_u32 v32, v32, v27
    v_cmp_eq_u32 vcc, -1, v32
    s_nop 3
    s_cmp_eq_u64 vcc, 0
    s_cbranch_scc1 L_k45_got
    s_sub_u32 s33, s33, 1
    s_cmp_eq_u32 s33, 0
    s_cbranch_scc1 L_k45_got
    s_sleep 2
    s_branch L_k45_poll
L_k45_got:
    v_add_f32 v0, v0, v1
    v_add_f32 v2, v2, v3
    v_add_f32 v4, v4, v5
    v_add_f32 v6, v6, v7
    v_add_f32 v8, v8, v9
    v_add_f32 v10, v10, v11
    v_add_f32 v12, v12, v13
    v_add_f32 v14, v14, v15
    v_add_f32 v16, v16, v17
    v_add_f32 v18, v18, v19
    v_add_f32 v20, v20, v21
    v_add_f32 v22, v22, v23
    v_add_f32 v24, v24, v25
    v_add_f32 v26, v26, v27
    v_add_f32 v0, v0, v2
    v_add_f32 v4, v4, v6
    v_add_f32 v8, v8, v10
    v_add_f32 v12, v12, v14
    v_add_f32 v16, v16, v18
    v_add_f32 v20, v20, v22
    v_add_f32 v24, v24, v26
    v_add_f32 v0, v0, v4
    v_add_f32 v8, v8, v12
    v_add_f32 v16, v16, v20
    v_add_f32 v0, v0, v8
    v_add_f32 v16, v16, v24
    v_add_f32 v0, v0, v16
    ds_write_b32 v214, v0 offset:32768
L_k45_sumdone:
    s_waitcnt lgkmcnt(0)
    s_barrier
    s_cmp_lt_u32 s10, 6
    s_cbranch_scc1 L_k45_nohread
    s_waitcnt vmcnt(0)
    s_sub_u32 s25, s10, 6
    s_mul_i32 s25, s25, 3
    s_lshl_b32 s25, s25, 13
    v_lshlrev_b32 v205, 4, v200
    v_add_u32 v205, s25, v205
    ds_read_b96 v[104:106], v205 offset:33792
    ds_read_b96 v[108:110], v205 offset:34816
    ds_read_b96 v[112:114], v205 offset:35840
    ds_read_b96 v[116:118], v205 offset:36864
    ds_read_b96 v[120:122], v205 offset:37888
    ds_read_b96 v[124:126], v205 offset:38912
    ds_read_b96 v[128:130], v205 offset:39936
    ds_read_b96 v[132:134], v205 offset:40960
    s_waitcnt lgkmcnt(0)
    ds_read_b96 v[136:138], v205 offset:41984
    ds_read_b96 v[140:142], v205 offset:43008
    ds_read_b96 v[144:146], v205 offset:44032
    ds_read_b96 v[148:150], v205 offset:45056
    ds_read_b96 v[152:154], v205 offset:46080
    ds_read_b96 v[156:158], v205 offset:47104
    ds_read_b96 v[160:162], v205 offset:48128
    ds_read_b96 v[164:166], v205 offset:49152
    s_waitcnt lgkmcnt(0)
    ds_read_b96 v[168:170], v205 offset:50176
    ds_read_b96 v[172:174], v205 offset:51200
    ds_read_b96 v[176:178], v205 offset:52224
    ds_read_b96 v[180:182], v205 offset:53248
    ds_read_b96 v[184:186], v205 offset:54272
    ds_read_b96 v[188:190], v205 offset:55296
    ds_read_b96 v[192:194], v205 offset:56320
    ds_read_b96 v[196:198], v205 offset:57344
L_k45_nohread:
    v_lshlrev_b32 v210, 5, v201
    ds_read_b128 v[44:47], v210 offset:32768
    ds_read_b128 v[48:51], v210 offset:32784
    ds_read_b128 v[52:55], v210 offset:33280
    ds_read_b128 v[56:59], v210 offset:33296
    s_mov_b32 s24, 0x39035177
    s_mov_b32 s25, 0x3727c5ac
    s_waitcnt vmcnt(0) lgkmcnt(0)
    v_mul_f32 v44, s24, v44
    v_mul_f32 v52, s24, v52
    v_fma_f32 v52, -v44, v44, v52
    v_max_f32 v52, 0, v52
    v_add_f32 v52, s25, v52
    v_rsq_f32 v52, v52
    v_lshlrev_b32 v216, 16, v232
    v_lshlrev_b32 v224, 16, v236
    v_mul_f32 v216, v216, v52
    v_fma_f32 v224, -v44, v216, v224
    v_mul_f32 v45, s24, v45
    v_mul_f32 v53, s24, v53
    v_fma_f32 v53, -v45, v45, v53
    v_max_f32 v53, 0, v53
    v_add_f32 v53, s25, v53
    v_rsq_f32 v53, v53
    v_and_b32 v217, 0xffff0000, v232
    v_and_b32 v225, 0xffff0000, v236
    v_mul_f32 v217, v217, v53
    v_fma_f32 v225, -v45, v217, v225
    v_mul_f32 v46, s24, v46
    v_mul_f32 v54, s24, v54
    v_fma_f32 v54, -v46, v46, v54
    v_max_f32 v54, 0, v54
    v_add_f32 v54, s25, v54
    v_rsq_f32 v54, v54
    v_lshlrev_b32 v218, 16, v233
    v_lshlrev_b32 v226, 16, v237
    v_mul_f32 v218, v218, v54
    v_fma_f32 v226, -v46, v218, v226
    v_mul_f32 v47, s24, v47
    v_mul_f32 v55, s24, v55
    v_fma_f32 v55, -v47, v47, v55
    v_max_f32 v55, 0, v55
    v_add_f32 v55, s25, v55
    v_rsq_f32 v55, v55
    v_and_b32 v219, 0xffff0000, v233
    v_and_b32 v227, 0xffff0000, v237
    v_mul_f32 v219, v219, v55
    v_fma_f32 v227, -v47, v219, v227
    v_mul_f32 v48, s24, v48
    v_mul_f32 v56, s24, v56
    v_fma_f32 v56, -v48, v48, v56
    v_max_f32 v56, 0, v56
    v_add_f32 v56, s25, v56
    v_rsq_f32 v56, v56
    v_lshlrev_b32 v220, 16, v234
    v_lshlrev_b32 v228, 16, v238
    v_mul_f32 v220, v220, v56
    v_fma_f32 v228, -v48, v220, v228
    v_mul_f32 v49, s24, v49
    v_mul_f32 v57, s24, v57
    v_fma_f32 v57, -v49, v49, v57
    v_max_f32 v57, 0, v57
    v_add_f32 v57, s25, v57
    v_rsq_f32 v57, v57
    v_and_b32 v221, 0xffff0000, v234
    v_and_b32 v229, 0xffff0000, v238
    v_mul_f32 v221, v221, v57
    v_fma_f32 v229, -v49, v221, v229
    v_mul_f32 v50, s24, v50
    v_mul_f32 v58, s24, v58
    v_fma_f32 v58, -v50, v50, v58
    v_max_f32 v58, 0, v58
    v_add_f32 v58, s25, v58
    v_rsq_f32 v58, v58
    v_lshlrev_b32 v222, 16, v235
    v_lshlrev_b32 v230, 16, v239
    v_mul_f32 v222, v222, v58
    v_fma_f32 v230, -v50, v222, v230
    v_mul_f32 v51, s24, v51
    v_mul_f32 v59, s24, v59
    v_fma_f32 v59, -v51, v51, v59
    v_max_f32 v59, 0, v59
    v_add_f32 v59, s25, v59
    v_rsq_f32 v59, v59
    v_and_b32 v223, 0xffff0000, v235
    v_and_b32 v231, 0xffff0000, v239
    v_mul_f32 v223, v223, v59
    v_fma_f32 v231, -v51, v223, v231
    s_mul_i32 s24, s11, 8176640
    s_add_u32 s28, s28, s24
    s_addc_u32 s29, s29, 0
    s_mov_b32 s32, s28
    s_and_b32 s33, s29, 0xffff
    s_mov_b32 s34, 8176640
    s_mov_b32 s35, 0x00020000
    s_lshl_b32 s25, s13, 8
    v_lshlrev_b32 v210, 12, v202
    v_lshl_add_u32 v210, v201, 4, v210
    v_add_u32 v210, s25, v210
    s_mov_b32 s26, 0xbdd2d3e8
    v_mov_b32 v211, 0xc0135761
    s_cmp_ge_u32 s10, 6
    s_cbranch_scc1 L_k45_hoff
    s_cmp_ge_u32 s14, 167
    s_cbranch_scc1 L_k45_fin
    s_mul_i32 s24, s14, 49152
    s_add_u32 s52, s24, 0
    s_add_u32 s53, s24, 1024
    s_add_u32 s54, s24, 2048
    s_add_u32 s55, s24, 16384
    s_add_u32 s56, s24, 17408
    s_add_u32 s57, s24, 18432
    s_add_u32 s58, s24, 32768
    s_add_u32 s59, s24, 33792
    s_add_u32 s60, s24, 34816
    s_branch L_k45_gelu
L_k45_hoff:
    s_sub_u32 s25, s10, 6
    s_mul_i32 s25, s25, 3
    s_mul_i32 s24, s12, 6
    s_add_u32 s24, s24, s25
    s_mul_i32 s24, s24, 49152
    s_add_u32 s52, s24, 3072
    s_add_u32 s53, s24, 19456
    s_add_u32 s54, s24, 35840
    s_add_u32 s55, s24, 52224
    s_add_u32 s56, s24, 68608
    s_add_u32 s57, s24, 84992
    s_add_u32 s58, s24, 101376
    s_add_u32 s59, s24, 117760
    s_add_u32 s60, s24, 134144
L_k45_gelu:
    v_fma_f32 v104, v104, v216, v224
    v_fma_f32 v108, v108, v217, v225
    v_fma_f32 v112, v112, v218, v226
    v_fma_f32 v116, v116, v219, v227
    v_fma_f32 v120, v120, v220, v228
    v_fma_f32 v124, v124, v221, v229
    v_fma_f32 v128, v128, v222, v230
    v_fma_f32 v132, v132, v223, v231
    v_mul_f32 v0, v104, v104
    v_mul_f32 v1, v108, v108
    v_mul_f32 v2, v112, v112
    v_mul_f32 v3, v116, v116
    v_mul_f32 v4, v120, v120
    v_mul_f32 v5, v124, v124
    v_mul_f32 v6, v128, v128
    v_mul_f32 v7, v132, v132
    v_fma_f32 v0, v0, s26, v211
    v_fma_f32 v1, v1, s26, v211
    v_fma_f32 v2, v2, s26, v211
    v_fma_f32 v3, v3, s26, v211
    v_fma_f32 v4, v4, s26, v211
    v_fma_f32 v5, v5, s26, v211
    v_fma_f32 v6, v6, s26, v211
    v_fma_f32 v7, v7, s26, v211
    v_mul_f32 v0, v0, v104
    v_mul_f32 v1, v1, v108
    v_mul_f32 v2, v2, v112
    v_mul_f32 v3, v3, v116
    v_mul_f32 v4, v4, v120
    v_mul_f32 v5, v5, v124
    v_mul_f32 v6, v6, v128
    v_mul_f32 v7, v7, v132
    v_exp_f32 v0, v0
    v_exp_f32 v1, v1
    v_exp_f32 v2, v2
    v_exp_f32 v3, v3
    v_exp_f32 v4, v4
    v_exp_f32 v5, v5
    v_exp_f32 v6, v6
    v_exp_f32 v7, v7
    v_add_f32 v0, 1.0, v0
    v_add_f32 v1, 1.0, v1
    v_add_f32 v2, 1.0, v2
    v_add_f32 v3, 1.0, v3
    v_add_f32 v4, 1.0, v4
    v_add_f32 v5, 1.0, v5
    v_add_f32 v6, 1.0, v6
    v_add_f32 v7, 1.0, v7
    v_rcp_f32 v0, v0
    v_rcp_f32 v1, v1
    v_rcp_f32 v2, v2
    v_rcp_f32 v3, v3
    v_rcp_f32 v4, v4
    v_rcp_f32 v5, v5
    v_rcp_f32 v6, v6
    v_rcp_f32 v7, v7
    v_mul_f32 v0, v0, v104
    v_mul_f32 v1, v1, v108
    v_mul_f32 v2, v2, v112
    v_mul_f32 v3, v3, v116
    v_mul_f32 v4, v4, v120
    v_mul_f32 v5, v5, v124
    v_mul_f32 v6, v6, v128
    v_mul_f32 v7, v7, v132
    v_cvt_pk_bf16_f32 v16, v0, v1
    v_cvt_pk_bf16_f32 v17, v2, v3
    v_cvt_pk_bf16_f32 v18, v4, v5
    v_cvt_pk_bf16_f32 v19, v6, v7
    buffer_store_dwordx4 v[16:19], v210, s[32:35], s52 offen sc1
    v_fma_f32 v105, v105, v216, v224
    v_fma_f32 v109, v109, v217, v225
    v_fma_f32 v113, v113, v218, v226
    v_fma_f32 v117, v117, v219, v227
    v_fma_f32 v121, v121, v220, v228
    v_fma_f32 v125, v125, v221, v229
    v_fma_f32 v129, v129, v222, v230
    v_fma_f32 v133, v133, v223, v231
    v_mul_f32 v0, v105, v105
    v_mul_f32 v1, v109, v109
    v_mul_f32 v2, v113, v113
    v_mul_f32 v3, v117, v117
    v_mul_f32 v4, v121, v121
    v_mul_f32 v5, v125, v125
    v_mul_f32 v6, v129, v129
    v_mul_f32 v7, v133, v133
    v_fma_f32 v0, v0, s26, v211
    v_fma_f32 v1, v1, s26, v211
    v_fma_f32 v2, v2, s26, v211
    v_fma_f32 v3, v3, s26, v211
    v_fma_f32 v4, v4, s26, v211
    v_fma_f32 v5, v5, s26, v211
    v_fma_f32 v6, v6, s26, v211
    v_fma_f32 v7, v7, s26, v211
    v_mul_f32 v0, v0, v105
    v_mul_f32 v1, v1, v109
    v_mul_f32 v2, v2, v113
    v_mul_f32 v3, v3, v117
    v_mul_f32 v4, v4, v121
    v_mul_f32 v5, v5, v125
    v_mul_f32 v6, v6, v129
    v_mul_f32 v7, v7, v133
    v_exp_f32 v0, v0
    v_exp_f32 v1, v1
    v_exp_f32 v2, v2
    v_exp_f32 v3, v3
    v_exp_f32 v4, v4
    v_exp_f32 v5, v5
    v_exp_f32 v6, v6
    v_exp_f32 v7, v7
    v_add_f32 v0, 1.0, v0
    v_add_f32 v1, 1.0, v1
    v_add_f32 v2, 1.0, v2
    v_add_f32 v3, 1.0, v3
    v_add_f32 v4, 1.0, v4
    v_add_f32 v5, 1.0, v5
    v_add_f32 v6, 1.0, v6
    v_add_f32 v7, 1.0, v7
    v_rcp_f32 v0, v0
    v_rcp_f32 v1, v1
    v_rcp_f32 v2, v2
    v_rcp_f32 v3, v3
    v_rcp_f32 v4, v4
    v_rcp_f32 v5, v5
    v_rcp_f32 v6, v6
    v_rcp_f32 v7, v7
    v_mul_f32 v0, v0, v105
    v_mul_f32 v1, v1, v109
    v_mul_f32 v2, v2, v113
    v_mul_f32 v3, v3, v117
    v_mul_f32 v4, v4, v121
    v_mul_f32 v5, v5, v125
    v_mul_f32 v6, v6, v129
    v_mul_f32 v7, v7, v133
    v_cvt_pk_bf16_f32 v20, v0, v1
    v_cvt_pk_bf16_f32 v21, v2, v3
    v_cvt_pk_bf16_f32 v22, v4, v5
    v_cvt_pk_bf16_f32 v23, v6, v7
    buffer_store_dwordx4 v[20:23], v210, s[32:35], s53 offen sc1
    v_fma_f32 v106, v106, v216, v224
    v_fma_f32 v110, v110, v217, v225
    v_fma_f32 v114, v114, v218, v226
    v_fma_f32 v118, v118, v219, v227
    v_fma_f32 v122, v122, v220, v228
    v_fma_f32 v126, v126, v221, v229
    v_fma_f32 v130, v130, v222, v230
    v_fma_f32 v134, v134, v223, v231
    v_mul_f32 v0, v106, v106
    v_mul_f32 v1, v110, v110
    v_mul_f32 v2, v114, v114
    v_mul_f32 v3, v118, v118
    v_mul_f32 v4, v122, v122
    v_mul_f32 v5, v126, v126
    v_mul_f32 v6, v130, v130
    v_mul_f32 v7, v134, v134
    v_fma_f32 v0, v0, s26, v211
    v_fma_f32 v1, v1, s26, v211
    v_fma_f32 v2, v2, s26, v211
    v_fma_f32 v3, v3, s26, v211
    v_fma_f32 v4, v4, s26, v211
    v_fma_f32 v5, v5, s26, v211
    v_fma_f32 v6, v6, s26, v211
    v_fma_f32 v7, v7, s26, v211
    v_mul_f32 v0, v0, v106
    v_mul_f32 v1, v1, v110
    v_mul_f32 v2, v2, v114
    v_mul_f32 v3, v3, v118
    v_mul_f32 v4, v4, v122
    v_mul_f32 v5, v5, v126
    v_mul_f32 v6, v6, v130
    v_mul_f32 v7, v7, v134
    v_exp_f32 v0, v0
    v_exp_f32 v1, v1
    v_exp_f32 v2, v2
    v_exp_f32 v3, v3
    v_exp_f32 v4, v4
    v_exp_f32 v5, v5
    v_exp_f32 v6, v6
    v_exp_f32 v7, v7
    v_add_f32 v0, 1.0, v0
    v_add_f32 v1, 1.0, v1
    v_add_f32 v2, 1.0, v2
    v_add_f32 v3, 1.0, v3
    v_add_f32 v4, 1.0, v4
    v_add_f32 v5, 1.0, v5
    v_add_f32 v6, 1.0, v6
    v_add_f32 v7, 1.0, v7
    v_rcp_f32 v0, v0
    v_rcp_f32 v1, v1
    v_rcp_f32 v2, v2
    v_rcp_f32 v3, v3
    v_rcp_f32 v4, v4
    v_rcp_f32 v5, v5
    v_rcp_f32 v6, v6
    v_rcp_f32 v7, v7
    v_mul_f32 v0, v0, v106
    v_mul_f32 v1, v1, v110
    v_mul_f32 v2, v2, v114
    v_mul_f32 v3, v3, v118
    v_mul_f32 v4, v4, v122
    v_mul_f32 v5, v5, v126
    v_mul_f32 v6, v6, v130
    v_mul_f32 v7, v7, v134
    v_cvt_pk_bf16_f32 v24, v0, v1
    v_cvt_pk_bf16_f32 v25, v2, v3
    v_cvt_pk_bf16_f32 v26, v4, v5
    v_cvt_pk_bf16_f32 v27, v6, v7
    buffer_store_dwordx4 v[24:27], v210, s[32:35], s54 offen sc1
    v_fma_f32 v136, v136, v216, v224
    v_fma_f32 v140, v140, v217, v225
    v_fma_f32 v144, v144, v218, v226
    v_fma_f32 v148, v148, v219, v227
    v_fma_f32 v152, v152, v220, v228
    v_fma_f32 v156, v156, v221, v229
    v_fma_f32 v160, v160, v222, v230
    v_fma_f32 v164, v164, v223, v231
    v_mul_f32 v0, v136, v136
    v_mul_f32 v1, v140, v140
    v_mul_f32 v2, v144, v144
    v_mul_f32 v3, v148, v148
    v_mul_f32 v4, v152, v152
    v_mul_f32 v5, v156, v156
    v_mul_f32 v6, v160, v160
    v_mul_f32 v7, v164, v164
    v_fma_f32 v0, v0, s26, v211
    v_fma_f32 v1, v1, s26, v211
    v_fma_f32 v2, v2, s26, v211
    v_fma_f32 v3, v3, s26, v211
    v_fma_f32 v4, v4, s26, v211
    v_fma_f32 v5, v5, s26, v211
    v_fma_f32 v6, v6, s26, v211
    v_fma_f32 v7, v7, s26, v211
    v_mul_f32 v0, v0, v136
    v_mul_f32 v1, v1, v140
    v_mul_f32 v2, v2, v144
    v_mul_f32 v3, v3, v148
    v_mul_f32 v4, v4, v152
    v_mul_f32 v5, v5, v156
    v_mul_f32 v6, v6, v160
    v_mul_f32 v7, v7, v164
    v_exp_f32 v0, v0
    v_exp_f32 v1, v1
    v_exp_f32 v2, v2
    v_exp_f32 v3, v3
    v_exp_f32 v4, v4
    v_exp_f32 v5, v5
    v_exp_f32 v6, v6
    v_exp_f32 v7, v7
    v_add_f32 v0, 1.0, v0
    v_add_f32 v1, 1.0, v1
    v_add_f32 v2, 1.0, v2
    v_add_f32 v3, 1.0, v3
    v_add_f32 v4, 1.0, v4
    v_add_f32 v5, 1.0, v5
    v_add_f32 v6, 1.0, v6
    v_add_f32 v7, 1.0, v7
    v_rcp_f32 v0, v0
    v_rcp_f32 v1, v1
    v_rcp_f32 v2, v2
    v_rcp_f32 v3, v3
    v_rcp_f32 v4, v4
    v_rcp_f32 v5, v5
    v_rcp_f32 v6, v6
    v_rcp_f32 v7, v7
    v_mul_f32 v0, v0, v136
    v_mul_f32 v1, v1, v140
    v_mul_f32 v2, v2, v144
    v_mul_f32 v3, v3, v148
    v_mul_f32 v4, v4, v152
    v_mul_f32 v5, v5, v156
    v_mul_f32 v6, v6, v160
    v_mul_f32 v7, v7, v164
    v_cvt_pk_bf16_f32 v28, v0, v1
    v_cvt_pk_bf16_f32 v29, v2, v3
    v_cvt_pk_bf16_f32 v30, v4, v5
    v_cvt_pk_bf16_f32 v31, v6, v7
    buffer_store_dwordx4 v[28:31], v210, s[32:35], s55 offen sc1
    v_fma_f32 v137, v137, v216, v224
    v_fma_f32 v141, v141, v217, v225
    v_fma_f32 v145, v145, v218, v226
    v_fma_f32 v149, v149, v219, v227
    v_fma_f32 v153, v153, v220, v228
    v_fma_f32 v157, v157, v221, v229
    v_fma_f32 v161, v161, v222, v230
    v_fma_f32 v165, v165, v223, v231
    v_mul_f32 v0, v137, v137
    v_mul_f32 v1, v141, v141
    v_mul_f32 v2, v145, v145
    v_mul_f32 v3, v149, v149
    v_mul_f32 v4, v153, v153
    v_mul_f32 v5, v157, v157
    v_mul_f32 v6, v161, v161
    v_mul_f32 v7, v165, v165
    v_fma_f32 v0, v0, s26, v211
    v_fma_f32 v1, v1, s26, v211
    v_fma_f32 v2, v2, s26, v211
    v_fma_f32 v3, v3, s26, v211
    v_fma_f32 v4, v4, s26, v211
    v_fma_f32 v5, v5, s26, v211
    v_fma_f32 v6, v6, s26, v211
    v_fma_f32 v7, v7, s26, v211
    v_mul_f32 v0, v0, v137
    v_mul_f32 v1, v1, v141
    v_mul_f32 v2, v2, v145
    v_mul_f32 v3, v3, v149
    v_mul_f32 v4, v4, v153
    v_mul_f32 v5, v5, v157
    v_mul_f32 v6, v6, v161
    v_mul_f32 v7, v7, v165
    v_exp_f32 v0, v0
    v_exp_f32 v1, v1
    v_exp_f32 v2, v2
    v_exp_f32 v3, v3
    v_exp_f32 v4, v4
    v_exp_f32 v5, v5
    v_exp_f32 v6, v6
    v_exp_f32 v7, v7
    v_add_f32 v0, 1.0, v0
    v_add_f32 v1, 1.0, v1
    v_add_f32 v2, 1.0, v2
    v_add_f32 v3, 1.0, v3
    v_add_f32 v4, 1.0, v4
    v_add_f32 v5, 1.0, v5
    v_add_f32 v6, 1.0, v6
    v_add_f32 v7, 1.0, v7
    v_rcp_f32 v0, v0
    v_rcp_f32 v1, v1
    v_rcp_f32 v2, v2
    v_rcp_f32 v3, v3
    v_rcp_f32 v4, v4
    v_rcp_f32 v5, v5
    v_rcp_f32 v6, v6
    v_rcp_f32 v7, v7
    v_mul_f32 v0, v0, v137
    v_mul_f32 v1, v1, v141
    v_mul_f32 v2, v2, v145
    v_mul_f32 v3, v3, v149
    v_mul_f32 v4, v4, v153
    v_mul_f32 v5, v5, v157
    v_mul_f32 v6, v6, v161
    v_mul_f32 v7, v7, v165
    v_cvt_pk_bf16_f32 v32, v0, v1
    v_cvt_pk_bf16_f32 v33, v2, v3
    v_cvt_pk_bf16_f32 v34, v4, v5
    v_cvt_pk_bf16_f32 v35, v6, v7
    buffer_store_dwordx4 v[32:35], v210, s[32:35], s56 offen sc1
    v_fma_f32 v138, v138, v216, v224
    v_fma_f32 v142, v142, v217, v225
    v_fma_f32 v146, v146, v218, v226
    v_fma_f32 v150, v150, v219, v227
    v_fma_f32 v154, v154, v220, v228
    v_fma_f32 v158, v158, v221, v229
    v_fma_f32 v162, v162, v222, v230
    v_fma_f32 v166, v166, v223, v231
    v_mul_f32 v0, v138, v138
    v_mul_f32 v1, v142, v142
    v_mul_f32 v2, v146, v146
    v_mul_f32 v3, v150, v150
    v_mul_f32 v4, v154, v154
    v_mul_f32 v5, v158, v158
    v_mul_f32 v6, v162, v162
    v_mul_f32 v7, v166, v166
    v_fma_f32 v0, v0, s26, v211
    v_fma_f32 v1, v1, s26, v211
    v_fma_f32 v2, v2, s26, v211
    v_fma_f32 v3, v3, s26, v211
    v_fma_f32 v4, v4, s26, v211
    v_fma_f32 v5, v5, s26, v211
    v_fma_f32 v6, v6, s26, v211
    v_fma_f32 v7, v7, s26, v211
    v_mul_f32 v0, v0, v138
    v_mul_f32 v1, v1, v142
    v_mul_f32 v2, v2, v146
    v_mul_f32 v3, v3, v150
    v_mul_f32 v4, v4, v154
    v_mul_f32 v5, v5, v158
    v_mul_f32 v6, v6, v162
    v_mul_f32 v7, v7, v166
    v_exp_f32 v0, v0
    v_exp_f32 v1, v1
    v_exp_f32 v2, v2
    v_exp_f32 v3, v3
    v_exp_f32 v4, v4
    v_exp_f32 v5, v5
    v_exp_f32 v6, v6
    v_exp_f32 v7, v7
    v_add_f32 v0, 1.0, v0
    v_add_f32 v1, 1.0, v1
    v_add_f32 v2, 1.0, v2
    v_add_f32 v3, 1.0, v3
    v_add_f32 v4, 1.0, v4
    v_add_f32 v5, 1.0, v5
    v_add_f32 v6, 1.0, v6
    v_add_f32 v7, 1.0, v7
    v_rcp_f32 v0, v0
    v_rcp_f32 v1, v1
    v_rcp_f32 v2, v2
    v_rcp_f32 v3, v3
    v_rcp_f32 v4, v4
    v_rcp_f32 v5, v5
    v_rcp_f32 v6, v6
    v_rcp_f32 v7, v7
    v_mul_f32 v0, v0, v138
    v_mul_f32 v1, v1, v142
    v_mul_f32 v2, v2, v146
    v_mul_f32 v3, v3, v150
    v_mul_f32 v4, v4, v154
    v_mul_f32 v5, v5, v158
    v_mul_f32 v6, v6, v162
    v_mul_f32 v7, v7, v166
    v_cvt_pk_bf16_f32 v36, v0, v1
    v_cvt_pk_bf16_f32 v37, v2, v3
    v_cvt_pk_bf16_f32 v38, v4, v5
    v_cvt_pk_bf16_f32 v39, v6, v7
    buffer_store_dwordx4 v[36:39], v210, s[32:35], s57 offen sc1
    v_fma_f32 v168, v168, v216, v224
    v_fma_f32 v172, v172, v217, v225
    v_fma_f32 v176, v176, v218, v226
    v_fma_f32 v180, v180, v219, v227
    v_fma_f32 v184, v184, v220, v228
    v_fma_f32 v188, v188, v221, v229
    v_fma_f32 v192, v192, v222, v230
    v_fma_f32 v196, v196, v223, v231
    v_mul_f32 v0, v168, v168
    v_mul_f32 v1, v172, v172
    v_mul_f32 v2, v176, v176
    v_mul_f32 v3, v180, v180
    v_mul_f32 v4, v184, v184
    v_mul_f32 v5, v188, v188
    v_mul_f32 v6, v192, v192
    v_mul_f32 v7, v196, v196
    v_fma_f32 v0, v0, s26, v211
    v_fma_f32 v1, v1, s26, v211
    v_fma_f32 v2, v2, s26, v211
    v_fma_f32 v3, v3, s26, v211
    v_fma_f32 v4, v4, s26, v211
    v_fma_f32 v5, v5, s26, v211
    v_fma_f32 v6, v6, s26, v211
    v_fma_f32 v7, v7, s26, v211
    v_mul_f32 v0, v0, v168
    v_mul_f32 v1, v1, v172
    v_mul_f32 v2, v2, v176
    v_mul_f32 v3, v3, v180
    v_mul_f32 v4, v4, v184
    v_mul_f32 v5, v5, v188
    v_mul_f32 v6, v6, v192
    v_mul_f32 v7, v7, v196
    v_exp_f32 v0, v0
    v_exp_f32 v1, v1
    v_exp_f32 v2, v2
    v_exp_f32 v3, v3
    v_exp_f32 v4, v4
    v_exp_f32 v5, v5
    v_exp_f32 v6, v6
    v_exp_f32 v7, v7
    v_add_f32 v0, 1.0, v0
    v_add_f32 v1, 1.0, v1
    v_add_f32 v2, 1.0, v2
    v_add_f32 v3, 1.0, v3
    v_add_f32 v4, 1.0, v4
    v_add_f32 v5, 1.0, v5
    v_add_f32 v6, 1.0, v6
    v_add_f32 v7, 1.0, v7
    v_rcp_f32 v0, v0
    v_rcp_f32 v1, v1
    v_rcp_f32 v2, v2
    v_rcp_f32 v3, v3
    v_rcp_f32 v4, v4
    v_rcp_f32 v5, v5
    v_rcp_f32 v6, v6
    v_rcp_f32 v7, v7
    v_mul_f32 v0, v0, v168
    v_mul_f32 v1, v1, v172
    v_mul_f32 v2, v2, v176
    v_mul_f32 v3, v3, v180
    v_mul_f32 v4, v4, v184
    v_mul_f32 v5, v5, v188
    v_mul_f32 v6, v6, v192
    v_mul_f32 v7, v7, v196
    v_cvt_pk_bf16_f32 v40, v0, v1
    v_cvt_pk_bf16_f32 v41, v2, v3
    v_cvt_pk_bf16_f32 v42, v4, v5
    v_cvt_pk_bf16_f32 v43, v6, v7
    buffer_store_dwordx4 v[40:43], v210, s[32:35], s58 offen sc1
    v_fma_f32 v169, v169, v216, v224
    v_fma_f32 v173, v173, v217, v225
    v_fma_f32 v177, v177, v218, v226
    v_fma_f32 v181, v181, v219, v227
    v_fma_f32 v185, v185, v220, v228
    v_fma_f32 v189, v189, v221, v229
    v_fma_f32 v193, v193, v222, v230
    v_fma_f32 v197, v197, v223, v231
    v_mul_f32 v0, v169, v169
    v_mul_f32 v1, v173, v173
    v_mul_f32 v2, v177, v177
    v_mul_f32 v3, v181, v181
    v_mul_f32 v4, v185, v185
    v_mul_f32 v5, v189, v189
    v_mul_f32 v6, v193, v193
    v_mul_f32 v7, v197, v197
    v_fma_f32 v0, v0, s26, v211
    v_fma_f32 v1, v1, s26, v211
    v_fma_f32 v2, v2, s26, v211
    v_fma_f32 v3, v3, s26, v211
    v_fma_f32 v4, v4, s26, v211
    v_fma_f32 v5, v5, s26, v211
    v_fma_f32 v6, v6, s26, v211
    v_fma_f32 v7, v7, s26, v211
    v_mul_f32 v0, v0, v169
    v_mul_f32 v1, v1, v173
    v_mul_f32 v2, v2, v177
    v_mul_f32 v3, v3, v181
    v_mul_f32 v4, v4, v185
    v_mul_f32 v5, v5, v189
    v_mul_f32 v6, v6, v193
    v_mul_f32 v7, v7, v197
    v_exp_f32 v0, v0
    v_exp_f32 v1, v1
    v_exp_f32 v2, v2
    v_exp_f32 v3, v3
    v_exp_f32 v4, v4
    v_exp_f32 v5, v5
    v_exp_f32 v6, v6
    v_exp_f32 v7, v7
    v_add_f32 v0, 1.0, v0
    v_add_f32 v1, 1.0, v1
    v_add_f32 v2, 1.0, v2
    v_add_f32 v3, 1.0, v3
    v_add_f32 v4, 1.0, v4
    v_add_f32 v5, 1.0, v5
    v_add_f32 v6, 1.0, v6
    v_add_f32 v7, 1.0, v7
    v_rcp_f32 v0, v0
    v_rcp_f32 v1, v1
    v_rcp_f32 v2, v2
    v_rcp_f32 v3, v3
    v_rcp_f32 v4, v4
    v_rcp_f32 v5, v5
    v_rcp_f32 v6, v6
    v_rcp_f32 v7, v7
    v_mul_f32 v0, v0, v169
    v_mul_f32 v1, v1, v173
    v_mul_f32 v2, v2, v177
    v_mul_f32 v3, v3, v181
    v_mul_f32 v4, v4, v185
    v_mul_f32 v5, v5, v189
    v_mul_f32 v6, v6, v193
    v_mul_f32 v7, v7, v197
    v_cvt_pk_bf16_f32 v44, v0, v1
    v_cvt_pk_bf16_f32 v45, v2, v3
    v_cvt_pk_bf16_f32 v46, v4, v5
    v_cvt_pk_bf16_f32 v47, v6, v7
    buffer_store_dwordx4 v[44:47], v210, s[32:35], s59 offen sc1
    v_fma_f32 v170, v170, v216, v224
    v_fma_f32 v174, v174, v217, v225
    v_fma_f32 v178, v178, v218, v226
    v_fma_f32 v182, v182, v219, v227
    v_fma_f32 v186, v186, v220, v228
    v_fma_f32 v190, v190, v221, v229
    v_fma_f32 v194, v194, v222, v230
    v_fma_f32 v198, v198, v223, v231
    v_mul_f32 v0, v170, v170
    v_mul_f32 v1, v174, v174
    v_mul_f32 v2, v178, v178
    v_mul_f32 v3, v182, v182
    v_mul_f32 v4, v186, v186
    v_mul_f32 v5, v190, v190
    v_mul_f32 v6, v194, v194
    v_mul_f32 v7, v198, v198
    v_fma_f32 v0, v0, s26, v211
    v_fma_f32 v1, v1, s26, v211
    v_fma_f32 v2, v2, s26, v211
    v_fma_f32 v3, v3, s26, v211
    v_fma_f32 v4, v4, s26, v211
    v_fma_f32 v5, v5, s26, v211
    v_fma_f32 v6, v6, s26, v211
    v_fma_f32 v7, v7, s26, v211
    v_mul_f32 v0, v0, v170
    v_mul_f32 v1, v1, v174
    v_mul_f32 v2, v2, v178
    v_mul_f32 v3, v3, v182
    v_mul_f32 v4, v4, v186
    v_mul_f32 v5, v5, v190
    v_mul_f32 v6, v6, v194
    v_mul_f32 v7, v7, v198
    v_exp_f32 v0, v0
    v_exp_f32 v1, v1
    v_exp_f32 v2, v2
    v_exp_f32 v3, v3
    v_exp_f32 v4, v4
    v_exp_f32 v5, v5
    v_exp_f32 v6, v6
    v_exp_f32 v7, v7
    v_add_f32 v0, 1.0, v0
    v_add_f32 v1, 1.0, v1
    v_add_f32 v2, 1.0, v2
    v_add_f32 v3, 1.0, v3
    v_add_f32 v4, 1.0, v4
    v_add_f32 v5, 1.0, v5
    v_add_f32 v6, 1.0, v6
    v_add_f32 v7, 1.0, v7
    v_rcp_f32 v0, v0
    v_rcp_f32 v1, v1
    v_rcp_f32 v2, v2
    v_rcp_f32 v3, v3
    v_rcp_f32 v4, v4
    v_rcp_f32 v5, v5
    v_rcp_f32 v6, v6
    v_rcp_f32 v7, v7
    v_mul_f32 v0, v0, v170
    v_mul_f32 v1, v1, v174
    v_mul_f32 v2, v2, v178
    v_mul_f32 v3, v3, v182
    v_mul_f32 v4, v4, v186
    v_mul_f32 v5, v5, v190
    v_mul_f32 v6, v6, v194
    v_mul_f32 v7, v7, v198
    v_cvt_pk_bf16_f32 v16, v0, v1
    v_cvt_pk_bf16_f32 v17, v2, v3
    v_cvt_pk_bf16_f32 v18, v4, v5
    v_cvt_pk_bf16_f32 v19, v6, v7
    buffer_store_dwordx4 v[16:19], v210, s[32:35], s60 offen sc1
L_k45_fin:
L_k45_end:
    s_endpgm
L_code_end:
    s_endpgm
.section .rodata,"a"
.p2align 6
.amdhsa_kernel conv_kernel
  .amdhsa_next_free_vgpr 256
  .amdhsa_next_free_sgpr 96
  .amdhsa_accum_offset 256
  .amdhsa_group_segment_fixed_size 0
  .amdhsa_kernarg_size 56
  .amdhsa_user_sgpr_count 2
  .amdhsa_user_sgpr_kernarg_segment_ptr 1
  .amdhsa_system_sgpr_workgroup_id_x 1
  .amdhsa_float_denorm_mode_32 3
.end_amdhsa_kernel

.p2align 6
.amdhsa_kernel final_kernel
  .amdhsa_next_free_vgpr 240
  .amdhsa_next_free_sgpr 96
  .amdhsa_accum_offset 240
  .amdhsa_group_segment_fixed_size 0
  .amdhsa_kernarg_size 56
  .amdhsa_user_sgpr_count 2
  .amdhsa_user_sgpr_kernarg_segment_ptr 1
  .amdhsa_system_sgpr_workgroup_id_x 1
  .amdhsa_float_denorm_mode_32 3
.end_amdhsa_kernel
```

```asm
; @launch kernel=conv_kernel grid=(256,1,1) block=(512,1,1) lds=155648
; @launch kernel=final_kernel grid=(224,1,1) block=(512,1,1) lds=82944
.amdgcn_target "amdgcn-amd-amdhsa--gfx950"
.text
.globl conv_kernel
.p2align 8
.type conv_kernel,@function
conv_kernel:
    s_cmp_ge_u32 s2, 256
    s_cbranch_scc1 L_fz_end
    s_load_dwordx4 s[4:7], s[0:1], 0
    s_load_dwordx4 s[36:39], s[0:1], 40
    v_lshrrev_b32 v253, 6, v0
    v_and_b32 v0, 63, v0
    v_readfirstlane_b32 s10, v253
    s_nop 3
    s_cmp_ge_u32 s10, 4
    s_cbranch_scc1 L_fz_helper
    s_cmp_ge_u32 s2, 8
    s_cbranch_scc1 L_nopf
    s_cmp_lg_u32 s10, 3
    s_cbranch_scc1 L_nopf
    s_getpc_b64 s[60:61]
L_pf_fz:
    s_sub_u32 s60, s60, L_pf_fz-conv_kernel
    s_subb_u32 s61, s61, 0
    v_mbcnt_lo_u32_b32 v200, -1, 0
    v_mbcnt_hi_u32_b32 v200, -1, v200
    v_lshlrev_b32 v200, 6, v200
    v_add_u32 v201, 0, v200
    v_min_u32 v201, L_code_end-conv_kernel-4, v201
    v_mov_b32 v203, s61
    v_add_co_u32 v202, vcc, s60, v201
    s_nop 1
    v_addc_co_u32 v203, vcc, 0, v203, vcc
    global_load_dword v204, v[202:203], off
    v_add_u32 v201, 4096, v200
    v_min_u32 v201, L_code_end-conv_kernel-4, v201
    v_mov_b32 v203, s61
    v_add_co_u32 v202, vcc, s60, v201
    s_nop 1
    v_addc_co_u32 v203, vcc, 0, v203, vcc
    global_load_dword v204, v[202:203], off
    v_add_u32 v201, 8192, v200
    v_min_u32 v201, L_code_end-conv_kernel-4, v201
    v_mov_b32 v203, s61
    v_add_co_u32 v202, vcc, s60, v201
    s_nop 1
    v_addc_co_u32 v203, vcc, 0, v203, vcc
    global_load_dword v204, v[202:203], off
    v_add_u32 v201, 12288, v200
    v_min_u32 v201, L_code_end-conv_kernel-4, v201
    v_mov_b32 v203, s61
    v_add_co_u32 v202, vcc, s60, v201
    s_nop 1
    v_addc_co_u32 v203, vcc, 0, v203, vcc
    global_load_dword v204, v[202:203], off
    v_add_u32 v201, 16384, v200
    v_min_u32 v201, L_code_end-conv_kernel-4, v201
    v_mov_b32 v203, s61
    v_add_co_u32 v202, vcc, s60, v201
    s_nop 1
    v_addc_co_u32 v203, vcc, 0, v203, vcc
    global_load_dword v204, v[202:203], off
    v_add_u32 v201, 20480, v200
    v_min_u32 v201, L_code_end-conv_kernel-4, v201
    v_mov_b32 v203, s61
    v_add_co_u32 v202, vcc, s60, v201
    s_nop 1
    v_addc_co_u32 v203, vcc, 0, v203, vcc
    global_load_dword v204, v[202:203], off
    v_add_u32 v201, 24576, v200
    v_min_u32 v201, L_code_end-conv_kernel-4, v201
    v_mov_b32 v203, s61
    v_add_co_u32 v202, vcc, s60, v201
    s_nop 1
    v_addc_co_u32 v203, vcc, 0, v203, vcc
    global_load_dword v204, v[202:203], off
    v_add_u32 v201, 28672, v200
    v_min_u32 v201, L_code_end-conv_kernel-4, v201
    v_mov_b32 v203, s61
    v_add_co_u32 v202, vcc, s60, v201
    s_nop 1
    v_addc_co_u32 v203, vcc, 0, v203, vcc
    global_load_dword v204, v[202:203], off
    v_add_u32 v201, 32768, v200
    v_min_u32 v201, L_code_end-conv_kernel-4, v201
    v_mov_b32 v203, s61
    v_add_co_u32 v202, vcc, s60, v201
    s_nop 1
    v_addc_co_u32 v203, vcc, 0, v203, vcc
    global_load_dword v204, v[202:203], off
    v_add_u32 v201, 36864, v200
    v_min_u32 v201, L_code_end-conv_kernel-4, v201
    v_mov_b32 v203, s61
    v_add_co_u32 v202, vcc, s60, v201
    s_nop 1
    v_addc_co_u32 v203, vcc, 0, v203, vcc
    global_load_dword v204, v[202:203], off
    v_add_u32 v201, 40960, v200
    v_min_u32 v201, L_code_end-conv_kernel-4, v201
    v_mov_b32 v203, s61
    v_add_co_u32 v202, vcc, s60, v201
    s_nop 1
    v_addc_co_u32 v203, vcc, 0, v203, vcc
    global_load_dword v204, v[202:203], off
    v_add_u32 v201, 45056, v200
    v_min_u32 v201, L_code_end-conv_kernel-4, v201
    v_mov_b32 v203, s61
    v_add_co_u32 v202, vcc, s60, v201
    s_nop 1
    v_addc_co_u32 v203, vcc, 0, v203, vcc
    global_load_dword v204, v[202:203], off
L_nopf:
    s_and_b32 s11, s2, 7
    s_lshr_b32 s12, s2, 3
    s_lshr_b32 s13, s12, 3
    s_lshl_b32 s11, s11, 2
    s_add_u32 s11, s11, s13
    s_bfe_u32 s13, s12, 0x10002
    s_and_b32 s14, s12, 3
    s_and_b32 s15, s10, 3
    v_lshrrev_b32 v253, 4, v0
    v_and_b32 v254, 15, v0
    v_bfe_u32 v255, v254, 3, 1
    v_mul_u32_u24 v255, 3, v255
    v_xor_b32 v255, v255, v253
    v_lshlrev_b32 v255, 4, v255
    v_lshl_add_u32 v250, v254, 6, v255
    v_lshrrev_b32 v255, 2, v254
    v_and_b32 v216, 1, v253
    v_lshl_or_b32 v216, v216, 2, v255
    v_lshl_add_u32 v255, v253, 3, v255
    v_lshlrev_b32 v255, 8, v255
    v_and_b32 v217, 3, v254
    v_lshl_add_u32 v255, v217, 3, v255
    s_lshl_b32 s20, s15, 1
    s_add_u32 s20, s20, s13
    v_xor_b32 v217, s20, v216
    v_lshl_add_u32 v248, v217, 5, v255
    s_xor_b32 s20, s20, 1
    v_xor_b32 v217, s20, v216
    v_lshl_add_u32 v249, v217, 5, v255
    v_lshlrev_b32 v251, 6, v254
    v_lshl_add_u32 v251, v253, 4, v251
    v_and_b32 v255, 7, v254
    v_lshlrev_b32 v252, 6, v255
    v_lshrrev_b32 v216, 3, v254
    v_xor_b32 v216, s13, v216
    s_mov_b32 s22, 11534336
    v_mul_lo_u32 v216, v216, s22
    v_add_u32 v252, v252, v216
    v_lshl_add_u32 v252, v253, 4, v252
    s_lshl_b32 s22, s13, 3
    v_add_u32 v252, s22, v252
    v_cmp_gt_u32 vcc, 7, v255
    v_mov_b32 v216, 0x80000000
    s_nop 0
    v_cndmask_b32 v252, v216, v252, vcc
    s_lshl_b32 s20, s14, 2
    s_add_u32 s20, s20, s15
    s_mul_i32 s48, s20, 720896
    s_mul_i32 s20, s11, 22528
    s_add_u32 s48, s48, s20
    s_add_u32 s48, s48, 117440512
    s_add_u32 s49, s48, 10240
    s_mul_i32 s20, s13, 11534336
    s_add_u32 s48, s48, s20
    s_waitcnt vmcnt(0) lgkmcnt(0)
    s_mov_b32 s16, s38
    s_and_b32 s17, s39, 0xffff
    s_mov_b32 s18, 268435456
    s_mov_b32 s19, 0x00020000
    v_mov_b32 v0, 0
    v_mov_b32 v1, 0
    v_mov_b32 v2, 0
    v_mov_b32 v3, 0
    v_mov_b32 v4, 0
    v_mov_b32 v5, 0
    v_mov_b32 v6, 0
    v_mov_b32 v7, 0
    v_mov_b32 v8, 0
    v_mov_b32 v9, 0
    v_mov_b32 v10, 0
    v_mov_b32 v11, 0
    v_mov_b32 v12, 0
    v_mov_b32 v13, 0
    v_mov_b32 v14, 0
    v_mov_b32 v15, 0
    v_mov_b32 v16, 0
    v_mov_b32 v17, 0
    v_mov_b32 v18, 0
    v_mov_b32 v19, 0
    v_mov_b32 v20, 0
    v_mov_b32 v21, 0
    v_mov_b32 v22, 0
    v_mov_b32 v23, 0
    v_mov_b32 v24, 0
    v_mov_b32 v25, 0
    v_mov_b32 v26, 0
    v_mov_b32 v27, 0
    v_mov_b32 v28, 0
    v_mov_b32 v29, 0
    v_mov_b32 v30, 0
    v_mov_b32 v31, 0
    v_mov_b32 v32, 0
    v_mov_b32 v33, 0
    v_mov_b32 v34, 0
    v_mov_b32 v35, 0
    v_mov_b32 v36, 0
    v_mov_b32 v37, 0
    v_mov_b32 v38, 0
    v_mov_b32 v39, 0
    v_mov_b32 v40, 0
    v_mov_b32 v41, 0
    v_mov_b32 v42, 0
    v_mov_b32 v43, 0
    v_mov_b32 v44, 0
    v_mov_b32 v45, 0
    v_mov_b32 v46, 0
    v_mov_b32 v47, 0
    v_mov_b32 v48, 0
    v_mov_b32 v49, 0
    v_mov_b32 v50, 0
    v_mov_b32 v51, 0
    v_mov_b32 v52, 0
    v_mov_b32 v53, 0
    v_mov_b32 v54, 0
    v_mov_b32 v55, 0
    v_mov_b32 v56, 0
    v_mov_b32 v57, 0
    v_mov_b32 v58, 0
    v_mov_b32 v59, 0
    v_mov_b32 v60, 0
    v_mov_b32 v61, 0
    v_mov_b32 v62, 0
    v_mov_b32 v63, 0
    v_mov_b32 v64, 0
    v_mov_b32 v65, 0
    v_mov_b32 v66, 0
    v_mov_b32 v67, 0
    v_mov_b32 v68, 0
    v_mov_b32 v69, 0
    v_mov_b32 v70, 0
    v_mov_b32 v71, 0
    v_mov_b32 v72, 0
    v_mov_b32 v73, 0
    v_mov_b32 v74, 0
    v_mov_b32 v75, 0
    v_mov_b32 v76, 0
    v_mov_b32 v77, 0
    v_mov_b32 v78, 0
    v_mov_b32 v79, 0
    v_mov_b32 v80, 0
    v_mov_b32 v81, 0
    v_mov_b32 v82, 0
    v_mov_b32 v83, 0
    v_mov_b32 v84, 0
    v_mov_b32 v85, 0
    v_mov_b32 v86, 0
    v_mov_b32 v87, 0
    v_mov_b32 v88, 0
    v_mov_b32 v89, 0
    v_mov_b32 v90, 0
    v_mov_b32 v91, 0
    v_mov_b32 v92, 0
    v_mov_b32 v93, 0
    v_mov_b32 v94, 0
    v_mov_b32 v95, 0
    v_mov_b32 v96, 0
    v_mov_b32 v97, 0
    v_mov_b32 v98, 0
    v_mov_b32 v99, 0
    v_mov_b32 v100, 0
    v_mov_b32 v101, 0
    v_mov_b32 v102, 0
    v_mov_b32 v103, 0
    v_mov_b32 v104, 0
    v_mov_b32 v105, 0
    v_mov_b32 v106, 0
    v_mov_b32 v107, 0
    v_mov_b32 v108, 0
    v_mov_b32 v109, 0
    v_mov_b32 v110, 0
    v_mov_b32 v111, 0
    v_mov_b32 v112, 0
    v_mov_b32 v113, 0
    v_mov_b32 v114, 0
    v_mov_b32 v115, 0
    v_mov_b32 v116, 0
    v_mov_b32 v117, 0
    v_mov_b32 v118, 0
    v_mov_b32 v119, 0
    v_mov_b32 v120, 0
    v_mov_b32 v121, 0
    v_mov_b32 v122, 0
    v_mov_b32 v123, 0
    v_mov_b32 v124, 0
    v_mov_b32 v125, 0
    v_mov_b32 v126, 0
    v_mov_b32 v127, 0
    v_mov_b32 v128, 0
    v_mov_b32 v129, 0
    v_mov_b32 v130, 0
    v_mov_b32 v131, 0
    v_mov_b32 v132, 0
    v_mov_b32 v133, 0
    v_mov_b32 v134, 0
    v_mov_b32 v135, 0
    v_mov_b32 v136, 0
    v_mov_b32 v137, 0
    v_mov_b32 v138, 0
    v_mov_b32 v139, 0
    v_mov_b32 v140, 0
    v_mov_b32 v141, 0
    v_mov_b32 v142, 0
    v_mov_b32 v143, 0
    v_mov_b32 v144, 0
    v_mov_b32 v145, 0
    v_mov_b32 v146, 0
    v_mov_b32 v147, 0
    v_mov_b32 v148, 0
    v_mov_b32 v149, 0
    v_mov_b32 v150, 0
    v_mov_b32 v151, 0
    v_mov_b32 v152, 0
    v_mov_b32 v153, 0
    v_mov_b32 v154, 0
    v_mov_b32 v155, 0
    v_mov_b32 v156, 0
    v_mov_b32 v157, 0
    v_mov_b32 v158, 0
    v_mov_b32 v159, 0
    v_mov_b32 v160, 0
    v_mov_b32 v161, 0
    v_mov_b32 v162, 0
    v_mov_b32 v163, 0
    v_mov_b32 v164, 0
    v_mov_b32 v165, 0
    v_mov_b32 v166, 0
    v_mov_b32 v167, 0
    s_mov_b32 s40, s2
    s_add_u32 s42, s2, 256
    s_mov_b32 s41, 129024
    s_barrier
L_f_loop:
    s_barrier
    v_mov_b32 v254, s41
    ds_read_b32 v255, v254
    s_xor_b32 s41, s41, 4
    s_mov_b32 s40, s42
    s_waitcnt lgkmcnt(0)
    v_readfirstlane_b32 s42, v255
    s_cmp_lt_u32 s40, 1696
    s_cbranch_scc1 L_f_loop
    s_barrier
    s_barrier
    ds_read_b64_tr_b16 v[176:177], v248 offset:0
    ds_read_b64_tr_b16 v[178:179], v248 offset:1024
    ds_read_b64_tr_b16 v[180:181], v249 offset:0
    ds_read_b64_tr_b16 v[182:183], v249 offset:1024
    ds_read_b64_tr_b16 v[184:185], v248 offset:8192
    ds_read_b64_tr_b16 v[186:187], v248 offset:9216
    ds_read_b64_tr_b16 v[188:189], v249 offset:8192
    ds_read_b64_tr_b16 v[190:191], v249 offset:9216
    ds_read_b128 v[216:219], v250 offset:16384
    ds_read_b128 v[220:223], v250 offset:27648
    ds_read_b128 v[224:227], v250 offset:17408
    ds_read_b128 v[228:231], v250 offset:28672
    s_waitcnt lgkmcnt(4)
    v_xor_b32 v208, 0x80008000, v184
    v_xor_b32 v209, 0x80008000, v185
    v_xor_b32 v210, 0x80008000, v186
    v_xor_b32 v211, 0x80008000, v187
    v_xor_b32 v212, 0x80008000, v188
    v_xor_b32 v213, 0x80008000, v189
    v_xor_b32 v214, 0x80008000, v190
    v_xor_b32 v215, 0x80008000, v191
    s_mov_b32 s46, 7
L_g_loop:
    s_barrier
    s_waitcnt lgkmcnt(2)
    v_mfma_f32_16x16x32_bf16 v[0:3], v[176:179], v[216:219], v[0:3]
    ds_read_b128 v[232:235], v250 offset:18432
    ds_read_b128 v[236:239], v250 offset:29696
    v_mfma_f32_16x16x32_bf16 v[4:7], v[180:183], v[216:219], v[4:7]
    v_mfma_f32_16x16x32_bf16 v[8:11], v[208:211], v[216:219], v[8:11]
    v_mfma_f32_16x16x32_bf16 v[12:15], v[212:215], v[216:219], v[12:15]
    v_mfma_f32_16x16x32_bf16 v[0:3], v[184:187], v[220:223], v[0:3]
    v_mfma_f32_16x16x32_bf16 v[4:7], v[188:191], v[220:223], v[4:7]
    v_mfma_f32_16x16x32_bf16 v[8:11], v[176:179], v[220:223], v[8:11]
    v_mfma_f32_16x16x32_bf16 v[12:15], v[180:183], v[220:223], v[12:15]
    s_waitcnt lgkmcnt(2)
    v_mfma_f32_16x16x32_bf16 v[16:19], v[176:179], v[224:227], v[16:19]
    ds_read_b128 v[240:243], v250 offset:19456
    ds_read_b128 v[244:247], v250 offset:30720
    v_mfma_f32_16x16x32_bf16 v[20:23], v[180:183], v[224:227], v[20:23]
    v_mfma_f32_16x16x32_bf16 v[24:27], v[208:211], v[224:227], v[24:27]
    v_mfma_f32_16x16x32_bf16 v[28:31], v[212:215], v[224:227], v[28:31]
    v_mfma_f32_16x16x32_bf16 v[16:19], v[184:187], v[228:231], v[16:19]
    v_mfma_f32_16x16x32_bf16 v[20:23], v[188:191], v[228:231], v[20:23]
    v_mfma_f32_16x16x32_bf16 v[24:27], v[176:179], v[228:231], v[24:27]
    v_mfma_f32_16x16x32_bf16 v[28:31], v[180:183], v[228:231], v[28:31]
    s_waitcnt lgkmcnt(2)
    v_mfma_f32_16x16x32_bf16 v[32:35], v[176:179], v[232:235], v[32:35]
    ds_read_b128 v[216:219], v250 offset:20480
    ds_read_b128 v[220:223], v250 offset:31744
    v_mfma_f32_16x16x32_bf16 v[36:39], v[180:183], v[232:235], v[36:39]
    v_mfma_f32_16x16x32_bf16 v[40:43], v[208:211], v[232:235], v[40:43]
    v_mfma_f32_16x16x32_bf16 v[44:47], v[212:215], v[232:235], v[44:47]
    v_mfma_f32_16x16x32_bf16 v[32:35], v[184:187], v[236:239], v[32:35]
    v_mfma_f32_16x16x32_bf16 v[36:39], v[188:191], v[236:239], v[36:39]
    v_mfma_f32_16x16x32_bf16 v[40:43], v[176:179], v[236:239], v[40:43]
    v_mfma_f32_16x16x32_bf16 v[44:47], v[180:183], v[236:239], v[44:47]
    s_waitcnt lgkmcnt(2)
    v_mfma_f32_16x16x32_bf16 v[48:51], v[176:179], v[240:243], v[48:51]
    ds_read_b128 v[224:227], v250 offset:21504
    ds_read_b128 v[228:231], v250 offset:32768
    v_mfma_f32_16x16x32_bf16 v[52:55], v[180:183], v[240:243], v[52:55]
    v_mfma_f32_16x16x32_bf16 v[56:59], v[208:211], v[240:243], v[56:59]
    v_mfma_f32_16x16x32_bf16 v[60:63], v[212:215], v[240:243], v[60:63]
    v_mfma_f32_16x16x32_bf16 v[48:51], v[184:187], v[244:247], v[48:51]
    v_mfma_f32_16x16x32_bf16 v[52:55], v[188:191], v[244:247], v[52:55]
    v_mfma_f32_16x16x32_bf16 v[56:59], v[176:179], v[244:247], v[56:59]
    v_mfma_f32_16x16x32_bf16 v[60:63], v[180:183], v[244:247], v[60:63]
    s_waitcnt lgkmcnt(2)
    v_mfma_f32_16x16x32_bf16 v[64:67], v[176:179], v[216:219], v[64:67]
    ds_read_b128 v[232:235], v250 offset:22528
    ds_read_b128 v[236:239], v250 offset:33792
    v_mfma_f32_16x16x32_bf16 v[68:71], v[180:183], v[216:219], v[68:71]
    v_mfma_f32_16x16x32_bf16 v[72:75], v[208:211], v[216:219], v[72:75]
    v_mfma_f32_16x16x32_bf16 v[76:79], v[212:215], v[216:219], v[76:79]
    v_mfma_f32_16x16x32_bf16 v[64:67], v[184:187], v[220:223], v[64:67]
    v_mfma_f32_16x16x32_bf16 v[68:71], v[188:191], v[220:223], v[68:71]
    v_mfma_f32_16x16x32_bf16 v[72:75], v[176:179], v[220:223], v[72:75]
    v_mfma_f32_16x16x32_bf16 v[76:79], v[180:183], v[220:223], v[76:79]
    s_waitcnt lgkmcnt(2)
    v_mfma_f32_16x16x32_bf16 v[80:83], v[176:179], v[224:227], v[80:83]
    ds_read_b128 v[240:243], v250 offset:23552
    ds_read_b128 v[244:247], v250 offset:34816
    v_mfma_f32_16x16x32_bf16 v[84:87], v[180:183], v[224:227], v[84:87]
    v_mfma_f32_16x16x32_bf16 v[88:91], v[208:211], v[224:227], v[88:91]
    v_mfma_f32_16x16x32_bf16 v[92:95], v[212:215], v[224:227], v[92:95]
    v_mfma_f32_16x16x32_bf16 v[80:83], v[184:187], v[228:231], v[80:83]
    v_add_u32 v248, 0x9800, v248
    v_add_u32 v249, 0x9800, v249
    v_mfma_f32_16x16x32_bf16 v[84:87], v[188:191], v[228:231], v[84:87]
    v_mfma_f32_16x16x32_bf16 v[88:91], v[176:179], v[228:231], v[88:91]
    v_mfma_f32_16x16x32_bf16 v[92:95], v[180:183], v[228:231], v[92:95]
    s_waitcnt lgkmcnt(2)
    v_mfma_f32_16x16x32_bf16 v[96:99], v[176:179], v[232:235], v[96:99]
    ds_read_b128 v[216:219], v250 offset:24576
    ds_read_b128 v[220:223], v250 offset:35840
    v_mfma_f32_16x16x32_bf16 v[100:103], v[180:183], v[232:235], v[100:103]
    v_mfma_f32_16x16x32_bf16 v[104:107], v[208:211], v[232:235], v[104:107]
    v_mfma_f32_16x16x32_bf16 v[108:111], v[212:215], v[232:235], v[108:111]
    ds_read_b64_tr_b16 v[192:193], v248 offset:0
    ds_read_b64_tr_b16 v[194:195], v248 offset:1024
    ds_read_b64_tr_b16 v[196:197], v249 offset:0
    ds_read_b64_tr_b16 v[198:199], v249 offset:1024
    v_mfma_f32_16x16x32_bf16 v[96:99], v[184:187], v[236:239], v[96:99]
    v_mfma_f32_16x16x32_bf16 v[100:103], v[188:191], v[236:239], v[100:103]
    v_mfma_f32_16x16x32_bf16 v[104:107], v[176:179], v[236:239], v[104:107]
    v_mfma_f32_16x16x32_bf16 v[108:111], v[180:183], v[236:239], v[108:111]
    s_waitcnt lgkmcnt(6)
    v_mfma_f32_16x16x32_bf16 v[112:115], v[176:179], v[240:243], v[112:115]
    ds_read_b128 v[224:227], v250 offset:25600
    ds_read_b128 v[228:231], v250 offset:36864
    v_mfma_f32_16x16x32_bf16 v[116:119], v[180:183], v[240:243], v[116:119]
    v_mfma_f32_16x16x32_bf16 v[120:123], v[208:211], v[240:243], v[120:123]
    v_mfma_f32_16x16x32_bf16 v[124:127], v[212:215], v[240:243], v[124:127]
    ds_read_b64_tr_b16 v[200:201], v248 offset:8192
    ds_read_b64_tr_b16 v[202:203], v248 offset:9216
    ds_read_b64_tr_b16 v[204:205], v249 offset:8192
    ds_read_b64_tr_b16 v[206:207], v249 offset:9216
    v_mfma_f32_16x16x32_bf16 v[112:115], v[184:187], v[244:247], v[112:115]
    v_mfma_f32_16x16x32_bf16 v[116:119], v[188:191], v[244:247], v[116:119]
    v_mfma_f32_16x16x32_bf16 v[120:123], v[176:179], v[244:247], v[120:123]
    v_mfma_f32_16x16x32_bf16 v[124:127], v[180:183], v[244:247], v[124:127]
    s_waitcnt lgkmcnt(10)
    v_mfma_f32_16x16x32_bf16 v[128:131], v[176:179], v[216:219], v[128:131]
    ds_read_b128 v[232:235], v250 offset:26624
    ds_read_b128 v[236:239], v250 offset:37888
    v_mfma_f32_16x16x32_bf16 v[132:135], v[180:183], v[216:219], v[132:135]
    v_mfma_f32_16x16x32_bf16 v[136:139], v[208:211], v[216:219], v[136:139]
    v_mfma_f32_16x16x32_bf16 v[140:143], v[212:215], v[216:219], v[140:143]
    v_mfma_f32_16x16x32_bf16 v[128:131], v[184:187], v[220:223], v[128:131]
    v_mfma_f32_16x16x32_bf16 v[132:135], v[188:191], v[220:223], v[132:135]
    v_mfma_f32_16x16x32_bf16 v[136:139], v[176:179], v[220:223], v[136:139]
    v_mfma_f32_16x16x32_bf16 v[140:143], v[180:183], v[220:223], v[140:143]
    s_waitcnt lgkmcnt(6)
    v_mfma_f32_16x16x32_bf16 v[144:147], v[176:179], v[224:227], v[144:147]
    v_add_u32 v250, 0x9800, v250
    ds_read_b128 v[240:243], v250 offset:16384
    ds_read_b128 v[244:247], v250 offset:27648
    v_mfma_f32_16x16x32_bf16 v[148:151], v[180:183], v[224:227], v[148:151]
    v_mfma_f32_16x16x32_bf16 v[152:155], v[208:211], v[224:227], v[152:155]
    v_mfma_f32_16x16x32_bf16 v[156:159], v[212:215], v[224:227], v[156:159]
    v_mfma_f32_16x16x32_bf16 v[144:147], v[184:187], v[228:231], v[144:147]
    s_waitcnt lgkmcnt(4)
    v_xor_b32 v212, 0x80008000, v204
    v_xor_b32 v213, 0x80008000, v205
    v_mfma_f32_16x16x32_bf16 v[148:151], v[188:191], v[228:231], v[148:151]
    v_xor_b32 v214, 0x80008000, v206
    v_xor_b32 v215, 0x80008000, v207
    v_mfma_f32_16x16x32_bf16 v[152:155], v[176:179], v[228:231], v[152:155]
    v_mfma_f32_16x16x32_bf16 v[156:159], v[180:183], v[228:231], v[156:159]
    s_waitcnt lgkmcnt(2)
    v_mfma_f32_16x16x32_bf16 v[160:163], v[176:179], v[232:235], v[160:163]
    ds_read_b128 v[216:219], v250 offset:17408
    ds_read_b128 v[220:223], v250 offset:28672
    v_mfma_f32_16x16x32_bf16 v[164:167], v[208:211], v[232:235], v[164:167]
    v_xor_b32 v208, 0x80008000, v200
    v_xor_b32 v209, 0x80008000, v201
    v_mfma_f32_16x16x32_bf16 v[160:163], v[184:187], v[236:239], v[160:163]
    v_xor_b32 v210, 0x80008000, v202
    v_xor_b32 v211, 0x80008000, v203
    v_mfma_f32_16x16x32_bf16 v[164:167], v[176:179], v[236:239], v[164:167]
    s_barrier
    s_waitcnt lgkmcnt(2)
    v_mfma_f32_16x16x32_bf16 v[0:3], v[192:195], v[240:243], v[0:3]
    ds_read_b128 v[224:227], v250 offset:18432
    ds_read_b128 v[228:231], v250 offset:29696
    v_mfma_f32_16x16x32_bf16 v[4:7], v[196:199], v[240:243], v[4:7]
    v_mfma_f32_16x16x32_bf16 v[8:11], v[208:211], v[240:243], v[8:11]
    v_mfma_f32_16x16x32_bf16 v[12:15], v[212:215], v[240:243], v[12:15]
    v_mfma_f32_16x16x32_bf16 v[0:3], v[200:203], v[244:247], v[0:3]
    v_mfma_f32_16x16x32_bf16 v[4:7], v[204:207], v[244:247], v[4:7]
    v_mfma_f32_16x16x32_bf16 v[8:11], v[192:195], v[244:247], v[8:11]
    v_mfma_f32_16x16x32_bf16 v[12:15], v[196:199], v[244:247], v[12:15]
    s_waitcnt lgkmcnt(2)
    v_mfma_f32_16x16x32_bf16 v[16:19], v[192:195], v[216:219], v[16:19]
    ds_read_b128 v[232:235], v250 offset:19456
    ds_read_b128 v[236:239], v250 offset:30720
    v_mfma_f32_16x16x32_bf16 v[20:23], v[196:199], v[216:219], v[20:23]
    v_mfma_f32_16x16x32_bf16 v[24:27], v[208:211], v[216:219], v[24:27]
    v_mfma_f32_16x16x32_bf16 v[28:31], v[212:215], v[216:219], v[28:31]
    v_mfma_f32_16x16x32_bf16 v[16:19], v[200:203], v[220:223], v[16:19]
    v_mfma_f32_16x16x32_bf16 v[20:23], v[204:207], v[220:223], v[20:23]
    v_mfma_f32_16x16x32_bf16 v[24:27], v[192:195], v[220:223], v[24:27]
    v_mfma_f32_16x16x32_bf16 v[28:31], v[196:199], v[220:223], v[28:31]
    s_waitcnt lgkmcnt(2)
    v_mfma_f32_16x16x32_bf16 v[32:35], v[192:195], v[224:227], v[32:35]
    ds_read_b128 v[240:243], v250 offset:20480
    ds_read_b128 v[244:247], v250 offset:31744
    v_mfma_f32_16x16x32_bf16 v[36:39], v[196:199], v[224:227], v[36:39]
    v_mfma_f32_16x16x32_bf16 v[40:43], v[208:211], v[224:227], v[40:43]
    v_mfma_f32_16x16x32_bf16 v[44:47], v[212:215], v[224:227], v[44:47]
    v_mfma_f32_16x16x32_bf16 v[32:35], v[200:203], v[228:231], v[32:35]
    v_mfma_f32_16x16x32_bf16 v[36:39], v[204:207], v[228:231], v[36:39]
    v_mfma_f32_16x16x32_bf16 v[40:43], v[192:195], v[228:231], v[40:43]
    v_mfma_f32_16x16x32_bf16 v[44:47], v[196:199], v[228:231], v[44:47]
    s_waitcnt lgkmcnt(2)
    v_mfma_f32_16x16x32_bf16 v[48:51], v[192:195], v[232:235], v[48:51]
    ds_read_b128 v[216:219], v250 offset:21504
    ds_read_b128 v[220:223], v250 offset:32768
    v_mfma_f32_16x16x32_bf16 v[52:55], v[196:199], v[232:235], v[52:55]
    v_mfma_f32_16x16x32_bf16 v[56:59], v[208:211], v[232:235], v[56:59]
    v_mfma_f32_16x16x32_bf16 v[60:63], v[212:215], v[232:235], v[60:63]
    v_mfma_f32_16x16x32_bf16 v[48:51], v[200:203], v[236:239], v[48:51]
    v_mfma_f32_16x16x32_bf16 v[52:55], v[204:207], v[236:239], v[52:55]
    v_mfma_f32_16x16x32_bf16 v[56:59], v[192:195], v[236:239], v[56:59]
    v_mfma_f32_16x16x32_bf16 v[60:63], v[196:199], v[236:239], v[60:63]
    s_waitcnt lgkmcnt(2)
    v_mfma_f32_16x16x32_bf16 v[64:67], v[192:195], v[240:243], v[64:67]
    ds_read_b128 v[224:227], v250 offset:22528
    ds_read_b128 v[228:231], v250 offset:33792
    v_mfma_f32_16x16x32_bf16 v[68:71], v[196:199], v[240:243], v[68:71]
    v_mfma_f32_16x16x32_bf16 v[72:75], v[208:211], v[240:243], v[72:75]
    v_mfma_f32_16x16x32_bf16 v[76:79], v[212:215], v[240:243], v[76:79]
    v_mfma_f32_16x16x32_bf16 v[64:67], v[200:203], v[244:247], v[64:67]
    v_mfma_f32_16x16x32_bf16 v[68:71], v[204:207], v[244:247], v[68:71]
    v_mfma_f32_16x16x32_bf16 v[72:75], v[192:195], v[244:247], v[72:75]
    v_mfma_f32_16x16x32_bf16 v[76:79], v[196:199], v[244:247], v[76:79]
    s_waitcnt lgkmcnt(2)
    v_mfma_f32_16x16x32_bf16 v[80:83], v[192:195], v[216:219], v[80:83]
    ds_read_b128 v[232:235], v250 offset:23552
    ds_read_b128 v[236:239], v250 offset:34816
    v_mfma_f32_16x16x32_bf16 v[84:87], v[196:199], v[216:219], v[84:87]
    v_mfma_f32_16x16x32_bf16 v[88:91], v[208:211], v[216:219], v[88:91]
    v_mfma_f32_16x16x32_bf16 v[92:95], v[212:215], v[216:219], v[92:95]
    v_mfma_f32_16x16x32_bf16 v[80:83], v[200:203], v[220:223], v[80:83]
    v_add_u32 v248, 0x9800, v248
    v_add_u32 v249, 0x9800, v249
    v_mfma_f32_16x16x32_bf16 v[84:87], v[204:207], v[220:223], v[84:87]
    v_mfma_f32_16x16x32_bf16 v[88:91], v[192:195], v[220:223], v[88:91]
    v_mfma_f32_16x16x32_bf16 v[92:95], v[196:199], v[220:223], v[92:95]
    s_waitcnt lgkmcnt(2)
    v_mfma_f32_16x16x32_bf16 v[96:99], v[192:195], v[224:227], v[96:99]
    ds_read_b128 v[240:243], v250 offset:24576
    ds_read_b128 v[244:247], v250 offset:35840
    v_mfma_f32_16x16x32_bf16 v[100:103], v[196:199], v[224:227], v[100:103]
    v_mfma_f32_16x16x32_bf16 v[104:107], v[208:211], v[224:227], v[104:107]
    v_mfma_f32_16x16x32_bf16 v[108:111], v[212:215], v[224:227], v[108:111]
    ds_read_b64_tr_b16 v[176:177], v248 offset:0
    ds_read_b64_tr_b16 v[178:179], v248 offset:1024
    ds_read_b64_tr_b16 v[180:181], v249 offset:0
    ds_read_b64_tr_b16 v[182:183], v249 offset:1024
    v_mfma_f32_16x16x32_bf16 v[96:99], v[200:203], v[228:231], v[96:99]
    v_mfma_f32_16x16x32_bf16 v[100:103], v[204:207], v[228:231], v[100:103]
    v_mfma_f32_16x16x32_bf16 v[104:107], v[192:195], v[228:231], v[104:107]
    v_mfma_f32_16x16x32_bf16 v[108:111], v[196:199], v[228:231], v[108:111]
    s_waitcnt lgkmcnt(6)
    v_mfma_f32_16x16x32_bf16 v[112:115], v[192:195], v[232:235], v[112:115]
    ds_read_b128 v[216:219], v250 offset:25600
    ds_read_b128 v[220:223], v250 offset:36864
    v_mfma_f32_16x16x32_bf16 v[116:119], v[196:199], v[232:235], v[116:119]
    v_mfma_f32_16x16x32_bf16 v[120:123], v[208:211], v[232:235], v[120:123]
    v_mfma_f32_16x16x32_bf16 v[124:127], v[212:215], v[232:235], v[124:127]
    ds_read_b64_tr_b16 v[184:185], v248 offset:8192
    ds_read_b64_tr_b16 v[186:187], v248 offset:9216
    ds_read_b64_tr_b16 v[188:189], v249 offset:8192
    ds_read_b64_tr_b16 v[190:191], v249 offset:9216
    v_mfma_f32_16x16x32_bf16 v[112:115], v[200:203], v[236:239], v[112:115]
    v_mfma_f32_16x16x32_bf16 v[116:119], v[204:207], v[236:239], v[116:119]
    v_mfma_f32_16x16x32_bf16 v[120:123], v[192:195], v[236:239], v[120:123]
    v_mfma_f32_16x16x32_bf16 v[124:127], v[196:199], v[236:239], v[124:127]
    s_waitcnt lgkmcnt(10)
    v_mfma_f32_16x16x32_bf16 v[128:131], v[192:195], v[240:243], v[128:131]
    ds_read_b128 v[224:227], v250 offset:26624
    ds_read_b128 v[228:231], v250 offset:37888
    v_mfma_f32_16x16x32_bf16 v[132:135], v[196:199], v[240:243], v[132:135]
    v_mfma_f32_16x16x32_bf16 v[136:139], v[208:211], v[240:243], v[136:139]
    v_mfma_f32_16x16x32_bf16 v[140:143], v[212:215], v[240:243], v[140:143]
    v_mfma_f32_16x16x32_bf16 v[128:131], v[200:203], v[244:247], v[128:131]
    v_mfma_f32_16x16x32_bf16 v[132:135], v[204:207], v[244:247], v[132:135]
    v_mfma_f32_16x16x32_bf16 v[136:139], v[192:195], v[244:247], v[136:139]
    v_mfma_f32_16x16x32_bf16 v[140:143], v[196:199], v[244:247], v[140:143]
    s_waitcnt lgkmcnt(6)
    v_mfma_f32_16x16x32_bf16 v[144:147], v[192:195], v[216:219], v[144:147]
    v_add_u32 v250, 0x9800, v250
    ds_read_b128 v[232:235], v250 offset:16384
    ds_read_b128 v[236:239], v250 offset:27648
    v_mfma_f32_16x16x32_bf16 v[148:151], v[196:199], v[216:219], v[148:151]
    v_mfma_f32_16x16x32_bf16 v[152:155], v[208:211], v[216:219], v[152:155]
    v_mfma_f32_16x16x32_bf16 v[156:159], v[212:215], v[216:219], v[156:159]
    v_mfma_f32_16x16x32_bf16 v[144:147], v[200:203], v[220:223], v[144:147]
    s_waitcnt lgkmcnt(4)
    v_xor_b32 v212, 0x80008000, v188
    v_xor_b32 v213, 0x80008000, v189
    v_mfma_f32_16x16x32_bf16 v[148:151], v[204:207], v[220:223], v[148:151]
    v_xor_b32 v214, 0x80008000, v190
    v_xor_b32 v215, 0x80008000, v191
    v_mfma_f32_16x16x32_bf16 v[152:155], v[192:195], v[220:223], v[152:155]
    v_mfma_f32_16x16x32_bf16 v[156:159], v[196:199], v[220:223], v[156:159]
    s_waitcnt lgkmcnt(2)
    v_mfma_f32_16x16x32_bf16 v[160:163], v[192:195], v[224:227], v[160:163]
    ds_read_b128 v[240:243], v250 offset:17408
    ds_read_b128 v[244:247], v250 offset:28672
    v_mfma_f32_16x16x32_bf16 v[164:167], v[208:211], v[224:227], v[164:167]
    v_xor_b32 v208, 0x80008000, v184
    v_xor_b32 v209, 0x80008000, v185
    v_mfma_f32_16x16x32_bf16 v[160:163], v[200:203], v[228:231], v[160:163]
    v_xor_b32 v210, 0x80008000, v186
    v_xor_b32 v211, 0x80008000, v187
    v_mfma_f32_16x16x32_bf16 v[164:167], v[192:195], v[228:231], v[164:167]
    s_barrier
    s_waitcnt lgkmcnt(2)
    v_mfma_f32_16x16x32_bf16 v[0:3], v[176:179], v[232:235], v[0:3]
    ds_read_b128 v[216:219], v250 offset:18432
    ds_read_b128 v[220:223], v250 offset:29696
    v_mfma_f32_16x16x32_bf16 v[4:7], v[180:183], v[232:235], v[4:7]
    v_mfma_f32_16x16x32_bf16 v[8:11], v[208:211], v[232:235], v[8:11]
    v_mfma_f32_16x16x32_bf16 v[12:15], v[212:215], v[232:235], v[12:15]
    v_mfma_f32_16x16x32_bf16 v[0:3], v[184:187], v[236:239], v[0:3]
    v_mfma_f32_16x16x32_bf16 v[4:7], v[188:191], v[236:239], v[4:7]
    v_mfma_f32_16x16x32_bf16 v[8:11], v[176:179], v[236:239], v[8:11]
    v_mfma_f32_16x16x32_bf16 v[12:15], v[180:183], v[236:239], v[12:15]
    s_waitcnt lgkmcnt(2)
    v_mfma_f32_16x16x32_bf16 v[16:19], v[176:179], v[240:243], v[16:19]
    ds_read_b128 v[224:227], v250 offset:19456
    ds_read_b128 v[228:231], v250 offset:30720
    v_mfma_f32_16x16x32_bf16 v[20:23], v[180:183], v[240:243], v[20:23]
    v_mfma_f32_16x16x32_bf16 v[24:27], v[208:211], v[240:243], v[24:27]
    v_mfma_f32_16x16x32_bf16 v[28:31], v[212:215], v[240:243], v[28:31]
    v_mfma_f32_16x16x32_bf16 v[16:19], v[184:187], v[244:247], v[16:19]
    v_mfma_f32_16x16x32_bf16 v[20:23], v[188:191], v[244:247], v[20:23]
    v_mfma_f32_16x16x32_bf16 v[24:27], v[176:179], v[244:247], v[24:27]
    v_mfma_f32_16x16x32_bf16 v[28:31], v[180:183], v[244:247], v[28:31]
    s_waitcnt lgkmcnt(2)
    v_mfma_f32_16x16x32_bf16 v[32:35], v[176:179], v[216:219], v[32:35]
    ds_read_b128 v[232:235], v250 offset:20480
    ds_read_b128 v[236:239], v250 offset:31744
    v_mfma_f32_16x16x32_bf16 v[36:39], v[180:183], v[216:219], v[36:39]
    v_mfma_f32_16x16x32_bf16 v[40:43], v[208:211], v[216:219], v[40:43]
    v_mfma_f32_16x16x32_bf16 v[44:47], v[212:215], v[216:219], v[44:47]
    v_mfma_f32_16x16x32_bf16 v[32:35], v[184:187], v[220:223], v[32:35]
    v_mfma_f32_16x16x32_bf16 v[36:39], v[188:191], v[220:223], v[36:39]
    v_mfma_f32_16x16x32_bf16 v[40:43], v[176:179], v[220:223], v[40:43]
    v_mfma_f32_16x16x32_bf16 v[44:47], v[180:183], v[220:223], v[44:47]
    s_waitcnt lgkmcnt(2)
    v_mfma_f32_16x16x32_bf16 v[48:51], v[176:179], v[224:227], v[48:51]
    ds_read_b128 v[240:243], v250 offset:21504
    ds_read_b128 v[244:247], v250 offset:32768
    v_mfma_f32_16x16x32_bf16 v[52:55], v[180:183], v[224:227], v[52:55]
    v_mfma_f32_16x16x32_bf16 v[56:59], v[208:211], v[224:227], v[56:59]
    v_mfma_f32_16x16x32_bf16 v[60:63], v[212:215], v[224:227], v[60:63]
    v_mfma_f32_16x16x32_bf16 v[48:51], v[184:187], v[228:231], v[48:51]
    v_mfma_f32_16x16x32_bf16 v[52:55], v[188:191], v[228:231], v[52:55]
    v_mfma_f32_16x16x32_bf16 v[56:59], v[176:179], v[228:231], v[56:59]
    v_mfma_f32_16x16x32_bf16 v[60:63], v[180:183], v[228:231], v[60:63]
    s_waitcnt lgkmcnt(2)
    v_mfma_f32_16x16x32_bf16 v[64:67], v[176:179], v[232:235], v[64:67]
    ds_read_b128 v[216:219], v250 offset:22528
    ds_read_b128 v[220:223], v250 offset:33792
    v_mfma_f32_16x16x32_bf16 v[68:71], v[180:183], v[232:235], v[68:71]
    v_mfma_f32_16x16x32_bf16 v[72:75], v[208:211], v[232:235], v[72:75]
    v_mfma_f32_16x16x32_bf16 v[76:79], v[212:215], v[232:235], v[76:79]
    v_mfma_f32_16x16x32_bf16 v[64:67], v[184:187], v[236:239], v[64:67]
    v_mfma_f32_16x16x32_bf16 v[68:71], v[188:191], v[236:239], v[68:71]
    v_mfma_f32_16x16x32_bf16 v[72:75], v[176:179], v[236:239], v[72:75]
    v_mfma_f32_16x16x32_bf16 v[76:79], v[180:183], v[236:239], v[76:79]
    s_waitcnt lgkmcnt(2)
    v_mfma_f32_16x16x32_bf16 v[80:83], v[176:179], v[240:243], v[80:83]
    ds_read_b128 v[224:227], v250 offset:23552
    ds_read_b128 v[228:231], v250 offset:34816
    v_mfma_f32_16x16x32_bf16 v[84:87], v[180:183], v[240:243], v[84:87]
    v_mfma_f32_16x16x32_bf16 v[88:91], v[208:211], v[240:243], v[88:91]
    v_mfma_f32_16x16x32_bf16 v[92:95], v[212:215], v[240:243], v[92:95]
    v_mfma_f32_16x16x32_bf16 v[80:83], v[184:187], v[244:247], v[80:83]
    v_add_u32 v248, 0x9800, v248
    v_add_u32 v249, 0x9800, v249
    v_mfma_f32_16x16x32_bf16 v[84:87], v[188:191], v[244:247], v[84:87]
    v_mfma_f32_16x16x32_bf16 v[88:91], v[176:179], v[244:247], v[88:91]
    v_mfma_f32_16x16x32_bf16 v[92:95], v[180:183], v[244:247], v[92:95]
    s_waitcnt lgkmcnt(2)
    v_mfma_f32_16x16x32_bf16 v[96:99], v[176:179], v[216:219], v[96:99]
    ds_read_b128 v[232:235], v250 offset:24576
    ds_read_b128 v[236:239], v250 offset:35840
    v_mfma_f32_16x16x32_bf16 v[100:103], v[180:183], v[216:219], v[100:103]
    v_mfma_f32_16x16x32_bf16 v[104:107], v[208:211], v[216:219], v[104:107]
    v_mfma_f32_16x16x32_bf16 v[108:111], v[212:215], v[216:219], v[108:111]
    ds_read_b64_tr_b16 v[192:193], v248 offset:0
    ds_read_b64_tr_b16 v[194:195], v248 offset:1024
    ds_read_b64_tr_b16 v[196:197], v249 offset:0
    ds_read_b64_tr_b16 v[198:199], v249 offset:1024
    v_mfma_f32_16x16x32_bf16 v[96:99], v[184:187], v[220:223], v[96:99]
    v_mfma_f32_16x16x32_bf16 v[100:103], v[188:191], v[220:223], v[100:103]
    v_mfma_f32_16x16x32_bf16 v[104:107], v[176:179], v[220:223], v[104:107]
    v_mfma_f32_16x16x32_bf16 v[108:111], v[180:183], v[220:223], v[108:111]
    s_waitcnt lgkmcnt(6)
    v_mfma_f32_16x16x32_bf16 v[112:115], v[176:179], v[224:227], v[112:115]
    ds_read_b128 v[240:243], v250 offset:25600
    ds_read_b128 v[244:247], v250 offset:36864
    v_mfma_f32_16x16x32_bf16 v[116:119], v[180:183], v[224:227], v[116:119]
    v_mfma_f32_16x16x32_bf16 v[120:123], v[208:211], v[224:227], v[120:123]
    v_mfma_f32_16x16x32_bf16 v[124:127], v[212:215], v[224:227], v[124:127]
    ds_read_b64_tr_b16 v[200:201], v248 offset:8192
    ds_read_b64_tr_b16 v[202:203], v248 offset:9216
    ds_read_b64_tr_b16 v[204:205], v249 offset:8192
    ds_read_b64_tr_b16 v[206:207], v249 offset:9216
    v_mfma_f32_16x16x32_bf16 v[112:115], v[184:187], v[228:231], v[112:115]
    v_mfma_f32_16x16x32_bf16 v[116:119], v[188:191], v[228:231], v[116:119]
    v_mfma_f32_16x16x32_bf16 v[120:123], v[176:179], v[228:231], v[120:123]
    v_mfma_f32_16x16x32_bf16 v[124:127], v[180:183], v[228:231], v[124:127]
    s_waitcnt lgkmcnt(10)
    v_mfma_f32_16x16x32_bf16 v[128:131], v[176:179], v[232:235], v[128:131]
    ds_read_b128 v[216:219], v250 offset:26624
    ds_read_b128 v[220:223], v250 offset:37888
    v_mfma_f32_16x16x32_bf16 v[132:135], v[180:183], v[232:235], v[132:135]
    v_mfma_f32_16x16x32_bf16 v[136:139], v[208:211], v[232:235], v[136:139]
    v_mfma_f32_16x16x32_bf16 v[140:143], v[212:215], v[232:235], v[140:143]
    v_mfma_f32_16x16x32_bf16 v[128:131], v[184:187], v[236:239], v[128:131]
    v_mfma_f32_16x16x32_bf16 v[132:135], v[188:191], v[236:239], v[132:135]
    v_mfma_f32_16x16x32_bf16 v[136:139], v[176:179], v[236:239], v[136:139]
    v_mfma_f32_16x16x32_bf16 v[140:143], v[180:183], v[236:239], v[140:143]
    s_waitcnt lgkmcnt(6)
    v_mfma_f32_16x16x32_bf16 v[144:147], v[176:179], v[240:243], v[144:147]
    v_add_u32 v250, 0x9800, v250
    ds_read_b128 v[224:227], v250 offset:16384
    ds_read_b128 v[228:231], v250 offset:27648
    v_mfma_f32_16x16x32_bf16 v[148:151], v[180:183], v[240:243], v[148:151]
    v_mfma_f32_16x16x32_bf16 v[152:155], v[208:211], v[240:243], v[152:155]
    v_mfma_f32_16x16x32_bf16 v[156:159], v[212:215], v[240:243], v[156:159]
    v_mfma_f32_16x16x32_bf16 v[144:147], v[184:187], v[244:247], v[144:147]
    s_waitcnt lgkmcnt(4)
    v_xor_b32 v212, 0x80008000, v204
    v_xor_b32 v213, 0x80008000, v205
    v_mfma_f32_16x16x32_bf16 v[148:151], v[188:191], v[244:247], v[148:151]
    v_xor_b32 v214, 0x80008000, v206
    v_xor_b32 v215, 0x80008000, v207
    v_mfma_f32_16x16x32_bf16 v[152:155], v[176:179], v[244:247], v[152:155]
    v_mfma_f32_16x16x32_bf16 v[156:159], v[180:183], v[244:247], v[156:159]
    s_waitcnt lgkmcnt(2)
    v_mfma_f32_16x16x32_bf16 v[160:163], v[176:179], v[216:219], v[160:163]
    ds_read_b128 v[232:235], v250 offset:17408
    ds_read_b128 v[236:239], v250 offset:28672
    v_mfma_f32_16x16x32_bf16 v[164:167], v[208:211], v[216:219], v[164:167]
    v_xor_b32 v208, 0x80008000, v200
    v_xor_b32 v209, 0x80008000, v201
    v_mfma_f32_16x16x32_bf16 v[160:163], v[184:187], v[220:223], v[160:163]
    v_xor_b32 v210, 0x80008000, v202
    v_xor_b32 v211, 0x80008000, v203
    v_mfma_f32_16x16x32_bf16 v[164:167], v[176:179], v[220:223], v[164:167]
    s_barrier
    s_waitcnt lgkmcnt(2)
    v_mfma_f32_16x16x32_bf16 v[0:3], v[192:195], v[224:227], v[0:3]
    ds_read_b128 v[240:243], v250 offset:18432
    ds_read_b128 v[244:247], v250 offset:29696
    v_mfma_f32_16x16x32_bf16 v[4:7], v[196:199], v[224:227], v[4:7]
    v_mfma_f32_16x16x32_bf16 v[8:11], v[208:211], v[224:227], v[8:11]
    v_mfma_f32_16x16x32_bf16 v[12:15], v[212:215], v[224:227], v[12:15]
    v_mfma_f32_16x16x32_bf16 v[0:3], v[200:203], v[228:231], v[0:3]
    v_mfma_f32_16x16x32_bf16 v[4:7], v[204:207], v[228:231], v[4:7]
    v_mfma_f32_16x16x32_bf16 v[8:11], v[192:195], v[228:231], v[8:11]
    v_mfma_f32_16x16x32_bf16 v[12:15], v[196:199], v[228:231], v[12:15]
    s_waitcnt lgkmcnt(2)
    v_mfma_f32_16x16x32_bf16 v[16:19], v[192:195], v[232:235], v[16:19]
    ds_read_b128 v[216:219], v250 offset:19456
    ds_read_b128 v[220:223], v250 offset:30720
    v_mfma_f32_16x16x32_bf16 v[20:23], v[196:199], v[232:235], v[20:23]
    v_mfma_f32_16x16x32_bf16 v[24:27], v[208:211], v[232:235], v[24:27]
    v_mfma_f32_16x16x32_bf16 v[28:31], v[212:215], v[232:235], v[28:31]
    v_mfma_f32_16x16x32_bf16 v[16:19], v[200:203], v[236:239], v[16:19]
    v_mfma_f32_16x16x32_bf16 v[20:23], v[204:207], v[236:239], v[20:23]
    v_mfma_f32_16x16x32_bf16 v[24:27], v[192:195], v[236:239], v[24:27]
    v_mfma_f32_16x16x32_bf16 v[28:31], v[196:199], v[236:239], v[28:31]
    s_waitcnt lgkmcnt(2)
    v_mfma_f32_16x16x32_bf16 v[32:35], v[192:195], v[240:243], v[32:35]
    ds_read_b128 v[224:227], v250 offset:20480
    ds_read_b128 v[228:231], v250 offset:31744
    v_mfma_f32_16x16x32_bf16 v[36:39], v[196:199], v[240:243], v[36:39]
    v_mfma_f32_16x16x32_bf16 v[40:43], v[208:211], v[240:243], v[40:43]
    v_mfma_f32_16x16x32_bf16 v[44:47], v[212:215], v[240:243], v[44:47]
    v_mfma_f32_16x16x32_bf16 v[32:35], v[200:203], v[244:247], v[32:35]
    v_mfma_f32_16x16x32_bf16 v[36:39], v[204:207], v[244:247], v[36:39]
    v_mfma_f32_16x16x32_bf16 v[40:43], v[192:195], v[244:247], v[40:43]
    v_mfma_f32_16x16x32_bf16 v[44:47], v[196:199], v[244:247], v[44:47]
    s_waitcnt lgkmcnt(2)
    v_mfma_f32_16x16x32_bf16 v[48:51], v[192:195], v[216:219], v[48:51]
    ds_read_b128 v[232:235], v250 offset:21504
    ds_read_b128 v[236:239], v250 offset:32768
    v_mfma_f32_16x16x32_bf16 v[52:55], v[196:199], v[216:219], v[52:55]
    v_mfma_f32_16x16x32_bf16 v[56:59], v[208:211], v[216:219], v[56:59]
    v_mfma_f32_16x16x32_bf16 v[60:63], v[212:215], v[216:219], v[60:63]
    v_mfma_f32_16x16x32_bf16 v[48:51], v[200:203], v[220:223], v[48:51]
    v_mfma_f32_16x16x32_bf16 v[52:55], v[204:207], v[220:223], v[52:55]
    v_mfma_f32_16x16x32_bf16 v[56:59], v[192:195], v[220:223], v[56:59]
    v_mfma_f32_16x16x32_bf16 v[60:63], v[196:199], v[220:223], v[60:63]
    s_waitcnt lgkmcnt(2)
    v_mfma_f32_16x16x32_bf16 v[64:67], v[192:195], v[224:227], v[64:67]
    ds_read_b128 v[240:243], v250 offset:22528
    ds_read_b128 v[244:247], v250 offset:33792
    v_mfma_f32_16x16x32_bf16 v[68:71], v[196:199], v[224:227], v[68:71]
    v_mfma_f32_16x16x32_bf16 v[72:75], v[208:211], v[224:227], v[72:75]
    v_mfma_f32_16x16x32_bf16 v[76:79], v[212:215], v[224:227], v[76:79]
    v_mfma_f32_16x16x32_bf16 v[64:67], v[200:203], v[228:231], v[64:67]
    v_mfma_f32_16x16x32_bf16 v[68:71], v[204:207], v[228:231], v[68:71]
    v_mfma_f32_16x16x32_bf16 v[72:75], v[192:195], v[228:231], v[72:75]
    v_mfma_f32_16x16x32_bf16 v[76:79], v[196:199], v[228:231], v[76:79]
    s_waitcnt lgkmcnt(2)
    v_mfma_f32_16x16x32_bf16 v[80:83], v[192:195], v[232:235], v[80:83]
    ds_read_b128 v[216:219], v250 offset:23552
    ds_read_b128 v[220:223], v250 offset:34816
    v_mfma_f32_16x16x32_bf16 v[84:87], v[196:199], v[232:235], v[84:87]
    v_mfma_f32_16x16x32_bf16 v[88:91], v[208:211], v[232:235], v[88:91]
    v_mfma_f32_16x16x32_bf16 v[92:95], v[212:215], v[232:235], v[92:95]
    v_mfma_f32_16x16x32_bf16 v[80:83], v[200:203], v[236:239], v[80:83]
    v_add_u32 v248, 0xfffe3800, v248
    v_add_u32 v249, 0xfffe3800, v249
    v_mfma_f32_16x16x32_bf16 v[84:87], v[204:207], v[236:239], v[84:87]
    v_mfma_f32_16x16x32_bf16 v[88:91], v[192:195], v[236:239], v[88:91]
    v_mfma_f32_16x16x32_bf16 v[92:95], v[196:199], v[236:239], v[92:95]
    s_waitcnt lgkmcnt(2)
    v_mfma_f32_16x16x32_bf16 v[96:99], v[192:195], v[240:243], v[96:99]
    ds_read_b128 v[224:227], v250 offset:24576
    ds_read_b128 v[228:231], v250 offset:35840
    v_mfma_f32_16x16x32_bf16 v[100:103], v[196:199], v[240:243], v[100:103]
    v_mfma_f32_16x16x32_bf16 v[104:107], v[208:211], v[240:243], v[104:107]
    v_mfma_f32_16x16x32_bf16 v[108:111], v[212:215], v[240:243], v[108:111]
    ds_read_b64_tr_b16 v[176:177], v248 offset:0
    ds_read_b64_tr_b16 v[178:179], v248 offset:1024
    ds_read_b64_tr_b16 v[180:181], v249 offset:0
    ds_read_b64_tr_b16 v[182:183], v249 offset:1024
    v_mfma_f32_16x16x32_bf16 v[96:99], v[200:203], v[244:247], v[96:99]
    v_mfma_f32_16x16x32_bf16 v[100:103], v[204:207], v[244:247], v[100:103]
    v_mfma_f32_16x16x32_bf16 v[104:107], v[192:195], v[244:247], v[104:107]
    v_mfma_f32_16x16x32_bf16 v[108:111], v[196:199], v[244:247], v[108:111]
    s_waitcnt lgkmcnt(6)
    v_mfma_f32_16x16x32_bf16 v[112:115], v[192:195], v[216:219], v[112:115]
    ds_read_b128 v[232:235], v250 offset:25600
    ds_read_b128 v[236:239], v250 offset:36864
    v_mfma_f32_16x16x32_bf16 v[116:119], v[196:199], v[216:219], v[116:119]
    v_mfma_f32_16x16x32_bf16 v[120:123], v[208:211], v[216:219], v[120:123]
    v_mfma_f32_16x16x32_bf16 v[124:127], v[212:215], v[216:219], v[124:127]
    ds_read_b64_tr_b16 v[184:185], v248 offset:8192
    ds_read_b64_tr_b16 v[186:187], v248 offset:9216
    ds_read_b64_tr_b16 v[188:189], v249 offset:8192
    ds_read_b64_tr_b16 v[190:191], v249 offset:9216
    v_mfma_f32_16x16x32_bf16 v[112:115], v[200:203], v[220:223], v[112:115]
    v_mfma_f32_16x16x32_bf16 v[116:119], v[204:207], v[220:223], v[116:119]
    v_mfma_f32_16x16x32_bf16 v[120:123], v[192:195], v[220:223], v[120:123]
    v_mfma_f32_16x16x32_bf16 v[124:127], v[196:199], v[220:223], v[124:127]
    s_waitcnt lgkmcnt(10)
    v_mfma_f32_16x16x32_bf16 v[128:131], v[192:195], v[224:227], v[128:131]
    ds_read_b128 v[240:243], v250 offset:26624
    ds_read_b128 v[244:247], v250 offset:37888
    v_mfma_f32_16x16x32_bf16 v[132:135], v[196:199], v[224:227], v[132:135]
    v_mfma_f32_16x16x32_bf16 v[136:139], v[208:211], v[224:227], v[136:139]
    v_mfma_f32_16x16x32_bf16 v[140:143], v[212:215], v[224:227], v[140:143]
    v_mfma_f32_16x16x32_bf16 v[128:131], v[200:203], v[228:231], v[128:131]
    v_mfma_f32_16x16x32_bf16 v[132:135], v[204:207], v[228:231], v[132:135]
    v_mfma_f32_16x16x32_bf16 v[136:139], v[192:195], v[228:231], v[136:139]
    v_mfma_f32_16x16x32_bf16 v[140:143], v[196:199], v[228:231], v[140:143]
    s_waitcnt lgkmcnt(6)
    v_mfma_f32_16x16x32_bf16 v[144:147], v[192:195], v[232:235], v[144:147]
    v_add_u32 v250, 0xfffe3800, v250
    ds_read_b128 v[216:219], v250 offset:16384
    ds_read_b128 v[220:223], v250 offset:27648
    v_mfma_f32_16x16x32_bf16 v[148:151], v[196:199], v[232:235], v[148:151]
    v_mfma_f32_16x16x32_bf16 v[152:155], v[208:211], v[232:235], v[152:155]
    v_mfma_f32_16x16x32_bf16 v[156:159], v[212:215], v[232:235], v[156:159]
    v_mfma_f32_16x16x32_bf16 v[144:147], v[200:203], v[236:239], v[144:147]
    s_waitcnt lgkmcnt(4)
    v_xor_b32 v212, 0x80008000, v188
    v_xor_b32 v213, 0x80008000, v189
    v_mfma_f32_16x16x32_bf16 v[148:151], v[204:207], v[236:239], v[148:151]
    v_xor_b32 v214, 0x80008000, v190
    v_xor_b32 v215, 0x80008000, v191
    v_mfma_f32_16x16x32_bf16 v[152:155], v[192:195], v[236:239], v[152:155]
    v_mfma_f32_16x16x32_bf16 v[156:159], v[196:199], v[236:239], v[156:159]
    s_waitcnt lgkmcnt(2)
    v_mfma_f32_16x16x32_bf16 v[160:163], v[192:195], v[240:243], v[160:163]
    ds_read_b128 v[224:227], v250 offset:17408
    ds_read_b128 v[228:231], v250 offset:28672
    v_mfma_f32_16x16x32_bf16 v[164:167], v[208:211], v[240:243], v[164:167]
    v_xor_b32 v208, 0x80008000, v184
    v_xor_b32 v209, 0x80008000, v185
    v_mfma_f32_16x16x32_bf16 v[160:163], v[200:203], v[244:247], v[160:163]
    v_xor_b32 v210, 0x80008000, v186
    v_xor_b32 v211, 0x80008000, v187
    v_mfma_f32_16x16x32_bf16 v[164:167], v[192:195], v[244:247], v[164:167]
    s_sub_u32 s46, s46, 1
    s_cmp_lg_u32 s46, 0
    s_cbranch_scc1 L_g_loop
    s_barrier
    s_waitcnt lgkmcnt(2)
    v_mfma_f32_16x16x32_bf16 v[0:3], v[176:179], v[216:219], v[0:3]
    ds_read_b128 v[232:235], v250 offset:18432
    ds_read_b128 v[236:239], v250 offset:29696
    v_mfma_f32_16x16x32_bf16 v[4:7], v[180:183], v[216:219], v[4:7]
    v_mfma_f32_16x16x32_bf16 v[8:11], v[208:211], v[216:219], v[8:11]
    v_mfma_f32_16x16x32_bf16 v[12:15], v[212:215], v[216:219], v[12:15]
    v_mfma_f32_16x16x32_bf16 v[0:3], v[184:187], v[220:223], v[0:3]
    v_mfma_f32_16x16x32_bf16 v[4:7], v[188:191], v[220:223], v[4:7]
    v_mfma_f32_16x16x32_bf16 v[8:11], v[176:179], v[220:223], v[8:11]
    v_mfma_f32_16x16x32_bf16 v[12:15], v[180:183], v[220:223], v[12:15]
    s_waitcnt lgkmcnt(2)
    v_mfma_f32_16x16x32_bf16 v[16:19], v[176:179], v[224:227], v[16:19]
    ds_read_b128 v[240:243], v250 offset:19456
    ds_read_b128 v[244:247], v250 offset:30720
    v_mfma_f32_16x16x32_bf16 v[20:23], v[180:183], v[224:227], v[20:23]
    v_mfma_f32_16x16x32_bf16 v[24:27], v[208:211], v[224:227], v[24:27]
    v_mfma_f32_16x16x32_bf16 v[28:31], v[212:215], v[224:227], v[28:31]
    v_mfma_f32_16x16x32_bf16 v[16:19], v[184:187], v[228:231], v[16:19]
    v_mfma_f32_16x16x32_bf16 v[20:23], v[188:191], v[228:231], v[20:23]
    v_mfma_f32_16x16x32_bf16 v[24:27], v[176:179], v[228:231], v[24:27]
    v_mfma_f32_16x16x32_bf16 v[28:31], v[180:183], v[228:231], v[28:31]
    s_waitcnt lgkmcnt(2)
    v_mfma_f32_16x16x32_bf16 v[32:35], v[176:179], v[232:235], v[32:35]
    ds_read_b128 v[216:219], v250 offset:20480
    ds_read_b128 v[220:223], v250 offset:31744
    v_mfma_f32_16x16x32_bf16 v[36:39], v[180:183], v[232:235], v[36:39]
    v_mfma_f32_16x16x32_bf16 v[40:43], v[208:211], v[232:235], v[40:43]
    v_mfma_f32_16x16x32_bf16 v[44:47], v[212:215], v[232:235], v[44:47]
    v_mfma_f32_16x16x32_bf16 v[32:35], v[184:187], v[236:239], v[32:35]
    v_mfma_f32_16x16x32_bf16 v[36:39], v[188:191], v[236:239], v[36:39]
    v_mfma_f32_16x16x32_bf16 v[40:43], v[176:179], v[236:239], v[40:43]
    v_mfma_f32_16x16x32_bf16 v[44:47], v[180:183], v[236:239], v[44:47]
    s_waitcnt lgkmcnt(2)
    v_mfma_f32_16x16x32_bf16 v[48:51], v[176:179], v[240:243], v[48:51]
    ds_read_b128 v[224:227], v250 offset:21504
    ds_read_b128 v[228:231], v250 offset:32768
    v_mfma_f32_16x16x32_bf16 v[52:55], v[180:183], v[240:243], v[52:55]
    v_mfma_f32_16x16x32_bf16 v[56:59], v[208:211], v[240:243], v[56:59]
    v_mfma_f32_16x16x32_bf16 v[60:63], v[212:215], v[240:243], v[60:63]
    v_mfma_f32_16x16x32_bf16 v[48:51], v[184:187], v[244:247], v[48:51]
    v_mfma_f32_16x16x32_bf16 v[52:55], v[188:191], v[244:247], v[52:55]
    v_mfma_f32_16x16x32_bf16 v[56:59], v[176:179], v[244:247], v[56:59]
    v_mfma_f32_16x16x32_bf16 v[60:63], v[180:183], v[244:247], v[60:63]
    s_waitcnt lgkmcnt(2)
    v_mfma_f32_16x16x32_bf16 v[64:67], v[176:179], v[216:219], v[64:67]
    ds_read_b128 v[232:235], v250 offset:22528
    ds_read_b128 v[236:239], v250 offset:33792
    v_mfma_f32_16x16x32_bf16 v[68:71], v[180:183], v[216:219], v[68:71]
    v_mfma_f32_16x16x32_bf16 v[72:75], v[208:211], v[216:219], v[72:75]
    v_mfma_f32_16x16x32_bf16 v[76:79], v[212:215], v[216:219], v[76:79]
    v_mfma_f32_16x16x32_bf16 v[64:67], v[184:187], v[220:223], v[64:67]
    v_mfma_f32_16x16x32_bf16 v[68:71], v[188:191], v[220:223], v[68:71]
    v_mfma_f32_16x16x32_bf16 v[72:75], v[176:179], v[220:223], v[72:75]
    v_mfma_f32_16x16x32_bf16 v[76:79], v[180:183], v[220:223], v[76:79]
    s_waitcnt lgkmcnt(2)
    v_mfma_f32_16x16x32_bf16 v[80:83], v[176:179], v[224:227], v[80:83]
    ds_read_b128 v[240:243], v250 offset:23552
    ds_read_b128 v[244:247], v250 offset:34816
    v_mfma_f32_16x16x32_bf16 v[84:87], v[180:183], v[224:227], v[84:87]
    v_mfma_f32_16x16x32_bf16 v[88:91], v[208:211], v[224:227], v[88:91]
    v_mfma_f32_16x16x32_bf16 v[92:95], v[212:215], v[224:227], v[92:95]
    v_mfma_f32_16x16x32_bf16 v[80:83], v[184:187], v[228:231], v[80:83]
    v_add_u32 v248, 0x9800, v248
    v_add_u32 v249, 0x9800, v249
    v_mfma_f32_16x16x32_bf16 v[84:87], v[188:191], v[228:231], v[84:87]
    v_mfma_f32_16x16x32_bf16 v[88:91], v[176:179], v[228:231], v[88:91]
    v_mfma_f32_16x16x32_bf16 v[92:95], v[180:183], v[228:231], v[92:95]
    s_waitcnt lgkmcnt(2)
    v_mfma_f32_16x16x32_bf16 v[96:99], v[176:179], v[232:235], v[96:99]
    ds_read_b128 v[216:219], v250 offset:24576
    ds_read_b128 v[220:223], v250 offset:35840
    v_mfma_f32_16x16x32_bf16 v[100:103], v[180:183], v[232:235], v[100:103]
    v_mfma_f32_16x16x32_bf16 v[104:107], v[208:211], v[232:235], v[104:107]
    v_mfma_f32_16x16x32_bf16 v[108:111], v[212:215], v[232:235], v[108:111]
    ds_read_b64_tr_b16 v[192:193], v248 offset:0
    ds_read_b64_tr_b16 v[194:195], v248 offset:1024
    ds_read_b64_tr_b16 v[196:197], v249 offset:0
    ds_read_b64_tr_b16 v[198:199], v249 offset:1024
    v_mfma_f32_16x16x32_bf16 v[96:99], v[184:187], v[236:239], v[96:99]
    v_mfma_f32_16x16x32_bf16 v[100:103], v[188:191], v[236:239], v[100:103]
    v_mfma_f32_16x16x32_bf16 v[104:107], v[176:179], v[236:239], v[104:107]
    v_mfma_f32_16x16x32_bf16 v[108:111], v[180:183], v[236:239], v[108:111]
    s_waitcnt lgkmcnt(6)
    v_mfma_f32_16x16x32_bf16 v[112:115], v[176:179], v[240:243], v[112:115]
    ds_read_b128 v[224:227], v250 offset:25600
    ds_read_b128 v[228:231], v250 offset:36864
    v_mfma_f32_16x16x32_bf16 v[116:119], v[180:183], v[240:243], v[116:119]
    v_mfma_f32_16x16x32_bf16 v[120:123], v[208:211], v[240:243], v[120:123]
    v_mfma_f32_16x16x32_bf16 v[124:127], v[212:215], v[240:243], v[124:127]
    ds_read_b64_tr_b16 v[200:201], v248 offset:8192
    ds_read_b64_tr_b16 v[202:203], v248 offset:9216
    ds_read_b64_tr_b16 v[204:205], v249 offset:8192
    ds_read_b64_tr_b16 v[206:207], v249 offset:9216
    v_mfma_f32_16x16x32_bf16 v[112:115], v[184:187], v[244:247], v[112:115]
    v_mfma_f32_16x16x32_bf16 v[116:119], v[188:191], v[244:247], v[116:119]
    v_mfma_f32_16x16x32_bf16 v[120:123], v[176:179], v[244:247], v[120:123]
    v_mfma_f32_16x16x32_bf16 v[124:127], v[180:183], v[244:247], v[124:127]
    s_waitcnt lgkmcnt(10)
    v_mfma_f32_16x16x32_bf16 v[128:131], v[176:179], v[216:219], v[128:131]
    ds_read_b128 v[232:235], v250 offset:26624
    ds_read_b128 v[236:239], v250 offset:37888
    v_mfma_f32_16x16x32_bf16 v[132:135], v[180:183], v[216:219], v[132:135]
    v_mfma_f32_16x16x32_bf16 v[136:139], v[208:211], v[216:219], v[136:139]
    v_mfma_f32_16x16x32_bf16 v[140:143], v[212:215], v[216:219], v[140:143]
    v_mfma_f32_16x16x32_bf16 v[128:131], v[184:187], v[220:223], v[128:131]
    v_mfma_f32_16x16x32_bf16 v[132:135], v[188:191], v[220:223], v[132:135]
    v_mfma_f32_16x16x32_bf16 v[136:139], v[176:179], v[220:223], v[136:139]
    v_mfma_f32_16x16x32_bf16 v[140:143], v[180:183], v[220:223], v[140:143]
    s_waitcnt lgkmcnt(6)
    v_mfma_f32_16x16x32_bf16 v[144:147], v[176:179], v[224:227], v[144:147]
    v_add_u32 v250, 0x9800, v250
    ds_read_b128 v[240:243], v250 offset:16384
    ds_read_b128 v[244:247], v250 offset:27648
    v_mfma_f32_16x16x32_bf16 v[148:151], v[180:183], v[224:227], v[148:151]
    v_mfma_f32_16x16x32_bf16 v[152:155], v[208:211], v[224:227], v[152:155]
    v_mfma_f32_16x16x32_bf16 v[156:159], v[212:215], v[224:227], v[156:159]
    v_mfma_f32_16x16x32_bf16 v[144:147], v[184:187], v[228:231], v[144:147]
    s_waitcnt lgkmcnt(4)
    v_xor_b32 v212, 0x80008000, v204
    v_xor_b32 v213, 0x80008000, v205
    v_mfma_f32_16x16x32_bf16 v[148:151], v[188:191], v[228:231], v[148:151]
    v_xor_b32 v214, 0x80008000, v206
    v_xor_b32 v215, 0x80008000, v207
    v_mfma_f32_16x16x32_bf16 v[152:155], v[176:179], v[228:231], v[152:155]
    v_mfma_f32_16x16x32_bf16 v[156:159], v[180:183], v[228:231], v[156:159]
    s_waitcnt lgkmcnt(2)
    v_mfma_f32_16x16x32_bf16 v[160:163], v[176:179], v[232:235], v[160:163]
    ds_read_b128 v[216:219], v250 offset:17408
    ds_read_b128 v[220:223], v250 offset:28672
    v_mfma_f32_16x16x32_bf16 v[164:167], v[208:211], v[232:235], v[164:167]
    v_xor_b32 v208, 0x80008000, v200
    v_xor_b32 v209, 0x80008000, v201
    v_mfma_f32_16x16x32_bf16 v[160:163], v[184:187], v[236:239], v[160:163]
    v_xor_b32 v210, 0x80008000, v202
    v_xor_b32 v211, 0x80008000, v203
    v_mfma_f32_16x16x32_bf16 v[164:167], v[176:179], v[236:239], v[164:167]
    s_barrier
    s_waitcnt lgkmcnt(2)
    v_mfma_f32_16x16x32_bf16 v[0:3], v[192:195], v[240:243], v[0:3]
    ds_read_b128 v[224:227], v250 offset:18432
    ds_read_b128 v[228:231], v250 offset:29696
    v_mfma_f32_16x16x32_bf16 v[4:7], v[196:199], v[240:243], v[4:7]
    v_mfma_f32_16x16x32_bf16 v[8:11], v[208:211], v[240:243], v[8:11]
    v_mfma_f32_16x16x32_bf16 v[12:15], v[212:215], v[240:243], v[12:15]
    v_mfma_f32_16x16x32_bf16 v[0:3], v[200:203], v[244:247], v[0:3]
    v_mfma_f32_16x16x32_bf16 v[4:7], v[204:207], v[244:247], v[4:7]
    v_mfma_f32_16x16x32_bf16 v[8:11], v[192:195], v[244:247], v[8:11]
    v_mfma_f32_16x16x32_bf16 v[12:15], v[196:199], v[244:247], v[12:15]
    s_waitcnt lgkmcnt(2)
    v_mfma_f32_16x16x32_bf16 v[16:19], v[192:195], v[216:219], v[16:19]
    ds_read_b128 v[232:235], v250 offset:19456
    ds_read_b128 v[236:239], v250 offset:30720
    v_mfma_f32_16x16x32_bf16 v[20:23], v[196:199], v[216:219], v[20:23]
    v_mfma_f32_16x16x32_bf16 v[24:27], v[208:211], v[216:219], v[24:27]
    v_mfma_f32_16x16x32_bf16 v[28:31], v[212:215], v[216:219], v[28:31]
    v_mfma_f32_16x16x32_bf16 v[16:19], v[200:203], v[220:223], v[16:19]
    v_mfma_f32_16x16x32_bf16 v[20:23], v[204:207], v[220:223], v[20:23]
    v_mfma_f32_16x16x32_bf16 v[24:27], v[192:195], v[220:223], v[24:27]
    v_mfma_f32_16x16x32_bf16 v[28:31], v[196:199], v[220:223], v[28:31]
    s_waitcnt lgkmcnt(2)
    v_mfma_f32_16x16x32_bf16 v[32:35], v[192:195], v[224:227], v[32:35]
    ds_read_b128 v[240:243], v250 offset:20480
    ds_read_b128 v[244:247], v250 offset:31744
    v_mfma_f32_16x16x32_bf16 v[36:39], v[196:199], v[224:227], v[36:39]
    v_mfma_f32_16x16x32_bf16 v[40:43], v[208:211], v[224:227], v[40:43]
    v_mfma_f32_16x16x32_bf16 v[44:47], v[212:215], v[224:227], v[44:47]
    v_mfma_f32_16x16x32_bf16 v[32:35], v[200:203], v[228:231], v[32:35]
    v_mfma_f32_16x16x32_bf16 v[36:39], v[204:207], v[228:231], v[36:39]
    v_mfma_f32_16x16x32_bf16 v[40:43], v[192:195], v[228:231], v[40:43]
    v_mfma_f32_16x16x32_bf16 v[44:47], v[196:199], v[228:231], v[44:47]
    s_waitcnt lgkmcnt(2)
    v_mfma_f32_16x16x32_bf16 v[48:51], v[192:195], v[232:235], v[48:51]
    ds_read_b128 v[216:219], v250 offset:21504
    ds_read_b128 v[220:223], v250 offset:32768
    v_mfma_f32_16x16x32_bf16 v[52:55], v[196:199], v[232:235], v[52:55]
    v_mfma_f32_16x16x32_bf16 v[56:59], v[208:211], v[232:235], v[56:59]
    v_mfma_f32_16x16x32_bf16 v[60:63], v[212:215], v[232:235], v[60:63]
    v_mfma_f32_16x16x32_bf16 v[48:51], v[200:203], v[236:239], v[48:51]
    v_mfma_f32_16x16x32_bf16 v[52:55], v[204:207], v[236:239], v[52:55]
    v_mfma_f32_16x16x32_bf16 v[56:59], v[192:195], v[236:239], v[56:59]
    v_mfma_f32_16x16x32_bf16 v[60:63], v[196:199], v[236:239], v[60:63]
    s_waitcnt lgkmcnt(2)
    v_mfma_f32_16x16x32_bf16 v[64:67], v[192:195], v[240:243], v[64:67]
    ds_read_b128 v[224:227], v250 offset:22528
    ds_read_b128 v[228:231], v250 offset:33792
    v_mfma_f32_16x16x32_bf16 v[68:71], v[196:199], v[240:243], v[68:71]
    v_mfma_f32_16x16x32_bf16 v[72:75], v[208:211], v[240:243], v[72:75]
    v_mfma_f32_16x16x32_bf16 v[76:79], v[212:215], v[240:243], v[76:79]
    v_mfma_f32_16x16x32_bf16 v[64:67], v[200:203], v[244:247], v[64:67]
    v_mfma_f32_16x16x32_bf16 v[68:71], v[204:207], v[244:247], v[68:71]
    v_mfma_f32_16x16x32_bf16 v[72:75], v[192:195], v[244:247], v[72:75]
    v_mfma_f32_16x16x32_bf16 v[76:79], v[196:199], v[244:247], v[76:79]
    s_waitcnt lgkmcnt(2)
    v_mfma_f32_16x16x32_bf16 v[80:83], v[192:195], v[216:219], v[80:83]
    ds_read_b128 v[232:235], v250 offset:23552
    ds_read_b128 v[236:239], v250 offset:34816
    v_mfma_f32_16x16x32_bf16 v[84:87], v[196:199], v[216:219], v[84:87]
    v_mfma_f32_16x16x32_bf16 v[88:91], v[208:211], v[216:219], v[88:91]
    v_mfma_f32_16x16x32_bf16 v[92:95], v[212:215], v[216:219], v[92:95]
    v_mfma_f32_16x16x32_bf16 v[80:83], v[200:203], v[220:223], v[80:83]
    v_add_u32 v248, 0x9800, v248
    v_add_u32 v249, 0x9800, v249
    v_mfma_f32_16x16x32_bf16 v[84:87], v[204:207], v[220:223], v[84:87]
    v_mfma_f32_16x16x32_bf16 v[88:91], v[192:195], v[220:223], v[88:91]
    v_mfma_f32_16x16x32_bf16 v[92:95], v[196:199], v[220:223], v[92:95]
    s_waitcnt lgkmcnt(2)
    v_mfma_f32_16x16x32_bf16 v[96:99], v[192:195], v[224:227], v[96:99]
    ds_read_b128 v[240:243], v250 offset:24576
    ds_read_b128 v[244:247], v250 offset:35840
    v_mfma_f32_16x16x32_bf16 v[100:103], v[196:199], v[224:227], v[100:103]
    v_mfma_f32_16x16x32_bf16 v[104:107], v[208:211], v[224:227], v[104:107]
    v_mfma_f32_16x16x32_bf16 v[108:111], v[212:215], v[224:227], v[108:111]
    ds_read_b64_tr_b16 v[176:177], v248 offset:0
    ds_read_b64_tr_b16 v[178:179], v248 offset:1024
    ds_read_b64_tr_b16 v[180:181], v249 offset:0
    ds_read_b64_tr_b16 v[182:183], v249 offset:1024
    v_mfma_f32_16x16x32_bf16 v[96:99], v[200:203], v[228:231], v[96:99]
    v_mfma_f32_16x16x32_bf16 v[100:103], v[204:207], v[228:231], v[100:103]
    v_mfma_f32_16x16x32_bf16 v[104:107], v[192:195], v[228:231], v[104:107]
    v_mfma_f32_16x16x32_bf16 v[108:111], v[196:199], v[228:231], v[108:111]
    s_waitcnt lgkmcnt(6)
    v_mfma_f32_16x16x32_bf16 v[112:115], v[192:195], v[232:235], v[112:115]
    ds_read_b128 v[216:219], v250 offset:25600
    ds_read_b128 v[220:223], v250 offset:36864
    v_mfma_f32_16x16x32_bf16 v[116:119], v[196:199], v[232:235], v[116:119]
    v_mfma_f32_16x16x32_bf16 v[120:123], v[208:211], v[232:235], v[120:123]
    v_mfma_f32_16x16x32_bf16 v[124:127], v[212:215], v[232:235], v[124:127]
    ds_read_b64_tr_b16 v[184:185], v248 offset:8192
    ds_read_b64_tr_b16 v[186:187], v248 offset:9216
    ds_read_b64_tr_b16 v[188:189], v249 offset:8192
    ds_read_b64_tr_b16 v[190:191], v249 offset:9216
    v_mfma_f32_16x16x32_bf16 v[112:115], v[200:203], v[236:239], v[112:115]
    v_mfma_f32_16x16x32_bf16 v[116:119], v[204:207], v[236:239], v[116:119]
    v_mfma_f32_16x16x32_bf16 v[120:123], v[192:195], v[236:239], v[120:123]
    v_mfma_f32_16x16x32_bf16 v[124:127], v[196:199], v[236:239], v[124:127]
    s_waitcnt lgkmcnt(10)
    v_mfma_f32_16x16x32_bf16 v[128:131], v[192:195], v[240:243], v[128:131]
    ds_read_b128 v[224:227], v250 offset:26624
    ds_read_b128 v[228:231], v250 offset:37888
    v_mfma_f32_16x16x32_bf16 v[132:135], v[196:199], v[240:243], v[132:135]
    v_mfma_f32_16x16x32_bf16 v[136:139], v[208:211], v[240:243], v[136:139]
    v_mfma_f32_16x16x32_bf16 v[140:143], v[212:215], v[240:243], v[140:143]
    v_mfma_f32_16x16x32_bf16 v[128:131], v[200:203], v[244:247], v[128:131]
    v_mfma_f32_16x16x32_bf16 v[132:135], v[204:207], v[244:247], v[132:135]
    v_mfma_f32_16x16x32_bf16 v[136:139], v[192:195], v[244:247], v[136:139]
    v_mfma_f32_16x16x32_bf16 v[140:143], v[196:199], v[244:247], v[140:143]
    s_waitcnt lgkmcnt(6)
    v_mfma_f32_16x16x32_bf16 v[144:147], v[192:195], v[216:219], v[144:147]
    v_add_u32 v250, 0x9800, v250
    ds_read_b128 v[232:235], v250 offset:16384
    ds_read_b128 v[236:239], v250 offset:27648
    v_mfma_f32_16x16x32_bf16 v[148:151], v[196:199], v[216:219], v[148:151]
    v_mfma_f32_16x16x32_bf16 v[152:155], v[208:211], v[216:219], v[152:155]
    v_mfma_f32_16x16x32_bf16 v[156:159], v[212:215], v[216:219], v[156:159]
    v_mfma_f32_16x16x32_bf16 v[144:147], v[200:203], v[220:223], v[144:147]
    s_waitcnt lgkmcnt(4)
    v_xor_b32 v212, 0x80008000, v188
    v_xor_b32 v213, 0x80008000, v189
    v_mfma_f32_16x16x32_bf16 v[148:151], v[204:207], v[220:223], v[148:151]
    v_xor_b32 v214, 0x80008000, v190
    v_xor_b32 v215, 0x80008000, v191
    v_mfma_f32_16x16x32_bf16 v[152:155], v[192:195], v[220:223], v[152:155]
    v_mfma_f32_16x16x32_bf16 v[156:159], v[196:199], v[220:223], v[156:159]
    s_waitcnt lgkmcnt(2)
    v_mfma_f32_16x16x32_bf16 v[160:163], v[192:195], v[224:227], v[160:163]
    ds_read_b128 v[240:243], v250 offset:17408
    ds_read_b128 v[244:247], v250 offset:28672
    v_mfma_f32_16x16x32_bf16 v[164:167], v[208:211], v[224:227], v[164:167]
    v_xor_b32 v208, 0x80008000, v184
    v_xor_b32 v209, 0x80008000, v185
    v_mfma_f32_16x16x32_bf16 v[160:163], v[200:203], v[228:231], v[160:163]
    v_xor_b32 v210, 0x80008000, v186
    v_xor_b32 v211, 0x80008000, v187
    v_mfma_f32_16x16x32_bf16 v[164:167], v[192:195], v[228:231], v[164:167]
    s_barrier
    s_cmp_lg_u32 s13, 0
    s_cbranch_scc1 L_epi_b1
    v_add_u32 v248, 0x9800, v248
    v_add_u32 v249, 0x9800, v249
    v_add_u32 v253, 38912, v250
    ds_read_b64_tr_b16 v[192:193], v248 offset:0
    ds_read_b64_tr_b16 v[194:195], v248 offset:1024
    ds_read_b64_tr_b16 v[196:197], v249 offset:0
    ds_read_b64_tr_b16 v[198:199], v249 offset:1024
    ds_read_b64_tr_b16 v[200:201], v248 offset:8192
    ds_read_b64_tr_b16 v[202:203], v248 offset:9216
    ds_read_b64_tr_b16 v[204:205], v249 offset:8192
    ds_read_b64_tr_b16 v[206:207], v249 offset:9216
    s_waitcnt lgkmcnt(10)
    v_mfma_f32_16x16x32_bf16 v[0:3], v[176:179], v[232:235], v[0:3]
    ds_read_b128 v[216:219], v250 offset:18432
    ds_read_b128 v[220:223], v250 offset:29696
    v_mfma_f32_16x16x32_bf16 v[4:7], v[180:183], v[232:235], v[4:7]
    v_mfma_f32_16x16x32_bf16 v[8:11], v[208:211], v[232:235], v[8:11]
    v_mfma_f32_16x16x32_bf16 v[12:15], v[212:215], v[232:235], v[12:15]
    v_mfma_f32_16x16x32_bf16 v[0:3], v[184:187], v[236:239], v[0:3]
    v_mfma_f32_16x16x32_bf16 v[4:7], v[188:191], v[236:239], v[4:7]
    v_mfma_f32_16x16x32_bf16 v[8:11], v[176:179], v[236:239], v[8:11]
    v_mfma_f32_16x16x32_bf16 v[12:15], v[180:183], v[236:239], v[12:15]
    s_waitcnt lgkmcnt(10)
    v_mfma_f32_16x16x32_bf16 v[16:19], v[176:179], v[240:243], v[16:19]
    ds_read_b128 v[224:227], v253 offset:16384
    ds_read_b128 v[228:231], v253 offset:27648
    v_mfma_f32_16x16x32_bf16 v[20:23], v[180:183], v[240:243], v[20:23]
    v_mfma_f32_16x16x32_bf16 v[24:27], v[208:211], v[240:243], v[24:27]
    v_mfma_f32_16x16x32_bf16 v[28:31], v[212:215], v[240:243], v[28:31]
    v_mfma_f32_16x16x32_bf16 v[16:19], v[184:187], v[244:247], v[16:19]
    v_mfma_f32_16x16x32_bf16 v[20:23], v[188:191], v[244:247], v[20:23]
    v_mfma_f32_16x16x32_bf16 v[24:27], v[176:179], v[244:247], v[24:27]
    v_mfma_f32_16x16x32_bf16 v[28:31], v[180:183], v[244:247], v[28:31]
    s_waitcnt lgkmcnt(2)
    v_mfma_f32_16x16x32_bf16 v[32:35], v[176:179], v[216:219], v[32:35]
    ds_read_b128 v[232:235], v250 offset:19456
    ds_read_b128 v[236:239], v250 offset:30720
    v_mfma_f32_16x16x32_bf16 v[36:39], v[180:183], v[216:219], v[36:39]
    v_mfma_f32_16x16x32_bf16 v[40:43], v[208:211], v[216:219], v[40:43]
    v_mfma_f32_16x16x32_bf16 v[44:47], v[212:215], v[216:219], v[44:47]
    v_mfma_f32_16x16x32_bf16 v[32:35], v[184:187], v[220:223], v[32:35]
    v_mfma_f32_16x16x32_bf16 v[36:39], v[188:191], v[220:223], v[36:39]
    v_mfma_f32_16x16x32_bf16 v[40:43], v[176:179], v[220:223], v[40:43]
    v_mfma_f32_16x16x32_bf16 v[44:47], v[180:183], v[220:223], v[44:47]
    v_xor_b32 v168, 0x80008000, v200
    v_xor_b32 v169, 0x80008000, v201
    v_xor_b32 v170, 0x80008000, v202
    v_xor_b32 v171, 0x80008000, v203
    v_xor_b32 v172, 0x80008000, v204
    v_xor_b32 v173, 0x80008000, v205
    v_xor_b32 v174, 0x80008000, v206
    v_xor_b32 v175, 0x80008000, v207
    s_waitcnt lgkmcnt(2)
    v_mfma_f32_16x16x32_bf16 v[0:3], v[192:195], v[224:227], v[0:3]
    ds_read_b128 v[240:243], v253 offset:17408
    ds_read_b128 v[244:247], v253 offset:28672
    v_mfma_f32_16x16x32_bf16 v[4:7], v[196:199], v[224:227], v[4:7]
    v_mfma_f32_16x16x32_bf16 v[8:11], v[168:171], v[224:227], v[8:11]
    v_mfma_f32_16x16x32_bf16 v[12:15], v[172:175], v[224:227], v[12:15]
    v_mfma_f32_16x16x32_bf16 v[0:3], v[200:203], v[228:231], v[0:3]
    v_mfma_f32_16x16x32_bf16 v[4:7], v[204:207], v[228:231], v[4:7]
    v_mfma_f32_16x16x32_bf16 v[8:11], v[192:195], v[228:231], v[8:11]
    v_mfma_f32_16x16x32_bf16 v[12:15], v[196:199], v[228:231], v[12:15]
    s_waitcnt lgkmcnt(2)
    v_mfma_f32_16x16x32_bf16 v[48:51], v[176:179], v[232:235], v[48:51]
    ds_read_b128 v[216:219], v250 offset:20480
    ds_read_b128 v[220:223], v250 offset:31744
    v_mfma_f32_16x16x32_bf16 v[52:55], v[180:183], v[232:235], v[52:55]
    v_mfma_f32_16x16x32_bf16 v[56:59], v[208:211], v[232:235], v[56:59]
    v_mfma_f32_16x16x32_bf16 v[60:63], v[212:215], v[232:235], v[60:63]
    v_mfma_f32_16x16x32_bf16 v[48:51], v[184:187], v[236:239], v[48:51]
    v_mfma_f32_16x16x32_bf16 v[52:55], v[188:191], v[236:239], v[52:55]
    v_mfma_f32_16x16x32_bf16 v[56:59], v[176:179], v[236:239], v[56:59]
    v_mfma_f32_16x16x32_bf16 v[60:63], v[180:183], v[236:239], v[60:63]
    s_waitcnt lgkmcnt(2)
    v_mfma_f32_16x16x32_bf16 v[16:19], v[192:195], v[240:243], v[16:19]
    ds_read_b128 v[224:227], v253 offset:18432
    ds_read_b128 v[228:231], v253 offset:29696
    v_mfma_f32_16x16x32_bf16 v[20:23], v[196:199], v[240:243], v[20:23]
    v_cvt_pk_bf16_f32 v0, v0, v1
    v_cvt_pk_bf16_f32 v1, v2, v3
    v_mfma_f32_16x16x32_bf16 v[24:27], v[168:171], v[240:243], v[24:27]
    v_cvt_pk_bf16_f32 v2, v4, v5
    v_cvt_pk_bf16_f32 v3, v6, v7
    v_mfma_f32_16x16x32_bf16 v[28:31], v[172:175], v[240:243], v[28:31]
    s_add_u32 s47, s48, 0
    buffer_store_dwordx4 v[0:3], v251, s[16:19], s47 offen sc1
    v_mfma_f32_16x16x32_bf16 v[16:19], v[200:203], v[244:247], v[16:19]
    v_cvt_pk_bf16_f32 v8, v8, v9
    v_cvt_pk_bf16_f32 v9, v10, v11
    v_mfma_f32_16x16x32_bf16 v[20:23], v[204:207], v[244:247], v[20:23]
    v_cvt_pk_bf16_f32 v10, v12, v13
    v_cvt_pk_bf16_f32 v11, v14, v15
    v_mfma_f32_16x16x32_bf16 v[24:27], v[192:195], v[244:247], v[24:27]
    s_add_u32 s47, s48, 11264
    buffer_store_dwordx4 v[8:11], v251, s[16:19], s47 offen sc1
    v_mfma_f32_16x16x32_bf16 v[28:31], v[196:199], v[244:247], v[28:31]
    s_waitcnt lgkmcnt(2)
    v_mfma_f32_16x16x32_bf16 v[64:67], v[176:179], v[216:219], v[64:67]
    ds_read_b128 v[232:235], v250 offset:21504
    ds_read_b128 v[236:239], v250 offset:32768
    v_mfma_f32_16x16x32_bf16 v[68:71], v[180:183], v[216:219], v[68:71]
    v_mfma_f32_16x16x32_bf16 v[72:75], v[208:211], v[216:219], v[72:75]
    v_mfma_f32_16x16x32_bf16 v[76:79], v[212:215], v[216:219], v[76:79]
    v_mfma_f32_16x16x32_bf16 v[64:67], v[184:187], v[220:223], v[64:67]
    v_mfma_f32_16x16x32_bf16 v[68:71], v[188:191], v[220:223], v[68:71]
    v_mfma_f32_16x16x32_bf16 v[72:75], v[176:179], v[220:223], v[72:75]
    v_mfma_f32_16x16x32_bf16 v[76:79], v[180:183], v[220:223], v[76:79]
    s_waitcnt lgkmcnt(2)
    v_mfma_f32_16x16x32_bf16 v[32:35], v[192:195], v[224:227], v[32:35]
    ds_read_b128 v[240:243], v253 offset:19456
    ds_read_b128 v[244:247], v253 offset:30720
    v_mfma_f32_16x16x32_bf16 v[36:39], v[196:199], v[224:227], v[36:39]
    v_cvt_pk_bf16_f32 v16, v16, v17
    v_cvt_pk_bf16_f32 v17, v18, v19
    v_mfma_f32_16x16x32_bf16 v[40:43], v[168:171], v[224:227], v[40:43]
    v_cvt_pk_bf16_f32 v18, v20, v21
    v_cvt_pk_bf16_f32 v19, v22, v23
    v_mfma_f32_16x16x32_bf16 v[44:47], v[172:175], v[224:227], v[44:47]
    s_add_u32 s47, s48, 1024
    buffer_store_dwordx4 v[16:19], v251, s[16:19], s47 offen sc1
    v_mfma_f32_16x16x32_bf16 v[32:35], v[200:203], v[228:231], v[32:35]
    v_cvt_pk_bf16_f32 v24, v24, v25
    v_cvt_pk_bf16_f32 v25, v26, v27
    v_mfma_f32_16x16x32_bf16 v[36:39], v[204:207], v[228:231], v[36:39]
    v_cvt_pk_bf16_f32 v26, v28, v29
    v_cvt_pk_bf16_f32 v27, v30, v31
    v_mfma_f32_16x16x32_bf16 v[40:43], v[192:195], v[228:231], v[40:43]
    s_add_u32 s47, s48, 12288
    buffer_store_dwordx4 v[24:27], v251, s[16:19], s47 offen sc1
    v_mfma_f32_16x16x32_bf16 v[44:47], v[196:199], v[228:231], v[44:47]
    s_waitcnt lgkmcnt(2)
    v_mfma_f32_16x16x32_bf16 v[80:83], v[176:179], v[232:235], v[80:83]
    ds_read_b128 v[216:219], v250 offset:22528
    ds_read_b128 v[220:223], v250 offset:33792
    v_mfma_f32_16x16x32_bf16 v[84:87], v[180:183], v[232:235], v[84:87]
    v_mfma_f32_16x16x32_bf16 v[88:91], v[208:211], v[232:235], v[88:91]
    v_mfma_f32_16x16x32_bf16 v[92:95], v[212:215], v[232:235], v[92:95]
    v_mfma_f32_16x16x32_bf16 v[80:83], v[184:187], v[236:239], v[80:83]
    v_mfma_f32_16x16x32_bf16 v[84:87], v[188:191], v[236:239], v[84:87]
    v_mfma_f32_16x16x32_bf16 v[88:91], v[176:179], v[236:239], v[88:91]
    v_mfma_f32_16x16x32_bf16 v[92:95], v[180:183], v[236:239], v[92:95]
    s_waitcnt lgkmcnt(2)
    v_mfma_f32_16x16x32_bf16 v[48:51], v[192:195], v[240:243], v[48:51]
    ds_read_b128 v[224:227], v253 offset:20480
    ds_read_b128 v[228:231], v253 offset:31744
    v_mfma_f32_16x16x32_bf16 v[52:55], v[196:199], v[240:243], v[52:55]
    v_cvt_pk_bf16_f32 v32, v32, v33
    v_cvt_pk_bf16_f32 v33, v34, v35
    v_mfma_f32_16x16x32_bf16 v[56:59], v[168:171], v[240:243], v[56:59]
    v_cvt_pk_bf16_f32 v34, v36, v37
    v_cvt_pk_bf16_f32 v35, v38, v39
    v_mfma_f32_16x16x32_bf16 v[60:63], v[172:175], v[240:243], v[60:63]
    s_add_u32 s47, s48, 2048
    buffer_store_dwordx4 v[32:35], v251, s[16:19], s47 offen sc1
    v_mfma_f32_16x16x32_bf16 v[48:51], v[200:203], v[244:247], v[48:51]
    v_cvt_pk_bf16_f32 v40, v40, v41
    v_cvt_pk_bf16_f32 v41, v42, v43
    v_mfma_f32_16x16x32_bf16 v[52:55], v[204:207], v[244:247], v[52:55]
    v_cvt_pk_bf16_f32 v42, v44, v45
    v_cvt_pk_bf16_f32 v43, v46, v47
    v_mfma_f32_16x16x32_bf16 v[56:59], v[192:195], v[244:247], v[56:59]
    s_add_u32 s47, s48, 13312
    buffer_store_dwordx4 v[40:43], v251, s[16:19], s47 offen sc1
    v_mfma_f32_16x16x32_bf16 v[60:63], v[196:199], v[244:247], v[60:63]
    s_waitcnt lgkmcnt(2)
    v_mfma_f32_16x16x32_bf16 v[96:99], v[176:179], v[216:219], v[96:99]
    ds_read_b128 v[232:235], v250 offset:23552
    ds_read_b128 v[236:239], v250 offset:34816
    v_mfma_f32_16x16x32_bf16 v[100:103], v[180:183], v[216:219], v[100:103]
    v_mfma_f32_16x16x32_bf16 v[104:107], v[208:211], v[216:219], v[104:107]
    v_mfma_f32_16x16x32_bf16 v[108:111], v[212:215], v[216:219], v[108:111]
    v_mfma_f32_16x16x32_bf16 v[96:99], v[184:187], v[220:223], v[96:99]
    v_mfma_f32_16x16x32_bf16 v[100:103], v[188:191], v[220:223], v[100:103]
    v_mfma_f32_16x16x32_bf16 v[104:107], v[176:179], v[220:223], v[104:107]
    v_mfma_f32_16x16x32_bf16 v[108:111], v[180:183], v[220:223], v[108:111]
    s_waitcnt lgkmcnt(2)
    v_mfma_f32_16x16x32_bf16 v[64:67], v[192:195], v[224:227], v[64:67]
    ds_read_b128 v[240:243], v253 offset:21504
    ds_read_b128 v[244:247], v253 offset:32768
    v_mfma_f32_16x16x32_bf16 v[68:71], v[196:199], v[224:227], v[68:71]
    v_cvt_pk_bf16_f32 v48, v48, v49
    v_cvt_pk_bf16_f32 v49, v50, v51
    v_mfma_f32_16x16x32_bf16 v[72:75], v[168:171], v[224:227], v[72:75]
    v_cvt_pk_bf16_f32 v50, v52, v53
    v_cvt_pk_bf16_f32 v51, v54, v55
    v_mfma_f32_16x16x32_bf16 v[76:79], v[172:175], v[224:227], v[76:79]
    s_add_u32 s47, s48, 3072
    buffer_store_dwordx4 v[48:51], v251, s[16:19], s47 offen sc1
    v_mfma_f32_16x16x32_bf16 v[64:67], v[200:203], v[228:231], v[64:67]
    v_cvt_pk_bf16_f32 v56, v56, v57
    v_cvt_pk_bf16_f32 v57, v58, v59
    v_mfma_f32_16x16x32_bf16 v[68:71], v[204:207], v[228:231], v[68:71]
    v_cvt_pk_bf16_f32 v58, v60, v61
    v_cvt_pk_bf16_f32 v59, v62, v63
    v_mfma_f32_16x16x32_bf16 v[72:75], v[192:195], v[228:231], v[72:75]
    s_add_u32 s47, s48, 14336
    buffer_store_dwordx4 v[56:59], v251, s[16:19], s47 offen sc1
    v_mfma_f32_16x16x32_bf16 v[76:79], v[196:199], v[228:231], v[76:79]
    s_waitcnt lgkmcnt(2)
    v_mfma_f32_16x16x32_bf16 v[112:115], v[176:179], v[232:235], v[112:115]
    ds_read_b128 v[216:219], v250 offset:24576
    ds_read_b128 v[220:223], v250 offset:35840
    v_mfma_f32_16x16x32_bf16 v[116:119], v[180:183], v[232:235], v[116:119]
    v_mfma_f32_16x16x32_bf16 v[120:123], v[208:211], v[232:235], v[120:123]
    v_mfma_f32_16x16x32_bf16 v[124:127], v[212:215], v[232:235], v[124:127]
    v_mfma_f32_16x16x32_bf16 v[112:115], v[184:187], v[236:239], v[112:115]
    v_mfma_f32_16x16x32_bf16 v[116:119], v[188:191], v[236:239], v[116:119]
    v_mfma_f32_16x16x32_bf16 v[120:123], v[176:179], v[236:239], v[120:123]
    v_mfma_f32_16x16x32_bf16 v[124:127], v[180:183], v[236:239], v[124:127]
    s_waitcnt lgkmcnt(2)
    v_mfma_f32_16x16x32_bf16 v[80:83], v[192:195], v[240:243], v[80:83]
    ds_read_b128 v[224:227], v253 offset:22528
    ds_read_b128 v[228:231], v253 offset:33792
    v_mfma_f32_16x16x32_bf16 v[84:87], v[196:199], v[240:243], v[84:87]
    v_cvt_pk_bf16_f32 v64, v64, v65
    v_cvt_pk_bf16_f32 v65, v66, v67
    v_mfma_f32_16x16x32_bf16 v[88:91], v[168:171], v[240:243], v[88:91]
    v_cvt_pk_bf16_f32 v66, v68, v69
    v_cvt_pk_bf16_f32 v67, v70, v71
    v_mfma_f32_16x16x32_bf16 v[92:95], v[172:175], v[240:243], v[92:95]
    s_add_u32 s47, s48, 4096
    buffer_store_dwordx4 v[64:67], v251, s[16:19], s47 offen sc1
    v_mfma_f32_16x16x32_bf16 v[80:83], v[200:203], v[244:247], v[80:83]
    v_cvt_pk_bf16_f32 v72, v72, v73
    v_cvt_pk_bf16_f32 v73, v74, v75
    v_mfma_f32_16x16x32_bf16 v[84:87], v[204:207], v[244:247], v[84:87]
    v_cvt_pk_bf16_f32 v74, v76, v77
    v_cvt_pk_bf16_f32 v75, v78, v79
    v_mfma_f32_16x16x32_bf16 v[88:91], v[192:195], v[244:247], v[88:91]
    s_add_u32 s47, s48, 15360
    buffer_store_dwordx4 v[72:75], v251, s[16:19], s47 offen sc1
    v_mfma_f32_16x16x32_bf16 v[92:95], v[196:199], v[244:247], v[92:95]
    s_waitcnt lgkmcnt(2)
    v_mfma_f32_16x16x32_bf16 v[128:131], v[176:179], v[216:219], v[128:131]
    ds_read_b128 v[232:235], v250 offset:25600
    ds_read_b128 v[236:239], v250 offset:36864
    v_mfma_f32_16x16x32_bf16 v[132:135], v[180:183], v[216:219], v[132:135]
    v_mfma_f32_16x16x32_bf16 v[136:139], v[208:211], v[216:219], v[136:139]
    v_mfma_f32_16x16x32_bf16 v[140:143], v[212:215], v[216:219], v[140:143]
    v_mfma_f32_16x16x32_bf16 v[128:131], v[184:187], v[220:223], v[128:131]
    v_mfma_f32_16x16x32_bf16 v[132:135], v[188:191], v[220:223], v[132:135]
    v_mfma_f32_16x16x32_bf16 v[136:139], v[176:179], v[220:223], v[136:139]
    v_mfma_f32_16x16x32_bf16 v[140:143], v[180:183], v[220:223], v[140:143]
    s_waitcnt lgkmcnt(2)
    v_mfma_f32_16x16x32_bf16 v[96:99], v[192:195], v[224:227], v[96:99]
    ds_read_b128 v[240:243], v253 offset:23552
    ds_read_b128 v[244:247], v253 offset:34816
    v_mfma_f32_16x16x32_bf16 v[100:103], v[196:199], v[224:227], v[100:103]
    v_cvt_pk_bf16_f32 v80, v80, v81
    v_cvt_pk_bf16_f32 v81, v82, v83
    v_mfma_f32_16x16x32_bf16 v[104:107], v[168:171], v[224:227], v[104:107]
    v_cvt_pk_bf16_f32 v82, v84, v85
    v_cvt_pk_bf16_f32 v83, v86, v87
    v_mfma_f32_16x16x32_bf16 v[108:111], v[172:175], v[224:227], v[108:111]
    s_add_u32 s47, s48, 5120
    buffer_store_dwordx4 v[80:83], v251, s[16:19], s47 offen sc1
    v_mfma_f32_16x16x32_bf16 v[96:99], v[200:203], v[228:231], v[96:99]
    v_cvt_pk_bf16_f32 v88, v88, v89
    v_cvt_pk_bf16_f32 v89, v90, v91
    v_mfma_f32_16x16x32_bf16 v[100:103], v[204:207], v[228:231], v[100:103]
    v_cvt_pk_bf16_f32 v90, v92, v93
    v_cvt_pk_bf16_f32 v91, v94, v95
    v_mfma_f32_16x16x32_bf16 v[104:107], v[192:195], v[228:231], v[104:107]
    s_add_u32 s47, s48, 16384
    buffer_store_dwordx4 v[88:91], v251, s[16:19], s47 offen sc1
    v_mfma_f32_16x16x32_bf16 v[108:111], v[196:199], v[228:231], v[108:111]
    s_waitcnt lgkmcnt(2)
    v_mfma_f32_16x16x32_bf16 v[144:147], v[176:179], v[232:235], v[144:147]
    ds_read_b128 v[216:219], v250 offset:26624
    ds_read_b128 v[220:223], v250 offset:37888
    v_mfma_f32_16x16x32_bf16 v[148:151], v[180:183], v[232:235], v[148:151]
    v_mfma_f32_16x16x32_bf16 v[152:155], v[208:211], v[232:235], v[152:155]
    v_mfma_f32_16x16x32_bf16 v[156:159], v[212:215], v[232:235], v[156:159]
    v_mfma_f32_16x16x32_bf16 v[144:147], v[184:187], v[236:239], v[144:147]
    v_mfma_f32_16x16x32_bf16 v[148:151], v[188:191], v[236:239], v[148:151]
    v_mfma_f32_16x16x32_bf16 v[152:155], v[176:179], v[236:239], v[152:155]
    v_mfma_f32_16x16x32_bf16 v[156:159], v[180:183], v[236:239], v[156:159]
    s_waitcnt lgkmcnt(2)
    v_mfma_f32_16x16x32_bf16 v[112:115], v[192:195], v[240:243], v[112:115]
    ds_read_b128 v[224:227], v253 offset:24576
    ds_read_b128 v[228:231], v253 offset:35840
    v_mfma_f32_16x16x32_bf16 v[116:119], v[196:199], v[240:243], v[116:119]
    v_cvt_pk_bf16_f32 v96, v96, v97
    v_cvt_pk_bf16_f32 v97, v98, v99
    v_mfma_f32_16x16x32_bf16 v[120:123], v[168:171], v[240:243], v[120:123]
    v_cvt_pk_bf16_f32 v98, v100, v101
    v_cvt_pk_bf16_f32 v99, v102, v103
    v_mfma_f32_16x16x32_bf16 v[124:127], v[172:175], v[240:243], v[124:127]
    s_add_u32 s47, s48, 6144
    buffer_store_dwordx4 v[96:99], v251, s[16:19], s47 offen sc1
    v_mfma_f32_16x16x32_bf16 v[112:115], v[200:203], v[244:247], v[112:115]
    v_cvt_pk_bf16_f32 v104, v104, v105
    v_cvt_pk_bf16_f32 v105, v106, v107
    v_mfma_f32_16x16x32_bf16 v[116:119], v[204:207], v[244:247], v[116:119]
    v_cvt_pk_bf16_f32 v106, v108, v109
    v_cvt_pk_bf16_f32 v107, v110, v111
    v_mfma_f32_16x16x32_bf16 v[120:123], v[192:195], v[244:247], v[120:123]
    s_add_u32 s47, s48, 17408
    buffer_store_dwordx4 v[104:107], v251, s[16:19], s47 offen sc1
    v_mfma_f32_16x16x32_bf16 v[124:127], v[196:199], v[244:247], v[124:127]
    s_waitcnt lgkmcnt(2)
    v_mfma_f32_16x16x32_bf16 v[160:163], v[176:179], v[216:219], v[160:163]
    ds_read_b128 v[232:235], v253 offset:25600
    ds_read_b128 v[236:239], v253 offset:36864
    v_mfma_f32_16x16x32_bf16 v[164:167], v[208:211], v[216:219], v[164:167]
    v_mfma_f32_16x16x32_bf16 v[160:163], v[184:187], v[220:223], v[160:163]
    v_mfma_f32_16x16x32_bf16 v[164:167], v[176:179], v[220:223], v[164:167]
    s_waitcnt lgkmcnt(2)
    v_mfma_f32_16x16x32_bf16 v[128:131], v[192:195], v[224:227], v[128:131]
    ds_read_b128 v[240:243], v253 offset:26624
    ds_read_b128 v[244:247], v253 offset:37888
    v_mfma_f32_16x16x32_bf16 v[132:135], v[196:199], v[224:227], v[132:135]
    v_cvt_pk_bf16_f32 v112, v112, v113
    v_cvt_pk_bf16_f32 v113, v114, v115
    v_mfma_f32_16x16x32_bf16 v[136:139], v[168:171], v[224:227], v[136:139]
    v_cvt_pk_bf16_f32 v114, v116, v117
    v_cvt_pk_bf16_f32 v115, v118, v119
    v_mfma_f32_16x16x32_bf16 v[140:143], v[172:175], v[224:227], v[140:143]
    s_add_u32 s47, s48, 7168
    buffer_store_dwordx4 v[112:115], v251, s[16:19], s47 offen sc1
    v_mfma_f32_16x16x32_bf16 v[128:131], v[200:203], v[228:231], v[128:131]
    v_cvt_pk_bf16_f32 v120, v120, v121
    v_cvt_pk_bf16_f32 v121, v122, v123
    v_mfma_f32_16x16x32_bf16 v[132:135], v[204:207], v[228:231], v[132:135]
    v_cvt_pk_bf16_f32 v122, v124, v125
    v_cvt_pk_bf16_f32 v123, v126, v127
    v_mfma_f32_16x16x32_bf16 v[136:139], v[192:195], v[228:231], v[136:139]
    s_add_u32 s47, s48, 18432
    buffer_store_dwordx4 v[120:123], v251, s[16:19], s47 offen sc1
    v_mfma_f32_16x16x32_bf16 v[140:143], v[196:199], v[228:231], v[140:143]
    s_waitcnt lgkmcnt(2)
    v_mfma_f32_16x16x32_bf16 v[144:147], v[192:195], v[232:235], v[144:147]
    v_mfma_f32_16x16x32_bf16 v[148:151], v[196:199], v[232:235], v[148:151]
    v_mfma_f32_16x16x32_bf16 v[152:155], v[168:171], v[232:235], v[152:155]
    v_mfma_f32_16x16x32_bf16 v[156:159], v[172:175], v[232:235], v[156:159]
    v_mfma_f32_16x16x32_bf16 v[144:147], v[200:203], v[236:239], v[144:147]
    v_mfma_f32_16x16x32_bf16 v[148:151], v[204:207], v[236:239], v[148:151]
    v_mfma_f32_16x16x32_bf16 v[152:155], v[192:195], v[236:239], v[152:155]
    v_mfma_f32_16x16x32_bf16 v[156:159], v[196:199], v[236:239], v[156:159]
    s_waitcnt lgkmcnt(0)
    v_mfma_f32_16x16x32_bf16 v[160:163], v[192:195], v[240:243], v[160:163]
    v_mfma_f32_16x16x32_bf16 v[164:167], v[168:171], v[240:243], v[164:167]
    v_cvt_pk_bf16_f32 v128, v128, v129
    v_cvt_pk_bf16_f32 v129, v130, v131
    v_mfma_f32_16x16x32_bf16 v[160:163], v[200:203], v[244:247], v[160:163]
    v_cvt_pk_bf16_f32 v130, v132, v133
    v_cvt_pk_bf16_f32 v131, v134, v135
    v_mfma_f32_16x16x32_bf16 v[164:167], v[192:195], v[244:247], v[164:167]
    s_add_u32 s47, s48, 8192
    buffer_store_dwordx4 v[128:131], v251, s[16:19], s47 offen sc1
    s_nop 7
    v_cvt_pk_bf16_f32 v136, v136, v137
    v_cvt_pk_bf16_f32 v137, v138, v139
    v_cvt_pk_bf16_f32 v138, v140, v141
    v_cvt_pk_bf16_f32 v139, v142, v143
    s_add_u32 s47, s48, 19456
    buffer_store_dwordx4 v[136:139], v251, s[16:19], s47 offen sc1
    v_cvt_pk_bf16_f32 v144, v144, v145
    v_cvt_pk_bf16_f32 v145, v146, v147
    v_cvt_pk_bf16_f32 v146, v148, v149
    v_cvt_pk_bf16_f32 v147, v150, v151
    s_add_u32 s47, s48, 9216
    buffer_store_dwordx4 v[144:147], v251, s[16:19], s47 offen sc1
    v_cvt_pk_bf16_f32 v152, v152, v153
    v_cvt_pk_bf16_f32 v153, v154, v155
    v_cvt_pk_bf16_f32 v154, v156, v157
    v_cvt_pk_bf16_f32 v155, v158, v159
    s_add_u32 s47, s48, 20480
    buffer_store_dwordx4 v[152:155], v251, s[16:19], s47 offen sc1
    v_cvt_pk_bf16_f32 v160, v160, v161
    v_cvt_pk_bf16_f32 v161, v162, v163
    s_add_u32 s47, s49, 0
    buffer_store_dwordx2 v[160:161], v252, s[16:19], s47 offen sc1
    v_cvt_pk_bf16_f32 v164, v164, v165
    v_cvt_pk_bf16_f32 v165, v166, v167
    s_add_u32 s47, s49, 11264
    buffer_store_dwordx2 v[164:165], v252, s[16:19], s47 offen sc1
    s_branch L_epi_done
L_epi_b1:
    v_add_u32 v248, 0x9800, v248
    v_add_u32 v249, 0x9800, v249
    v_add_u32 v253, 38912, v250
    ds_read_b64_tr_b16 v[192:193], v248 offset:0
    ds_read_b64_tr_b16 v[194:195], v248 offset:1024
    ds_read_b64_tr_b16 v[196:197], v249 offset:0
    ds_read_b64_tr_b16 v[198:199], v249 offset:1024
    ds_read_b64_tr_b16 v[200:201], v248 offset:8192
    ds_read_b64_tr_b16 v[202:203], v248 offset:9216
    ds_read_b64_tr_b16 v[204:205], v249 offset:8192
    ds_read_b64_tr_b16 v[206:207], v249 offset:9216
    s_waitcnt lgkmcnt(10)
    v_mfma_f32_16x16x32_bf16 v[0:3], v[176:179], v[232:235], v[0:3]
    ds_read_b128 v[216:219], v250 offset:18432
    ds_read_b128 v[220:223], v250 offset:29696
    v_mfma_f32_16x16x32_bf16 v[4:7], v[180:183], v[232:235], v[4:7]
    v_mfma_f32_16x16x32_bf16 v[8:11], v[208:211], v[232:235], v[8:11]
    v_mfma_f32_16x16x32_bf16 v[12:15], v[212:215], v[232:235], v[12:15]
    v_mfma_f32_16x16x32_bf16 v[0:3], v[184:187], v[236:239], v[0:3]
    v_mfma_f32_16x16x32_bf16 v[4:7], v[188:191], v[236:239], v[4:7]
    v_mfma_f32_16x16x32_bf16 v[8:11], v[176:179], v[236:239], v[8:11]
    v_mfma_f32_16x16x32_bf16 v[12:15], v[180:183], v[236:239], v[12:15]
    s_waitcnt lgkmcnt(10)
    v_mfma_f32_16x16x32_bf16 v[16:19], v[176:179], v[240:243], v[16:19]
    ds_read_b128 v[224:227], v253 offset:16384
    ds_read_b128 v[228:231], v253 offset:27648
    v_mfma_f32_16x16x32_bf16 v[20:23], v[180:183], v[240:243], v[20:23]
    v_mfma_f32_16x16x32_bf16 v[24:27], v[208:211], v[240:243], v[24:27]
    v_mfma_f32_16x16x32_bf16 v[28:31], v[212:215], v[240:243], v[28:31]
    v_mfma_f32_16x16x32_bf16 v[16:19], v[184:187], v[244:247], v[16:19]
    v_mfma_f32_16x16x32_bf16 v[20:23], v[188:191], v[244:247], v[20:23]
    v_mfma_f32_16x16x32_bf16 v[24:27], v[176:179], v[244:247], v[24:27]
    v_mfma_f32_16x16x32_bf16 v[28:31], v[180:183], v[244:247], v[28:31]
    s_waitcnt lgkmcnt(2)
    v_mfma_f32_16x16x32_bf16 v[32:35], v[176:179], v[216:219], v[32:35]
    ds_read_b128 v[232:235], v250 offset:19456
    ds_read_b128 v[236:239], v250 offset:30720
    v_mfma_f32_16x16x32_bf16 v[36:39], v[180:183], v[216:219], v[36:39]
    v_mfma_f32_16x16x32_bf16 v[40:43], v[208:211], v[216:219], v[40:43]
    v_mfma_f32_16x16x32_bf16 v[44:47], v[212:215], v[216:219], v[44:47]
    v_mfma_f32_16x16x32_bf16 v[32:35], v[184:187], v[220:223], v[32:35]
    v_mfma_f32_16x16x32_bf16 v[36:39], v[188:191], v[220:223], v[36:39]
    v_mfma_f32_16x16x32_bf16 v[40:43], v[176:179], v[220:223], v[40:43]
    v_mfma_f32_16x16x32_bf16 v[44:47], v[180:183], v[220:223], v[44:47]
    v_xor_b32 v168, 0x80008000, v200
    v_xor_b32 v169, 0x80008000, v201
    v_xor_b32 v170, 0x80008000, v202
    v_xor_b32 v171, 0x80008000, v203
    v_xor_b32 v172, 0x80008000, v204
    v_xor_b32 v173, 0x80008000, v205
    v_xor_b32 v174, 0x80008000, v206
    v_xor_b32 v175, 0x80008000, v207
    s_waitcnt lgkmcnt(2)
    v_mfma_f32_16x16x32_bf16 v[0:3], v[192:195], v[224:227], v[0:3]
    ds_read_b128 v[240:243], v253 offset:17408
    ds_read_b128 v[244:247], v253 offset:28672
    v_mfma_f32_16x16x32_bf16 v[4:7], v[196:199], v[224:227], v[4:7]
    v_mfma_f32_16x16x32_bf16 v[8:11], v[168:171], v[224:227], v[8:11]
    v_mfma_f32_16x16x32_bf16 v[12:15], v[172:175], v[224:227], v[12:15]
    v_mfma_f32_16x16x32_bf16 v[0:3], v[200:203], v[228:231], v[0:3]
    v_mfma_f32_16x16x32_bf16 v[4:7], v[204:207], v[228:231], v[4:7]
    v_mfma_f32_16x16x32_bf16 v[8:11], v[192:195], v[228:231], v[8:11]
    v_mfma_f32_16x16x32_bf16 v[12:15], v[196:199], v[228:231], v[12:15]
    s_waitcnt lgkmcnt(2)
    v_mfma_f32_16x16x32_bf16 v[48:51], v[176:179], v[232:235], v[48:51]
    ds_read_b128 v[216:219], v250 offset:20480
    ds_read_b128 v[220:223], v250 offset:31744
    v_mfma_f32_16x16x32_bf16 v[52:55], v[180:183], v[232:235], v[52:55]
    v_mfma_f32_16x16x32_bf16 v[56:59], v[208:211], v[232:235], v[56:59]
    v_mfma_f32_16x16x32_bf16 v[60:63], v[212:215], v[232:235], v[60:63]
    v_mfma_f32_16x16x32_bf16 v[48:51], v[184:187], v[236:239], v[48:51]
    v_mfma_f32_16x16x32_bf16 v[52:55], v[188:191], v[236:239], v[52:55]
    v_mfma_f32_16x16x32_bf16 v[56:59], v[176:179], v[236:239], v[56:59]
    v_mfma_f32_16x16x32_bf16 v[60:63], v[180:183], v[236:239], v[60:63]
    s_waitcnt lgkmcnt(2)
    v_mfma_f32_16x16x32_bf16 v[16:19], v[192:195], v[240:243], v[16:19]
    ds_read_b128 v[224:227], v253 offset:18432
    ds_read_b128 v[228:231], v253 offset:29696
    v_mfma_f32_16x16x32_bf16 v[20:23], v[196:199], v[240:243], v[20:23]
    v_cvt_pk_bf16_f32 v4, v4, v5
    v_cvt_pk_bf16_f32 v5, v6, v7
    v_mfma_f32_16x16x32_bf16 v[24:27], v[168:171], v[240:243], v[24:27]
    v_cvt_pk_bf16_f32 v6, v0, v1
    v_cvt_pk_bf16_f32 v7, v2, v3
    v_mfma_f32_16x16x32_bf16 v[28:31], v[172:175], v[240:243], v[28:31]
    s_add_u32 s47, s48, 0
    buffer_store_dwordx4 v[4:7], v251, s[16:19], s47 offen sc1
    v_mfma_f32_16x16x32_bf16 v[16:19], v[200:203], v[244:247], v[16:19]
    v_cvt_pk_bf16_f32 v12, v12, v13
    v_cvt_pk_bf16_f32 v13, v14, v15
    v_mfma_f32_16x16x32_bf16 v[20:23], v[204:207], v[244:247], v[20:23]
    v_cvt_pk_bf16_f32 v14, v8, v9
    v_cvt_pk_bf16_f32 v15, v10, v11
    v_mfma_f32_16x16x32_bf16 v[24:27], v[192:195], v[244:247], v[24:27]
    s_add_u32 s47, s48, 11264
    buffer_store_dwordx4 v[12:15], v251, s[16:19], s47 offen sc1
    v_mfma_f32_16x16x32_bf16 v[28:31], v[196:199], v[244:247], v[28:31]
    s_waitcnt lgkmcnt(2)
    v_mfma_f32_16x16x32_bf16 v[64:67], v[176:179], v[216:219], v[64:67]
    ds_read_b128 v[232:235], v250 offset:21504
    ds_read_b128 v[236:239], v250 offset:32768
    v_mfma_f32_16x16x32_bf16 v[68:71], v[180:183], v[216:219], v[68:71]
    v_mfma_f32_16x16x32_bf16 v[72:75], v[208:211], v[216:219], v[72:75]
    v_mfma_f32_16x16x32_bf16 v[76:79], v[212:215], v[216:219], v[76:79]
    v_mfma_f32_16x16x32_bf16 v[64:67], v[184:187], v[220:223], v[64:67]
    v_mfma_f32_16x16x32_bf16 v[68:71], v[188:191], v[220:223], v[68:71]
    v_mfma_f32_16x16x32_bf16 v[72:75], v[176:179], v[220:223], v[72:75]
    v_mfma_f32_16x16x32_bf16 v[76:79], v[180:183], v[220:223], v[76:79]
    s_waitcnt lgkmcnt(2)
    v_mfma_f32_16x16x32_bf16 v[32:35], v[192:195], v[224:227], v[32:35]
    ds_read_b128 v[240:243], v253 offset:19456
    ds_read_b128 v[244:247], v253 offset:30720
    v_mfma_f32_16x16x32_bf16 v[36:39], v[196:199], v[224:227], v[36:39]
    v_cvt_pk_bf16_f32 v20, v20, v21
    v_cvt_pk_bf16_f32 v21, v22, v23
    v_mfma_f32_16x16x32_bf16 v[40:43], v[168:171], v[224:227], v[40:43]
    v_cvt_pk_bf16_f32 v22, v16, v17
    v_cvt_pk_bf16_f32 v23, v18, v19
    v_mfma_f32_16x16x32_bf16 v[44:47], v[172:175], v[224:227], v[44:47]
    s_add_u32 s47, s48, 1024
    buffer_store_dwordx4 v[20:23], v251, s[16:19], s47 offen sc1
    v_mfma_f32_16x16x32_bf16 v[32:35], v[200:203], v[228:231], v[32:35]
    v_cvt_pk_bf16_f32 v28, v28, v29
    v_cvt_pk_bf16_f32 v29, v30, v31
    v_mfma_f32_16x16x32_bf16 v[36:39], v[204:207], v[228:231], v[36:39]
    v_cvt_pk_bf16_f32 v30, v24, v25
    v_cvt_pk_bf16_f32 v31, v26, v27
    v_mfma_f32_16x16x32_bf16 v[40:43], v[192:195], v[228:231], v[40:43]
    s_add_u32 s47, s48, 12288
    buffer_store_dwordx4 v[28:31], v251, s[16:19], s47 offen sc1
    v_mfma_f32_16x16x32_bf16 v[44:47], v[196:199], v[228:231], v[44:47]
    s_waitcnt lgkmcnt(2)
    v_mfma_f32_16x16x32_bf16 v[80:83], v[176:179], v[232:235], v[80:83]
    ds_read_b128 v[216:219], v250 offset:22528
    ds_read_b128 v[220:223], v250 offset:33792
    v_mfma_f32_16x16x32_bf16 v[84:87], v[180:183], v[232:235], v[84:87]
    v_mfma_f32_16x16x32_bf16 v[88:91], v[208:211], v[232:235], v[88:91]
    v_mfma_f32_16x16x32_bf16 v[92:95], v[212:215], v[232:235], v[92:95]
    v_mfma_f32_16x16x32_bf16 v[80:83], v[184:187], v[236:239], v[80:83]
    v_mfma_f32_16x16x32_bf16 v[84:87], v[188:191], v[236:239], v[84:87]
    v_mfma_f32_16x16x32_bf16 v[88:91], v[176:179], v[236:239], v[88:91]
    v_mfma_f32_16x16x32_bf16 v[92:95], v[180:183], v[236:239], v[92:95]
    s_waitcnt lgkmcnt(2)
    v_mfma_f32_16x16x32_bf16 v[48:51], v[192:195], v[240:243], v[48:51]
    ds_read_b128 v[224:227], v253 offset:20480
    ds_read_b128 v[228:231], v253 offset:31744
    v_mfma_f32_16x16x32_bf16 v[52:55], v[196:199], v[240:243], v[52:55]
    v_cvt_pk_bf16_f32 v36, v36, v37
    v_cvt_pk_bf16_f32 v37, v38, v39
    v_mfma_f32_16x16x32_bf16 v[56:59], v[168:171], v[240:243], v[56:59]
    v_cvt_pk_bf16_f32 v38, v32, v33
    v_cvt_pk_bf16_f32 v39, v34, v35
    v_mfma_f32_16x16x32_bf16 v[60:63], v[172:175], v[240:243], v[60:63]
    s_add_u32 s47, s48, 2048
    buffer_store_dwordx4 v[36:39], v251, s[16:19], s47 offen sc1
    v_mfma_f32_16x16x32_bf16 v[48:51], v[200:203], v[244:247], v[48:51]
    v_cvt_pk_bf16_f32 v44, v44, v45
    v_cvt_pk_bf16_f32 v45, v46, v47
    v_mfma_f32_16x16x32_bf16 v[52:55], v[204:207], v[244:247], v[52:55]
    v_cvt_pk_bf16_f32 v46, v40, v41
    v_cvt_pk_bf16_f32 v47, v42, v43
    v_mfma_f32_16x16x32_bf16 v[56:59], v[192:195], v[244:247], v[56:59]
    s_add_u32 s47, s48, 13312
    buffer_store_dwordx4 v[44:47], v251, s[16:19], s47 offen sc1
    v_mfma_f32_16x16x32_bf16 v[60:63], v[196:199], v[244:247], v[60:63]
    s_waitcnt lgkmcnt(2)
    v_mfma_f32_16x16x32_bf16 v[96:99], v[176:179], v[216:219], v[96:99]
    ds_read_b128 v[232:235], v250 offset:23552
    ds_read_b128 v[236:239], v250 offset:34816
    v_mfma_f32_16x16x32_bf16 v[100:103], v[180:183], v[216:219], v[100:103]
    v_mfma_f32_16x16x32_bf16 v[104:107], v[208:211], v[216:219], v[104:107]
    v_mfma_f32_16x16x32_bf16 v[108:111], v[212:215], v[216:219], v[108:111]
    v_mfma_f32_16x16x32_bf16 v[96:99], v[184:187], v[220:223], v[96:99]
    v_mfma_f32_16x16x32_bf16 v[100:103], v[188:191], v[220:223], v[100:103]
    v_mfma_f32_16x16x32_bf16 v[104:107], v[176:179], v[220:223], v[104:107]
    v_mfma_f32_16x16x32_bf16 v[108:111], v[180:183], v[220:223], v[108:111]
    s_waitcnt lgkmcnt(2)
    v_mfma_f32_16x16x32_bf16 v[64:67], v[192:195], v[224:227], v[64:67]
    ds_read_b128 v[240:243], v253 offset:21504
    ds_read_b128 v[244:247], v253 offset:32768
    v_mfma_f32_16x16x32_bf16 v[68:71], v[196:199], v[224:227], v[68:71]
    v_cvt_pk_bf16_f32 v52, v52, v53
    v_cvt_pk_bf16_f32 v53, v54, v55
    v_mfma_f32_16x16x32_bf16 v[72:75], v[168:171], v[224:227], v[72:75]
    v_cvt_pk_bf16_f32 v54, v48, v49
    v_cvt_pk_bf16_f32 v55, v50, v51
    v_mfma_f32_16x16x32_bf16 v[76:79], v[172:175], v[224:227], v[76:79]
    s_add_u32 s47, s48, 3072
    buffer_store_dwordx4 v[52:55], v251, s[16:19], s47 offen sc1
    v_mfma_f32_16x16x32_bf16 v[64:67], v[200:203], v[228:231], v[64:67]
    v_cvt_pk_bf16_f32 v60, v60, v61
    v_cvt_pk_bf16_f32 v61, v62, v63
    v_mfma_f32_16x16x32_bf16 v[68:71], v[204:207], v[228:231], v[68:71]
    v_cvt_pk_bf16_f32 v62, v56, v57
    v_cvt_pk_bf16_f32 v63, v58, v59
    v_mfma_f32_16x16x32_bf16 v[72:75], v[192:195], v[228:231], v[72:75]
    s_add_u32 s47, s48, 14336
    buffer_store_dwordx4 v[60:63], v251, s[16:19], s47 offen sc1
    v_mfma_f32_16x16x32_bf16 v[76:79], v[196:199], v[228:231], v[76:79]
    s_waitcnt lgkmcnt(2)
    v_mfma_f32_16x16x32_bf16 v[112:115], v[176:179], v[232:235], v[112:115]
    ds_read_b128 v[216:219], v250 offset:24576
    ds_read_b128 v[220:223], v250 offset:35840
    v_mfma_f32_16x16x32_bf16 v[116:119], v[180:183], v[232:235], v[116:119]
    v_mfma_f32_16x16x32_bf16 v[120:123], v[208:211], v[232:235], v[120:123]
    v_mfma_f32_16x16x32_bf16 v[124:127], v[212:215], v[232:235], v[124:127]
    v_mfma_f32_16x16x32_bf16 v[112:115], v[184:187], v[236:239], v[112:115]
    v_mfma_f32_16x16x32_bf16 v[116:119], v[188:191], v[236:239], v[116:119]
    v_mfma_f32_16x16x32_bf16 v[120:123], v[176:179], v[236:239], v[120:123]
    v_mfma_f32_16x16x32_bf16 v[124:127], v[180:183], v[236:239], v[124:127]
    s_waitcnt lgkmcnt(2)
    v_mfma_f32_16x16x32_bf16 v[80:83], v[192:195], v[240:243], v[80:83]
    ds_read_b128 v[224:227], v253 offset:22528
    ds_read_b128 v[228:231], v253 offset:33792
    v_mfma_f32_16x16x32_bf16 v[84:87], v[196:199], v[240:243], v[84:87]
    v_cvt_pk_bf16_f32 v68, v68, v69
    v_cvt_pk_bf16_f32 v69, v70, v71
    v_mfma_f32_16x16x32_bf16 v[88:91], v[168:171], v[240:243], v[88:91]
    v_cvt_pk_bf16_f32 v70, v64, v65
    v_cvt_pk_bf16_f32 v71, v66, v67
    v_mfma_f32_16x16x32_bf16 v[92:95], v[172:175], v[240:243], v[92:95]
    s_add_u32 s47, s48, 4096
    buffer_store_dwordx4 v[68:71], v251, s[16:19], s47 offen sc1
    v_mfma_f32_16x16x32_bf16 v[80:83], v[200:203], v[244:247], v[80:83]
    v_cvt_pk_bf16_f32 v76, v76, v77
    v_cvt_pk_bf16_f32 v77, v78, v79
    v_mfma_f32_16x16x32_bf16 v[84:87], v[204:207], v[244:247], v[84:87]
    v_cvt_pk_bf16_f32 v78, v72, v73
    v_cvt_pk_bf16_f32 v79, v74, v75
    v_mfma_f32_16x16x32_bf16 v[88:91], v[192:195], v[244:247], v[88:91]
    s_add_u32 s47, s48, 15360
    buffer_store_dwordx4 v[76:79], v251, s[16:19], s47 offen sc1
    v_mfma_f32_16x16x32_bf16 v[92:95], v[196:199], v[244:247], v[92:95]
    s_waitcnt lgkmcnt(2)
    v_mfma_f32_16x16x32_bf16 v[128:131], v[176:179], v[216:219], v[128:131]
    ds_read_b128 v[232:235], v250 offset:25600
    ds_read_b128 v[236:239], v250 offset:36864
    v_mfma_f32_16x16x32_bf16 v[132:135], v[180:183], v[216:219], v[132:135]
    v_mfma_f32_16x16x32_bf16 v[136:139], v[208:211], v[216:219], v[136:139]
    v_mfma_f32_16x16x32_bf16 v[140:143], v[212:215], v[216:219], v[140:143]
    v_mfma_f32_16x16x32_bf16 v[128:131], v[184:187], v[220:223], v[128:131]
    v_mfma_f32_16x16x32_bf16 v[132:135], v[188:191], v[220:223], v[132:135]
    v_mfma_f32_16x16x32_bf16 v[136:139], v[176:179], v[220:223], v[136:139]
    v_mfma_f32_16x16x32_bf16 v[140:143], v[180:183], v[220:223], v[140:143]
    s_waitcnt lgkmcnt(2)
    v_mfma_f32_16x16x32_bf16 v[96:99], v[192:195], v[224:227], v[96:99]
    ds_read_b128 v[240:243], v253 offset:23552
    ds_read_b128 v[244:247], v253 offset:34816
    v_mfma_f32_16x16x32_bf16 v[100:103], v[196:199], v[224:227], v[100:103]
    v_cvt_pk_bf16_f32 v84, v84, v85
    v_cvt_pk_bf16_f32 v85, v86, v87
    v_mfma_f32_16x16x32_bf16 v[104:107], v[168:171], v[224:227], v[104:107]
    v_cvt_pk_bf16_f32 v86, v80, v81
    v_cvt_pk_bf16_f32 v87, v82, v83
    v_mfma_f32_16x16x32_bf16 v[108:111], v[172:175], v[224:227], v[108:111]
    s_add_u32 s47, s48, 5120
    buffer_store_dwordx4 v[84:87], v251, s[16:19], s47 offen sc1
    v_mfma_f32_16x16x32_bf16 v[96:99], v[200:203], v[228:231], v[96:99]
    v_cvt_pk_bf16_f32 v92, v92, v93
    v_cvt_pk_bf16_f32 v93, v94, v95
    v_mfma_f32_16x16x32_bf16 v[100:103], v[204:207], v[228:231], v[100:103]
    v_cvt_pk_bf16_f32 v94, v88, v89
    v_cvt_pk_bf16_f32 v95, v90, v91
    v_mfma_f32_16x16x32_bf16 v[104:107], v[192:195], v[228:231], v[104:107]
    s_add_u32 s47, s48, 16384
    buffer_store_dwordx4 v[92:95], v251, s[16:19], s47 offen sc1
    v_mfma_f32_16x16x32_bf16 v[108:111], v[196:199], v[228:231], v[108:111]
    s_waitcnt lgkmcnt(2)
    v_mfma_f32_16x16x32_bf16 v[144:147], v[176:179], v[232:235], v[144:147]
    ds_read_b128 v[216:219], v250 offset:26624
    ds_read_b128 v[220:223], v250 offset:37888
    v_mfma_f32_16x16x32_bf16 v[148:151], v[180:183], v[232:235], v[148:151]
    v_mfma_f32_16x16x32_bf16 v[152:155], v[208:211], v[232:235], v[152:155]
    v_mfma_f32_16x16x32_bf16 v[156:159], v[212:215], v[232:235], v[156:159]
    v_mfma_f32_16x16x32_bf16 v[144:147], v[184:187], v[236:239], v[144:147]
    v_mfma_f32_16x16x32_bf16 v[148:151], v[188:191], v[236:239], v[148:151]
    v_mfma_f32_16x16x32_bf16 v[152:155], v[176:179], v[236:239], v[152:155]
    v_mfma_f32_16x16x32_bf16 v[156:159], v[180:183], v[236:239], v[156:159]
    s_waitcnt lgkmcnt(2)
    v_mfma_f32_16x16x32_bf16 v[112:115], v[192:195], v[240:243], v[112:115]
    ds_read_b128 v[224:227], v253 offset:24576
    ds_read_b128 v[228:231], v253 offset:35840
    v_mfma_f32_16x16x32_bf16 v[116:119], v[196:199], v[240:243], v[116:119]
    v_cvt_pk_bf16_f32 v100, v100, v101
    v_cvt_pk_bf16_f32 v101, v102, v103
    v_mfma_f32_16x16x32_bf16 v[120:123], v[168:171], v[240:243], v[120:123]
    v_cvt_pk_bf16_f32 v102, v96, v97
    v_cvt_pk_bf16_f32 v103, v98, v99
    v_mfma_f32_16x16x32_bf16 v[124:127], v[172:175], v[240:243], v[124:127]
    s_add_u32 s47, s48, 6144
    buffer_store_dwordx4 v[100:103], v251, s[16:19], s47 offen sc1
    v_mfma_f32_16x16x32_bf16 v[112:115], v[200:203], v[244:247], v[112:115]
    v_cvt_pk_bf16_f32 v108, v108, v109
    v_cvt_pk_bf16_f32 v109, v110, v111
    v_mfma_f32_16x16x32_bf16 v[116:119], v[204:207], v[244:247], v[116:119]
    v_cvt_pk_bf16_f32 v110, v104, v105
    v_cvt_pk_bf16_f32 v111, v106, v107
    v_mfma_f32_16x16x32_bf16 v[120:123], v[192:195], v[244:247], v[120:123]
    s_add_u32 s47, s48, 17408
    buffer_store_dwordx4 v[108:111], v251, s[16:19], s47 offen sc1
    v_mfma_f32_16x16x32_bf16 v[124:127], v[196:199], v[244:247], v[124:127]
    s_waitcnt lgkmcnt(2)
    v_mfma_f32_16x16x32_bf16 v[160:163], v[176:179], v[216:219], v[160:163]
    ds_read_b128 v[232:235], v253 offset:25600
    ds_read_b128 v[236:239], v253 offset:36864
    v_mfma_f32_16x16x32_bf16 v[164:167], v[208:211], v[216:219], v[164:167]
    v_mfma_f32_16x16x32_bf16 v[160:163], v[184:187], v[220:223], v[160:163]
    v_mfma_f32_16x16x32_bf16 v[164:167], v[176:179], v[220:223], v[164:167]
    s_waitcnt lgkmcnt(2)
    v_mfma_f32_16x16x32_bf16 v[128:131], v[192:195], v[224:227], v[128:131]
    ds_read_b128 v[240:243], v253 offset:26624
    ds_read_b128 v[244:247], v253 offset:37888
    v_mfma_f32_16x16x32_bf16 v[132:135], v[196:199], v[224:227], v[132:135]
    v_cvt_pk_bf16_f32 v116, v116, v117
    v_cvt_pk_bf16_f32 v117, v118, v119
    v_mfma_f32_16x16x32_bf16 v[136:139], v[168:171], v[224:227], v[136:139]
    v_cvt_pk_bf16_f32 v118, v112, v113
    v_cvt_pk_bf16_f32 v119, v114, v115
    v_mfma_f32_16x16x32_bf16 v[140:143], v[172:175], v[224:227], v[140:143]
    s_add_u32 s47, s48, 7168
    buffer_store_dwordx4 v[116:119], v251, s[16:19], s47 offen sc1
    v_mfma_f32_16x16x32_bf16 v[128:131], v[200:203], v[228:231], v[128:131]
    v_cvt_pk_bf16_f32 v124, v124, v125
    v_cvt_pk_bf16_f32 v125, v126, v127
    v_mfma_f32_16x16x32_bf16 v[132:135], v[204:207], v[228:231], v[132:135]
    v_cvt_pk_bf16_f32 v126, v120, v121
    v_cvt_pk_bf16_f32 v127, v122, v123
    v_mfma_f32_16x16x32_bf16 v[136:139], v[192:195], v[228:231], v[136:139]
    s_add_u32 s47, s48, 18432
    buffer_store_dwordx4 v[124:127], v251, s[16:19], s47 offen sc1
    v_mfma_f32_16x16x32_bf16 v[140:143], v[196:199], v[228:231], v[140:143]
    s_waitcnt lgkmcnt(2)
    v_mfma_f32_16x16x32_bf16 v[144:147], v[192:195], v[232:235], v[144:147]
    v_mfma_f32_16x16x32_bf16 v[148:151], v[196:199], v[232:235], v[148:151]
    v_mfma_f32_16x16x32_bf16 v[152:155], v[168:171], v[232:235], v[152:155]
    v_mfma_f32_16x16x32_bf16 v[156:159], v[172:175], v[232:235], v[156:159]
    v_mfma_f32_16x16x32_bf16 v[144:147], v[200:203], v[236:239], v[144:147]
    v_mfma_f32_16x16x32_bf16 v[148:151], v[204:207], v[236:239], v[148:151]
    v_mfma_f32_16x16x32_bf16 v[152:155], v[192:195], v[236:239], v[152:155]
    v_mfma_f32_16x16x32_bf16 v[156:159], v[196:199], v[236:239], v[156:159]
    s_waitcnt lgkmcnt(0)
    v_mfma_f32_16x16x32_bf16 v[160:163], v[192:195], v[240:243], v[160:163]
    v_mfma_f32_16x16x32_bf16 v[164:167], v[168:171], v[240:243], v[164:167]
    v_cvt_pk_bf16_f32 v132, v132, v133
    v_cvt_pk_bf16_f32 v133, v134, v135
    v_mfma_f32_16x16x32_bf16 v[160:163], v[200:203], v[244:247], v[160:163]
    v_cvt_pk_bf16_f32 v134, v128, v129
    v_cvt_pk_bf16_f32 v135, v130, v131
    v_mfma_f32_16x16x32_bf16 v[164:167], v[192:195], v[244:247], v[164:167]
    s_add_u32 s47, s48, 8192
    buffer_store_dwordx4 v[132:135], v251, s[16:19], s47 offen sc1
    s_nop 7
    v_cvt_pk_bf16_f32 v140, v140, v141
    v_cvt_pk_bf16_f32 v141, v142, v143
    v_cvt_pk_bf16_f32 v142, v136, v137
    v_cvt_pk_bf16_f32 v143, v138, v139
    s_add_u32 s47, s48, 19456
    buffer_store_dwordx4 v[140:143], v251, s[16:19], s47 offen sc1
    v_cvt_pk_bf16_f32 v148, v148, v149
    v_cvt_pk_bf16_f32 v149, v150, v151
    v_cvt_pk_bf16_f32 v150, v144, v145
    v_cvt_pk_bf16_f32 v151, v146, v147
    s_add_u32 s47, s48, 9216
    buffer_store_dwordx4 v[148:151], v251, s[16:19], s47 offen sc1
    v_cvt_pk_bf16_f32 v156, v156, v157
    v_cvt_pk_bf16_f32 v157, v158, v159
    v_cvt_pk_bf16_f32 v158, v152, v153
    v_cvt_pk_bf16_f32 v159, v154, v155
    s_add_u32 s47, s48, 20480
    buffer_store_dwordx4 v[156:159], v251, s[16:19], s47 offen sc1
    v_cvt_pk_bf16_f32 v160, v160, v161
    v_cvt_pk_bf16_f32 v161, v162, v163
    s_add_u32 s47, s49, 0
    buffer_store_dwordx2 v[160:161], v252, s[16:19], s47 offen sc1
    v_cvt_pk_bf16_f32 v164, v164, v165
    v_cvt_pk_bf16_f32 v165, v166, v167
    s_add_u32 s47, s49, 11264
    buffer_store_dwordx2 v[164:165], v252, s[16:19], s47 offen sc1
L_epi_done:
    s_endpgm
L_fz_helper:
    s_sub_u32 s10, s10, 4
    v_and_b32 v217, 15, v0
    v_lshrrev_b32 v218, 4, v0
    v_lshlrev_b32 v231, 4, v0
    v_add_u32 v231, 116736, v231
    v_mov_b32 v230, 0
    v_lshlrev_b32 v238, 4, v0
    s_mov_b32 s30, 0x05040100
    s_mov_b32 s31, 0x07060302
    s_mov_b32 s32, 0x01000100
    s_mov_b32 s33, 0x03020302
    s_mov_b32 s40, s2
    s_add_u32 s42, s2, 256
    s_mov_b32 s55, -1
    s_mov_b32 s41, 129024
    s_mov_b32 s43, 0
    v_lshlrev_b32 v232, 14, v218
    v_lshl_add_u32 v232, v217, 4, v232
    v_lshlrev_b32 v233, 22, v218
    v_lshrrev_b32 v221, 2, v217
    v_lshl_add_u32 v233, v221, 6, v233
    v_and_b32 v221, 1, v217
    v_lshl_add_u32 v233, v221, 5, v233
    v_bfe_u32 v221, v217, 1, 1
    v_lshl_add_u32 v233, v221, 3, v233
    v_lshrrev_b32 v221, 2, v217
    s_mov_b32 s24, 688128
    v_mul_u32_u24 v234, s24, v221
    s_mov_b32 s24, 43008
    v_mad_u32_u24 v234, v218, s24, v234
    s_mov_b32 s24, 32768
    v_mul_u32_u24 v235, s24, v218
    s_cmp_ge_u32 s40, 736
    s_cbranch_scc1 L_rm0
    s_sub_u32 s28, s40, 64
    s_add_u32 s29, s40, 672
    s_cmp_ge_u32 s40, 64
    s_cselect_b32 s40, s28, s29
L_rm0:
    s_cmp_ge_u32 s42, 736
    s_cbranch_scc1 L_rm1
    s_sub_u32 s28, s42, 64
    s_add_u32 s29, s42, 672
    s_cmp_ge_u32 s42, 64
    s_cselect_b32 s42, s28, s29
L_rm1:
    s_waitcnt lgkmcnt(0)
    s_mov_b32 s16, s38
    s_and_b32 s17, s39, 0xffff
    s_mov_b32 s18, 268435456
    s_mov_b32 s19, 0x00020000
    s_mov_b32 s44, s36
    s_and_b32 s45, s37, 0xffff
    s_mov_b32 s46, 256
    s_mov_b32 s47, 0x00020000
    s_or_b32 s24, s2, s10
    s_cmp_lg_u32 s24, 0
    s_cbranch_scc1 L_nononce
    s_memrealtime s[24:25]
    s_waitcnt lgkmcnt(0)
    s_or_b32 s24, s24, 1
    v_mov_b32 v237, s24
    s_mov_b64 exec, 1
    buffer_store_dword v237, v230, s[44:47], 0 offen offset:128 sc1
    s_mov_b64 exec, -1
L_nononce:
    s_mov_b32 s54, 0
    s_cmp_ge_u32 s40, 1696
    s_cbranch_scc1 L_ld_done2
    s_cmp_ge_u32 s40, 672
    s_cbranch_scc1 L_ld_w2
    s_cmp_ge_u32 s40, 336
    s_cselect_b32 s11, 1, 0
    s_mul_i32 s12, s11, 336
    s_sub_u32 s12, s40, s12
    s_and_b32 s13, s12, 7
    s_lshr_b32 s14, s12, 3
    s_lshl_b32 s14, s14, 2
    s_add_u32 s14, s14, s10
    s_mul_i32 s15, s11, 16384000
    s_add_u32 s34, s4, s15
    s_addc_u32 s35, s5, 0
    s_mov_b32 s20, s34
    s_and_b32 s21, s35, 0xffff
    s_mov_b32 s22, 16384000
    s_mov_b32 s23, 0x00020000
    s_mul_i32 s15, s14, 98304
    s_lshl_b32 s24, s13, 8
    s_add_u32 s15, s15, s24
    s_add_u32 s25, s15, 0
    buffer_load_dwordx4 v[8:11], v232, s[20:23], s25 offen
    s_add_u32 s25, s15, 2048
    buffer_load_dwordx4 v[12:15], v232, s[20:23], s25 offen
    s_add_u32 s25, s15, 4096
    buffer_load_dwordx4 v[16:19], v232, s[20:23], s25 offen
    s_add_u32 s25, s15, 6144
    buffer_load_dwordx4 v[20:23], v232, s[20:23], s25 offen
    s_add_u32 s25, s15, 8192
    buffer_load_dwordx4 v[24:27], v232, s[20:23], s25 offen
    s_add_u32 s25, s15, 10240
    buffer_load_dwordx4 v[28:31], v232, s[20:23], s25 offen
    s_add_u32 s25, s15, 12288
    buffer_load_dwordx4 v[32:35], v232, s[20:23], s25 offen
    s_add_u32 s25, s15, 14336
    buffer_load_dwordx4 v[36:39], v232, s[20:23], s25 offen
    s_add_u32 s25, s15, 65536
    buffer_load_dwordx4 v[40:43], v232, s[20:23], s25 offen
    s_add_u32 s25, s15, 67584
    buffer_load_dwordx4 v[44:47], v232, s[20:23], s25 offen
    s_add_u32 s25, s15, 69632
    buffer_load_dwordx4 v[48:51], v232, s[20:23], s25 offen
    s_add_u32 s25, s15, 71680
    buffer_load_dwordx4 v[52:55], v232, s[20:23], s25 offen
    s_add_u32 s25, s15, 73728
    buffer_load_dwordx4 v[56:59], v232, s[20:23], s25 offen
    s_add_u32 s25, s15, 75776
    buffer_load_dwordx4 v[60:63], v232, s[20:23], s25 offen
    s_add_u32 s25, s15, 77824
    buffer_load_dwordx4 v[64:67], v232, s[20:23], s25 offen
    s_add_u32 s25, s15, 79872
    buffer_load_dwordx4 v[68:71], v232, s[20:23], s25 offen
    s_branch L_ld_done2
L_ld_w2:
    s_sub_u32 s12, s40, 672
    s_and_b32 s13, s12, 3
    s_lshr_b32 s14, s12, 2
    s_lshl_b32 s14, s14, 2
    s_add_u32 s14, s14, s10
    s_mov_b32 s20, s6
    s_and_b32 s21, s7, 0xffff
    s_mov_b32 s22, 16252928
    s_mov_b32 s23, 0x00020000
    s_lshl_b32 s15, s14, 10
    s_lshl_b32 s24, s13, 8
    s_add_u32 s15, s15, s24
    s_add_u32 s25, s15, 0
    buffer_load_dwordx2 v[8:9], v233, s[20:23], s25 offen
    buffer_load_dwordx2 v[10:11], v233, s[20:23], s25 offen offset:16
    s_add_u32 s25, s15, 1048576
    buffer_load_dwordx2 v[12:13], v233, s[20:23], s25 offen
    buffer_load_dwordx2 v[14:15], v233, s[20:23], s25 offen offset:16
    s_add_u32 s25, s15, 2097152
    buffer_load_dwordx2 v[16:17], v233, s[20:23], s25 offen
    buffer_load_dwordx2 v[18:19], v233, s[20:23], s25 offen offset:16
    s_add_u32 s25, s15, 3145728
    buffer_load_dwordx2 v[20:21], v233, s[20:23], s25 offen
    buffer_load_dwordx2 v[22:23], v233, s[20:23], s25 offen offset:16
L_ld_done2:
    v_lshrrev_b32 v221, 2, v217
    v_lshlrev_b32 v221, 1, v221
    v_bfe_u32 v222, v217, 1, 1
    v_add_u32 v221, v221, v222
    s_lshl_b32 s24, s10, 3
    v_add_u32 v221, s24, v221
    v_lshl_add_u32 v221, v221, 1, 1
    v_and_b32 v222, 1, v217
    v_lshlrev_b32 v222, 5, v222
    v_lshlrev_b32 v223, 3, v218
    v_mad_u32_u24 v168, v221, v223, v222
    v_add_u32 v169, v168, v221
    v_add_u32 v170, v169, v221
    v_add_u32 v171, v170, v221
    v_add_u32 v172, v171, v221
    v_add_u32 v173, v172, v221
    v_add_u32 v174, v173, v221
    v_add_u32 v175, v174, v221
    v_and_b32 v168, 127, v168
    v_cvt_f32_u32 v168, v168
    v_mul_f32 v168, 0x3c000000, v168
    v_cos_f32 v168, v168
    v_and_b32 v169, 127, v169
    v_cvt_f32_u32 v169, v169
    v_mul_f32 v169, 0x3c000000, v169
    v_cos_f32 v169, v169
    v_and_b32 v170, 127, v170
    v_cvt_f32_u32 v170, v170
    v_mul_f32 v170, 0x3c000000, v170
    v_cos_f32 v170, v170
    v_and_b32 v171, 127, v171
    v_cvt_f32_u32 v171, v171
    v_mul_f32 v171, 0x3c000000, v171
    v_cos_f32 v171, v171
    v_and_b32 v172, 127, v172
    v_cvt_f32_u32 v172, v172
    v_mul_f32 v172, 0x3c000000, v172
    v_cos_f32 v172, v172
    v_and_b32 v173, 127, v173
    v_cvt_f32_u32 v173, v173
    v_mul_f32 v173, 0x3c000000, v173
    v_cos_f32 v173, v173
    v_and_b32 v174, 127, v174
    v_cvt_f32_u32 v174, v174
    v_mul_f32 v174, 0x3c000000, v174
    v_cos_f32 v174, v174
    v_and_b32 v175, 127, v175
    v_cvt_f32_u32 v175, v175
    v_mul_f32 v175, 0x3c000000, v175
    v_cos_f32 v175, v175
    v_cvt_pk_bf16_f32 v184, v168, v169
    v_cvt_pk_bf16_f32 v185, v170, v171
    v_cvt_pk_bf16_f32 v186, v172, v173
    v_cvt_pk_bf16_f32 v187, v174, v175
    s_lshl_b32 s24, s10, 11
    v_add_u32 v224, s24, v231
    ds_write_b128 v224, v[184:187] offset:0
    v_lshlrev_b32 v223, 3, v218
    v_add_u32 v223, 32, v223
    v_mad_u32_u24 v168, v221, v223, v222
    v_add_u32 v169, v168, v221
    v_add_u32 v170, v169, v221
    v_add_u32 v171, v170, v221
    v_add_u32 v172, v171, v221
    v_add_u32 v173, v172, v221
    v_add_u32 v174, v173, v221
    v_add_u32 v175, v174, v221
    v_and_b32 v168, 127, v168
    v_cvt_f32_u32 v168, v168
    v_mul_f32 v168, 0x3c000000, v168
    v_cos_f32 v168, v168
    v_and_b32 v169, 127, v169
    v_cvt_f32_u32 v169, v169
    v_mul_f32 v169, 0x3c000000, v169
    v_cos_f32 v169, v169
    v_and_b32 v170, 127, v170
    v_cvt_f32_u32 v170, v170
    v_mul_f32 v170, 0x3c000000, v170
    v_cos_f32 v170, v170
    v_and_b32 v171, 127, v171
    v_cvt_f32_u32 v171, v171
    v_mul_f32 v171, 0x3c000000, v171
    v_cos_f32 v171, v171
    v_and_b32 v172, 127, v172
    v_cvt_f32_u32 v172, v172
    v_mul_f32 v172, 0x3c000000, v172
    v_cos_f32 v172, v172
    v_and_b32 v173, 127, v173
    v_cvt_f32_u32 v173, v173
    v_mul_f32 v173, 0x3c000000, v173
    v_cos_f32 v173, v173
    v_and_b32 v174, 127, v174
    v_cvt_f32_u32 v174, v174
    v_mul_f32 v174, 0x3c000000, v174
    v_cos_f32 v174, v174
    v_and_b32 v175, 127, v175
    v_cvt_f32_u32 v175, v175
    v_mul_f32 v175, 0x3c000000, v175
    v_cos_f32 v175, v175
    v_cvt_pk_bf16_f32 v184, v168, v169
    v_cvt_pk_bf16_f32 v185, v170, v171
    v_cvt_pk_bf16_f32 v186, v172, v173
    v_cvt_pk_bf16_f32 v187, v174, v175
    s_lshl_b32 s24, s10, 11
    v_add_u32 v224, s24, v231
    ds_write_b128 v224, v[184:187] offset:1024
    v_lshlrev_b32 v223, 2, v218
    v_mad_u32_u24 v168, v221, v223, v222
    v_add_u32 v169, v168, v221
    v_add_u32 v170, v169, v221
    v_add_u32 v171, v170, v221
    v_and_b32 v168, 127, v168
    v_cvt_f32_u32 v168, v168
    v_mul_f32 v168, 0x3c000000, v168
    v_cos_f32 v168, v168
    v_and_b32 v169, 127, v169
    v_cvt_f32_u32 v169, v169
    v_mul_f32 v169, 0x3c000000, v169
    v_cos_f32 v169, v169
    v_and_b32 v170, 127, v170
    v_cvt_f32_u32 v170, v170
    v_mul_f32 v170, 0x3c000000, v170
    v_cos_f32 v170, v170
    v_and_b32 v171, 127, v171
    v_cvt_f32_u32 v171, v171
    v_mul_f32 v171, 0x3c000000, v171
    v_cos_f32 v171, v171
    v_cvt_pk_bf16_f32 v188, v168, v168
    v_lshlrev_b32 v189, 16, v188
    v_sub_f32 v189, v168, v189
    v_cvt_pk_bf16_f32 v189, v189, v189
    v_perm_b32 v184, v189, v188, s30
    v_cvt_pk_bf16_f32 v188, v169, v169
    v_lshlrev_b32 v189, 16, v188
    v_sub_f32 v189, v169, v189
    v_cvt_pk_bf16_f32 v189, v189, v189
    v_perm_b32 v185, v189, v188, s30
    v_cvt_pk_bf16_f32 v188, v170, v170
    v_lshlrev_b32 v189, 16, v188
    v_sub_f32 v189, v170, v189
    v_cvt_pk_bf16_f32 v189, v189, v189
    v_perm_b32 v186, v189, v188, s30
    v_cvt_pk_bf16_f32 v188, v171, v171
    v_lshlrev_b32 v189, 16, v188
    v_sub_f32 v189, v171, v189
    v_cvt_pk_bf16_f32 v189, v189, v189
    v_perm_b32 v187, v189, v188, s30
    s_lshl_b32 s24, s10, 10
    v_add_u32 v224, s24, v231
    ds_write_b128 v224, v[184:187] offset:8192
    s_waitcnt lgkmcnt(0)
    s_barrier
L_x_loop:
    s_cmp_lg_u32 s10, 0
    s_cbranch_scc1 L_nofetch0
    v_mov_b32 v229, 1
    s_mov_b64 exec, 1
    buffer_atomic_add v229, v230, s[44:47], 0 offen sc0 sc1
    s_mov_b64 exec, -1
L_nofetch0:
    s_cmp_ge_u32 s42, 1696
    s_cbranch_scc1 L_ld_done3
    s_cmp_ge_u32 s42, 672
    s_cbranch_scc1 L_ld_w3
    s_cmp_ge_u32 s42, 336
    s_cselect_b32 s11, 1, 0
    s_mul_i32 s12, s11, 336
    s_sub_u32 s12, s42, s12
    s_and_b32 s13, s12, 7
    s_lshr_b32 s14, s12, 3
    s_lshl_b32 s14, s14, 2
    s_add_u32 s14, s14, s10
    s_mul_i32 s15, s11, 16384000
    s_add_u32 s34, s4, s15
    s_addc_u32 s35, s5, 0
    s_mov_b32 s20, s34
    s_and_b32 s21, s35, 0xffff
    s_mov_b32 s22, 16384000
    s_mov_b32 s23, 0x00020000
    s_mul_i32 s15, s14, 98304
    s_lshl_b32 s24, s13, 8
    s_add_u32 s15, s15, s24
    s_add_u32 s25, s15, 0
    buffer_load_dwordx4 v[72:75], v232, s[20:23], s25 offen
    s_add_u32 s25, s15, 2048
    buffer_load_dwordx4 v[76:79], v232, s[20:23], s25 offen
    s_add_u32 s25, s15, 4096
    buffer_load_dwordx4 v[80:83], v232, s[20:23], s25 offen
    s_add_u32 s25, s15, 6144
    buffer_load_dwordx4 v[84:87], v232, s[20:23], s25 offen
    s_add_u32 s25, s15, 8192
    buffer_load_dwordx4 v[88:91], v232, s[20:23], s25 offen
    s_add_u32 s25, s15, 10240
    buffer_load_dwordx4 v[92:95], v232, s[20:23], s25 offen
    s_add_u32 s25, s15, 12288
    buffer_load_dwordx4 v[96:99], v232, s[20:23], s25 offen
    s_add_u32 s25, s15, 14336
    buffer_load_dwordx4 v[100:103], v232, s[20:23], s25 offen
    s_add_u32 s25, s15, 65536
    buffer_load_dwordx4 v[104:107], v232, s[20:23], s25 offen
    s_add_u32 s25, s15, 67584
    buffer_load_dwordx4 v[108:111], v232, s[20:23], s25 offen
    s_add_u32 s25, s15, 69632
    buffer_load_dwordx4 v[112:115], v232, s[20:23], s25 offen
    s_add_u32 s25, s15, 71680
    buffer_load_dwordx4 v[116:119], v232, s[20:23], s25 offen
    s_add_u32 s25, s15, 73728
    buffer_load_dwordx4 v[120:123], v232, s[20:23], s25 offen
    s_add_u32 s25, s15, 75776
    buffer_load_dwordx4 v[124:127], v232, s[20:23], s25 offen
    s_add_u32 s25, s15, 77824
    buffer_load_dwordx4 v[128:131], v232, s[20:23], s25 offen
    s_add_u32 s25, s15, 79872
    buffer_load_dwordx4 v[132:135], v232, s[20:23], s25 offen
    s_branch L_ld_done3
L_ld_w3:
    s_sub_u32 s12, s42, 672
    s_and_b32 s13, s12, 3
    s_lshr_b32 s14, s12, 2
    s_lshl_b32 s14, s14, 2
    s_add_u32 s14, s14, s10
    s_mov_b32 s20, s6
    s_and_b32 s21, s7, 0xffff
    s_mov_b32 s22, 16252928
    s_mov_b32 s23, 0x00020000
    s_lshl_b32 s15, s14, 10
    s_lshl_b32 s24, s13, 8
    s_add_u32 s15, s15, s24
    s_add_u32 s25, s15, 0
    buffer_load_dwordx2 v[72:73], v233, s[20:23], s25 offen
    buffer_load_dwordx2 v[74:75], v233, s[20:23], s25 offen offset:16
    s_add_u32 s25, s15, 1048576
    buffer_load_dwordx2 v[76:77], v233, s[20:23], s25 offen
    buffer_load_dwordx2 v[78:79], v233, s[20:23], s25 offen offset:16
    s_add_u32 s25, s15, 2097152
    buffer_load_dwordx2 v[80:81], v233, s[20:23], s25 offen
    buffer_load_dwordx2 v[82:83], v233, s[20:23], s25 offen offset:16
    s_add_u32 s25, s15, 3145728
    buffer_load_dwordx2 v[84:85], v233, s[20:23], s25 offen
    buffer_load_dwordx2 v[86:87], v233, s[20:23], s25 offen offset:16
L_ld_done3:
    s_cmp_lg_u32 s43, 0
    s_cbranch_scc1 L_notfirst
    s_cmp_ge_u32 s42, 1696
    s_cbranch_scc1 L_w0_f
    s_cmp_ge_u32 s42, 672
    s_cbranch_scc1 L_w8_f
    s_waitcnt vmcnt(16)
    s_branch L_wd_f
L_w8_f:
    s_waitcnt vmcnt(8)
    s_branch L_wd_f
L_w0_f:
    s_waitcnt vmcnt(0)
L_wd_f:
    s_mov_b32 s43, 1
    s_branch L_wfin
L_notfirst:
    s_cmp_ge_u32 s42, 1696
    s_cbranch_scc1 L_w0_a0
    s_cmp_ge_u32 s42, 672
    s_cbranch_scc1 L_w8_a0
    s_waitcnt vmcnt(32)
    s_branch L_wd_a0
L_w8_a0:
    s_waitcnt vmcnt(24)
    s_branch L_wd_a0
L_w0_a0:
    s_waitcnt vmcnt(16)
L_wd_a0:
L_wfin:
    s_cmp_ge_u32 s40, 672
    s_cbranch_scc1 L_cw0
    s_cmp_ge_u32 s40, 336
    s_cselect_b32 s11, 1, 0
    s_mul_i32 s12, s11, 336
    s_sub_u32 s12, s40, s12
    s_and_b32 s13, s12, 7
    s_lshr_b32 s14, s12, 3
    s_lshl_b32 s14, s14, 2
    s_add_u32 s14, s14, s10
    ds_read_b128 v[136:139], v231 offset:0
    ds_read_b128 v[140:143], v231 offset:1024
    ds_read_b128 v[144:147], v231 offset:2048
    ds_read_b128 v[148:151], v231 offset:3072
    ds_read_b128 v[152:155], v231 offset:4096
    ds_read_b128 v[156:159], v231 offset:5120
    ds_read_b128 v[160:163], v231 offset:6144
    ds_read_b128 v[164:167], v231 offset:7168
    s_bfe_u32 s24, s14, 0x10003
    s_mul_i32 s24, s24, 3
    v_and_b32 v221, 3, v217
    v_xor_b32 v221, s24, v221
    v_lshl_add_u32 v220, v221, 4, v234
    s_mul_i32 s24, s11, 22020096
    s_mul_i32 s25, s13, 2752512
    s_add_u32 s24, s24, s25
    s_lshl_b32 s25, s14, 6
    s_add_u32 s24, s24, s25
    s_add_u32 s24, s24, 67108864
    v_perm_b32 v168, v12, v8, s30
    v_perm_b32 v169, v20, v16, s30
    v_perm_b32 v170, v28, v24, s30
    v_perm_b32 v171, v36, v32, s30
    v_perm_b32 v172, v12, v8, s31
    v_perm_b32 v173, v20, v16, s31
    v_perm_b32 v174, v28, v24, s31
    v_perm_b32 v175, v36, v32, s31
    v_perm_b32 v176, v44, v40, s30
    v_perm_b32 v177, v52, v48, s30
    v_perm_b32 v178, v60, v56, s30
    v_perm_b32 v179, v68, v64, s30
    v_perm_b32 v180, v44, v40, s31
    v_perm_b32 v181, v52, v48, s31
    v_perm_b32 v182, v60, v56, s31
    v_perm_b32 v183, v68, v64, s31
    s_waitcnt lgkmcnt(0)
    v_mfma_f32_16x16x32_bf16 v[184:187], v[136:139], v[168:171], 0
    v_mfma_f32_16x16x32_bf16 v[188:191], v[136:139], v[172:175], 0
    v_mfma_f32_16x16x32_bf16 v[192:195], v[144:147], v[168:171], 0
    v_mfma_f32_16x16x32_bf16 v[196:199], v[144:147], v[172:175], 0
    v_mfma_f32_16x16x32_bf16 v[200:203], v[152:155], v[168:171], 0
    v_mfma_f32_16x16x32_bf16 v[204:207], v[152:155], v[172:175], 0
    v_mfma_f32_16x16x32_bf16 v[208:211], v[160:163], v[168:171], 0
    v_mfma_f32_16x16x32_bf16 v[212:215], v[160:163], v[172:175], 0
    v_mfma_f32_16x16x32_bf16 v[184:187], v[140:143], v[176:179], v[184:187]
    v_mfma_f32_16x16x32_bf16 v[188:191], v[140:143], v[180:183], v[188:191]
    v_mfma_f32_16x16x32_bf16 v[192:195], v[148:151], v[176:179], v[192:195]
    v_mfma_f32_16x16x32_bf16 v[196:199], v[148:151], v[180:183], v[196:199]
    v_mfma_f32_16x16x32_bf16 v[200:203], v[156:159], v[176:179], v[200:203]
    v_mfma_f32_16x16x32_bf16 v[204:207], v[156:159], v[180:183], v[204:207]
    v_mfma_f32_16x16x32_bf16 v[208:211], v[164:167], v[176:179], v[208:211]
    v_mfma_f32_16x16x32_bf16 v[212:215], v[164:167], v[180:183], v[212:215]
    v_perm_b32 v168, v13, v9, s30
    v_perm_b32 v169, v21, v17, s30
    v_perm_b32 v170, v29, v25, s30
    v_perm_b32 v171, v37, v33, s30
    v_perm_b32 v172, v13, v9, s31
    v_perm_b32 v173, v21, v17, s31
    v_perm_b32 v174, v29, v25, s31
    v_perm_b32 v175, v37, v33, s31
    v_perm_b32 v176, v45, v41, s30
    v_perm_b32 v177, v53, v49, s30
    v_perm_b32 v178, v61, v57, s30
    v_perm_b32 v179, v69, v65, s30
    v_perm_b32 v180, v45, v41, s31
    v_perm_b32 v181, v53, v49, s31
    v_perm_b32 v182, v61, v57, s31
    v_perm_b32 v183, v69, v65, s31
    v_cvt_pk_bf16_f32 v8, v184, v188
    v_cvt_pk_bf16_f32 v12, v185, v189
    v_cvt_pk_bf16_f32 v16, v186, v190
    v_cvt_pk_bf16_f32 v20, v187, v191
    v_cvt_pk_bf16_f32 v24, v192, v196
    v_cvt_pk_bf16_f32 v28, v193, v197
    v_cvt_pk_bf16_f32 v32, v194, v198
    v_cvt_pk_bf16_f32 v36, v195, v199
    v_cvt_pk_bf16_f32 v40, v200, v204
    v_cvt_pk_bf16_f32 v44, v201, v205
    v_cvt_pk_bf16_f32 v48, v202, v206
    v_cvt_pk_bf16_f32 v52, v203, v207
    v_cvt_pk_bf16_f32 v56, v208, v212
    v_cvt_pk_bf16_f32 v60, v209, v213
    v_cvt_pk_bf16_f32 v64, v210, v214
    v_cvt_pk_bf16_f32 v68, v211, v215
    v_mfma_f32_16x16x32_bf16 v[184:187], v[136:139], v[168:171], 0
    v_mfma_f32_16x16x32_bf16 v[188:191], v[136:139], v[172:175], 0
    v_mfma_f32_16x16x32_bf16 v[192:195], v[144:147], v[168:171], 0
    v_mfma_f32_16x16x32_bf16 v[196:199], v[144:147], v[172:175], 0
    v_mfma_f32_16x16x32_bf16 v[200:203], v[152:155], v[168:171], 0
    v_mfma_f32_16x16x32_bf16 v[204:207], v[152:155], v[172:175], 0
    v_mfma_f32_16x16x32_bf16 v[208:211], v[160:163], v[168:171], 0
    v_mfma_f32_16x16x32_bf16 v[212:215], v[160:163], v[172:175], 0
    v_mfma_f32_16x16x32_bf16 v[184:187], v[140:143], v[176:179], v[184:187]
    v_mfma_f32_16x16x32_bf16 v[188:191], v[140:143], v[180:183], v[188:191]
    v_mfma_f32_16x16x32_bf16 v[192:195], v[148:151], v[176:179], v[192:195]
    v_mfma_f32_16x16x32_bf16 v[196:199], v[148:151], v[180:183], v[196:199]
    v_mfma_f32_16x16x32_bf16 v[200:203], v[156:159], v[176:179], v[200:203]
    v_mfma_f32_16x16x32_bf16 v[204:207], v[156:159], v[180:183], v[204:207]
    v_mfma_f32_16x16x32_bf16 v[208:211], v[164:167], v[176:179], v[208:211]
    v_mfma_f32_16x16x32_bf16 v[212:215], v[164:167], v[180:183], v[212:215]
    v_perm_b32 v168, v14, v10, s30
    v_perm_b32 v169, v22, v18, s30
    v_perm_b32 v170, v30, v26, s30
    v_perm_b32 v171, v38, v34, s30
    v_perm_b32 v172, v14, v10, s31
    v_perm_b32 v173, v22, v18, s31
    v_perm_b32 v174, v30, v26, s31
    v_perm_b32 v175, v38, v34, s31
    v_perm_b32 v176, v46, v42, s30
    v_perm_b32 v177, v54, v50, s30
    v_perm_b32 v178, v62, v58, s30
    v_perm_b32 v179, v70, v66, s30
    v_perm_b32 v180, v46, v42, s31
    v_perm_b32 v181, v54, v50, s31
    v_perm_b32 v182, v62, v58, s31
    v_perm_b32 v183, v70, v66, s31
    v_cvt_pk_bf16_f32 v9, v184, v188
    v_cvt_pk_bf16_f32 v13, v185, v189
    v_cvt_pk_bf16_f32 v17, v186, v190
    v_cvt_pk_bf16_f32 v21, v187, v191
    v_cvt_pk_bf16_f32 v25, v192, v196
    v_cvt_pk_bf16_f32 v29, v193, v197
    v_cvt_pk_bf16_f32 v33, v194, v198
    v_cvt_pk_bf16_f32 v37, v195, v199
    v_cvt_pk_bf16_f32 v41, v200, v204
    v_cvt_pk_bf16_f32 v45, v201, v205
    v_cvt_pk_bf16_f32 v49, v202, v206
    v_cvt_pk_bf16_f32 v53, v203, v207
    v_cvt_pk_bf16_f32 v57, v208, v212
    v_cvt_pk_bf16_f32 v61, v209, v213
    v_cvt_pk_bf16_f32 v65, v210, v214
    v_cvt_pk_bf16_f32 v69, v211, v215
    v_mfma_f32_16x16x32_bf16 v[184:187], v[136:139], v[168:171], 0
    v_mfma_f32_16x16x32_bf16 v[188:191], v[136:139], v[172:175], 0
    v_mfma_f32_16x16x32_bf16 v[192:195], v[144:147], v[168:171], 0
    v_mfma_f32_16x16x32_bf16 v[196:199], v[144:147], v[172:175], 0
    v_mfma_f32_16x16x32_bf16 v[200:203], v[152:155], v[168:171], 0
    v_mfma_f32_16x16x32_bf16 v[204:207], v[152:155], v[172:175], 0
    v_mfma_f32_16x16x32_bf16 v[208:211], v[160:163], v[168:171], 0
    v_mfma_f32_16x16x32_bf16 v[212:215], v[160:163], v[172:175], 0
    v_mfma_f32_16x16x32_bf16 v[184:187], v[140:143], v[176:179], v[184:187]
    v_mfma_f32_16x16x32_bf16 v[188:191], v[140:143], v[180:183], v[188:191]
    v_mfma_f32_16x16x32_bf16 v[192:195], v[148:151], v[176:179], v[192:195]
    v_mfma_f32_16x16x32_bf16 v[196:199], v[148:151], v[180:183], v[196:199]
    v_mfma_f32_16x16x32_bf16 v[200:203], v[156:159], v[176:179], v[200:203]
    v_mfma_f32_16x16x32_bf16 v[204:207], v[156:159], v[180:183], v[204:207]
    v_mfma_f32_16x16x32_bf16 v[208:211], v[164:167], v[176:179], v[208:211]
    v_mfma_f32_16x16x32_bf16 v[212:215], v[164:167], v[180:183], v[212:215]
    v_perm_b32 v168, v15, v11, s30
    v_perm_b32 v169, v23, v19, s30
    v_perm_b32 v170, v31, v27, s30
    v_perm_b32 v171, v39, v35, s30
    v_perm_b32 v172, v15, v11, s31
    v_perm_b32 v173, v23, v19, s31
    v_perm_b32 v174, v31, v27, s31
    v_perm_b32 v175, v39, v35, s31
    v_perm_b32 v176, v47, v43, s30
    v_perm_b32 v177, v55, v51, s30
    v_perm_b32 v178, v63, v59, s30
    v_perm_b32 v179, v71, v67, s30
    v_perm_b32 v180, v47, v43, s31
    v_perm_b32 v181, v55, v51, s31
    v_perm_b32 v182, v63, v59, s31
    v_perm_b32 v183, v71, v67, s31
    v_cvt_pk_bf16_f32 v10, v184, v188
    v_cvt_pk_bf16_f32 v14, v185, v189
    v_cvt_pk_bf16_f32 v18, v186, v190
    v_cvt_pk_bf16_f32 v22, v187, v191
    v_cvt_pk_bf16_f32 v26, v192, v196
    v_cvt_pk_bf16_f32 v30, v193, v197
    v_cvt_pk_bf16_f32 v34, v194, v198
    v_cvt_pk_bf16_f32 v38, v195, v199
    v_cvt_pk_bf16_f32 v42, v200, v204
    v_cvt_pk_bf16_f32 v46, v201, v205
    v_cvt_pk_bf16_f32 v50, v202, v206
    v_cvt_pk_bf16_f32 v54, v203, v207
    v_cvt_pk_bf16_f32 v58, v208, v212
    v_cvt_pk_bf16_f32 v62, v209, v213
    v_cvt_pk_bf16_f32 v66, v210, v214
    v_cvt_pk_bf16_f32 v70, v211, v215
    v_mfma_f32_16x16x32_bf16 v[184:187], v[136:139], v[168:171], 0
    v_mfma_f32_16x16x32_bf16 v[188:191], v[136:139], v[172:175], 0
    v_mfma_f32_16x16x32_bf16 v[192:195], v[144:147], v[168:171], 0
    v_mfma_f32_16x16x32_bf16 v[196:199], v[144:147], v[172:175], 0
    v_mfma_f32_16x16x32_bf16 v[200:203], v[152:155], v[168:171], 0
    v_mfma_f32_16x16x32_bf16 v[204:207], v[152:155], v[172:175], 0
    v_mfma_f32_16x16x32_bf16 v[208:211], v[160:163], v[168:171], 0
    v_mfma_f32_16x16x32_bf16 v[212:215], v[160:163], v[172:175], 0
    v_mfma_f32_16x16x32_bf16 v[184:187], v[140:143], v[176:179], v[184:187]
    v_mfma_f32_16x16x32_bf16 v[188:191], v[140:143], v[180:183], v[188:191]
    v_mfma_f32_16x16x32_bf16 v[192:195], v[148:151], v[176:179], v[192:195]
    v_mfma_f32_16x16x32_bf16 v[196:199], v[148:151], v[180:183], v[196:199]
    v_mfma_f32_16x16x32_bf16 v[200:203], v[156:159], v[176:179], v[200:203]
    v_mfma_f32_16x16x32_bf16 v[204:207], v[156:159], v[180:183], v[204:207]
    v_mfma_f32_16x16x32_bf16 v[208:211], v[164:167], v[176:179], v[208:211]
    v_mfma_f32_16x16x32_bf16 v[212:215], v[164:167], v[180:183], v[212:215]
    s_nop 1
    v_cvt_pk_bf16_f32 v11, v184, v188
    v_cvt_pk_bf16_f32 v15, v185, v189
    v_cvt_pk_bf16_f32 v19, v186, v190
    v_cvt_pk_bf16_f32 v23, v187, v191
    v_cvt_pk_bf16_f32 v27, v192, v196
    v_cvt_pk_bf16_f32 v31, v193, v197
    v_cvt_pk_bf16_f32 v35, v194, v198
    v_cvt_pk_bf16_f32 v39, v195, v199
    v_cvt_pk_bf16_f32 v43, v200, v204
    v_cvt_pk_bf16_f32 v47, v201, v205
    v_cvt_pk_bf16_f32 v51, v202, v206
    v_cvt_pk_bf16_f32 v55, v203, v207
    v_cvt_pk_bf16_f32 v59, v208, v212
    v_cvt_pk_bf16_f32 v63, v209, v213
    v_cvt_pk_bf16_f32 v67, v210, v214
    v_cvt_pk_bf16_f32 v71, v211, v215
    s_add_u32 s25, s24, 0
    buffer_store_dwordx4 v[8:11], v220, s[16:19], s25 offen sc1
    s_add_u32 s25, s24, 10752
    buffer_store_dwordx4 v[12:15], v220, s[16:19], s25 offen sc1
    s_add_u32 s25, s24, 21504
    buffer_store_dwordx4 v[16:19], v220, s[16:19], s25 offen sc1
    s_add_u32 s25, s24, 32256
    buffer_store_dwordx4 v[20:23], v220, s[16:19], s25 offen sc1
    s_add_u32 s25, s24, 172032
    buffer_store_dwordx4 v[24:27], v220, s[16:19], s25 offen sc1
    s_add_u32 s25, s24, 182784
    buffer_store_dwordx4 v[28:31], v220, s[16:19], s25 offen sc1
    s_add_u32 s25, s24, 193536
    buffer_store_dwordx4 v[32:35], v220, s[16:19], s25 offen sc1
    s_add_u32 s25, s24, 204288
    buffer_store_dwordx4 v[36:39], v220, s[16:19], s25 offen sc1
    s_add_u32 s25, s24, 344064
    buffer_store_dwordx4 v[40:43], v220, s[16:19], s25 offen sc1
    s_add_u32 s25, s24, 354816
    buffer_store_dwordx4 v[44:47], v220, s[16:19], s25 offen sc1
    s_add_u32 s25, s24, 365568
    buffer_store_dwordx4 v[48:51], v220, s[16:19], s25 offen sc1
    s_add_u32 s25, s24, 376320
    buffer_store_dwordx4 v[52:55], v220, s[16:19], s25 offen sc1
    s_add_u32 s25, s24, 516096
    buffer_store_dwordx4 v[56:59], v220, s[16:19], s25 offen sc1
    s_add_u32 s25, s24, 526848
    buffer_store_dwordx4 v[60:63], v220, s[16:19], s25 offen sc1
    s_add_u32 s25, s24, 537600
    buffer_store_dwordx4 v[64:67], v220, s[16:19], s25 offen sc1
    s_add_u32 s25, s24, 548352
    buffer_store_dwordx4 v[68:71], v220, s[16:19], s25 offen sc1
    s_branch L_next0
L_cw0:
    s_sub_u32 s12, s40, 672
    s_and_b32 s13, s12, 3
    s_lshr_b32 s14, s12, 2
    s_lshl_b32 s14, s14, 2
    s_add_u32 s14, s14, s10
    ds_read_b128 v[136:139], v231 offset:8192
    ds_read_b128 v[140:143], v231 offset:9216
    ds_read_b128 v[144:147], v231 offset:10240
    ds_read_b128 v[148:151], v231 offset:11264
    s_and_b32 s24, s14, 3
    s_bfe_u32 s25, s14, 0x10003
    s_lshl_b32 s25, s25, 2
    s_or_b32 s24, s24, s25
    s_lshl_b32 s24, s24, 1
    v_xor_b32 v221, s24, v217
    v_lshl_add_u32 v220, v221, 4, v235
    s_mul_i32 s24, s13, 16777216
    s_lshr_b32 s25, s14, 5
    s_mul_i32 s25, s25, 524288
    s_add_u32 s24, s24, s25
    s_and_b32 s25, s14, 31
    s_lshl_b32 s25, s25, 8
    s_add_u32 s24, s24, s25
    v_perm_b32 v24, v8, v8, s32
    v_perm_b32 v25, v12, v12, s32
    v_perm_b32 v26, v16, v16, s32
    v_perm_b32 v27, v20, v20, s32
    v_perm_b32 v28, v8, v8, s33
    v_perm_b32 v29, v12, v12, s33
    v_perm_b32 v30, v16, v16, s33
    v_perm_b32 v31, v20, v20, s33
    v_perm_b32 v32, v9, v9, s32
    v_perm_b32 v33, v13, v13, s32
    v_perm_b32 v34, v17, v17, s32
    v_perm_b32 v35, v21, v21, s32
    v_perm_b32 v36, v9, v9, s33
    v_perm_b32 v37, v13, v13, s33
    v_perm_b32 v38, v17, v17, s33
    v_perm_b32 v39, v21, v21, s33
    v_perm_b32 v40, v10, v10, s32
    v_perm_b32 v41, v14, v14, s32
    v_perm_b32 v42, v18, v18, s32
    v_perm_b32 v43, v22, v22, s32
    v_perm_b32 v44, v10, v10, s33
    v_perm_b32 v45, v14, v14, s33
    v_perm_b32 v46, v18, v18, s33
    v_perm_b32 v47, v22, v22, s33
    v_perm_b32 v48, v11, v11, s32
    v_perm_b32 v49, v15, v15, s32
    v_perm_b32 v50, v19, v19, s32
    v_perm_b32 v51, v23, v23, s32
    v_perm_b32 v52, v11, v11, s33
    v_perm_b32 v53, v15, v15, s33
    v_perm_b32 v54, v19, v19, s33
    v_perm_b32 v55, v23, v23, s33
    s_waitcnt lgkmcnt(0)
    v_mfma_f32_16x16x32_bf16 v[184:187], v[136:139], v[24:27], 0
    v_mfma_f32_16x16x32_bf16 v[188:191], v[136:139], v[28:31], 0
    v_mfma_f32_16x16x32_bf16 v[192:195], v[136:139], v[32:35], 0
    v_mfma_f32_16x16x32_bf16 v[196:199], v[136:139], v[36:39], 0
    v_mfma_f32_16x16x32_bf16 v[200:203], v[136:139], v[40:43], 0
    v_mfma_f32_16x16x32_bf16 v[204:207], v[136:139], v[44:47], 0
    v_mfma_f32_16x16x32_bf16 v[208:211], v[136:139], v[48:51], 0
    v_mfma_f32_16x16x32_bf16 v[212:215], v[136:139], v[52:55], 0
    s_nop 1
    v_cvt_pk_bf16_f32 v8, v184, v188
    s_nop 0
    v_cvt_pk_bf16_f32 v9, v192, v196
    s_nop 0
    v_cvt_pk_bf16_f32 v10, v200, v204
    s_nop 0
    v_cvt_pk_bf16_f32 v11, v208, v212
    v_cvt_pk_bf16_f32 v12, v185, v189
    v_cvt_pk_bf16_f32 v13, v193, v197
    v_cvt_pk_bf16_f32 v14, v201, v205
    v_cvt_pk_bf16_f32 v15, v209, v213
    v_cvt_pk_bf16_f32 v16, v186, v190
    v_cvt_pk_bf16_f32 v17, v194, v198
    v_cvt_pk_bf16_f32 v18, v202, v206
    v_cvt_pk_bf16_f32 v19, v210, v214
    v_cvt_pk_bf16_f32 v20, v187, v191
    v_cvt_pk_bf16_f32 v21, v195, v199
    v_cvt_pk_bf16_f32 v22, v203, v207
    v_cvt_pk_bf16_f32 v23, v211, v215
    s_add_u32 s25, s24, 0
    buffer_store_dwordx4 v[8:11], v220, s[16:19], s25 offen sc1
    s_add_u32 s25, s24, 8192
    buffer_store_dwordx4 v[12:15], v220, s[16:19], s25 offen sc1
    s_add_u32 s25, s24, 16384
    buffer_store_dwordx4 v[16:19], v220, s[16:19], s25 offen sc1
    s_add_u32 s25, s24, 24576
    buffer_store_dwordx4 v[20:23], v220, s[16:19], s25 offen sc1
    v_mfma_f32_16x16x32_bf16 v[184:187], v[140:143], v[24:27], 0
    v_mfma_f32_16x16x32_bf16 v[188:191], v[140:143], v[28:31], 0
    v_mfma_f32_16x16x32_bf16 v[192:195], v[140:143], v[32:35], 0
    v_mfma_f32_16x16x32_bf16 v[196:199], v[140:143], v[36:39], 0
    v_mfma_f32_16x16x32_bf16 v[200:203], v[140:143], v[40:43], 0
    v_mfma_f32_16x16x32_bf16 v[204:207], v[140:143], v[44:47], 0
    v_mfma_f32_16x16x32_bf16 v[208:211], v[140:143], v[48:51], 0
    v_mfma_f32_16x16x32_bf16 v[212:215], v[140:143], v[52:55], 0
    s_nop 1
    v_cvt_pk_bf16_f32 v56, v184, v188
    s_nop 0
    v_cvt_pk_bf16_f32 v57, v192, v196
    s_nop 0
    v_cvt_pk_bf16_f32 v58, v200, v204
    s_nop 0
    v_cvt_pk_bf16_f32 v59, v208, v212
    v_cvt_pk_bf16_f32 v60, v185, v189
    v_cvt_pk_bf16_f32 v61, v193, v197
    v_cvt_pk_bf16_f32 v62, v201, v205
    v_cvt_pk_bf16_f32 v63, v209, v213
    v_cvt_pk_bf16_f32 v64, v186, v190
    v_cvt_pk_bf16_f32 v65, v194, v198
    v_cvt_pk_bf16_f32 v66, v202, v206
    v_cvt_pk_bf16_f32 v67, v210, v214
    v_cvt_pk_bf16_f32 v68, v187, v191
    v_cvt_pk_bf16_f32 v69, v195, v199
    v_cvt_pk_bf16_f32 v70, v203, v207
    v_cvt_pk_bf16_f32 v71, v211, v215
    s_add_u32 s25, s24, 131072
    buffer_store_dwordx4 v[56:59], v220, s[16:19], s25 offen sc1
    s_add_u32 s25, s24, 139264
    buffer_store_dwordx4 v[60:63], v220, s[16:19], s25 offen sc1
    s_add_u32 s25, s24, 147456
    buffer_store_dwordx4 v[64:67], v220, s[16:19], s25 offen sc1
    s_add_u32 s25, s24, 155648
    buffer_store_dwordx4 v[68:71], v220, s[16:19], s25 offen sc1
    v_mfma_f32_16x16x32_bf16 v[184:187], v[144:147], v[24:27], 0
    v_mfma_f32_16x16x32_bf16 v[188:191], v[144:147], v[28:31], 0
    v_mfma_f32_16x16x32_bf16 v[192:195], v[144:147], v[32:35], 0
    v_mfma_f32_16x16x32_bf16 v[196:199], v[144:147], v[36:39], 0
    v_mfma_f32_16x16x32_bf16 v[200:203], v[144:147], v[40:43], 0
    v_mfma_f32_16x16x32_bf16 v[204:207], v[144:147], v[44:47], 0
    v_mfma_f32_16x16x32_bf16 v[208:211], v[144:147], v[48:51], 0
    v_mfma_f32_16x16x32_bf16 v[212:215], v[144:147], v[52:55], 0
    s_nop 1
    v_cvt_pk_bf16_f32 v8, v184, v188
    s_nop 0
    v_cvt_pk_bf16_f32 v9, v192, v196
    s_nop 0
    v_cvt_pk_bf16_f32 v10, v200, v204
    s_nop 0
    v_cvt_pk_bf16_f32 v11, v208, v212
    v_cvt_pk_bf16_f32 v12, v185, v189
    v_cvt_pk_bf16_f32 v13, v193, v197
    v_cvt_pk_bf16_f32 v14, v201, v205
    v_cvt_pk_bf16_f32 v15, v209, v213
    v_cvt_pk_bf16_f32 v16, v186, v190
    v_cvt_pk_bf16_f32 v17, v194, v198
    v_cvt_pk_bf16_f32 v18, v202, v206
    v_cvt_pk_bf16_f32 v19, v210, v214
    v_cvt_pk_bf16_f32 v20, v187, v191
    v_cvt_pk_bf16_f32 v21, v195, v199
    v_cvt_pk_bf16_f32 v22, v203, v207
    v_cvt_pk_bf16_f32 v23, v211, v215
    s_add_u32 s25, s24, 262144
    buffer_store_dwordx4 v[8:11], v220, s[16:19], s25 offen sc1
    s_add_u32 s25, s24, 270336
    buffer_store_dwordx4 v[12:15], v220, s[16:19], s25 offen sc1
    s_add_u32 s25, s24, 278528
    buffer_store_dwordx4 v[16:19], v220, s[16:19], s25 offen sc1
    s_add_u32 s25, s24, 286720
    buffer_store_dwordx4 v[20:23], v220, s[16:19], s25 offen sc1
    v_mfma_f32_16x16x32_bf16 v[184:187], v[148:151], v[24:27], 0
    v_mfma_f32_16x16x32_bf16 v[188:191], v[148:151], v[28:31], 0
    v_mfma_f32_16x16x32_bf16 v[192:195], v[148:151], v[32:35], 0
    v_mfma_f32_16x16x32_bf16 v[196:199], v[148:151], v[36:39], 0
    v_mfma_f32_16x16x32_bf16 v[200:203], v[148:151], v[40:43], 0
    v_mfma_f32_16x16x32_bf16 v[204:207], v[148:151], v[44:47], 0
    v_mfma_f32_16x16x32_bf16 v[208:211], v[148:151], v[48:51], 0
    v_mfma_f32_16x16x32_bf16 v[212:215], v[148:151], v[52:55], 0
    s_nop 1
    v_cvt_pk_bf16_f32 v56, v184, v188
    s_nop 0
    v_cvt_pk_bf16_f32 v57, v192, v196
    s_nop 0
    v_cvt_pk_bf16_f32 v58, v200, v204
    s_nop 0
    v_cvt_pk_bf16_f32 v59, v208, v212
    v_cvt_pk_bf16_f32 v60, v185, v189
    v_cvt_pk_bf16_f32 v61, v193, v197
    v_cvt_pk_bf16_f32 v62, v201, v205
    v_cvt_pk_bf16_f32 v63, v209, v213
    v_cvt_pk_bf16_f32 v64, v186, v190
    v_cvt_pk_bf16_f32 v65, v194, v198
    v_cvt_pk_bf16_f32 v66, v202, v206
    v_cvt_pk_bf16_f32 v67, v210, v214
    v_cvt_pk_bf16_f32 v68, v187, v191
    v_cvt_pk_bf16_f32 v69, v195, v199
    v_cvt_pk_bf16_f32 v70, v203, v207
    v_cvt_pk_bf16_f32 v71, v211, v215
    s_add_u32 s25, s24, 393216
    buffer_store_dwordx4 v[56:59], v220, s[16:19], s25 offen sc1
    s_add_u32 s25, s24, 401408
    buffer_store_dwordx4 v[60:63], v220, s[16:19], s25 offen sc1
    s_add_u32 s25, s24, 409600
    buffer_store_dwordx4 v[64:67], v220, s[16:19], s25 offen sc1
    s_add_u32 s25, s24, 417792
    buffer_store_dwordx4 v[68:71], v220, s[16:19], s25 offen sc1
L_next0:
    s_cmp_ge_u32 s42, 1696
    s_cbranch_scc1 L_w0_p0
    s_cmp_ge_u32 s42, 672
    s_cbranch_scc1 L_w8_p0
    s_waitcnt vmcnt(32)
    s_branch L_wd_p0
L_w8_p0:
    s_waitcnt vmcnt(24)
    s_branch L_wd_p0
L_w0_p0:
    s_waitcnt vmcnt(16)
L_wd_p0:
    s_cmp_lg_u32 s10, 0
    s_cbranch_scc1 L_pub0
    v_add_u32 v229, 512, v229
    v_mov_b32 v221, s41
    s_mov_b64 exec, 1
    ds_write_b32 v221, v229
    s_mov_b64 exec, -1
L_pub0:
    s_waitcnt lgkmcnt(0)
    s_barrier
    s_cmp_lg_u32 s10, 0
    s_cbranch_scc1 L_nofl0
    s_cmp_ge_u32 s55, 1696
    s_cbranch_scc1 L_nofl0
    s_lshl_b32 s24, s55, 2
    s_add_u32 s24, s24, 157286400
    v_mov_b32 v237, s54
    s_mov_b64 exec, 1
    buffer_store_dword v237, v230, s[16:19], s24 offen sc1
    s_mov_b64 exec, -1
L_nofl0:
    v_mov_b32 v221, s41
    ds_read_b32 v222, v221
    s_xor_b32 s41, s41, 4
    s_mov_b32 s55, s40
    s_mov_b32 s40, s42
    s_waitcnt lgkmcnt(0)
    v_readfirstlane_b32 s42, v222
    s_nop 3
    s_cmp_ge_u32 s42, 736
    s_cbranch_scc1 L_rm4
    s_sub_u32 s28, s42, 64
    s_add_u32 s29, s42, 672
    s_cmp_ge_u32 s42, 64
    s_cselect_b32 s42, s28, s29
L_rm4:
    s_cmp_ge_u32 s40, 1696
    s_cbranch_scc1 L_x_fin
    s_cmp_lg_u32 s43, 1
    s_cbranch_scc1 L_non_skip0
    buffer_load_dword v236, v230, s[44:47], 0 offen offset:128 sc1
L_non_skip0:
    s_cmp_lg_u32 s10, 0
    s_cbranch_scc1 L_nofetch1
    v_mov_b32 v229, 1
    s_mov_b64 exec, 1
    buffer_atomic_add v229, v230, s[44:47], 0 offen sc0 sc1
    s_mov_b64 exec, -1
L_nofetch1:
    s_cmp_ge_u32 s42, 1696
    s_cbranch_scc1 L_ld_done5
    s_cmp_ge_u32 s42, 672
    s_cbranch_scc1 L_ld_w5
    s_cmp_ge_u32 s42, 336
    s_cselect_b32 s11, 1, 0
    s_mul_i32 s12, s11, 336
    s_sub_u32 s12, s42, s12
    s_and_b32 s13, s12, 7
    s_lshr_b32 s14, s12, 3
    s_lshl_b32 s14, s14, 2
    s_add_u32 s14, s14, s10
    s_mul_i32 s15, s11, 16384000
    s_add_u32 s34, s4, s15
    s_addc_u32 s35, s5, 0
    s_mov_b32 s20, s34
    s_and_b32 s21, s35, 0xffff
    s_mov_b32 s22, 16384000
    s_mov_b32 s23, 0x00020000
    s_mul_i32 s15, s14, 98304
    s_lshl_b32 s24, s13, 8
    s_add_u32 s15, s15, s24
    s_add_u32 s25, s15, 0
    buffer_load_dwordx4 v[8:11], v232, s[20:23], s25 offen
    s_add_u32 s25, s15, 2048
    buffer_load_dwordx4 v[12:15], v232, s[20:23], s25 offen
    s_add_u32 s25, s15, 4096
    buffer_load_dwordx4 v[16:19], v232, s[20:23], s25 offen
    s_add_u32 s25, s15, 6144
    buffer_load_dwordx4 v[20:23], v232, s[20:23], s25 offen
    s_add_u32 s25, s15, 8192
    buffer_load_dwordx4 v[24:27], v232, s[20:23], s25 offen
    s_add_u32 s25, s15, 10240
    buffer_load_dwordx4 v[28:31], v232, s[20:23], s25 offen
    s_add_u32 s25, s15, 12288
    buffer_load_dwordx4 v[32:35], v232, s[20:23], s25 offen
    s_add_u32 s25, s15, 14336
    buffer_load_dwordx4 v[36:39], v232, s[20:23], s25 offen
    s_add_u32 s25, s15, 65536
    buffer_load_dwordx4 v[40:43], v232, s[20:23], s25 offen
    s_add_u32 s25, s15, 67584
    buffer_load_dwordx4 v[44:47], v232, s[20:23], s25 offen
    s_add_u32 s25, s15, 69632
    buffer_load_dwordx4 v[48:51], v232, s[20:23], s25 offen
    s_add_u32 s25, s15, 71680
    buffer_load_dwordx4 v[52:55], v232, s[20:23], s25 offen
    s_add_u32 s25, s15, 73728
    buffer_load_dwordx4 v[56:59], v232, s[20:23], s25 offen
    s_add_u32 s25, s15, 75776
    buffer_load_dwordx4 v[60:63], v232, s[20:23], s25 offen
    s_add_u32 s25, s15, 77824
    buffer_load_dwordx4 v[64:67], v232, s[20:23], s25 offen
    s_add_u32 s25, s15, 79872
    buffer_load_dwordx4 v[68:71], v232, s[20:23], s25 offen
    s_branch L_ld_done5
L_ld_w5:
    s_sub_u32 s12, s42, 672
    s_and_b32 s13, s12, 3
    s_lshr_b32 s14, s12, 2
    s_lshl_b32 s14, s14, 2
    s_add_u32 s14, s14, s10
    s_mov_b32 s20, s6
    s_and_b32 s21, s7, 0xffff
    s_mov_b32 s22, 16252928
    s_mov_b32 s23, 0x00020000
    s_lshl_b32 s15, s14, 10
    s_lshl_b32 s24, s13, 8
    s_add_u32 s15, s15, s24
    s_add_u32 s25, s15, 0
    buffer_load_dwordx2 v[8:9], v233, s[20:23], s25 offen
    buffer_load_dwordx2 v[10:11], v233, s[20:23], s25 offen offset:16
    s_add_u32 s25, s15, 1048576
    buffer_load_dwordx2 v[12:13], v233, s[20:23], s25 offen
    buffer_load_dwordx2 v[14:15], v233, s[20:23], s25 offen offset:16
    s_add_u32 s25, s15, 2097152
    buffer_load_dwordx2 v[16:17], v233, s[20:23], s25 offen
    buffer_load_dwordx2 v[18:19], v233, s[20:23], s25 offen offset:16
    s_add_u32 s25, s15, 3145728
    buffer_load_dwordx2 v[20:21], v233, s[20:23], s25 offen
    buffer_load_dwordx2 v[22:23], v233, s[20:23], s25 offen offset:16
L_ld_done5:
    s_cmp_ge_u32 s42, 1696
    s_cbranch_scc1 L_w0_a1
    s_cmp_ge_u32 s42, 672
    s_cbranch_scc1 L_w8_a1
    s_waitcnt vmcnt(32)
    s_branch L_wd_a1
L_w8_a1:
    s_waitcnt vmcnt(24)
    s_branch L_wd_a1
L_w0_a1:
    s_waitcnt vmcnt(16)
L_wd_a1:
    s_cmp_ge_u32 s40, 672
    s_cbranch_scc1 L_cw1
    s_cmp_ge_u32 s40, 336
    s_cselect_b32 s11, 1, 0
    s_mul_i32 s12, s11, 336
    s_sub_u32 s12, s40, s12
    s_and_b32 s13, s12, 7
    s_lshr_b32 s14, s12, 3
    s_lshl_b32 s14, s14, 2
    s_add_u32 s14, s14, s10
    ds_read_b128 v[136:139], v231 offset:0
    ds_read_b128 v[140:143], v231 offset:1024
    ds_read_b128 v[144:147], v231 offset:2048
    ds_read_b128 v[148:151], v231 offset:3072
    ds_read_b128 v[152:155], v231 offset:4096
    ds_read_b128 v[156:159], v231 offset:5120
    ds_read_b128 v[160:163], v231 offset:6144
    ds_read_b128 v[164:167], v231 offset:7168
    s_bfe_u32 s24, s14, 0x10003
    s_mul_i32 s24, s24, 3
    v_and_b32 v221, 3, v217
    v_xor_b32 v221, s24, v221
    v_lshl_add_u32 v220, v221, 4, v234
    s_mul_i32 s24, s11, 22020096
    s_mul_i32 s25, s13, 2752512
    s_add_u32 s24, s24, s25
    s_lshl_b32 s25, s14, 6
    s_add_u32 s24, s24, s25
    s_add_u32 s24, s24, 67108864
    v_perm_b32 v168, v76, v72, s30
    v_perm_b32 v169, v84, v80, s30
    v_perm_b32 v170, v92, v88, s30
    v_perm_b32 v171, v100, v96, s30
    v_perm_b32 v172, v76, v72, s31
    v_perm_b32 v173, v84, v80, s31
    v_perm_b32 v174, v92, v88, s31
    v_perm_b32 v175, v100, v96, s31
    v_perm_b32 v176, v108, v104, s30
    v_perm_b32 v177, v116, v112, s30
    v_perm_b32 v178, v124, v120, s30
    v_perm_b32 v179, v132, v128, s30
    v_perm_b32 v180, v108, v104, s31
    v_perm_b32 v181, v116, v112, s31
    v_perm_b32 v182, v124, v120, s31
    v_perm_b32 v183, v132, v128, s31
    s_waitcnt lgkmcnt(0)
    v_mfma_f32_16x16x32_bf16 v[184:187], v[136:139], v[168:171], 0
    v_mfma_f32_16x16x32_bf16 v[188:191], v[136:139], v[172:175], 0
    v_mfma_f32_16x16x32_bf16 v[192:195], v[144:147], v[168:171], 0
    v_mfma_f32_16x16x32_bf16 v[196:199], v[144:147], v[172:175], 0
    v_mfma_f32_16x16x32_bf16 v[200:203], v[152:155], v[168:171], 0
    v_mfma_f32_16x16x32_bf16 v[204:207], v[152:155], v[172:175], 0
    v_mfma_f32_16x16x32_bf16 v[208:211], v[160:163], v[168:171], 0
    v_mfma_f32_16x16x32_bf16 v[212:215], v[160:163], v[172:175], 0
    v_mfma_f32_16x16x32_bf16 v[184:187], v[140:143], v[176:179], v[184:187]
    v_mfma_f32_16x16x32_bf16 v[188:191], v[140:143], v[180:183], v[188:191]
    v_mfma_f32_16x16x32_bf16 v[192:195], v[148:151], v[176:179], v[192:195]
    v_mfma_f32_16x16x32_bf16 v[196:199], v[148:151], v[180:183], v[196:199]
    v_mfma_f32_16x16x32_bf16 v[200:203], v[156:159], v[176:179], v[200:203]
    v_mfma_f32_16x16x32_bf16 v[204:207], v[156:159], v[180:183], v[204:207]
    v_mfma_f32_16x16x32_bf16 v[208:211], v[164:167], v[176:179], v[208:211]
    v_mfma_f32_16x16x32_bf16 v[212:215], v[164:167], v[180:183], v[212:215]
    v_perm_b32 v168, v77, v73, s30
    v_perm_b32 v169, v85, v81, s30
    v_perm_b32 v170, v93, v89, s30
    v_perm_b32 v171, v101, v97, s30
    v_perm_b32 v172, v77, v73, s31
    v_perm_b32 v173, v85, v81, s31
    v_perm_b32 v174, v93, v89, s31
    v_perm_b32 v175, v101, v97, s31
    v_perm_b32 v176, v109, v105, s30
    v_perm_b32 v177, v117, v113, s30
    v_perm_b32 v178, v125, v121, s30
    v_perm_b32 v179, v133, v129, s30
    v_perm_b32 v180, v109, v105, s31
    v_perm_b32 v181, v117, v113, s31
    v_perm_b32 v182, v125, v121, s31
    v_perm_b32 v183, v133, v129, s31
    v_cvt_pk_bf16_f32 v72, v184, v188
    v_cvt_pk_bf16_f32 v76, v185, v189
    v_cvt_pk_bf16_f32 v80, v186, v190
    v_cvt_pk_bf16_f32 v84, v187, v191
    v_cvt_pk_bf16_f32 v88, v192, v196
    v_cvt_pk_bf16_f32 v92, v193, v197
    v_cvt_pk_bf16_f32 v96, v194, v198
    v_cvt_pk_bf16_f32 v100, v195, v199
    v_cvt_pk_bf16_f32 v104, v200, v204
    v_cvt_pk_bf16_f32 v108, v201, v205
    v_cvt_pk_bf16_f32 v112, v202, v206
    v_cvt_pk_bf16_f32 v116, v203, v207
    v_cvt_pk_bf16_f32 v120, v208, v212
    v_cvt_pk_bf16_f32 v124, v209, v213
    v_cvt_pk_bf16_f32 v128, v210, v214
    v_cvt_pk_bf16_f32 v132, v211, v215
    v_mfma_f32_16x16x32_bf16 v[184:187], v[136:139], v[168:171], 0
    v_mfma_f32_16x16x32_bf16 v[188:191], v[136:139], v[172:175], 0
    v_mfma_f32_16x16x32_bf16 v[192:195], v[144:147], v[168:171], 0
    v_mfma_f32_16x16x32_bf16 v[196:199], v[144:147], v[172:175], 0
    v_mfma_f32_16x16x32_bf16 v[200:203], v[152:155], v[168:171], 0
    v_mfma_f32_16x16x32_bf16 v[204:207], v[152:155], v[172:175], 0
    v_mfma_f32_16x16x32_bf16 v[208:211], v[160:163], v[168:171], 0
    v_mfma_f32_16x16x32_bf16 v[212:215], v[160:163], v[172:175], 0
    v_mfma_f32_16x16x32_bf16 v[184:187], v[140:143], v[176:179], v[184:187]
    v_mfma_f32_16x16x32_bf16 v[188:191], v[140:143], v[180:183], v[188:191]
    v_mfma_f32_16x16x32_bf16 v[192:195], v[148:151], v[176:179], v[192:195]
    v_mfma_f32_16x16x32_bf16 v[196:199], v[148:151], v[180:183], v[196:199]
    v_mfma_f32_16x16x32_bf16 v[200:203], v[156:159], v[176:179], v[200:203]
    v_mfma_f32_16x16x32_bf16 v[204:207], v[156:159], v[180:183], v[204:207]
    v_mfma_f32_16x16x32_bf16 v[208:211], v[164:167], v[176:179], v[208:211]
    v_mfma_f32_16x16x32_bf16 v[212:215], v[164:167], v[180:183], v[212:215]
    v_perm_b32 v168, v78, v74, s30
    v_perm_b32 v169, v86, v82, s30
    v_perm_b32 v170, v94, v90, s30
    v_perm_b32 v171, v102, v98, s30
    v_perm_b32 v172, v78, v74, s31
    v_perm_b32 v173, v86, v82, s31
    v_perm_b32 v174, v94, v90, s31
    v_perm_b32 v175, v102, v98, s31
    v_perm_b32 v176, v110, v106, s30
    v_perm_b32 v177, v118, v114, s30
    v_perm_b32 v178, v126, v122, s30
    v_perm_b32 v179, v134, v130, s30
    v_perm_b32 v180, v110, v106, s31
    v_perm_b32 v181, v118, v114, s31
    v_perm_b32 v182, v126, v122, s31
    v_perm_b32 v183, v134, v130, s31
    v_cvt_pk_bf16_f32 v73, v184, v188
    v_cvt_pk_bf16_f32 v77, v185, v189
    v_cvt_pk_bf16_f32 v81, v186, v190
    v_cvt_pk_bf16_f32 v85, v187, v191
    v_cvt_pk_bf16_f32 v89, v192, v196
    v_cvt_pk_bf16_f32 v93, v193, v197
    v_cvt_pk_bf16_f32 v97, v194, v198
    v_cvt_pk_bf16_f32 v101, v195, v199
    v_cvt_pk_bf16_f32 v105, v200, v204
    v_cvt_pk_bf16_f32 v109, v201, v205
    v_cvt_pk_bf16_f32 v113, v202, v206
    v_cvt_pk_bf16_f32 v117, v203, v207
    v_cvt_pk_bf16_f32 v121, v208, v212
    v_cvt_pk_bf16_f32 v125, v209, v213
    v_cvt_pk_bf16_f32 v129, v210, v214
    v_cvt_pk_bf16_f32 v133, v211, v215
    v_mfma_f32_16x16x32_bf16 v[184:187], v[136:139], v[168:171], 0
    v_mfma_f32_16x16x32_bf16 v[188:191], v[136:139], v[172:175], 0
    v_mfma_f32_16x16x32_bf16 v[192:195], v[144:147], v[168:171], 0
    v_mfma_f32_16x16x32_bf16 v[196:199], v[144:147], v[172:175], 0
    v_mfma_f32_16x16x32_bf16 v[200:203], v[152:155], v[168:171], 0
    v_mfma_f32_16x16x32_bf16 v[204:207], v[152:155], v[172:175], 0
    v_mfma_f32_16x16x32_bf16 v[208:211], v[160:163], v[168:171], 0
    v_mfma_f32_16x16x32_bf16 v[212:215], v[160:163], v[172:175], 0
    v_mfma_f32_16x16x32_bf16 v[184:187], v[140:143], v[176:179], v[184:187]
    v_mfma_f32_16x16x32_bf16 v[188:191], v[140:143], v[180:183], v[188:191]
    v_mfma_f32_16x16x32_bf16 v[192:195], v[148:151], v[176:179], v[192:195]
    v_mfma_f32_16x16x32_bf16 v[196:199], v[148:151], v[180:183], v[196:199]
    v_mfma_f32_16x16x32_bf16 v[200:203], v[156:159], v[176:179], v[200:203]
    v_mfma_f32_16x16x32_bf16 v[204:207], v[156:159], v[180:183], v[204:207]
    v_mfma_f32_16x16x32_bf16 v[208:211], v[164:167], v[176:179], v[208:211]
    v_mfma_f32_16x16x32_bf16 v[212:215], v[164:167], v[180:183], v[212:215]
    v_perm_b32 v168, v79, v75, s30
    v_perm_b32 v169, v87, v83, s30
    v_perm_b32 v170, v95, v91, s30
    v_perm_b32 v171, v103, v99, s30
    v_perm_b32 v172, v79, v75, s31
    v_perm_b32 v173, v87, v83, s31
    v_perm_b32 v174, v95, v91, s31
    v_perm_b32 v175, v103, v99, s31
    v_perm_b32 v176, v111, v107, s30
    v_perm_b32 v177, v119, v115, s30
    v_perm_b32 v178, v127, v123, s30
    v_perm_b32 v179, v135, v131, s30
    v_perm_b32 v180, v111, v107, s31
    v_perm_b32 v181, v119, v115, s31
    v_perm_b32 v182, v127, v123, s31
    v_perm_b32 v183, v135, v131, s31
    v_cvt_pk_bf16_f32 v74, v184, v188
    v_cvt_pk_bf16_f32 v78, v185, v189
    v_cvt_pk_bf16_f32 v82, v186, v190
    v_cvt_pk_bf16_f32 v86, v187, v191
    v_cvt_pk_bf16_f32 v90, v192, v196
    v_cvt_pk_bf16_f32 v94, v193, v197
    v_cvt_pk_bf16_f32 v98, v194, v198
    v_cvt_pk_bf16_f32 v102, v195, v199
    v_cvt_pk_bf16_f32 v106, v200, v204
    v_cvt_pk_bf16_f32 v110, v201, v205
    v_cvt_pk_bf16_f32 v114, v202, v206
    v_cvt_pk_bf16_f32 v118, v203, v207
    v_cvt_pk_bf16_f32 v122, v208, v212
    v_cvt_pk_bf16_f32 v126, v209, v213
    v_cvt_pk_bf16_f32 v130, v210, v214
    v_cvt_pk_bf16_f32 v134, v211, v215
    v_mfma_f32_16x16x32_bf16 v[184:187], v[136:139], v[168:171], 0
    v_mfma_f32_16x16x32_bf16 v[188:191], v[136:139], v[172:175], 0
    v_mfma_f32_16x16x32_bf16 v[192:195], v[144:147], v[168:171], 0
    v_mfma_f32_16x16x32_bf16 v[196:199], v[144:147], v[172:175], 0
    v_mfma_f32_16x16x32_bf16 v[200:203], v[152:155], v[168:171], 0
    v_mfma_f32_16x16x32_bf16 v[204:207], v[152:155], v[172:175], 0
    v_mfma_f32_16x16x32_bf16 v[208:211], v[160:163], v[168:171], 0
    v_mfma_f32_16x16x32_bf16 v[212:215], v[160:163], v[172:175], 0
    v_mfma_f32_16x16x32_bf16 v[184:187], v[140:143], v[176:179], v[184:187]
    v_mfma_f32_16x16x32_bf16 v[188:191], v[140:143], v[180:183], v[188:191]
    v_mfma_f32_16x16x32_bf16 v[192:195], v[148:151], v[176:179], v[192:195]
    v_mfma_f32_16x16x32_bf16 v[196:199], v[148:151], v[180:183], v[196:199]
    v_mfma_f32_16x16x32_bf16 v[200:203], v[156:159], v[176:179], v[200:203]
    v_mfma_f32_16x16x32_bf16 v[204:207], v[156:159], v[180:183], v[204:207]
    v_mfma_f32_16x16x32_bf16 v[208:211], v[164:167], v[176:179], v[208:211]
    v_mfma_f32_16x16x32_bf16 v[212:215], v[164:167], v[180:183], v[212:215]
    s_nop 1
    v_cvt_pk_bf16_f32 v75, v184, v188
    v_cvt_pk_bf16_f32 v79, v185, v189
    v_cvt_pk_bf16_f32 v83, v186, v190
    v_cvt_pk_bf16_f32 v87, v187, v191
    v_cvt_pk_bf16_f32 v91, v192, v196
    v_cvt_pk_bf16_f32 v95, v193, v197
    v_cvt_pk_bf16_f32 v99, v194, v198
    v_cvt_pk_bf16_f32 v103, v195, v199
    v_cvt_pk_bf16_f32 v107, v200, v204
    v_cvt_pk_bf16_f32 v111, v201, v205
    v_cvt_pk_bf16_f32 v115, v202, v206
    v_cvt_pk_bf16_f32 v119, v203, v207
    v_cvt_pk_bf16_f32 v123, v208, v212
    v_cvt_pk_bf16_f32 v127, v209, v213
    v_cvt_pk_bf16_f32 v131, v210, v214
    v_cvt_pk_bf16_f32 v135, v211, v215
    s_add_u32 s25, s24, 0
    buffer_store_dwordx4 v[72:75], v220, s[16:19], s25 offen sc1
    s_add_u32 s25, s24, 10752
    buffer_store_dwordx4 v[76:79], v220, s[16:19], s25 offen sc1
    s_add_u32 s25, s24, 21504
    buffer_store_dwordx4 v[80:83], v220, s[16:19], s25 offen sc1
    s_add_u32 s25, s24, 32256
    buffer_store_dwordx4 v[84:87], v220, s[16:19], s25 offen sc1
    s_add_u32 s25, s24, 172032
    buffer_store_dwordx4 v[88:91], v220, s[16:19], s25 offen sc1
    s_add_u32 s25, s24, 182784
    buffer_store_dwordx4 v[92:95], v220, s[16:19], s25 offen sc1
    s_add_u32 s25, s24, 193536
    buffer_store_dwordx4 v[96:99], v220, s[16:19], s25 offen sc1
    s_add_u32 s25, s24, 204288
    buffer_store_dwordx4 v[100:103], v220, s[16:19], s25 offen sc1
    s_add_u32 s25, s24, 344064
    buffer_store_dwordx4 v[104:107], v220, s[16:19], s25 offen sc1
    s_add_u32 s25, s24, 354816
    buffer_store_dwordx4 v[108:111], v220, s[16:19], s25 offen sc1
    s_add_u32 s25, s24, 365568
    buffer_store_dwordx4 v[112:115], v220, s[16:19], s25 offen sc1
    s_add_u32 s25, s24, 376320
    buffer_store_dwordx4 v[116:119], v220, s[16:19], s25 offen sc1
    s_add_u32 s25, s24, 516096
    buffer_store_dwordx4 v[120:123], v220, s[16:19], s25 offen sc1
    s_add_u32 s25, s24, 526848
    buffer_store_dwordx4 v[124:127], v220, s[16:19], s25 offen sc1
    s_add_u32 s25, s24, 537600
    buffer_store_dwordx4 v[128:131], v220, s[16:19], s25 offen sc1
    s_add_u32 s25, s24, 548352
    buffer_store_dwordx4 v[132:135], v220, s[16:19], s25 offen sc1
    s_branch L_next1
L_cw1:
    s_sub_u32 s12, s40, 672
    s_and_b32 s13, s12, 3
    s_lshr_b32 s14, s12, 2
    s_lshl_b32 s14, s14, 2
    s_add_u32 s14, s14, s10
    ds_read_b128 v[136:139], v231 offset:8192
    ds_read_b128 v[140:143], v231 offset:9216
    ds_read_b128 v[144:147], v231 offset:10240
    ds_read_b128 v[148:151], v231 offset:11264
    s_and_b32 s24, s14, 3
    s_bfe_u32 s25, s14, 0x10003
    s_lshl_b32 s25, s25, 2
    s_or_b32 s24, s24, s25
    s_lshl_b32 s24, s24, 1
    v_xor_b32 v221, s24, v217
    v_lshl_add_u32 v220, v221, 4, v235
    s_mul_i32 s24, s13, 16777216
    s_lshr_b32 s25, s14, 5
    s_mul_i32 s25, s25, 524288
    s_add_u32 s24, s24, s25
    s_and_b32 s25, s14, 31
    s_lshl_b32 s25, s25, 8
    s_add_u32 s24, s24, s25
    v_perm_b32 v88, v72, v72, s32
    v_perm_b32 v89, v76, v76, s32
    v_perm_b32 v90, v80, v80, s32
    v_perm_b32 v91, v84, v84, s32
    v_perm_b32 v92, v72, v72, s33
    v_perm_b32 v93, v76, v76, s33
    v_perm_b32 v94, v80, v80, s33
    v_perm_b32 v95, v84, v84, s33
    v_perm_b32 v96, v73, v73, s32
    v_perm_b32 v97, v77, v77, s32
    v_perm_b32 v98, v81, v81, s32
    v_perm_b32 v99, v85, v85, s32
    v_perm_b32 v100, v73, v73, s33
    v_perm_b32 v101, v77, v77, s33
    v_perm_b32 v102, v81, v81, s33
    v_perm_b32 v103, v85, v85, s33
    v_perm_b32 v104, v74, v74, s32
    v_perm_b32 v105, v78, v78, s32
    v_perm_b32 v106, v82, v82, s32
    v_perm_b32 v107, v86, v86, s32
    v_perm_b32 v108, v74, v74, s33
    v_perm_b32 v109, v78, v78, s33
    v_perm_b32 v110, v82, v82, s33
    v_perm_b32 v111, v86, v86, s33
    v_perm_b32 v112, v75, v75, s32
    v_perm_b32 v113, v79, v79, s32
    v_perm_b32 v114, v83, v83, s32
    v_perm_b32 v115, v87, v87, s32
    v_perm_b32 v116, v75, v75, s33
    v_perm_b32 v117, v79, v79, s33
    v_perm_b32 v118, v83, v83, s33
    v_perm_b32 v119, v87, v87, s33
    s_waitcnt lgkmcnt(0)
    v_mfma_f32_16x16x32_bf16 v[184:187], v[136:139], v[88:91], 0
    v_mfma_f32_16x16x32_bf16 v[188:191], v[136:139], v[92:95], 0
    v_mfma_f32_16x16x32_bf16 v[192:195], v[136:139], v[96:99], 0
    v_mfma_f32_16x16x32_bf16 v[196:199], v[136:139], v[100:103], 0
    v_mfma_f32_16x16x32_bf16 v[200:203], v[136:139], v[104:107], 0
    v_mfma_f32_16x16x32_bf16 v[204:207], v[136:139], v[108:111], 0
    v_mfma_f32_16x16x32_bf16 v[208:211], v[136:139], v[112:115], 0
    v_mfma_f32_16x16x32_bf16 v[212:215], v[136:139], v[116:119], 0
    s_nop 1
    v_cvt_pk_bf16_f32 v72, v184, v188
    s_nop 0
    v_cvt_pk_bf16_f32 v73, v192, v196
    s_nop 0
    v_cvt_pk_bf16_f32 v74, v200, v204
    s_nop 0
    v_cvt_pk_bf16_f32 v75, v208, v212
    v_cvt_pk_bf16_f32 v76, v185, v189
    v_cvt_pk_bf16_f32 v77, v193, v197
    v_cvt_pk_bf16_f32 v78, v201, v205
    v_cvt_pk_bf16_f32 v79, v209, v213
    v_cvt_pk_bf16_f32 v80, v186, v190
    v_cvt_pk_bf16_f32 v81, v194, v198
    v_cvt_pk_bf16_f32 v82, v202, v206
    v_cvt_pk_bf16_f32 v83, v210, v214
    v_cvt_pk_bf16_f32 v84, v187, v191
    v_cvt_pk_bf16_f32 v85, v195, v199
    v_cvt_pk_bf16_f32 v86, v203, v207
    v_cvt_pk_bf16_f32 v87, v211, v215
    s_add_u32 s25, s24, 0
    buffer_store_dwordx4 v[72:75], v220, s[16:19], s25 offen sc1
    s_add_u32 s25, s24, 8192
    buffer_store_dwordx4 v[76:79], v220, s[16:19], s25 offen sc1
    s_add_u32 s25, s24, 16384
    buffer_store_dwordx4 v[80:83], v220, s[16:19], s25 offen sc1
    s_add_u32 s25, s24, 24576
    buffer_store_dwordx4 v[84:87], v220, s[16:19], s25 offen sc1
    v_mfma_f32_16x16x32_bf16 v[184:187], v[140:143], v[88:91], 0
    v_mfma_f32_16x16x32_bf16 v[188:191], v[140:143], v[92:95], 0
    v_mfma_f32_16x16x32_bf16 v[192:195], v[140:143], v[96:99], 0
    v_mfma_f32_16x16x32_bf16 v[196:199], v[140:143], v[100:103], 0
    v_mfma_f32_16x16x32_bf16 v[200:203], v[140:143], v[104:107], 0
    v_mfma_f32_16x16x32_bf16 v[204:207], v[140:143], v[108:111], 0
    v_mfma_f32_16x16x32_bf16 v[208:211], v[140:143], v[112:115], 0
    v_mfma_f32_16x16x32_bf16 v[212:215], v[140:143], v[116:119], 0
    s_nop 1
    v_cvt_pk_bf16_f32 v120, v184, v188
    s_nop 0
    v_cvt_pk_bf16_f32 v121, v192, v196
    s_nop 0
    v_cvt_pk_bf16_f32 v122, v200, v204
    s_nop 0
    v_cvt_pk_bf16_f32 v123, v208, v212
    v_cvt_pk_bf16_f32 v124, v185, v189
    v_cvt_pk_bf16_f32 v125, v193, v197
    v_cvt_pk_bf16_f32 v126, v201, v205
    v_cvt_pk_bf16_f32 v127, v209, v213
    v_cvt_pk_bf16_f32 v128, v186, v190
    v_cvt_pk_bf16_f32 v129, v194, v198
    v_cvt_pk_bf16_f32 v130, v202, v206
    v_cvt_pk_bf16_f32 v131, v210, v214
    v_cvt_pk_bf16_f32 v132, v187, v191
    v_cvt_pk_bf16_f32 v133, v195, v199
    v_cvt_pk_bf16_f32 v134, v203, v207
    v_cvt_pk_bf16_f32 v135, v211, v215
    s_add_u32 s25, s24, 131072
    buffer_store_dwordx4 v[120:123], v220, s[16:19], s25 offen sc1
    s_add_u32 s25, s24, 139264
    buffer_store_dwordx4 v[124:127], v220, s[16:19], s25 offen sc1
    s_add_u32 s25, s24, 147456
    buffer_store_dwordx4 v[128:131], v220, s[16:19], s25 offen sc1
    s_add_u32 s25, s24, 155648
    buffer_store_dwordx4 v[132:135], v220, s[16:19], s25 offen sc1
    v_mfma_f32_16x16x32_bf16 v[184:187], v[144:147], v[88:91], 0
    v_mfma_f32_16x16x32_bf16 v[188:191], v[144:147], v[92:95], 0
    v_mfma_f32_16x16x32_bf16 v[192:195], v[144:147], v[96:99], 0
    v_mfma_f32_16x16x32_bf16 v[196:199], v[144:147], v[100:103], 0
    v_mfma_f32_16x16x32_bf16 v[200:203], v[144:147], v[104:107], 0
    v_mfma_f32_16x16x32_bf16 v[204:207], v[144:147], v[108:111], 0
    v_mfma_f32_16x16x32_bf16 v[208:211], v[144:147], v[112:115], 0
    v_mfma_f32_16x16x32_bf16 v[212:215], v[144:147], v[116:119], 0
    s_nop 1
    v_cvt_pk_bf16_f32 v72, v184, v188
    s_nop 0
    v_cvt_pk_bf16_f32 v73, v192, v196
    s_nop 0
    v_cvt_pk_bf16_f32 v74, v200, v204
    s_nop 0
    v_cvt_pk_bf16_f32 v75, v208, v212
    v_cvt_pk_bf16_f32 v76, v185, v189
    v_cvt_pk_bf16_f32 v77, v193, v197
    v_cvt_pk_bf16_f32 v78, v201, v205
    v_cvt_pk_bf16_f32 v79, v209, v213
    v_cvt_pk_bf16_f32 v80, v186, v190
    v_cvt_pk_bf16_f32 v81, v194, v198
    v_cvt_pk_bf16_f32 v82, v202, v206
    v_cvt_pk_bf16_f32 v83, v210, v214
    v_cvt_pk_bf16_f32 v84, v187, v191
    v_cvt_pk_bf16_f32 v85, v195, v199
    v_cvt_pk_bf16_f32 v86, v203, v207
    v_cvt_pk_bf16_f32 v87, v211, v215
    s_add_u32 s25, s24, 262144
    buffer_store_dwordx4 v[72:75], v220, s[16:19], s25 offen sc1
    s_add_u32 s25, s24, 270336
    buffer_store_dwordx4 v[76:79], v220, s[16:19], s25 offen sc1
    s_add_u32 s25, s24, 278528
    buffer_store_dwordx4 v[80:83], v220, s[16:19], s25 offen sc1
    s_add_u32 s25, s24, 286720
    buffer_store_dwordx4 v[84:87], v220, s[16:19], s25 offen sc1
    v_mfma_f32_16x16x32_bf16 v[184:187], v[148:151], v[88:91], 0
    v_mfma_f32_16x16x32_bf16 v[188:191], v[148:151], v[92:95], 0
    v_mfma_f32_16x16x32_bf16 v[192:195], v[148:151], v[96:99], 0
    v_mfma_f32_16x16x32_bf16 v[196:199], v[148:151], v[100:103], 0
    v_mfma_f32_16x16x32_bf16 v[200:203], v[148:151], v[104:107], 0
    v_mfma_f32_16x16x32_bf16 v[204:207], v[148:151], v[108:111], 0
    v_mfma_f32_16x16x32_bf16 v[208:211], v[148:151], v[112:115], 0
    v_mfma_f32_16x16x32_bf16 v[212:215], v[148:151], v[116:119], 0
    s_nop 1
    v_cvt_pk_bf16_f32 v120, v184, v188
    s_nop 0
    v_cvt_pk_bf16_f32 v121, v192, v196
    s_nop 0
    v_cvt_pk_bf16_f32 v122, v200, v204
    s_nop 0
    v_cvt_pk_bf16_f32 v123, v208, v212
    v_cvt_pk_bf16_f32 v124, v185, v189
    v_cvt_pk_bf16_f32 v125, v193, v197
    v_cvt_pk_bf16_f32 v126, v201, v205
    v_cvt_pk_bf16_f32 v127, v209, v213
    v_cvt_pk_bf16_f32 v128, v186, v190
    v_cvt_pk_bf16_f32 v129, v194, v198
    v_cvt_pk_bf16_f32 v130, v202, v206
    v_cvt_pk_bf16_f32 v131, v210, v214
    v_cvt_pk_bf16_f32 v132, v187, v191
    v_cvt_pk_bf16_f32 v133, v195, v199
    v_cvt_pk_bf16_f32 v134, v203, v207
    v_cvt_pk_bf16_f32 v135, v211, v215
    s_add_u32 s25, s24, 393216
    buffer_store_dwordx4 v[120:123], v220, s[16:19], s25 offen sc1
    s_add_u32 s25, s24, 401408
    buffer_store_dwordx4 v[124:127], v220, s[16:19], s25 offen sc1
    s_add_u32 s25, s24, 409600
    buffer_store_dwordx4 v[128:131], v220, s[16:19], s25 offen sc1
    s_add_u32 s25, s24, 417792
    buffer_store_dwordx4 v[132:135], v220, s[16:19], s25 offen sc1
L_next1:
    s_cmp_ge_u32 s42, 1696
    s_cbranch_scc1 L_w0_p1
    s_cmp_ge_u32 s42, 672
    s_cbranch_scc1 L_w8_p1
    s_waitcnt vmcnt(32)
    s_branch L_wd_p1
L_w8_p1:
    s_waitcnt vmcnt(24)
    s_branch L_wd_p1
L_w0_p1:
    s_waitcnt vmcnt(16)
L_wd_p1:
    s_cmp_lg_u32 s43, 1
    s_cbranch_scc1 L_nonok
    s_mov_b32 s43, 2
    s_mov_b32 s57, 32768
L_non:
    v_readfirstlane_b32 s54, v236
    s_nop 3
    s_cmp_lg_u32 s54, 0
    s_cbranch_scc1 L_nonok
    s_sub_u32 s57, s57, 1
    s_cmp_eq_u32 s57, 0
    s_cbranch_scc1 L_nonok
    buffer_load_dword v236, v230, s[44:47], 0 offen offset:128 sc1
    s_waitcnt vmcnt(0)
    s_branch L_non
L_nonok:
    s_cmp_lg_u32 s10, 0
    s_cbranch_scc1 L_pub1
    v_add_u32 v229, 512, v229
    v_mov_b32 v221, s41
    s_mov_b64 exec, 1
    ds_write_b32 v221, v229
    s_mov_b64 exec, -1
L_pub1:
    s_waitcnt lgkmcnt(0)
    s_barrier
    s_cmp_lg_u32 s10, 0
    s_cbranch_scc1 L_nofl1
    s_cmp_ge_u32 s55, 1696
    s_cbranch_scc1 L_nofl1
    s_lshl_b32 s24, s55, 2
    s_add_u32 s24, s24, 157286400
    v_mov_b32 v237, s54
    s_mov_b64 exec, 1
    buffer_store_dword v237, v230, s[16:19], s24 offen sc1
    s_mov_b64 exec, -1
L_nofl1:
    v_mov_b32 v221, s41
    ds_read_b32 v222, v221
    s_xor_b32 s41, s41, 4
    s_mov_b32 s55, s40
    s_mov_b32 s40, s42
    s_waitcnt lgkmcnt(0)
    v_readfirstlane_b32 s42, v222
    s_nop 3
    s_cmp_ge_u32 s42, 736
    s_cbranch_scc1 L_rm6
    s_sub_u32 s28, s42, 64
    s_add_u32 s29, s42, 672
    s_cmp_ge_u32 s42, 64
    s_cselect_b32 s42, s28, s29
L_rm6:
    s_cmp_ge_u32 s40, 1696
    s_cbranch_scc1 L_x_fin
    s_branch L_x_loop
L_x_fin:
    s_waitcnt vmcnt(0)
    s_barrier
    s_cmp_lg_u32 s10, 0
    s_cbranch_scc1 L_noflf
    s_cmp_ge_u32 s55, 1696
    s_cbranch_scc1 L_noflf
    s_lshl_b32 s24, s55, 2
    s_add_u32 s24, s24, 157286400
    v_mov_b32 v237, s54
    s_mov_b64 exec, 1
    buffer_store_dword v237, v230, s[16:19], s24 offen sc1
    s_mov_b64 exec, -1
L_noflf:
    s_add_u32 s10, s10, 4
    s_and_b32 s11, s2, 7
    s_lshr_b32 s12, s2, 3
    s_lshr_b32 s13, s12, 3
    s_lshl_b32 s11, s11, 2
    s_add_u32 s11, s11, s13
    s_bfe_u32 s13, s12, 0x10002
    s_and_b32 s14, s12, 3
    s_and_b32 s15, s10, 3
    s_mul_i32 s40, s11, 16384
    s_mul_i32 s20, s14, 16777216
    s_add_u32 s40, s40, s20
    s_mul_i32 s41, s11, 21504
    s_mul_i32 s20, s13, 22020096
    s_add_u32 s41, s41, s20
    s_add_u32 s41, s41, 67108864
    s_lshl_b32 s42, s15, 12
    s_mul_i32 s43, s15, 5632
    s_lshr_b32 s20, s15, 1
    s_lshl_b32 s21, s20, 9
    s_sub_u32 s21, s43, s21
    v_lshlrev_b32 v1, 4, v0
    v_lshlrev_b32 v1, 4, v0
    v_add_u32 v2, s21, v1
    s_add_u32 s22, s21, 4096
    v_add_u32 v5, s22, v1
    s_mov_b32 s44, s41
    s_bitcmp1_b32 s15, 0
    s_cbranch_scc0 L_six_even
    s_mul_i32 s22, s20, 10752
    s_add_u32 s22, s22, 9216
    v_lshrrev_b32 v5, 2, v0
    v_lshlrev_b32 v5, 6, v5
    v_and_b32 v3, 3, v0
    v_xor_b32 v3, 3, v3
    v_lshl_add_u32 v5, v3, 4, v5
    v_add_u32 v5, s22, v5
    s_mul_i32 s44, s11, 21504
    s_xor_b32 s22, s13, 1
    s_mul_i32 s22, s22, 22020096
    s_add_u32 s44, s44, s22
    s_add_u32 s44, s44, 67108864
L_six_even:
    s_mov_b32 s50, -1
    s_mov_b32 s51, 0
    v_add_u32 v1, s42, v1
    s_add_u32 s43, s43, 16384
    v_lshlrev_b32 v6, 4, v0
    v_min_u32 v7, 31, v0
    v_lshlrev_b32 v7, 4, v7
    s_mov_b32 s58, 157286400
    buffer_load_dwordx4 v[8:11], v6, s[16:19], s58 offen sc1
    s_mov_b32 s58, 157287424
    buffer_load_dwordx4 v[12:15], v6, s[16:19], s58 offen sc1
    s_mov_b32 s58, 157288448
    buffer_load_dwordx4 v[16:19], v6, s[16:19], s58 offen sc1
    s_mov_b32 s58, 157288576
    buffer_load_dwordx4 v[20:23], v6, s[16:19], s58 offen sc1
    s_waitcnt vmcnt(0)
    s_mov_b32 s57, 32768
L_chk0:
    v_xor_b32 v24, s54, v8
    v_xor_b32 v25, s54, v9
    v_xor_b32 v26, s54, v10
    v_xor_b32 v27, s54, v11
    v_xor_b32 v28, s54, v12
    v_xor_b32 v29, s54, v13
    v_xor_b32 v30, s54, v14
    v_xor_b32 v31, s54, v15
    v_xor_b32 v32, s54, v16
    v_xor_b32 v33, s54, v17
    v_xor_b32 v34, s54, v18
    v_xor_b32 v35, s54, v19
    v_xor_b32 v36, s54, v20
    v_xor_b32 v37, s54, v21
    v_xor_b32 v38, s54, v22
    v_xor_b32 v39, s54, v23
    v_or3_b32 v24, v24, v25, v26
    v_or3_b32 v24, v24, v27, v28
    v_or3_b32 v24, v24, v29, v30
    v_or3_b32 v24, v24, v31, v32
    v_or3_b32 v24, v24, v33, v34
    v_or3_b32 v24, v24, v35, v36
    v_or3_b32 v24, v24, v37, v38
    v_or_b32 v24, v24, v39
    v_cmp_ne_u32 vcc, 0, v24
    s_nop 3
    s_cmp_eq_u64 vcc, 0
    s_cbranch_scc1 L_ok0
    s_sub_u32 s57, s57, 1
    s_cmp_eq_u32 s57, 0
    s_cbranch_scc1 L_ok0
    s_sleep 8
    s_mov_b32 s58, 157286400
    buffer_load_dwordx4 v[8:11], v6, s[16:19], s58 offen sc1
    s_mov_b32 s58, 157287424
    buffer_load_dwordx4 v[12:15], v6, s[16:19], s58 offen sc1
    s_mov_b32 s58, 157288448
    buffer_load_dwordx4 v[16:19], v6, s[16:19], s58 offen sc1
    s_mov_b32 s58, 157288576
    buffer_load_dwordx4 v[20:23], v6, s[16:19], s58 offen sc1
    s_waitcnt vmcnt(0)
    s_branch L_chk0
L_ok0:
    s_add_u32 m0, s42, 0
    s_nop 0
    buffer_load_dwordx4 v1, s[16:19], s40 offen offset:0 lds
    buffer_load_dwordx4 v1, s[16:19], s40 offen offset:1024 lds
    buffer_load_dwordx4 v1, s[16:19], s40 offen offset:2048 lds
    buffer_load_dwordx4 v1, s[16:19], s40 offen offset:3072 lds
    s_add_u32 s40, s40, 524288
    s_add_u32 m0, s43, 0
    s_nop 0
    buffer_load_dwordx4 v2, s[16:19], s41 offen offset:0 lds
    buffer_load_dwordx4 v2, s[16:19], s41 offen offset:1024 lds
    buffer_load_dwordx4 v2, s[16:19], s41 offen offset:2048 lds
    buffer_load_dwordx4 v2, s[16:19], s41 offen offset:3072 lds
    s_add_u32 m0, s43, 4096
    s_add_u32 s49, s41, 4096
    buffer_load_dwordx4 v2, s[16:19], s49 offen lds
    s_mov_b64 exec, s[50:51]
    buffer_load_dwordx4 v5, s[16:19], s44 offen offset:1024 lds
    s_mov_b64 exec, -1
    s_add_u32 s41, s41, 688128
    s_add_u32 s44, s44, 688128
    s_add_u32 m0, s42, 38912
    s_nop 0
    buffer_load_dwordx4 v1, s[16:19], s40 offen offset:0 lds
    buffer_load_dwordx4 v1, s[16:19], s40 offen offset:1024 lds
    buffer_load_dwordx4 v1, s[16:19], s40 offen offset:2048 lds
    buffer_load_dwordx4 v1, s[16:19], s40 offen offset:3072 lds
    s_add_u32 s40, s40, 524288
    s_add_u32 m0, s43, 38912
    s_nop 0
    buffer_load_dwordx4 v2, s[16:19], s41 offen offset:0 lds
    buffer_load_dwordx4 v2, s[16:19], s41 offen offset:1024 lds
    buffer_load_dwordx4 v2, s[16:19], s41 offen offset:2048 lds
    buffer_load_dwordx4 v2, s[16:19], s41 offen offset:3072 lds
    s_add_u32 m0, s43, 43008
    s_add_u32 s49, s41, 4096
    buffer_load_dwordx4 v2, s[16:19], s49 offen lds
    s_mov_b64 exec, s[50:51]
    buffer_load_dwordx4 v5, s[16:19], s44 offen offset:1024 lds
    s_mov_b64 exec, -1
    s_add_u32 s41, s41, 688128
    s_add_u32 s44, s44, 688128
    s_add_u32 m0, s42, 77824
    s_nop 0
    buffer_load_dwordx4 v1, s[16:19], s40 offen offset:0 lds
    buffer_load_dwordx4 v1, s[16:19], s40 offen offset:1024 lds
    buffer_load_dwordx4 v1, s[16:19], s40 offen offset:2048 lds
    buffer_load_dwordx4 v1, s[16:19], s40 offen offset:3072 lds
    s_add_u32 s40, s40, 524288
    s_add_u32 m0, s43, 77824
    s_nop 0
    buffer_load_dwordx4 v2, s[16:19], s41 offen offset:0 lds
    buffer_load_dwordx4 v2, s[16:19], s41 offen offset:1024 lds
    buffer_load_dwordx4 v2, s[16:19], s41 offen offset:2048 lds
    buffer_load_dwordx4 v2, s[16:19], s41 offen offset:3072 lds
    s_add_u32 m0, s43, 81920
    s_add_u32 s49, s41, 4096
    buffer_load_dwordx4 v2, s[16:19], s49 offen lds
    s_mov_b64 exec, s[50:51]
    buffer_load_dwordx4 v5, s[16:19], s44 offen offset:1024 lds
    s_mov_b64 exec, -1
    s_add_u32 s41, s41, 688128
    s_add_u32 s44, s44, 688128
    s_mov_b32 s58, 157289600
    buffer_load_dwordx4 v[8:11], v7, s[16:19], s58 offen sc1
    s_waitcnt vmcnt(21)
    s_barrier
    s_waitcnt vmcnt(11)
    s_barrier
    s_add_u32 m0, s42, 116736
    s_nop 0
    buffer_load_dwordx4 v1, s[16:19], s40 offen offset:0 lds
    buffer_load_dwordx4 v1, s[16:19], s40 offen offset:1024 lds
    buffer_load_dwordx4 v1, s[16:19], s40 offen offset:2048 lds
    buffer_load_dwordx4 v1, s[16:19], s40 offen offset:3072 lds
    s_add_u32 s40, s40, 524288
    s_add_u32 m0, s43, 116736
    s_nop 0
    buffer_load_dwordx4 v2, s[16:19], s41 offen offset:0 lds
    buffer_load_dwordx4 v2, s[16:19], s41 offen offset:1024 lds
    buffer_load_dwordx4 v2, s[16:19], s41 offen offset:2048 lds
    buffer_load_dwordx4 v2, s[16:19], s41 offen offset:3072 lds
    s_add_u32 m0, s43, 120832
    s_add_u32 s49, s41, 4096
    buffer_load_dwordx4 v2, s[16:19], s49 offen lds
    s_mov_b64 exec, s[50:51]
    buffer_load_dwordx4 v5, s[16:19], s44 offen offset:1024 lds
    s_mov_b64 exec, -1
    s_add_u32 s41, s41, 688128
    s_add_u32 s44, s44, 688128
    s_waitcnt vmcnt(11)
    s_barrier
    s_waitcnt vmcnt(10)
    s_mov_b32 s57, 32768
L_chk1:
    v_xor_b32 v24, s54, v8
    v_xor_b32 v25, s54, v9
    v_xor_b32 v26, s54, v10
    v_xor_b32 v27, s54, v11
    v_or3_b32 v24, v24, v25, v26
    v_or_b32 v24, v24, v27
    v_cmp_ne_u32 vcc, 0, v24
    s_nop 3
    s_cmp_eq_u64 vcc, 0
    s_cbranch_scc1 L_ok1
    s_sub_u32 s57, s57, 1
    s_cmp_eq_u32 s57, 0
    s_cbranch_scc1 L_ok1
    s_sleep 8
    s_mov_b32 s58, 157289600
    buffer_load_dwordx4 v[8:11], v7, s[16:19], s58 offen sc1
    s_waitcnt vmcnt(0)
    s_branch L_chk1
L_ok1:
    s_add_u32 m0, s42, 0
    s_nop 0
    buffer_load_dwordx4 v1, s[16:19], s40 offen offset:0 lds
    buffer_load_dwordx4 v1, s[16:19], s40 offen offset:1024 lds
    buffer_load_dwordx4 v1, s[16:19], s40 offen offset:2048 lds
    buffer_load_dwordx4 v1, s[16:19], s40 offen offset:3072 lds
    s_add_u32 s40, s40, 524288
    s_add_u32 m0, s43, 0
    s_nop 0
    buffer_load_dwordx4 v2, s[16:19], s41 offen offset:0 lds
    buffer_load_dwordx4 v2, s[16:19], s41 offen offset:1024 lds
    buffer_load_dwordx4 v2, s[16:19], s41 offen offset:2048 lds
    buffer_load_dwordx4 v2, s[16:19], s41 offen offset:3072 lds
    s_add_u32 m0, s43, 4096
    s_add_u32 s49, s41, 4096
    buffer_load_dwordx4 v2, s[16:19], s49 offen lds
    s_mov_b64 exec, s[50:51]
    buffer_load_dwordx4 v5, s[16:19], s44 offen offset:1024 lds
    s_mov_b64 exec, -1
    s_add_u32 s41, s41, 688128
    s_add_u32 s44, s44, 688128
    s_waitcnt vmcnt(10)
    s_barrier
    s_add_u32 m0, s42, 38912
    s_nop 0
    buffer_load_dwordx4 v1, s[16:19], s40 offen offset:0 lds
    buffer_load_dwordx4 v1, s[16:19], s40 offen offset:1024 lds
    buffer_load_dwordx4 v1, s[16:19], s40 offen offset:2048 lds
    buffer_load_dwordx4 v1, s[16:19], s40 offen offset:3072 lds
    s_add_u32 s40, s40, 524288
    s_add_u32 m0, s43, 38912
    s_nop 0
    buffer_load_dwordx4 v2, s[16:19], s41 offen offset:0 lds
    buffer_load_dwordx4 v2, s[16:19], s41 offen offset:1024 lds
    buffer_load_dwordx4 v2, s[16:19], s41 offen offset:2048 lds
    buffer_load_dwordx4 v2, s[16:19], s41 offen offset:3072 lds
    s_add_u32 m0, s43, 43008
    s_add_u32 s49, s41, 4096
    buffer_load_dwordx4 v2, s[16:19], s49 offen lds
    s_mov_b64 exec, s[50:51]
    buffer_load_dwordx4 v5, s[16:19], s44 offen offset:1024 lds
    s_mov_b64 exec, -1
    s_add_u32 s41, s41, 688128
    s_add_u32 s44, s44, 688128
    s_waitcnt vmcnt(10)
    s_barrier
    s_add_u32 m0, s42, 77824
    s_nop 0
    buffer_load_dwordx4 v1, s[16:19], s40 offen offset:0 lds
    buffer_load_dwordx4 v1, s[16:19], s40 offen offset:1024 lds
    buffer_load_dwordx4 v1, s[16:19], s40 offen offset:2048 lds
    buffer_load_dwordx4 v1, s[16:19], s40 offen offset:3072 lds
    s_add_u32 s40, s40, 524288
    s_add_u32 m0, s43, 77824
    s_nop 0
    buffer_load_dwordx4 v2, s[16:19], s41 offen offset:0 lds
    buffer_load_dwordx4 v2, s[16:19], s41 offen offset:1024 lds
    buffer_load_dwordx4 v2, s[16:19], s41 offen offset:2048 lds
    buffer_load_dwordx4 v2, s[16:19], s41 offen offset:3072 lds
    s_add_u32 m0, s43, 81920
    s_add_u32 s49, s41, 4096
    buffer_load_dwordx4 v2, s[16:19], s49 offen lds
    s_mov_b64 exec, s[50:51]
    buffer_load_dwordx4 v5, s[16:19], s44 offen offset:1024 lds
    s_mov_b64 exec, -1
    s_add_u32 s41, s41, 688128
    s_add_u32 s44, s44, 688128
    s_waitcnt vmcnt(10)
    s_barrier
    s_add_u32 m0, s42, 116736
    s_nop 0
    buffer_load_dwordx4 v1, s[16:19], s40 offen offset:0 lds
    buffer_load_dwordx4 v1, s[16:19], s40 offen offset:1024 lds
    buffer_load_dwordx4 v1, s[16:19], s40 offen offset:2048 lds
    buffer_load_dwordx4 v1, s[16:19], s40 offen offset:3072 lds
    s_add_u32 s40, s40, 524288
    s_add_u32 m0, s43, 116736
    s_nop 0
    buffer_load_dwordx4 v2, s[16:19], s41 offen offset:0 lds
    buffer_load_dwordx4 v2, s[16:19], s41 offen offset:1024 lds
    buffer_load_dwordx4 v2, s[16:19], s41 offen offset:2048 lds
    buffer_load_dwordx4 v2, s[16:19], s41 offen offset:3072 lds
    s_add_u32 m0, s43, 120832
    s_add_u32 s49, s41, 4096
    buffer_load_dwordx4 v2, s[16:19], s49 offen lds
    s_mov_b64 exec, s[50:51]
    buffer_load_dwordx4 v5, s[16:19], s44 offen offset:1024 lds
    s_mov_b64 exec, -1
    s_add_u32 s41, s41, 688128
    s_add_u32 s44, s44, 688128
    s_mov_b32 s58, 157290112
    buffer_load_dwordx4 v[8:11], v7, s[16:19], s58 offen sc1
    s_waitcnt vmcnt(11)
    s_barrier
    s_waitcnt vmcnt(0)
    s_mov_b32 s57, 32768
L_chk2:
    v_xor_b32 v24, s54, v8
    v_xor_b32 v25, s54, v9
    v_xor_b32 v26, s54, v10
    v_xor_b32 v27, s54, v11
    v_or3_b32 v24, v24, v25, v26
    v_or_b32 v24, v24, v27
    v_cmp_ne_u32 vcc, 0, v24
    s_nop 3
    s_cmp_eq_u64 vcc, 0
    s_cbranch_scc1 L_ok2
    s_sub_u32 s57, s57, 1
    s_cmp_eq_u32 s57, 0
    s_cbranch_scc1 L_ok2
    s_sleep 8
    s_mov_b32 s58, 157290112
    buffer_load_dwordx4 v[8:11], v7, s[16:19], s58 offen sc1
    s_waitcnt vmcnt(0)
    s_branch L_chk2
L_ok2:
    s_add_u32 m0, s42, 0
    s_nop 0
    buffer_load_dwordx4 v1, s[16:19], s40 offen offset:0 lds
    buffer_load_dwordx4 v1, s[16:19], s40 offen offset:1024 lds
    buffer_load_dwordx4 v1, s[16:19], s40 offen offset:2048 lds
    buffer_load_dwordx4 v1, s[16:19], s40 offen offset:3072 lds
    s_add_u32 s40, s40, 524288
    s_add_u32 m0, s43, 0
    s_nop 0
    buffer_load_dwordx4 v2, s[16:19], s41 offen offset:0 lds
    buffer_load_dwordx4 v2, s[16:19], s41 offen offset:1024 lds
    buffer_load_dwordx4 v2, s[16:19], s41 offen offset:2048 lds
    buffer_load_dwordx4 v2, s[16:19], s41 offen offset:3072 lds
    s_add_u32 m0, s43, 4096
    s_add_u32 s49, s41, 4096
    buffer_load_dwordx4 v2, s[16:19], s49 offen lds
    s_mov_b64 exec, s[50:51]
    buffer_load_dwordx4 v5, s[16:19], s44 offen offset:1024 lds
    s_mov_b64 exec, -1
    s_add_u32 s41, s41, 688128
    s_add_u32 s44, s44, 688128
    s_waitcnt vmcnt(11)
    s_barrier
    s_add_u32 m0, s42, 38912
    s_nop 0
    buffer_load_dwordx4 v1, s[16:19], s40 offen offset:0 lds
    buffer_load_dwordx4 v1, s[16:19], s40 offen offset:1024 lds
    buffer_load_dwordx4 v1, s[16:19], s40 offen offset:2048 lds
    buffer_load_dwordx4 v1, s[16:19], s40 offen offset:3072 lds
    s_add_u32 s40, s40, 524288
    s_add_u32 m0, s43, 38912
    s_nop 0
    buffer_load_dwordx4 v2, s[16:19], s41 offen offset:0 lds
    buffer_load_dwordx4 v2, s[16:19], s41 offen offset:1024 lds
    buffer_load_dwordx4 v2, s[16:19], s41 offen offset:2048 lds
    buffer_load_dwordx4 v2, s[16:19], s41 offen offset:3072 lds
    s_add_u32 m0, s43, 43008
    s_add_u32 s49, s41, 4096
    buffer_load_dwordx4 v2, s[16:19], s49 offen lds
    s_mov_b64 exec, s[50:51]
    buffer_load_dwordx4 v5, s[16:19], s44 offen offset:1024 lds
    s_mov_b64 exec, -1
    s_add_u32 s41, s41, 688128
    s_add_u32 s44, s44, 688128
    s_waitcnt vmcnt(10)
    s_barrier
    s_add_u32 m0, s42, 77824
    s_nop 0
    buffer_load_dwordx4 v1, s[16:19], s40 offen offset:0 lds
    buffer_load_dwordx4 v1, s[16:19], s40 offen offset:1024 lds
    buffer_load_dwordx4 v1, s[16:19], s40 offen offset:2048 lds
    buffer_load_dwordx4 v1, s[16:19], s40 offen offset:3072 lds
    s_add_u32 s40, s40, 524288
    s_add_u32 m0, s43, 77824
    s_nop 0
    buffer_load_dwordx4 v2, s[16:19], s41 offen offset:0 lds
    buffer_load_dwordx4 v2, s[16:19], s41 offen offset:1024 lds
    buffer_load_dwordx4 v2, s[16:19], s41 offen offset:2048 lds
    buffer_load_dwordx4 v2, s[16:19], s41 offen offset:3072 lds
    s_add_u32 m0, s43, 81920
    s_add_u32 s49, s41, 4096
    buffer_load_dwordx4 v2, s[16:19], s49 offen lds
    s_mov_b64 exec, s[50:51]
    buffer_load_dwordx4 v5, s[16:19], s44 offen offset:1024 lds
    s_mov_b64 exec, -1
    s_add_u32 s41, s41, 688128
    s_add_u32 s44, s44, 688128
    s_waitcnt vmcnt(10)
    s_barrier
    s_add_u32 m0, s42, 116736
    s_nop 0
    buffer_load_dwordx4 v1, s[16:19], s40 offen offset:0 lds
    buffer_load_dwordx4 v1, s[16:19], s40 offen offset:1024 lds
    buffer_load_dwordx4 v1, s[16:19], s40 offen offset:2048 lds
    buffer_load_dwordx4 v1, s[16:19], s40 offen offset:3072 lds
    s_add_u32 s40, s40, 524288
    s_add_u32 m0, s43, 116736
    s_nop 0
    buffer_load_dwordx4 v2, s[16:19], s41 offen offset:0 lds
    buffer_load_dwordx4 v2, s[16:19], s41 offen offset:1024 lds
    buffer_load_dwordx4 v2, s[16:19], s41 offen offset:2048 lds
    buffer_load_dwordx4 v2, s[16:19], s41 offen offset:3072 lds
    s_add_u32 m0, s43, 120832
    s_add_u32 s49, s41, 4096
    buffer_load_dwordx4 v2, s[16:19], s49 offen lds
    s_mov_b64 exec, s[50:51]
    buffer_load_dwordx4 v5, s[16:19], s44 offen offset:1024 lds
    s_mov_b64 exec, -1
    s_add_u32 s41, s41, 688128
    s_add_u32 s44, s44, 688128
    s_mov_b32 s58, 157290624
    buffer_load_dwordx4 v[8:11], v7, s[16:19], s58 offen sc1
    s_waitcnt vmcnt(11)
    s_barrier
    s_waitcnt vmcnt(0)
    s_mov_b32 s57, 32768
L_chk3:
    v_xor_b32 v24, s54, v8
    v_xor_b32 v25, s54, v9
    v_xor_b32 v26, s54, v10
    v_xor_b32 v27, s54, v11
    v_or3_b32 v24, v24, v25, v26
    v_or_b32 v24, v24, v27
    v_cmp_ne_u32 vcc, 0, v24
    s_nop 3
    s_cmp_eq_u64 vcc, 0
    s_cbranch_scc1 L_ok3
    s_sub_u32 s57, s57, 1
    s_cmp_eq_u32 s57, 0
    s_cbranch_scc1 L_ok3
    s_sleep 8
    s_mov_b32 s58, 157290624
    buffer_load_dwordx4 v[8:11], v7, s[16:19], s58 offen sc1
    s_waitcnt vmcnt(0)
    s_branch L_chk3
L_ok3:
    s_add_u32 m0, s42, 0
    s_nop 0
    buffer_load_dwordx4 v1, s[16:19], s40 offen offset:0 lds
    buffer_load_dwordx4 v1, s[16:19], s40 offen offset:1024 lds
    buffer_load_dwordx4 v1, s[16:19], s40 offen offset:2048 lds
    buffer_load_dwordx4 v1, s[16:19], s40 offen offset:3072 lds
    s_add_u32 s40, s40, 524288
    s_add_u32 m0, s43, 0
    s_nop 0
    buffer_load_dwordx4 v2, s[16:19], s41 offen offset:0 lds
    buffer_load_dwordx4 v2, s[16:19], s41 offen offset:1024 lds
    buffer_load_dwordx4 v2, s[16:19], s41 offen offset:2048 lds
    buffer_load_dwordx4 v2, s[16:19], s41 offen offset:3072 lds
    s_add_u32 m0, s43, 4096
    s_add_u32 s49, s41, 4096
    buffer_load_dwordx4 v2, s[16:19], s49 offen lds
    s_mov_b64 exec, s[50:51]
    buffer_load_dwordx4 v5, s[16:19], s44 offen offset:1024 lds
    s_mov_b64 exec, -1
    s_add_u32 s41, s41, 688128
    s_add_u32 s44, s44, 688128
    s_waitcnt vmcnt(11)
    s_barrier
    s_add_u32 m0, s42, 38912
    s_nop 0
    buffer_load_dwordx4 v1, s[16:19], s40 offen offset:0 lds
    buffer_load_dwordx4 v1, s[16:19], s40 offen offset:1024 lds
    buffer_load_dwordx4 v1, s[16:19], s40 offen offset:2048 lds
    buffer_load_dwordx4 v1, s[16:19], s40 offen offset:3072 lds
    s_add_u32 s40, s40, 524288
    s_add_u32 m0, s43, 38912
    s_nop 0
    buffer_load_dwordx4 v2, s[16:19], s41 offen offset:0 lds
    buffer_load_dwordx4 v2, s[16:19], s41 offen offset:1024 lds
    buffer_load_dwordx4 v2, s[16:19], s41 offen offset:2048 lds
    buffer_load_dwordx4 v2, s[16:19], s41 offen offset:3072 lds
    s_add_u32 m0, s43, 43008
    s_add_u32 s49, s41, 4096
    buffer_load_dwordx4 v2, s[16:19], s49 offen lds
    s_mov_b64 exec, s[50:51]
    buffer_load_dwordx4 v5, s[16:19], s44 offen offset:1024 lds
    s_mov_b64 exec, -1
    s_add_u32 s41, s41, 688128
    s_add_u32 s44, s44, 688128
    s_waitcnt vmcnt(10)
    s_barrier
    s_add_u32 m0, s42, 77824
    s_nop 0
    buffer_load_dwordx4 v1, s[16:19], s40 offen offset:0 lds
    buffer_load_dwordx4 v1, s[16:19], s40 offen offset:1024 lds
    buffer_load_dwordx4 v1, s[16:19], s40 offen offset:2048 lds
    buffer_load_dwordx4 v1, s[16:19], s40 offen offset:3072 lds
    s_add_u32 s40, s40, 524288
    s_add_u32 m0, s43, 77824
    s_nop 0
    buffer_load_dwordx4 v2, s[16:19], s41 offen offset:0 lds
    buffer_load_dwordx4 v2, s[16:19], s41 offen offset:1024 lds
    buffer_load_dwordx4 v2, s[16:19], s41 offen offset:2048 lds
    buffer_load_dwordx4 v2, s[16:19], s41 offen offset:3072 lds
    s_add_u32 m0, s43, 81920
    s_add_u32 s49, s41, 4096
    buffer_load_dwordx4 v2, s[16:19], s49 offen lds
    s_mov_b64 exec, s[50:51]
    buffer_load_dwordx4 v5, s[16:19], s44 offen offset:1024 lds
    s_mov_b64 exec, -1
    s_add_u32 s41, s41, 688128
    s_add_u32 s44, s44, 688128
    s_waitcnt vmcnt(10)
    s_barrier
    s_add_u32 m0, s42, 116736
    s_nop 0
    buffer_load_dwordx4 v1, s[16:19], s40 offen offset:0 lds
    buffer_load_dwordx4 v1, s[16:19], s40 offen offset:1024 lds
    buffer_load_dwordx4 v1, s[16:19], s40 offen offset:2048 lds
    buffer_load_dwordx4 v1, s[16:19], s40 offen offset:3072 lds
    s_add_u32 s40, s40, 524288
    s_add_u32 m0, s43, 116736
    s_nop 0
    buffer_load_dwordx4 v2, s[16:19], s41 offen offset:0 lds
    buffer_load_dwordx4 v2, s[16:19], s41 offen offset:1024 lds
    buffer_load_dwordx4 v2, s[16:19], s41 offen offset:2048 lds
    buffer_load_dwordx4 v2, s[16:19], s41 offen offset:3072 lds
    s_add_u32 m0, s43, 120832
    s_add_u32 s49, s41, 4096
    buffer_load_dwordx4 v2, s[16:19], s49 offen lds
    s_mov_b64 exec, s[50:51]
    buffer_load_dwordx4 v5, s[16:19], s44 offen offset:1024 lds
    s_mov_b64 exec, -1
    s_add_u32 s41, s41, 688128
    s_add_u32 s44, s44, 688128
    s_mov_b32 s58, 157291136
    buffer_load_dwordx4 v[8:11], v7, s[16:19], s58 offen sc1
    s_waitcnt vmcnt(11)
    s_barrier
    s_waitcnt vmcnt(0)
    s_mov_b32 s57, 32768
L_chk4:
    v_xor_b32 v24, s54, v8
    v_xor_b32 v25, s54, v9
    v_xor_b32 v26, s54, v10
    v_xor_b32 v27, s54, v11
    v_or3_b32 v24, v24, v25, v26
    v_or_b32 v24, v24, v27
    v_cmp_ne_u32 vcc, 0, v24
    s_nop 3
    s_cmp_eq_u64 vcc, 0
    s_cbranch_scc1 L_ok4
    s_sub_u32 s57, s57, 1
    s_cmp_eq_u32 s57, 0
    s_cbranch_scc1 L_ok4
    s_sleep 8
    s_mov_b32 s58, 157291136
    buffer_load_dwordx4 v[8:11], v7, s[16:19], s58 offen sc1
    s_waitcnt vmcnt(0)
    s_branch L_chk4
L_ok4:
    s_add_u32 m0, s42, 0
    s_nop 0
    buffer_load_dwordx4 v1, s[16:19], s40 offen offset:0 lds
    buffer_load_dwordx4 v1, s[16:19], s40 offen offset:1024 lds
    buffer_load_dwordx4 v1, s[16:19], s40 offen offset:2048 lds
    buffer_load_dwordx4 v1, s[16:19], s40 offen offset:3072 lds
    s_add_u32 s40, s40, 524288
    s_add_u32 m0, s43, 0
    s_nop 0
    buffer_load_dwordx4 v2, s[16:19], s41 offen offset:0 lds
    buffer_load_dwordx4 v2, s[16:19], s41 offen offset:1024 lds
    buffer_load_dwordx4 v2, s[16:19], s41 offen offset:2048 lds
    buffer_load_dwordx4 v2, s[16:19], s41 offen offset:3072 lds
    s_add_u32 m0, s43, 4096
    s_add_u32 s49, s41, 4096
    buffer_load_dwordx4 v2, s[16:19], s49 offen lds
    s_mov_b64 exec, s[50:51]
    buffer_load_dwordx4 v5, s[16:19], s44 offen offset:1024 lds
    s_mov_b64 exec, -1
    s_add_u32 s41, s41, 688128
    s_add_u32 s44, s44, 688128
    s_waitcnt vmcnt(11)
    s_barrier
    s_add_u32 m0, s42, 38912
    s_nop 0
    buffer_load_dwordx4 v1, s[16:19], s40 offen offset:0 lds
    buffer_load_dwordx4 v1, s[16:19], s40 offen offset:1024 lds
    buffer_load_dwordx4 v1, s[16:19], s40 offen offset:2048 lds
    buffer_load_dwordx4 v1, s[16:19], s40 offen offset:3072 lds
    s_add_u32 s40, s40, 524288
    s_add_u32 m0, s43, 38912
    s_nop 0
    buffer_load_dwordx4 v2, s[16:19], s41 offen offset:0 lds
    buffer_load_dwordx4 v2, s[16:19], s41 offen offset:1024 lds
    buffer_load_dwordx4 v2, s[16:19], s41 offen offset:2048 lds
    buffer_load_dwordx4 v2, s[16:19], s41 offen offset:3072 lds
    s_add_u32 m0, s43, 43008
    s_add_u32 s49, s41, 4096
    buffer_load_dwordx4 v2, s[16:19], s49 offen lds
    s_mov_b64 exec, s[50:51]
    buffer_load_dwordx4 v5, s[16:19], s44 offen offset:1024 lds
    s_mov_b64 exec, -1
    s_add_u32 s41, s41, 688128
    s_add_u32 s44, s44, 688128
    s_waitcnt vmcnt(10)
    s_barrier
    s_add_u32 m0, s42, 77824
    s_nop 0
    buffer_load_dwordx4 v1, s[16:19], s40 offen offset:0 lds
    buffer_load_dwordx4 v1, s[16:19], s40 offen offset:1024 lds
    buffer_load_dwordx4 v1, s[16:19], s40 offen offset:2048 lds
    buffer_load_dwordx4 v1, s[16:19], s40 offen offset:3072 lds
    s_add_u32 s40, s40, 524288
    s_add_u32 m0, s43, 77824
    s_nop 0
    buffer_load_dwordx4 v2, s[16:19], s41 offen offset:0 lds
    buffer_load_dwordx4 v2, s[16:19], s41 offen offset:1024 lds
    buffer_load_dwordx4 v2, s[16:19], s41 offen offset:2048 lds
    buffer_load_dwordx4 v2, s[16:19], s41 offen offset:3072 lds
    s_add_u32 m0, s43, 81920
    s_add_u32 s49, s41, 4096
    buffer_load_dwordx4 v2, s[16:19], s49 offen lds
    s_mov_b64 exec, s[50:51]
    buffer_load_dwordx4 v5, s[16:19], s44 offen offset:1024 lds
    s_mov_b64 exec, -1
    s_add_u32 s41, s41, 688128
    s_add_u32 s44, s44, 688128
    s_waitcnt vmcnt(10)
    s_barrier
    s_add_u32 m0, s42, 116736
    s_nop 0
    buffer_load_dwordx4 v1, s[16:19], s40 offen offset:0 lds
    buffer_load_dwordx4 v1, s[16:19], s40 offen offset:1024 lds
    buffer_load_dwordx4 v1, s[16:19], s40 offen offset:2048 lds
    buffer_load_dwordx4 v1, s[16:19], s40 offen offset:3072 lds
    s_add_u32 s40, s40, 524288
    s_add_u32 m0, s43, 116736
    s_nop 0
    buffer_load_dwordx4 v2, s[16:19], s41 offen offset:0 lds
    buffer_load_dwordx4 v2, s[16:19], s41 offen offset:1024 lds
    buffer_load_dwordx4 v2, s[16:19], s41 offen offset:2048 lds
    buffer_load_dwordx4 v2, s[16:19], s41 offen offset:3072 lds
    s_add_u32 m0, s43, 120832
    s_add_u32 s49, s41, 4096
    buffer_load_dwordx4 v2, s[16:19], s49 offen lds
    s_mov_b64 exec, s[50:51]
    buffer_load_dwordx4 v5, s[16:19], s44 offen offset:1024 lds
    s_mov_b64 exec, -1
    s_add_u32 s41, s41, 688128
    s_add_u32 s44, s44, 688128
    s_mov_b32 s58, 157291648
    buffer_load_dwordx4 v[8:11], v7, s[16:19], s58 offen sc1
    s_waitcnt vmcnt(11)
    s_barrier
    s_waitcnt vmcnt(0)
    s_mov_b32 s57, 32768
L_chk5:
    v_xor_b32 v24, s54, v8
    v_xor_b32 v25, s54, v9
    v_xor_b32 v26, s54, v10
    v_xor_b32 v27, s54, v11
    v_or3_b32 v24, v24, v25, v26
    v_or_b32 v24, v24, v27
    v_cmp_ne_u32 vcc, 0, v24
    s_nop 3
    s_cmp_eq_u64 vcc, 0
    s_cbranch_scc1 L_ok5
    s_sub_u32 s57, s57, 1
    s_cmp_eq_u32 s57, 0
    s_cbranch_scc1 L_ok5
    s_sleep 8
    s_mov_b32 s58, 157291648
    buffer_load_dwordx4 v[8:11], v7, s[16:19], s58 offen sc1
    s_waitcnt vmcnt(0)
    s_branch L_chk5
L_ok5:
    s_add_u32 m0, s42, 0
    s_nop 0
    buffer_load_dwordx4 v1, s[16:19], s40 offen offset:0 lds
    buffer_load_dwordx4 v1, s[16:19], s40 offen offset:1024 lds
    buffer_load_dwordx4 v1, s[16:19], s40 offen offset:2048 lds
    buffer_load_dwordx4 v1, s[16:19], s40 offen offset:3072 lds
    s_add_u32 s40, s40, 524288
    s_add_u32 m0, s43, 0
    s_nop 0
    buffer_load_dwordx4 v2, s[16:19], s41 offen offset:0 lds
    buffer_load_dwordx4 v2, s[16:19], s41 offen offset:1024 lds
    buffer_load_dwordx4 v2, s[16:19], s41 offen offset:2048 lds
    buffer_load_dwordx4 v2, s[16:19], s41 offen offset:3072 lds
    s_add_u32 m0, s43, 4096
    s_add_u32 s49, s41, 4096
    buffer_load_dwordx4 v2, s[16:19], s49 offen lds
    s_mov_b64 exec, s[50:51]
    buffer_load_dwordx4 v5, s[16:19], s44 offen offset:1024 lds
    s_mov_b64 exec, -1
    s_add_u32 s41, s41, 688128
    s_add_u32 s44, s44, 688128
    s_waitcnt vmcnt(11)
    s_barrier
    s_add_u32 m0, s42, 38912
    s_nop 0
    buffer_load_dwordx4 v1, s[16:19], s40 offen offset:0 lds
    buffer_load_dwordx4 v1, s[16:19], s40 offen offset:1024 lds
    buffer_load_dwordx4 v1, s[16:19], s40 offen offset:2048 lds
    buffer_load_dwordx4 v1, s[16:19], s40 offen offset:3072 lds
    s_add_u32 s40, s40, 524288
    s_add_u32 m0, s43, 38912
    s_nop 0
    buffer_load_dwordx4 v2, s[16:19], s41 offen offset:0 lds
    buffer_load_dwordx4 v2, s[16:19], s41 offen offset:1024 lds
    buffer_load_dwordx4 v2, s[16:19], s41 offen offset:2048 lds
    buffer_load_dwordx4 v2, s[16:19], s41 offen offset:3072 lds
    s_add_u32 m0, s43, 43008
    s_add_u32 s49, s41, 4096
    buffer_load_dwordx4 v2, s[16:19], s49 offen lds
    s_mov_b64 exec, s[50:51]
    buffer_load_dwordx4 v5, s[16:19], s44 offen offset:1024 lds
    s_mov_b64 exec, -1
    s_add_u32 s41, s41, 688128
    s_add_u32 s44, s44, 688128
    s_waitcnt vmcnt(10)
    s_barrier
    s_add_u32 m0, s42, 77824
    s_nop 0
    buffer_load_dwordx4 v1, s[16:19], s40 offen offset:0 lds
    buffer_load_dwordx4 v1, s[16:19], s40 offen offset:1024 lds
    buffer_load_dwordx4 v1, s[16:19], s40 offen offset:2048 lds
    buffer_load_dwordx4 v1, s[16:19], s40 offen offset:3072 lds
    s_add_u32 s40, s40, 524288
    s_add_u32 m0, s43, 77824
    s_nop 0
    buffer_load_dwordx4 v2, s[16:19], s41 offen offset:0 lds
    buffer_load_dwordx4 v2, s[16:19], s41 offen offset:1024 lds
    buffer_load_dwordx4 v2, s[16:19], s41 offen offset:2048 lds
    buffer_load_dwordx4 v2, s[16:19], s41 offen offset:3072 lds
    s_add_u32 m0, s43, 81920
    s_add_u32 s49, s41, 4096
    buffer_load_dwordx4 v2, s[16:19], s49 offen lds
    s_mov_b64 exec, s[50:51]
    buffer_load_dwordx4 v5, s[16:19], s44 offen offset:1024 lds
    s_mov_b64 exec, -1
    s_add_u32 s41, s41, 688128
    s_add_u32 s44, s44, 688128
    s_waitcnt vmcnt(10)
    s_barrier
    s_add_u32 m0, s42, 116736
    s_nop 0
    buffer_load_dwordx4 v1, s[16:19], s40 offen offset:0 lds
    buffer_load_dwordx4 v1, s[16:19], s40 offen offset:1024 lds
    buffer_load_dwordx4 v1, s[16:19], s40 offen offset:2048 lds
    buffer_load_dwordx4 v1, s[16:19], s40 offen offset:3072 lds
    s_add_u32 s40, s40, 524288
    s_add_u32 m0, s43, 116736
    s_nop 0
    buffer_load_dwordx4 v2, s[16:19], s41 offen offset:0 lds
    buffer_load_dwordx4 v2, s[16:19], s41 offen offset:1024 lds
    buffer_load_dwordx4 v2, s[16:19], s41 offen offset:2048 lds
    buffer_load_dwordx4 v2, s[16:19], s41 offen offset:3072 lds
    s_add_u32 m0, s43, 120832
    s_add_u32 s49, s41, 4096
    buffer_load_dwordx4 v2, s[16:19], s49 offen lds
    s_mov_b64 exec, s[50:51]
    buffer_load_dwordx4 v5, s[16:19], s44 offen offset:1024 lds
    s_mov_b64 exec, -1
    s_add_u32 s41, s41, 688128
    s_add_u32 s44, s44, 688128
    s_mov_b32 s58, 157292160
    buffer_load_dwordx4 v[8:11], v7, s[16:19], s58 offen sc1
    s_waitcnt vmcnt(11)
    s_barrier
    s_waitcnt vmcnt(0)
    s_mov_b32 s57, 32768
L_chk6:
    v_xor_b32 v24, s54, v8
    v_xor_b32 v25, s54, v9
    v_xor_b32 v26, s54, v10
    v_xor_b32 v27, s54, v11
    v_or3_b32 v24, v24, v25, v26
    v_or_b32 v24, v24, v27
    v_cmp_ne_u32 vcc, 0, v24
    s_nop 3
    s_cmp_eq_u64 vcc, 0
    s_cbranch_scc1 L_ok6
    s_sub_u32 s57, s57, 1
    s_cmp_eq_u32 s57, 0
    s_cbranch_scc1 L_ok6
    s_sleep 8
    s_mov_b32 s58, 157292160
    buffer_load_dwordx4 v[8:11], v7, s[16:19], s58 offen sc1
    s_waitcnt vmcnt(0)
    s_branch L_chk6
L_ok6:
    s_add_u32 m0, s42, 0
    s_nop 0
    buffer_load_dwordx4 v1, s[16:19], s40 offen offset:0 lds
    buffer_load_dwordx4 v1, s[16:19], s40 offen offset:1024 lds
    buffer_load_dwordx4 v1, s[16:19], s40 offen offset:2048 lds
    buffer_load_dwordx4 v1, s[16:19], s40 offen offset:3072 lds
    s_add_u32 s40, s40, 524288
    s_add_u32 m0, s43, 0
    s_nop 0
    buffer_load_dwordx4 v2, s[16:19], s41 offen offset:0 lds
    buffer_load_dwordx4 v2, s[16:19], s41 offen offset:1024 lds
    buffer_load_dwordx4 v2, s[16:19], s41 offen offset:2048 lds
    buffer_load_dwordx4 v2, s[16:19], s41 offen offset:3072 lds
    s_add_u32 m0, s43, 4096
    s_add_u32 s49, s41, 4096
    buffer_load_dwordx4 v2, s[16:19], s49 offen lds
    s_mov_b64 exec, s[50:51]
    buffer_load_dwordx4 v5, s[16:19], s44 offen offset:1024 lds
    s_mov_b64 exec, -1
    s_add_u32 s41, s41, 688128
    s_add_u32 s44, s44, 688128
    s_waitcnt vmcnt(11)
    s_barrier
    s_add_u32 m0, s42, 38912
    s_nop 0
    buffer_load_dwordx4 v1, s[16:19], s40 offen offset:0 lds
    buffer_load_dwordx4 v1, s[16:19], s40 offen offset:1024 lds
    buffer_load_dwordx4 v1, s[16:19], s40 offen offset:2048 lds
    buffer_load_dwordx4 v1, s[16:19], s40 offen offset:3072 lds
    s_add_u32 s40, s40, 524288
    s_add_u32 m0, s43, 38912
    s_nop 0
    buffer_load_dwordx4 v2, s[16:19], s41 offen offset:0 lds
    buffer_load_dwordx4 v2, s[16:19], s41 offen offset:1024 lds
    buffer_load_dwordx4 v2, s[16:19], s41 offen offset:2048 lds
    buffer_load_dwordx4 v2, s[16:19], s41 offen offset:3072 lds
    s_add_u32 m0, s43, 43008
    s_add_u32 s49, s41, 4096
    buffer_load_dwordx4 v2, s[16:19], s49 offen lds
    s_mov_b64 exec, s[50:51]
    buffer_load_dwordx4 v5, s[16:19], s44 offen offset:1024 lds
    s_mov_b64 exec, -1
    s_add_u32 s41, s41, 688128
    s_add_u32 s44, s44, 688128
    s_waitcnt vmcnt(10)
    s_barrier
    s_add_u32 m0, s42, 77824
    s_nop 0
    buffer_load_dwordx4 v1, s[16:19], s40 offen offset:0 lds
    buffer_load_dwordx4 v1, s[16:19], s40 offen offset:1024 lds
    buffer_load_dwordx4 v1, s[16:19], s40 offen offset:2048 lds
    buffer_load_dwordx4 v1, s[16:19], s40 offen offset:3072 lds
    s_add_u32 s40, s40, 524288
    s_add_u32 m0, s43, 77824
    s_nop 0
    buffer_load_dwordx4 v2, s[16:19], s41 offen offset:0 lds
    buffer_load_dwordx4 v2, s[16:19], s41 offen offset:1024 lds
    buffer_load_dwordx4 v2, s[16:19], s41 offen offset:2048 lds
    buffer_load_dwordx4 v2, s[16:19], s41 offen offset:3072 lds
    s_add_u32 m0, s43, 81920
    s_add_u32 s49, s41, 4096
    buffer_load_dwordx4 v2, s[16:19], s49 offen lds
    s_mov_b64 exec, s[50:51]
    buffer_load_dwordx4 v5, s[16:19], s44 offen offset:1024 lds
    s_mov_b64 exec, -1
    s_add_u32 s41, s41, 688128
    s_add_u32 s44, s44, 688128
    s_waitcnt vmcnt(10)
    s_barrier
    s_add_u32 m0, s42, 116736
    s_nop 0
    buffer_load_dwordx4 v1, s[16:19], s40 offen offset:0 lds
    buffer_load_dwordx4 v1, s[16:19], s40 offen offset:1024 lds
    buffer_load_dwordx4 v1, s[16:19], s40 offen offset:2048 lds
    buffer_load_dwordx4 v1, s[16:19], s40 offen offset:3072 lds
    s_add_u32 s40, s40, 524288
    s_add_u32 m0, s43, 116736
    s_nop 0
    buffer_load_dwordx4 v2, s[16:19], s41 offen offset:0 lds
    buffer_load_dwordx4 v2, s[16:19], s41 offen offset:1024 lds
    buffer_load_dwordx4 v2, s[16:19], s41 offen offset:2048 lds
    buffer_load_dwordx4 v2, s[16:19], s41 offen offset:3072 lds
    s_add_u32 m0, s43, 120832
    s_add_u32 s49, s41, 4096
    buffer_load_dwordx4 v2, s[16:19], s49 offen lds
    s_mov_b64 exec, s[50:51]
    buffer_load_dwordx4 v5, s[16:19], s44 offen offset:1024 lds
    s_mov_b64 exec, -1
    s_add_u32 s41, s41, 688128
    s_add_u32 s44, s44, 688128
    s_mov_b32 s58, 157292672
    buffer_load_dwordx4 v[8:11], v7, s[16:19], s58 offen sc1
    s_waitcnt vmcnt(11)
    s_barrier
    s_waitcnt vmcnt(0)
    s_mov_b32 s57, 32768
L_chk7:
    v_xor_b32 v24, s54, v8
    v_xor_b32 v25, s54, v9
    v_xor_b32 v26, s54, v10
    v_xor_b32 v27, s54, v11
    v_or3_b32 v24, v24, v25, v26
    v_or_b32 v24, v24, v27
    v_cmp_ne_u32 vcc, 0, v24
    s_nop 3
    s_cmp_eq_u64 vcc, 0
    s_cbranch_scc1 L_ok7
    s_sub_u32 s57, s57, 1
    s_cmp_eq_u32 s57, 0
    s_cbranch_scc1 L_ok7
    s_sleep 8
    s_mov_b32 s58, 157292672
    buffer_load_dwordx4 v[8:11], v7, s[16:19], s58 offen sc1
    s_waitcnt vmcnt(0)
    s_branch L_chk7
L_ok7:
    s_add_u32 m0, s42, 0
    s_nop 0
    buffer_load_dwordx4 v1, s[16:19], s40 offen offset:0 lds
    buffer_load_dwordx4 v1, s[16:19], s40 offen offset:1024 lds
    buffer_load_dwordx4 v1, s[16:19], s40 offen offset:2048 lds
    buffer_load_dwordx4 v1, s[16:19], s40 offen offset:3072 lds
    s_add_u32 s40, s40, 524288
    s_add_u32 m0, s43, 0
    s_nop 0
    buffer_load_dwordx4 v2, s[16:19], s41 offen offset:0 lds
    buffer_load_dwordx4 v2, s[16:19], s41 offen offset:1024 lds
    buffer_load_dwordx4 v2, s[16:19], s41 offen offset:2048 lds
    buffer_load_dwordx4 v2, s[16:19], s41 offen offset:3072 lds
    s_add_u32 m0, s43, 4096
    s_add_u32 s49, s41, 4096
    buffer_load_dwordx4 v2, s[16:19], s49 offen lds
    s_mov_b64 exec, s[50:51]
    buffer_load_dwordx4 v5, s[16:19], s44 offen offset:1024 lds
    s_mov_b64 exec, -1
    s_add_u32 s41, s41, 688128
    s_add_u32 s44, s44, 688128
    s_waitcnt vmcnt(11)
    s_barrier
    s_add_u32 m0, s42, 38912
    s_nop 0
    buffer_load_dwordx4 v1, s[16:19], s40 offen offset:0 lds
    buffer_load_dwordx4 v1, s[16:19], s40 offen offset:1024 lds
    buffer_load_dwordx4 v1, s[16:19], s40 offen offset:2048 lds
    buffer_load_dwordx4 v1, s[16:19], s40 offen offset:3072 lds
    s_add_u32 s40, s40, 524288
    s_add_u32 m0, s43, 38912
    s_nop 0
    buffer_load_dwordx4 v2, s[16:19], s41 offen offset:0 lds
    buffer_load_dwordx4 v2, s[16:19], s41 offen offset:1024 lds
    buffer_load_dwordx4 v2, s[16:19], s41 offen offset:2048 lds
    buffer_load_dwordx4 v2, s[16:19], s41 offen offset:3072 lds
    s_add_u32 m0, s43, 43008
    s_add_u32 s49, s41, 4096
    buffer_load_dwordx4 v2, s[16:19], s49 offen lds
    s_mov_b64 exec, s[50:51]
    buffer_load_dwordx4 v5, s[16:19], s44 offen offset:1024 lds
    s_mov_b64 exec, -1
    s_add_u32 s41, s41, 688128
    s_add_u32 s44, s44, 688128
    s_waitcnt vmcnt(10)
    s_barrier
    s_add_u32 m0, s42, 77824
    s_nop 0
    buffer_load_dwordx4 v1, s[16:19], s40 offen offset:0 lds
    buffer_load_dwordx4 v1, s[16:19], s40 offen offset:1024 lds
    buffer_load_dwordx4 v1, s[16:19], s40 offen offset:2048 lds
    buffer_load_dwordx4 v1, s[16:19], s40 offen offset:3072 lds
    s_add_u32 s40, s40, 524288
    s_add_u32 m0, s43, 77824
    s_nop 0
    buffer_load_dwordx4 v2, s[16:19], s41 offen offset:0 lds
    buffer_load_dwordx4 v2, s[16:19], s41 offen offset:1024 lds
    buffer_load_dwordx4 v2, s[16:19], s41 offen offset:2048 lds
    buffer_load_dwordx4 v2, s[16:19], s41 offen offset:3072 lds
    s_add_u32 m0, s43, 81920
    s_add_u32 s49, s41, 4096
    buffer_load_dwordx4 v2, s[16:19], s49 offen lds
    s_mov_b64 exec, s[50:51]
    buffer_load_dwordx4 v5, s[16:19], s44 offen offset:1024 lds
    s_mov_b64 exec, -1
    s_add_u32 s41, s41, 688128
    s_add_u32 s44, s44, 688128
    s_waitcnt vmcnt(10)
    s_barrier
    s_add_u32 m0, s42, 116736
    s_nop 0
    buffer_load_dwordx4 v1, s[16:19], s40 offen offset:0 lds
    buffer_load_dwordx4 v1, s[16:19], s40 offen offset:1024 lds
    buffer_load_dwordx4 v1, s[16:19], s40 offen offset:2048 lds
    buffer_load_dwordx4 v1, s[16:19], s40 offen offset:3072 lds
    s_add_u32 s40, s40, 524288
    s_add_u32 m0, s43, 116736
    s_nop 0
    buffer_load_dwordx4 v2, s[16:19], s41 offen offset:0 lds
    buffer_load_dwordx4 v2, s[16:19], s41 offen offset:1024 lds
    buffer_load_dwordx4 v2, s[16:19], s41 offen offset:2048 lds
    buffer_load_dwordx4 v2, s[16:19], s41 offen offset:3072 lds
    s_add_u32 m0, s43, 120832
    s_add_u32 s49, s41, 4096
    buffer_load_dwordx4 v2, s[16:19], s49 offen lds
    s_mov_b64 exec, s[50:51]
    buffer_load_dwordx4 v5, s[16:19], s44 offen offset:1024 lds
    s_mov_b64 exec, -1
    s_add_u32 s41, s41, 688128
    s_add_u32 s44, s44, 688128
    s_waitcnt vmcnt(10)
    s_barrier
    s_waitcnt vmcnt(0)
    s_barrier
    s_cmp_ge_u32 s2, 224
    s_cbranch_scc1 L_nofill
    s_cmp_lg_u32 s15, 1
    s_cbranch_scc1 L_nofill
    s_lshl_b32 s20, s2, 10
    s_add_u32 s20, s20, 146800640
    v_mov_b32 v8, -1
    v_mov_b32 v9, -1
    v_mov_b32 v10, -1
    v_mov_b32 v11, -1
    v_lshlrev_b32 v4, 4, v0
    buffer_store_dwordx4 v[8:11], v4, s[16:19], s20 offen sc1
L_nofill:
L_fz_end:
    s_endpgm
.globl final_kernel
.p2align 8
.type final_kernel,@function
final_kernel:
    s_cmp_ge_u32 s2, 224
    s_cbranch_scc1 L_k45_end
    s_load_dwordx2 s[8:9], s[0:1], 48
    s_load_dwordx4 s[4:7], s[0:1], 16
    s_load_dwordx2 s[28:29], s[0:1], 32
    v_lshrrev_b32 v204, 6, v0
    v_and_b32 v200, 63, v0
    v_readfirstlane_b32 s10, v204
    s_cmp_ge_u32 s2, 8
    s_cbranch_scc1 L_nopf45
    s_nop 1
    s_cmp_lg_u32 s10, 7
    s_cbranch_scc1 L_nopf45
    s_getpc_b64 s[60:61]
L_pf_k45:
    s_sub_u32 s60, s60, L_pf_k45-final_kernel
    s_subb_u32 s61, s61, 0
    v_mbcnt_lo_u32_b32 v112, -1, 0
    v_mbcnt_hi_u32_b32 v112, -1, v112
    v_lshlrev_b32 v112, 6, v112
    v_add_u32 v113, 0, v112
    v_min_u32 v113, L_code_end-final_kernel-4, v113
    v_mov_b32 v115, s61
    v_add_co_u32 v114, vcc, s60, v113
    s_nop 1
    v_addc_co_u32 v115, vcc, 0, v115, vcc
    global_load_dword v116, v[114:115], off
    v_add_u32 v113, 4096, v112
    v_min_u32 v113, L_code_end-final_kernel-4, v113
    v_mov_b32 v115, s61
    v_add_co_u32 v114, vcc, s60, v113
    s_nop 1
    v_addc_co_u32 v115, vcc, 0, v115, vcc
    global_load_dword v116, v[114:115], off
    v_add_u32 v113, 8192, v112
    v_min_u32 v113, L_code_end-final_kernel-4, v113
    v_mov_b32 v115, s61
    v_add_co_u32 v114, vcc, s60, v113
    s_nop 1
    v_addc_co_u32 v115, vcc, 0, v115, vcc
    global_load_dword v116, v[114:115], off
L_nopf45:
    v_lshlrev_b32 v214, 2, v0
    v_and_b32 v201, 15, v200
    v_lshrrev_b32 v202, 4, v200
    s_and_b32 s13, s2, 3
    s_lshr_b32 s12, s2, 2
    s_cmp_ge_u32 s12, 28
    s_cselect_b32 s11, 1, 0
    s_mul_i32 s15, s11, 28
    s_sub_u32 s12, s12, s15
    s_mul_i32 s14, s12, 6
    s_add_u32 s14, s14, s10
    s_mov_b32 s24, 90112
    v_mul_u32_u24 v203, s24, v202
    v_lshrrev_b32 v205, 2, v201
    s_mov_b32 s24, 720896
    v_mad_u32_u24 v203, v205, s24, v203
    v_and_b32 v205, 3, v201
    v_lshl_add_u32 v203, v205, 4, v203
    s_mul_i32 s24, s11, 11534336
    s_mul_i32 s25, s13, 2883584
    s_add_u32 s24, s24, s25
    s_lshl_b32 s25, s14, 6
    s_add_u32 s24, s24, s25
    s_add_u32 s24, s24, 117440512
    s_mov_b32 s30, 0x05040100
    s_mov_b32 s31, 0x07060302
    s_waitcnt lgkmcnt(0)
    s_mov_b32 s16, s8
    s_and_b32 s17, s9, 0xffff
    s_mov_b32 s18, 268435456
    s_mov_b32 s19, 0x00020000
    s_cmp_ge_u32 s10, 6
    s_cbranch_scc1 L_k45_gb
    s_add_u32 s25, s24, 0
    buffer_load_dwordx4 v[0:3], v203, s[16:19], s25 offen
    s_add_u32 s25, s24, 11264
    buffer_load_dwordx4 v[4:7], v203, s[16:19], s25 offen
    s_add_u32 s25, s24, 22528
    buffer_load_dwordx4 v[8:11], v203, s[16:19], s25 offen
    s_add_u32 s25, s24, 33792
    buffer_load_dwordx4 v[12:15], v203, s[16:19], s25 offen
    s_add_u32 s25, s24, 45056
    buffer_load_dwordx4 v[16:19], v203, s[16:19], s25 offen
    s_add_u32 s25, s24, 56320
    buffer_load_dwordx4 v[20:23], v203, s[16:19], s25 offen
    s_add_u32 s25, s24, 67584
    buffer_load_dwordx4 v[24:27], v203, s[16:19], s25 offen
    s_add_u32 s25, s24, 78848
    buffer_load_dwordx4 v[28:31], v203, s[16:19], s25 offen
    s_add_u32 s25, s24, 360448
    buffer_load_dwordx4 v[32:35], v203, s[16:19], s25 offen
    s_add_u32 s25, s24, 371712
    buffer_load_dwordx4 v[36:39], v203, s[16:19], s25 offen
    s_add_u32 s25, s24, 382976
    buffer_load_dwordx4 v[40:43], v203, s[16:19], s25 offen
    s_add_u32 s25, s24, 394240
    buffer_load_dwordx4 v[44:47], v203, s[16:19], s25 offen
    s_add_u32 s25, s24, 405504
    buffer_load_dwordx4 v[48:51], v203, s[16:19], s25 offen
    s_add_u32 s25, s24, 416768
    buffer_load_dwordx4 v[52:55], v203, s[16:19], s25 offen
    s_add_u32 s25, s24, 428032
    buffer_load_dwordx4 v[56:59], v203, s[16:19], s25 offen
    s_add_u32 s25, s24, 439296
    buffer_load_dwordx4 v[60:63], v203, s[16:19], s25 offen
    s_lshr_b32 s27, s10, 1
    s_and_b32 s33, s10, 1
    s_lshl_b32 s27, s27, 4
    v_add_u32 v204, s27, v201
    s_lshl_b32 s33, s33, 5
    s_add_u32 s33, s33, 1
    v_lshlrev_b32 v205, 3, v202
    v_add_u32 v205, s33, v205
    v_mul_u32_u24 v88, v205, v204
    v_add_u32 v89, 32, v88
    v_add_u32 v205, 2, v205
    v_mul_u32_u24 v90, v205, v204
    v_add_u32 v91, 32, v90
    v_add_u32 v205, 2, v205
    v_mul_u32_u24 v92, v205, v204
    v_add_u32 v93, 32, v92
    v_add_u32 v205, 2, v205
    v_mul_u32_u24 v94, v205, v204
    v_add_u32 v95, 32, v94
    v_and_b32 v88, 127, v88
    v_cvt_f32_u32 v88, v88
    v_mul_f32 v88, 0x3c000000, v88
    v_cos_f32 v88, v88
    v_and_b32 v89, 127, v89
    v_cvt_f32_u32 v89, v89
    v_mul_f32 v89, 0x3c000000, v89
    v_cos_f32 v89, v89
    v_and_b32 v90, 127, v90
    v_cvt_f32_u32 v90, v90
    v_mul_f32 v90, 0x3c000000, v90
    v_cos_f32 v90, v90
    v_and_b32 v91, 127, v91
    v_cvt_f32_u32 v91, v91
    v_mul_f32 v91, 0x3c000000, v91
    v_cos_f32 v91, v91
    v_and_b32 v92, 127, v92
    v_cvt_f32_u32 v92, v92
    v_mul_f32 v92, 0x3c000000, v92
    v_cos_f32 v92, v92
    v_and_b32 v93, 127, v93
    v_cvt_f32_u32 v93, v93
    v_mul_f32 v93, 0x3c000000, v93
    v_cos_f32 v93, v93
    v_and_b32 v94, 127, v94
    v_cvt_f32_u32 v94, v94
    v_mul_f32 v94, 0x3c000000, v94
    v_cos_f32 v94, v94
    v_and_b32 v95, 127, v95
    v_cvt_f32_u32 v95, v95
    v_mul_f32 v95, 0x3c000000, v95
    v_cos_f32 v95, v95
    v_mul_f32 v88, 0x3d000000, v88
    v_mul_f32 v89, 0x3d000000, v89
    v_mul_f32 v90, 0x3d000000, v90
    v_mul_f32 v91, 0x3d000000, v91
    v_mul_f32 v92, 0x3d000000, v92
    v_mul_f32 v93, 0x3d000000, v93
    v_mul_f32 v94, 0x3d000000, v94
    v_mul_f32 v95, 0x3d000000, v95
    v_cvt_pk_bf16_f32 v104, v88, v89
    v_cvt_pk_bf16_f32 v105, v90, v91
    v_cvt_pk_bf16_f32 v106, v92, v93
    v_cvt_pk_bf16_f32 v107, v94, v95
    s_lshl_b32 s26, s10, 10
    v_lshlrev_b32 v207, 4, v200
    v_add_u32 v207, s26, v207
    ds_write_b128 v207, v[104:107] offset:0
L_k45_gb:
    s_mov_b32 s20, s4
    s_and_b32 s21, s5, 0xffff
    s_mov_b32 s22, 1024
    s_mov_b32 s23, 0x00020000
    s_mov_b32 s36, s6
    s_and_b32 s37, s7, 0xffff
    s_mov_b32 s38, 1024
    s_mov_b32 s39, 0x00020000
    v_lshlrev_b32 v210, 4, v201
    s_lshl_b32 s25, s13, 8
    buffer_load_dwordx4 v[232:235], v210, s[20:23], s25 offen
    buffer_load_dwordx4 v[236:239], v210, s[36:39], s25 offen
    s_waitcnt lgkmcnt(0)
    s_barrier
    s_cmp_ge_u32 s10, 6
    s_cbranch_scc1 L_k45_red2
    v_lshlrev_b32 v207, 4, v200
    ds_read_b128 v[64:67], v207 offset:0
    ds_read_b128 v[68:71], v207 offset:1024
    ds_read_b128 v[72:75], v207 offset:2048
    ds_read_b128 v[76:79], v207 offset:3072
    ds_read_b128 v[80:83], v207 offset:4096
    ds_read_b128 v[84:87], v207 offset:5120
    s_cmp_ge_u32 s14, 167
    s_cbranch_scc1 L_k45_zero
    s_waitcnt lgkmcnt(0)
    s_cmp_lg_u32 s14, 166
    s_cbranch_scc1 L_k45_full
    v_cmp_gt_i32 vcc, 17, v201
    s_nop 1
    v_cndmask_b32 v64, 0, v64, vcc
    v_cndmask_b32 v65, 0, v65, vcc
    v_cndmask_b32 v66, 0, v66, vcc
    v_cndmask_b32 v67, 0, v67, vcc
    v_cndmask_b32 v68, 0, v68, vcc
    v_cndmask_b32 v69, 0, v69, vcc
    v_cndmask_b32 v70, 0, v70, vcc
    v_cndmask_b32 v71, 0, v71, vcc
    v_cmp_gt_i32 vcc, 1, v201
    s_nop 1
    v_cndmask_b32 v72, 0, v72, vcc
    v_cndmask_b32 v73, 0, v73, vcc
    v_cndmask_b32 v74, 0, v74, vcc
    v_cndmask_b32 v75, 0, v75, vcc
    v_cndmask_b32 v76, 0, v76, vcc
    v_cndmask_b32 v77, 0, v77, vcc
    v_cndmask_b32 v78, 0, v78, vcc
    v_cndmask_b32 v79, 0, v79, vcc
    v_cmp_gt_i32 vcc, 0, v201
    s_nop 1
    v_cndmask_b32 v80, 0, v80, vcc
    v_cndmask_b32 v81, 0, v81, vcc
    v_cndmask_b32 v82, 0, v82, vcc
    v_cndmask_b32 v83, 0, v83, vcc
    v_cndmask_b32 v84, 0, v84, vcc
    v_cndmask_b32 v85, 0, v85, vcc
    v_cndmask_b32 v86, 0, v86, vcc
    v_cndmask_b32 v87, 0, v87, vcc
L_k45_full:
    s_waitcnt vmcnt(2)
    v_perm_b32 v88, v4, v0, s30
    v_perm_b32 v89, v12, v8, s30
    v_perm_b32 v90, v20, v16, s30
    v_perm_b32 v91, v28, v24, s30
    v_perm_b32 v92, v4, v0, s31
    v_perm_b32 v93, v12, v8, s31
    v_perm_b32 v94, v20, v16, s31
    v_perm_b32 v95, v28, v24, s31
    v_perm_b32 v96, v36, v32, s30
    v_perm_b32 v97, v44, v40, s30
    v_perm_b32 v98, v52, v48, s30
    v_perm_b32 v99, v60, v56, s30
    v_perm_b32 v100, v36, v32, s31
    v_perm_b32 v101, v44, v40, s31
    v_perm_b32 v102, v52, v48, s31
    v_perm_b32 v103, v60, v56, s31
    v_mfma_f32_16x16x32_bf16 v[104:107], v[64:67], v[88:91], 0
    v_mfma_f32_16x16x32_bf16 v[108:111], v[64:67], v[92:95], 0
    v_mfma_f32_16x16x32_bf16 v[136:139], v[72:75], v[88:91], 0
    v_mfma_f32_16x16x32_bf16 v[140:143], v[72:75], v[92:95], 0
    v_mfma_f32_16x16x32_bf16 v[168:171], v[80:83], v[88:91], 0
    v_mfma_f32_16x16x32_bf16 v[172:175], v[80:83], v[92:95], 0
    v_mfma_f32_16x16x32_bf16 v[104:107], v[68:71], v[96:99], v[104:107]
    v_mfma_f32_16x16x32_bf16 v[108:111], v[68:71], v[100:103], v[108:111]
    v_mfma_f32_16x16x32_bf16 v[136:139], v[76:79], v[96:99], v[136:139]
    v_mfma_f32_16x16x32_bf16 v[140:143], v[76:79], v[100:103], v[140:143]
    v_mfma_f32_16x16x32_bf16 v[168:171], v[84:87], v[96:99], v[168:171]
    v_mfma_f32_16x16x32_bf16 v[172:175], v[84:87], v[100:103], v[172:175]
    v_perm_b32 v88, v5, v1, s30
    v_perm_b32 v89, v13, v9, s30
    v_perm_b32 v90, v21, v17, s30
    v_perm_b32 v91, v29, v25, s30
    v_perm_b32 v92, v5, v1, s31
    v_perm_b32 v93, v13, v9, s31
    v_perm_b32 v94, v21, v17, s31
    v_perm_b32 v95, v29, v25, s31
    v_perm_b32 v96, v37, v33, s30
    v_perm_b32 v97, v45, v41, s30
    v_perm_b32 v98, v53, v49, s30
    v_perm_b32 v99, v61, v57, s30
    v_perm_b32 v100, v37, v33, s31
    v_perm_b32 v101, v45, v41, s31
    v_perm_b32 v102, v53, v49, s31
    v_perm_b32 v103, v61, v57, s31
    v_mfma_f32_16x16x32_bf16 v[112:115], v[64:67], v[88:91], 0
    v_mfma_f32_16x16x32_bf16 v[116:119], v[64:67], v[92:95], 0
    v_mfma_f32_16x16x32_bf16 v[144:147], v[72:75], v[88:91], 0
    v_mfma_f32_16x16x32_bf16 v[148:151], v[72:75], v[92:95], 0
    v_mfma_f32_16x16x32_bf16 v[176:179], v[80:83], v[88:91], 0
    v_mfma_f32_16x16x32_bf16 v[180:183], v[80:83], v[92:95], 0
    v_mfma_f32_16x16x32_bf16 v[112:115], v[68:71], v[96:99], v[112:115]
    v_mfma_f32_16x16x32_bf16 v[116:119], v[68:71], v[100:103], v[116:119]
    v_mfma_f32_16x16x32_bf16 v[144:147], v[76:79], v[96:99], v[144:147]
    v_mfma_f32_16x16x32_bf16 v[148:151], v[76:79], v[100:103], v[148:151]
    v_mfma_f32_16x16x32_bf16 v[176:179], v[84:87], v[96:99], v[176:179]
    v_mfma_f32_16x16x32_bf16 v[180:183], v[84:87], v[100:103], v[180:183]
    v_perm_b32 v88, v6, v2, s30
    v_perm_b32 v89, v14, v10, s30
    v_perm_b32 v90, v22, v18, s30
    v_perm_b32 v91, v30, v26, s30
    v_perm_b32 v92, v6, v2, s31
    v_perm_b32 v93, v14, v10, s31
    v_perm_b32 v94, v22, v18, s31
    v_perm_b32 v95, v30, v26, s31
    v_perm_b32 v96, v38, v34, s30
    v_perm_b32 v97, v46, v42, s30
    v_perm_b32 v98, v54, v50, s30
    v_perm_b32 v99, v62, v58, s30
    v_perm_b32 v100, v38, v34, s31
    v_perm_b32 v101, v46, v42, s31
    v_perm_b32 v102, v54, v50, s31
    v_perm_b32 v103, v62, v58, s31
    v_mfma_f32_16x16x32_bf16 v[120:123], v[64:67], v[88:91], 0
    v_mfma_f32_16x16x32_bf16 v[124:127], v[64:67], v[92:95], 0
    v_mfma_f32_16x16x32_bf16 v[152:155], v[72:75], v[88:91], 0
    v_mfma_f32_16x16x32_bf16 v[156:159], v[72:75], v[92:95], 0
    v_mfma_f32_16x16x32_bf16 v[184:187], v[80:83], v[88:91], 0
    v_mfma_f32_16x16x32_bf16 v[188:191], v[80:83], v[92:95], 0
    v_mfma_f32_16x16x32_bf16 v[120:123], v[68:71], v[96:99], v[120:123]
    v_mfma_f32_16x16x32_bf16 v[124:127], v[68:71], v[100:103], v[124:127]
    v_mfma_f32_16x16x32_bf16 v[152:155], v[76:79], v[96:99], v[152:155]
    v_mfma_f32_16x16x32_bf16 v[156:159], v[76:79], v[100:103], v[156:159]
    v_mfma_f32_16x16x32_bf16 v[184:187], v[84:87], v[96:99], v[184:187]
    v_mfma_f32_16x16x32_bf16 v[188:191], v[84:87], v[100:103], v[188:191]
    v_perm_b32 v88, v7, v3, s30
    v_perm_b32 v89, v15, v11, s30
    v_perm_b32 v90, v23, v19, s30
    v_perm_b32 v91, v31, v27, s30
    v_perm_b32 v92, v7, v3, s31
    v_perm_b32 v93, v15, v11, s31
    v_perm_b32 v94, v23, v19, s31
    v_perm_b32 v95, v31, v27, s31
    v_perm_b32 v96, v39, v35, s30
    v_perm_b32 v97, v47, v43, s30
    v_perm_b32 v98, v55, v51, s30
    v_perm_b32 v99, v63, v59, s30
    v_perm_b32 v100, v39, v35, s31
    v_perm_b32 v101, v47, v43, s31
    v_perm_b32 v102, v55, v51, s31
    v_perm_b32 v103, v63, v59, s31
    v_mfma_f32_16x16x32_bf16 v[128:131], v[64:67], v[88:91], 0
    v_mfma_f32_16x16x32_bf16 v[132:135], v[64:67], v[92:95], 0
    v_mfma_f32_16x16x32_bf16 v[160:163], v[72:75], v[88:91], 0
    v_mfma_f32_16x16x32_bf16 v[164:167], v[72:75], v[92:95], 0
    v_mfma_f32_16x16x32_bf16 v[192:195], v[80:83], v[88:91], 0
    v_mfma_f32_16x16x32_bf16 v[196:199], v[80:83], v[92:95], 0
    v_mfma_f32_16x16x32_bf16 v[128:131], v[68:71], v[96:99], v[128:131]
    v_mfma_f32_16x16x32_bf16 v[132:135], v[68:71], v[100:103], v[132:135]
    v_mfma_f32_16x16x32_bf16 v[160:163], v[76:79], v[96:99], v[160:163]
    v_mfma_f32_16x16x32_bf16 v[164:167], v[76:79], v[100:103], v[164:167]
    v_mfma_f32_16x16x32_bf16 v[192:195], v[84:87], v[96:99], v[192:195]
    v_mfma_f32_16x16x32_bf16 v[196:199], v[84:87], v[100:103], v[196:199]
    s_nop 7
    v_mul_f32 v224, v104, v104
    v_mov_b32 v216, v104
    v_fmac_f32 v224, v105, v105
    v_add_f32 v216, v216, v105
    v_fmac_f32 v224, v106, v106
    v_add_f32 v216, v216, v106
    v_fmac_f32 v224, v107, v107
    v_add_f32 v216, v216, v107
    v_fmac_f32 v224, v136, v136
    v_add_f32 v216, v216, v136
    v_fmac_f32 v224, v137, v137
    v_add_f32 v216, v216, v137
    v_fmac_f32 v224, v138, v138
    v_add_f32 v216, v216, v138
    v_fmac_f32 v224, v139, v139
    v_add_f32 v216, v216, v139
    v_fmac_f32 v224, v168, v168
    v_add_f32 v216, v216, v168
    v_fmac_f32 v224, v169, v169
    v_add_f32 v216, v216, v169
    v_fmac_f32 v224, v170, v170
    v_add_f32 v216, v216, v170
    v_fmac_f32 v224, v171, v171
    v_add_f32 v216, v216, v171
    v_mul_f32 v225, v108, v108
    v_mov_b32 v217, v108
    v_fmac_f32 v225, v109, v109
    v_add_f32 v217, v217, v109
    v_fmac_f32 v225, v110, v110
    v_add_f32 v217, v217, v110
    v_fmac_f32 v225, v111, v111
    v_add_f32 v217, v217, v111
    v_fmac_f32 v225, v140, v140
    v_add_f32 v217, v217, v140
    v_fmac_f32 v225, v141, v141
    v_add_f32 v217, v217, v141
    v_fmac_f32 v225, v142, v142
    v_add_f32 v217, v217, v142
    v_fmac_f32 v225, v143, v143
    v_add_f32 v217, v217, v143
    v_fmac_f32 v225, v172, v172
    v_add_f32 v217, v217, v172
    v_fmac_f32 v225, v173, v173
    v_add_f32 v217, v217, v173
    v_fmac_f32 v225, v174, v174
    v_add_f32 v217, v217, v174
    v_fmac_f32 v225, v175, v175
    v_add_f32 v217, v217, v175
    v_mul_f32 v226, v112, v112
    v_mov_b32 v218, v112
    v_fmac_f32 v226, v113, v113
    v_add_f32 v218, v218, v113
    v_fmac_f32 v226, v114, v114
    v_add_f32 v218, v218, v114
    v_fmac_f32 v226, v115, v115
    v_add_f32 v218, v218, v115
    v_fmac_f32 v226, v144, v144
    v_add_f32 v218, v218, v144
    v_fmac_f32 v226, v145, v145
    v_add_f32 v218, v218, v145
    v_fmac_f32 v226, v146, v146
    v_add_f32 v218, v218, v146
    v_fmac_f32 v226, v147, v147
    v_add_f32 v218, v218, v147
    v_fmac_f32 v226, v176, v176
    v_add_f32 v218, v218, v176
    v_fmac_f32 v226, v177, v177
    v_add_f32 v218, v218, v177
    v_fmac_f32 v226, v178, v178
    v_add_f32 v218, v218, v178
    v_fmac_f32 v226, v179, v179
    v_add_f32 v218, v218, v179
    v_mul_f32 v227, v116, v116
    v_mov_b32 v219, v116
    v_fmac_f32 v227, v117, v117
    v_add_f32 v219, v219, v117
    v_fmac_f32 v227, v118, v118
    v_add_f32 v219, v219, v118
    v_fmac_f32 v227, v119, v119
    v_add_f32 v219, v219, v119
    v_fmac_f32 v227, v148, v148
    v_add_f32 v219, v219, v148
    v_fmac_f32 v227, v149, v149
    v_add_f32 v219, v219, v149
    v_fmac_f32 v227, v150, v150
    v_add_f32 v219, v219, v150
    v_fmac_f32 v227, v151, v151
    v_add_f32 v219, v219, v151
    v_fmac_f32 v227, v180, v180
    v_add_f32 v219, v219, v180
    v_fmac_f32 v227, v181, v181
    v_add_f32 v219, v219, v181
    v_fmac_f32 v227, v182, v182
    v_add_f32 v219, v219, v182
    v_fmac_f32 v227, v183, v183
    v_add_f32 v219, v219, v183
    v_mul_f32 v228, v120, v120
    v_mov_b32 v220, v120
    v_fmac_f32 v228, v121, v121
    v_add_f32 v220, v220, v121
    v_fmac_f32 v228, v122, v122
    v_add_f32 v220, v220, v122
    v_fmac_f32 v228, v123, v123
    v_add_f32 v220, v220, v123
    v_fmac_f32 v228, v152, v152
    v_add_f32 v220, v220, v152
    v_fmac_f32 v228, v153, v153
    v_add_f32 v220, v220, v153
    v_fmac_f32 v228, v154, v154
    v_add_f32 v220, v220, v154
    v_fmac_f32 v228, v155, v155
    v_add_f32 v220, v220, v155
    v_fmac_f32 v228, v184, v184
    v_add_f32 v220, v220, v184
    v_fmac_f32 v228, v185, v185
    v_add_f32 v220, v220, v185
    v_fmac_f32 v228, v186, v186
    v_add_f32 v220, v220, v186
    v_fmac_f32 v228, v187, v187
    v_add_f32 v220, v220, v187
    v_mul_f32 v229, v124, v124
    v_mov_b32 v221, v124
    v_fmac_f32 v229, v125, v125
    v_add_f32 v221, v221, v125
    v_fmac_f32 v229, v126, v126
    v_add_f32 v221, v221, v126
    v_fmac_f32 v229, v127, v127
    v_add_f32 v221, v221, v127
    v_fmac_f32 v229, v156, v156
    v_add_f32 v221, v221, v156
    v_fmac_f32 v229, v157, v157
    v_add_f32 v221, v221, v157
    v_fmac_f32 v229, v158, v158
    v_add_f32 v221, v221, v158
    v_fmac_f32 v229, v159, v159
    v_add_f32 v221, v221, v159
    v_fmac_f32 v229, v188, v188
    v_add_f32 v221, v221, v188
    v_fmac_f32 v229, v189, v189
    v_add_f32 v221, v221, v189
    v_fmac_f32 v229, v190, v190
    v_add_f32 v221, v221, v190
    v_fmac_f32 v229, v191, v191
    v_add_f32 v221, v221, v191
    v_mul_f32 v230, v128, v128
    v_mov_b32 v222, v128
    v_fmac_f32 v230, v129, v129
    v_add_f32 v222, v222, v129
    v_fmac_f32 v230, v130, v130
    v_add_f32 v222, v222, v130
    v_fmac_f32 v230, v131, v131
    v_add_f32 v222, v222, v131
    v_fmac_f32 v230, v160, v160
    v_add_f32 v222, v222, v160
    v_fmac_f32 v230, v161, v161
    v_add_f32 v222, v222, v161
    v_fmac_f32 v230, v162, v162
    v_add_f32 v222, v222, v162
    v_fmac_f32 v230, v163, v163
    v_add_f32 v222, v222, v163
    v_fmac_f32 v230, v192, v192
    v_add_f32 v222, v222, v192
    v_fmac_f32 v230, v193, v193
    v_add_f32 v222, v222, v193
    v_fmac_f32 v230, v194, v194
    v_add_f32 v222, v222, v194
    v_fmac_f32 v230, v195, v195
    v_add_f32 v222, v222, v195
    v_mul_f32 v231, v132, v132
    v_mov_b32 v223, v132
    v_fmac_f32 v231, v133, v133
    v_add_f32 v223, v223, v133
    v_fmac_f32 v231, v134, v134
    v_add_f32 v223, v223, v134
    v_fmac_f32 v231, v135, v135
    v_add_f32 v223, v223, v135
    v_fmac_f32 v231, v164, v164
    v_add_f32 v223, v223, v164
    v_fmac_f32 v231, v165, v165
    v_add_f32 v223, v223, v165
    v_fmac_f32 v231, v166, v166
    v_add_f32 v223, v223, v166
    v_fmac_f32 v231, v167, v167
    v_add_f32 v223, v223, v167
    v_fmac_f32 v231, v196, v196
    v_add_f32 v223, v223, v196
    v_fmac_f32 v231, v197, v197
    v_add_f32 v223, v223, v197
    v_fmac_f32 v231, v198, v198
    v_add_f32 v223, v223, v198
    v_fmac_f32 v231, v199, v199
    v_add_f32 v223, v223, v199
    s_branch L_k45_red
L_k45_zero:
    s_waitcnt vmcnt(0) lgkmcnt(0)
    v_mov_b32 v216, 0
    v_mov_b32 v224, 0
    v_mov_b32 v217, 0
    v_mov_b32 v225, 0
    v_mov_b32 v218, 0
    v_mov_b32 v226, 0
    v_mov_b32 v219, 0
    v_mov_b32 v227, 0
    v_mov_b32 v220, 0
    v_mov_b32 v228, 0
    v_mov_b32 v221, 0
    v_mov_b32 v229, 0
    v_mov_b32 v222, 0
    v_mov_b32 v230, 0
    v_mov_b32 v223, 0
    v_mov_b32 v231, 0
L_k45_red:
    s_lshl_b32 s25, s10, 12
    v_lshlrev_b32 v204, 10, v202
    v_lshl_add_u32 v204, v201, 5, v204
    v_add_u32 v204, s25, v204
    ds_write_b128 v204, v[216:219] offset:8192
    ds_write_b128 v204, v[220:223] offset:8208
    ds_write_b128 v204, v[224:227] offset:8704
    ds_write_b128 v204, v[228:231] offset:8720
L_k45_red2:
    s_waitcnt lgkmcnt(0)
    s_barrier
    s_mul_i32 s24, s11, 112
    s_mul_i32 s25, s13, 28
    s_add_u32 s24, s24, s25
    s_lshl_b32 s26, s24, 10
    s_add_u32 s26, s26, 146800640
    s_cmp_ge_u32 s10, 6
    s_cbranch_scc1 L_k45_sumdone
    s_cmp_lt_u32 s10, 4
    s_cbranch_scc1 L_k45_red4
    s_lshl_b32 s25, s10, 13
    v_lshlrev_b32 v205, 4, v200
    v_add_u32 v205, s25, v205
    ds_write_b32 v205, v107 offset:33792
    ds_write_b32 v205, v139 offset:33796
    ds_write_b32 v205, v171 offset:33800
    ds_write_b32 v205, v111 offset:34816
    ds_write_b32 v205, v143 offset:34820
    ds_write_b32 v205, v175 offset:34824
    ds_write_b32 v205, v115 offset:35840
    ds_write_b32 v205, v147 offset:35844
    ds_write_b32 v205, v179 offset:35848
    ds_write_b32 v205, v119 offset:36864
    ds_write_b32 v205, v151 offset:36868
    ds_write_b32 v205, v183 offset:36872
    ds_write_b32 v205, v123 offset:37888
    ds_write_b32 v205, v155 offset:37892
    ds_write_b32 v205, v187 offset:37896
    ds_write_b32 v205, v127 offset:38912
    ds_write_b32 v205, v159 offset:38916
    ds_write_b32 v205, v191 offset:38920
    ds_write_b32 v205, v131 offset:39936
    ds_write_b32 v205, v163 offset:39940
    ds_write_b32 v205, v195 offset:39944
    ds_write_b32 v205, v135 offset:40960
    ds_write_b32 v205, v167 offset:40964
    ds_write_b32 v205, v199 offset:40968
    s_branch L_k45_sumdone
L_k45_red4:
    ds_read_b32 v16, v214 offset:8192
    ds_read_b32 v17, v214 offset:9216
    ds_read_b32 v18, v214 offset:10240
    ds_read_b32 v19, v214 offset:11264
    ds_read_b32 v20, v214 offset:12288
    ds_read_b32 v21, v214 offset:13312
    ds_read_b32 v22, v214 offset:14336
    ds_read_b32 v23, v214 offset:15360
    ds_read_b32 v24, v214 offset:16384
    ds_read_b32 v25, v214 offset:17408
    ds_read_b32 v26, v214 offset:18432
    ds_read_b32 v27, v214 offset:19456
    ds_read_b32 v28, v214 offset:20480
    ds_read_b32 v29, v214 offset:21504
    ds_read_b32 v30, v214 offset:22528
    ds_read_b32 v31, v214 offset:23552
    ds_read_b32 v32, v214 offset:24576
    ds_read_b32 v33, v214 offset:25600
    ds_read_b32 v34, v214 offset:26624
    ds_read_b32 v35, v214 offset:27648
    ds_read_b32 v36, v214 offset:28672
    ds_read_b32 v37, v214 offset:29696
    ds_read_b32 v38, v214 offset:30720
    ds_read_b32 v39, v214 offset:31744
    s_waitcnt lgkmcnt(0)
    v_add_f32 v16, v16, v17
    v_add_f32 v18, v18, v19
    v_add_f32 v20, v20, v21
    v_add_f32 v22, v22, v23
    v_add_f32 v24, v24, v25
    v_add_f32 v26, v26, v27
    v_add_f32 v28, v28, v29
    v_add_f32 v30, v30, v31
    v_add_f32 v32, v32, v33
    v_add_f32 v34, v34, v35
    v_add_f32 v36, v36, v37
    v_add_f32 v38, v38, v39
    v_add_f32 v16, v16, v18
    v_add_f32 v20, v20, v22
    v_add_f32 v24, v24, v26
    v_add_f32 v28, v28, v30
    v_add_f32 v32, v32, v34
    v_add_f32 v36, v36, v38
    v_add_f32 v16, v16, v20
    v_add_f32 v24, v24, v28
    v_add_f32 v32, v32, v36
    v_add_f32 v16, v16, v24
    v_add_f32 v16, v16, v32
    s_lshl_b32 s24, s12, 10
    s_add_u32 s24, s24, s26
    buffer_store_dword v16, v214, s[16:19], s24 offen sc1
    s_lshl_b32 s25, s10, 13
    v_lshlrev_b32 v205, 4, v200
    v_add_u32 v205, s25, v205
    ds_write_b32 v205, v107 offset:33792
    ds_write_b32 v205, v139 offset:33796
    ds_write_b32 v205, v171 offset:33800
    ds_write_b32 v205, v111 offset:34816
    ds_write_b32 v205, v143 offset:34820
    ds_write_b32 v205, v175 offset:34824
    ds_write_b32 v205, v115 offset:35840
    ds_write_b32 v205, v147 offset:35844
    ds_write_b32 v205, v179 offset:35848
    ds_write_b32 v205, v119 offset:36864
    ds_write_b32 v205, v151 offset:36868
    ds_write_b32 v205, v183 offset:36872
    ds_write_b32 v205, v123 offset:37888
    ds_write_b32 v205, v155 offset:37892
    ds_write_b32 v205, v187 offset:37896
    ds_write_b32 v205, v127 offset:38912
    ds_write_b32 v205, v159 offset:38916
    ds_write_b32 v205, v191 offset:38920
    ds_write_b32 v205, v131 offset:39936
    ds_write_b32 v205, v163 offset:39940
    ds_write_b32 v205, v195 offset:39944
    ds_write_b32 v205, v135 offset:40960
    ds_write_b32 v205, v167 offset:40964
    ds_write_b32 v205, v199 offset:40968
    s_mov_b32 s33, 16384
L_k45_poll:
    s_mov_b32 s27, s26
    buffer_load_dword v0, v214, s[16:19], s27 offen offset:0 sc1
    buffer_load_dword v1, v214, s[16:19], s27 offen offset:1024 sc1
    buffer_load_dword v2, v214, s[16:19], s27 offen offset:2048 sc1
    buffer_load_dword v3, v214, s[16:19], s27 offen offset:3072 sc1
    s_add_u32 s27, s27, 4096
    buffer_load_dword v4, v214, s[16:19], s27 offen offset:0 sc1
    buffer_load_dword v5, v214, s[16:19], s27 offen offset:1024 sc1
    buffer_load_dword v6, v214, s[16:19], s27 offen offset:2048 sc1
    buffer_load_dword v7, v214, s[16:19], s27 offen offset:3072 sc1
    s_add_u32 s27, s27, 4096
    buffer_load_dword v8, v214, s[16:19], s27 offen offset:0 sc1
    buffer_load_dword v9, v214, s[16:19], s27 offen offset:1024 sc1
    buffer_load_dword v10, v214, s[16:19], s27 offen offset:2048 sc1
    buffer_load_dword v11, v214, s[16:19], s27 offen offset:3072 sc1
    s_add_u32 s27, s27, 4096
    buffer_load_dword v12, v214, s[16:19], s27 offen offset:0 sc1
    buffer_load_dword v13, v214, s[16:19], s27 offen offset:1024 sc1
    buffer_load_dword v14, v214, s[16:19], s27 offen offset:2048 sc1
    buffer_load_dword v15, v214, s[16:19], s27 offen offset:3072 sc1
    s_add_u32 s27, s27, 4096
    buffer_load_dword v16, v214, s[16:19], s27 offen offset:0 sc1
    buffer_load_dword v17, v214, s[16:19], s27 offen offset:1024 sc1
    buffer_load_dword v18, v214, s[16:19], s27 offen offset:2048 sc1
    buffer_load_dword v19, v214, s[16:19], s27 offen offset:3072 sc1
    s_add_u32 s27, s27, 4096
    buffer_load_dword v20, v214, s[16:19], s27 offen offset:0 sc1
    buffer_load_dword v21, v214, s[16:19], s27 offen offset:1024 sc1
    buffer_load_dword v22, v214, s[16:19], s27 offen offset:2048 sc1
    buffer_load_dword v23, v214, s[16:19], s27 offen offset:3072 sc1
    s_add_u32 s27, s27, 4096
    buffer_load_dword v24, v214, s[16:19], s27 offen offset:0 sc1
    buffer_load_dword v25, v214, s[16:19], s27 offen offset:1024 sc1
    buffer_load_dword v26, v214, s[16:19], s27 offen offset:2048 sc1
    buffer_load_dword v27, v214, s[16:19], s27 offen offset:3072 sc1
    s_waitcnt vmcnt(0)
    v_max3_u32 v32, v0, v1, v2
    v_max3_u32 v32, v32, v3, v4
    v_max3_u32 v32, v32, v5, v6
    v_max3_u32 v32, v32, v7, v8
    v_max3_u32 v32, v32, v9, v10
    v_max3_u32 v32, v32, v11, v12
    v_max3_u32 v32, v32, v13, v14
    v_max3_u32 v32, v32, v15, v16
    v_max3_u32 v32, v32, v17, v18
    v_max3_u32 v32, v32, v19, v20
    v_max3_u32 v32, v32, v21, v22
    v_max3_u32 v32, v32, v23, v24
    v_max3_u32 v32, v32, v25, v26
    v_max_u32 v32, v32, v27
    v_cmp_eq_u32 vcc, -1, v32
    s_nop 3
    s_cmp_eq_u64 vcc, 0
    s_cbranch_scc1 L_k45_got
    s_sub_u32 s33, s33, 1
    s_cmp_eq_u32 s33, 0
    s_cbranch_scc1 L_k45_got
    s_sleep 2
    s_branch L_k45_poll
L_k45_got:
    v_add_f32 v0, v0, v1
    v_add_f32 v2, v2, v3
    v_add_f32 v4, v4, v5
    v_add_f32 v6, v6, v7
    v_add_f32 v8, v8, v9
    v_add_f32 v10, v10, v11
    v_add_f32 v12, v12, v13
    v_add_f32 v14, v14, v15
    v_add_f32 v16, v16, v17
    v_add_f32 v18, v18, v19
    v_add_f32 v20, v20, v21
    v_add_f32 v22, v22, v23
    v_add_f32 v24, v24, v25
    v_add_f32 v26, v26, v27
    v_add_f32 v0, v0, v2
    v_add_f32 v4, v4, v6
    v_add_f32 v8, v8, v10
    v_add_f32 v12, v12, v14
    v_add_f32 v16, v16, v18
    v_add_f32 v20, v20, v22
    v_add_f32 v24, v24, v26
    v_add_f32 v0, v0, v4
    v_add_f32 v8, v8, v12
    v_add_f32 v16, v16, v20
    v_add_f32 v0, v0, v8
    v_add_f32 v16, v16, v24
    v_add_f32 v0, v0, v16
    ds_write_b32 v214, v0 offset:32768
L_k45_sumdone:
    s_waitcnt lgkmcnt(0)
    s_barrier
    s_cmp_lt_u32 s10, 6
    s_cbranch_scc1 L_k45_nohread
    s_waitcnt vmcnt(0)
    s_sub_u32 s25, s10, 6
    s_mul_i32 s25, s25, 3
    s_lshl_b32 s25, s25, 13
    v_lshlrev_b32 v205, 4, v200
    v_add_u32 v205, s25, v205
    ds_read_b96 v[104:106], v205 offset:33792
    ds_read_b96 v[108:110], v205 offset:34816
    ds_read_b96 v[112:114], v205 offset:35840
    ds_read_b96 v[116:118], v205 offset:36864
    ds_read_b96 v[120:122], v205 offset:37888
    ds_read_b96 v[124:126], v205 offset:38912
    ds_read_b96 v[128:130], v205 offset:39936
    ds_read_b96 v[132:134], v205 offset:40960
    s_waitcnt lgkmcnt(0)
    ds_read_b96 v[136:138], v205 offset:41984
    ds_read_b96 v[140:142], v205 offset:43008
    ds_read_b96 v[144:146], v205 offset:44032
    ds_read_b96 v[148:150], v205 offset:45056
    ds_read_b96 v[152:154], v205 offset:46080
    ds_read_b96 v[156:158], v205 offset:47104
    ds_read_b96 v[160:162], v205 offset:48128
    ds_read_b96 v[164:166], v205 offset:49152
    s_waitcnt lgkmcnt(0)
    ds_read_b96 v[168:170], v205 offset:50176
    ds_read_b96 v[172:174], v205 offset:51200
    ds_read_b96 v[176:178], v205 offset:52224
    ds_read_b96 v[180:182], v205 offset:53248
    ds_read_b96 v[184:186], v205 offset:54272
    ds_read_b96 v[188:190], v205 offset:55296
    ds_read_b96 v[192:194], v205 offset:56320
    ds_read_b96 v[196:198], v205 offset:57344
L_k45_nohread:
    v_lshlrev_b32 v210, 5, v201
    ds_read_b128 v[44:47], v210 offset:32768
    ds_read_b128 v[48:51], v210 offset:32784
    ds_read_b128 v[52:55], v210 offset:33280
    ds_read_b128 v[56:59], v210 offset:33296
    s_mov_b32 s24, 0x39035177
    s_mov_b32 s25, 0x3727c5ac
    s_waitcnt vmcnt(0) lgkmcnt(0)
    v_mul_f32 v44, s24, v44
    v_mul_f32 v52, s24, v52
    v_fma_f32 v52, -v44, v44, v52
    v_max_f32 v52, 0, v52
    v_add_f32 v52, s25, v52
    v_rsq_f32 v52, v52
    v_lshlrev_b32 v216, 16, v232
    v_lshlrev_b32 v224, 16, v236
    v_mul_f32 v216, v216, v52
    v_fma_f32 v224, -v44, v216, v224
    v_mul_f32 v45, s24, v45
    v_mul_f32 v53, s24, v53
    v_fma_f32 v53, -v45, v45, v53
    v_max_f32 v53, 0, v53
    v_add_f32 v53, s25, v53
    v_rsq_f32 v53, v53
    v_and_b32 v217, 0xffff0000, v232
    v_and_b32 v225, 0xffff0000, v236
    v_mul_f32 v217, v217, v53
    v_fma_f32 v225, -v45, v217, v225
    v_mul_f32 v46, s24, v46
    v_mul_f32 v54, s24, v54
    v_fma_f32 v54, -v46, v46, v54
    v_max_f32 v54, 0, v54
    v_add_f32 v54, s25, v54
    v_rsq_f32 v54, v54
    v_lshlrev_b32 v218, 16, v233
    v_lshlrev_b32 v226, 16, v237
    v_mul_f32 v218, v218, v54
    v_fma_f32 v226, -v46, v218, v226
    v_mul_f32 v47, s24, v47
    v_mul_f32 v55, s24, v55
    v_fma_f32 v55, -v47, v47, v55
    v_max_f32 v55, 0, v55
    v_add_f32 v55, s25, v55
    v_rsq_f32 v55, v55
    v_and_b32 v219, 0xffff0000, v233
    v_and_b32 v227, 0xffff0000, v237
    v_mul_f32 v219, v219, v55
    v_fma_f32 v227, -v47, v219, v227
    v_mul_f32 v48, s24, v48
    v_mul_f32 v56, s24, v56
    v_fma_f32 v56, -v48, v48, v56
    v_max_f32 v56, 0, v56
    v_add_f32 v56, s25, v56
    v_rsq_f32 v56, v56
    v_lshlrev_b32 v220, 16, v234
    v_lshlrev_b32 v228, 16, v238
    v_mul_f32 v220, v220, v56
    v_fma_f32 v228, -v48, v220, v228
    v_mul_f32 v49, s24, v49
    v_mul_f32 v57, s24, v57
    v_fma_f32 v57, -v49, v49, v57
    v_max_f32 v57, 0, v57
    v_add_f32 v57, s25, v57
    v_rsq_f32 v57, v57
    v_and_b32 v221, 0xffff0000, v234
    v_and_b32 v229, 0xffff0000, v238
    v_mul_f32 v221, v221, v57
    v_fma_f32 v229, -v49, v221, v229
    v_mul_f32 v50, s24, v50
    v_mul_f32 v58, s24, v58
    v_fma_f32 v58, -v50, v50, v58
    v_max_f32 v58, 0, v58
    v_add_f32 v58, s25, v58
    v_rsq_f32 v58, v58
    v_lshlrev_b32 v222, 16, v235
    v_lshlrev_b32 v230, 16, v239
    v_mul_f32 v222, v222, v58
    v_fma_f32 v230, -v50, v222, v230
    v_mul_f32 v51, s24, v51
    v_mul_f32 v59, s24, v59
    v_fma_f32 v59, -v51, v51, v59
    v_max_f32 v59, 0, v59
    v_add_f32 v59, s25, v59
    v_rsq_f32 v59, v59
    v_and_b32 v223, 0xffff0000, v235
    v_and_b32 v231, 0xffff0000, v239
    v_mul_f32 v223, v223, v59
    v_fma_f32 v231, -v51, v223, v231
    s_mul_i32 s24, s11, 8176640
    s_add_u32 s28, s28, s24
    s_addc_u32 s29, s29, 0
    s_mov_b32 s32, s28
    s_and_b32 s33, s29, 0xffff
    s_mov_b32 s34, 8176640
    s_mov_b32 s35, 0x00020000
    s_lshl_b32 s25, s13, 8
    v_lshlrev_b32 v210, 12, v202
    v_lshl_add_u32 v210, v201, 4, v210
    v_add_u32 v210, s25, v210
    s_mov_b32 s26, 0xbdd2d3e8
    v_mov_b32 v211, 0xc0135761
    s_cmp_ge_u32 s10, 6
    s_cbranch_scc1 L_k45_hoff
    s_cmp_ge_u32 s14, 167
    s_cbranch_scc1 L_k45_fin
    s_mul_i32 s24, s14, 49152
    s_add_u32 s52, s24, 0
    s_add_u32 s53, s24, 1024
    s_add_u32 s54, s24, 2048
    s_add_u32 s55, s24, 16384
    s_add_u32 s56, s24, 17408
    s_add_u32 s57, s24, 18432
    s_add_u32 s58, s24, 32768
    s_add_u32 s59, s24, 33792
    s_add_u32 s60, s24, 34816
    s_branch L_k45_gelu
L_k45_hoff:
    s_sub_u32 s25, s10, 6
    s_mul_i32 s25, s25, 3
    s_mul_i32 s24, s12, 6
    s_add_u32 s24, s24, s25
    s_mul_i32 s24, s24, 49152
    s_add_u32 s52, s24, 3072
    s_add_u32 s53, s24, 19456
    s_add_u32 s54, s24, 35840
    s_add_u32 s55, s24, 52224
    s_add_u32 s56, s24, 68608
    s_add_u32 s57, s24, 84992
    s_add_u32 s58, s24, 101376
    s_add_u32 s59, s24, 117760
    s_add_u32 s60, s24, 134144
L_k45_gelu:
    v_fma_f32 v104, v104, v216, v224
    v_fma_f32 v108, v108, v217, v225
    v_fma_f32 v112, v112, v218, v226
    v_fma_f32 v116, v116, v219, v227
    v_fma_f32 v120, v120, v220, v228
    v_fma_f32 v124, v124, v221, v229
    v_fma_f32 v128, v128, v222, v230
    v_fma_f32 v132, v132, v223, v231
    v_mul_f32 v0, v104, v104
    v_mul_f32 v1, v108, v108
    v_mul_f32 v2, v112, v112
    v_mul_f32 v3, v116, v116
    v_mul_f32 v4, v120, v120
    v_mul_f32 v5, v124, v124
    v_mul_f32 v6, v128, v128
    v_mul_f32 v7, v132, v132
    v_fma_f32 v0, v0, s26, v211
    v_fma_f32 v1, v1, s26, v211
    v_fma_f32 v2, v2, s26, v211
    v_fma_f32 v3, v3, s26, v211
    v_fma_f32 v4, v4, s26, v211
    v_fma_f32 v5, v5, s26, v211
    v_fma_f32 v6, v6, s26, v211
    v_fma_f32 v7, v7, s26, v211
    v_mul_f32 v0, v0, v104
    v_mul_f32 v1, v1, v108
    v_mul_f32 v2, v2, v112
    v_mul_f32 v3, v3, v116
    v_mul_f32 v4, v4, v120
    v_mul_f32 v5, v5, v124
    v_mul_f32 v6, v6, v128
    v_mul_f32 v7, v7, v132
    v_exp_f32 v0, v0
    v_exp_f32 v1, v1
    v_exp_f32 v2, v2
    v_exp_f32 v3, v3
    v_exp_f32 v4, v4
    v_exp_f32 v5, v5
    v_exp_f32 v6, v6
    v_exp_f32 v7, v7
    v_add_f32 v0, 1.0, v0
    v_add_f32 v1, 1.0, v1
    v_add_f32 v2, 1.0, v2
    v_add_f32 v3, 1.0, v3
    v_add_f32 v4, 1.0, v4
    v_add_f32 v5, 1.0, v5
    v_add_f32 v6, 1.0, v6
    v_add_f32 v7, 1.0, v7
    v_rcp_f32 v0, v0
    v_rcp_f32 v1, v1
    v_rcp_f32 v2, v2
    v_rcp_f32 v3, v3
    v_rcp_f32 v4, v4
    v_rcp_f32 v5, v5
    v_rcp_f32 v6, v6
    v_rcp_f32 v7, v7
    v_mul_f32 v0, v0, v104
    v_mul_f32 v1, v1, v108
    v_mul_f32 v2, v2, v112
    v_mul_f32 v3, v3, v116
    v_mul_f32 v4, v4, v120
    v_mul_f32 v5, v5, v124
    v_mul_f32 v6, v6, v128
    v_mul_f32 v7, v7, v132
    v_cvt_pk_bf16_f32 v16, v0, v1
    v_cvt_pk_bf16_f32 v17, v2, v3
    v_cvt_pk_bf16_f32 v18, v4, v5
    v_cvt_pk_bf16_f32 v19, v6, v7
    buffer_store_dwordx4 v[16:19], v210, s[32:35], s52 offen sc1
    v_fma_f32 v105, v105, v216, v224
    v_fma_f32 v109, v109, v217, v225
    v_fma_f32 v113, v113, v218, v226
    v_fma_f32 v117, v117, v219, v227
    v_fma_f32 v121, v121, v220, v228
    v_fma_f32 v125, v125, v221, v229
    v_fma_f32 v129, v129, v222, v230
    v_fma_f32 v133, v133, v223, v231
    v_mul_f32 v0, v105, v105
    v_mul_f32 v1, v109, v109
    v_mul_f32 v2, v113, v113
    v_mul_f32 v3, v117, v117
    v_mul_f32 v4, v121, v121
    v_mul_f32 v5, v125, v125
    v_mul_f32 v6, v129, v129
    v_mul_f32 v7, v133, v133
    v_fma_f32 v0, v0, s26, v211
    v_fma_f32 v1, v1, s26, v211
    v_fma_f32 v2, v2, s26, v211
    v_fma_f32 v3, v3, s26, v211
    v_fma_f32 v4, v4, s26, v211
    v_fma_f32 v5, v5, s26, v211
    v_fma_f32 v6, v6, s26, v211
    v_fma_f32 v7, v7, s26, v211
    v_mul_f32 v0, v0, v105
    v_mul_f32 v1, v1, v109
    v_mul_f32 v2, v2, v113
    v_mul_f32 v3, v3, v117
    v_mul_f32 v4, v4, v121
    v_mul_f32 v5, v5, v125
    v_mul_f32 v6, v6, v129
    v_mul_f32 v7, v7, v133
    v_exp_f32 v0, v0
    v_exp_f32 v1, v1
    v_exp_f32 v2, v2
    v_exp_f32 v3, v3
    v_exp_f32 v4, v4
    v_exp_f32 v5, v5
    v_exp_f32 v6, v6
    v_exp_f32 v7, v7
    v_add_f32 v0, 1.0, v0
    v_add_f32 v1, 1.0, v1
    v_add_f32 v2, 1.0, v2
    v_add_f32 v3, 1.0, v3
    v_add_f32 v4, 1.0, v4
    v_add_f32 v5, 1.0, v5
    v_add_f32 v6, 1.0, v6
    v_add_f32 v7, 1.0, v7
    v_rcp_f32 v0, v0
    v_rcp_f32 v1, v1
    v_rcp_f32 v2, v2
    v_rcp_f32 v3, v3
    v_rcp_f32 v4, v4
    v_rcp_f32 v5, v5
    v_rcp_f32 v6, v6
    v_rcp_f32 v7, v7
    v_mul_f32 v0, v0, v105
    v_mul_f32 v1, v1, v109
    v_mul_f32 v2, v2, v113
    v_mul_f32 v3, v3, v117
    v_mul_f32 v4, v4, v121
    v_mul_f32 v5, v5, v125
    v_mul_f32 v6, v6, v129
    v_mul_f32 v7, v7, v133
    v_cvt_pk_bf16_f32 v20, v0, v1
    v_cvt_pk_bf16_f32 v21, v2, v3
    v_cvt_pk_bf16_f32 v22, v4, v5
    v_cvt_pk_bf16_f32 v23, v6, v7
    buffer_store_dwordx4 v[20:23], v210, s[32:35], s53 offen sc1
    v_fma_f32 v106, v106, v216, v224
    v_fma_f32 v110, v110, v217, v225
    v_fma_f32 v114, v114, v218, v226
    v_fma_f32 v118, v118, v219, v227
    v_fma_f32 v122, v122, v220, v228
    v_fma_f32 v126, v126, v221, v229
    v_fma_f32 v130, v130, v222, v230
    v_fma_f32 v134, v134, v223, v231
    v_mul_f32 v0, v106, v106
    v_mul_f32 v1, v110, v110
    v_mul_f32 v2, v114, v114
    v_mul_f32 v3, v118, v118
    v_mul_f32 v4, v122, v122
    v_mul_f32 v5, v126, v126
    v_mul_f32 v6, v130, v130
    v_mul_f32 v7, v134, v134
    v_fma_f32 v0, v0, s26, v211
    v_fma_f32 v1, v1, s26, v211
    v_fma_f32 v2, v2, s26, v211
    v_fma_f32 v3, v3, s26, v211
    v_fma_f32 v4, v4, s26, v211
    v_fma_f32 v5, v5, s26, v211
    v_fma_f32 v6, v6, s26, v211
    v_fma_f32 v7, v7, s26, v211
    v_mul_f32 v0, v0, v106
    v_mul_f32 v1, v1, v110
    v_mul_f32 v2, v2, v114
    v_mul_f32 v3, v3, v118
    v_mul_f32 v4, v4, v122
    v_mul_f32 v5, v5, v126
    v_mul_f32 v6, v6, v130
    v_mul_f32 v7, v7, v134
    v_exp_f32 v0, v0
    v_exp_f32 v1, v1
    v_exp_f32 v2, v2
    v_exp_f32 v3, v3
    v_exp_f32 v4, v4
    v_exp_f32 v5, v5
    v_exp_f32 v6, v6
    v_exp_f32 v7, v7
    v_add_f32 v0, 1.0, v0
    v_add_f32 v1, 1.0, v1
    v_add_f32 v2, 1.0, v2
    v_add_f32 v3, 1.0, v3
    v_add_f32 v4, 1.0, v4
    v_add_f32 v5, 1.0, v5
    v_add_f32 v6, 1.0, v6
    v_add_f32 v7, 1.0, v7
    v_rcp_f32 v0, v0
    v_rcp_f32 v1, v1
    v_rcp_f32 v2, v2
    v_rcp_f32 v3, v3
    v_rcp_f32 v4, v4
    v_rcp_f32 v5, v5
    v_rcp_f32 v6, v6
    v_rcp_f32 v7, v7
    v_mul_f32 v0, v0, v106
    v_mul_f32 v1, v1, v110
    v_mul_f32 v2, v2, v114
    v_mul_f32 v3, v3, v118
    v_mul_f32 v4, v4, v122
    v_mul_f32 v5, v5, v126
    v_mul_f32 v6, v6, v130
    v_mul_f32 v7, v7, v134
    v_cvt_pk_bf16_f32 v24, v0, v1
    v_cvt_pk_bf16_f32 v25, v2, v3
    v_cvt_pk_bf16_f32 v26, v4, v5
    v_cvt_pk_bf16_f32 v27, v6, v7
    buffer_store_dwordx4 v[24:27], v210, s[32:35], s54 offen sc1
    v_fma_f32 v136, v136, v216, v224
    v_fma_f32 v140, v140, v217, v225
    v_fma_f32 v144, v144, v218, v226
    v_fma_f32 v148, v148, v219, v227
    v_fma_f32 v152, v152, v220, v228
    v_fma_f32 v156, v156, v221, v229
    v_fma_f32 v160, v160, v222, v230
    v_fma_f32 v164, v164, v223, v231
    v_mul_f32 v0, v136, v136
    v_mul_f32 v1, v140, v140
    v_mul_f32 v2, v144, v144
    v_mul_f32 v3, v148, v148
    v_mul_f32 v4, v152, v152
    v_mul_f32 v5, v156, v156
    v_mul_f32 v6, v160, v160
    v_mul_f32 v7, v164, v164
    v_fma_f32 v0, v0, s26, v211
    v_fma_f32 v1, v1, s26, v211
    v_fma_f32 v2, v2, s26, v211
    v_fma_f32 v3, v3, s26, v211
    v_fma_f32 v4, v4, s26, v211
    v_fma_f32 v5, v5, s26, v211
    v_fma_f32 v6, v6, s26, v211
    v_fma_f32 v7, v7, s26, v211
    v_mul_f32 v0, v0, v136
    v_mul_f32 v1, v1, v140
    v_mul_f32 v2, v2, v144
    v_mul_f32 v3, v3, v148
    v_mul_f32 v4, v4, v152
    v_mul_f32 v5, v5, v156
    v_mul_f32 v6, v6, v160
    v_mul_f32 v7, v7, v164
    v_exp_f32 v0, v0
    v_exp_f32 v1, v1
    v_exp_f32 v2, v2
    v_exp_f32 v3, v3
    v_exp_f32 v4, v4
    v_exp_f32 v5, v5
    v_exp_f32 v6, v6
    v_exp_f32 v7, v7
    v_add_f32 v0, 1.0, v0
    v_add_f32 v1, 1.0, v1
    v_add_f32 v2, 1.0, v2
    v_add_f32 v3, 1.0, v3
    v_add_f32 v4, 1.0, v4
    v_add_f32 v5, 1.0, v5
    v_add_f32 v6, 1.0, v6
    v_add_f32 v7, 1.0, v7
    v_rcp_f32 v0, v0
    v_rcp_f32 v1, v1
    v_rcp_f32 v2, v2
    v_rcp_f32 v3, v3
    v_rcp_f32 v4, v4
    v_rcp_f32 v5, v5
    v_rcp_f32 v6, v6
    v_rcp_f32 v7, v7
    v_mul_f32 v0, v0, v136
    v_mul_f32 v1, v1, v140
    v_mul_f32 v2, v2, v144
    v_mul_f32 v3, v3, v148
    v_mul_f32 v4, v4, v152
    v_mul_f32 v5, v5, v156
    v_mul_f32 v6, v6, v160
    v_mul_f32 v7, v7, v164
    v_cvt_pk_bf16_f32 v28, v0, v1
    v_cvt_pk_bf16_f32 v29, v2, v3
    v_cvt_pk_bf16_f32 v30, v4, v5
    v_cvt_pk_bf16_f32 v31, v6, v7
    buffer_store_dwordx4 v[28:31], v210, s[32:35], s55 offen sc1
    v_fma_f32 v137, v137, v216, v224
    v_fma_f32 v141, v141, v217, v225
    v_fma_f32 v145, v145, v218, v226
    v_fma_f32 v149, v149, v219, v227
    v_fma_f32 v153, v153, v220, v228
    v_fma_f32 v157, v157, v221, v229
    v_fma_f32 v161, v161, v222, v230
    v_fma_f32 v165, v165, v223, v231
    v_mul_f32 v0, v137, v137
    v_mul_f32 v1, v141, v141
    v_mul_f32 v2, v145, v145
    v_mul_f32 v3, v149, v149
    v_mul_f32 v4, v153, v153
    v_mul_f32 v5, v157, v157
    v_mul_f32 v6, v161, v161
    v_mul_f32 v7, v165, v165
    v_fma_f32 v0, v0, s26, v211
    v_fma_f32 v1, v1, s26, v211
    v_fma_f32 v2, v2, s26, v211
    v_fma_f32 v3, v3, s26, v211
    v_fma_f32 v4, v4, s26, v211
    v_fma_f32 v5, v5, s26, v211
    v_fma_f32 v6, v6, s26, v211
    v_fma_f32 v7, v7, s26, v211
    v_mul_f32 v0, v0, v137
    v_mul_f32 v1, v1, v141
    v_mul_f32 v2, v2, v145
    v_mul_f32 v3, v3, v149
    v_mul_f32 v4, v4, v153
    v_mul_f32 v5, v5, v157
    v_mul_f32 v6, v6, v161
    v_mul_f32 v7, v7, v165
    v_exp_f32 v0, v0
    v_exp_f32 v1, v1
    v_exp_f32 v2, v2
    v_exp_f32 v3, v3
    v_exp_f32 v4, v4
    v_exp_f32 v5, v5
    v_exp_f32 v6, v6
    v_exp_f32 v7, v7
    v_add_f32 v0, 1.0, v0
    v_add_f32 v1, 1.0, v1
    v_add_f32 v2, 1.0, v2
    v_add_f32 v3, 1.0, v3
    v_add_f32 v4, 1.0, v4
    v_add_f32 v5, 1.0, v5
    v_add_f32 v6, 1.0, v6
    v_add_f32 v7, 1.0, v7
    v_rcp_f32 v0, v0
    v_rcp_f32 v1, v1
    v_rcp_f32 v2, v2
    v_rcp_f32 v3, v3
    v_rcp_f32 v4, v4
    v_rcp_f32 v5, v5
    v_rcp_f32 v6, v6
    v_rcp_f32 v7, v7
    v_mul_f32 v0, v0, v137
    v_mul_f32 v1, v1, v141
    v_mul_f32 v2, v2, v145
    v_mul_f32 v3, v3, v149
    v_mul_f32 v4, v4, v153
    v_mul_f32 v5, v5, v157
    v_mul_f32 v6, v6, v161
    v_mul_f32 v7, v7, v165
    v_cvt_pk_bf16_f32 v32, v0, v1
    v_cvt_pk_bf16_f32 v33, v2, v3
    v_cvt_pk_bf16_f32 v34, v4, v5
    v_cvt_pk_bf16_f32 v35, v6, v7
    buffer_store_dwordx4 v[32:35], v210, s[32:35], s56 offen sc1
    v_fma_f32 v138, v138, v216, v224
    v_fma_f32 v142, v142, v217, v225
    v_fma_f32 v146, v146, v218, v226
    v_fma_f32 v150, v150, v219, v227
    v_fma_f32 v154, v154, v220, v228
    v_fma_f32 v158, v158, v221, v229
    v_fma_f32 v162, v162, v222, v230
    v_fma_f32 v166, v166, v223, v231
    v_mul_f32 v0, v138, v138
    v_mul_f32 v1, v142, v142
    v_mul_f32 v2, v146, v146
    v_mul_f32 v3, v150, v150
    v_mul_f32 v4, v154, v154
    v_mul_f32 v5, v158, v158
    v_mul_f32 v6, v162, v162
    v_mul_f32 v7, v166, v166
    v_fma_f32 v0, v0, s26, v211
    v_fma_f32 v1, v1, s26, v211
    v_fma_f32 v2, v2, s26, v211
    v_fma_f32 v3, v3, s26, v211
    v_fma_f32 v4, v4, s26, v211
    v_fma_f32 v5, v5, s26, v211
    v_fma_f32 v6, v6, s26, v211
    v_fma_f32 v7, v7, s26, v211
    v_mul_f32 v0, v0, v138
    v_mul_f32 v1, v1, v142
    v_mul_f32 v2, v2, v146
    v_mul_f32 v3, v3, v150
    v_mul_f32 v4, v4, v154
    v_mul_f32 v5, v5, v158
    v_mul_f32 v6, v6, v162
    v_mul_f32 v7, v7, v166
    v_exp_f32 v0, v0
    v_exp_f32 v1, v1
    v_exp_f32 v2, v2
    v_exp_f32 v3, v3
    v_exp_f32 v4, v4
    v_exp_f32 v5, v5
    v_exp_f32 v6, v6
    v_exp_f32 v7, v7
    v_add_f32 v0, 1.0, v0
    v_add_f32 v1, 1.0, v1
    v_add_f32 v2, 1.0, v2
    v_add_f32 v3, 1.0, v3
    v_add_f32 v4, 1.0, v4
    v_add_f32 v5, 1.0, v5
    v_add_f32 v6, 1.0, v6
    v_add_f32 v7, 1.0, v7
    v_rcp_f32 v0, v0
    v_rcp_f32 v1, v1
    v_rcp_f32 v2, v2
    v_rcp_f32 v3, v3
    v_rcp_f32 v4, v4
    v_rcp_f32 v5, v5
    v_rcp_f32 v6, v6
    v_rcp_f32 v7, v7
    v_mul_f32 v0, v0, v138
    v_mul_f32 v1, v1, v142
    v_mul_f32 v2, v2, v146
    v_mul_f32 v3, v3, v150
    v_mul_f32 v4, v4, v154
    v_mul_f32 v5, v5, v158
    v_mul_f32 v6, v6, v162
    v_mul_f32 v7, v7, v166
    v_cvt_pk_bf16_f32 v36, v0, v1
    v_cvt_pk_bf16_f32 v37, v2, v3
    v_cvt_pk_bf16_f32 v38, v4, v5
    v_cvt_pk_bf16_f32 v39, v6, v7
    buffer_store_dwordx4 v[36:39], v210, s[32:35], s57 offen sc1
    v_fma_f32 v168, v168, v216, v224
    v_fma_f32 v172, v172, v217, v225
    v_fma_f32 v176, v176, v218, v226
    v_fma_f32 v180, v180, v219, v227
    v_fma_f32 v184, v184, v220, v228
    v_fma_f32 v188, v188, v221, v229
    v_fma_f32 v192, v192, v222, v230
    v_fma_f32 v196, v196, v223, v231
    v_mul_f32 v0, v168, v168
    v_mul_f32 v1, v172, v172
    v_mul_f32 v2, v176, v176
    v_mul_f32 v3, v180, v180
    v_mul_f32 v4, v184, v184
    v_mul_f32 v5, v188, v188
    v_mul_f32 v6, v192, v192
    v_mul_f32 v7, v196, v196
    v_fma_f32 v0, v0, s26, v211
    v_fma_f32 v1, v1, s26, v211
    v_fma_f32 v2, v2, s26, v211
    v_fma_f32 v3, v3, s26, v211
    v_fma_f32 v4, v4, s26, v211
    v_fma_f32 v5, v5, s26, v211
    v_fma_f32 v6, v6, s26, v211
    v_fma_f32 v7, v7, s26, v211
    v_mul_f32 v0, v0, v168
    v_mul_f32 v1, v1, v172
    v_mul_f32 v2, v2, v176
    v_mul_f32 v3, v3, v180
    v_mul_f32 v4, v4, v184
    v_mul_f32 v5, v5, v188
    v_mul_f32 v6, v6, v192
    v_mul_f32 v7, v7, v196
    v_exp_f32 v0, v0
    v_exp_f32 v1, v1
    v_exp_f32 v2, v2
    v_exp_f32 v3, v3
    v_exp_f32 v4, v4
    v_exp_f32 v5, v5
    v_exp_f32 v6, v6
    v_exp_f32 v7, v7
    v_add_f32 v0, 1.0, v0
    v_add_f32 v1, 1.0, v1
    v_add_f32 v2, 1.0, v2
    v_add_f32 v3, 1.0, v3
    v_add_f32 v4, 1.0, v4
    v_add_f32 v5, 1.0, v5
    v_add_f32 v6, 1.0, v6
    v_add_f32 v7, 1.0, v7
    v_rcp_f32 v0, v0
    v_rcp_f32 v1, v1
    v_rcp_f32 v2, v2
    v_rcp_f32 v3, v3
    v_rcp_f32 v4, v4
    v_rcp_f32 v5, v5
    v_rcp_f32 v6, v6
    v_rcp_f32 v7, v7
    v_mul_f32 v0, v0, v168
    v_mul_f32 v1, v1, v172
    v_mul_f32 v2, v2, v176
    v_mul_f32 v3, v3, v180
    v_mul_f32 v4, v4, v184
    v_mul_f32 v5, v5, v188
    v_mul_f32 v6, v6, v192
    v_mul_f32 v7, v7, v196
    v_cvt_pk_bf16_f32 v40, v0, v1
    v_cvt_pk_bf16_f32 v41, v2, v3
    v_cvt_pk_bf16_f32 v42, v4, v5
    v_cvt_pk_bf16_f32 v43, v6, v7
    buffer_store_dwordx4 v[40:43], v210, s[32:35], s58 offen sc1
    v_fma_f32 v169, v169, v216, v224
    v_fma_f32 v173, v173, v217, v225
    v_fma_f32 v177, v177, v218, v226
    v_fma_f32 v181, v181, v219, v227
    v_fma_f32 v185, v185, v220, v228
    v_fma_f32 v189, v189, v221, v229
    v_fma_f32 v193, v193, v222, v230
    v_fma_f32 v197, v197, v223, v231
    v_mul_f32 v0, v169, v169
    v_mul_f32 v1, v173, v173
    v_mul_f32 v2, v177, v177
    v_mul_f32 v3, v181, v181
    v_mul_f32 v4, v185, v185
    v_mul_f32 v5, v189, v189
    v_mul_f32 v6, v193, v193
    v_mul_f32 v7, v197, v197
    v_fma_f32 v0, v0, s26, v211
    v_fma_f32 v1, v1, s26, v211
    v_fma_f32 v2, v2, s26, v211
    v_fma_f32 v3, v3, s26, v211
    v_fma_f32 v4, v4, s26, v211
    v_fma_f32 v5, v5, s26, v211
    v_fma_f32 v6, v6, s26, v211
    v_fma_f32 v7, v7, s26, v211
    v_mul_f32 v0, v0, v169
    v_mul_f32 v1, v1, v173
    v_mul_f32 v2, v2, v177
    v_mul_f32 v3, v3, v181
    v_mul_f32 v4, v4, v185
    v_mul_f32 v5, v5, v189
    v_mul_f32 v6, v6, v193
    v_mul_f32 v7, v7, v197
    v_exp_f32 v0, v0
    v_exp_f32 v1, v1
    v_exp_f32 v2, v2
    v_exp_f32 v3, v3
    v_exp_f32 v4, v4
    v_exp_f32 v5, v5
    v_exp_f32 v6, v6
    v_exp_f32 v7, v7
    v_add_f32 v0, 1.0, v0
    v_add_f32 v1, 1.0, v1
    v_add_f32 v2, 1.0, v2
    v_add_f32 v3, 1.0, v3
    v_add_f32 v4, 1.0, v4
    v_add_f32 v5, 1.0, v5
    v_add_f32 v6, 1.0, v6
    v_add_f32 v7, 1.0, v7
    v_rcp_f32 v0, v0
    v_rcp_f32 v1, v1
    v_rcp_f32 v2, v2
    v_rcp_f32 v3, v3
    v_rcp_f32 v4, v4
    v_rcp_f32 v5, v5
    v_rcp_f32 v6, v6
    v_rcp_f32 v7, v7
    v_mul_f32 v0, v0, v169
    v_mul_f32 v1, v1, v173
    v_mul_f32 v2, v2, v177
    v_mul_f32 v3, v3, v181
    v_mul_f32 v4, v4, v185
    v_mul_f32 v5, v5, v189
    v_mul_f32 v6, v6, v193
    v_mul_f32 v7, v7, v197
    v_cvt_pk_bf16_f32 v44, v0, v1
    v_cvt_pk_bf16_f32 v45, v2, v3
    v_cvt_pk_bf16_f32 v46, v4, v5
    v_cvt_pk_bf16_f32 v47, v6, v7
    buffer_store_dwordx4 v[44:47], v210, s[32:35], s59 offen sc1
    v_fma_f32 v170, v170, v216, v224
    v_fma_f32 v174, v174, v217, v225
    v_fma_f32 v178, v178, v218, v226
    v_fma_f32 v182, v182, v219, v227
    v_fma_f32 v186, v186, v220, v228
    v_fma_f32 v190, v190, v221, v229
    v_fma_f32 v194, v194, v222, v230
    v_fma_f32 v198, v198, v223, v231
    v_mul_f32 v0, v170, v170
    v_mul_f32 v1, v174, v174
    v_mul_f32 v2, v178, v178
    v_mul_f32 v3, v182, v182
    v_mul_f32 v4, v186, v186
    v_mul_f32 v5, v190, v190
    v_mul_f32 v6, v194, v194
    v_mul_f32 v7, v198, v198
    v_fma_f32 v0, v0, s26, v211
    v_fma_f32 v1, v1, s26, v211
    v_fma_f32 v2, v2, s26, v211
    v_fma_f32 v3, v3, s26, v211
    v_fma_f32 v4, v4, s26, v211
    v_fma_f32 v5, v5, s26, v211
    v_fma_f32 v6, v6, s26, v211
    v_fma_f32 v7, v7, s26, v211
    v_mul_f32 v0, v0, v170
    v_mul_f32 v1, v1, v174
    v_mul_f32 v2, v2, v178
    v_mul_f32 v3, v3, v182
    v_mul_f32 v4, v4, v186
    v_mul_f32 v5, v5, v190
    v_mul_f32 v6, v6, v194
    v_mul_f32 v7, v7, v198
    v_exp_f32 v0, v0
    v_exp_f32 v1, v1
    v_exp_f32 v2, v2
    v_exp_f32 v3, v3
    v_exp_f32 v4, v4
    v_exp_f32 v5, v5
    v_exp_f32 v6, v6
    v_exp_f32 v7, v7
    v_add_f32 v0, 1.0, v0
    v_add_f32 v1, 1.0, v1
    v_add_f32 v2, 1.0, v2
    v_add_f32 v3, 1.0, v3
    v_add_f32 v4, 1.0, v4
    v_add_f32 v5, 1.0, v5
    v_add_f32 v6, 1.0, v6
    v_add_f32 v7, 1.0, v7
    v_rcp_f32 v0, v0
    v_rcp_f32 v1, v1
    v_rcp_f32 v2, v2
    v_rcp_f32 v3, v3
    v_rcp_f32 v4, v4
    v_rcp_f32 v5, v5
    v_rcp_f32 v6, v6
    v_rcp_f32 v7, v7
    v_mul_f32 v0, v0, v170
    v_mul_f32 v1, v1, v174
    v_mul_f32 v2, v2, v178
    v_mul_f32 v3, v3, v182
    v_mul_f32 v4, v4, v186
    v_mul_f32 v5, v5, v190
    v_mul_f32 v6, v6, v194
    v_mul_f32 v7, v7, v198
    v_cvt_pk_bf16_f32 v16, v0, v1
    v_cvt_pk_bf16_f32 v17, v2, v3
    v_cvt_pk_bf16_f32 v18, v4, v5
    v_cvt_pk_bf16_f32 v19, v6, v7
    buffer_store_dwordx4 v[16:19], v210, s[32:35], s60 offen sc1
L_k45_fin:
L_k45_end:
    s_endpgm
L_code_end:
    s_endpgm
.section .rodata,"a"
.p2align 6
.amdhsa_kernel conv_kernel
  .amdhsa_next_free_vgpr 256
  .amdhsa_next_free_sgpr 96
  .amdhsa_accum_offset 256
  .amdhsa_group_segment_fixed_size 0
  .amdhsa_kernarg_size 56
  .amdhsa_user_sgpr_count 2
  .amdhsa_user_sgpr_kernarg_segment_ptr 1
  .amdhsa_system_sgpr_workgroup_id_x 1
  .amdhsa_float_denorm_mode_32 3
.end_amdhsa_kernel

.p2align 6
.amdhsa_kernel final_kernel
  .amdhsa_next_free_vgpr 240
  .amdhsa_next_free_sgpr 96
  .amdhsa_accum_offset 240
  .amdhsa_group_segment_fixed_size 0
  .amdhsa_kernarg_size 56
  .amdhsa_user_sgpr_count 2
  .amdhsa_user_sgpr_kernarg_segment_ptr 1
  .amdhsa_system_sgpr_workgroup_id_x 1
  .amdhsa_float_denorm_mode_32 3
.end_amdhsa_kernel
```

```asm
; @launch kernel=conv_kernel grid=(256,1,1) block=(512,1,1) lds=155648
; @launch kernel=final_kernel grid=(224,1,1) block=(512,1,1) lds=82944
.amdgcn_target "amdgcn-amd-amdhsa--gfx950"
.text
.globl conv_kernel
.p2align 8
.type conv_kernel,@function
conv_kernel:
    s_cmp_ge_u32 s2, 256
    s_cbranch_scc1 L_fz_end
    s_load_dwordx4 s[4:7], s[0:1], 0
    s_load_dwordx4 s[36:39], s[0:1], 40
    v_lshrrev_b32 v253, 6, v0
    v_and_b32 v0, 63, v0
    v_readfirstlane_b32 s10, v253
    s_nop 3
    s_cmp_ge_u32 s10, 4
    s_cbranch_scc1 L_fz_helper
    s_cmp_ge_u32 s2, 8
    s_cbranch_scc1 L_nopf
    s_cmp_lg_u32 s10, 3
    s_cbranch_scc1 L_nopf
    s_getpc_b64 s[60:61]
L_pf_fz:
    s_sub_u32 s60, s60, L_pf_fz-conv_kernel
    s_subb_u32 s61, s61, 0
    v_mbcnt_lo_u32_b32 v200, -1, 0
    v_mbcnt_hi_u32_b32 v200, -1, v200
    v_lshlrev_b32 v200, 6, v200
    v_add_u32 v201, 0, v200
    v_min_u32 v201, L_code_end-conv_kernel-4, v201
    v_mov_b32 v203, s61
    v_add_co_u32 v202, vcc, s60, v201
    s_nop 1
    v_addc_co_u32 v203, vcc, 0, v203, vcc
    global_load_dword v204, v[202:203], off
    v_add_u32 v201, 4096, v200
    v_min_u32 v201, L_code_end-conv_kernel-4, v201
    v_mov_b32 v203, s61
    v_add_co_u32 v202, vcc, s60, v201
    s_nop 1
    v_addc_co_u32 v203, vcc, 0, v203, vcc
    global_load_dword v204, v[202:203], off
    v_add_u32 v201, 8192, v200
    v_min_u32 v201, L_code_end-conv_kernel-4, v201
    v_mov_b32 v203, s61
    v_add_co_u32 v202, vcc, s60, v201
    s_nop 1
    v_addc_co_u32 v203, vcc, 0, v203, vcc
    global_load_dword v204, v[202:203], off
    v_add_u32 v201, 12288, v200
    v_min_u32 v201, L_code_end-conv_kernel-4, v201
    v_mov_b32 v203, s61
    v_add_co_u32 v202, vcc, s60, v201
    s_nop 1
    v_addc_co_u32 v203, vcc, 0, v203, vcc
    global_load_dword v204, v[202:203], off
    v_add_u32 v201, 16384, v200
    v_min_u32 v201, L_code_end-conv_kernel-4, v201
    v_mov_b32 v203, s61
    v_add_co_u32 v202, vcc, s60, v201
    s_nop 1
    v_addc_co_u32 v203, vcc, 0, v203, vcc
    global_load_dword v204, v[202:203], off
    v_add_u32 v201, 20480, v200
    v_min_u32 v201, L_code_end-conv_kernel-4, v201
    v_mov_b32 v203, s61
    v_add_co_u32 v202, vcc, s60, v201
    s_nop 1
    v_addc_co_u32 v203, vcc, 0, v203, vcc
    global_load_dword v204, v[202:203], off
    v_add_u32 v201, 24576, v200
    v_min_u32 v201, L_code_end-conv_kernel-4, v201
    v_mov_b32 v203, s61
    v_add_co_u32 v202, vcc, s60, v201
    s_nop 1
    v_addc_co_u32 v203, vcc, 0, v203, vcc
    global_load_dword v204, v[202:203], off
    v_add_u32 v201, 28672, v200
    v_min_u32 v201, L_code_end-conv_kernel-4, v201
    v_mov_b32 v203, s61
    v_add_co_u32 v202, vcc, s60, v201
    s_nop 1
    v_addc_co_u32 v203, vcc, 0, v203, vcc
    global_load_dword v204, v[202:203], off
    v_add_u32 v201, 32768, v200
    v_min_u32 v201, L_code_end-conv_kernel-4, v201
    v_mov_b32 v203, s61
    v_add_co_u32 v202, vcc, s60, v201
    s_nop 1
    v_addc_co_u32 v203, vcc, 0, v203, vcc
    global_load_dword v204, v[202:203], off
    v_add_u32 v201, 36864, v200
    v_min_u32 v201, L_code_end-conv_kernel-4, v201
    v_mov_b32 v203, s61
    v_add_co_u32 v202, vcc, s60, v201
    s_nop 1
    v_addc_co_u32 v203, vcc, 0, v203, vcc
    global_load_dword v204, v[202:203], off
    v_add_u32 v201, 40960, v200
    v_min_u32 v201, L_code_end-conv_kernel-4, v201
    v_mov_b32 v203, s61
    v_add_co_u32 v202, vcc, s60, v201
    s_nop 1
    v_addc_co_u32 v203, vcc, 0, v203, vcc
    global_load_dword v204, v[202:203], off
    v_add_u32 v201, 45056, v200
    v_min_u32 v201, L_code_end-conv_kernel-4, v201
    v_mov_b32 v203, s61
    v_add_co_u32 v202, vcc, s60, v201
    s_nop 1
    v_addc_co_u32 v203, vcc, 0, v203, vcc
    global_load_dword v204, v[202:203], off
L_nopf:
    s_and_b32 s11, s2, 7
    s_lshr_b32 s12, s2, 3
    s_lshr_b32 s13, s12, 3
    s_lshl_b32 s11, s11, 2
    s_add_u32 s11, s11, s13
    s_bfe_u32 s13, s12, 0x10002
    s_and_b32 s14, s12, 3
    s_and_b32 s15, s10, 3
    v_lshrrev_b32 v253, 4, v0
    v_and_b32 v254, 15, v0
    v_bfe_u32 v255, v254, 3, 1
    v_mul_u32_u24 v255, 3, v255
    v_xor_b32 v255, v255, v253
    v_lshlrev_b32 v255, 4, v255
    v_lshl_add_u32 v250, v254, 6, v255
    v_lshrrev_b32 v255, 2, v254
    v_and_b32 v216, 1, v253
    v_lshl_or_b32 v216, v216, 2, v255
    v_lshl_add_u32 v255, v253, 3, v255
    v_lshlrev_b32 v255, 8, v255
    v_and_b32 v217, 3, v254
    v_lshl_add_u32 v255, v217, 3, v255
    s_lshl_b32 s20, s15, 1
    s_add_u32 s20, s20, s13
    v_xor_b32 v217, s20, v216
    v_lshl_add_u32 v248, v217, 5, v255
    s_xor_b32 s20, s20, 1
    v_xor_b32 v217, s20, v216
    v_lshl_add_u32 v249, v217, 5, v255
    v_lshlrev_b32 v251, 6, v254
    v_lshl_add_u32 v251, v253, 4, v251
    v_and_b32 v255, 7, v254
    v_lshlrev_b32 v252, 6, v255
    v_lshrrev_b32 v216, 3, v254
    v_xor_b32 v216, s13, v216
    s_mov_b32 s22, 11534336
    v_mul_lo_u32 v216, v216, s22
    v_add_u32 v252, v252, v216
    v_lshl_add_u32 v252, v253, 4, v252
    s_lshl_b32 s22, s13, 3
    v_add_u32 v252, s22, v252
    v_cmp_gt_u32 vcc, 7, v255
    v_mov_b32 v216, 0x80000000
    s_nop 0
    v_cndmask_b32 v252, v216, v252, vcc
    s_lshl_b32 s20, s14, 2
    s_add_u32 s20, s20, s15
    s_mul_i32 s48, s20, 720896
    s_mul_i32 s20, s11, 22528
    s_add_u32 s48, s48, s20
    s_add_u32 s48, s48, 117440512
    s_add_u32 s49, s48, 10240
    s_mul_i32 s20, s13, 11534336
    s_add_u32 s48, s48, s20
    s_waitcnt vmcnt(0) lgkmcnt(0)
    s_mov_b32 s16, s38
    s_and_b32 s17, s39, 0xffff
    s_mov_b32 s18, 268435456
    s_mov_b32 s19, 0x00020000
    v_mov_b32 v0, 0
    v_mov_b32 v1, 0
    v_mov_b32 v2, 0
    v_mov_b32 v3, 0
    v_mov_b32 v4, 0
    v_mov_b32 v5, 0
    v_mov_b32 v6, 0
    v_mov_b32 v7, 0
    v_mov_b32 v8, 0
    v_mov_b32 v9, 0
    v_mov_b32 v10, 0
    v_mov_b32 v11, 0
    v_mov_b32 v12, 0
    v_mov_b32 v13, 0
    v_mov_b32 v14, 0
    v_mov_b32 v15, 0
    v_mov_b32 v16, 0
    v_mov_b32 v17, 0
    v_mov_b32 v18, 0
    v_mov_b32 v19, 0
    v_mov_b32 v20, 0
    v_mov_b32 v21, 0
    v_mov_b32 v22, 0
    v_mov_b32 v23, 0
    v_mov_b32 v24, 0
    v_mov_b32 v25, 0
    v_mov_b32 v26, 0
    v_mov_b32 v27, 0
    v_mov_b32 v28, 0
    v_mov_b32 v29, 0
    v_mov_b32 v30, 0
    v_mov_b32 v31, 0
    v_mov_b32 v32, 0
    v_mov_b32 v33, 0
    v_mov_b32 v34, 0
    v_mov_b32 v35, 0
    v_mov_b32 v36, 0
    v_mov_b32 v37, 0
    v_mov_b32 v38, 0
    v_mov_b32 v39, 0
    v_mov_b32 v40, 0
    v_mov_b32 v41, 0
    v_mov_b32 v42, 0
    v_mov_b32 v43, 0
    v_mov_b32 v44, 0
    v_mov_b32 v45, 0
    v_mov_b32 v46, 0
    v_mov_b32 v47, 0
    v_mov_b32 v48, 0
    v_mov_b32 v49, 0
    v_mov_b32 v50, 0
    v_mov_b32 v51, 0
    v_mov_b32 v52, 0
    v_mov_b32 v53, 0
    v_mov_b32 v54, 0
    v_mov_b32 v55, 0
    v_mov_b32 v56, 0
    v_mov_b32 v57, 0
    v_mov_b32 v58, 0
    v_mov_b32 v59, 0
    v_mov_b32 v60, 0
    v_mov_b32 v61, 0
    v_mov_b32 v62, 0
    v_mov_b32 v63, 0
    v_mov_b32 v64, 0
    v_mov_b32 v65, 0
    v_mov_b32 v66, 0
    v_mov_b32 v67, 0
    v_mov_b32 v68, 0
    v_mov_b32 v69, 0
    v_mov_b32 v70, 0
    v_mov_b32 v71, 0
    v_mov_b32 v72, 0
    v_mov_b32 v73, 0
    v_mov_b32 v74, 0
    v_mov_b32 v75, 0
    v_mov_b32 v76, 0
    v_mov_b32 v77, 0
    v_mov_b32 v78, 0
    v_mov_b32 v79, 0
    v_mov_b32 v80, 0
    v_mov_b32 v81, 0
    v_mov_b32 v82, 0
    v_mov_b32 v83, 0
    v_mov_b32 v84, 0
    v_mov_b32 v85, 0
    v_mov_b32 v86, 0
    v_mov_b32 v87, 0
    v_mov_b32 v88, 0
    v_mov_b32 v89, 0
    v_mov_b32 v90, 0
    v_mov_b32 v91, 0
    v_mov_b32 v92, 0
    v_mov_b32 v93, 0
    v_mov_b32 v94, 0
    v_mov_b32 v95, 0
    v_mov_b32 v96, 0
    v_mov_b32 v97, 0
    v_mov_b32 v98, 0
    v_mov_b32 v99, 0
    v_mov_b32 v100, 0
    v_mov_b32 v101, 0
    v_mov_b32 v102, 0
    v_mov_b32 v103, 0
    v_mov_b32 v104, 0
    v_mov_b32 v105, 0
    v_mov_b32 v106, 0
    v_mov_b32 v107, 0
    v_mov_b32 v108, 0
    v_mov_b32 v109, 0
    v_mov_b32 v110, 0
    v_mov_b32 v111, 0
    v_mov_b32 v112, 0
    v_mov_b32 v113, 0
    v_mov_b32 v114, 0
    v_mov_b32 v115, 0
    v_mov_b32 v116, 0
    v_mov_b32 v117, 0
    v_mov_b32 v118, 0
    v_mov_b32 v119, 0
    v_mov_b32 v120, 0
    v_mov_b32 v121, 0
    v_mov_b32 v122, 0
    v_mov_b32 v123, 0
    v_mov_b32 v124, 0
    v_mov_b32 v125, 0
    v_mov_b32 v126, 0
    v_mov_b32 v127, 0
    v_mov_b32 v128, 0
    v_mov_b32 v129, 0
    v_mov_b32 v130, 0
    v_mov_b32 v131, 0
    v_mov_b32 v132, 0
    v_mov_b32 v133, 0
    v_mov_b32 v134, 0
    v_mov_b32 v135, 0
    v_mov_b32 v136, 0
    v_mov_b32 v137, 0
    v_mov_b32 v138, 0
    v_mov_b32 v139, 0
    v_mov_b32 v140, 0
    v_mov_b32 v141, 0
    v_mov_b32 v142, 0
    v_mov_b32 v143, 0
    v_mov_b32 v144, 0
    v_mov_b32 v145, 0
    v_mov_b32 v146, 0
    v_mov_b32 v147, 0
    v_mov_b32 v148, 0
    v_mov_b32 v149, 0
    v_mov_b32 v150, 0
    v_mov_b32 v151, 0
    v_mov_b32 v152, 0
    v_mov_b32 v153, 0
    v_mov_b32 v154, 0
    v_mov_b32 v155, 0
    v_mov_b32 v156, 0
    v_mov_b32 v157, 0
    v_mov_b32 v158, 0
    v_mov_b32 v159, 0
    v_mov_b32 v160, 0
    v_mov_b32 v161, 0
    v_mov_b32 v162, 0
    v_mov_b32 v163, 0
    v_mov_b32 v164, 0
    v_mov_b32 v165, 0
    v_mov_b32 v166, 0
    v_mov_b32 v167, 0
    s_mov_b32 s40, s2
    s_add_u32 s42, s2, 256
    s_mov_b32 s41, 129024
    s_barrier
L_f_loop:
    s_barrier
    v_mov_b32 v254, s41
    ds_read_b32 v255, v254
    s_xor_b32 s41, s41, 4
    s_mov_b32 s40, s42
    s_waitcnt lgkmcnt(0)
    v_readfirstlane_b32 s42, v255
    s_cmp_lt_u32 s40, 1696
    s_cbranch_scc1 L_f_loop
    s_barrier
    s_barrier
    ds_read_b64_tr_b16 v[176:177], v248 offset:0
    ds_read_b64_tr_b16 v[178:179], v248 offset:1024
    ds_read_b64_tr_b16 v[180:181], v249 offset:0
    ds_read_b64_tr_b16 v[182:183], v249 offset:1024
    ds_read_b64_tr_b16 v[184:185], v248 offset:8192
    ds_read_b64_tr_b16 v[186:187], v248 offset:9216
    ds_read_b64_tr_b16 v[188:189], v249 offset:8192
    ds_read_b64_tr_b16 v[190:191], v249 offset:9216
    ds_read_b128 v[216:219], v250 offset:16384
    ds_read_b128 v[220:223], v250 offset:27648
    ds_read_b128 v[224:227], v250 offset:17408
    ds_read_b128 v[228:231], v250 offset:28672
    s_waitcnt lgkmcnt(4)
    v_xor_b32 v208, 0x80008000, v184
    v_xor_b32 v209, 0x80008000, v185
    v_xor_b32 v210, 0x80008000, v186
    v_xor_b32 v211, 0x80008000, v187
    v_xor_b32 v212, 0x80008000, v188
    v_xor_b32 v213, 0x80008000, v189
    v_xor_b32 v214, 0x80008000, v190
    v_xor_b32 v215, 0x80008000, v191
    s_mov_b32 s46, 7
L_g_loop:
    s_barrier
    s_waitcnt lgkmcnt(2)
    v_mfma_f32_16x16x32_bf16 v[0:3], v[176:179], v[216:219], v[0:3]
    ds_read_b128 v[232:235], v250 offset:18432
    ds_read_b128 v[236:239], v250 offset:29696
    v_mfma_f32_16x16x32_bf16 v[4:7], v[180:183], v[216:219], v[4:7]
    v_mfma_f32_16x16x32_bf16 v[8:11], v[208:211], v[216:219], v[8:11]
    v_mfma_f32_16x16x32_bf16 v[12:15], v[212:215], v[216:219], v[12:15]
    v_mfma_f32_16x16x32_bf16 v[0:3], v[184:187], v[220:223], v[0:3]
    v_mfma_f32_16x16x32_bf16 v[4:7], v[188:191], v[220:223], v[4:7]
    v_mfma_f32_16x16x32_bf16 v[8:11], v[176:179], v[220:223], v[8:11]
    v_mfma_f32_16x16x32_bf16 v[12:15], v[180:183], v[220:223], v[12:15]
    s_waitcnt lgkmcnt(2)
    v_mfma_f32_16x16x32_bf16 v[16:19], v[176:179], v[224:227], v[16:19]
    ds_read_b128 v[240:243], v250 offset:19456
    ds_read_b128 v[244:247], v250 offset:30720
    v_mfma_f32_16x16x32_bf16 v[20:23], v[180:183], v[224:227], v[20:23]
    v_mfma_f32_16x16x32_bf16 v[24:27], v[208:211], v[224:227], v[24:27]
    v_mfma_f32_16x16x32_bf16 v[28:31], v[212:215], v[224:227], v[28:31]
    v_mfma_f32_16x16x32_bf16 v[16:19], v[184:187], v[228:231], v[16:19]
    v_mfma_f32_16x16x32_bf16 v[20:23], v[188:191], v[228:231], v[20:23]
    v_mfma_f32_16x16x32_bf16 v[24:27], v[176:179], v[228:231], v[24:27]
    v_mfma_f32_16x16x32_bf16 v[28:31], v[180:183], v[228:231], v[28:31]
    s_waitcnt lgkmcnt(2)
    v_mfma_f32_16x16x32_bf16 v[32:35], v[176:179], v[232:235], v[32:35]
    ds_read_b128 v[216:219], v250 offset:20480
    ds_read_b128 v[220:223], v250 offset:31744
    v_mfma_f32_16x16x32_bf16 v[36:39], v[180:183], v[232:235], v[36:39]
    v_mfma_f32_16x16x32_bf16 v[40:43], v[208:211], v[232:235], v[40:43]
    v_mfma_f32_16x16x32_bf16 v[44:47], v[212:215], v[232:235], v[44:47]
    v_mfma_f32_16x16x32_bf16 v[32:35], v[184:187], v[236:239], v[32:35]
    v_mfma_f32_16x16x32_bf16 v[36:39], v[188:191], v[236:239], v[36:39]
    v_mfma_f32_16x16x32_bf16 v[40:43], v[176:179], v[236:239], v[40:43]
    v_mfma_f32_16x16x32_bf16 v[44:47], v[180:183], v[236:239], v[44:47]
    s_waitcnt lgkmcnt(2)
    v_mfma_f32_16x16x32_bf16 v[48:51], v[176:179], v[240:243], v[48:51]
    ds_read_b128 v[224:227], v250 offset:21504
    ds_read_b128 v[228:231], v250 offset:32768
    v_mfma_f32_16x16x32_bf16 v[52:55], v[180:183], v[240:243], v[52:55]
    v_mfma_f32_16x16x32_bf16 v[56:59], v[208:211], v[240:243], v[56:59]
    v_mfma_f32_16x16x32_bf16 v[60:63], v[212:215], v[240:243], v[60:63]
    v_mfma_f32_16x16x32_bf16 v[48:51], v[184:187], v[244:247], v[48:51]
    v_mfma_f32_16x16x32_bf16 v[52:55], v[188:191], v[244:247], v[52:55]
    v_mfma_f32_16x16x32_bf16 v[56:59], v[176:179], v[244:247], v[56:59]
    v_mfma_f32_16x16x32_bf16 v[60:63], v[180:183], v[244:247], v[60:63]
    s_waitcnt lgkmcnt(2)
    v_mfma_f32_16x16x32_bf16 v[64:67], v[176:179], v[216:219], v[64:67]
    ds_read_b128 v[232:235], v250 offset:22528
    ds_read_b128 v[236:239], v250 offset:33792
    v_mfma_f32_16x16x32_bf16 v[68:71], v[180:183], v[216:219], v[68:71]
    v_mfma_f32_16x16x32_bf16 v[72:75], v[208:211], v[216:219], v[72:75]
    v_mfma_f32_16x16x32_bf16 v[76:79], v[212:215], v[216:219], v[76:79]
    v_mfma_f32_16x16x32_bf16 v[64:67], v[184:187], v[220:223], v[64:67]
    v_mfma_f32_16x16x32_bf16 v[68:71], v[188:191], v[220:223], v[68:71]
    v_mfma_f32_16x16x32_bf16 v[72:75], v[176:179], v[220:223], v[72:75]
    v_mfma_f32_16x16x32_bf16 v[76:79], v[180:183], v[220:223], v[76:79]
    s_waitcnt lgkmcnt(2)
    v_mfma_f32_16x16x32_bf16 v[80:83], v[176:179], v[224:227], v[80:83]
    ds_read_b128 v[240:243], v250 offset:23552
    ds_read_b128 v[244:247], v250 offset:34816
    v_mfma_f32_16x16x32_bf16 v[84:87], v[180:183], v[224:227], v[84:87]
    v_mfma_f32_16x16x32_bf16 v[88:91], v[208:211], v[224:227], v[88:91]
    v_mfma_f32_16x16x32_bf16 v[92:95], v[212:215], v[224:227], v[92:95]
    v_mfma_f32_16x16x32_bf16 v[80:83], v[184:187], v[228:231], v[80:83]
    v_add_u32 v248, 0x9800, v248
    v_add_u32 v249, 0x9800, v249
    v_mfma_f32_16x16x32_bf16 v[84:87], v[188:191], v[228:231], v[84:87]
    v_mfma_f32_16x16x32_bf16 v[88:91], v[176:179], v[228:231], v[88:91]
    v_mfma_f32_16x16x32_bf16 v[92:95], v[180:183], v[228:231], v[92:95]
    s_waitcnt lgkmcnt(2)
    v_mfma_f32_16x16x32_bf16 v[96:99], v[176:179], v[232:235], v[96:99]
    ds_read_b128 v[216:219], v250 offset:24576
    ds_read_b128 v[220:223], v250 offset:35840
    v_mfma_f32_16x16x32_bf16 v[100:103], v[180:183], v[232:235], v[100:103]
    v_mfma_f32_16x16x32_bf16 v[104:107], v[208:211], v[232:235], v[104:107]
    v_mfma_f32_16x16x32_bf16 v[108:111], v[212:215], v[232:235], v[108:111]
    ds_read_b64_tr_b16 v[192:193], v248 offset:0
    ds_read_b64_tr_b16 v[194:195], v248 offset:1024
    ds_read_b64_tr_b16 v[196:197], v249 offset:0
    ds_read_b64_tr_b16 v[198:199], v249 offset:1024
    v_mfma_f32_16x16x32_bf16 v[96:99], v[184:187], v[236:239], v[96:99]
    v_mfma_f32_16x16x32_bf16 v[100:103], v[188:191], v[236:239], v[100:103]
    v_mfma_f32_16x16x32_bf16 v[104:107], v[176:179], v[236:239], v[104:107]
    v_mfma_f32_16x16x32_bf16 v[108:111], v[180:183], v[236:239], v[108:111]
    s_waitcnt lgkmcnt(6)
    v_mfma_f32_16x16x32_bf16 v[112:115], v[176:179], v[240:243], v[112:115]
    ds_read_b128 v[224:227], v250 offset:25600
    ds_read_b128 v[228:231], v250 offset:36864
    v_mfma_f32_16x16x32_bf16 v[116:119], v[180:183], v[240:243], v[116:119]
    v_mfma_f32_16x16x32_bf16 v[120:123], v[208:211], v[240:243], v[120:123]
    v_mfma_f32_16x16x32_bf16 v[124:127], v[212:215], v[240:243], v[124:127]
    ds_read_b64_tr_b16 v[200:201], v248 offset:8192
    ds_read_b64_tr_b16 v[202:203], v248 offset:9216
    ds_read_b64_tr_b16 v[204:205], v249 offset:8192
    ds_read_b64_tr_b16 v[206:207], v249 offset:9216
    v_mfma_f32_16x16x32_bf16 v[112:115], v[184:187], v[244:247], v[112:115]
    v_mfma_f32_16x16x32_bf16 v[116:119], v[188:191], v[244:247], v[116:119]
    v_mfma_f32_16x16x32_bf16 v[120:123], v[176:179], v[244:247], v[120:123]
    v_mfma_f32_16x16x32_bf16 v[124:127], v[180:183], v[244:247], v[124:127]
    s_waitcnt lgkmcnt(10)
    v_mfma_f32_16x16x32_bf16 v[128:131], v[176:179], v[216:219], v[128:131]
    ds_read_b128 v[232:235], v250 offset:26624
    ds_read_b128 v[236:239], v250 offset:37888
    v_mfma_f32_16x16x32_bf16 v[132:135], v[180:183], v[216:219], v[132:135]
    v_mfma_f32_16x16x32_bf16 v[136:139], v[208:211], v[216:219], v[136:139]
    v_mfma_f32_16x16x32_bf16 v[140:143], v[212:215], v[216:219], v[140:143]
    v_mfma_f32_16x16x32_bf16 v[128:131], v[184:187], v[220:223], v[128:131]
    v_mfma_f32_16x16x32_bf16 v[132:135], v[188:191], v[220:223], v[132:135]
    v_mfma_f32_16x16x32_bf16 v[136:139], v[176:179], v[220:223], v[136:139]
    v_mfma_f32_16x16x32_bf16 v[140:143], v[180:183], v[220:223], v[140:143]
    s_waitcnt lgkmcnt(6)
    v_mfma_f32_16x16x32_bf16 v[144:147], v[176:179], v[224:227], v[144:147]
    v_add_u32 v250, 0x9800, v250
    ds_read_b128 v[240:243], v250 offset:16384
    ds_read_b128 v[244:247], v250 offset:27648
    v_mfma_f32_16x16x32_bf16 v[148:151], v[180:183], v[224:227], v[148:151]
    v_mfma_f32_16x16x32_bf16 v[152:155], v[208:211], v[224:227], v[152:155]
    v_mfma_f32_16x16x32_bf16 v[156:159], v[212:215], v[224:227], v[156:159]
    v_mfma_f32_16x16x32_bf16 v[144:147], v[184:187], v[228:231], v[144:147]
    s_waitcnt lgkmcnt(4)
    v_xor_b32 v212, 0x80008000, v204
    v_xor_b32 v213, 0x80008000, v205
    v_mfma_f32_16x16x32_bf16 v[148:151], v[188:191], v[228:231], v[148:151]
    v_xor_b32 v214, 0x80008000, v206
    v_xor_b32 v215, 0x80008000, v207
    v_mfma_f32_16x16x32_bf16 v[152:155], v[176:179], v[228:231], v[152:155]
    v_mfma_f32_16x16x32_bf16 v[156:159], v[180:183], v[228:231], v[156:159]
    s_waitcnt lgkmcnt(2)
    v_mfma_f32_16x16x32_bf16 v[160:163], v[176:179], v[232:235], v[160:163]
    ds_read_b128 v[216:219], v250 offset:17408
    ds_read_b128 v[220:223], v250 offset:28672
    v_mfma_f32_16x16x32_bf16 v[164:167], v[208:211], v[232:235], v[164:167]
    v_xor_b32 v208, 0x80008000, v200
    v_xor_b32 v209, 0x80008000, v201
    v_mfma_f32_16x16x32_bf16 v[160:163], v[184:187], v[236:239], v[160:163]
    v_xor_b32 v210, 0x80008000, v202
    v_xor_b32 v211, 0x80008000, v203
    v_mfma_f32_16x16x32_bf16 v[164:167], v[176:179], v[236:239], v[164:167]
    s_barrier
    s_waitcnt lgkmcnt(2)
    v_mfma_f32_16x16x32_bf16 v[0:3], v[192:195], v[240:243], v[0:3]
    ds_read_b128 v[224:227], v250 offset:18432
    ds_read_b128 v[228:231], v250 offset:29696
    v_mfma_f32_16x16x32_bf16 v[4:7], v[196:199], v[240:243], v[4:7]
    v_mfma_f32_16x16x32_bf16 v[8:11], v[208:211], v[240:243], v[8:11]
    v_mfma_f32_16x16x32_bf16 v[12:15], v[212:215], v[240:243], v[12:15]
    v_mfma_f32_16x16x32_bf16 v[0:3], v[200:203], v[244:247], v[0:3]
    v_mfma_f32_16x16x32_bf16 v[4:7], v[204:207], v[244:247], v[4:7]
    v_mfma_f32_16x16x32_bf16 v[8:11], v[192:195], v[244:247], v[8:11]
    v_mfma_f32_16x16x32_bf16 v[12:15], v[196:199], v[244:247], v[12:15]
    s_waitcnt lgkmcnt(2)
    v_mfma_f32_16x16x32_bf16 v[16:19], v[192:195], v[216:219], v[16:19]
    ds_read_b128 v[232:235], v250 offset:19456
    ds_read_b128 v[236:239], v250 offset:30720
    v_mfma_f32_16x16x32_bf16 v[20:23], v[196:199], v[216:219], v[20:23]
    v_mfma_f32_16x16x32_bf16 v[24:27], v[208:211], v[216:219], v[24:27]
    v_mfma_f32_16x16x32_bf16 v[28:31], v[212:215], v[216:219], v[28:31]
    v_mfma_f32_16x16x32_bf16 v[16:19], v[200:203], v[220:223], v[16:19]
    v_mfma_f32_16x16x32_bf16 v[20:23], v[204:207], v[220:223], v[20:23]
    v_mfma_f32_16x16x32_bf16 v[24:27], v[192:195], v[220:223], v[24:27]
    v_mfma_f32_16x16x32_bf16 v[28:31], v[196:199], v[220:223], v[28:31]
    s_waitcnt lgkmcnt(2)
    v_mfma_f32_16x16x32_bf16 v[32:35], v[192:195], v[224:227], v[32:35]
    ds_read_b128 v[240:243], v250 offset:20480
    ds_read_b128 v[244:247], v250 offset:31744
    v_mfma_f32_16x16x32_bf16 v[36:39], v[196:199], v[224:227], v[36:39]
    v_mfma_f32_16x16x32_bf16 v[40:43], v[208:211], v[224:227], v[40:43]
    v_mfma_f32_16x16x32_bf16 v[44:47], v[212:215], v[224:227], v[44:47]
    v_mfma_f32_16x16x32_bf16 v[32:35], v[200:203], v[228:231], v[32:35]
    v_mfma_f32_16x16x32_bf16 v[36:39], v[204:207], v[228:231], v[36:39]
    v_mfma_f32_16x16x32_bf16 v[40:43], v[192:195], v[228:231], v[40:43]
    v_mfma_f32_16x16x32_bf16 v[44:47], v[196:199], v[228:231], v[44:47]
    s_waitcnt lgkmcnt(2)
    v_mfma_f32_16x16x32_bf16 v[48:51], v[192:195], v[232:235], v[48:51]
    ds_read_b128 v[216:219], v250 offset:21504
    ds_read_b128 v[220:223], v250 offset:32768
    v_mfma_f32_16x16x32_bf16 v[52:55], v[196:199], v[232:235], v[52:55]
    v_mfma_f32_16x16x32_bf16 v[56:59], v[208:211], v[232:235], v[56:59]
    v_mfma_f32_16x16x32_bf16 v[60:63], v[212:215], v[232:235], v[60:63]
    v_mfma_f32_16x16x32_bf16 v[48:51], v[200:203], v[236:239], v[48:51]
    v_mfma_f32_16x16x32_bf16 v[52:55], v[204:207], v[236:239], v[52:55]
    v_mfma_f32_16x16x32_bf16 v[56:59], v[192:195], v[236:239], v[56:59]
    v_mfma_f32_16x16x32_bf16 v[60:63], v[196:199], v[236:239], v[60:63]
    s_waitcnt lgkmcnt(2)
    v_mfma_f32_16x16x32_bf16 v[64:67], v[192:195], v[240:243], v[64:67]
    ds_read_b128 v[224:227], v250 offset:22528
    ds_read_b128 v[228:231], v250 offset:33792
    v_mfma_f32_16x16x32_bf16 v[68:71], v[196:199], v[240:243], v[68:71]
    v_mfma_f32_16x16x32_bf16 v[72:75], v[208:211], v[240:243], v[72:75]
    v_mfma_f32_16x16x32_bf16 v[76:79], v[212:215], v[240:243], v[76:79]
    v_mfma_f32_16x16x32_bf16 v[64:67], v[200:203], v[244:247], v[64:67]
    v_mfma_f32_16x16x32_bf16 v[68:71], v[204:207], v[244:247], v[68:71]
    v_mfma_f32_16x16x32_bf16 v[72:75], v[192:195], v[244:247], v[72:75]
    v_mfma_f32_16x16x32_bf16 v[76:79], v[196:199], v[244:247], v[76:79]
    s_waitcnt lgkmcnt(2)
    v_mfma_f32_16x16x32_bf16 v[80:83], v[192:195], v[216:219], v[80:83]
    ds_read_b128 v[232:235], v250 offset:23552
    ds_read_b128 v[236:239], v250 offset:34816
    v_mfma_f32_16x16x32_bf16 v[84:87], v[196:199], v[216:219], v[84:87]
    v_mfma_f32_16x16x32_bf16 v[88:91], v[208:211], v[216:219], v[88:91]
    v_mfma_f32_16x16x32_bf16 v[92:95], v[212:215], v[216:219], v[92:95]
    v_mfma_f32_16x16x32_bf16 v[80:83], v[200:203], v[220:223], v[80:83]
    v_add_u32 v248, 0x9800, v248
    v_add_u32 v249, 0x9800, v249
    v_mfma_f32_16x16x32_bf16 v[84:87], v[204:207], v[220:223], v[84:87]
    v_mfma_f32_16x16x32_bf16 v[88:91], v[192:195], v[220:223], v[88:91]
    v_mfma_f32_16x16x32_bf16 v[92:95], v[196:199], v[220:223], v[92:95]
    s_waitcnt lgkmcnt(2)
    v_mfma_f32_16x16x32_bf16 v[96:99], v[192:195], v[224:227], v[96:99]
    ds_read_b128 v[240:243], v250 offset:24576
    ds_read_b128 v[244:247], v250 offset:35840
    v_mfma_f32_16x16x32_bf16 v[100:103], v[196:199], v[224:227], v[100:103]
    v_mfma_f32_16x16x32_bf16 v[104:107], v[208:211], v[224:227], v[104:107]
    v_mfma_f32_16x16x32_bf16 v[108:111], v[212:215], v[224:227], v[108:111]
    ds_read_b64_tr_b16 v[176:177], v248 offset:0
    ds_read_b64_tr_b16 v[178:179], v248 offset:1024
    ds_read_b64_tr_b16 v[180:181], v249 offset:0
    ds_read_b64_tr_b16 v[182:183], v249 offset:1024
    v_mfma_f32_16x16x32_bf16 v[96:99], v[200:203], v[228:231], v[96:99]
    v_mfma_f32_16x16x32_bf16 v[100:103], v[204:207], v[228:231], v[100:103]
    v_mfma_f32_16x16x32_bf16 v[104:107], v[192:195], v[228:231], v[104:107]
    v_mfma_f32_16x16x32_bf16 v[108:111], v[196:199], v[228:231], v[108:111]
    s_waitcnt lgkmcnt(6)
    v_mfma_f32_16x16x32_bf16 v[112:115], v[192:195], v[232:235], v[112:115]
    ds_read_b128 v[216:219], v250 offset:25600
    ds_read_b128 v[220:223], v250 offset:36864
    v_mfma_f32_16x16x32_bf16 v[116:119], v[196:199], v[232:235], v[116:119]
    v_mfma_f32_16x16x32_bf16 v[120:123], v[208:211], v[232:235], v[120:123]
    v_mfma_f32_16x16x32_bf16 v[124:127], v[212:215], v[232:235], v[124:127]
    ds_read_b64_tr_b16 v[184:185], v248 offset:8192
    ds_read_b64_tr_b16 v[186:187], v248 offset:9216
    ds_read_b64_tr_b16 v[188:189], v249 offset:8192
    ds_read_b64_tr_b16 v[190:191], v249 offset:9216
    v_mfma_f32_16x16x32_bf16 v[112:115], v[200:203], v[236:239], v[112:115]
    v_mfma_f32_16x16x32_bf16 v[116:119], v[204:207], v[236:239], v[116:119]
    v_mfma_f32_16x16x32_bf16 v[120:123], v[192:195], v[236:239], v[120:123]
    v_mfma_f32_16x16x32_bf16 v[124:127], v[196:199], v[236:239], v[124:127]
    s_waitcnt lgkmcnt(10)
    v_mfma_f32_16x16x32_bf16 v[128:131], v[192:195], v[240:243], v[128:131]
    ds_read_b128 v[224:227], v250 offset:26624
    ds_read_b128 v[228:231], v250 offset:37888
    v_mfma_f32_16x16x32_bf16 v[132:135], v[196:199], v[240:243], v[132:135]
    v_mfma_f32_16x16x32_bf16 v[136:139], v[208:211], v[240:243], v[136:139]
    v_mfma_f32_16x16x32_bf16 v[140:143], v[212:215], v[240:243], v[140:143]
    v_mfma_f32_16x16x32_bf16 v[128:131], v[200:203], v[244:247], v[128:131]
    v_mfma_f32_16x16x32_bf16 v[132:135], v[204:207], v[244:247], v[132:135]
    v_mfma_f32_16x16x32_bf16 v[136:139], v[192:195], v[244:247], v[136:139]
    v_mfma_f32_16x16x32_bf16 v[140:143], v[196:199], v[244:247], v[140:143]
    s_waitcnt lgkmcnt(6)
    v_mfma_f32_16x16x32_bf16 v[144:147], v[192:195], v[216:219], v[144:147]
    v_add_u32 v250, 0x9800, v250
    ds_read_b128 v[232:235], v250 offset:16384
    ds_read_b128 v[236:239], v250 offset:27648
    v_mfma_f32_16x16x32_bf16 v[148:151], v[196:199], v[216:219], v[148:151]
    v_mfma_f32_16x16x32_bf16 v[152:155], v[208:211], v[216:219], v[152:155]
    v_mfma_f32_16x16x32_bf16 v[156:159], v[212:215], v[216:219], v[156:159]
    v_mfma_f32_16x16x32_bf16 v[144:147], v[200:203], v[220:223], v[144:147]
    s_waitcnt lgkmcnt(4)
    v_xor_b32 v212, 0x80008000, v188
    v_xor_b32 v213, 0x80008000, v189
    v_mfma_f32_16x16x32_bf16 v[148:151], v[204:207], v[220:223], v[148:151]
    v_xor_b32 v214, 0x80008000, v190
    v_xor_b32 v215, 0x80008000, v191
    v_mfma_f32_16x16x32_bf16 v[152:155], v[192:195], v[220:223], v[152:155]
    v_mfma_f32_16x16x32_bf16 v[156:159], v[196:199], v[220:223], v[156:159]
    s_waitcnt lgkmcnt(2)
    v_mfma_f32_16x16x32_bf16 v[160:163], v[192:195], v[224:227], v[160:163]
    ds_read_b128 v[240:243], v250 offset:17408
    ds_read_b128 v[244:247], v250 offset:28672
    v_mfma_f32_16x16x32_bf16 v[164:167], v[208:211], v[224:227], v[164:167]
    v_xor_b32 v208, 0x80008000, v184
    v_xor_b32 v209, 0x80008000, v185
    v_mfma_f32_16x16x32_bf16 v[160:163], v[200:203], v[228:231], v[160:163]
    v_xor_b32 v210, 0x80008000, v186
    v_xor_b32 v211, 0x80008000, v187
    v_mfma_f32_16x16x32_bf16 v[164:167], v[192:195], v[228:231], v[164:167]
    s_barrier
    s_waitcnt lgkmcnt(2)
    v_mfma_f32_16x16x32_bf16 v[0:3], v[176:179], v[232:235], v[0:3]
    ds_read_b128 v[216:219], v250 offset:18432
    ds_read_b128 v[220:223], v250 offset:29696
    v_mfma_f32_16x16x32_bf16 v[4:7], v[180:183], v[232:235], v[4:7]
    v_mfma_f32_16x16x32_bf16 v[8:11], v[208:211], v[232:235], v[8:11]
    v_mfma_f32_16x16x32_bf16 v[12:15], v[212:215], v[232:235], v[12:15]
    v_mfma_f32_16x16x32_bf16 v[0:3], v[184:187], v[236:239], v[0:3]
    v_mfma_f32_16x16x32_bf16 v[4:7], v[188:191], v[236:239], v[4:7]
    v_mfma_f32_16x16x32_bf16 v[8:11], v[176:179], v[236:239], v[8:11]
    v_mfma_f32_16x16x32_bf16 v[12:15], v[180:183], v[236:239], v[12:15]
    s_waitcnt lgkmcnt(2)
    v_mfma_f32_16x16x32_bf16 v[16:19], v[176:179], v[240:243], v[16:19]
    ds_read_b128 v[224:227], v250 offset:19456
    ds_read_b128 v[228:231], v250 offset:30720
    v_mfma_f32_16x16x32_bf16 v[20:23], v[180:183], v[240:243], v[20:23]
    v_mfma_f32_16x16x32_bf16 v[24:27], v[208:211], v[240:243], v[24:27]
    v_mfma_f32_16x16x32_bf16 v[28:31], v[212:215], v[240:243], v[28:31]
    v_mfma_f32_16x16x32_bf16 v[16:19], v[184:187], v[244:247], v[16:19]
    v_mfma_f32_16x16x32_bf16 v[20:23], v[188:191], v[244:247], v[20:23]
    v_mfma_f32_16x16x32_bf16 v[24:27], v[176:179], v[244:247], v[24:27]
    v_mfma_f32_16x16x32_bf16 v[28:31], v[180:183], v[244:247], v[28:31]
    s_waitcnt lgkmcnt(2)
    v_mfma_f32_16x16x32_bf16 v[32:35], v[176:179], v[216:219], v[32:35]
    ds_read_b128 v[232:235], v250 offset:20480
    ds_read_b128 v[236:239], v250 offset:31744
    v_mfma_f32_16x16x32_bf16 v[36:39], v[180:183], v[216:219], v[36:39]
    v_mfma_f32_16x16x32_bf16 v[40:43], v[208:211], v[216:219], v[40:43]
    v_mfma_f32_16x16x32_bf16 v[44:47], v[212:215], v[216:219], v[44:47]
    v_mfma_f32_16x16x32_bf16 v[32:35], v[184:187], v[220:223], v[32:35]
    v_mfma_f32_16x16x32_bf16 v[36:39], v[188:191], v[220:223], v[36:39]
    v_mfma_f32_16x16x32_bf16 v[40:43], v[176:179], v[220:223], v[40:43]
    v_mfma_f32_16x16x32_bf16 v[44:47], v[180:183], v[220:223], v[44:47]
    s_waitcnt lgkmcnt(2)
    v_mfma_f32_16x16x32_bf16 v[48:51], v[176:179], v[224:227], v[48:51]
    ds_read_b128 v[240:243], v250 offset:21504
    ds_read_b128 v[244:247], v250 offset:32768
    v_mfma_f32_16x16x32_bf16 v[52:55], v[180:183], v[224:227], v[52:55]
    v_mfma_f32_16x16x32_bf16 v[56:59], v[208:211], v[224:227], v[56:59]
    v_mfma_f32_16x16x32_bf16 v[60:63], v[212:215], v[224:227], v[60:63]
    v_mfma_f32_16x16x32_bf16 v[48:51], v[184:187], v[228:231], v[48:51]
    v_mfma_f32_16x16x32_bf16 v[52:55], v[188:191], v[228:231], v[52:55]
    v_mfma_f32_16x16x32_bf16 v[56:59], v[176:179], v[228:231], v[56:59]
    v_mfma_f32_16x16x32_bf16 v[60:63], v[180:183], v[228:231], v[60:63]
    s_waitcnt lgkmcnt(2)
    v_mfma_f32_16x16x32_bf16 v[64:67], v[176:179], v[232:235], v[64:67]
    ds_read_b128 v[216:219], v250 offset:22528
    ds_read_b128 v[220:223], v250 offset:33792
    v_mfma_f32_16x16x32_bf16 v[68:71], v[180:183], v[232:235], v[68:71]
    v_mfma_f32_16x16x32_bf16 v[72:75], v[208:211], v[232:235], v[72:75]
    v_mfma_f32_16x16x32_bf16 v[76:79], v[212:215], v[232:235], v[76:79]
    v_mfma_f32_16x16x32_bf16 v[64:67], v[184:187], v[236:239], v[64:67]
    v_mfma_f32_16x16x32_bf16 v[68:71], v[188:191], v[236:239], v[68:71]
    v_mfma_f32_16x16x32_bf16 v[72:75], v[176:179], v[236:239], v[72:75]
    v_mfma_f32_16x16x32_bf16 v[76:79], v[180:183], v[236:239], v[76:79]
    s_waitcnt lgkmcnt(2)
    v_mfma_f32_16x16x32_bf16 v[80:83], v[176:179], v[240:243], v[80:83]
    ds_read_b128 v[224:227], v250 offset:23552
    ds_read_b128 v[228:231], v250 offset:34816
    v_mfma_f32_16x16x32_bf16 v[84:87], v[180:183], v[240:243], v[84:87]
    v_mfma_f32_16x16x32_bf16 v[88:91], v[208:211], v[240:243], v[88:91]
    v_mfma_f32_16x16x32_bf16 v[92:95], v[212:215], v[240:243], v[92:95]
    v_mfma_f32_16x16x32_bf16 v[80:83], v[184:187], v[244:247], v[80:83]
    v_add_u32 v248, 0x9800, v248
    v_add_u32 v249, 0x9800, v249
    v_mfma_f32_16x16x32_bf16 v[84:87], v[188:191], v[244:247], v[84:87]
    v_mfma_f32_16x16x32_bf16 v[88:91], v[176:179], v[244:247], v[88:91]
    v_mfma_f32_16x16x32_bf16 v[92:95], v[180:183], v[244:247], v[92:95]
    s_waitcnt lgkmcnt(2)
    v_mfma_f32_16x16x32_bf16 v[96:99], v[176:179], v[216:219], v[96:99]
    ds_read_b128 v[232:235], v250 offset:24576
    ds_read_b128 v[236:239], v250 offset:35840
    v_mfma_f32_16x16x32_bf16 v[100:103], v[180:183], v[216:219], v[100:103]
    v_mfma_f32_16x16x32_bf16 v[104:107], v[208:211], v[216:219], v[104:107]
    v_mfma_f32_16x16x32_bf16 v[108:111], v[212:215], v[216:219], v[108:111]
    ds_read_b64_tr_b16 v[192:193], v248 offset:0
    ds_read_b64_tr_b16 v[194:195], v248 offset:1024
    ds_read_b64_tr_b16 v[196:197], v249 offset:0
    ds_read_b64_tr_b16 v[198:199], v249 offset:1024
    v_mfma_f32_16x16x32_bf16 v[96:99], v[184:187], v[220:223], v[96:99]
    v_mfma_f32_16x16x32_bf16 v[100:103], v[188:191], v[220:223], v[100:103]
    v_mfma_f32_16x16x32_bf16 v[104:107], v[176:179], v[220:223], v[104:107]
    v_mfma_f32_16x16x32_bf16 v[108:111], v[180:183], v[220:223], v[108:111]
    s_waitcnt lgkmcnt(6)
    v_mfma_f32_16x16x32_bf16 v[112:115], v[176:179], v[224:227], v[112:115]
    ds_read_b128 v[240:243], v250 offset:25600
    ds_read_b128 v[244:247], v250 offset:36864
    v_mfma_f32_16x16x32_bf16 v[116:119], v[180:183], v[224:227], v[116:119]
    v_mfma_f32_16x16x32_bf16 v[120:123], v[208:211], v[224:227], v[120:123]
    v_mfma_f32_16x16x32_bf16 v[124:127], v[212:215], v[224:227], v[124:127]
    ds_read_b64_tr_b16 v[200:201], v248 offset:8192
    ds_read_b64_tr_b16 v[202:203], v248 offset:9216
    ds_read_b64_tr_b16 v[204:205], v249 offset:8192
    ds_read_b64_tr_b16 v[206:207], v249 offset:9216
    v_mfma_f32_16x16x32_bf16 v[112:115], v[184:187], v[228:231], v[112:115]
    v_mfma_f32_16x16x32_bf16 v[116:119], v[188:191], v[228:231], v[116:119]
    v_mfma_f32_16x16x32_bf16 v[120:123], v[176:179], v[228:231], v[120:123]
    v_mfma_f32_16x16x32_bf16 v[124:127], v[180:183], v[228:231], v[124:127]
    s_waitcnt lgkmcnt(10)
    v_mfma_f32_16x16x32_bf16 v[128:131], v[176:179], v[232:235], v[128:131]
    ds_read_b128 v[216:219], v250 offset:26624
    ds_read_b128 v[220:223], v250 offset:37888
    v_mfma_f32_16x16x32_bf16 v[132:135], v[180:183], v[232:235], v[132:135]
    v_mfma_f32_16x16x32_bf16 v[136:139], v[208:211], v[232:235], v[136:139]
    v_mfma_f32_16x16x32_bf16 v[140:143], v[212:215], v[232:235], v[140:143]
    v_mfma_f32_16x16x32_bf16 v[128:131], v[184:187], v[236:239], v[128:131]
    v_mfma_f32_16x16x32_bf16 v[132:135], v[188:191], v[236:239], v[132:135]
    v_mfma_f32_16x16x32_bf16 v[136:139], v[176:179], v[236:239], v[136:139]
    v_mfma_f32_16x16x32_bf16 v[140:143], v[180:183], v[236:239], v[140:143]
    s_waitcnt lgkmcnt(6)
    v_mfma_f32_16x16x32_bf16 v[144:147], v[176:179], v[240:243], v[144:147]
    v_add_u32 v250, 0x9800, v250
    ds_read_b128 v[224:227], v250 offset:16384
    ds_read_b128 v[228:231], v250 offset:27648
    v_mfma_f32_16x16x32_bf16 v[148:151], v[180:183], v[240:243], v[148:151]
    v_mfma_f32_16x16x32_bf16 v[152:155], v[208:211], v[240:243], v[152:155]
    v_mfma_f32_16x16x32_bf16 v[156:159], v[212:215], v[240:243], v[156:159]
    v_mfma_f32_16x16x32_bf16 v[144:147], v[184:187], v[244:247], v[144:147]
    s_waitcnt lgkmcnt(4)
    v_xor_b32 v212, 0x80008000, v204
    v_xor_b32 v213, 0x80008000, v205
    v_mfma_f32_16x16x32_bf16 v[148:151], v[188:191], v[244:247], v[148:151]
    v_xor_b32 v214, 0x80008000, v206
    v_xor_b32 v215, 0x80008000, v207
    v_mfma_f32_16x16x32_bf16 v[152:155], v[176:179], v[244:247], v[152:155]
    v_mfma_f32_16x16x32_bf16 v[156:159], v[180:183], v[244:247], v[156:159]
    s_waitcnt lgkmcnt(2)
    v_mfma_f32_16x16x32_bf16 v[160:163], v[176:179], v[216:219], v[160:163]
    ds_read_b128 v[232:235], v250 offset:17408
    ds_read_b128 v[236:239], v250 offset:28672
    v_mfma_f32_16x16x32_bf16 v[164:167], v[208:211], v[216:219], v[164:167]
    v_xor_b32 v208, 0x80008000, v200
    v_xor_b32 v209, 0x80008000, v201
    v_mfma_f32_16x16x32_bf16 v[160:163], v[184:187], v[220:223], v[160:163]
    v_xor_b32 v210, 0x80008000, v202
    v_xor_b32 v211, 0x80008000, v203
    v_mfma_f32_16x16x32_bf16 v[164:167], v[176:179], v[220:223], v[164:167]
    s_barrier
    s_waitcnt lgkmcnt(2)
    v_mfma_f32_16x16x32_bf16 v[0:3], v[192:195], v[224:227], v[0:3]
    ds_read_b128 v[240:243], v250 offset:18432
    ds_read_b128 v[244:247], v250 offset:29696
    v_mfma_f32_16x16x32_bf16 v[4:7], v[196:199], v[224:227], v[4:7]
    v_mfma_f32_16x16x32_bf16 v[8:11], v[208:211], v[224:227], v[8:11]
    v_mfma_f32_16x16x32_bf16 v[12:15], v[212:215], v[224:227], v[12:15]
    v_mfma_f32_16x16x32_bf16 v[0:3], v[200:203], v[228:231], v[0:3]
    v_mfma_f32_16x16x32_bf16 v[4:7], v[204:207], v[228:231], v[4:7]
    v_mfma_f32_16x16x32_bf16 v[8:11], v[192:195], v[228:231], v[8:11]
    v_mfma_f32_16x16x32_bf16 v[12:15], v[196:199], v[228:231], v[12:15]
    s_waitcnt lgkmcnt(2)
    v_mfma_f32_16x16x32_bf16 v[16:19], v[192:195], v[232:235], v[16:19]
    ds_read_b128 v[216:219], v250 offset:19456
    ds_read_b128 v[220:223], v250 offset:30720
    v_mfma_f32_16x16x32_bf16 v[20:23], v[196:199], v[232:235], v[20:23]
    v_mfma_f32_16x16x32_bf16 v[24:27], v[208:211], v[232:235], v[24:27]
    v_mfma_f32_16x16x32_bf16 v[28:31], v[212:215], v[232:235], v[28:31]
    v_mfma_f32_16x16x32_bf16 v[16:19], v[200:203], v[236:239], v[16:19]
    v_mfma_f32_16x16x32_bf16 v[20:23], v[204:207], v[236:239], v[20:23]
    v_mfma_f32_16x16x32_bf16 v[24:27], v[192:195], v[236:239], v[24:27]
    v_mfma_f32_16x16x32_bf16 v[28:31], v[196:199], v[236:239], v[28:31]
    s_waitcnt lgkmcnt(2)
    v_mfma_f32_16x16x32_bf16 v[32:35], v[192:195], v[240:243], v[32:35]
    ds_read_b128 v[224:227], v250 offset:20480
    ds_read_b128 v[228:231], v250 offset:31744
    v_mfma_f32_16x16x32_bf16 v[36:39], v[196:199], v[240:243], v[36:39]
    v_mfma_f32_16x16x32_bf16 v[40:43], v[208:211], v[240:243], v[40:43]
    v_mfma_f32_16x16x32_bf16 v[44:47], v[212:215], v[240:243], v[44:47]
    v_mfma_f32_16x16x32_bf16 v[32:35], v[200:203], v[244:247], v[32:35]
    v_mfma_f32_16x16x32_bf16 v[36:39], v[204:207], v[244:247], v[36:39]
    v_mfma_f32_16x16x32_bf16 v[40:43], v[192:195], v[244:247], v[40:43]
    v_mfma_f32_16x16x32_bf16 v[44:47], v[196:199], v[244:247], v[44:47]
    s_waitcnt lgkmcnt(2)
    v_mfma_f32_16x16x32_bf16 v[48:51], v[192:195], v[216:219], v[48:51]
    ds_read_b128 v[232:235], v250 offset:21504
    ds_read_b128 v[236:239], v250 offset:32768
    v_mfma_f32_16x16x32_bf16 v[52:55], v[196:199], v[216:219], v[52:55]
    v_mfma_f32_16x16x32_bf16 v[56:59], v[208:211], v[216:219], v[56:59]
    v_mfma_f32_16x16x32_bf16 v[60:63], v[212:215], v[216:219], v[60:63]
    v_mfma_f32_16x16x32_bf16 v[48:51], v[200:203], v[220:223], v[48:51]
    v_mfma_f32_16x16x32_bf16 v[52:55], v[204:207], v[220:223], v[52:55]
    v_mfma_f32_16x16x32_bf16 v[56:59], v[192:195], v[220:223], v[56:59]
    v_mfma_f32_16x16x32_bf16 v[60:63], v[196:199], v[220:223], v[60:63]
    s_waitcnt lgkmcnt(2)
    v_mfma_f32_16x16x32_bf16 v[64:67], v[192:195], v[224:227], v[64:67]
    ds_read_b128 v[240:243], v250 offset:22528
    ds_read_b128 v[244:247], v250 offset:33792
    v_mfma_f32_16x16x32_bf16 v[68:71], v[196:199], v[224:227], v[68:71]
    v_mfma_f32_16x16x32_bf16 v[72:75], v[208:211], v[224:227], v[72:75]
    v_mfma_f32_16x16x32_bf16 v[76:79], v[212:215], v[224:227], v[76:79]
    v_mfma_f32_16x16x32_bf16 v[64:67], v[200:203], v[228:231], v[64:67]
    v_mfma_f32_16x16x32_bf16 v[68:71], v[204:207], v[228:231], v[68:71]
    v_mfma_f32_16x16x32_bf16 v[72:75], v[192:195], v[228:231], v[72:75]
    v_mfma_f32_16x16x32_bf16 v[76:79], v[196:199], v[228:231], v[76:79]
    s_waitcnt lgkmcnt(2)
    v_mfma_f32_16x16x32_bf16 v[80:83], v[192:195], v[232:235], v[80:83]
    ds_read_b128 v[216:219], v250 offset:23552
    ds_read_b128 v[220:223], v250 offset:34816
    v_mfma_f32_16x16x32_bf16 v[84:87], v[196:199], v[232:235], v[84:87]
    v_mfma_f32_16x16x32_bf16 v[88:91], v[208:211], v[232:235], v[88:91]
    v_mfma_f32_16x16x32_bf16 v[92:95], v[212:215], v[232:235], v[92:95]
    v_mfma_f32_16x16x32_bf16 v[80:83], v[200:203], v[236:239], v[80:83]
    v_add_u32 v248, 0xfffe3800, v248
    v_add_u32 v249, 0xfffe3800, v249
    v_mfma_f32_16x16x32_bf16 v[84:87], v[204:207], v[236:239], v[84:87]
    v_mfma_f32_16x16x32_bf16 v[88:91], v[192:195], v[236:239], v[88:91]
    v_mfma_f32_16x16x32_bf16 v[92:95], v[196:199], v[236:239], v[92:95]
    s_waitcnt lgkmcnt(2)
    v_mfma_f32_16x16x32_bf16 v[96:99], v[192:195], v[240:243], v[96:99]
    ds_read_b128 v[224:227], v250 offset:24576
    ds_read_b128 v[228:231], v250 offset:35840
    v_mfma_f32_16x16x32_bf16 v[100:103], v[196:199], v[240:243], v[100:103]
    v_mfma_f32_16x16x32_bf16 v[104:107], v[208:211], v[240:243], v[104:107]
    v_mfma_f32_16x16x32_bf16 v[108:111], v[212:215], v[240:243], v[108:111]
    ds_read_b64_tr_b16 v[176:177], v248 offset:0
    ds_read_b64_tr_b16 v[178:179], v248 offset:1024
    ds_read_b64_tr_b16 v[180:181], v249 offset:0
    ds_read_b64_tr_b16 v[182:183], v249 offset:1024
    v_mfma_f32_16x16x32_bf16 v[96:99], v[200:203], v[244:247], v[96:99]
    v_mfma_f32_16x16x32_bf16 v[100:103], v[204:207], v[244:247], v[100:103]
    v_mfma_f32_16x16x32_bf16 v[104:107], v[192:195], v[244:247], v[104:107]
    v_mfma_f32_16x16x32_bf16 v[108:111], v[196:199], v[244:247], v[108:111]
    s_waitcnt lgkmcnt(6)
    v_mfma_f32_16x16x32_bf16 v[112:115], v[192:195], v[216:219], v[112:115]
    ds_read_b128 v[232:235], v250 offset:25600
    ds_read_b128 v[236:239], v250 offset:36864
    v_mfma_f32_16x16x32_bf16 v[116:119], v[196:199], v[216:219], v[116:119]
    v_mfma_f32_16x16x32_bf16 v[120:123], v[208:211], v[216:219], v[120:123]
    v_mfma_f32_16x16x32_bf16 v[124:127], v[212:215], v[216:219], v[124:127]
    ds_read_b64_tr_b16 v[184:185], v248 offset:8192
    ds_read_b64_tr_b16 v[186:187], v248 offset:9216
    ds_read_b64_tr_b16 v[188:189], v249 offset:8192
    ds_read_b64_tr_b16 v[190:191], v249 offset:9216
    v_mfma_f32_16x16x32_bf16 v[112:115], v[200:203], v[220:223], v[112:115]
    v_mfma_f32_16x16x32_bf16 v[116:119], v[204:207], v[220:223], v[116:119]
    v_mfma_f32_16x16x32_bf16 v[120:123], v[192:195], v[220:223], v[120:123]
    v_mfma_f32_16x16x32_bf16 v[124:127], v[196:199], v[220:223], v[124:127]
    s_waitcnt lgkmcnt(10)
    v_mfma_f32_16x16x32_bf16 v[128:131], v[192:195], v[224:227], v[128:131]
    ds_read_b128 v[240:243], v250 offset:26624
    ds_read_b128 v[244:247], v250 offset:37888
    v_mfma_f32_16x16x32_bf16 v[132:135], v[196:199], v[224:227], v[132:135]
    v_mfma_f32_16x16x32_bf16 v[136:139], v[208:211], v[224:227], v[136:139]
    v_mfma_f32_16x16x32_bf16 v[140:143], v[212:215], v[224:227], v[140:143]
    v_mfma_f32_16x16x32_bf16 v[128:131], v[200:203], v[228:231], v[128:131]
    v_mfma_f32_16x16x32_bf16 v[132:135], v[204:207], v[228:231], v[132:135]
    v_mfma_f32_16x16x32_bf16 v[136:139], v[192:195], v[228:231], v[136:139]
    v_mfma_f32_16x16x32_bf16 v[140:143], v[196:199], v[228:231], v[140:143]
    s_waitcnt lgkmcnt(6)
    v_mfma_f32_16x16x32_bf16 v[144:147], v[192:195], v[232:235], v[144:147]
    v_add_u32 v250, 0xfffe3800, v250
    ds_read_b128 v[216:219], v250 offset:16384
    ds_read_b128 v[220:223], v250 offset:27648
    v_mfma_f32_16x16x32_bf16 v[148:151], v[196:199], v[232:235], v[148:151]
    v_mfma_f32_16x16x32_bf16 v[152:155], v[208:211], v[232:235], v[152:155]
    v_mfma_f32_16x16x32_bf16 v[156:159], v[212:215], v[232:235], v[156:159]
    v_mfma_f32_16x16x32_bf16 v[144:147], v[200:203], v[236:239], v[144:147]
    s_waitcnt lgkmcnt(4)
    v_xor_b32 v212, 0x80008000, v188
    v_xor_b32 v213, 0x80008000, v189
    v_mfma_f32_16x16x32_bf16 v[148:151], v[204:207], v[236:239], v[148:151]
    v_xor_b32 v214, 0x80008000, v190
    v_xor_b32 v215, 0x80008000, v191
    v_mfma_f32_16x16x32_bf16 v[152:155], v[192:195], v[236:239], v[152:155]
    v_mfma_f32_16x16x32_bf16 v[156:159], v[196:199], v[236:239], v[156:159]
    s_waitcnt lgkmcnt(2)
    v_mfma_f32_16x16x32_bf16 v[160:163], v[192:195], v[240:243], v[160:163]
    ds_read_b128 v[224:227], v250 offset:17408
    ds_read_b128 v[228:231], v250 offset:28672
    v_mfma_f32_16x16x32_bf16 v[164:167], v[208:211], v[240:243], v[164:167]
    v_xor_b32 v208, 0x80008000, v184
    v_xor_b32 v209, 0x80008000, v185
    v_mfma_f32_16x16x32_bf16 v[160:163], v[200:203], v[244:247], v[160:163]
    v_xor_b32 v210, 0x80008000, v186
    v_xor_b32 v211, 0x80008000, v187
    v_mfma_f32_16x16x32_bf16 v[164:167], v[192:195], v[244:247], v[164:167]
    s_sub_u32 s46, s46, 1
    s_cmp_lg_u32 s46, 0
    s_cbranch_scc1 L_g_loop
    s_barrier
    s_waitcnt lgkmcnt(2)
    v_mfma_f32_16x16x32_bf16 v[0:3], v[176:179], v[216:219], v[0:3]
    ds_read_b128 v[232:235], v250 offset:18432
    ds_read_b128 v[236:239], v250 offset:29696
    v_mfma_f32_16x16x32_bf16 v[4:7], v[180:183], v[216:219], v[4:7]
    v_mfma_f32_16x16x32_bf16 v[8:11], v[208:211], v[216:219], v[8:11]
    v_mfma_f32_16x16x32_bf16 v[12:15], v[212:215], v[216:219], v[12:15]
    v_mfma_f32_16x16x32_bf16 v[0:3], v[184:187], v[220:223], v[0:3]
    v_mfma_f32_16x16x32_bf16 v[4:7], v[188:191], v[220:223], v[4:7]
    v_mfma_f32_16x16x32_bf16 v[8:11], v[176:179], v[220:223], v[8:11]
    v_mfma_f32_16x16x32_bf16 v[12:15], v[180:183], v[220:223], v[12:15]
    s_waitcnt lgkmcnt(2)
    v_mfma_f32_16x16x32_bf16 v[16:19], v[176:179], v[224:227], v[16:19]
    ds_read_b128 v[240:243], v250 offset:19456
    ds_read_b128 v[244:247], v250 offset:30720
    v_mfma_f32_16x16x32_bf16 v[20:23], v[180:183], v[224:227], v[20:23]
    v_mfma_f32_16x16x32_bf16 v[24:27], v[208:211], v[224:227], v[24:27]
    v_mfma_f32_16x16x32_bf16 v[28:31], v[212:215], v[224:227], v[28:31]
    v_mfma_f32_16x16x32_bf16 v[16:19], v[184:187], v[228:231], v[16:19]
    v_mfma_f32_16x16x32_bf16 v[20:23], v[188:191], v[228:231], v[20:23]
    v_mfma_f32_16x16x32_bf16 v[24:27], v[176:179], v[228:231], v[24:27]
    v_mfma_f32_16x16x32_bf16 v[28:31], v[180:183], v[228:231], v[28:31]
    s_waitcnt lgkmcnt(2)
    v_mfma_f32_16x16x32_bf16 v[32:35], v[176:179], v[232:235], v[32:35]
    ds_read_b128 v[216:219], v250 offset:20480
    ds_read_b128 v[220:223], v250 offset:31744
    v_mfma_f32_16x16x32_bf16 v[36:39], v[180:183], v[232:235], v[36:39]
    v_mfma_f32_16x16x32_bf16 v[40:43], v[208:211], v[232:235], v[40:43]
    v_mfma_f32_16x16x32_bf16 v[44:47], v[212:215], v[232:235], v[44:47]
    v_mfma_f32_16x16x32_bf16 v[32:35], v[184:187], v[236:239], v[32:35]
    v_mfma_f32_16x16x32_bf16 v[36:39], v[188:191], v[236:239], v[36:39]
    v_mfma_f32_16x16x32_bf16 v[40:43], v[176:179], v[236:239], v[40:43]
    v_mfma_f32_16x16x32_bf16 v[44:47], v[180:183], v[236:239], v[44:47]
    s_waitcnt lgkmcnt(2)
    v_mfma_f32_16x16x32_bf16 v[48:51], v[176:179], v[240:243], v[48:51]
    ds_read_b128 v[224:227], v250 offset:21504
    ds_read_b128 v[228:231], v250 offset:32768
    v_mfma_f32_16x16x32_bf16 v[52:55], v[180:183], v[240:243], v[52:55]
    v_mfma_f32_16x16x32_bf16 v[56:59], v[208:211], v[240:243], v[56:59]
    v_mfma_f32_16x16x32_bf16 v[60:63], v[212:215], v[240:243], v[60:63]
    v_mfma_f32_16x16x32_bf16 v[48:51], v[184:187], v[244:247], v[48:51]
    v_mfma_f32_16x16x32_bf16 v[52:55], v[188:191], v[244:247], v[52:55]
    v_mfma_f32_16x16x32_bf16 v[56:59], v[176:179], v[244:247], v[56:59]
    v_mfma_f32_16x16x32_bf16 v[60:63], v[180:183], v[244:247], v[60:63]
    s_waitcnt lgkmcnt(2)
    v_mfma_f32_16x16x32_bf16 v[64:67], v[176:179], v[216:219], v[64:67]
    ds_read_b128 v[232:235], v250 offset:22528
    ds_read_b128 v[236:239], v250 offset:33792
    v_mfma_f32_16x16x32_bf16 v[68:71], v[180:183], v[216:219], v[68:71]
    v_mfma_f32_16x16x32_bf16 v[72:75], v[208:211], v[216:219], v[72:75]
    v_mfma_f32_16x16x32_bf16 v[76:79], v[212:215], v[216:219], v[76:79]
    v_mfma_f32_16x16x32_bf16 v[64:67], v[184:187], v[220:223], v[64:67]
    v_mfma_f32_16x16x32_bf16 v[68:71], v[188:191], v[220:223], v[68:71]
    v_mfma_f32_16x16x32_bf16 v[72:75], v[176:179], v[220:223], v[72:75]
    v_mfma_f32_16x16x32_bf16 v[76:79], v[180:183], v[220:223], v[76:79]
    s_waitcnt lgkmcnt(2)
    v_mfma_f32_16x16x32_bf16 v[80:83], v[176:179], v[224:227], v[80:83]
    ds_read_b128 v[240:243], v250 offset:23552
    ds_read_b128 v[244:247], v250 offset:34816
    v_mfma_f32_16x16x32_bf16 v[84:87], v[180:183], v[224:227], v[84:87]
    v_mfma_f32_16x16x32_bf16 v[88:91], v[208:211], v[224:227], v[88:91]
    v_mfma_f32_16x16x32_bf16 v[92:95], v[212:215], v[224:227], v[92:95]
    v_mfma_f32_16x16x32_bf16 v[80:83], v[184:187], v[228:231], v[80:83]
    v_add_u32 v248, 0x9800, v248
    v_add_u32 v249, 0x9800, v249
    v_mfma_f32_16x16x32_bf16 v[84:87], v[188:191], v[228:231], v[84:87]
    v_mfma_f32_16x16x32_bf16 v[88:91], v[176:179], v[228:231], v[88:91]
    v_mfma_f32_16x16x32_bf16 v[92:95], v[180:183], v[228:231], v[92:95]
    s_waitcnt lgkmcnt(2)
    v_mfma_f32_16x16x32_bf16 v[96:99], v[176:179], v[232:235], v[96:99]
    ds_read_b128 v[216:219], v250 offset:24576
    ds_read_b128 v[220:223], v250 offset:35840
    v_mfma_f32_16x16x32_bf16 v[100:103], v[180:183], v[232:235], v[100:103]
    v_mfma_f32_16x16x32_bf16 v[104:107], v[208:211], v[232:235], v[104:107]
    v_mfma_f32_16x16x32_bf16 v[108:111], v[212:215], v[232:235], v[108:111]
    ds_read_b64_tr_b16 v[192:193], v248 offset:0
    ds_read_b64_tr_b16 v[194:195], v248 offset:1024
    ds_read_b64_tr_b16 v[196:197], v249 offset:0
    ds_read_b64_tr_b16 v[198:199], v249 offset:1024
    v_mfma_f32_16x16x32_bf16 v[96:99], v[184:187], v[236:239], v[96:99]
    v_mfma_f32_16x16x32_bf16 v[100:103], v[188:191], v[236:239], v[100:103]
    v_mfma_f32_16x16x32_bf16 v[104:107], v[176:179], v[236:239], v[104:107]
    v_mfma_f32_16x16x32_bf16 v[108:111], v[180:183], v[236:239], v[108:111]
    s_waitcnt lgkmcnt(6)
    v_mfma_f32_16x16x32_bf16 v[112:115], v[176:179], v[240:243], v[112:115]
    ds_read_b128 v[224:227], v250 offset:25600
    ds_read_b128 v[228:231], v250 offset:36864
    v_mfma_f32_16x16x32_bf16 v[116:119], v[180:183], v[240:243], v[116:119]
    v_mfma_f32_16x16x32_bf16 v[120:123], v[208:211], v[240:243], v[120:123]
    v_mfma_f32_16x16x32_bf16 v[124:127], v[212:215], v[240:243], v[124:127]
    ds_read_b64_tr_b16 v[200:201], v248 offset:8192
    ds_read_b64_tr_b16 v[202:203], v248 offset:9216
    ds_read_b64_tr_b16 v[204:205], v249 offset:8192
    ds_read_b64_tr_b16 v[206:207], v249 offset:9216
    v_mfma_f32_16x16x32_bf16 v[112:115], v[184:187], v[244:247], v[112:115]
    v_mfma_f32_16x16x32_bf16 v[116:119], v[188:191], v[244:247], v[116:119]
    v_mfma_f32_16x16x32_bf16 v[120:123], v[176:179], v[244:247], v[120:123]
    v_mfma_f32_16x16x32_bf16 v[124:127], v[180:183], v[244:247], v[124:127]
    s_waitcnt lgkmcnt(10)
    v_mfma_f32_16x16x32_bf16 v[128:131], v[176:179], v[216:219], v[128:131]
    ds_read_b128 v[232:235], v250 offset:26624
    ds_read_b128 v[236:239], v250 offset:37888
    v_mfma_f32_16x16x32_bf16 v[132:135], v[180:183], v[216:219], v[132:135]
    v_mfma_f32_16x16x32_bf16 v[136:139], v[208:211], v[216:219], v[136:139]
    v_mfma_f32_16x16x32_bf16 v[140:143], v[212:215], v[216:219], v[140:143]
    v_mfma_f32_16x16x32_bf16 v[128:131], v[184:187], v[220:223], v[128:131]
    v_mfma_f32_16x16x32_bf16 v[132:135], v[188:191], v[220:223], v[132:135]
    v_mfma_f32_16x16x32_bf16 v[136:139], v[176:179], v[220:223], v[136:139]
    v_mfma_f32_16x16x32_bf16 v[140:143], v[180:183], v[220:223], v[140:143]
    s_waitcnt lgkmcnt(6)
    v_mfma_f32_16x16x32_bf16 v[144:147], v[176:179], v[224:227], v[144:147]
    v_add_u32 v250, 0x9800, v250
    ds_read_b128 v[240:243], v250 offset:16384
    ds_read_b128 v[244:247], v250 offset:27648
    v_mfma_f32_16x16x32_bf16 v[148:151], v[180:183], v[224:227], v[148:151]
    v_mfma_f32_16x16x32_bf16 v[152:155], v[208:211], v[224:227], v[152:155]
    v_mfma_f32_16x16x32_bf16 v[156:159], v[212:215], v[224:227], v[156:159]
    v_mfma_f32_16x16x32_bf16 v[144:147], v[184:187], v[228:231], v[144:147]
    s_waitcnt lgkmcnt(4)
    v_xor_b32 v212, 0x80008000, v204
    v_xor_b32 v213, 0x80008000, v205
    v_mfma_f32_16x16x32_bf16 v[148:151], v[188:191], v[228:231], v[148:151]
    v_xor_b32 v214, 0x80008000, v206
    v_xor_b32 v215, 0x80008000, v207
    v_mfma_f32_16x16x32_bf16 v[152:155], v[176:179], v[228:231], v[152:155]
    v_mfma_f32_16x16x32_bf16 v[156:159], v[180:183], v[228:231], v[156:159]
    s_waitcnt lgkmcnt(2)
    v_mfma_f32_16x16x32_bf16 v[160:163], v[176:179], v[232:235], v[160:163]
    ds_read_b128 v[216:219], v250 offset:17408
    ds_read_b128 v[220:223], v250 offset:28672
    v_mfma_f32_16x16x32_bf16 v[164:167], v[208:211], v[232:235], v[164:167]
    v_xor_b32 v208, 0x80008000, v200
    v_xor_b32 v209, 0x80008000, v201
    v_mfma_f32_16x16x32_bf16 v[160:163], v[184:187], v[236:239], v[160:163]
    v_xor_b32 v210, 0x80008000, v202
    v_xor_b32 v211, 0x80008000, v203
    v_mfma_f32_16x16x32_bf16 v[164:167], v[176:179], v[236:239], v[164:167]
    s_barrier
    s_waitcnt lgkmcnt(2)
    v_mfma_f32_16x16x32_bf16 v[0:3], v[192:195], v[240:243], v[0:3]
    ds_read_b128 v[224:227], v250 offset:18432
    ds_read_b128 v[228:231], v250 offset:29696
    v_mfma_f32_16x16x32_bf16 v[4:7], v[196:199], v[240:243], v[4:7]
    v_mfma_f32_16x16x32_bf16 v[8:11], v[208:211], v[240:243], v[8:11]
    v_mfma_f32_16x16x32_bf16 v[12:15], v[212:215], v[240:243], v[12:15]
    v_mfma_f32_16x16x32_bf16 v[0:3], v[200:203], v[244:247], v[0:3]
    v_mfma_f32_16x16x32_bf16 v[4:7], v[204:207], v[244:247], v[4:7]
    v_mfma_f32_16x16x32_bf16 v[8:11], v[192:195], v[244:247], v[8:11]
    v_mfma_f32_16x16x32_bf16 v[12:15], v[196:199], v[244:247], v[12:15]
    s_waitcnt lgkmcnt(2)
    v_mfma_f32_16x16x32_bf16 v[16:19], v[192:195], v[216:219], v[16:19]
    ds_read_b128 v[232:235], v250 offset:19456
    ds_read_b128 v[236:239], v250 offset:30720
    v_mfma_f32_16x16x32_bf16 v[20:23], v[196:199], v[216:219], v[20:23]
    v_mfma_f32_16x16x32_bf16 v[24:27], v[208:211], v[216:219], v[24:27]
    v_mfma_f32_16x16x32_bf16 v[28:31], v[212:215], v[216:219], v[28:31]
    v_mfma_f32_16x16x32_bf16 v[16:19], v[200:203], v[220:223], v[16:19]
    v_mfma_f32_16x16x32_bf16 v[20:23], v[204:207], v[220:223], v[20:23]
    v_mfma_f32_16x16x32_bf16 v[24:27], v[192:195], v[220:223], v[24:27]
    v_mfma_f32_16x16x32_bf16 v[28:31], v[196:199], v[220:223], v[28:31]
    s_waitcnt lgkmcnt(2)
    v_mfma_f32_16x16x32_bf16 v[32:35], v[192:195], v[224:227], v[32:35]
    ds_read_b128 v[240:243], v250 offset:20480
    ds_read_b128 v[244:247], v250 offset:31744
    v_mfma_f32_16x16x32_bf16 v[36:39], v[196:199], v[224:227], v[36:39]
    v_mfma_f32_16x16x32_bf16 v[40:43], v[208:211], v[224:227], v[40:43]
    v_mfma_f32_16x16x32_bf16 v[44:47], v[212:215], v[224:227], v[44:47]
    v_mfma_f32_16x16x32_bf16 v[32:35], v[200:203], v[228:231], v[32:35]
    v_mfma_f32_16x16x32_bf16 v[36:39], v[204:207], v[228:231], v[36:39]
    v_mfma_f32_16x16x32_bf16 v[40:43], v[192:195], v[228:231], v[40:43]
    v_mfma_f32_16x16x32_bf16 v[44:47], v[196:199], v[228:231], v[44:47]
    s_waitcnt lgkmcnt(2)
    v_mfma_f32_16x16x32_bf16 v[48:51], v[192:195], v[232:235], v[48:51]
    ds_read_b128 v[216:219], v250 offset:21504
    ds_read_b128 v[220:223], v250 offset:32768
    v_mfma_f32_16x16x32_bf16 v[52:55], v[196:199], v[232:235], v[52:55]
    v_mfma_f32_16x16x32_bf16 v[56:59], v[208:211], v[232:235], v[56:59]
    v_mfma_f32_16x16x32_bf16 v[60:63], v[212:215], v[232:235], v[60:63]
    v_mfma_f32_16x16x32_bf16 v[48:51], v[200:203], v[236:239], v[48:51]
    v_mfma_f32_16x16x32_bf16 v[52:55], v[204:207], v[236:239], v[52:55]
    v_mfma_f32_16x16x32_bf16 v[56:59], v[192:195], v[236:239], v[56:59]
    v_mfma_f32_16x16x32_bf16 v[60:63], v[196:199], v[236:239], v[60:63]
    s_waitcnt lgkmcnt(2)
    v_mfma_f32_16x16x32_bf16 v[64:67], v[192:195], v[240:243], v[64:67]
    ds_read_b128 v[224:227], v250 offset:22528
    ds_read_b128 v[228:231], v250 offset:33792
    v_mfma_f32_16x16x32_bf16 v[68:71], v[196:199], v[240:243], v[68:71]
    v_mfma_f32_16x16x32_bf16 v[72:75], v[208:211], v[240:243], v[72:75]
    v_mfma_f32_16x16x32_bf16 v[76:79], v[212:215], v[240:243], v[76:79]
    v_mfma_f32_16x16x32_bf16 v[64:67], v[200:203], v[244:247], v[64:67]
    v_mfma_f32_16x16x32_bf16 v[68:71], v[204:207], v[244:247], v[68:71]
    v_mfma_f32_16x16x32_bf16 v[72:75], v[192:195], v[244:247], v[72:75]
    v_mfma_f32_16x16x32_bf16 v[76:79], v[196:199], v[244:247], v[76:79]
    s_waitcnt lgkmcnt(2)
    v_mfma_f32_16x16x32_bf16 v[80:83], v[192:195], v[216:219], v[80:83]
    ds_read_b128 v[232:235], v250 offset:23552
    ds_read_b128 v[236:239], v250 offset:34816
    v_mfma_f32_16x16x32_bf16 v[84:87], v[196:199], v[216:219], v[84:87]
    v_mfma_f32_16x16x32_bf16 v[88:91], v[208:211], v[216:219], v[88:91]
    v_mfma_f32_16x16x32_bf16 v[92:95], v[212:215], v[216:219], v[92:95]
    v_mfma_f32_16x16x32_bf16 v[80:83], v[200:203], v[220:223], v[80:83]
    v_add_u32 v248, 0x9800, v248
    v_add_u32 v249, 0x9800, v249
    v_mfma_f32_16x16x32_bf16 v[84:87], v[204:207], v[220:223], v[84:87]
    v_mfma_f32_16x16x32_bf16 v[88:91], v[192:195], v[220:223], v[88:91]
    v_mfma_f32_16x16x32_bf16 v[92:95], v[196:199], v[220:223], v[92:95]
    s_waitcnt lgkmcnt(2)
    v_mfma_f32_16x16x32_bf16 v[96:99], v[192:195], v[224:227], v[96:99]
    ds_read_b128 v[240:243], v250 offset:24576
    ds_read_b128 v[244:247], v250 offset:35840
    v_mfma_f32_16x16x32_bf16 v[100:103], v[196:199], v[224:227], v[100:103]
    v_mfma_f32_16x16x32_bf16 v[104:107], v[208:211], v[224:227], v[104:107]
    v_mfma_f32_16x16x32_bf16 v[108:111], v[212:215], v[224:227], v[108:111]
    ds_read_b64_tr_b16 v[176:177], v248 offset:0
    ds_read_b64_tr_b16 v[178:179], v248 offset:1024
    ds_read_b64_tr_b16 v[180:181], v249 offset:0
    ds_read_b64_tr_b16 v[182:183], v249 offset:1024
    v_mfma_f32_16x16x32_bf16 v[96:99], v[200:203], v[228:231], v[96:99]
    v_mfma_f32_16x16x32_bf16 v[100:103], v[204:207], v[228:231], v[100:103]
    v_mfma_f32_16x16x32_bf16 v[104:107], v[192:195], v[228:231], v[104:107]
    v_mfma_f32_16x16x32_bf16 v[108:111], v[196:199], v[228:231], v[108:111]
    s_waitcnt lgkmcnt(6)
    v_mfma_f32_16x16x32_bf16 v[112:115], v[192:195], v[232:235], v[112:115]
    ds_read_b128 v[216:219], v250 offset:25600
    ds_read_b128 v[220:223], v250 offset:36864
    v_mfma_f32_16x16x32_bf16 v[116:119], v[196:199], v[232:235], v[116:119]
    v_mfma_f32_16x16x32_bf16 v[120:123], v[208:211], v[232:235], v[120:123]
    v_mfma_f32_16x16x32_bf16 v[124:127], v[212:215], v[232:235], v[124:127]
    ds_read_b64_tr_b16 v[184:185], v248 offset:8192
    ds_read_b64_tr_b16 v[186:187], v248 offset:9216
    ds_read_b64_tr_b16 v[188:189], v249 offset:8192
    ds_read_b64_tr_b16 v[190:191], v249 offset:9216
    v_mfma_f32_16x16x32_bf16 v[112:115], v[200:203], v[236:239], v[112:115]
    v_mfma_f32_16x16x32_bf16 v[116:119], v[204:207], v[236:239], v[116:119]
    v_mfma_f32_16x16x32_bf16 v[120:123], v[192:195], v[236:239], v[120:123]
    v_mfma_f32_16x16x32_bf16 v[124:127], v[196:199], v[236:239], v[124:127]
    s_waitcnt lgkmcnt(10)
    v_mfma_f32_16x16x32_bf16 v[128:131], v[192:195], v[240:243], v[128:131]
    ds_read_b128 v[224:227], v250 offset:26624
    ds_read_b128 v[228:231], v250 offset:37888
    v_mfma_f32_16x16x32_bf16 v[132:135], v[196:199], v[240:243], v[132:135]
    v_mfma_f32_16x16x32_bf16 v[136:139], v[208:211], v[240:243], v[136:139]
    v_mfma_f32_16x16x32_bf16 v[140:143], v[212:215], v[240:243], v[140:143]
    v_mfma_f32_16x16x32_bf16 v[128:131], v[200:203], v[244:247], v[128:131]
    v_mfma_f32_16x16x32_bf16 v[132:135], v[204:207], v[244:247], v[132:135]
    v_mfma_f32_16x16x32_bf16 v[136:139], v[192:195], v[244:247], v[136:139]
    v_mfma_f32_16x16x32_bf16 v[140:143], v[196:199], v[244:247], v[140:143]
    s_waitcnt lgkmcnt(6)
    v_mfma_f32_16x16x32_bf16 v[144:147], v[192:195], v[216:219], v[144:147]
    v_add_u32 v250, 0x9800, v250
    ds_read_b128 v[232:235], v250 offset:16384
    ds_read_b128 v[236:239], v250 offset:27648
    v_mfma_f32_16x16x32_bf16 v[148:151], v[196:199], v[216:219], v[148:151]
    v_mfma_f32_16x16x32_bf16 v[152:155], v[208:211], v[216:219], v[152:155]
    v_mfma_f32_16x16x32_bf16 v[156:159], v[212:215], v[216:219], v[156:159]
    v_mfma_f32_16x16x32_bf16 v[144:147], v[200:203], v[220:223], v[144:147]
    s_waitcnt lgkmcnt(4)
    v_xor_b32 v212, 0x80008000, v188
    v_xor_b32 v213, 0x80008000, v189
    v_mfma_f32_16x16x32_bf16 v[148:151], v[204:207], v[220:223], v[148:151]
    v_xor_b32 v214, 0x80008000, v190
    v_xor_b32 v215, 0x80008000, v191
    v_mfma_f32_16x16x32_bf16 v[152:155], v[192:195], v[220:223], v[152:155]
    v_mfma_f32_16x16x32_bf16 v[156:159], v[196:199], v[220:223], v[156:159]
    s_waitcnt lgkmcnt(2)
    v_mfma_f32_16x16x32_bf16 v[160:163], v[192:195], v[224:227], v[160:163]
    ds_read_b128 v[240:243], v250 offset:17408
    ds_read_b128 v[244:247], v250 offset:28672
    v_mfma_f32_16x16x32_bf16 v[164:167], v[208:211], v[224:227], v[164:167]
    v_xor_b32 v208, 0x80008000, v184
    v_xor_b32 v209, 0x80008000, v185
    v_mfma_f32_16x16x32_bf16 v[160:163], v[200:203], v[228:231], v[160:163]
    v_xor_b32 v210, 0x80008000, v186
    v_xor_b32 v211, 0x80008000, v187
    v_mfma_f32_16x16x32_bf16 v[164:167], v[192:195], v[228:231], v[164:167]
    s_barrier
    s_cmp_lg_u32 s13, 0
    s_cbranch_scc1 L_epi_b1
    v_add_u32 v248, 0x9800, v248
    v_add_u32 v249, 0x9800, v249
    v_add_u32 v253, 38912, v250
    ds_read_b64_tr_b16 v[192:193], v248 offset:0
    ds_read_b64_tr_b16 v[194:195], v248 offset:1024
    ds_read_b64_tr_b16 v[196:197], v249 offset:0
    ds_read_b64_tr_b16 v[198:199], v249 offset:1024
    ds_read_b64_tr_b16 v[200:201], v248 offset:8192
    ds_read_b64_tr_b16 v[202:203], v248 offset:9216
    ds_read_b64_tr_b16 v[204:205], v249 offset:8192
    ds_read_b64_tr_b16 v[206:207], v249 offset:9216
    s_waitcnt lgkmcnt(10)
    v_mfma_f32_16x16x32_bf16 v[0:3], v[176:179], v[232:235], v[0:3]
    ds_read_b128 v[216:219], v250 offset:18432
    ds_read_b128 v[220:223], v250 offset:29696
    v_mfma_f32_16x16x32_bf16 v[4:7], v[180:183], v[232:235], v[4:7]
    v_mfma_f32_16x16x32_bf16 v[8:11], v[208:211], v[232:235], v[8:11]
    v_mfma_f32_16x16x32_bf16 v[12:15], v[212:215], v[232:235], v[12:15]
    v_mfma_f32_16x16x32_bf16 v[0:3], v[184:187], v[236:239], v[0:3]
    v_mfma_f32_16x16x32_bf16 v[4:7], v[188:191], v[236:239], v[4:7]
    v_mfma_f32_16x16x32_bf16 v[8:11], v[176:179], v[236:239], v[8:11]
    v_mfma_f32_16x16x32_bf16 v[12:15], v[180:183], v[236:239], v[12:15]
    s_waitcnt lgkmcnt(10)
    v_mfma_f32_16x16x32_bf16 v[16:19], v[176:179], v[240:243], v[16:19]
    ds_read_b128 v[224:227], v253 offset:16384
    ds_read_b128 v[228:231], v253 offset:27648
    v_mfma_f32_16x16x32_bf16 v[20:23], v[180:183], v[240:243], v[20:23]
    v_mfma_f32_16x16x32_bf16 v[24:27], v[208:211], v[240:243], v[24:27]
    v_mfma_f32_16x16x32_bf16 v[28:31], v[212:215], v[240:243], v[28:31]
    v_mfma_f32_16x16x32_bf16 v[16:19], v[184:187], v[244:247], v[16:19]
    v_mfma_f32_16x16x32_bf16 v[20:23], v[188:191], v[244:247], v[20:23]
    v_mfma_f32_16x16x32_bf16 v[24:27], v[176:179], v[244:247], v[24:27]
    v_mfma_f32_16x16x32_bf16 v[28:31], v[180:183], v[244:247], v[28:31]
    s_waitcnt lgkmcnt(2)
    v_mfma_f32_16x16x32_bf16 v[32:35], v[176:179], v[216:219], v[32:35]
    ds_read_b128 v[232:235], v250 offset:19456
    ds_read_b128 v[236:239], v250 offset:30720
    v_mfma_f32_16x16x32_bf16 v[36:39], v[180:183], v[216:219], v[36:39]
    v_mfma_f32_16x16x32_bf16 v[40:43], v[208:211], v[216:219], v[40:43]
    v_mfma_f32_16x16x32_bf16 v[44:47], v[212:215], v[216:219], v[44:47]
    v_mfma_f32_16x16x32_bf16 v[32:35], v[184:187], v[220:223], v[32:35]
    v_mfma_f32_16x16x32_bf16 v[36:39], v[188:191], v[220:223], v[36:39]
    v_mfma_f32_16x16x32_bf16 v[40:43], v[176:179], v[220:223], v[40:43]
    v_mfma_f32_16x16x32_bf16 v[44:47], v[180:183], v[220:223], v[44:47]
    v_xor_b32 v168, 0x80008000, v200
    v_xor_b32 v169, 0x80008000, v201
    v_xor_b32 v170, 0x80008000, v202
    v_xor_b32 v171, 0x80008000, v203
    v_xor_b32 v172, 0x80008000, v204
    v_xor_b32 v173, 0x80008000, v205
    v_xor_b32 v174, 0x80008000, v206
    v_xor_b32 v175, 0x80008000, v207
    s_waitcnt lgkmcnt(2)
    v_mfma_f32_16x16x32_bf16 v[0:3], v[192:195], v[224:227], v[0:3]
    ds_read_b128 v[240:243], v253 offset:17408
    ds_read_b128 v[244:247], v253 offset:28672
    v_mfma_f32_16x16x32_bf16 v[4:7], v[196:199], v[224:227], v[4:7]
    v_mfma_f32_16x16x32_bf16 v[8:11], v[168:171], v[224:227], v[8:11]
    v_mfma_f32_16x16x32_bf16 v[12:15], v[172:175], v[224:227], v[12:15]
    v_mfma_f32_16x16x32_bf16 v[0:3], v[200:203], v[228:231], v[0:3]
    v_mfma_f32_16x16x32_bf16 v[4:7], v[204:207], v[228:231], v[4:7]
    v_mfma_f32_16x16x32_bf16 v[8:11], v[192:195], v[228:231], v[8:11]
    v_mfma_f32_16x16x32_bf16 v[12:15], v[196:199], v[228:231], v[12:15]
    s_waitcnt lgkmcnt(2)
    v_mfma_f32_16x16x32_bf16 v[48:51], v[176:179], v[232:235], v[48:51]
    ds_read_b128 v[216:219], v250 offset:20480
    ds_read_b128 v[220:223], v250 offset:31744
    v_mfma_f32_16x16x32_bf16 v[52:55], v[180:183], v[232:235], v[52:55]
    v_mfma_f32_16x16x32_bf16 v[56:59], v[208:211], v[232:235], v[56:59]
    v_mfma_f32_16x16x32_bf16 v[60:63], v[212:215], v[232:235], v[60:63]
    v_mfma_f32_16x16x32_bf16 v[48:51], v[184:187], v[236:239], v[48:51]
    v_mfma_f32_16x16x32_bf16 v[52:55], v[188:191], v[236:239], v[52:55]
    v_mfma_f32_16x16x32_bf16 v[56:59], v[176:179], v[236:239], v[56:59]
    v_mfma_f32_16x16x32_bf16 v[60:63], v[180:183], v[236:239], v[60:63]
    s_waitcnt lgkmcnt(2)
    v_mfma_f32_16x16x32_bf16 v[16:19], v[192:195], v[240:243], v[16:19]
    ds_read_b128 v[224:227], v253 offset:18432
    ds_read_b128 v[228:231], v253 offset:29696
    v_mfma_f32_16x16x32_bf16 v[20:23], v[196:199], v[240:243], v[20:23]
    v_cvt_pk_bf16_f32 v0, v0, v1
    v_cvt_pk_bf16_f32 v1, v2, v3
    v_mfma_f32_16x16x32_bf16 v[24:27], v[168:171], v[240:243], v[24:27]
    v_cvt_pk_bf16_f32 v2, v4, v5
    v_cvt_pk_bf16_f32 v3, v6, v7
    v_mfma_f32_16x16x32_bf16 v[28:31], v[172:175], v[240:243], v[28:31]
    s_add_u32 s47, s48, 0
    buffer_store_dwordx4 v[0:3], v251, s[16:19], s47 offen sc1
    v_mfma_f32_16x16x32_bf16 v[16:19], v[200:203], v[244:247], v[16:19]
    v_cvt_pk_bf16_f32 v8, v8, v9
    v_cvt_pk_bf16_f32 v9, v10, v11
    v_mfma_f32_16x16x32_bf16 v[20:23], v[204:207], v[244:247], v[20:23]
    v_cvt_pk_bf16_f32 v10, v12, v13
    v_cvt_pk_bf16_f32 v11, v14, v15
    v_mfma_f32_16x16x32_bf16 v[24:27], v[192:195], v[244:247], v[24:27]
    s_add_u32 s47, s48, 11264
    buffer_store_dwordx4 v[8:11], v251, s[16:19], s47 offen sc1
    v_mfma_f32_16x16x32_bf16 v[28:31], v[196:199], v[244:247], v[28:31]
    s_waitcnt lgkmcnt(2)
    v_mfma_f32_16x16x32_bf16 v[64:67], v[176:179], v[216:219], v[64:67]
    ds_read_b128 v[232:235], v250 offset:21504
    ds_read_b128 v[236:239], v250 offset:32768
    v_mfma_f32_16x16x32_bf16 v[68:71], v[180:183], v[216:219], v[68:71]
    v_mfma_f32_16x16x32_bf16 v[72:75], v[208:211], v[216:219], v[72:75]
    v_mfma_f32_16x16x32_bf16 v[76:79], v[212:215], v[216:219], v[76:79]
    v_mfma_f32_16x16x32_bf16 v[64:67], v[184:187], v[220:223], v[64:67]
    v_mfma_f32_16x16x32_bf16 v[68:71], v[188:191], v[220:223], v[68:71]
    v_mfma_f32_16x16x32_bf16 v[72:75], v[176:179], v[220:223], v[72:75]
    v_mfma_f32_16x16x32_bf16 v[76:79], v[180:183], v[220:223], v[76:79]
    s_waitcnt lgkmcnt(2)
    v_mfma_f32_16x16x32_bf16 v[32:35], v[192:195], v[224:227], v[32:35]
    ds_read_b128 v[240:243], v253 offset:19456
    ds_read_b128 v[244:247], v253 offset:30720
    v_mfma_f32_16x16x32_bf16 v[36:39], v[196:199], v[224:227], v[36:39]
    v_cvt_pk_bf16_f32 v16, v16, v17
    v_cvt_pk_bf16_f32 v17, v18, v19
    v_mfma_f32_16x16x32_bf16 v[40:43], v[168:171], v[224:227], v[40:43]
    v_cvt_pk_bf16_f32 v18, v20, v21
    v_cvt_pk_bf16_f32 v19, v22, v23
    v_mfma_f32_16x16x32_bf16 v[44:47], v[172:175], v[224:227], v[44:47]
    s_add_u32 s47, s48, 1024
    buffer_store_dwordx4 v[16:19], v251, s[16:19], s47 offen sc1
    v_mfma_f32_16x16x32_bf16 v[32:35], v[200:203], v[228:231], v[32:35]
    v_cvt_pk_bf16_f32 v24, v24, v25
    v_cvt_pk_bf16_f32 v25, v26, v27
    v_mfma_f32_16x16x32_bf16 v[36:39], v[204:207], v[228:231], v[36:39]
    v_cvt_pk_bf16_f32 v26, v28, v29
    v_cvt_pk_bf16_f32 v27, v30, v31
    v_mfma_f32_16x16x32_bf16 v[40:43], v[192:195], v[228:231], v[40:43]
    s_add_u32 s47, s48, 12288
    buffer_store_dwordx4 v[24:27], v251, s[16:19], s47 offen sc1
    v_mfma_f32_16x16x32_bf16 v[44:47], v[196:199], v[228:231], v[44:47]
    s_waitcnt lgkmcnt(2)
    v_mfma_f32_16x16x32_bf16 v[80:83], v[176:179], v[232:235], v[80:83]
    ds_read_b128 v[216:219], v250 offset:22528
    ds_read_b128 v[220:223], v250 offset:33792
    v_mfma_f32_16x16x32_bf16 v[84:87], v[180:183], v[232:235], v[84:87]
    v_mfma_f32_16x16x32_bf16 v[88:91], v[208:211], v[232:235], v[88:91]
    v_mfma_f32_16x16x32_bf16 v[92:95], v[212:215], v[232:235], v[92:95]
    v_mfma_f32_16x16x32_bf16 v[80:83], v[184:187], v[236:239], v[80:83]
    v_mfma_f32_16x16x32_bf16 v[84:87], v[188:191], v[236:239], v[84:87]
    v_mfma_f32_16x16x32_bf16 v[88:91], v[176:179], v[236:239], v[88:91]
    v_mfma_f32_16x16x32_bf16 v[92:95], v[180:183], v[236:239], v[92:95]
    s_waitcnt lgkmcnt(2)
    v_mfma_f32_16x16x32_bf16 v[48:51], v[192:195], v[240:243], v[48:51]
    ds_read_b128 v[224:227], v253 offset:20480
    ds_read_b128 v[228:231], v253 offset:31744
    v_mfma_f32_16x16x32_bf16 v[52:55], v[196:199], v[240:243], v[52:55]
    v_cvt_pk_bf16_f32 v32, v32, v33
    v_cvt_pk_bf16_f32 v33, v34, v35
    v_mfma_f32_16x16x32_bf16 v[56:59], v[168:171], v[240:243], v[56:59]
    v_cvt_pk_bf16_f32 v34, v36, v37
    v_cvt_pk_bf16_f32 v35, v38, v39
    v_mfma_f32_16x16x32_bf16 v[60:63], v[172:175], v[240:243], v[60:63]
    s_add_u32 s47, s48, 2048
    buffer_store_dwordx4 v[32:35], v251, s[16:19], s47 offen sc1
    v_mfma_f32_16x16x32_bf16 v[48:51], v[200:203], v[244:247], v[48:51]
    v_cvt_pk_bf16_f32 v40, v40, v41
    v_cvt_pk_bf16_f32 v41, v42, v43
    v_mfma_f32_16x16x32_bf16 v[52:55], v[204:207], v[244:247], v[52:55]
    v_cvt_pk_bf16_f32 v42, v44, v45
    v_cvt_pk_bf16_f32 v43, v46, v47
    v_mfma_f32_16x16x32_bf16 v[56:59], v[192:195], v[244:247], v[56:59]
    s_add_u32 s47, s48, 13312
    buffer_store_dwordx4 v[40:43], v251, s[16:19], s47 offen sc1
    v_mfma_f32_16x16x32_bf16 v[60:63], v[196:199], v[244:247], v[60:63]
    s_waitcnt lgkmcnt(2)
    v_mfma_f32_16x16x32_bf16 v[96:99], v[176:179], v[216:219], v[96:99]
    ds_read_b128 v[232:235], v250 offset:23552
    ds_read_b128 v[236:239], v250 offset:34816
    v_mfma_f32_16x16x32_bf16 v[100:103], v[180:183], v[216:219], v[100:103]
    v_mfma_f32_16x16x32_bf16 v[104:107], v[208:211], v[216:219], v[104:107]
    v_mfma_f32_16x16x32_bf16 v[108:111], v[212:215], v[216:219], v[108:111]
    v_mfma_f32_16x16x32_bf16 v[96:99], v[184:187], v[220:223], v[96:99]
    v_mfma_f32_16x16x32_bf16 v[100:103], v[188:191], v[220:223], v[100:103]
    v_mfma_f32_16x16x32_bf16 v[104:107], v[176:179], v[220:223], v[104:107]
    v_mfma_f32_16x16x32_bf16 v[108:111], v[180:183], v[220:223], v[108:111]
    s_waitcnt lgkmcnt(2)
    v_mfma_f32_16x16x32_bf16 v[64:67], v[192:195], v[224:227], v[64:67]
    ds_read_b128 v[240:243], v253 offset:21504
    ds_read_b128 v[244:247], v253 offset:32768
    v_mfma_f32_16x16x32_bf16 v[68:71], v[196:199], v[224:227], v[68:71]
    v_cvt_pk_bf16_f32 v48, v48, v49
    v_cvt_pk_bf16_f32 v49, v50, v51
    v_mfma_f32_16x16x32_bf16 v[72:75], v[168:171], v[224:227], v[72:75]
    v_cvt_pk_bf16_f32 v50, v52, v53
    v_cvt_pk_bf16_f32 v51, v54, v55
    v_mfma_f32_16x16x32_bf16 v[76:79], v[172:175], v[224:227], v[76:79]
    s_add_u32 s47, s48, 3072
    buffer_store_dwordx4 v[48:51], v251, s[16:19], s47 offen sc1
    v_mfma_f32_16x16x32_bf16 v[64:67], v[200:203], v[228:231], v[64:67]
    v_cvt_pk_bf16_f32 v56, v56, v57
    v_cvt_pk_bf16_f32 v57, v58, v59
    v_mfma_f32_16x16x32_bf16 v[68:71], v[204:207], v[228:231], v[68:71]
    v_cvt_pk_bf16_f32 v58, v60, v61
    v_cvt_pk_bf16_f32 v59, v62, v63
    v_mfma_f32_16x16x32_bf16 v[72:75], v[192:195], v[228:231], v[72:75]
    s_add_u32 s47, s48, 14336
    buffer_store_dwordx4 v[56:59], v251, s[16:19], s47 offen sc1
    v_mfma_f32_16x16x32_bf16 v[76:79], v[196:199], v[228:231], v[76:79]
    s_waitcnt lgkmcnt(2)
    v_mfma_f32_16x16x32_bf16 v[112:115], v[176:179], v[232:235], v[112:115]
    ds_read_b128 v[216:219], v250 offset:24576
    ds_read_b128 v[220:223], v250 offset:35840
    v_mfma_f32_16x16x32_bf16 v[116:119], v[180:183], v[232:235], v[116:119]
    v_mfma_f32_16x16x32_bf16 v[120:123], v[208:211], v[232:235], v[120:123]
    v_mfma_f32_16x16x32_bf16 v[124:127], v[212:215], v[232:235], v[124:127]
    v_mfma_f32_16x16x32_bf16 v[112:115], v[184:187], v[236:239], v[112:115]
    v_mfma_f32_16x16x32_bf16 v[116:119], v[188:191], v[236:239], v[116:119]
    v_mfma_f32_16x16x32_bf16 v[120:123], v[176:179], v[236:239], v[120:123]
    v_mfma_f32_16x16x32_bf16 v[124:127], v[180:183], v[236:239], v[124:127]
    s_waitcnt lgkmcnt(2)
    v_mfma_f32_16x16x32_bf16 v[80:83], v[192:195], v[240:243], v[80:83]
    ds_read_b128 v[224:227], v253 offset:22528
    ds_read_b128 v[228:231], v253 offset:33792
    v_mfma_f32_16x16x32_bf16 v[84:87], v[196:199], v[240:243], v[84:87]
    v_cvt_pk_bf16_f32 v64, v64, v65
    v_cvt_pk_bf16_f32 v65, v66, v67
    v_mfma_f32_16x16x32_bf16 v[88:91], v[168:171], v[240:243], v[88:91]
    v_cvt_pk_bf16_f32 v66, v68, v69
    v_cvt_pk_bf16_f32 v67, v70, v71
    v_mfma_f32_16x16x32_bf16 v[92:95], v[172:175], v[240:243], v[92:95]
    s_add_u32 s47, s48, 4096
    buffer_store_dwordx4 v[64:67], v251, s[16:19], s47 offen sc1
    v_mfma_f32_16x16x32_bf16 v[80:83], v[200:203], v[244:247], v[80:83]
    v_cvt_pk_bf16_f32 v72, v72, v73
    v_cvt_pk_bf16_f32 v73, v74, v75
    v_mfma_f32_16x16x32_bf16 v[84:87], v[204:207], v[244:247], v[84:87]
    v_cvt_pk_bf16_f32 v74, v76, v77
    v_cvt_pk_bf16_f32 v75, v78, v79
    v_mfma_f32_16x16x32_bf16 v[88:91], v[192:195], v[244:247], v[88:91]
    s_add_u32 s47, s48, 15360
    buffer_store_dwordx4 v[72:75], v251, s[16:19], s47 offen sc1
    v_mfma_f32_16x16x32_bf16 v[92:95], v[196:199], v[244:247], v[92:95]
    s_waitcnt lgkmcnt(2)
    v_mfma_f32_16x16x32_bf16 v[128:131], v[176:179], v[216:219], v[128:131]
    ds_read_b128 v[232:235], v250 offset:25600
    ds_read_b128 v[236:239], v250 offset:36864
    v_mfma_f32_16x16x32_bf16 v[132:135], v[180:183], v[216:219], v[132:135]
    v_mfma_f32_16x16x32_bf16 v[136:139], v[208:211], v[216:219], v[136:139]
    v_mfma_f32_16x16x32_bf16 v[140:143], v[212:215], v[216:219], v[140:143]
    v_mfma_f32_16x16x32_bf16 v[128:131], v[184:187], v[220:223], v[128:131]
    v_mfma_f32_16x16x32_bf16 v[132:135], v[188:191], v[220:223], v[132:135]
    v_mfma_f32_16x16x32_bf16 v[136:139], v[176:179], v[220:223], v[136:139]
    v_mfma_f32_16x16x32_bf16 v[140:143], v[180:183], v[220:223], v[140:143]
    s_waitcnt lgkmcnt(2)
    v_mfma_f32_16x16x32_bf16 v[96:99], v[192:195], v[224:227], v[96:99]
    ds_read_b128 v[240:243], v253 offset:23552
    ds_read_b128 v[244:247], v253 offset:34816
    v_mfma_f32_16x16x32_bf16 v[100:103], v[196:199], v[224:227], v[100:103]
    v_cvt_pk_bf16_f32 v80, v80, v81
    v_cvt_pk_bf16_f32 v81, v82, v83
    v_mfma_f32_16x16x32_bf16 v[104:107], v[168:171], v[224:227], v[104:107]
    v_cvt_pk_bf16_f32 v82, v84, v85
    v_cvt_pk_bf16_f32 v83, v86, v87
    v_mfma_f32_16x16x32_bf16 v[108:111], v[172:175], v[224:227], v[108:111]
    s_add_u32 s47, s48, 5120
    buffer_store_dwordx4 v[80:83], v251, s[16:19], s47 offen sc1
    v_mfma_f32_16x16x32_bf16 v[96:99], v[200:203], v[228:231], v[96:99]
    v_cvt_pk_bf16_f32 v88, v88, v89
    v_cvt_pk_bf16_f32 v89, v90, v91
    v_mfma_f32_16x16x32_bf16 v[100:103], v[204:207], v[228:231], v[100:103]
    v_cvt_pk_bf16_f32 v90, v92, v93
    v_cvt_pk_bf16_f32 v91, v94, v95
    v_mfma_f32_16x16x32_bf16 v[104:107], v[192:195], v[228:231], v[104:107]
    s_add_u32 s47, s48, 16384
    buffer_store_dwordx4 v[88:91], v251, s[16:19], s47 offen sc1
    v_mfma_f32_16x16x32_bf16 v[108:111], v[196:199], v[228:231], v[108:111]
    s_waitcnt lgkmcnt(2)
    v_mfma_f32_16x16x32_bf16 v[144:147], v[176:179], v[232:235], v[144:147]
    ds_read_b128 v[216:219], v250 offset:26624
    ds_read_b128 v[220:223], v250 offset:37888
    v_mfma_f32_16x16x32_bf16 v[148:151], v[180:183], v[232:235], v[148:151]
    v_mfma_f32_16x16x32_bf16 v[152:155], v[208:211], v[232:235], v[152:155]
    v_mfma_f32_16x16x32_bf16 v[156:159], v[212:215], v[232:235], v[156:159]
    v_mfma_f32_16x16x32_bf16 v[144:147], v[184:187], v[236:239], v[144:147]
    v_mfma_f32_16x16x32_bf16 v[148:151], v[188:191], v[236:239], v[148:151]
    v_mfma_f32_16x16x32_bf16 v[152:155], v[176:179], v[236:239], v[152:155]
    v_mfma_f32_16x16x32_bf16 v[156:159], v[180:183], v[236:239], v[156:159]
    s_waitcnt lgkmcnt(2)
    v_mfma_f32_16x16x32_bf16 v[112:115], v[192:195], v[240:243], v[112:115]
    ds_read_b128 v[224:227], v253 offset:24576
    ds_read_b128 v[228:231], v253 offset:35840
    v_mfma_f32_16x16x32_bf16 v[116:119], v[196:199], v[240:243], v[116:119]
    v_cvt_pk_bf16_f32 v96, v96, v97
    v_cvt_pk_bf16_f32 v97, v98, v99
    v_mfma_f32_16x16x32_bf16 v[120:123], v[168:171], v[240:243], v[120:123]
    v_cvt_pk_bf16_f32 v98, v100, v101
    v_cvt_pk_bf16_f32 v99, v102, v103
    v_mfma_f32_16x16x32_bf16 v[124:127], v[172:175], v[240:243], v[124:127]
    s_add_u32 s47, s48, 6144
    buffer_store_dwordx4 v[96:99], v251, s[16:19], s47 offen sc1
    v_mfma_f32_16x16x32_bf16 v[112:115], v[200:203], v[244:247], v[112:115]
    v_cvt_pk_bf16_f32 v104, v104, v105
    v_cvt_pk_bf16_f32 v105, v106, v107
    v_mfma_f32_16x16x32_bf16 v[116:119], v[204:207], v[244:247], v[116:119]
    v_cvt_pk_bf16_f32 v106, v108, v109
    v_cvt_pk_bf16_f32 v107, v110, v111
    v_mfma_f32_16x16x32_bf16 v[120:123], v[192:195], v[244:247], v[120:123]
    s_add_u32 s47, s48, 17408
    buffer_store_dwordx4 v[104:107], v251, s[16:19], s47 offen sc1
    v_mfma_f32_16x16x32_bf16 v[124:127], v[196:199], v[244:247], v[124:127]
    s_waitcnt lgkmcnt(2)
    v_mfma_f32_16x16x32_bf16 v[160:163], v[176:179], v[216:219], v[160:163]
    ds_read_b128 v[232:235], v253 offset:25600
    ds_read_b128 v[236:239], v253 offset:36864
    v_mfma_f32_16x16x32_bf16 v[164:167], v[208:211], v[216:219], v[164:167]
    v_mfma_f32_16x16x32_bf16 v[160:163], v[184:187], v[220:223], v[160:163]
    v_mfma_f32_16x16x32_bf16 v[164:167], v[176:179], v[220:223], v[164:167]
    s_waitcnt lgkmcnt(2)
    v_mfma_f32_16x16x32_bf16 v[128:131], v[192:195], v[224:227], v[128:131]
    ds_read_b128 v[240:243], v253 offset:26624
    ds_read_b128 v[244:247], v253 offset:37888
    v_mfma_f32_16x16x32_bf16 v[132:135], v[196:199], v[224:227], v[132:135]
    v_cvt_pk_bf16_f32 v112, v112, v113
    v_cvt_pk_bf16_f32 v113, v114, v115
    v_mfma_f32_16x16x32_bf16 v[136:139], v[168:171], v[224:227], v[136:139]
    v_cvt_pk_bf16_f32 v114, v116, v117
    v_cvt_pk_bf16_f32 v115, v118, v119
    v_mfma_f32_16x16x32_bf16 v[140:143], v[172:175], v[224:227], v[140:143]
    s_add_u32 s47, s48, 7168
    buffer_store_dwordx4 v[112:115], v251, s[16:19], s47 offen sc1
    v_mfma_f32_16x16x32_bf16 v[128:131], v[200:203], v[228:231], v[128:131]
    v_cvt_pk_bf16_f32 v120, v120, v121
    v_cvt_pk_bf16_f32 v121, v122, v123
    v_mfma_f32_16x16x32_bf16 v[132:135], v[204:207], v[228:231], v[132:135]
    v_cvt_pk_bf16_f32 v122, v124, v125
    v_cvt_pk_bf16_f32 v123, v126, v127
    v_mfma_f32_16x16x32_bf16 v[136:139], v[192:195], v[228:231], v[136:139]
    s_add_u32 s47, s48, 18432
    buffer_store_dwordx4 v[120:123], v251, s[16:19], s47 offen sc1
    v_mfma_f32_16x16x32_bf16 v[140:143], v[196:199], v[228:231], v[140:143]
    s_waitcnt lgkmcnt(2)
    v_mfma_f32_16x16x32_bf16 v[144:147], v[192:195], v[232:235], v[144:147]
    v_mfma_f32_16x16x32_bf16 v[148:151], v[196:199], v[232:235], v[148:151]
    v_mfma_f32_16x16x32_bf16 v[152:155], v[168:171], v[232:235], v[152:155]
    v_mfma_f32_16x16x32_bf16 v[156:159], v[172:175], v[232:235], v[156:159]
    v_mfma_f32_16x16x32_bf16 v[144:147], v[200:203], v[236:239], v[144:147]
    v_mfma_f32_16x16x32_bf16 v[148:151], v[204:207], v[236:239], v[148:151]
    v_mfma_f32_16x16x32_bf16 v[152:155], v[192:195], v[236:239], v[152:155]
    v_mfma_f32_16x16x32_bf16 v[156:159], v[196:199], v[236:239], v[156:159]
    s_waitcnt lgkmcnt(0)
    v_mfma_f32_16x16x32_bf16 v[160:163], v[192:195], v[240:243], v[160:163]
    v_mfma_f32_16x16x32_bf16 v[164:167], v[168:171], v[240:243], v[164:167]
    v_cvt_pk_bf16_f32 v128, v128, v129
    v_cvt_pk_bf16_f32 v129, v130, v131
    v_mfma_f32_16x16x32_bf16 v[160:163], v[200:203], v[244:247], v[160:163]
    v_cvt_pk_bf16_f32 v130, v132, v133
    v_cvt_pk_bf16_f32 v131, v134, v135
    v_mfma_f32_16x16x32_bf16 v[164:167], v[192:195], v[244:247], v[164:167]
    s_add_u32 s47, s48, 8192
    buffer_store_dwordx4 v[128:131], v251, s[16:19], s47 offen sc1
    s_nop 7
    v_cvt_pk_bf16_f32 v136, v136, v137
    v_cvt_pk_bf16_f32 v137, v138, v139
    v_cvt_pk_bf16_f32 v138, v140, v141
    v_cvt_pk_bf16_f32 v139, v142, v143
    s_add_u32 s47, s48, 19456
    buffer_store_dwordx4 v[136:139], v251, s[16:19], s47 offen sc1
    v_cvt_pk_bf16_f32 v144, v144, v145
    v_cvt_pk_bf16_f32 v145, v146, v147
    v_cvt_pk_bf16_f32 v146, v148, v149
    v_cvt_pk_bf16_f32 v147, v150, v151
    s_add_u32 s47, s48, 9216
    buffer_store_dwordx4 v[144:147], v251, s[16:19], s47 offen sc1
    v_cvt_pk_bf16_f32 v152, v152, v153
    v_cvt_pk_bf16_f32 v153, v154, v155
    v_cvt_pk_bf16_f32 v154, v156, v157
    v_cvt_pk_bf16_f32 v155, v158, v159
    s_add_u32 s47, s48, 20480
    buffer_store_dwordx4 v[152:155], v251, s[16:19], s47 offen sc1
    v_cvt_pk_bf16_f32 v160, v160, v161
    v_cvt_pk_bf16_f32 v161, v162, v163
    s_add_u32 s47, s49, 0
    buffer_store_dwordx2 v[160:161], v252, s[16:19], s47 offen sc1
    v_cvt_pk_bf16_f32 v164, v164, v165
    v_cvt_pk_bf16_f32 v165, v166, v167
    s_add_u32 s47, s49, 11264
    buffer_store_dwordx2 v[164:165], v252, s[16:19], s47 offen sc1
    s_branch L_epi_done
L_epi_b1:
    v_add_u32 v248, 0x9800, v248
    v_add_u32 v249, 0x9800, v249
    v_add_u32 v253, 38912, v250
    ds_read_b64_tr_b16 v[192:193], v248 offset:0
    ds_read_b64_tr_b16 v[194:195], v248 offset:1024
    ds_read_b64_tr_b16 v[196:197], v249 offset:0
    ds_read_b64_tr_b16 v[198:199], v249 offset:1024
    ds_read_b64_tr_b16 v[200:201], v248 offset:8192
    ds_read_b64_tr_b16 v[202:203], v248 offset:9216
    ds_read_b64_tr_b16 v[204:205], v249 offset:8192
    ds_read_b64_tr_b16 v[206:207], v249 offset:9216
    s_waitcnt lgkmcnt(10)
    v_mfma_f32_16x16x32_bf16 v[0:3], v[176:179], v[232:235], v[0:3]
    ds_read_b128 v[216:219], v250 offset:18432
    ds_read_b128 v[220:223], v250 offset:29696
    v_mfma_f32_16x16x32_bf16 v[4:7], v[180:183], v[232:235], v[4:7]
    v_mfma_f32_16x16x32_bf16 v[8:11], v[208:211], v[232:235], v[8:11]
    v_mfma_f32_16x16x32_bf16 v[12:15], v[212:215], v[232:235], v[12:15]
    v_mfma_f32_16x16x32_bf16 v[0:3], v[184:187], v[236:239], v[0:3]
    v_mfma_f32_16x16x32_bf16 v[4:7], v[188:191], v[236:239], v[4:7]
    v_mfma_f32_16x16x32_bf16 v[8:11], v[176:179], v[236:239], v[8:11]
    v_mfma_f32_16x16x32_bf16 v[12:15], v[180:183], v[236:239], v[12:15]
    s_waitcnt lgkmcnt(10)
    v_mfma_f32_16x16x32_bf16 v[16:19], v[176:179], v[240:243], v[16:19]
    ds_read_b128 v[224:227], v253 offset:16384
    ds_read_b128 v[228:231], v253 offset:27648
    v_mfma_f32_16x16x32_bf16 v[20:23], v[180:183], v[240:243], v[20:23]
    v_mfma_f32_16x16x32_bf16 v[24:27], v[208:211], v[240:243], v[24:27]
    v_mfma_f32_16x16x32_bf16 v[28:31], v[212:215], v[240:243], v[28:31]
    v_mfma_f32_16x16x32_bf16 v[16:19], v[184:187], v[244:247], v[16:19]
    v_mfma_f32_16x16x32_bf16 v[20:23], v[188:191], v[244:247], v[20:23]
    v_mfma_f32_16x16x32_bf16 v[24:27], v[176:179], v[244:247], v[24:27]
    v_mfma_f32_16x16x32_bf16 v[28:31], v[180:183], v[244:247], v[28:31]
    s_waitcnt lgkmcnt(2)
    v_mfma_f32_16x16x32_bf16 v[32:35], v[176:179], v[216:219], v[32:35]
    ds_read_b128 v[232:235], v250 offset:19456
    ds_read_b128 v[236:239], v250 offset:30720
    v_mfma_f32_16x16x32_bf16 v[36:39], v[180:183], v[216:219], v[36:39]
    v_mfma_f32_16x16x32_bf16 v[40:43], v[208:211], v[216:219], v[40:43]
    v_mfma_f32_16x16x32_bf16 v[44:47], v[212:215], v[216:219], v[44:47]
    v_mfma_f32_16x16x32_bf16 v[32:35], v[184:187], v[220:223], v[32:35]
    v_mfma_f32_16x16x32_bf16 v[36:39], v[188:191], v[220:223], v[36:39]
    v_mfma_f32_16x16x32_bf16 v[40:43], v[176:179], v[220:223], v[40:43]
    v_mfma_f32_16x16x32_bf16 v[44:47], v[180:183], v[220:223], v[44:47]
    v_xor_b32 v168, 0x80008000, v200
    v_xor_b32 v169, 0x80008000, v201
    v_xor_b32 v170, 0x80008000, v202
    v_xor_b32 v171, 0x80008000, v203
    v_xor_b32 v172, 0x80008000, v204
    v_xor_b32 v173, 0x80008000, v205
    v_xor_b32 v174, 0x80008000, v206
    v_xor_b32 v175, 0x80008000, v207
    s_waitcnt lgkmcnt(2)
    v_mfma_f32_16x16x32_bf16 v[0:3], v[192:195], v[224:227], v[0:3]
    ds_read_b128 v[240:243], v253 offset:17408
    ds_read_b128 v[244:247], v253 offset:28672
    v_mfma_f32_16x16x32_bf16 v[4:7], v[196:199], v[224:227], v[4:7]
    v_mfma_f32_16x16x32_bf16 v[8:11], v[168:171], v[224:227], v[8:11]
    v_mfma_f32_16x16x32_bf16 v[12:15], v[172:175], v[224:227], v[12:15]
    v_mfma_f32_16x16x32_bf16 v[0:3], v[200:203], v[228:231], v[0:3]
    v_mfma_f32_16x16x32_bf16 v[4:7], v[204:207], v[228:231], v[4:7]
    v_mfma_f32_16x16x32_bf16 v[8:11], v[192:195], v[228:231], v[8:11]
    v_mfma_f32_16x16x32_bf16 v[12:15], v[196:199], v[228:231], v[12:15]
    s_waitcnt lgkmcnt(2)
    v_mfma_f32_16x16x32_bf16 v[48:51], v[176:179], v[232:235], v[48:51]
    ds_read_b128 v[216:219], v250 offset:20480
    ds_read_b128 v[220:223], v250 offset:31744
    v_mfma_f32_16x16x32_bf16 v[52:55], v[180:183], v[232:235], v[52:55]
    v_mfma_f32_16x16x32_bf16 v[56:59], v[208:211], v[232:235], v[56:59]
    v_mfma_f32_16x16x32_bf16 v[60:63], v[212:215], v[232:235], v[60:63]
    v_mfma_f32_16x16x32_bf16 v[48:51], v[184:187], v[236:239], v[48:51]
    v_mfma_f32_16x16x32_bf16 v[52:55], v[188:191], v[236:239], v[52:55]
    v_mfma_f32_16x16x32_bf16 v[56:59], v[176:179], v[236:239], v[56:59]
    v_mfma_f32_16x16x32_bf16 v[60:63], v[180:183], v[236:239], v[60:63]
    s_waitcnt lgkmcnt(2)
    v_mfma_f32_16x16x32_bf16 v[16:19], v[192:195], v[240:243], v[16:19]
    ds_read_b128 v[224:227], v253 offset:18432
    ds_read_b128 v[228:231], v253 offset:29696
    v_mfma_f32_16x16x32_bf16 v[20:23], v[196:199], v[240:243], v[20:23]
    v_cvt_pk_bf16_f32 v4, v4, v5
    v_cvt_pk_bf16_f32 v5, v6, v7
    v_mfma_f32_16x16x32_bf16 v[24:27], v[168:171], v[240:243], v[24:27]
    v_cvt_pk_bf16_f32 v6, v0, v1
    v_cvt_pk_bf16_f32 v7, v2, v3
    v_mfma_f32_16x16x32_bf16 v[28:31], v[172:175], v[240:243], v[28:31]
    s_add_u32 s47, s48, 0
    buffer_store_dwordx4 v[4:7], v251, s[16:19], s47 offen sc1
    v_mfma_f32_16x16x32_bf16 v[16:19], v[200:203], v[244:247], v[16:19]
    v_cvt_pk_bf16_f32 v12, v12, v13
    v_cvt_pk_bf16_f32 v13, v14, v15
    v_mfma_f32_16x16x32_bf16 v[20:23], v[204:207], v[244:247], v[20:23]
    v_cvt_pk_bf16_f32 v14, v8, v9
    v_cvt_pk_bf16_f32 v15, v10, v11
    v_mfma_f32_16x16x32_bf16 v[24:27], v[192:195], v[244:247], v[24:27]
    s_add_u32 s47, s48, 11264
    buffer_store_dwordx4 v[12:15], v251, s[16:19], s47 offen sc1
    v_mfma_f32_16x16x32_bf16 v[28:31], v[196:199], v[244:247], v[28:31]
    s_waitcnt lgkmcnt(2)
    v_mfma_f32_16x16x32_bf16 v[64:67], v[176:179], v[216:219], v[64:67]
    ds_read_b128 v[232:235], v250 offset:21504
    ds_read_b128 v[236:239], v250 offset:32768
    v_mfma_f32_16x16x32_bf16 v[68:71], v[180:183], v[216:219], v[68:71]
    v_mfma_f32_16x16x32_bf16 v[72:75], v[208:211], v[216:219], v[72:75]
    v_mfma_f32_16x16x32_bf16 v[76:79], v[212:215], v[216:219], v[76:79]
    v_mfma_f32_16x16x32_bf16 v[64:67], v[184:187], v[220:223], v[64:67]
    v_mfma_f32_16x16x32_bf16 v[68:71], v[188:191], v[220:223], v[68:71]
    v_mfma_f32_16x16x32_bf16 v[72:75], v[176:179], v[220:223], v[72:75]
    v_mfma_f32_16x16x32_bf16 v[76:79], v[180:183], v[220:223], v[76:79]
    s_waitcnt lgkmcnt(2)
    v_mfma_f32_16x16x32_bf16 v[32:35], v[192:195], v[224:227], v[32:35]
    ds_read_b128 v[240:243], v253 offset:19456
    ds_read_b128 v[244:247], v253 offset:30720
    v_mfma_f32_16x16x32_bf16 v[36:39], v[196:199], v[224:227], v[36:39]
    v_cvt_pk_bf16_f32 v20, v20, v21
    v_cvt_pk_bf16_f32 v21, v22, v23
    v_mfma_f32_16x16x32_bf16 v[40:43], v[168:171], v[224:227], v[40:43]
    v_cvt_pk_bf16_f32 v22, v16, v17
    v_cvt_pk_bf16_f32 v23, v18, v19
    v_mfma_f32_16x16x32_bf16 v[44:47], v[172:175], v[224:227], v[44:47]
    s_add_u32 s47, s48, 1024
    buffer_store_dwordx4 v[20:23], v251, s[16:19], s47 offen sc1
    v_mfma_f32_16x16x32_bf16 v[32:35], v[200:203], v[228:231], v[32:35]
    v_cvt_pk_bf16_f32 v28, v28, v29
    v_cvt_pk_bf16_f32 v29, v30, v31
    v_mfma_f32_16x16x32_bf16 v[36:39], v[204:207], v[228:231], v[36:39]
    v_cvt_pk_bf16_f32 v30, v24, v25
    v_cvt_pk_bf16_f32 v31, v26, v27
    v_mfma_f32_16x16x32_bf16 v[40:43], v[192:195], v[228:231], v[40:43]
    s_add_u32 s47, s48, 12288
    buffer_store_dwordx4 v[28:31], v251, s[16:19], s47 offen sc1
    v_mfma_f32_16x16x32_bf16 v[44:47], v[196:199], v[228:231], v[44:47]
    s_waitcnt lgkmcnt(2)
    v_mfma_f32_16x16x32_bf16 v[80:83], v[176:179], v[232:235], v[80:83]
    ds_read_b128 v[216:219], v250 offset:22528
    ds_read_b128 v[220:223], v250 offset:33792
    v_mfma_f32_16x16x32_bf16 v[84:87], v[180:183], v[232:235], v[84:87]
    v_mfma_f32_16x16x32_bf16 v[88:91], v[208:211], v[232:235], v[88:91]
    v_mfma_f32_16x16x32_bf16 v[92:95], v[212:215], v[232:235], v[92:95]
    v_mfma_f32_16x16x32_bf16 v[80:83], v[184:187], v[236:239], v[80:83]
    v_mfma_f32_16x16x32_bf16 v[84:87], v[188:191], v[236:239], v[84:87]
    v_mfma_f32_16x16x32_bf16 v[88:91], v[176:179], v[236:239], v[88:91]
    v_mfma_f32_16x16x32_bf16 v[92:95], v[180:183], v[236:239], v[92:95]
    s_waitcnt lgkmcnt(2)
    v_mfma_f32_16x16x32_bf16 v[48:51], v[192:195], v[240:243], v[48:51]
    ds_read_b128 v[224:227], v253 offset:20480
    ds_read_b128 v[228:231], v253 offset:31744
    v_mfma_f32_16x16x32_bf16 v[52:55], v[196:199], v[240:243], v[52:55]
    v_cvt_pk_bf16_f32 v36, v36, v37
    v_cvt_pk_bf16_f32 v37, v38, v39
    v_mfma_f32_16x16x32_bf16 v[56:59], v[168:171], v[240:243], v[56:59]
    v_cvt_pk_bf16_f32 v38, v32, v33
    v_cvt_pk_bf16_f32 v39, v34, v35
    v_mfma_f32_16x16x32_bf16 v[60:63], v[172:175], v[240:243], v[60:63]
    s_add_u32 s47, s48, 2048
    buffer_store_dwordx4 v[36:39], v251, s[16:19], s47 offen sc1
    v_mfma_f32_16x16x32_bf16 v[48:51], v[200:203], v[244:247], v[48:51]
    v_cvt_pk_bf16_f32 v44, v44, v45
    v_cvt_pk_bf16_f32 v45, v46, v47
    v_mfma_f32_16x16x32_bf16 v[52:55], v[204:207], v[244:247], v[52:55]
    v_cvt_pk_bf16_f32 v46, v40, v41
    v_cvt_pk_bf16_f32 v47, v42, v43
    v_mfma_f32_16x16x32_bf16 v[56:59], v[192:195], v[244:247], v[56:59]
    s_add_u32 s47, s48, 13312
    buffer_store_dwordx4 v[44:47], v251, s[16:19], s47 offen sc1
    v_mfma_f32_16x16x32_bf16 v[60:63], v[196:199], v[244:247], v[60:63]
    s_waitcnt lgkmcnt(2)
    v_mfma_f32_16x16x32_bf16 v[96:99], v[176:179], v[216:219], v[96:99]
    ds_read_b128 v[232:235], v250 offset:23552
    ds_read_b128 v[236:239], v250 offset:34816
    v_mfma_f32_16x16x32_bf16 v[100:103], v[180:183], v[216:219], v[100:103]
    v_mfma_f32_16x16x32_bf16 v[104:107], v[208:211], v[216:219], v[104:107]
    v_mfma_f32_16x16x32_bf16 v[108:111], v[212:215], v[216:219], v[108:111]
    v_mfma_f32_16x16x32_bf16 v[96:99], v[184:187], v[220:223], v[96:99]
    v_mfma_f32_16x16x32_bf16 v[100:103], v[188:191], v[220:223], v[100:103]
    v_mfma_f32_16x16x32_bf16 v[104:107], v[176:179], v[220:223], v[104:107]
    v_mfma_f32_16x16x32_bf16 v[108:111], v[180:183], v[220:223], v[108:111]
    s_waitcnt lgkmcnt(2)
    v_mfma_f32_16x16x32_bf16 v[64:67], v[192:195], v[224:227], v[64:67]
    ds_read_b128 v[240:243], v253 offset:21504
    ds_read_b128 v[244:247], v253 offset:32768
    v_mfma_f32_16x16x32_bf16 v[68:71], v[196:199], v[224:227], v[68:71]
    v_cvt_pk_bf16_f32 v52, v52, v53
    v_cvt_pk_bf16_f32 v53, v54, v55
    v_mfma_f32_16x16x32_bf16 v[72:75], v[168:171], v[224:227], v[72:75]
    v_cvt_pk_bf16_f32 v54, v48, v49
    v_cvt_pk_bf16_f32 v55, v50, v51
    v_mfma_f32_16x16x32_bf16 v[76:79], v[172:175], v[224:227], v[76:79]
    s_add_u32 s47, s48, 3072
    buffer_store_dwordx4 v[52:55], v251, s[16:19], s47 offen sc1
    v_mfma_f32_16x16x32_bf16 v[64:67], v[200:203], v[228:231], v[64:67]
    v_cvt_pk_bf16_f32 v60, v60, v61
    v_cvt_pk_bf16_f32 v61, v62, v63
    v_mfma_f32_16x16x32_bf16 v[68:71], v[204:207], v[228:231], v[68:71]
    v_cvt_pk_bf16_f32 v62, v56, v57
    v_cvt_pk_bf16_f32 v63, v58, v59
    v_mfma_f32_16x16x32_bf16 v[72:75], v[192:195], v[228:231], v[72:75]
    s_add_u32 s47, s48, 14336
    buffer_store_dwordx4 v[60:63], v251, s[16:19], s47 offen sc1
    v_mfma_f32_16x16x32_bf16 v[76:79], v[196:199], v[228:231], v[76:79]
    s_waitcnt lgkmcnt(2)
    v_mfma_f32_16x16x32_bf16 v[112:115], v[176:179], v[232:235], v[112:115]
    ds_read_b128 v[216:219], v250 offset:24576
    ds_read_b128 v[220:223], v250 offset:35840
    v_mfma_f32_16x16x32_bf16 v[116:119], v[180:183], v[232:235], v[116:119]
    v_mfma_f32_16x16x32_bf16 v[120:123], v[208:211], v[232:235], v[120:123]
    v_mfma_f32_16x16x32_bf16 v[124:127], v[212:215], v[232:235], v[124:127]
    v_mfma_f32_16x16x32_bf16 v[112:115], v[184:187], v[236:239], v[112:115]
    v_mfma_f32_16x16x32_bf16 v[116:119], v[188:191], v[236:239], v[116:119]
    v_mfma_f32_16x16x32_bf16 v[120:123], v[176:179], v[236:239], v[120:123]
    v_mfma_f32_16x16x32_bf16 v[124:127], v[180:183], v[236:239], v[124:127]
    s_waitcnt lgkmcnt(2)
    v_mfma_f32_16x16x32_bf16 v[80:83], v[192:195], v[240:243], v[80:83]
    ds_read_b128 v[224:227], v253 offset:22528
    ds_read_b128 v[228:231], v253 offset:33792
    v_mfma_f32_16x16x32_bf16 v[84:87], v[196:199], v[240:243], v[84:87]
    v_cvt_pk_bf16_f32 v68, v68, v69
    v_cvt_pk_bf16_f32 v69, v70, v71
    v_mfma_f32_16x16x32_bf16 v[88:91], v[168:171], v[240:243], v[88:91]
    v_cvt_pk_bf16_f32 v70, v64, v65
    v_cvt_pk_bf16_f32 v71, v66, v67
    v_mfma_f32_16x16x32_bf16 v[92:95], v[172:175], v[240:243], v[92:95]
    s_add_u32 s47, s48, 4096
    buffer_store_dwordx4 v[68:71], v251, s[16:19], s47 offen sc1
    v_mfma_f32_16x16x32_bf16 v[80:83], v[200:203], v[244:247], v[80:83]
    v_cvt_pk_bf16_f32 v76, v76, v77
    v_cvt_pk_bf16_f32 v77, v78, v79
    v_mfma_f32_16x16x32_bf16 v[84:87], v[204:207], v[244:247], v[84:87]
    v_cvt_pk_bf16_f32 v78, v72, v73
    v_cvt_pk_bf16_f32 v79, v74, v75
    v_mfma_f32_16x16x32_bf16 v[88:91], v[192:195], v[244:247], v[88:91]
    s_add_u32 s47, s48, 15360
    buffer_store_dwordx4 v[76:79], v251, s[16:19], s47 offen sc1
    v_mfma_f32_16x16x32_bf16 v[92:95], v[196:199], v[244:247], v[92:95]
    s_waitcnt lgkmcnt(2)
    v_mfma_f32_16x16x32_bf16 v[128:131], v[176:179], v[216:219], v[128:131]
    ds_read_b128 v[232:235], v250 offset:25600
    ds_read_b128 v[236:239], v250 offset:36864
    v_mfma_f32_16x16x32_bf16 v[132:135], v[180:183], v[216:219], v[132:135]
    v_mfma_f32_16x16x32_bf16 v[136:139], v[208:211], v[216:219], v[136:139]
    v_mfma_f32_16x16x32_bf16 v[140:143], v[212:215], v[216:219], v[140:143]
    v_mfma_f32_16x16x32_bf16 v[128:131], v[184:187], v[220:223], v[128:131]
    v_mfma_f32_16x16x32_bf16 v[132:135], v[188:191], v[220:223], v[132:135]
    v_mfma_f32_16x16x32_bf16 v[136:139], v[176:179], v[220:223], v[136:139]
    v_mfma_f32_16x16x32_bf16 v[140:143], v[180:183], v[220:223], v[140:143]
    s_waitcnt lgkmcnt(2)
    v_mfma_f32_16x16x32_bf16 v[96:99], v[192:195], v[224:227], v[96:99]
    ds_read_b128 v[240:243], v253 offset:23552
    ds_read_b128 v[244:247], v253 offset:34816
    v_mfma_f32_16x16x32_bf16 v[100:103], v[196:199], v[224:227], v[100:103]
    v_cvt_pk_bf16_f32 v84, v84, v85
    v_cvt_pk_bf16_f32 v85, v86, v87
    v_mfma_f32_16x16x32_bf16 v[104:107], v[168:171], v[224:227], v[104:107]
    v_cvt_pk_bf16_f32 v86, v80, v81
    v_cvt_pk_bf16_f32 v87, v82, v83
    v_mfma_f32_16x16x32_bf16 v[108:111], v[172:175], v[224:227], v[108:111]
    s_add_u32 s47, s48, 5120
    buffer_store_dwordx4 v[84:87], v251, s[16:19], s47 offen sc1
    v_mfma_f32_16x16x32_bf16 v[96:99], v[200:203], v[228:231], v[96:99]
    v_cvt_pk_bf16_f32 v92, v92, v93
    v_cvt_pk_bf16_f32 v93, v94, v95
    v_mfma_f32_16x16x32_bf16 v[100:103], v[204:207], v[228:231], v[100:103]
    v_cvt_pk_bf16_f32 v94, v88, v89
    v_cvt_pk_bf16_f32 v95, v90, v91
    v_mfma_f32_16x16x32_bf16 v[104:107], v[192:195], v[228:231], v[104:107]
    s_add_u32 s47, s48, 16384
    buffer_store_dwordx4 v[92:95], v251, s[16:19], s47 offen sc1
    v_mfma_f32_16x16x32_bf16 v[108:111], v[196:199], v[228:231], v[108:111]
    s_waitcnt lgkmcnt(2)
    v_mfma_f32_16x16x32_bf16 v[144:147], v[176:179], v[232:235], v[144:147]
    ds_read_b128 v[216:219], v250 offset:26624
    ds_read_b128 v[220:223], v250 offset:37888
    v_mfma_f32_16x16x32_bf16 v[148:151], v[180:183], v[232:235], v[148:151]
    v_mfma_f32_16x16x32_bf16 v[152:155], v[208:211], v[232:235], v[152:155]
    v_mfma_f32_16x16x32_bf16 v[156:159], v[212:215], v[232:235], v[156:159]
    v_mfma_f32_16x16x32_bf16 v[144:147], v[184:187], v[236:239], v[144:147]
    v_mfma_f32_16x16x32_bf16 v[148:151], v[188:191], v[236:239], v[148:151]
    v_mfma_f32_16x16x32_bf16 v[152:155], v[176:179], v[236:239], v[152:155]
    v_mfma_f32_16x16x32_bf16 v[156:159], v[180:183], v[236:239], v[156:159]
    s_waitcnt lgkmcnt(2)
    v_mfma_f32_16x16x32_bf16 v[112:115], v[192:195], v[240:243], v[112:115]
    ds_read_b128 v[224:227], v253 offset:24576
    ds_read_b128 v[228:231], v253 offset:35840
    v_mfma_f32_16x16x32_bf16 v[116:119], v[196:199], v[240:243], v[116:119]
    v_cvt_pk_bf16_f32 v100, v100, v101
    v_cvt_pk_bf16_f32 v101, v102, v103
    v_mfma_f32_16x16x32_bf16 v[120:123], v[168:171], v[240:243], v[120:123]
    v_cvt_pk_bf16_f32 v102, v96, v97
    v_cvt_pk_bf16_f32 v103, v98, v99
    v_mfma_f32_16x16x32_bf16 v[124:127], v[172:175], v[240:243], v[124:127]
    s_add_u32 s47, s48, 6144
    buffer_store_dwordx4 v[100:103], v251, s[16:19], s47 offen sc1
    v_mfma_f32_16x16x32_bf16 v[112:115], v[200:203], v[244:247], v[112:115]
    v_cvt_pk_bf16_f32 v108, v108, v109
    v_cvt_pk_bf16_f32 v109, v110, v111
    v_mfma_f32_16x16x32_bf16 v[116:119], v[204:207], v[244:247], v[116:119]
    v_cvt_pk_bf16_f32 v110, v104, v105
    v_cvt_pk_bf16_f32 v111, v106, v107
    v_mfma_f32_16x16x32_bf16 v[120:123], v[192:195], v[244:247], v[120:123]
    s_add_u32 s47, s48, 17408
    buffer_store_dwordx4 v[108:111], v251, s[16:19], s47 offen sc1
    v_mfma_f32_16x16x32_bf16 v[124:127], v[196:199], v[244:247], v[124:127]
    s_waitcnt lgkmcnt(2)
    v_mfma_f32_16x16x32_bf16 v[160:163], v[176:179], v[216:219], v[160:163]
    ds_read_b128 v[232:235], v253 offset:25600
    ds_read_b128 v[236:239], v253 offset:36864
    v_mfma_f32_16x16x32_bf16 v[164:167], v[208:211], v[216:219], v[164:167]
    v_mfma_f32_16x16x32_bf16 v[160:163], v[184:187], v[220:223], v[160:163]
    v_mfma_f32_16x16x32_bf16 v[164:167], v[176:179], v[220:223], v[164:167]
    s_waitcnt lgkmcnt(2)
    v_mfma_f32_16x16x32_bf16 v[128:131], v[192:195], v[224:227], v[128:131]
    ds_read_b128 v[240:243], v253 offset:26624
    ds_read_b128 v[244:247], v253 offset:37888
    v_mfma_f32_16x16x32_bf16 v[132:135], v[196:199], v[224:227], v[132:135]
    v_cvt_pk_bf16_f32 v116, v116, v117
    v_cvt_pk_bf16_f32 v117, v118, v119
    v_mfma_f32_16x16x32_bf16 v[136:139], v[168:171], v[224:227], v[136:139]
    v_cvt_pk_bf16_f32 v118, v112, v113
    v_cvt_pk_bf16_f32 v119, v114, v115
    v_mfma_f32_16x16x32_bf16 v[140:143], v[172:175], v[224:227], v[140:143]
    s_add_u32 s47, s48, 7168
    buffer_store_dwordx4 v[116:119], v251, s[16:19], s47 offen sc1
    v_mfma_f32_16x16x32_bf16 v[128:131], v[200:203], v[228:231], v[128:131]
    v_cvt_pk_bf16_f32 v124, v124, v125
    v_cvt_pk_bf16_f32 v125, v126, v127
    v_mfma_f32_16x16x32_bf16 v[132:135], v[204:207], v[228:231], v[132:135]
    v_cvt_pk_bf16_f32 v126, v120, v121
    v_cvt_pk_bf16_f32 v127, v122, v123
    v_mfma_f32_16x16x32_bf16 v[136:139], v[192:195], v[228:231], v[136:139]
    s_add_u32 s47, s48, 18432
    buffer_store_dwordx4 v[124:127], v251, s[16:19], s47 offen sc1
    v_mfma_f32_16x16x32_bf16 v[140:143], v[196:199], v[228:231], v[140:143]
    s_waitcnt lgkmcnt(2)
    v_mfma_f32_16x16x32_bf16 v[144:147], v[192:195], v[232:235], v[144:147]
    v_mfma_f32_16x16x32_bf16 v[148:151], v[196:199], v[232:235], v[148:151]
    v_mfma_f32_16x16x32_bf16 v[152:155], v[168:171], v[232:235], v[152:155]
    v_mfma_f32_16x16x32_bf16 v[156:159], v[172:175], v[232:235], v[156:159]
    v_mfma_f32_16x16x32_bf16 v[144:147], v[200:203], v[236:239], v[144:147]
    v_mfma_f32_16x16x32_bf16 v[148:151], v[204:207], v[236:239], v[148:151]
    v_mfma_f32_16x16x32_bf16 v[152:155], v[192:195], v[236:239], v[152:155]
    v_mfma_f32_16x16x32_bf16 v[156:159], v[196:199], v[236:239], v[156:159]
    s_waitcnt lgkmcnt(0)
    v_mfma_f32_16x16x32_bf16 v[160:163], v[192:195], v[240:243], v[160:163]
    v_mfma_f32_16x16x32_bf16 v[164:167], v[168:171], v[240:243], v[164:167]
    v_cvt_pk_bf16_f32 v132, v132, v133
    v_cvt_pk_bf16_f32 v133, v134, v135
    v_mfma_f32_16x16x32_bf16 v[160:163], v[200:203], v[244:247], v[160:163]
    v_cvt_pk_bf16_f32 v134, v128, v129
    v_cvt_pk_bf16_f32 v135, v130, v131
    v_mfma_f32_16x16x32_bf16 v[164:167], v[192:195], v[244:247], v[164:167]
    s_add_u32 s47, s48, 8192
    buffer_store_dwordx4 v[132:135], v251, s[16:19], s47 offen sc1
    s_nop 7
    v_cvt_pk_bf16_f32 v140, v140, v141
    v_cvt_pk_bf16_f32 v141, v142, v143
    v_cvt_pk_bf16_f32 v142, v136, v137
    v_cvt_pk_bf16_f32 v143, v138, v139
    s_add_u32 s47, s48, 19456
    buffer_store_dwordx4 v[140:143], v251, s[16:19], s47 offen sc1
    v_cvt_pk_bf16_f32 v148, v148, v149
    v_cvt_pk_bf16_f32 v149, v150, v151
    v_cvt_pk_bf16_f32 v150, v144, v145
    v_cvt_pk_bf16_f32 v151, v146, v147
    s_add_u32 s47, s48, 9216
    buffer_store_dwordx4 v[148:151], v251, s[16:19], s47 offen sc1
    v_cvt_pk_bf16_f32 v156, v156, v157
    v_cvt_pk_bf16_f32 v157, v158, v159
    v_cvt_pk_bf16_f32 v158, v152, v153
    v_cvt_pk_bf16_f32 v159, v154, v155
    s_add_u32 s47, s48, 20480
    buffer_store_dwordx4 v[156:159], v251, s[16:19], s47 offen sc1
    v_cvt_pk_bf16_f32 v160, v160, v161
    v_cvt_pk_bf16_f32 v161, v162, v163
    s_add_u32 s47, s49, 0
    buffer_store_dwordx2 v[160:161], v252, s[16:19], s47 offen sc1
    v_cvt_pk_bf16_f32 v164, v164, v165
    v_cvt_pk_bf16_f32 v165, v166, v167
    s_add_u32 s47, s49, 11264
    buffer_store_dwordx2 v[164:165], v252, s[16:19], s47 offen sc1
L_epi_done:
    s_endpgm
L_fz_helper:
    s_sub_u32 s10, s10, 4
    v_and_b32 v217, 15, v0
    v_lshrrev_b32 v218, 4, v0
    v_lshlrev_b32 v231, 4, v0
    v_add_u32 v231, 116736, v231
    v_mov_b32 v230, 0
    v_lshlrev_b32 v238, 4, v0
    s_mov_b32 s30, 0x05040100
    s_mov_b32 s31, 0x07060302
    s_mov_b32 s32, 0x01000100
    s_mov_b32 s33, 0x03020302
    s_mov_b32 s40, s2
    s_add_u32 s42, s2, 256
    s_mov_b32 s55, -1
    s_mov_b32 s41, 129024
    s_mov_b32 s43, 0
    v_lshlrev_b32 v232, 14, v218
    v_lshl_add_u32 v232, v217, 4, v232
    v_lshlrev_b32 v233, 22, v218
    v_lshrrev_b32 v221, 2, v217
    v_lshl_add_u32 v233, v221, 6, v233
    v_and_b32 v221, 1, v217
    v_lshl_add_u32 v233, v221, 5, v233
    v_bfe_u32 v221, v217, 1, 1
    v_lshl_add_u32 v233, v221, 3, v233
    v_lshrrev_b32 v221, 2, v217
    s_mov_b32 s24, 688128
    v_mul_u32_u24 v234, s24, v221
    s_mov_b32 s24, 43008
    v_mad_u32_u24 v234, v218, s24, v234
    s_mov_b32 s24, 32768
    v_mul_u32_u24 v235, s24, v218
    s_cmp_ge_u32 s40, 736
    s_cbranch_scc1 L_rm0
    s_sub_u32 s28, s40, 64
    s_add_u32 s29, s40, 672
    s_cmp_ge_u32 s40, 64
    s_cselect_b32 s40, s28, s29
L_rm0:
    s_cmp_ge_u32 s42, 736
    s_cbranch_scc1 L_rm1
    s_sub_u32 s28, s42, 64
    s_add_u32 s29, s42, 672
    s_cmp_ge_u32 s42, 64
    s_cselect_b32 s42, s28, s29
L_rm1:
    s_waitcnt lgkmcnt(0)
    s_mov_b32 s16, s38
    s_and_b32 s17, s39, 0xffff
    s_mov_b32 s18, 268435456
    s_mov_b32 s19, 0x00020000
    s_mov_b32 s44, s36
    s_and_b32 s45, s37, 0xffff
    s_mov_b32 s46, 256
    s_mov_b32 s47, 0x00020000
    s_or_b32 s24, s2, s10
    s_cmp_lg_u32 s24, 0
    s_cbranch_scc1 L_nononce
    s_memrealtime s[24:25]
    s_waitcnt lgkmcnt(0)
    s_or_b32 s24, s24, 1
    v_mov_b32 v237, s24
    s_mov_b64 exec, 1
    buffer_store_dword v237, v230, s[44:47], 0 offen offset:128 sc1
    s_mov_b64 exec, -1
L_nononce:
    s_mov_b32 s54, 0
    s_cmp_ge_u32 s40, 1696
    s_cbranch_scc1 L_ld_done2
    s_cmp_ge_u32 s40, 672
    s_cbranch_scc1 L_ld_w2
    s_cmp_ge_u32 s40, 336
    s_cselect_b32 s11, 1, 0
    s_mul_i32 s12, s11, 336
    s_sub_u32 s12, s40, s12
    s_and_b32 s13, s12, 7
    s_lshr_b32 s14, s12, 3
    s_lshl_b32 s14, s14, 2
    s_add_u32 s14, s14, s10
    s_mul_i32 s15, s11, 16384000
    s_add_u32 s34, s4, s15
    s_addc_u32 s35, s5, 0
    s_mov_b32 s20, s34
    s_and_b32 s21, s35, 0xffff
    s_mov_b32 s22, 16384000
    s_mov_b32 s23, 0x00020000
    s_mul_i32 s15, s14, 98304
    s_lshl_b32 s24, s13, 8
    s_add_u32 s15, s15, s24
    s_add_u32 s25, s15, 0
    buffer_load_dwordx4 v[8:11], v232, s[20:23], s25 offen
    s_add_u32 s25, s15, 2048
    buffer_load_dwordx4 v[12:15], v232, s[20:23], s25 offen
    s_add_u32 s25, s15, 4096
    buffer_load_dwordx4 v[16:19], v232, s[20:23], s25 offen
    s_add_u32 s25, s15, 6144
    buffer_load_dwordx4 v[20:23], v232, s[20:23], s25 offen
    s_add_u32 s25, s15, 8192
    buffer_load_dwordx4 v[24:27], v232, s[20:23], s25 offen
    s_add_u32 s25, s15, 10240
    buffer_load_dwordx4 v[28:31], v232, s[20:23], s25 offen
    s_add_u32 s25, s15, 12288
    buffer_load_dwordx4 v[32:35], v232, s[20:23], s25 offen
    s_add_u32 s25, s15, 14336
    buffer_load_dwordx4 v[36:39], v232, s[20:23], s25 offen
    s_add_u32 s25, s15, 65536
    buffer_load_dwordx4 v[40:43], v232, s[20:23], s25 offen
    s_add_u32 s25, s15, 67584
    buffer_load_dwordx4 v[44:47], v232, s[20:23], s25 offen
    s_add_u32 s25, s15, 69632
    buffer_load_dwordx4 v[48:51], v232, s[20:23], s25 offen
    s_add_u32 s25, s15, 71680
    buffer_load_dwordx4 v[52:55], v232, s[20:23], s25 offen
    s_add_u32 s25, s15, 73728
    buffer_load_dwordx4 v[56:59], v232, s[20:23], s25 offen
    s_add_u32 s25, s15, 75776
    buffer_load_dwordx4 v[60:63], v232, s[20:23], s25 offen
    s_add_u32 s25, s15, 77824
    buffer_load_dwordx4 v[64:67], v232, s[20:23], s25 offen
    s_add_u32 s25, s15, 79872
    buffer_load_dwordx4 v[68:71], v232, s[20:23], s25 offen
    s_branch L_ld_done2
L_ld_w2:
    s_sub_u32 s12, s40, 672
    s_and_b32 s13, s12, 3
    s_lshr_b32 s14, s12, 2
    s_lshl_b32 s14, s14, 2
    s_add_u32 s14, s14, s10
    s_mov_b32 s20, s6
    s_and_b32 s21, s7, 0xffff
    s_mov_b32 s22, 16252928
    s_mov_b32 s23, 0x00020000
    s_lshl_b32 s15, s14, 10
    s_lshl_b32 s24, s13, 8
    s_add_u32 s15, s15, s24
    s_add_u32 s25, s15, 0
    buffer_load_dwordx2 v[8:9], v233, s[20:23], s25 offen
    buffer_load_dwordx2 v[10:11], v233, s[20:23], s25 offen offset:16
    s_add_u32 s25, s15, 1048576
    buffer_load_dwordx2 v[12:13], v233, s[20:23], s25 offen
    buffer_load_dwordx2 v[14:15], v233, s[20:23], s25 offen offset:16
    s_add_u32 s25, s15, 2097152
    buffer_load_dwordx2 v[16:17], v233, s[20:23], s25 offen
    buffer_load_dwordx2 v[18:19], v233, s[20:23], s25 offen offset:16
    s_add_u32 s25, s15, 3145728
    buffer_load_dwordx2 v[20:21], v233, s[20:23], s25 offen
    buffer_load_dwordx2 v[22:23], v233, s[20:23], s25 offen offset:16
L_ld_done2:
    v_lshrrev_b32 v221, 2, v217
    v_lshlrev_b32 v221, 1, v221
    v_bfe_u32 v222, v217, 1, 1
    v_add_u32 v221, v221, v222
    s_lshl_b32 s24, s10, 3
    v_add_u32 v221, s24, v221
    v_lshl_add_u32 v221, v221, 1, 1
    v_and_b32 v222, 1, v217
    v_lshlrev_b32 v222, 5, v222
    v_lshlrev_b32 v223, 3, v218
    v_mad_u32_u24 v168, v221, v223, v222
    v_add_u32 v169, v168, v221
    v_add_u32 v170, v169, v221
    v_add_u32 v171, v170, v221
    v_add_u32 v172, v171, v221
    v_add_u32 v173, v172, v221
    v_add_u32 v174, v173, v221
    v_add_u32 v175, v174, v221
    v_and_b32 v168, 127, v168
    v_cvt_f32_u32 v168, v168
    v_mul_f32 v168, 0x3c000000, v168
    v_cos_f32 v168, v168
    v_and_b32 v169, 127, v169
    v_cvt_f32_u32 v169, v169
    v_mul_f32 v169, 0x3c000000, v169
    v_cos_f32 v169, v169
    v_and_b32 v170, 127, v170
    v_cvt_f32_u32 v170, v170
    v_mul_f32 v170, 0x3c000000, v170
    v_cos_f32 v170, v170
    v_and_b32 v171, 127, v171
    v_cvt_f32_u32 v171, v171
    v_mul_f32 v171, 0x3c000000, v171
    v_cos_f32 v171, v171
    v_and_b32 v172, 127, v172
    v_cvt_f32_u32 v172, v172
    v_mul_f32 v172, 0x3c000000, v172
    v_cos_f32 v172, v172
    v_and_b32 v173, 127, v173
    v_cvt_f32_u32 v173, v173
    v_mul_f32 v173, 0x3c000000, v173
    v_cos_f32 v173, v173
    v_and_b32 v174, 127, v174
    v_cvt_f32_u32 v174, v174
    v_mul_f32 v174, 0x3c000000, v174
    v_cos_f32 v174, v174
    v_and_b32 v175, 127, v175
    v_cvt_f32_u32 v175, v175
    v_mul_f32 v175, 0x3c000000, v175
    v_cos_f32 v175, v175
    v_cvt_pk_bf16_f32 v184, v168, v169
    v_cvt_pk_bf16_f32 v185, v170, v171
    v_cvt_pk_bf16_f32 v186, v172, v173
    v_cvt_pk_bf16_f32 v187, v174, v175
    s_lshl_b32 s24, s10, 11
    v_add_u32 v224, s24, v231
    ds_write_b128 v224, v[184:187] offset:0
    v_lshlrev_b32 v223, 3, v218
    v_add_u32 v223, 32, v223
    v_mad_u32_u24 v168, v221, v223, v222
    v_add_u32 v169, v168, v221
    v_add_u32 v170, v169, v221
    v_add_u32 v171, v170, v221
    v_add_u32 v172, v171, v221
    v_add_u32 v173, v172, v221
    v_add_u32 v174, v173, v221
    v_add_u32 v175, v174, v221
    v_and_b32 v168, 127, v168
    v_cvt_f32_u32 v168, v168
    v_mul_f32 v168, 0x3c000000, v168
    v_cos_f32 v168, v168
    v_and_b32 v169, 127, v169
    v_cvt_f32_u32 v169, v169
    v_mul_f32 v169, 0x3c000000, v169
    v_cos_f32 v169, v169
    v_and_b32 v170, 127, v170
    v_cvt_f32_u32 v170, v170
    v_mul_f32 v170, 0x3c000000, v170
    v_cos_f32 v170, v170
    v_and_b32 v171, 127, v171
    v_cvt_f32_u32 v171, v171
    v_mul_f32 v171, 0x3c000000, v171
    v_cos_f32 v171, v171
    v_and_b32 v172, 127, v172
    v_cvt_f32_u32 v172, v172
    v_mul_f32 v172, 0x3c000000, v172
    v_cos_f32 v172, v172
    v_and_b32 v173, 127, v173
    v_cvt_f32_u32 v173, v173
    v_mul_f32 v173, 0x3c000000, v173
    v_cos_f32 v173, v173
    v_and_b32 v174, 127, v174
    v_cvt_f32_u32 v174, v174
    v_mul_f32 v174, 0x3c000000, v174
    v_cos_f32 v174, v174
    v_and_b32 v175, 127, v175
    v_cvt_f32_u32 v175, v175
    v_mul_f32 v175, 0x3c000000, v175
    v_cos_f32 v175, v175
    v_cvt_pk_bf16_f32 v184, v168, v169
    v_cvt_pk_bf16_f32 v185, v170, v171
    v_cvt_pk_bf16_f32 v186, v172, v173
    v_cvt_pk_bf16_f32 v187, v174, v175
    s_lshl_b32 s24, s10, 11
    v_add_u32 v224, s24, v231
    ds_write_b128 v224, v[184:187] offset:1024
    v_lshlrev_b32 v223, 2, v218
    v_mad_u32_u24 v168, v221, v223, v222
    v_add_u32 v169, v168, v221
    v_add_u32 v170, v169, v221
    v_add_u32 v171, v170, v221
    v_and_b32 v168, 127, v168
    v_cvt_f32_u32 v168, v168
    v_mul_f32 v168, 0x3c000000, v168
    v_cos_f32 v168, v168
    v_and_b32 v169, 127, v169
    v_cvt_f32_u32 v169, v169
    v_mul_f32 v169, 0x3c000000, v169
    v_cos_f32 v169, v169
    v_and_b32 v170, 127, v170
    v_cvt_f32_u32 v170, v170
    v_mul_f32 v170, 0x3c000000, v170
    v_cos_f32 v170, v170
    v_and_b32 v171, 127, v171
    v_cvt_f32_u32 v171, v171
    v_mul_f32 v171, 0x3c000000, v171
    v_cos_f32 v171, v171
    v_cvt_pk_bf16_f32 v188, v168, v168
    v_lshlrev_b32 v189, 16, v188
    v_sub_f32 v189, v168, v189
    v_cvt_pk_bf16_f32 v189, v189, v189
    v_perm_b32 v184, v189, v188, s30
    v_cvt_pk_bf16_f32 v188, v169, v169
    v_lshlrev_b32 v189, 16, v188
    v_sub_f32 v189, v169, v189
    v_cvt_pk_bf16_f32 v189, v189, v189
    v_perm_b32 v185, v189, v188, s30
    v_cvt_pk_bf16_f32 v188, v170, v170
    v_lshlrev_b32 v189, 16, v188
    v_sub_f32 v189, v170, v189
    v_cvt_pk_bf16_f32 v189, v189, v189
    v_perm_b32 v186, v189, v188, s30
    v_cvt_pk_bf16_f32 v188, v171, v171
    v_lshlrev_b32 v189, 16, v188
    v_sub_f32 v189, v171, v189
    v_cvt_pk_bf16_f32 v189, v189, v189
    v_perm_b32 v187, v189, v188, s30
    s_lshl_b32 s24, s10, 10
    v_add_u32 v224, s24, v231
    ds_write_b128 v224, v[184:187] offset:8192
    s_waitcnt lgkmcnt(0)
    s_barrier
L_x_loop:
    s_cmp_lg_u32 s10, 0
    s_cbranch_scc1 L_nofetch0
    v_mov_b32 v229, 1
    s_mov_b64 exec, 1
    buffer_atomic_add v229, v230, s[44:47], 0 offen sc0 sc1
    s_mov_b64 exec, -1
L_nofetch0:
    s_cmp_ge_u32 s42, 1696
    s_cbranch_scc1 L_ld_done3
    s_cmp_ge_u32 s42, 672
    s_cbranch_scc1 L_ld_w3
    s_cmp_ge_u32 s42, 336
    s_cselect_b32 s11, 1, 0
    s_mul_i32 s12, s11, 336
    s_sub_u32 s12, s42, s12
    s_and_b32 s13, s12, 7
    s_lshr_b32 s14, s12, 3
    s_lshl_b32 s14, s14, 2
    s_add_u32 s14, s14, s10
    s_mul_i32 s15, s11, 16384000
    s_add_u32 s34, s4, s15
    s_addc_u32 s35, s5, 0
    s_mov_b32 s20, s34
    s_and_b32 s21, s35, 0xffff
    s_mov_b32 s22, 16384000
    s_mov_b32 s23, 0x00020000
    s_mul_i32 s15, s14, 98304
    s_lshl_b32 s24, s13, 8
    s_add_u32 s15, s15, s24
    s_add_u32 s25, s15, 0
    buffer_load_dwordx4 v[72:75], v232, s[20:23], s25 offen
    s_add_u32 s25, s15, 2048
    buffer_load_dwordx4 v[76:79], v232, s[20:23], s25 offen
    s_add_u32 s25, s15, 4096
    buffer_load_dwordx4 v[80:83], v232, s[20:23], s25 offen
    s_add_u32 s25, s15, 6144
    buffer_load_dwordx4 v[84:87], v232, s[20:23], s25 offen
    s_add_u32 s25, s15, 8192
    buffer_load_dwordx4 v[88:91], v232, s[20:23], s25 offen
    s_add_u32 s25, s15, 10240
    buffer_load_dwordx4 v[92:95], v232, s[20:23], s25 offen
    s_add_u32 s25, s15, 12288
    buffer_load_dwordx4 v[96:99], v232, s[20:23], s25 offen
    s_add_u32 s25, s15, 14336
    buffer_load_dwordx4 v[100:103], v232, s[20:23], s25 offen
    s_add_u32 s25, s15, 65536
    buffer_load_dwordx4 v[104:107], v232, s[20:23], s25 offen
    s_add_u32 s25, s15, 67584
    buffer_load_dwordx4 v[108:111], v232, s[20:23], s25 offen
    s_add_u32 s25, s15, 69632
    buffer_load_dwordx4 v[112:115], v232, s[20:23], s25 offen
    s_add_u32 s25, s15, 71680
    buffer_load_dwordx4 v[116:119], v232, s[20:23], s25 offen
    s_add_u32 s25, s15, 73728
    buffer_load_dwordx4 v[120:123], v232, s[20:23], s25 offen
    s_add_u32 s25, s15, 75776
    buffer_load_dwordx4 v[124:127], v232, s[20:23], s25 offen
    s_add_u32 s25, s15, 77824
    buffer_load_dwordx4 v[128:131], v232, s[20:23], s25 offen
    s_add_u32 s25, s15, 79872
    buffer_load_dwordx4 v[132:135], v232, s[20:23], s25 offen
    s_branch L_ld_done3
L_ld_w3:
    s_sub_u32 s12, s42, 672
    s_and_b32 s13, s12, 3
    s_lshr_b32 s14, s12, 2
    s_lshl_b32 s14, s14, 2
    s_add_u32 s14, s14, s10
    s_mov_b32 s20, s6
    s_and_b32 s21, s7, 0xffff
    s_mov_b32 s22, 16252928
    s_mov_b32 s23, 0x00020000
    s_lshl_b32 s15, s14, 10
    s_lshl_b32 s24, s13, 8
    s_add_u32 s15, s15, s24
    s_add_u32 s25, s15, 0
    buffer_load_dwordx2 v[72:73], v233, s[20:23], s25 offen
    buffer_load_dwordx2 v[74:75], v233, s[20:23], s25 offen offset:16
    s_add_u32 s25, s15, 1048576
    buffer_load_dwordx2 v[76:77], v233, s[20:23], s25 offen
    buffer_load_dwordx2 v[78:79], v233, s[20:23], s25 offen offset:16
    s_add_u32 s25, s15, 2097152
    buffer_load_dwordx2 v[80:81], v233, s[20:23], s25 offen
    buffer_load_dwordx2 v[82:83], v233, s[20:23], s25 offen offset:16
    s_add_u32 s25, s15, 3145728
    buffer_load_dwordx2 v[84:85], v233, s[20:23], s25 offen
    buffer_load_dwordx2 v[86:87], v233, s[20:23], s25 offen offset:16
L_ld_done3:
    s_cmp_lg_u32 s43, 0
    s_cbranch_scc1 L_notfirst
    s_cmp_ge_u32 s42, 1696
    s_cbranch_scc1 L_w0_f
    s_cmp_ge_u32 s42, 672
    s_cbranch_scc1 L_w8_f
    s_waitcnt vmcnt(16)
    s_branch L_wd_f
L_w8_f:
    s_waitcnt vmcnt(8)
    s_branch L_wd_f
L_w0_f:
    s_waitcnt vmcnt(0)
L_wd_f:
    s_mov_b32 s43, 1
    s_branch L_wfin
L_notfirst:
    s_cmp_ge_u32 s42, 1696
    s_cbranch_scc1 L_w0_a0
    s_cmp_ge_u32 s42, 672
    s_cbranch_scc1 L_w8_a0
    s_waitcnt vmcnt(32)
    s_branch L_wd_a0
L_w8_a0:
    s_waitcnt vmcnt(24)
    s_branch L_wd_a0
L_w0_a0:
    s_waitcnt vmcnt(16)
L_wd_a0:
L_wfin:
    s_cmp_ge_u32 s40, 672
    s_cbranch_scc1 L_cw0
    s_cmp_ge_u32 s40, 336
    s_cselect_b32 s11, 1, 0
    s_mul_i32 s12, s11, 336
    s_sub_u32 s12, s40, s12
    s_and_b32 s13, s12, 7
    s_lshr_b32 s14, s12, 3
    s_lshl_b32 s14, s14, 2
    s_add_u32 s14, s14, s10
    ds_read_b128 v[136:139], v231 offset:0
    ds_read_b128 v[140:143], v231 offset:1024
    ds_read_b128 v[144:147], v231 offset:2048
    ds_read_b128 v[148:151], v231 offset:3072
    ds_read_b128 v[152:155], v231 offset:4096
    ds_read_b128 v[156:159], v231 offset:5120
    ds_read_b128 v[160:163], v231 offset:6144
    ds_read_b128 v[164:167], v231 offset:7168
    s_bfe_u32 s24, s14, 0x10003
    s_mul_i32 s24, s24, 3
    v_and_b32 v221, 3, v217
    v_xor_b32 v221, s24, v221
    v_lshl_add_u32 v220, v221, 4, v234
    s_mul_i32 s24, s11, 22020096
    s_mul_i32 s25, s13, 2752512
    s_add_u32 s24, s24, s25
    s_lshl_b32 s25, s14, 6
    s_add_u32 s24, s24, s25
    s_add_u32 s24, s24, 67108864
    v_perm_b32 v168, v12, v8, s30
    v_perm_b32 v169, v20, v16, s30
    v_perm_b32 v170, v28, v24, s30
    v_perm_b32 v171, v36, v32, s30
    v_perm_b32 v172, v12, v8, s31
    v_perm_b32 v173, v20, v16, s31
    v_perm_b32 v174, v28, v24, s31
    v_perm_b32 v175, v36, v32, s31
    v_perm_b32 v176, v44, v40, s30
    v_perm_b32 v177, v52, v48, s30
    v_perm_b32 v178, v60, v56, s30
    v_perm_b32 v179, v68, v64, s30
    v_perm_b32 v180, v44, v40, s31
    v_perm_b32 v181, v52, v48, s31
    v_perm_b32 v182, v60, v56, s31
    v_perm_b32 v183, v68, v64, s31
    s_waitcnt lgkmcnt(0)
    v_mfma_f32_16x16x32_bf16 v[184:187], v[136:139], v[168:171], 0
    v_mfma_f32_16x16x32_bf16 v[188:191], v[136:139], v[172:175], 0
    v_mfma_f32_16x16x32_bf16 v[192:195], v[144:147], v[168:171], 0
    v_mfma_f32_16x16x32_bf16 v[196:199], v[144:147], v[172:175], 0
    v_mfma_f32_16x16x32_bf16 v[200:203], v[152:155], v[168:171], 0
    v_mfma_f32_16x16x32_bf16 v[204:207], v[152:155], v[172:175], 0
    v_mfma_f32_16x16x32_bf16 v[208:211], v[160:163], v[168:171], 0
    v_mfma_f32_16x16x32_bf16 v[212:215], v[160:163], v[172:175], 0
    v_mfma_f32_16x16x32_bf16 v[184:187], v[140:143], v[176:179], v[184:187]
    v_mfma_f32_16x16x32_bf16 v[188:191], v[140:143], v[180:183], v[188:191]
    v_mfma_f32_16x16x32_bf16 v[192:195], v[148:151], v[176:179], v[192:195]
    v_mfma_f32_16x16x32_bf16 v[196:199], v[148:151], v[180:183], v[196:199]
    v_mfma_f32_16x16x32_bf16 v[200:203], v[156:159], v[176:179], v[200:203]
    v_mfma_f32_16x16x32_bf16 v[204:207], v[156:159], v[180:183], v[204:207]
    v_mfma_f32_16x16x32_bf16 v[208:211], v[164:167], v[176:179], v[208:211]
    v_mfma_f32_16x16x32_bf16 v[212:215], v[164:167], v[180:183], v[212:215]
    v_perm_b32 v168, v13, v9, s30
    v_perm_b32 v169, v21, v17, s30
    v_perm_b32 v170, v29, v25, s30
    v_perm_b32 v171, v37, v33, s30
    v_perm_b32 v172, v13, v9, s31
    v_perm_b32 v173, v21, v17, s31
    v_perm_b32 v174, v29, v25, s31
    v_perm_b32 v175, v37, v33, s31
    v_perm_b32 v176, v45, v41, s30
    v_perm_b32 v177, v53, v49, s30
    v_perm_b32 v178, v61, v57, s30
    v_perm_b32 v179, v69, v65, s30
    v_perm_b32 v180, v45, v41, s31
    v_perm_b32 v181, v53, v49, s31
    v_perm_b32 v182, v61, v57, s31
    v_perm_b32 v183, v69, v65, s31
    v_cvt_pk_bf16_f32 v8, v184, v188
    v_cvt_pk_bf16_f32 v12, v185, v189
    v_cvt_pk_bf16_f32 v16, v186, v190
    v_cvt_pk_bf16_f32 v20, v187, v191
    v_cvt_pk_bf16_f32 v24, v192, v196
    v_cvt_pk_bf16_f32 v28, v193, v197
    v_cvt_pk_bf16_f32 v32, v194, v198
    v_cvt_pk_bf16_f32 v36, v195, v199
    v_cvt_pk_bf16_f32 v40, v200, v204
    v_cvt_pk_bf16_f32 v44, v201, v205
    v_cvt_pk_bf16_f32 v48, v202, v206
    v_cvt_pk_bf16_f32 v52, v203, v207
    v_cvt_pk_bf16_f32 v56, v208, v212
    v_cvt_pk_bf16_f32 v60, v209, v213
    v_cvt_pk_bf16_f32 v64, v210, v214
    v_cvt_pk_bf16_f32 v68, v211, v215
    v_mfma_f32_16x16x32_bf16 v[184:187], v[136:139], v[168:171], 0
    v_mfma_f32_16x16x32_bf16 v[188:191], v[136:139], v[172:175], 0
    v_mfma_f32_16x16x32_bf16 v[192:195], v[144:147], v[168:171], 0
    v_mfma_f32_16x16x32_bf16 v[196:199], v[144:147], v[172:175], 0
    v_mfma_f32_16x16x32_bf16 v[200:203], v[152:155], v[168:171], 0
    v_mfma_f32_16x16x32_bf16 v[204:207], v[152:155], v[172:175], 0
    v_mfma_f32_16x16x32_bf16 v[208:211], v[160:163], v[168:171], 0
    v_mfma_f32_16x16x32_bf16 v[212:215], v[160:163], v[172:175], 0
    v_mfma_f32_16x16x32_bf16 v[184:187], v[140:143], v[176:179], v[184:187]
    v_mfma_f32_16x16x32_bf16 v[188:191], v[140:143], v[180:183], v[188:191]
    v_mfma_f32_16x16x32_bf16 v[192:195], v[148:151], v[176:179], v[192:195]
    v_mfma_f32_16x16x32_bf16 v[196:199], v[148:151], v[180:183], v[196:199]
    v_mfma_f32_16x16x32_bf16 v[200:203], v[156:159], v[176:179], v[200:203]
    v_mfma_f32_16x16x32_bf16 v[204:207], v[156:159], v[180:183], v[204:207]
    v_mfma_f32_16x16x32_bf16 v[208:211], v[164:167], v[176:179], v[208:211]
    v_mfma_f32_16x16x32_bf16 v[212:215], v[164:167], v[180:183], v[212:215]
    v_perm_b32 v168, v14, v10, s30
    v_perm_b32 v169, v22, v18, s30
    v_perm_b32 v170, v30, v26, s30
    v_perm_b32 v171, v38, v34, s30
    v_perm_b32 v172, v14, v10, s31
    v_perm_b32 v173, v22, v18, s31
    v_perm_b32 v174, v30, v26, s31
    v_perm_b32 v175, v38, v34, s31
    v_perm_b32 v176, v46, v42, s30
    v_perm_b32 v177, v54, v50, s30
    v_perm_b32 v178, v62, v58, s30
    v_perm_b32 v179, v70, v66, s30
    v_perm_b32 v180, v46, v42, s31
    v_perm_b32 v181, v54, v50, s31
    v_perm_b32 v182, v62, v58, s31
    v_perm_b32 v183, v70, v66, s31
    v_cvt_pk_bf16_f32 v9, v184, v188
    v_cvt_pk_bf16_f32 v13, v185, v189
    v_cvt_pk_bf16_f32 v17, v186, v190
    v_cvt_pk_bf16_f32 v21, v187, v191
    v_cvt_pk_bf16_f32 v25, v192, v196
    v_cvt_pk_bf16_f32 v29, v193, v197
    v_cvt_pk_bf16_f32 v33, v194, v198
    v_cvt_pk_bf16_f32 v37, v195, v199
    v_cvt_pk_bf16_f32 v41, v200, v204
    v_cvt_pk_bf16_f32 v45, v201, v205
    v_cvt_pk_bf16_f32 v49, v202, v206
    v_cvt_pk_bf16_f32 v53, v203, v207
    v_cvt_pk_bf16_f32 v57, v208, v212
    v_cvt_pk_bf16_f32 v61, v209, v213
    v_cvt_pk_bf16_f32 v65, v210, v214
    v_cvt_pk_bf16_f32 v69, v211, v215
    v_mfma_f32_16x16x32_bf16 v[184:187], v[136:139], v[168:171], 0
    v_mfma_f32_16x16x32_bf16 v[188:191], v[136:139], v[172:175], 0
    v_mfma_f32_16x16x32_bf16 v[192:195], v[144:147], v[168:171], 0
    v_mfma_f32_16x16x32_bf16 v[196:199], v[144:147], v[172:175], 0
    v_mfma_f32_16x16x32_bf16 v[200:203], v[152:155], v[168:171], 0
    v_mfma_f32_16x16x32_bf16 v[204:207], v[152:155], v[172:175], 0
    v_mfma_f32_16x16x32_bf16 v[208:211], v[160:163], v[168:171], 0
    v_mfma_f32_16x16x32_bf16 v[212:215], v[160:163], v[172:175], 0
    v_mfma_f32_16x16x32_bf16 v[184:187], v[140:143], v[176:179], v[184:187]
    v_mfma_f32_16x16x32_bf16 v[188:191], v[140:143], v[180:183], v[188:191]
    v_mfma_f32_16x16x32_bf16 v[192:195], v[148:151], v[176:179], v[192:195]
    v_mfma_f32_16x16x32_bf16 v[196:199], v[148:151], v[180:183], v[196:199]
    v_mfma_f32_16x16x32_bf16 v[200:203], v[156:159], v[176:179], v[200:203]
    v_mfma_f32_16x16x32_bf16 v[204:207], v[156:159], v[180:183], v[204:207]
    v_mfma_f32_16x16x32_bf16 v[208:211], v[164:167], v[176:179], v[208:211]
    v_mfma_f32_16x16x32_bf16 v[212:215], v[164:167], v[180:183], v[212:215]
    v_perm_b32 v168, v15, v11, s30
    v_perm_b32 v169, v23, v19, s30
    v_perm_b32 v170, v31, v27, s30
    v_perm_b32 v171, v39, v35, s30
    v_perm_b32 v172, v15, v11, s31
    v_perm_b32 v173, v23, v19, s31
    v_perm_b32 v174, v31, v27, s31
    v_perm_b32 v175, v39, v35, s31
    v_perm_b32 v176, v47, v43, s30
    v_perm_b32 v177, v55, v51, s30
    v_perm_b32 v178, v63, v59, s30
    v_perm_b32 v179, v71, v67, s30
    v_perm_b32 v180, v47, v43, s31
    v_perm_b32 v181, v55, v51, s31
    v_perm_b32 v182, v63, v59, s31
    v_perm_b32 v183, v71, v67, s31
    v_cvt_pk_bf16_f32 v10, v184, v188
    v_cvt_pk_bf16_f32 v14, v185, v189
    v_cvt_pk_bf16_f32 v18, v186, v190
    v_cvt_pk_bf16_f32 v22, v187, v191
    v_cvt_pk_bf16_f32 v26, v192, v196
    v_cvt_pk_bf16_f32 v30, v193, v197
    v_cvt_pk_bf16_f32 v34, v194, v198
    v_cvt_pk_bf16_f32 v38, v195, v199
    v_cvt_pk_bf16_f32 v42, v200, v204
    v_cvt_pk_bf16_f32 v46, v201, v205
    v_cvt_pk_bf16_f32 v50, v202, v206
    v_cvt_pk_bf16_f32 v54, v203, v207
    v_cvt_pk_bf16_f32 v58, v208, v212
    v_cvt_pk_bf16_f32 v62, v209, v213
    v_cvt_pk_bf16_f32 v66, v210, v214
    v_cvt_pk_bf16_f32 v70, v211, v215
    v_mfma_f32_16x16x32_bf16 v[184:187], v[136:139], v[168:171], 0
    v_mfma_f32_16x16x32_bf16 v[188:191], v[136:139], v[172:175], 0
    v_mfma_f32_16x16x32_bf16 v[192:195], v[144:147], v[168:171], 0
    v_mfma_f32_16x16x32_bf16 v[196:199], v[144:147], v[172:175], 0
    v_mfma_f32_16x16x32_bf16 v[200:203], v[152:155], v[168:171], 0
    v_mfma_f32_16x16x32_bf16 v[204:207], v[152:155], v[172:175], 0
    v_mfma_f32_16x16x32_bf16 v[208:211], v[160:163], v[168:171], 0
    v_mfma_f32_16x16x32_bf16 v[212:215], v[160:163], v[172:175], 0
    v_mfma_f32_16x16x32_bf16 v[184:187], v[140:143], v[176:179], v[184:187]
    v_mfma_f32_16x16x32_bf16 v[188:191], v[140:143], v[180:183], v[188:191]
    v_mfma_f32_16x16x32_bf16 v[192:195], v[148:151], v[176:179], v[192:195]
    v_mfma_f32_16x16x32_bf16 v[196:199], v[148:151], v[180:183], v[196:199]
    v_mfma_f32_16x16x32_bf16 v[200:203], v[156:159], v[176:179], v[200:203]
    v_mfma_f32_16x16x32_bf16 v[204:207], v[156:159], v[180:183], v[204:207]
    v_mfma_f32_16x16x32_bf16 v[208:211], v[164:167], v[176:179], v[208:211]
    v_mfma_f32_16x16x32_bf16 v[212:215], v[164:167], v[180:183], v[212:215]
    s_nop 1
    v_cvt_pk_bf16_f32 v11, v184, v188
    v_cvt_pk_bf16_f32 v15, v185, v189
    v_cvt_pk_bf16_f32 v19, v186, v190
    v_cvt_pk_bf16_f32 v23, v187, v191
    v_cvt_pk_bf16_f32 v27, v192, v196
    v_cvt_pk_bf16_f32 v31, v193, v197
    v_cvt_pk_bf16_f32 v35, v194, v198
    v_cvt_pk_bf16_f32 v39, v195, v199
    v_cvt_pk_bf16_f32 v43, v200, v204
    v_cvt_pk_bf16_f32 v47, v201, v205
    v_cvt_pk_bf16_f32 v51, v202, v206
    v_cvt_pk_bf16_f32 v55, v203, v207
    v_cvt_pk_bf16_f32 v59, v208, v212
    v_cvt_pk_bf16_f32 v63, v209, v213
    v_cvt_pk_bf16_f32 v67, v210, v214
    v_cvt_pk_bf16_f32 v71, v211, v215
    s_add_u32 s25, s24, 0
    buffer_store_dwordx4 v[8:11], v220, s[16:19], s25 offen sc1
    s_add_u32 s25, s24, 10752
    buffer_store_dwordx4 v[12:15], v220, s[16:19], s25 offen sc1
    s_add_u32 s25, s24, 21504
    buffer_store_dwordx4 v[16:19], v220, s[16:19], s25 offen sc1
    s_add_u32 s25, s24, 32256
    buffer_store_dwordx4 v[20:23], v220, s[16:19], s25 offen sc1
    s_add_u32 s25, s24, 172032
    buffer_store_dwordx4 v[24:27], v220, s[16:19], s25 offen sc1
    s_add_u32 s25, s24, 182784
    buffer_store_dwordx4 v[28:31], v220, s[16:19], s25 offen sc1
    s_add_u32 s25, s24, 193536
    buffer_store_dwordx4 v[32:35], v220, s[16:19], s25 offen sc1
    s_add_u32 s25, s24, 204288
    buffer_store_dwordx4 v[36:39], v220, s[16:19], s25 offen sc1
    s_add_u32 s25, s24, 344064
    buffer_store_dwordx4 v[40:43], v220, s[16:19], s25 offen sc1
    s_add_u32 s25, s24, 354816
    buffer_store_dwordx4 v[44:47], v220, s[16:19], s25 offen sc1
    s_add_u32 s25, s24, 365568
    buffer_store_dwordx4 v[48:51], v220, s[16:19], s25 offen sc1
    s_add_u32 s25, s24, 376320
    buffer_store_dwordx4 v[52:55], v220, s[16:19], s25 offen sc1
    s_add_u32 s25, s24, 516096
    buffer_store_dwordx4 v[56:59], v220, s[16:19], s25 offen sc1
    s_add_u32 s25, s24, 526848
    buffer_store_dwordx4 v[60:63], v220, s[16:19], s25 offen sc1
    s_add_u32 s25, s24, 537600
    buffer_store_dwordx4 v[64:67], v220, s[16:19], s25 offen sc1
    s_add_u32 s25, s24, 548352
    buffer_store_dwordx4 v[68:71], v220, s[16:19], s25 offen sc1
    s_branch L_next0
L_cw0:
    s_sub_u32 s12, s40, 672
    s_and_b32 s13, s12, 3
    s_lshr_b32 s14, s12, 2
    s_lshl_b32 s14, s14, 2
    s_add_u32 s14, s14, s10
    ds_read_b128 v[136:139], v231 offset:8192
    ds_read_b128 v[140:143], v231 offset:9216
    ds_read_b128 v[144:147], v231 offset:10240
    ds_read_b128 v[148:151], v231 offset:11264
    s_and_b32 s24, s14, 3
    s_bfe_u32 s25, s14, 0x10003
    s_lshl_b32 s25, s25, 2
    s_or_b32 s24, s24, s25
    s_lshl_b32 s24, s24, 1
    v_xor_b32 v221, s24, v217
    v_lshl_add_u32 v220, v221, 4, v235
    s_mul_i32 s24, s13, 16777216
    s_lshr_b32 s25, s14, 5
    s_mul_i32 s25, s25, 524288
    s_add_u32 s24, s24, s25
    s_and_b32 s25, s14, 31
    s_lshl_b32 s25, s25, 8
    s_add_u32 s24, s24, s25
    v_perm_b32 v24, v8, v8, s32
    v_perm_b32 v25, v12, v12, s32
    v_perm_b32 v26, v16, v16, s32
    v_perm_b32 v27, v20, v20, s32
    v_perm_b32 v28, v8, v8, s33
    v_perm_b32 v29, v12, v12, s33
    v_perm_b32 v30, v16, v16, s33
    v_perm_b32 v31, v20, v20, s33
    v_perm_b32 v32, v9, v9, s32
    v_perm_b32 v33, v13, v13, s32
    v_perm_b32 v34, v17, v17, s32
    v_perm_b32 v35, v21, v21, s32
    v_perm_b32 v36, v9, v9, s33
    v_perm_b32 v37, v13, v13, s33
    v_perm_b32 v38, v17, v17, s33
    v_perm_b32 v39, v21, v21, s33
    v_perm_b32 v40, v10, v10, s32
    v_perm_b32 v41, v14, v14, s32
    v_perm_b32 v42, v18, v18, s32
    v_perm_b32 v43, v22, v22, s32
    v_perm_b32 v44, v10, v10, s33
    v_perm_b32 v45, v14, v14, s33
    v_perm_b32 v46, v18, v18, s33
    v_perm_b32 v47, v22, v22, s33
    v_perm_b32 v48, v11, v11, s32
    v_perm_b32 v49, v15, v15, s32
    v_perm_b32 v50, v19, v19, s32
    v_perm_b32 v51, v23, v23, s32
    v_perm_b32 v52, v11, v11, s33
    v_perm_b32 v53, v15, v15, s33
    v_perm_b32 v54, v19, v19, s33
    v_perm_b32 v55, v23, v23, s33
    s_waitcnt lgkmcnt(0)
    v_mfma_f32_16x16x32_bf16 v[184:187], v[136:139], v[24:27], 0
    v_mfma_f32_16x16x32_bf16 v[188:191], v[136:139], v[28:31], 0
    v_mfma_f32_16x16x32_bf16 v[192:195], v[136:139], v[32:35], 0
    v_mfma_f32_16x16x32_bf16 v[196:199], v[136:139], v[36:39], 0
    v_mfma_f32_16x16x32_bf16 v[200:203], v[136:139], v[40:43], 0
    v_mfma_f32_16x16x32_bf16 v[204:207], v[136:139], v[44:47], 0
    v_mfma_f32_16x16x32_bf16 v[208:211], v[136:139], v[48:51], 0
    v_mfma_f32_16x16x32_bf16 v[212:215], v[136:139], v[52:55], 0
    s_nop 1
    v_cvt_pk_bf16_f32 v8, v184, v188
    s_nop 0
    v_cvt_pk_bf16_f32 v9, v192, v196
    s_nop 0
    v_cvt_pk_bf16_f32 v10, v200, v204
    s_nop 0
    v_cvt_pk_bf16_f32 v11, v208, v212
    v_cvt_pk_bf16_f32 v12, v185, v189
    v_cvt_pk_bf16_f32 v13, v193, v197
    v_cvt_pk_bf16_f32 v14, v201, v205
    v_cvt_pk_bf16_f32 v15, v209, v213
    v_cvt_pk_bf16_f32 v16, v186, v190
    v_cvt_pk_bf16_f32 v17, v194, v198
    v_cvt_pk_bf16_f32 v18, v202, v206
    v_cvt_pk_bf16_f32 v19, v210, v214
    v_cvt_pk_bf16_f32 v20, v187, v191
    v_cvt_pk_bf16_f32 v21, v195, v199
    v_cvt_pk_bf16_f32 v22, v203, v207
    v_cvt_pk_bf16_f32 v23, v211, v215
    s_add_u32 s25, s24, 0
    buffer_store_dwordx4 v[8:11], v220, s[16:19], s25 offen sc1
    s_add_u32 s25, s24, 8192
    buffer_store_dwordx4 v[12:15], v220, s[16:19], s25 offen sc1
    s_add_u32 s25, s24, 16384
    buffer_store_dwordx4 v[16:19], v220, s[16:19], s25 offen sc1
    s_add_u32 s25, s24, 24576
    buffer_store_dwordx4 v[20:23], v220, s[16:19], s25 offen sc1
    v_mfma_f32_16x16x32_bf16 v[184:187], v[140:143], v[24:27], 0
    v_mfma_f32_16x16x32_bf16 v[188:191], v[140:143], v[28:31], 0
    v_mfma_f32_16x16x32_bf16 v[192:195], v[140:143], v[32:35], 0
    v_mfma_f32_16x16x32_bf16 v[196:199], v[140:143], v[36:39], 0
    v_mfma_f32_16x16x32_bf16 v[200:203], v[140:143], v[40:43], 0
    v_mfma_f32_16x16x32_bf16 v[204:207], v[140:143], v[44:47], 0
    v_mfma_f32_16x16x32_bf16 v[208:211], v[140:143], v[48:51], 0
    v_mfma_f32_16x16x32_bf16 v[212:215], v[140:143], v[52:55], 0
    s_nop 1
    v_cvt_pk_bf16_f32 v56, v184, v188
    s_nop 0
    v_cvt_pk_bf16_f32 v57, v192, v196
    s_nop 0
    v_cvt_pk_bf16_f32 v58, v200, v204
    s_nop 0
    v_cvt_pk_bf16_f32 v59, v208, v212
    v_cvt_pk_bf16_f32 v60, v185, v189
    v_cvt_pk_bf16_f32 v61, v193, v197
    v_cvt_pk_bf16_f32 v62, v201, v205
    v_cvt_pk_bf16_f32 v63, v209, v213
    v_cvt_pk_bf16_f32 v64, v186, v190
    v_cvt_pk_bf16_f32 v65, v194, v198
    v_cvt_pk_bf16_f32 v66, v202, v206
    v_cvt_pk_bf16_f32 v67, v210, v214
    v_cvt_pk_bf16_f32 v68, v187, v191
    v_cvt_pk_bf16_f32 v69, v195, v199
    v_cvt_pk_bf16_f32 v70, v203, v207
    v_cvt_pk_bf16_f32 v71, v211, v215
    s_add_u32 s25, s24, 131072
    buffer_store_dwordx4 v[56:59], v220, s[16:19], s25 offen sc1
    s_add_u32 s25, s24, 139264
    buffer_store_dwordx4 v[60:63], v220, s[16:19], s25 offen sc1
    s_add_u32 s25, s24, 147456
    buffer_store_dwordx4 v[64:67], v220, s[16:19], s25 offen sc1
    s_add_u32 s25, s24, 155648
    buffer_store_dwordx4 v[68:71], v220, s[16:19], s25 offen sc1
    v_mfma_f32_16x16x32_bf16 v[184:187], v[144:147], v[24:27], 0
    v_mfma_f32_16x16x32_bf16 v[188:191], v[144:147], v[28:31], 0
    v_mfma_f32_16x16x32_bf16 v[192:195], v[144:147], v[32:35], 0
    v_mfma_f32_16x16x32_bf16 v[196:199], v[144:147], v[36:39], 0
    v_mfma_f32_16x16x32_bf16 v[200:203], v[144:147], v[40:43], 0
    v_mfma_f32_16x16x32_bf16 v[204:207], v[144:147], v[44:47], 0
    v_mfma_f32_16x16x32_bf16 v[208:211], v[144:147], v[48:51], 0
    v_mfma_f32_16x16x32_bf16 v[212:215], v[144:147], v[52:55], 0
    s_nop 1
    v_cvt_pk_bf16_f32 v8, v184, v188
    s_nop 0
    v_cvt_pk_bf16_f32 v9, v192, v196
    s_nop 0
    v_cvt_pk_bf16_f32 v10, v200, v204
    s_nop 0
    v_cvt_pk_bf16_f32 v11, v208, v212
    v_cvt_pk_bf16_f32 v12, v185, v189
    v_cvt_pk_bf16_f32 v13, v193, v197
    v_cvt_pk_bf16_f32 v14, v201, v205
    v_cvt_pk_bf16_f32 v15, v209, v213
    v_cvt_pk_bf16_f32 v16, v186, v190
    v_cvt_pk_bf16_f32 v17, v194, v198
    v_cvt_pk_bf16_f32 v18, v202, v206
    v_cvt_pk_bf16_f32 v19, v210, v214
    v_cvt_pk_bf16_f32 v20, v187, v191
    v_cvt_pk_bf16_f32 v21, v195, v199
    v_cvt_pk_bf16_f32 v22, v203, v207
    v_cvt_pk_bf16_f32 v23, v211, v215
    s_add_u32 s25, s24, 262144
    buffer_store_dwordx4 v[8:11], v220, s[16:19], s25 offen sc1
    s_add_u32 s25, s24, 270336
    buffer_store_dwordx4 v[12:15], v220, s[16:19], s25 offen sc1
    s_add_u32 s25, s24, 278528
    buffer_store_dwordx4 v[16:19], v220, s[16:19], s25 offen sc1
    s_add_u32 s25, s24, 286720
    buffer_store_dwordx4 v[20:23], v220, s[16:19], s25 offen sc1
    v_mfma_f32_16x16x32_bf16 v[184:187], v[148:151], v[24:27], 0
    v_mfma_f32_16x16x32_bf16 v[188:191], v[148:151], v[28:31], 0
    v_mfma_f32_16x16x32_bf16 v[192:195], v[148:151], v[32:35], 0
    v_mfma_f32_16x16x32_bf16 v[196:199], v[148:151], v[36:39], 0
    v_mfma_f32_16x16x32_bf16 v[200:203], v[148:151], v[40:43], 0
    v_mfma_f32_16x16x32_bf16 v[204:207], v[148:151], v[44:47], 0
    v_mfma_f32_16x16x32_bf16 v[208:211], v[148:151], v[48:51], 0
    v_mfma_f32_16x16x32_bf16 v[212:215], v[148:151], v[52:55], 0
    s_nop 1
    v_cvt_pk_bf16_f32 v56, v184, v188
    s_nop 0
    v_cvt_pk_bf16_f32 v57, v192, v196
    s_nop 0
    v_cvt_pk_bf16_f32 v58, v200, v204
    s_nop 0
    v_cvt_pk_bf16_f32 v59, v208, v212
    v_cvt_pk_bf16_f32 v60, v185, v189
    v_cvt_pk_bf16_f32 v61, v193, v197
    v_cvt_pk_bf16_f32 v62, v201, v205
    v_cvt_pk_bf16_f32 v63, v209, v213
    v_cvt_pk_bf16_f32 v64, v186, v190
    v_cvt_pk_bf16_f32 v65, v194, v198
    v_cvt_pk_bf16_f32 v66, v202, v206
    v_cvt_pk_bf16_f32 v67, v210, v214
    v_cvt_pk_bf16_f32 v68, v187, v191
    v_cvt_pk_bf16_f32 v69, v195, v199
    v_cvt_pk_bf16_f32 v70, v203, v207
    v_cvt_pk_bf16_f32 v71, v211, v215
    s_add_u32 s25, s24, 393216
    buffer_store_dwordx4 v[56:59], v220, s[16:19], s25 offen sc1
    s_add_u32 s25, s24, 401408
    buffer_store_dwordx4 v[60:63], v220, s[16:19], s25 offen sc1
    s_add_u32 s25, s24, 409600
    buffer_store_dwordx4 v[64:67], v220, s[16:19], s25 offen sc1
    s_add_u32 s25, s24, 417792
    buffer_store_dwordx4 v[68:71], v220, s[16:19], s25 offen sc1
L_next0:
    s_cmp_ge_u32 s42, 1696
    s_cbranch_scc1 L_w0_p0
    s_cmp_ge_u32 s42, 672
    s_cbranch_scc1 L_w8_p0
    s_waitcnt vmcnt(32)
    s_branch L_wd_p0
L_w8_p0:
    s_waitcnt vmcnt(24)
    s_branch L_wd_p0
L_w0_p0:
    s_waitcnt vmcnt(16)
L_wd_p0:
    s_cmp_lg_u32 s10, 0
    s_cbranch_scc1 L_pub0
    v_add_u32 v229, 512, v229
    v_mov_b32 v221, s41
    s_mov_b64 exec, 1
    ds_write_b32 v221, v229
    s_mov_b64 exec, -1
L_pub0:
    s_waitcnt lgkmcnt(0)
    s_barrier
    s_cmp_lg_u32 s10, 0
    s_cbranch_scc1 L_nofl0
    s_cmp_ge_u32 s55, 1696
    s_cbranch_scc1 L_nofl0
    s_lshl_b32 s24, s55, 2
    s_add_u32 s24, s24, 157286400
    v_mov_b32 v237, s54
    s_mov_b64 exec, 1
    buffer_store_dword v237, v230, s[16:19], s24 offen sc1
    s_mov_b64 exec, -1
L_nofl0:
    v_mov_b32 v221, s41
    ds_read_b32 v222, v221
    s_xor_b32 s41, s41, 4
    s_mov_b32 s55, s40
    s_mov_b32 s40, s42
    s_waitcnt lgkmcnt(0)
    v_readfirstlane_b32 s42, v222
    s_nop 3
    s_cmp_ge_u32 s42, 736
    s_cbranch_scc1 L_rm4
    s_sub_u32 s28, s42, 64
    s_add_u32 s29, s42, 672
    s_cmp_ge_u32 s42, 64
    s_cselect_b32 s42, s28, s29
L_rm4:
    s_cmp_ge_u32 s40, 1696
    s_cbranch_scc1 L_x_fin
    s_cmp_lg_u32 s43, 1
    s_cbranch_scc1 L_non_skip0
    buffer_load_dword v236, v230, s[44:47], 0 offen offset:128 sc1
L_non_skip0:
    s_cmp_lg_u32 s10, 0
    s_cbranch_scc1 L_nofetch1
    v_mov_b32 v229, 1
    s_mov_b64 exec, 1
    buffer_atomic_add v229, v230, s[44:47], 0 offen sc0 sc1
    s_mov_b64 exec, -1
L_nofetch1:
    s_cmp_ge_u32 s42, 1696
    s_cbranch_scc1 L_ld_done5
    s_cmp_ge_u32 s42, 672
    s_cbranch_scc1 L_ld_w5
    s_cmp_ge_u32 s42, 336
    s_cselect_b32 s11, 1, 0
    s_mul_i32 s12, s11, 336
    s_sub_u32 s12, s42, s12
    s_and_b32 s13, s12, 7
    s_lshr_b32 s14, s12, 3
    s_lshl_b32 s14, s14, 2
    s_add_u32 s14, s14, s10
    s_mul_i32 s15, s11, 16384000
    s_add_u32 s34, s4, s15
    s_addc_u32 s35, s5, 0
    s_mov_b32 s20, s34
    s_and_b32 s21, s35, 0xffff
    s_mov_b32 s22, 16384000
    s_mov_b32 s23, 0x00020000
    s_mul_i32 s15, s14, 98304
    s_lshl_b32 s24, s13, 8
    s_add_u32 s15, s15, s24
    s_add_u32 s25, s15, 0
    buffer_load_dwordx4 v[8:11], v232, s[20:23], s25 offen
    s_add_u32 s25, s15, 2048
    buffer_load_dwordx4 v[12:15], v232, s[20:23], s25 offen
    s_add_u32 s25, s15, 4096
    buffer_load_dwordx4 v[16:19], v232, s[20:23], s25 offen
    s_add_u32 s25, s15, 6144
    buffer_load_dwordx4 v[20:23], v232, s[20:23], s25 offen
    s_add_u32 s25, s15, 8192
    buffer_load_dwordx4 v[24:27], v232, s[20:23], s25 offen
    s_add_u32 s25, s15, 10240
    buffer_load_dwordx4 v[28:31], v232, s[20:23], s25 offen
    s_add_u32 s25, s15, 12288
    buffer_load_dwordx4 v[32:35], v232, s[20:23], s25 offen
    s_add_u32 s25, s15, 14336
    buffer_load_dwordx4 v[36:39], v232, s[20:23], s25 offen
    s_add_u32 s25, s15, 65536
    buffer_load_dwordx4 v[40:43], v232, s[20:23], s25 offen
    s_add_u32 s25, s15, 67584
    buffer_load_dwordx4 v[44:47], v232, s[20:23], s25 offen
    s_add_u32 s25, s15, 69632
    buffer_load_dwordx4 v[48:51], v232, s[20:23], s25 offen
    s_add_u32 s25, s15, 71680
    buffer_load_dwordx4 v[52:55], v232, s[20:23], s25 offen
    s_add_u32 s25, s15, 73728
    buffer_load_dwordx4 v[56:59], v232, s[20:23], s25 offen
    s_add_u32 s25, s15, 75776
    buffer_load_dwordx4 v[60:63], v232, s[20:23], s25 offen
    s_add_u32 s25, s15, 77824
    buffer_load_dwordx4 v[64:67], v232, s[20:23], s25 offen
    s_add_u32 s25, s15, 79872
    buffer_load_dwordx4 v[68:71], v232, s[20:23], s25 offen
    s_branch L_ld_done5
L_ld_w5:
    s_sub_u32 s12, s42, 672
    s_and_b32 s13, s12, 3
    s_lshr_b32 s14, s12, 2
    s_lshl_b32 s14, s14, 2
    s_add_u32 s14, s14, s10
    s_mov_b32 s20, s6
    s_and_b32 s21, s7, 0xffff
    s_mov_b32 s22, 16252928
    s_mov_b32 s23, 0x00020000
    s_lshl_b32 s15, s14, 10
    s_lshl_b32 s24, s13, 8
    s_add_u32 s15, s15, s24
    s_add_u32 s25, s15, 0
    buffer_load_dwordx2 v[8:9], v233, s[20:23], s25 offen
    buffer_load_dwordx2 v[10:11], v233, s[20:23], s25 offen offset:16
    s_add_u32 s25, s15, 1048576
    buffer_load_dwordx2 v[12:13], v233, s[20:23], s25 offen
    buffer_load_dwordx2 v[14:15], v233, s[20:23], s25 offen offset:16
    s_add_u32 s25, s15, 2097152
    buffer_load_dwordx2 v[16:17], v233, s[20:23], s25 offen
    buffer_load_dwordx2 v[18:19], v233, s[20:23], s25 offen offset:16
    s_add_u32 s25, s15, 3145728
    buffer_load_dwordx2 v[20:21], v233, s[20:23], s25 offen
    buffer_load_dwordx2 v[22:23], v233, s[20:23], s25 offen offset:16
L_ld_done5:
    s_cmp_ge_u32 s42, 1696
    s_cbranch_scc1 L_w0_a1
    s_cmp_ge_u32 s42, 672
    s_cbranch_scc1 L_w8_a1
    s_waitcnt vmcnt(32)
    s_branch L_wd_a1
L_w8_a1:
    s_waitcnt vmcnt(24)
    s_branch L_wd_a1
L_w0_a1:
    s_waitcnt vmcnt(16)
L_wd_a1:
    s_cmp_ge_u32 s40, 672
    s_cbranch_scc1 L_cw1
    s_cmp_ge_u32 s40, 336
    s_cselect_b32 s11, 1, 0
    s_mul_i32 s12, s11, 336
    s_sub_u32 s12, s40, s12
    s_and_b32 s13, s12, 7
    s_lshr_b32 s14, s12, 3
    s_lshl_b32 s14, s14, 2
    s_add_u32 s14, s14, s10
    ds_read_b128 v[136:139], v231 offset:0
    ds_read_b128 v[140:143], v231 offset:1024
    ds_read_b128 v[144:147], v231 offset:2048
    ds_read_b128 v[148:151], v231 offset:3072
    ds_read_b128 v[152:155], v231 offset:4096
    ds_read_b128 v[156:159], v231 offset:5120
    ds_read_b128 v[160:163], v231 offset:6144
    ds_read_b128 v[164:167], v231 offset:7168
    s_bfe_u32 s24, s14, 0x10003
    s_mul_i32 s24, s24, 3
    v_and_b32 v221, 3, v217
    v_xor_b32 v221, s24, v221
    v_lshl_add_u32 v220, v221, 4, v234
    s_mul_i32 s24, s11, 22020096
    s_mul_i32 s25, s13, 2752512
    s_add_u32 s24, s24, s25
    s_lshl_b32 s25, s14, 6
    s_add_u32 s24, s24, s25
    s_add_u32 s24, s24, 67108864
    v_perm_b32 v168, v76, v72, s30
    v_perm_b32 v169, v84, v80, s30
    v_perm_b32 v170, v92, v88, s30
    v_perm_b32 v171, v100, v96, s30
    v_perm_b32 v172, v76, v72, s31
    v_perm_b32 v173, v84, v80, s31
    v_perm_b32 v174, v92, v88, s31
    v_perm_b32 v175, v100, v96, s31
    v_perm_b32 v176, v108, v104, s30
    v_perm_b32 v177, v116, v112, s30
    v_perm_b32 v178, v124, v120, s30
    v_perm_b32 v179, v132, v128, s30
    v_perm_b32 v180, v108, v104, s31
    v_perm_b32 v181, v116, v112, s31
    v_perm_b32 v182, v124, v120, s31
    v_perm_b32 v183, v132, v128, s31
    s_waitcnt lgkmcnt(0)
    v_mfma_f32_16x16x32_bf16 v[184:187], v[136:139], v[168:171], 0
    v_mfma_f32_16x16x32_bf16 v[188:191], v[136:139], v[172:175], 0
    v_mfma_f32_16x16x32_bf16 v[192:195], v[144:147], v[168:171], 0
    v_mfma_f32_16x16x32_bf16 v[196:199], v[144:147], v[172:175], 0
    v_mfma_f32_16x16x32_bf16 v[200:203], v[152:155], v[168:171], 0
    v_mfma_f32_16x16x32_bf16 v[204:207], v[152:155], v[172:175], 0
    v_mfma_f32_16x16x32_bf16 v[208:211], v[160:163], v[168:171], 0
    v_mfma_f32_16x16x32_bf16 v[212:215], v[160:163], v[172:175], 0
    v_mfma_f32_16x16x32_bf16 v[184:187], v[140:143], v[176:179], v[184:187]
    v_mfma_f32_16x16x32_bf16 v[188:191], v[140:143], v[180:183], v[188:191]
    v_mfma_f32_16x16x32_bf16 v[192:195], v[148:151], v[176:179], v[192:195]
    v_mfma_f32_16x16x32_bf16 v[196:199], v[148:151], v[180:183], v[196:199]
    v_mfma_f32_16x16x32_bf16 v[200:203], v[156:159], v[176:179], v[200:203]
    v_mfma_f32_16x16x32_bf16 v[204:207], v[156:159], v[180:183], v[204:207]
    v_mfma_f32_16x16x32_bf16 v[208:211], v[164:167], v[176:179], v[208:211]
    v_mfma_f32_16x16x32_bf16 v[212:215], v[164:167], v[180:183], v[212:215]
    v_perm_b32 v168, v77, v73, s30
    v_perm_b32 v169, v85, v81, s30
    v_perm_b32 v170, v93, v89, s30
    v_perm_b32 v171, v101, v97, s30
    v_perm_b32 v172, v77, v73, s31
    v_perm_b32 v173, v85, v81, s31
    v_perm_b32 v174, v93, v89, s31
    v_perm_b32 v175, v101, v97, s31
    v_perm_b32 v176, v109, v105, s30
    v_perm_b32 v177, v117, v113, s30
    v_perm_b32 v178, v125, v121, s30
    v_perm_b32 v179, v133, v129, s30
    v_perm_b32 v180, v109, v105, s31
    v_perm_b32 v181, v117, v113, s31
    v_perm_b32 v182, v125, v121, s31
    v_perm_b32 v183, v133, v129, s31
    v_cvt_pk_bf16_f32 v72, v184, v188
    v_cvt_pk_bf16_f32 v76, v185, v189
    v_cvt_pk_bf16_f32 v80, v186, v190
    v_cvt_pk_bf16_f32 v84, v187, v191
    v_cvt_pk_bf16_f32 v88, v192, v196
    v_cvt_pk_bf16_f32 v92, v193, v197
    v_cvt_pk_bf16_f32 v96, v194, v198
    v_cvt_pk_bf16_f32 v100, v195, v199
    v_cvt_pk_bf16_f32 v104, v200, v204
    v_cvt_pk_bf16_f32 v108, v201, v205
    v_cvt_pk_bf16_f32 v112, v202, v206
    v_cvt_pk_bf16_f32 v116, v203, v207
    v_cvt_pk_bf16_f32 v120, v208, v212
    v_cvt_pk_bf16_f32 v124, v209, v213
    v_cvt_pk_bf16_f32 v128, v210, v214
    v_cvt_pk_bf16_f32 v132, v211, v215
    v_mfma_f32_16x16x32_bf16 v[184:187], v[136:139], v[168:171], 0
    v_mfma_f32_16x16x32_bf16 v[188:191], v[136:139], v[172:175], 0
    v_mfma_f32_16x16x32_bf16 v[192:195], v[144:147], v[168:171], 0
    v_mfma_f32_16x16x32_bf16 v[196:199], v[144:147], v[172:175], 0
    v_mfma_f32_16x16x32_bf16 v[200:203], v[152:155], v[168:171], 0
    v_mfma_f32_16x16x32_bf16 v[204:207], v[152:155], v[172:175], 0
    v_mfma_f32_16x16x32_bf16 v[208:211], v[160:163], v[168:171], 0
    v_mfma_f32_16x16x32_bf16 v[212:215], v[160:163], v[172:175], 0
    v_mfma_f32_16x16x32_bf16 v[184:187], v[140:143], v[176:179], v[184:187]
    v_mfma_f32_16x16x32_bf16 v[188:191], v[140:143], v[180:183], v[188:191]
    v_mfma_f32_16x16x32_bf16 v[192:195], v[148:151], v[176:179], v[192:195]
    v_mfma_f32_16x16x32_bf16 v[196:199], v[148:151], v[180:183], v[196:199]
    v_mfma_f32_16x16x32_bf16 v[200:203], v[156:159], v[176:179], v[200:203]
    v_mfma_f32_16x16x32_bf16 v[204:207], v[156:159], v[180:183], v[204:207]
    v_mfma_f32_16x16x32_bf16 v[208:211], v[164:167], v[176:179], v[208:211]
    v_mfma_f32_16x16x32_bf16 v[212:215], v[164:167], v[180:183], v[212:215]
    v_perm_b32 v168, v78, v74, s30
    v_perm_b32 v169, v86, v82, s30
    v_perm_b32 v170, v94, v90, s30
    v_perm_b32 v171, v102, v98, s30
    v_perm_b32 v172, v78, v74, s31
    v_perm_b32 v173, v86, v82, s31
    v_perm_b32 v174, v94, v90, s31
    v_perm_b32 v175, v102, v98, s31
    v_perm_b32 v176, v110, v106, s30
    v_perm_b32 v177, v118, v114, s30
    v_perm_b32 v178, v126, v122, s30
    v_perm_b32 v179, v134, v130, s30
    v_perm_b32 v180, v110, v106, s31
    v_perm_b32 v181, v118, v114, s31
    v_perm_b32 v182, v126, v122, s31
    v_perm_b32 v183, v134, v130, s31
    v_cvt_pk_bf16_f32 v73, v184, v188
    v_cvt_pk_bf16_f32 v77, v185, v189
    v_cvt_pk_bf16_f32 v81, v186, v190
    v_cvt_pk_bf16_f32 v85, v187, v191
    v_cvt_pk_bf16_f32 v89, v192, v196
    v_cvt_pk_bf16_f32 v93, v193, v197
    v_cvt_pk_bf16_f32 v97, v194, v198
    v_cvt_pk_bf16_f32 v101, v195, v199
    v_cvt_pk_bf16_f32 v105, v200, v204
    v_cvt_pk_bf16_f32 v109, v201, v205
    v_cvt_pk_bf16_f32 v113, v202, v206
    v_cvt_pk_bf16_f32 v117, v203, v207
    v_cvt_pk_bf16_f32 v121, v208, v212
    v_cvt_pk_bf16_f32 v125, v209, v213
    v_cvt_pk_bf16_f32 v129, v210, v214
    v_cvt_pk_bf16_f32 v133, v211, v215
    v_mfma_f32_16x16x32_bf16 v[184:187], v[136:139], v[168:171], 0
    v_mfma_f32_16x16x32_bf16 v[188:191], v[136:139], v[172:175], 0
    v_mfma_f32_16x16x32_bf16 v[192:195], v[144:147], v[168:171], 0
    v_mfma_f32_16x16x32_bf16 v[196:199], v[144:147], v[172:175], 0
    v_mfma_f32_16x16x32_bf16 v[200:203], v[152:155], v[168:171], 0
    v_mfma_f32_16x16x32_bf16 v[204:207], v[152:155], v[172:175], 0
    v_mfma_f32_16x16x32_bf16 v[208:211], v[160:163], v[168:171], 0
    v_mfma_f32_16x16x32_bf16 v[212:215], v[160:163], v[172:175], 0
    v_mfma_f32_16x16x32_bf16 v[184:187], v[140:143], v[176:179], v[184:187]
    v_mfma_f32_16x16x32_bf16 v[188:191], v[140:143], v[180:183], v[188:191]
    v_mfma_f32_16x16x32_bf16 v[192:195], v[148:151], v[176:179], v[192:195]
    v_mfma_f32_16x16x32_bf16 v[196:199], v[148:151], v[180:183], v[196:199]
    v_mfma_f32_16x16x32_bf16 v[200:203], v[156:159], v[176:179], v[200:203]
    v_mfma_f32_16x16x32_bf16 v[204:207], v[156:159], v[180:183], v[204:207]
    v_mfma_f32_16x16x32_bf16 v[208:211], v[164:167], v[176:179], v[208:211]
    v_mfma_f32_16x16x32_bf16 v[212:215], v[164:167], v[180:183], v[212:215]
    v_perm_b32 v168, v79, v75, s30
    v_perm_b32 v169, v87, v83, s30
    v_perm_b32 v170, v95, v91, s30
    v_perm_b32 v171, v103, v99, s30
    v_perm_b32 v172, v79, v75, s31
    v_perm_b32 v173, v87, v83, s31
    v_perm_b32 v174, v95, v91, s31
    v_perm_b32 v175, v103, v99, s31
    v_perm_b32 v176, v111, v107, s30
    v_perm_b32 v177, v119, v115, s30
    v_perm_b32 v178, v127, v123, s30
    v_perm_b32 v179, v135, v131, s30
    v_perm_b32 v180, v111, v107, s31
    v_perm_b32 v181, v119, v115, s31
    v_perm_b32 v182, v127, v123, s31
    v_perm_b32 v183, v135, v131, s31
    v_cvt_pk_bf16_f32 v74, v184, v188
    v_cvt_pk_bf16_f32 v78, v185, v189
    v_cvt_pk_bf16_f32 v82, v186, v190
    v_cvt_pk_bf16_f32 v86, v187, v191
    v_cvt_pk_bf16_f32 v90, v192, v196
    v_cvt_pk_bf16_f32 v94, v193, v197
    v_cvt_pk_bf16_f32 v98, v194, v198
    v_cvt_pk_bf16_f32 v102, v195, v199
    v_cvt_pk_bf16_f32 v106, v200, v204
    v_cvt_pk_bf16_f32 v110, v201, v205
    v_cvt_pk_bf16_f32 v114, v202, v206
    v_cvt_pk_bf16_f32 v118, v203, v207
    v_cvt_pk_bf16_f32 v122, v208, v212
    v_cvt_pk_bf16_f32 v126, v209, v213
    v_cvt_pk_bf16_f32 v130, v210, v214
    v_cvt_pk_bf16_f32 v134, v211, v215
    v_mfma_f32_16x16x32_bf16 v[184:187], v[136:139], v[168:171], 0
    v_mfma_f32_16x16x32_bf16 v[188:191], v[136:139], v[172:175], 0
    v_mfma_f32_16x16x32_bf16 v[192:195], v[144:147], v[168:171], 0
    v_mfma_f32_16x16x32_bf16 v[196:199], v[144:147], v[172:175], 0
    v_mfma_f32_16x16x32_bf16 v[200:203], v[152:155], v[168:171], 0
    v_mfma_f32_16x16x32_bf16 v[204:207], v[152:155], v[172:175], 0
    v_mfma_f32_16x16x32_bf16 v[208:211], v[160:163], v[168:171], 0
    v_mfma_f32_16x16x32_bf16 v[212:215], v[160:163], v[172:175], 0
    v_mfma_f32_16x16x32_bf16 v[184:187], v[140:143], v[176:179], v[184:187]
    v_mfma_f32_16x16x32_bf16 v[188:191], v[140:143], v[180:183], v[188:191]
    v_mfma_f32_16x16x32_bf16 v[192:195], v[148:151], v[176:179], v[192:195]
    v_mfma_f32_16x16x32_bf16 v[196:199], v[148:151], v[180:183], v[196:199]
    v_mfma_f32_16x16x32_bf16 v[200:203], v[156:159], v[176:179], v[200:203]
    v_mfma_f32_16x16x32_bf16 v[204:207], v[156:159], v[180:183], v[204:207]
    v_mfma_f32_16x16x32_bf16 v[208:211], v[164:167], v[176:179], v[208:211]
    v_mfma_f32_16x16x32_bf16 v[212:215], v[164:167], v[180:183], v[212:215]
    s_nop 1
    v_cvt_pk_bf16_f32 v75, v184, v188
    v_cvt_pk_bf16_f32 v79, v185, v189
    v_cvt_pk_bf16_f32 v83, v186, v190
    v_cvt_pk_bf16_f32 v87, v187, v191
    v_cvt_pk_bf16_f32 v91, v192, v196
    v_cvt_pk_bf16_f32 v95, v193, v197
    v_cvt_pk_bf16_f32 v99, v194, v198
    v_cvt_pk_bf16_f32 v103, v195, v199
    v_cvt_pk_bf16_f32 v107, v200, v204
    v_cvt_pk_bf16_f32 v111, v201, v205
    v_cvt_pk_bf16_f32 v115, v202, v206
    v_cvt_pk_bf16_f32 v119, v203, v207
    v_cvt_pk_bf16_f32 v123, v208, v212
    v_cvt_pk_bf16_f32 v127, v209, v213
    v_cvt_pk_bf16_f32 v131, v210, v214
    v_cvt_pk_bf16_f32 v135, v211, v215
    s_add_u32 s25, s24, 0
    buffer_store_dwordx4 v[72:75], v220, s[16:19], s25 offen sc1
    s_add_u32 s25, s24, 10752
    buffer_store_dwordx4 v[76:79], v220, s[16:19], s25 offen sc1
    s_add_u32 s25, s24, 21504
    buffer_store_dwordx4 v[80:83], v220, s[16:19], s25 offen sc1
    s_add_u32 s25, s24, 32256
    buffer_store_dwordx4 v[84:87], v220, s[16:19], s25 offen sc1
    s_add_u32 s25, s24, 172032
    buffer_store_dwordx4 v[88:91], v220, s[16:19], s25 offen sc1
    s_add_u32 s25, s24, 182784
    buffer_store_dwordx4 v[92:95], v220, s[16:19], s25 offen sc1
    s_add_u32 s25, s24, 193536
    buffer_store_dwordx4 v[96:99], v220, s[16:19], s25 offen sc1
    s_add_u32 s25, s24, 204288
    buffer_store_dwordx4 v[100:103], v220, s[16:19], s25 offen sc1
    s_add_u32 s25, s24, 344064
    buffer_store_dwordx4 v[104:107], v220, s[16:19], s25 offen sc1
    s_add_u32 s25, s24, 354816
    buffer_store_dwordx4 v[108:111], v220, s[16:19], s25 offen sc1
    s_add_u32 s25, s24, 365568
    buffer_store_dwordx4 v[112:115], v220, s[16:19], s25 offen sc1
    s_add_u32 s25, s24, 376320
    buffer_store_dwordx4 v[116:119], v220, s[16:19], s25 offen sc1
    s_add_u32 s25, s24, 516096
    buffer_store_dwordx4 v[120:123], v220, s[16:19], s25 offen sc1
    s_add_u32 s25, s24, 526848
    buffer_store_dwordx4 v[124:127], v220, s[16:19], s25 offen sc1
    s_add_u32 s25, s24, 537600
    buffer_store_dwordx4 v[128:131], v220, s[16:19], s25 offen sc1
    s_add_u32 s25, s24, 548352
    buffer_store_dwordx4 v[132:135], v220, s[16:19], s25 offen sc1
    s_branch L_next1
L_cw1:
    s_sub_u32 s12, s40, 672
    s_and_b32 s13, s12, 3
    s_lshr_b32 s14, s12, 2
    s_lshl_b32 s14, s14, 2
    s_add_u32 s14, s14, s10
    ds_read_b128 v[136:139], v231 offset:8192
    ds_read_b128 v[140:143], v231 offset:9216
    ds_read_b128 v[144:147], v231 offset:10240
    ds_read_b128 v[148:151], v231 offset:11264
    s_and_b32 s24, s14, 3
    s_bfe_u32 s25, s14, 0x10003
    s_lshl_b32 s25, s25, 2
    s_or_b32 s24, s24, s25
    s_lshl_b32 s24, s24, 1
    v_xor_b32 v221, s24, v217
    v_lshl_add_u32 v220, v221, 4, v235
    s_mul_i32 s24, s13, 16777216
    s_lshr_b32 s25, s14, 5
    s_mul_i32 s25, s25, 524288
    s_add_u32 s24, s24, s25
    s_and_b32 s25, s14, 31
    s_lshl_b32 s25, s25, 8
    s_add_u32 s24, s24, s25
    v_perm_b32 v88, v72, v72, s32
    v_perm_b32 v89, v76, v76, s32
    v_perm_b32 v90, v80, v80, s32
    v_perm_b32 v91, v84, v84, s32
    v_perm_b32 v92, v72, v72, s33
    v_perm_b32 v93, v76, v76, s33
    v_perm_b32 v94, v80, v80, s33
    v_perm_b32 v95, v84, v84, s33
    v_perm_b32 v96, v73, v73, s32
    v_perm_b32 v97, v77, v77, s32
    v_perm_b32 v98, v81, v81, s32
    v_perm_b32 v99, v85, v85, s32
    v_perm_b32 v100, v73, v73, s33
    v_perm_b32 v101, v77, v77, s33
    v_perm_b32 v102, v81, v81, s33
    v_perm_b32 v103, v85, v85, s33
    v_perm_b32 v104, v74, v74, s32
    v_perm_b32 v105, v78, v78, s32
    v_perm_b32 v106, v82, v82, s32
    v_perm_b32 v107, v86, v86, s32
    v_perm_b32 v108, v74, v74, s33
    v_perm_b32 v109, v78, v78, s33
    v_perm_b32 v110, v82, v82, s33
    v_perm_b32 v111, v86, v86, s33
    v_perm_b32 v112, v75, v75, s32
    v_perm_b32 v113, v79, v79, s32
    v_perm_b32 v114, v83, v83, s32
    v_perm_b32 v115, v87, v87, s32
    v_perm_b32 v116, v75, v75, s33
    v_perm_b32 v117, v79, v79, s33
    v_perm_b32 v118, v83, v83, s33
    v_perm_b32 v119, v87, v87, s33
    s_waitcnt lgkmcnt(0)
    v_mfma_f32_16x16x32_bf16 v[184:187], v[136:139], v[88:91], 0
    v_mfma_f32_16x16x32_bf16 v[188:191], v[136:139], v[92:95], 0
    v_mfma_f32_16x16x32_bf16 v[192:195], v[136:139], v[96:99], 0
    v_mfma_f32_16x16x32_bf16 v[196:199], v[136:139], v[100:103], 0
    v_mfma_f32_16x16x32_bf16 v[200:203], v[136:139], v[104:107], 0
    v_mfma_f32_16x16x32_bf16 v[204:207], v[136:139], v[108:111], 0
    v_mfma_f32_16x16x32_bf16 v[208:211], v[136:139], v[112:115], 0
    v_mfma_f32_16x16x32_bf16 v[212:215], v[136:139], v[116:119], 0
    s_nop 1
    v_cvt_pk_bf16_f32 v72, v184, v188
    s_nop 0
    v_cvt_pk_bf16_f32 v73, v192, v196
    s_nop 0
    v_cvt_pk_bf16_f32 v74, v200, v204
    s_nop 0
    v_cvt_pk_bf16_f32 v75, v208, v212
    v_cvt_pk_bf16_f32 v76, v185, v189
    v_cvt_pk_bf16_f32 v77, v193, v197
    v_cvt_pk_bf16_f32 v78, v201, v205
    v_cvt_pk_bf16_f32 v79, v209, v213
    v_cvt_pk_bf16_f32 v80, v186, v190
    v_cvt_pk_bf16_f32 v81, v194, v198
    v_cvt_pk_bf16_f32 v82, v202, v206
    v_cvt_pk_bf16_f32 v83, v210, v214
    v_cvt_pk_bf16_f32 v84, v187, v191
    v_cvt_pk_bf16_f32 v85, v195, v199
    v_cvt_pk_bf16_f32 v86, v203, v207
    v_cvt_pk_bf16_f32 v87, v211, v215
    s_add_u32 s25, s24, 0
    buffer_store_dwordx4 v[72:75], v220, s[16:19], s25 offen sc1
    s_add_u32 s25, s24, 8192
    buffer_store_dwordx4 v[76:79], v220, s[16:19], s25 offen sc1
    s_add_u32 s25, s24, 16384
    buffer_store_dwordx4 v[80:83], v220, s[16:19], s25 offen sc1
    s_add_u32 s25, s24, 24576
    buffer_store_dwordx4 v[84:87], v220, s[16:19], s25 offen sc1
    v_mfma_f32_16x16x32_bf16 v[184:187], v[140:143], v[88:91], 0
    v_mfma_f32_16x16x32_bf16 v[188:191], v[140:143], v[92:95], 0
    v_mfma_f32_16x16x32_bf16 v[192:195], v[140:143], v[96:99], 0
    v_mfma_f32_16x16x32_bf16 v[196:199], v[140:143], v[100:103], 0
    v_mfma_f32_16x16x32_bf16 v[200:203], v[140:143], v[104:107], 0
    v_mfma_f32_16x16x32_bf16 v[204:207], v[140:143], v[108:111], 0
    v_mfma_f32_16x16x32_bf16 v[208:211], v[140:143], v[112:115], 0
    v_mfma_f32_16x16x32_bf16 v[212:215], v[140:143], v[116:119], 0
    s_nop 1
    v_cvt_pk_bf16_f32 v120, v184, v188
    s_nop 0
    v_cvt_pk_bf16_f32 v121, v192, v196
    s_nop 0
    v_cvt_pk_bf16_f32 v122, v200, v204
    s_nop 0
    v_cvt_pk_bf16_f32 v123, v208, v212
    v_cvt_pk_bf16_f32 v124, v185, v189
    v_cvt_pk_bf16_f32 v125, v193, v197
    v_cvt_pk_bf16_f32 v126, v201, v205
    v_cvt_pk_bf16_f32 v127, v209, v213
    v_cvt_pk_bf16_f32 v128, v186, v190
    v_cvt_pk_bf16_f32 v129, v194, v198
    v_cvt_pk_bf16_f32 v130, v202, v206
    v_cvt_pk_bf16_f32 v131, v210, v214
    v_cvt_pk_bf16_f32 v132, v187, v191
    v_cvt_pk_bf16_f32 v133, v195, v199
    v_cvt_pk_bf16_f32 v134, v203, v207
    v_cvt_pk_bf16_f32 v135, v211, v215
    s_add_u32 s25, s24, 131072
    buffer_store_dwordx4 v[120:123], v220, s[16:19], s25 offen sc1
    s_add_u32 s25, s24, 139264
    buffer_store_dwordx4 v[124:127], v220, s[16:19], s25 offen sc1
    s_add_u32 s25, s24, 147456
    buffer_store_dwordx4 v[128:131], v220, s[16:19], s25 offen sc1
    s_add_u32 s25, s24, 155648
    buffer_store_dwordx4 v[132:135], v220, s[16:19], s25 offen sc1
    v_mfma_f32_16x16x32_bf16 v[184:187], v[144:147], v[88:91], 0
    v_mfma_f32_16x16x32_bf16 v[188:191], v[144:147], v[92:95], 0
    v_mfma_f32_16x16x32_bf16 v[192:195], v[144:147], v[96:99], 0
    v_mfma_f32_16x16x32_bf16 v[196:199], v[144:147], v[100:103], 0
    v_mfma_f32_16x16x32_bf16 v[200:203], v[144:147], v[104:107], 0
    v_mfma_f32_16x16x32_bf16 v[204:207], v[144:147], v[108:111], 0
    v_mfma_f32_16x16x32_bf16 v[208:211], v[144:147], v[112:115], 0
    v_mfma_f32_16x16x32_bf16 v[212:215], v[144:147], v[116:119], 0
    s_nop 1
    v_cvt_pk_bf16_f32 v72, v184, v188
    s_nop 0
    v_cvt_pk_bf16_f32 v73, v192, v196
    s_nop 0
    v_cvt_pk_bf16_f32 v74, v200, v204
    s_nop 0
    v_cvt_pk_bf16_f32 v75, v208, v212
    v_cvt_pk_bf16_f32 v76, v185, v189
    v_cvt_pk_bf16_f32 v77, v193, v197
    v_cvt_pk_bf16_f32 v78, v201, v205
    v_cvt_pk_bf16_f32 v79, v209, v213
    v_cvt_pk_bf16_f32 v80, v186, v190
    v_cvt_pk_bf16_f32 v81, v194, v198
    v_cvt_pk_bf16_f32 v82, v202, v206
    v_cvt_pk_bf16_f32 v83, v210, v214
    v_cvt_pk_bf16_f32 v84, v187, v191
    v_cvt_pk_bf16_f32 v85, v195, v199
    v_cvt_pk_bf16_f32 v86, v203, v207
    v_cvt_pk_bf16_f32 v87, v211, v215
    s_add_u32 s25, s24, 262144
    buffer_store_dwordx4 v[72:75], v220, s[16:19], s25 offen sc1
    s_add_u32 s25, s24, 270336
    buffer_store_dwordx4 v[76:79], v220, s[16:19], s25 offen sc1
    s_add_u32 s25, s24, 278528
    buffer_store_dwordx4 v[80:83], v220, s[16:19], s25 offen sc1
    s_add_u32 s25, s24, 286720
    buffer_store_dwordx4 v[84:87], v220, s[16:19], s25 offen sc1
    v_mfma_f32_16x16x32_bf16 v[184:187], v[148:151], v[88:91], 0
    v_mfma_f32_16x16x32_bf16 v[188:191], v[148:151], v[92:95], 0
    v_mfma_f32_16x16x32_bf16 v[192:195], v[148:151], v[96:99], 0
    v_mfma_f32_16x16x32_bf16 v[196:199], v[148:151], v[100:103], 0
    v_mfma_f32_16x16x32_bf16 v[200:203], v[148:151], v[104:107], 0
    v_mfma_f32_16x16x32_bf16 v[204:207], v[148:151], v[108:111], 0
    v_mfma_f32_16x16x32_bf16 v[208:211], v[148:151], v[112:115], 0
    v_mfma_f32_16x16x32_bf16 v[212:215], v[148:151], v[116:119], 0
    s_nop 1
    v_cvt_pk_bf16_f32 v120, v184, v188
    s_nop 0
    v_cvt_pk_bf16_f32 v121, v192, v196
    s_nop 0
    v_cvt_pk_bf16_f32 v122, v200, v204
    s_nop 0
    v_cvt_pk_bf16_f32 v123, v208, v212
    v_cvt_pk_bf16_f32 v124, v185, v189
    v_cvt_pk_bf16_f32 v125, v193, v197
    v_cvt_pk_bf16_f32 v126, v201, v205
    v_cvt_pk_bf16_f32 v127, v209, v213
    v_cvt_pk_bf16_f32 v128, v186, v190
    v_cvt_pk_bf16_f32 v129, v194, v198
    v_cvt_pk_bf16_f32 v130, v202, v206
    v_cvt_pk_bf16_f32 v131, v210, v214
    v_cvt_pk_bf16_f32 v132, v187, v191
    v_cvt_pk_bf16_f32 v133, v195, v199
    v_cvt_pk_bf16_f32 v134, v203, v207
    v_cvt_pk_bf16_f32 v135, v211, v215
    s_add_u32 s25, s24, 393216
    buffer_store_dwordx4 v[120:123], v220, s[16:19], s25 offen sc1
    s_add_u32 s25, s24, 401408
    buffer_store_dwordx4 v[124:127], v220, s[16:19], s25 offen sc1
    s_add_u32 s25, s24, 409600
    buffer_store_dwordx4 v[128:131], v220, s[16:19], s25 offen sc1
    s_add_u32 s25, s24, 417792
    buffer_store_dwordx4 v[132:135], v220, s[16:19], s25 offen sc1
L_next1:
    s_cmp_ge_u32 s42, 1696
    s_cbranch_scc1 L_w0_p1
    s_cmp_ge_u32 s42, 672
    s_cbranch_scc1 L_w8_p1
    s_waitcnt vmcnt(32)
    s_branch L_wd_p1
L_w8_p1:
    s_waitcnt vmcnt(24)
    s_branch L_wd_p1
L_w0_p1:
    s_waitcnt vmcnt(16)
L_wd_p1:
    s_cmp_lg_u32 s43, 1
    s_cbranch_scc1 L_nonok
    s_mov_b32 s43, 2
    s_mov_b32 s57, 32768
L_non:
    v_readfirstlane_b32 s54, v236
    s_nop 3
    s_cmp_lg_u32 s54, 0
    s_cbranch_scc1 L_nonok
    s_sub_u32 s57, s57, 1
    s_cmp_eq_u32 s57, 0
    s_cbranch_scc1 L_nonok
    buffer_load_dword v236, v230, s[44:47], 0 offen offset:128 sc1
    s_waitcnt vmcnt(0)
    s_branch L_non
L_nonok:
    s_cmp_lg_u32 s10, 0
    s_cbranch_scc1 L_pub1
    v_add_u32 v229, 512, v229
    v_mov_b32 v221, s41
    s_mov_b64 exec, 1
    ds_write_b32 v221, v229
    s_mov_b64 exec, -1
L_pub1:
    s_waitcnt lgkmcnt(0)
    s_barrier
    s_cmp_lg_u32 s10, 0
    s_cbranch_scc1 L_nofl1
    s_cmp_ge_u32 s55, 1696
    s_cbranch_scc1 L_nofl1
    s_lshl_b32 s24, s55, 2
    s_add_u32 s24, s24, 157286400
    v_mov_b32 v237, s54
    s_mov_b64 exec, 1
    buffer_store_dword v237, v230, s[16:19], s24 offen sc1
    s_mov_b64 exec, -1
L_nofl1:
    v_mov_b32 v221, s41
    ds_read_b32 v222, v221
    s_xor_b32 s41, s41, 4
    s_mov_b32 s55, s40
    s_mov_b32 s40, s42
    s_waitcnt lgkmcnt(0)
    v_readfirstlane_b32 s42, v222
    s_nop 3
    s_cmp_ge_u32 s42, 736
    s_cbranch_scc1 L_rm6
    s_sub_u32 s28, s42, 64
    s_add_u32 s29, s42, 672
    s_cmp_ge_u32 s42, 64
    s_cselect_b32 s42, s28, s29
L_rm6:
    s_cmp_ge_u32 s40, 1696
    s_cbranch_scc1 L_x_fin
    s_branch L_x_loop
L_x_fin:
    s_waitcnt vmcnt(0)
    s_barrier
    s_cmp_lg_u32 s10, 0
    s_cbranch_scc1 L_noflf
    s_cmp_ge_u32 s55, 1696
    s_cbranch_scc1 L_noflf
    s_lshl_b32 s24, s55, 2
    s_add_u32 s24, s24, 157286400
    v_mov_b32 v237, s54
    s_mov_b64 exec, 1
    buffer_store_dword v237, v230, s[16:19], s24 offen sc1
    s_mov_b64 exec, -1
L_noflf:
    s_add_u32 s10, s10, 4
    s_and_b32 s11, s2, 7
    s_lshr_b32 s12, s2, 3
    s_lshr_b32 s13, s12, 3
    s_lshl_b32 s11, s11, 2
    s_add_u32 s11, s11, s13
    s_bfe_u32 s13, s12, 0x10002
    s_and_b32 s14, s12, 3
    s_and_b32 s15, s10, 3
    s_mul_i32 s40, s11, 16384
    s_mul_i32 s20, s14, 16777216
    s_add_u32 s40, s40, s20
    s_mul_i32 s41, s11, 21504
    s_mul_i32 s20, s13, 22020096
    s_add_u32 s41, s41, s20
    s_add_u32 s41, s41, 67108864
    s_lshl_b32 s42, s15, 12
    s_mul_i32 s43, s15, 5632
    s_lshr_b32 s20, s15, 1
    s_lshl_b32 s21, s20, 9
    s_sub_u32 s21, s43, s21
    v_lshlrev_b32 v1, 4, v0
    v_lshlrev_b32 v1, 4, v0
    v_add_u32 v2, s21, v1
    s_add_u32 s22, s21, 4096
    v_add_u32 v5, s22, v1
    s_mov_b32 s44, s41
    s_bitcmp1_b32 s15, 0
    s_cbranch_scc0 L_six_even
    s_mul_i32 s22, s20, 10752
    s_add_u32 s22, s22, 9216
    v_lshrrev_b32 v5, 2, v0
    v_lshlrev_b32 v5, 6, v5
    v_and_b32 v3, 3, v0
    v_xor_b32 v3, 3, v3
    v_lshl_add_u32 v5, v3, 4, v5
    v_add_u32 v5, s22, v5
    s_mul_i32 s44, s11, 21504
    s_xor_b32 s22, s13, 1
    s_mul_i32 s22, s22, 22020096
    s_add_u32 s44, s44, s22
    s_add_u32 s44, s44, 67108864
L_six_even:
    s_mov_b32 s50, -1
    s_mov_b32 s51, 0
    v_add_u32 v1, s42, v1
    s_add_u32 s43, s43, 16384
    v_lshlrev_b32 v6, 4, v0
    v_min_u32 v7, 31, v0
    v_lshlrev_b32 v7, 4, v7
    s_mov_b32 s58, 157286400
    buffer_load_dwordx4 v[8:11], v6, s[16:19], s58 offen sc1
    s_mov_b32 s58, 157287424
    buffer_load_dwordx4 v[12:15], v6, s[16:19], s58 offen sc1
    s_mov_b32 s58, 157288448
    buffer_load_dwordx4 v[16:19], v6, s[16:19], s58 offen sc1
    s_mov_b32 s58, 157288576
    buffer_load_dwordx4 v[20:23], v6, s[16:19], s58 offen sc1
    s_waitcnt vmcnt(0)
    s_mov_b32 s57, 32768
L_chk0:
    v_xor_b32 v24, s54, v8
    v_xor_b32 v25, s54, v9
    v_xor_b32 v26, s54, v10
    v_xor_b32 v27, s54, v11
    v_xor_b32 v28, s54, v12
    v_xor_b32 v29, s54, v13
    v_xor_b32 v30, s54, v14
    v_xor_b32 v31, s54, v15
    v_xor_b32 v32, s54, v16
    v_xor_b32 v33, s54, v17
    v_xor_b32 v34, s54, v18
    v_xor_b32 v35, s54, v19
    v_xor_b32 v36, s54, v20
    v_xor_b32 v37, s54, v21
    v_xor_b32 v38, s54, v22
    v_xor_b32 v39, s54, v23
    v_or3_b32 v24, v24, v25, v26
    v_or3_b32 v24, v24, v27, v28
    v_or3_b32 v24, v24, v29, v30
    v_or3_b32 v24, v24, v31, v32
    v_or3_b32 v24, v24, v33, v34
    v_or3_b32 v24, v24, v35, v36
    v_or3_b32 v24, v24, v37, v38
    v_or_b32 v24, v24, v39
    v_cmp_ne_u32 vcc, 0, v24
    s_nop 3
    s_cmp_eq_u64 vcc, 0
    s_cbranch_scc1 L_ok0
    s_sub_u32 s57, s57, 1
    s_cmp_eq_u32 s57, 0
    s_cbranch_scc1 L_ok0
    s_sleep 8
    s_mov_b32 s58, 157286400
    buffer_load_dwordx4 v[8:11], v6, s[16:19], s58 offen sc1
    s_mov_b32 s58, 157287424
    buffer_load_dwordx4 v[12:15], v6, s[16:19], s58 offen sc1
    s_mov_b32 s58, 157288448
    buffer_load_dwordx4 v[16:19], v6, s[16:19], s58 offen sc1
    s_mov_b32 s58, 157288576
    buffer_load_dwordx4 v[20:23], v6, s[16:19], s58 offen sc1
    s_waitcnt vmcnt(0)
    s_branch L_chk0
L_ok0:
    s_add_u32 m0, s42, 0
    s_nop 0
    buffer_load_dwordx4 v1, s[16:19], s40 offen offset:0 lds
    buffer_load_dwordx4 v1, s[16:19], s40 offen offset:1024 lds
    buffer_load_dwordx4 v1, s[16:19], s40 offen offset:2048 lds
    buffer_load_dwordx4 v1, s[16:19], s40 offen offset:3072 lds
    s_add_u32 s40, s40, 524288
    s_add_u32 m0, s43, 0
    s_nop 0
    buffer_load_dwordx4 v2, s[16:19], s41 offen offset:0 lds
    buffer_load_dwordx4 v2, s[16:19], s41 offen offset:1024 lds
    buffer_load_dwordx4 v2, s[16:19], s41 offen offset:2048 lds
    buffer_load_dwordx4 v2, s[16:19], s41 offen offset:3072 lds
    s_add_u32 m0, s43, 4096
    s_add_u32 s49, s41, 4096
    buffer_load_dwordx4 v2, s[16:19], s49 offen lds
    s_mov_b64 exec, s[50:51]
    buffer_load_dwordx4 v5, s[16:19], s44 offen offset:1024 lds
    s_mov_b64 exec, -1
    s_add_u32 s41, s41, 688128
    s_add_u32 s44, s44, 688128
    s_add_u32 m0, s42, 38912
    s_nop 0
    buffer_load_dwordx4 v1, s[16:19], s40 offen offset:0 lds
    buffer_load_dwordx4 v1, s[16:19], s40 offen offset:1024 lds
    buffer_load_dwordx4 v1, s[16:19], s40 offen offset:2048 lds
    buffer_load_dwordx4 v1, s[16:19], s40 offen offset:3072 lds
    s_add_u32 s40, s40, 524288
    s_add_u32 m0, s43, 38912
    s_nop 0
    buffer_load_dwordx4 v2, s[16:19], s41 offen offset:0 lds
    buffer_load_dwordx4 v2, s[16:19], s41 offen offset:1024 lds
    buffer_load_dwordx4 v2, s[16:19], s41 offen offset:2048 lds
    buffer_load_dwordx4 v2, s[16:19], s41 offen offset:3072 lds
    s_add_u32 m0, s43, 43008
    s_add_u32 s49, s41, 4096
    buffer_load_dwordx4 v2, s[16:19], s49 offen lds
    s_mov_b64 exec, s[50:51]
    buffer_load_dwordx4 v5, s[16:19], s44 offen offset:1024 lds
    s_mov_b64 exec, -1
    s_add_u32 s41, s41, 688128
    s_add_u32 s44, s44, 688128
    s_add_u32 m0, s42, 77824
    s_nop 0
    buffer_load_dwordx4 v1, s[16:19], s40 offen offset:0 lds
    buffer_load_dwordx4 v1, s[16:19], s40 offen offset:1024 lds
    buffer_load_dwordx4 v1, s[16:19], s40 offen offset:2048 lds
    buffer_load_dwordx4 v1, s[16:19], s40 offen offset:3072 lds
    s_add_u32 s40, s40, 524288
    s_add_u32 m0, s43, 77824
    s_nop 0
    buffer_load_dwordx4 v2, s[16:19], s41 offen offset:0 lds
    buffer_load_dwordx4 v2, s[16:19], s41 offen offset:1024 lds
    buffer_load_dwordx4 v2, s[16:19], s41 offen offset:2048 lds
    buffer_load_dwordx4 v2, s[16:19], s41 offen offset:3072 lds
    s_add_u32 m0, s43, 81920
    s_add_u32 s49, s41, 4096
    buffer_load_dwordx4 v2, s[16:19], s49 offen lds
    s_mov_b64 exec, s[50:51]
    buffer_load_dwordx4 v5, s[16:19], s44 offen offset:1024 lds
    s_mov_b64 exec, -1
    s_add_u32 s41, s41, 688128
    s_add_u32 s44, s44, 688128
    s_mov_b32 s58, 157289600
    buffer_load_dwordx4 v[8:11], v7, s[16:19], s58 offen sc1
    s_waitcnt vmcnt(21)
    s_barrier
    s_waitcnt vmcnt(11)
    s_barrier
    s_add_u32 m0, s42, 116736
    s_nop 0
    buffer_load_dwordx4 v1, s[16:19], s40 offen offset:0 lds
    buffer_load_dwordx4 v1, s[16:19], s40 offen offset:1024 lds
    buffer_load_dwordx4 v1, s[16:19], s40 offen offset:2048 lds
    buffer_load_dwordx4 v1, s[16:19], s40 offen offset:3072 lds
    s_add_u32 s40, s40, 524288
    s_add_u32 m0, s43, 116736
    s_nop 0
    buffer_load_dwordx4 v2, s[16:19], s41 offen offset:0 lds
    buffer_load_dwordx4 v2, s[16:19], s41 offen offset:1024 lds
    buffer_load_dwordx4 v2, s[16:19], s41 offen offset:2048 lds
    buffer_load_dwordx4 v2, s[16:19], s41 offen offset:3072 lds
    s_add_u32 m0, s43, 120832
    s_add_u32 s49, s41, 4096
    buffer_load_dwordx4 v2, s[16:19], s49 offen lds
    s_mov_b64 exec, s[50:51]
    buffer_load_dwordx4 v5, s[16:19], s44 offen offset:1024 lds
    s_mov_b64 exec, -1
    s_add_u32 s41, s41, 688128
    s_add_u32 s44, s44, 688128
    s_waitcnt vmcnt(11)
    s_barrier
    s_waitcnt vmcnt(10)
    s_mov_b32 s57, 32768
L_chk1:
    v_xor_b32 v24, s54, v8
    v_xor_b32 v25, s54, v9
    v_xor_b32 v26, s54, v10
    v_xor_b32 v27, s54, v11
    v_or3_b32 v24, v24, v25, v26
    v_or_b32 v24, v24, v27
    v_cmp_ne_u32 vcc, 0, v24
    s_nop 3
    s_cmp_eq_u64 vcc, 0
    s_cbranch_scc1 L_ok1
    s_sub_u32 s57, s57, 1
    s_cmp_eq_u32 s57, 0
    s_cbranch_scc1 L_ok1
    s_sleep 8
    s_mov_b32 s58, 157289600
    buffer_load_dwordx4 v[8:11], v7, s[16:19], s58 offen sc1
    s_waitcnt vmcnt(0)
    s_branch L_chk1
L_ok1:
    s_add_u32 m0, s42, 0
    s_nop 0
    buffer_load_dwordx4 v1, s[16:19], s40 offen offset:0 lds
    buffer_load_dwordx4 v1, s[16:19], s40 offen offset:1024 lds
    buffer_load_dwordx4 v1, s[16:19], s40 offen offset:2048 lds
    buffer_load_dwordx4 v1, s[16:19], s40 offen offset:3072 lds
    s_add_u32 s40, s40, 524288
    s_add_u32 m0, s43, 0
    s_nop 0
    buffer_load_dwordx4 v2, s[16:19], s41 offen offset:0 lds
    buffer_load_dwordx4 v2, s[16:19], s41 offen offset:1024 lds
    buffer_load_dwordx4 v2, s[16:19], s41 offen offset:2048 lds
    buffer_load_dwordx4 v2, s[16:19], s41 offen offset:3072 lds
    s_add_u32 m0, s43, 4096
    s_add_u32 s49, s41, 4096
    buffer_load_dwordx4 v2, s[16:19], s49 offen lds
    s_mov_b64 exec, s[50:51]
    buffer_load_dwordx4 v5, s[16:19], s44 offen offset:1024 lds
    s_mov_b64 exec, -1
    s_add_u32 s41, s41, 688128
    s_add_u32 s44, s44, 688128
    s_waitcnt vmcnt(10)
    s_barrier
    s_add_u32 m0, s42, 38912
    s_nop 0
    buffer_load_dwordx4 v1, s[16:19], s40 offen offset:0 lds
    buffer_load_dwordx4 v1, s[16:19], s40 offen offset:1024 lds
    buffer_load_dwordx4 v1, s[16:19], s40 offen offset:2048 lds
    buffer_load_dwordx4 v1, s[16:19], s40 offen offset:3072 lds
    s_add_u32 s40, s40, 524288
    s_add_u32 m0, s43, 38912
    s_nop 0
    buffer_load_dwordx4 v2, s[16:19], s41 offen offset:0 lds
    buffer_load_dwordx4 v2, s[16:19], s41 offen offset:1024 lds
    buffer_load_dwordx4 v2, s[16:19], s41 offen offset:2048 lds
    buffer_load_dwordx4 v2, s[16:19], s41 offen offset:3072 lds
    s_add_u32 m0, s43, 43008
    s_add_u32 s49, s41, 4096
    buffer_load_dwordx4 v2, s[16:19], s49 offen lds
    s_mov_b64 exec, s[50:51]
    buffer_load_dwordx4 v5, s[16:19], s44 offen offset:1024 lds
    s_mov_b64 exec, -1
    s_add_u32 s41, s41, 688128
    s_add_u32 s44, s44, 688128
    s_waitcnt vmcnt(10)
    s_barrier
    s_add_u32 m0, s42, 77824
    s_nop 0
    buffer_load_dwordx4 v1, s[16:19], s40 offen offset:0 lds
    buffer_load_dwordx4 v1, s[16:19], s40 offen offset:1024 lds
    buffer_load_dwordx4 v1, s[16:19], s40 offen offset:2048 lds
    buffer_load_dwordx4 v1, s[16:19], s40 offen offset:3072 lds
    s_add_u32 s40, s40, 524288
    s_add_u32 m0, s43, 77824
    s_nop 0
    buffer_load_dwordx4 v2, s[16:19], s41 offen offset:0 lds
    buffer_load_dwordx4 v2, s[16:19], s41 offen offset:1024 lds
    buffer_load_dwordx4 v2, s[16:19], s41 offen offset:2048 lds
    buffer_load_dwordx4 v2, s[16:19], s41 offen offset:3072 lds
    s_add_u32 m0, s43, 81920
    s_add_u32 s49, s41, 4096
    buffer_load_dwordx4 v2, s[16:19], s49 offen lds
    s_mov_b64 exec, s[50:51]
    buffer_load_dwordx4 v5, s[16:19], s44 offen offset:1024 lds
    s_mov_b64 exec, -1
    s_add_u32 s41, s41, 688128
    s_add_u32 s44, s44, 688128
    s_waitcnt vmcnt(10)
    s_barrier
    s_add_u32 m0, s42, 116736
    s_nop 0
    buffer_load_dwordx4 v1, s[16:19], s40 offen offset:0 lds
    buffer_load_dwordx4 v1, s[16:19], s40 offen offset:1024 lds
    buffer_load_dwordx4 v1, s[16:19], s40 offen offset:2048 lds
    buffer_load_dwordx4 v1, s[16:19], s40 offen offset:3072 lds
    s_add_u32 s40, s40, 524288
    s_add_u32 m0, s43, 116736
    s_nop 0
    buffer_load_dwordx4 v2, s[16:19], s41 offen offset:0 lds
    buffer_load_dwordx4 v2, s[16:19], s41 offen offset:1024 lds
    buffer_load_dwordx4 v2, s[16:19], s41 offen offset:2048 lds
    buffer_load_dwordx4 v2, s[16:19], s41 offen offset:3072 lds
    s_add_u32 m0, s43, 120832
    s_add_u32 s49, s41, 4096
    buffer_load_dwordx4 v2, s[16:19], s49 offen lds
    s_mov_b64 exec, s[50:51]
    buffer_load_dwordx4 v5, s[16:19], s44 offen offset:1024 lds
    s_mov_b64 exec, -1
    s_add_u32 s41, s41, 688128
    s_add_u32 s44, s44, 688128
    s_mov_b32 s58, 157290112
    buffer_load_dwordx4 v[8:11], v7, s[16:19], s58 offen sc1
    s_waitcnt vmcnt(11)
    s_barrier
    s_waitcnt vmcnt(0)
    s_mov_b32 s57, 32768
L_chk2:
    v_xor_b32 v24, s54, v8
    v_xor_b32 v25, s54, v9
    v_xor_b32 v26, s54, v10
    v_xor_b32 v27, s54, v11
    v_or3_b32 v24, v24, v25, v26
    v_or_b32 v24, v24, v27
    v_cmp_ne_u32 vcc, 0, v24
    s_nop 3
    s_cmp_eq_u64 vcc, 0
    s_cbranch_scc1 L_ok2
    s_sub_u32 s57, s57, 1
    s_cmp_eq_u32 s57, 0
    s_cbranch_scc1 L_ok2
    s_sleep 8
    s_mov_b32 s58, 157290112
    buffer_load_dwordx4 v[8:11], v7, s[16:19], s58 offen sc1
    s_waitcnt vmcnt(0)
    s_branch L_chk2
L_ok2:
    s_add_u32 m0, s42, 0
    s_nop 0
    buffer_load_dwordx4 v1, s[16:19], s40 offen offset:0 lds
    buffer_load_dwordx4 v1, s[16:19], s40 offen offset:1024 lds
    buffer_load_dwordx4 v1, s[16:19], s40 offen offset:2048 lds
    buffer_load_dwordx4 v1, s[16:19], s40 offen offset:3072 lds
    s_add_u32 s40, s40, 524288
    s_add_u32 m0, s43, 0
    s_nop 0
    buffer_load_dwordx4 v2, s[16:19], s41 offen offset:0 lds
    buffer_load_dwordx4 v2, s[16:19], s41 offen offset:1024 lds
    buffer_load_dwordx4 v2, s[16:19], s41 offen offset:2048 lds
    buffer_load_dwordx4 v2, s[16:19], s41 offen offset:3072 lds
    s_add_u32 m0, s43, 4096
    s_add_u32 s49, s41, 4096
    buffer_load_dwordx4 v2, s[16:19], s49 offen lds
    s_mov_b64 exec, s[50:51]
    buffer_load_dwordx4 v5, s[16:19], s44 offen offset:1024 lds
    s_mov_b64 exec, -1
    s_add_u32 s41, s41, 688128
    s_add_u32 s44, s44, 688128
    s_waitcnt vmcnt(11)
    s_barrier
    s_add_u32 m0, s42, 38912
    s_nop 0
    buffer_load_dwordx4 v1, s[16:19], s40 offen offset:0 lds
    buffer_load_dwordx4 v1, s[16:19], s40 offen offset:1024 lds
    buffer_load_dwordx4 v1, s[16:19], s40 offen offset:2048 lds
    buffer_load_dwordx4 v1, s[16:19], s40 offen offset:3072 lds
    s_add_u32 s40, s40, 524288
    s_add_u32 m0, s43, 38912
    s_nop 0
    buffer_load_dwordx4 v2, s[16:19], s41 offen offset:0 lds
    buffer_load_dwordx4 v2, s[16:19], s41 offen offset:1024 lds
    buffer_load_dwordx4 v2, s[16:19], s41 offen offset:2048 lds
    buffer_load_dwordx4 v2, s[16:19], s41 offen offset:3072 lds
    s_add_u32 m0, s43, 43008
    s_add_u32 s49, s41, 4096
    buffer_load_dwordx4 v2, s[16:19], s49 offen lds
    s_mov_b64 exec, s[50:51]
    buffer_load_dwordx4 v5, s[16:19], s44 offen offset:1024 lds
    s_mov_b64 exec, -1
    s_add_u32 s41, s41, 688128
    s_add_u32 s44, s44, 688128
    s_waitcnt vmcnt(10)
    s_barrier
    s_add_u32 m0, s42, 77824
    s_nop 0
    buffer_load_dwordx4 v1, s[16:19], s40 offen offset:0 lds
    buffer_load_dwordx4 v1, s[16:19], s40 offen offset:1024 lds
    buffer_load_dwordx4 v1, s[16:19], s40 offen offset:2048 lds
    buffer_load_dwordx4 v1, s[16:19], s40 offen offset:3072 lds
    s_add_u32 s40, s40, 524288
    s_add_u32 m0, s43, 77824
    s_nop 0
    buffer_load_dwordx4 v2, s[16:19], s41 offen offset:0 lds
    buffer_load_dwordx4 v2, s[16:19], s41 offen offset:1024 lds
    buffer_load_dwordx4 v2, s[16:19], s41 offen offset:2048 lds
    buffer_load_dwordx4 v2, s[16:19], s41 offen offset:3072 lds
    s_add_u32 m0, s43, 81920
    s_add_u32 s49, s41, 4096
    buffer_load_dwordx4 v2, s[16:19], s49 offen lds
    s_mov_b64 exec, s[50:51]
    buffer_load_dwordx4 v5, s[16:19], s44 offen offset:1024 lds
    s_mov_b64 exec, -1
    s_add_u32 s41, s41, 688128
    s_add_u32 s44, s44, 688128
    s_waitcnt vmcnt(10)
    s_barrier
    s_add_u32 m0, s42, 116736
    s_nop 0
    buffer_load_dwordx4 v1, s[16:19], s40 offen offset:0 lds
    buffer_load_dwordx4 v1, s[16:19], s40 offen offset:1024 lds
    buffer_load_dwordx4 v1, s[16:19], s40 offen offset:2048 lds
    buffer_load_dwordx4 v1, s[16:19], s40 offen offset:3072 lds
    s_add_u32 s40, s40, 524288
    s_add_u32 m0, s43, 116736
    s_nop 0
    buffer_load_dwordx4 v2, s[16:19], s41 offen offset:0 lds
    buffer_load_dwordx4 v2, s[16:19], s41 offen offset:1024 lds
    buffer_load_dwordx4 v2, s[16:19], s41 offen offset:2048 lds
    buffer_load_dwordx4 v2, s[16:19], s41 offen offset:3072 lds
    s_add_u32 m0, s43, 120832
    s_add_u32 s49, s41, 4096
    buffer_load_dwordx4 v2, s[16:19], s49 offen lds
    s_mov_b64 exec, s[50:51]
    buffer_load_dwordx4 v5, s[16:19], s44 offen offset:1024 lds
    s_mov_b64 exec, -1
    s_add_u32 s41, s41, 688128
    s_add_u32 s44, s44, 688128
    s_mov_b32 s58, 157290624
    buffer_load_dwordx4 v[8:11], v7, s[16:19], s58 offen sc1
    s_waitcnt vmcnt(11)
    s_barrier
    s_waitcnt vmcnt(0)
    s_mov_b32 s57, 32768
L_chk3:
    v_xor_b32 v24, s54, v8
    v_xor_b32 v25, s54, v9
    v_xor_b32 v26, s54, v10
    v_xor_b32 v27, s54, v11
    v_or3_b32 v24, v24, v25, v26
    v_or_b32 v24, v24, v27
    v_cmp_ne_u32 vcc, 0, v24
    s_nop 3
    s_cmp_eq_u64 vcc, 0
    s_cbranch_scc1 L_ok3
    s_sub_u32 s57, s57, 1
    s_cmp_eq_u32 s57, 0
    s_cbranch_scc1 L_ok3
    s_sleep 8
    s_mov_b32 s58, 157290624
    buffer_load_dwordx4 v[8:11], v7, s[16:19], s58 offen sc1
    s_waitcnt vmcnt(0)
    s_branch L_chk3
L_ok3:
    s_add_u32 m0, s42, 0
    s_nop 0
    buffer_load_dwordx4 v1, s[16:19], s40 offen offset:0 lds
    buffer_load_dwordx4 v1, s[16:19], s40 offen offset:1024 lds
    buffer_load_dwordx4 v1, s[16:19], s40 offen offset:2048 lds
    buffer_load_dwordx4 v1, s[16:19], s40 offen offset:3072 lds
    s_add_u32 s40, s40, 524288
    s_add_u32 m0, s43, 0
    s_nop 0
    buffer_load_dwordx4 v2, s[16:19], s41 offen offset:0 lds
    buffer_load_dwordx4 v2, s[16:19], s41 offen offset:1024 lds
    buffer_load_dwordx4 v2, s[16:19], s41 offen offset:2048 lds
    buffer_load_dwordx4 v2, s[16:19], s41 offen offset:3072 lds
    s_add_u32 m0, s43, 4096
    s_add_u32 s49, s41, 4096
    buffer_load_dwordx4 v2, s[16:19], s49 offen lds
    s_mov_b64 exec, s[50:51]
    buffer_load_dwordx4 v5, s[16:19], s44 offen offset:1024 lds
    s_mov_b64 exec, -1
    s_add_u32 s41, s41, 688128
    s_add_u32 s44, s44, 688128
    s_waitcnt vmcnt(11)
    s_barrier
    s_add_u32 m0, s42, 38912
    s_nop 0
    buffer_load_dwordx4 v1, s[16:19], s40 offen offset:0 lds
    buffer_load_dwordx4 v1, s[16:19], s40 offen offset:1024 lds
    buffer_load_dwordx4 v1, s[16:19], s40 offen offset:2048 lds
    buffer_load_dwordx4 v1, s[16:19], s40 offen offset:3072 lds
    s_add_u32 s40, s40, 524288
    s_add_u32 m0, s43, 38912
    s_nop 0
    buffer_load_dwordx4 v2, s[16:19], s41 offen offset:0 lds
    buffer_load_dwordx4 v2, s[16:19], s41 offen offset:1024 lds
    buffer_load_dwordx4 v2, s[16:19], s41 offen offset:2048 lds
    buffer_load_dwordx4 v2, s[16:19], s41 offen offset:3072 lds
    s_add_u32 m0, s43, 43008
    s_add_u32 s49, s41, 4096
    buffer_load_dwordx4 v2, s[16:19], s49 offen lds
    s_mov_b64 exec, s[50:51]
    buffer_load_dwordx4 v5, s[16:19], s44 offen offset:1024 lds
    s_mov_b64 exec, -1
    s_add_u32 s41, s41, 688128
    s_add_u32 s44, s44, 688128
    s_waitcnt vmcnt(10)
    s_barrier
    s_add_u32 m0, s42, 77824
    s_nop 0
    buffer_load_dwordx4 v1, s[16:19], s40 offen offset:0 lds
    buffer_load_dwordx4 v1, s[16:19], s40 offen offset:1024 lds
    buffer_load_dwordx4 v1, s[16:19], s40 offen offset:2048 lds
    buffer_load_dwordx4 v1, s[16:19], s40 offen offset:3072 lds
    s_add_u32 s40, s40, 524288
    s_add_u32 m0, s43, 77824
    s_nop 0
    buffer_load_dwordx4 v2, s[16:19], s41 offen offset:0 lds
    buffer_load_dwordx4 v2, s[16:19], s41 offen offset:1024 lds
    buffer_load_dwordx4 v2, s[16:19], s41 offen offset:2048 lds
    buffer_load_dwordx4 v2, s[16:19], s41 offen offset:3072 lds
    s_add_u32 m0, s43, 81920
    s_add_u32 s49, s41, 4096
    buffer_load_dwordx4 v2, s[16:19], s49 offen lds
    s_mov_b64 exec, s[50:51]
    buffer_load_dwordx4 v5, s[16:19], s44 offen offset:1024 lds
    s_mov_b64 exec, -1
    s_add_u32 s41, s41, 688128
    s_add_u32 s44, s44, 688128
    s_waitcnt vmcnt(10)
    s_barrier
    s_add_u32 m0, s42, 116736
    s_nop 0
    buffer_load_dwordx4 v1, s[16:19], s40 offen offset:0 lds
    buffer_load_dwordx4 v1, s[16:19], s40 offen offset:1024 lds
    buffer_load_dwordx4 v1, s[16:19], s40 offen offset:2048 lds
    buffer_load_dwordx4 v1, s[16:19], s40 offen offset:3072 lds
    s_add_u32 s40, s40, 524288
    s_add_u32 m0, s43, 116736
    s_nop 0
    buffer_load_dwordx4 v2, s[16:19], s41 offen offset:0 lds
    buffer_load_dwordx4 v2, s[16:19], s41 offen offset:1024 lds
    buffer_load_dwordx4 v2, s[16:19], s41 offen offset:2048 lds
    buffer_load_dwordx4 v2, s[16:19], s41 offen offset:3072 lds
    s_add_u32 m0, s43, 120832
    s_add_u32 s49, s41, 4096
    buffer_load_dwordx4 v2, s[16:19], s49 offen lds
    s_mov_b64 exec, s[50:51]
    buffer_load_dwordx4 v5, s[16:19], s44 offen offset:1024 lds
    s_mov_b64 exec, -1
    s_add_u32 s41, s41, 688128
    s_add_u32 s44, s44, 688128
    s_mov_b32 s58, 157291136
    buffer_load_dwordx4 v[8:11], v7, s[16:19], s58 offen sc1
    s_waitcnt vmcnt(11)
    s_barrier
    s_waitcnt vmcnt(0)
    s_mov_b32 s57, 32768
L_chk4:
    v_xor_b32 v24, s54, v8
    v_xor_b32 v25, s54, v9
    v_xor_b32 v26, s54, v10
    v_xor_b32 v27, s54, v11
    v_or3_b32 v24, v24, v25, v26
    v_or_b32 v24, v24, v27
    v_cmp_ne_u32 vcc, 0, v24
    s_nop 3
    s_cmp_eq_u64 vcc, 0
    s_cbranch_scc1 L_ok4
    s_sub_u32 s57, s57, 1
    s_cmp_eq_u32 s57, 0
    s_cbranch_scc1 L_ok4
    s_sleep 8
    s_mov_b32 s58, 157291136
    buffer_load_dwordx4 v[8:11], v7, s[16:19], s58 offen sc1
    s_waitcnt vmcnt(0)
    s_branch L_chk4
L_ok4:
    s_add_u32 m0, s42, 0
    s_nop 0
    buffer_load_dwordx4 v1, s[16:19], s40 offen offset:0 lds
    buffer_load_dwordx4 v1, s[16:19], s40 offen offset:1024 lds
    buffer_load_dwordx4 v1, s[16:19], s40 offen offset:2048 lds
    buffer_load_dwordx4 v1, s[16:19], s40 offen offset:3072 lds
    s_add_u32 s40, s40, 524288
    s_add_u32 m0, s43, 0
    s_nop 0
    buffer_load_dwordx4 v2, s[16:19], s41 offen offset:0 lds
    buffer_load_dwordx4 v2, s[16:19], s41 offen offset:1024 lds
    buffer_load_dwordx4 v2, s[16:19], s41 offen offset:2048 lds
    buffer_load_dwordx4 v2, s[16:19], s41 offen offset:3072 lds
    s_add_u32 m0, s43, 4096
    s_add_u32 s49, s41, 4096
    buffer_load_dwordx4 v2, s[16:19], s49 offen lds
    s_mov_b64 exec, s[50:51]
    buffer_load_dwordx4 v5, s[16:19], s44 offen offset:1024 lds
    s_mov_b64 exec, -1
    s_add_u32 s41, s41, 688128
    s_add_u32 s44, s44, 688128
    s_waitcnt vmcnt(11)
    s_barrier
    s_add_u32 m0, s42, 38912
    s_nop 0
    buffer_load_dwordx4 v1, s[16:19], s40 offen offset:0 lds
    buffer_load_dwordx4 v1, s[16:19], s40 offen offset:1024 lds
    buffer_load_dwordx4 v1, s[16:19], s40 offen offset:2048 lds
    buffer_load_dwordx4 v1, s[16:19], s40 offen offset:3072 lds
    s_add_u32 s40, s40, 524288
    s_add_u32 m0, s43, 38912
    s_nop 0
    buffer_load_dwordx4 v2, s[16:19], s41 offen offset:0 lds
    buffer_load_dwordx4 v2, s[16:19], s41 offen offset:1024 lds
    buffer_load_dwordx4 v2, s[16:19], s41 offen offset:2048 lds
    buffer_load_dwordx4 v2, s[16:19], s41 offen offset:3072 lds
    s_add_u32 m0, s43, 43008
    s_add_u32 s49, s41, 4096
    buffer_load_dwordx4 v2, s[16:19], s49 offen lds
    s_mov_b64 exec, s[50:51]
    buffer_load_dwordx4 v5, s[16:19], s44 offen offset:1024 lds
    s_mov_b64 exec, -1
    s_add_u32 s41, s41, 688128
    s_add_u32 s44, s44, 688128
    s_waitcnt vmcnt(10)
    s_barrier
    s_add_u32 m0, s42, 77824
    s_nop 0
    buffer_load_dwordx4 v1, s[16:19], s40 offen offset:0 lds
    buffer_load_dwordx4 v1, s[16:19], s40 offen offset:1024 lds
    buffer_load_dwordx4 v1, s[16:19], s40 offen offset:2048 lds
    buffer_load_dwordx4 v1, s[16:19], s40 offen offset:3072 lds
    s_add_u32 s40, s40, 524288
    s_add_u32 m0, s43, 77824
    s_nop 0
    buffer_load_dwordx4 v2, s[16:19], s41 offen offset:0 lds
    buffer_load_dwordx4 v2, s[16:19], s41 offen offset:1024 lds
    buffer_load_dwordx4 v2, s[16:19], s41 offen offset:2048 lds
    buffer_load_dwordx4 v2, s[16:19], s41 offen offset:3072 lds
    s_add_u32 m0, s43, 81920
    s_add_u32 s49, s41, 4096
    buffer_load_dwordx4 v2, s[16:19], s49 offen lds
    s_mov_b64 exec, s[50:51]
    buffer_load_dwordx4 v5, s[16:19], s44 offen offset:1024 lds
    s_mov_b64 exec, -1
    s_add_u32 s41, s41, 688128
    s_add_u32 s44, s44, 688128
    s_waitcnt vmcnt(10)
    s_barrier
    s_add_u32 m0, s42, 116736
    s_nop 0
    buffer_load_dwordx4 v1, s[16:19], s40 offen offset:0 lds
    buffer_load_dwordx4 v1, s[16:19], s40 offen offset:1024 lds
    buffer_load_dwordx4 v1, s[16:19], s40 offen offset:2048 lds
    buffer_load_dwordx4 v1, s[16:19], s40 offen offset:3072 lds
    s_add_u32 s40, s40, 524288
    s_add_u32 m0, s43, 116736
    s_nop 0
    buffer_load_dwordx4 v2, s[16:19], s41 offen offset:0 lds
    buffer_load_dwordx4 v2, s[16:19], s41 offen offset:1024 lds
    buffer_load_dwordx4 v2, s[16:19], s41 offen offset:2048 lds
    buffer_load_dwordx4 v2, s[16:19], s41 offen offset:3072 lds
    s_add_u32 m0, s43, 120832
    s_add_u32 s49, s41, 4096
    buffer_load_dwordx4 v2, s[16:19], s49 offen lds
    s_mov_b64 exec, s[50:51]
    buffer_load_dwordx4 v5, s[16:19], s44 offen offset:1024 lds
    s_mov_b64 exec, -1
    s_add_u32 s41, s41, 688128
    s_add_u32 s44, s44, 688128
    s_mov_b32 s58, 157291648
    buffer_load_dwordx4 v[8:11], v7, s[16:19], s58 offen sc1
    s_waitcnt vmcnt(11)
    s_barrier
    s_waitcnt vmcnt(0)
    s_mov_b32 s57, 32768
L_chk5:
    v_xor_b32 v24, s54, v8
    v_xor_b32 v25, s54, v9
    v_xor_b32 v26, s54, v10
    v_xor_b32 v27, s54, v11
    v_or3_b32 v24, v24, v25, v26
    v_or_b32 v24, v24, v27
    v_cmp_ne_u32 vcc, 0, v24
    s_nop 3
    s_cmp_eq_u64 vcc, 0
    s_cbranch_scc1 L_ok5
    s_sub_u32 s57, s57, 1
    s_cmp_eq_u32 s57, 0
    s_cbranch_scc1 L_ok5
    s_sleep 8
    s_mov_b32 s58, 157291648
    buffer_load_dwordx4 v[8:11], v7, s[16:19], s58 offen sc1
    s_waitcnt vmcnt(0)
    s_branch L_chk5
L_ok5:
    s_add_u32 m0, s42, 0
    s_nop 0
    buffer_load_dwordx4 v1, s[16:19], s40 offen offset:0 lds
    buffer_load_dwordx4 v1, s[16:19], s40 offen offset:1024 lds
    buffer_load_dwordx4 v1, s[16:19], s40 offen offset:2048 lds
    buffer_load_dwordx4 v1, s[16:19], s40 offen offset:3072 lds
    s_add_u32 s40, s40, 524288
    s_add_u32 m0, s43, 0
    s_nop 0
    buffer_load_dwordx4 v2, s[16:19], s41 offen offset:0 lds
    buffer_load_dwordx4 v2, s[16:19], s41 offen offset:1024 lds
    buffer_load_dwordx4 v2, s[16:19], s41 offen offset:2048 lds
    buffer_load_dwordx4 v2, s[16:19], s41 offen offset:3072 lds
    s_add_u32 m0, s43, 4096
    s_add_u32 s49, s41, 4096
    buffer_load_dwordx4 v2, s[16:19], s49 offen lds
    s_mov_b64 exec, s[50:51]
    buffer_load_dwordx4 v5, s[16:19], s44 offen offset:1024 lds
    s_mov_b64 exec, -1
    s_add_u32 s41, s41, 688128
    s_add_u32 s44, s44, 688128
    s_waitcnt vmcnt(11)
    s_barrier
    s_add_u32 m0, s42, 38912
    s_nop 0
    buffer_load_dwordx4 v1, s[16:19], s40 offen offset:0 lds
    buffer_load_dwordx4 v1, s[16:19], s40 offen offset:1024 lds
    buffer_load_dwordx4 v1, s[16:19], s40 offen offset:2048 lds
    buffer_load_dwordx4 v1, s[16:19], s40 offen offset:3072 lds
    s_add_u32 s40, s40, 524288
    s_add_u32 m0, s43, 38912
    s_nop 0
    buffer_load_dwordx4 v2, s[16:19], s41 offen offset:0 lds
    buffer_load_dwordx4 v2, s[16:19], s41 offen offset:1024 lds
    buffer_load_dwordx4 v2, s[16:19], s41 offen offset:2048 lds
    buffer_load_dwordx4 v2, s[16:19], s41 offen offset:3072 lds
    s_add_u32 m0, s43, 43008
    s_add_u32 s49, s41, 4096
    buffer_load_dwordx4 v2, s[16:19], s49 offen lds
    s_mov_b64 exec, s[50:51]
    buffer_load_dwordx4 v5, s[16:19], s44 offen offset:1024 lds
    s_mov_b64 exec, -1
    s_add_u32 s41, s41, 688128
    s_add_u32 s44, s44, 688128
    s_waitcnt vmcnt(10)
    s_barrier
    s_add_u32 m0, s42, 77824
    s_nop 0
    buffer_load_dwordx4 v1, s[16:19], s40 offen offset:0 lds
    buffer_load_dwordx4 v1, s[16:19], s40 offen offset:1024 lds
    buffer_load_dwordx4 v1, s[16:19], s40 offen offset:2048 lds
    buffer_load_dwordx4 v1, s[16:19], s40 offen offset:3072 lds
    s_add_u32 s40, s40, 524288
    s_add_u32 m0, s43, 77824
    s_nop 0
    buffer_load_dwordx4 v2, s[16:19], s41 offen offset:0 lds
    buffer_load_dwordx4 v2, s[16:19], s41 offen offset:1024 lds
    buffer_load_dwordx4 v2, s[16:19], s41 offen offset:2048 lds
    buffer_load_dwordx4 v2, s[16:19], s41 offen offset:3072 lds
    s_add_u32 m0, s43, 81920
    s_add_u32 s49, s41, 4096
    buffer_load_dwordx4 v2, s[16:19], s49 offen lds
    s_mov_b64 exec, s[50:51]
    buffer_load_dwordx4 v5, s[16:19], s44 offen offset:1024 lds
    s_mov_b64 exec, -1
    s_add_u32 s41, s41, 688128
    s_add_u32 s44, s44, 688128
    s_waitcnt vmcnt(10)
    s_barrier
    s_add_u32 m0, s42, 116736
    s_nop 0
    buffer_load_dwordx4 v1, s[16:19], s40 offen offset:0 lds
    buffer_load_dwordx4 v1, s[16:19], s40 offen offset:1024 lds
    buffer_load_dwordx4 v1, s[16:19], s40 offen offset:2048 lds
    buffer_load_dwordx4 v1, s[16:19], s40 offen offset:3072 lds
    s_add_u32 s40, s40, 524288
    s_add_u32 m0, s43, 116736
    s_nop 0
    buffer_load_dwordx4 v2, s[16:19], s41 offen offset:0 lds
    buffer_load_dwordx4 v2, s[16:19], s41 offen offset:1024 lds
    buffer_load_dwordx4 v2, s[16:19], s41 offen offset:2048 lds
    buffer_load_dwordx4 v2, s[16:19], s41 offen offset:3072 lds
    s_add_u32 m0, s43, 120832
    s_add_u32 s49, s41, 4096
    buffer_load_dwordx4 v2, s[16:19], s49 offen lds
    s_mov_b64 exec, s[50:51]
    buffer_load_dwordx4 v5, s[16:19], s44 offen offset:1024 lds
    s_mov_b64 exec, -1
    s_add_u32 s41, s41, 688128
    s_add_u32 s44, s44, 688128
    s_mov_b32 s58, 157292160
    buffer_load_dwordx4 v[8:11], v7, s[16:19], s58 offen sc1
    s_waitcnt vmcnt(11)
    s_barrier
    s_waitcnt vmcnt(0)
    s_mov_b32 s57, 32768
L_chk6:
    v_xor_b32 v24, s54, v8
    v_xor_b32 v25, s54, v9
    v_xor_b32 v26, s54, v10
    v_xor_b32 v27, s54, v11
    v_or3_b32 v24, v24, v25, v26
    v_or_b32 v24, v24, v27
    v_cmp_ne_u32 vcc, 0, v24
    s_nop 3
    s_cmp_eq_u64 vcc, 0
    s_cbranch_scc1 L_ok6
    s_sub_u32 s57, s57, 1
    s_cmp_eq_u32 s57, 0
    s_cbranch_scc1 L_ok6
    s_sleep 8
    s_mov_b32 s58, 157292160
    buffer_load_dwordx4 v[8:11], v7, s[16:19], s58 offen sc1
    s_waitcnt vmcnt(0)
    s_branch L_chk6
L_ok6:
    s_add_u32 m0, s42, 0
    s_nop 0
    buffer_load_dwordx4 v1, s[16:19], s40 offen offset:0 lds
    buffer_load_dwordx4 v1, s[16:19], s40 offen offset:1024 lds
    buffer_load_dwordx4 v1, s[16:19], s40 offen offset:2048 lds
    buffer_load_dwordx4 v1, s[16:19], s40 offen offset:3072 lds
    s_add_u32 s40, s40, 524288
    s_add_u32 m0, s43, 0
    s_nop 0
    buffer_load_dwordx4 v2, s[16:19], s41 offen offset:0 lds
    buffer_load_dwordx4 v2, s[16:19], s41 offen offset:1024 lds
    buffer_load_dwordx4 v2, s[16:19], s41 offen offset:2048 lds
    buffer_load_dwordx4 v2, s[16:19], s41 offen offset:3072 lds
    s_add_u32 m0, s43, 4096
    s_add_u32 s49, s41, 4096
    buffer_load_dwordx4 v2, s[16:19], s49 offen lds
    s_mov_b64 exec, s[50:51]
    buffer_load_dwordx4 v5, s[16:19], s44 offen offset:1024 lds
    s_mov_b64 exec, -1
    s_add_u32 s41, s41, 688128
    s_add_u32 s44, s44, 688128
    s_waitcnt vmcnt(11)
    s_barrier
    s_add_u32 m0, s42, 38912
    s_nop 0
    buffer_load_dwordx4 v1, s[16:19], s40 offen offset:0 lds
    buffer_load_dwordx4 v1, s[16:19], s40 offen offset:1024 lds
    buffer_load_dwordx4 v1, s[16:19], s40 offen offset:2048 lds
    buffer_load_dwordx4 v1, s[16:19], s40 offen offset:3072 lds
    s_add_u32 s40, s40, 524288
    s_add_u32 m0, s43, 38912
    s_nop 0
    buffer_load_dwordx4 v2, s[16:19], s41 offen offset:0 lds
    buffer_load_dwordx4 v2, s[16:19], s41 offen offset:1024 lds
    buffer_load_dwordx4 v2, s[16:19], s41 offen offset:2048 lds
    buffer_load_dwordx4 v2, s[16:19], s41 offen offset:3072 lds
    s_add_u32 m0, s43, 43008
    s_add_u32 s49, s41, 4096
    buffer_load_dwordx4 v2, s[16:19], s49 offen lds
    s_mov_b64 exec, s[50:51]
    buffer_load_dwordx4 v5, s[16:19], s44 offen offset:1024 lds
    s_mov_b64 exec, -1
    s_add_u32 s41, s41, 688128
    s_add_u32 s44, s44, 688128
    s_waitcnt vmcnt(10)
    s_barrier
    s_add_u32 m0, s42, 77824
    s_nop 0
    buffer_load_dwordx4 v1, s[16:19], s40 offen offset:0 lds
    buffer_load_dwordx4 v1, s[16:19], s40 offen offset:1024 lds
    buffer_load_dwordx4 v1, s[16:19], s40 offen offset:2048 lds
    buffer_load_dwordx4 v1, s[16:19], s40 offen offset:3072 lds
    s_add_u32 s40, s40, 524288
    s_add_u32 m0, s43, 77824
    s_nop 0
    buffer_load_dwordx4 v2, s[16:19], s41 offen offset:0 lds
    buffer_load_dwordx4 v2, s[16:19], s41 offen offset:1024 lds
    buffer_load_dwordx4 v2, s[16:19], s41 offen offset:2048 lds
    buffer_load_dwordx4 v2, s[16:19], s41 offen offset:3072 lds
    s_add_u32 m0, s43, 81920
    s_add_u32 s49, s41, 4096
    buffer_load_dwordx4 v2, s[16:19], s49 offen lds
    s_mov_b64 exec, s[50:51]
    buffer_load_dwordx4 v5, s[16:19], s44 offen offset:1024 lds
    s_mov_b64 exec, -1
    s_add_u32 s41, s41, 688128
    s_add_u32 s44, s44, 688128
    s_waitcnt vmcnt(10)
    s_barrier
    s_add_u32 m0, s42, 116736
    s_nop 0
    buffer_load_dwordx4 v1, s[16:19], s40 offen offset:0 lds
    buffer_load_dwordx4 v1, s[16:19], s40 offen offset:1024 lds
    buffer_load_dwordx4 v1, s[16:19], s40 offen offset:2048 lds
    buffer_load_dwordx4 v1, s[16:19], s40 offen offset:3072 lds
    s_add_u32 s40, s40, 524288
    s_add_u32 m0, s43, 116736
    s_nop 0
    buffer_load_dwordx4 v2, s[16:19], s41 offen offset:0 lds
    buffer_load_dwordx4 v2, s[16:19], s41 offen offset:1024 lds
    buffer_load_dwordx4 v2, s[16:19], s41 offen offset:2048 lds
    buffer_load_dwordx4 v2, s[16:19], s41 offen offset:3072 lds
    s_add_u32 m0, s43, 120832
    s_add_u32 s49, s41, 4096
    buffer_load_dwordx4 v2, s[16:19], s49 offen lds
    s_mov_b64 exec, s[50:51]
    buffer_load_dwordx4 v5, s[16:19], s44 offen offset:1024 lds
    s_mov_b64 exec, -1
    s_add_u32 s41, s41, 688128
    s_add_u32 s44, s44, 688128
    s_mov_b32 s58, 157292672
    buffer_load_dwordx4 v[8:11], v7, s[16:19], s58 offen sc1
    s_waitcnt vmcnt(11)
    s_barrier
    s_waitcnt vmcnt(0)
    s_mov_b32 s57, 32768
L_chk7:
    v_xor_b32 v24, s54, v8
    v_xor_b32 v25, s54, v9
    v_xor_b32 v26, s54, v10
    v_xor_b32 v27, s54, v11
    v_or3_b32 v24, v24, v25, v26
    v_or_b32 v24, v24, v27
    v_cmp_ne_u32 vcc, 0, v24
    s_nop 3
    s_cmp_eq_u64 vcc, 0
    s_cbranch_scc1 L_ok7
    s_sub_u32 s57, s57, 1
    s_cmp_eq_u32 s57, 0
    s_cbranch_scc1 L_ok7
    s_sleep 8
    s_mov_b32 s58, 157292672
    buffer_load_dwordx4 v[8:11], v7, s[16:19], s58 offen sc1
    s_waitcnt vmcnt(0)
    s_branch L_chk7
L_ok7:
    s_add_u32 m0, s42, 0
    s_nop 0
    buffer_load_dwordx4 v1, s[16:19], s40 offen offset:0 lds
    buffer_load_dwordx4 v1, s[16:19], s40 offen offset:1024 lds
    buffer_load_dwordx4 v1, s[16:19], s40 offen offset:2048 lds
    buffer_load_dwordx4 v1, s[16:19], s40 offen offset:3072 lds
    s_add_u32 s40, s40, 524288
    s_add_u32 m0, s43, 0
    s_nop 0
    buffer_load_dwordx4 v2, s[16:19], s41 offen offset:0 lds
    buffer_load_dwordx4 v2, s[16:19], s41 offen offset:1024 lds
    buffer_load_dwordx4 v2, s[16:19], s41 offen offset:2048 lds
    buffer_load_dwordx4 v2, s[16:19], s41 offen offset:3072 lds
    s_add_u32 m0, s43, 4096
    s_add_u32 s49, s41, 4096
    buffer_load_dwordx4 v2, s[16:19], s49 offen lds
    s_mov_b64 exec, s[50:51]
    buffer_load_dwordx4 v5, s[16:19], s44 offen offset:1024 lds
    s_mov_b64 exec, -1
    s_add_u32 s41, s41, 688128
    s_add_u32 s44, s44, 688128
    s_waitcnt vmcnt(11)
    s_barrier
    s_add_u32 m0, s42, 38912
    s_nop 0
    buffer_load_dwordx4 v1, s[16:19], s40 offen offset:0 lds
    buffer_load_dwordx4 v1, s[16:19], s40 offen offset:1024 lds
    buffer_load_dwordx4 v1, s[16:19], s40 offen offset:2048 lds
    buffer_load_dwordx4 v1, s[16:19], s40 offen offset:3072 lds
    s_add_u32 s40, s40, 524288
    s_add_u32 m0, s43, 38912
    s_nop 0
    buffer_load_dwordx4 v2, s[16:19], s41 offen offset:0 lds
    buffer_load_dwordx4 v2, s[16:19], s41 offen offset:1024 lds
    buffer_load_dwordx4 v2, s[16:19], s41 offen offset:2048 lds
    buffer_load_dwordx4 v2, s[16:19], s41 offen offset:3072 lds
    s_add_u32 m0, s43, 43008
    s_add_u32 s49, s41, 4096
    buffer_load_dwordx4 v2, s[16:19], s49 offen lds
    s_mov_b64 exec, s[50:51]
    buffer_load_dwordx4 v5, s[16:19], s44 offen offset:1024 lds
    s_mov_b64 exec, -1
    s_add_u32 s41, s41, 688128
    s_add_u32 s44, s44, 688128
    s_waitcnt vmcnt(10)
    s_barrier
    s_add_u32 m0, s42, 77824
    s_nop 0
    buffer_load_dwordx4 v1, s[16:19], s40 offen offset:0 lds
    buffer_load_dwordx4 v1, s[16:19], s40 offen offset:1024 lds
    buffer_load_dwordx4 v1, s[16:19], s40 offen offset:2048 lds
    buffer_load_dwordx4 v1, s[16:19], s40 offen offset:3072 lds
    s_add_u32 s40, s40, 524288
    s_add_u32 m0, s43, 77824
    s_nop 0
    buffer_load_dwordx4 v2, s[16:19], s41 offen offset:0 lds
    buffer_load_dwordx4 v2, s[16:19], s41 offen offset:1024 lds
    buffer_load_dwordx4 v2, s[16:19], s41 offen offset:2048 lds
    buffer_load_dwordx4 v2, s[16:19], s41 offen offset:3072 lds
    s_add_u32 m0, s43, 81920
    s_add_u32 s49, s41, 4096
    buffer_load_dwordx4 v2, s[16:19], s49 offen lds
    s_mov_b64 exec, s[50:51]
    buffer_load_dwordx4 v5, s[16:19], s44 offen offset:1024 lds
    s_mov_b64 exec, -1
    s_add_u32 s41, s41, 688128
    s_add_u32 s44, s44, 688128
    s_waitcnt vmcnt(10)
    s_barrier
    s_add_u32 m0, s42, 116736
    s_nop 0
    buffer_load_dwordx4 v1, s[16:19], s40 offen offset:0 lds
    buffer_load_dwordx4 v1, s[16:19], s40 offen offset:1024 lds
    buffer_load_dwordx4 v1, s[16:19], s40 offen offset:2048 lds
    buffer_load_dwordx4 v1, s[16:19], s40 offen offset:3072 lds
    s_add_u32 s40, s40, 524288
    s_add_u32 m0, s43, 116736
    s_nop 0
    buffer_load_dwordx4 v2, s[16:19], s41 offen offset:0 lds
    buffer_load_dwordx4 v2, s[16:19], s41 offen offset:1024 lds
    buffer_load_dwordx4 v2, s[16:19], s41 offen offset:2048 lds
    buffer_load_dwordx4 v2, s[16:19], s41 offen offset:3072 lds
    s_add_u32 m0, s43, 120832
    s_add_u32 s49, s41, 4096
    buffer_load_dwordx4 v2, s[16:19], s49 offen lds
    s_mov_b64 exec, s[50:51]
    buffer_load_dwordx4 v5, s[16:19], s44 offen offset:1024 lds
    s_mov_b64 exec, -1
    s_add_u32 s41, s41, 688128
    s_add_u32 s44, s44, 688128
    s_waitcnt vmcnt(10)
    s_barrier
    s_waitcnt vmcnt(0)
    s_barrier
    s_cmp_ge_u32 s2, 224
    s_cbranch_scc1 L_nofill
    s_cmp_lg_u32 s15, 1
    s_cbranch_scc1 L_nofill
    s_lshl_b32 s20, s2, 10
    s_add_u32 s20, s20, 146800640
    v_mov_b32 v8, -1
    v_mov_b32 v9, -1
    v_mov_b32 v10, -1
    v_mov_b32 v11, -1
    v_lshlrev_b32 v4, 4, v0
    buffer_store_dwordx4 v[8:11], v4, s[16:19], s20 offen sc1
L_nofill:
L_fz_end:
    s_endpgm
.globl final_kernel
.p2align 8
.type final_kernel,@function
final_kernel:
    s_cmp_ge_u32 s2, 224
    s_cbranch_scc1 L_k45_end
    s_load_dwordx2 s[8:9], s[0:1], 48
    s_load_dwordx4 s[4:7], s[0:1], 16
    s_load_dwordx2 s[28:29], s[0:1], 32
    v_lshrrev_b32 v204, 6, v0
    v_and_b32 v200, 63, v0
    v_readfirstlane_b32 s10, v204
    s_cmp_ge_u32 s2, 8
    s_cbranch_scc1 L_nopf45
    s_nop 1
    s_cmp_lg_u32 s10, 7
    s_cbranch_scc1 L_nopf45
    s_getpc_b64 s[60:61]
L_pf_k45:
    s_sub_u32 s60, s60, L_pf_k45-final_kernel
    s_subb_u32 s61, s61, 0
    v_mbcnt_lo_u32_b32 v112, -1, 0
    v_mbcnt_hi_u32_b32 v112, -1, v112
    v_lshlrev_b32 v112, 6, v112
    v_add_u32 v113, 0, v112
    v_min_u32 v113, L_code_end-final_kernel-4, v113
    v_mov_b32 v115, s61
    v_add_co_u32 v114, vcc, s60, v113
    s_nop 1
    v_addc_co_u32 v115, vcc, 0, v115, vcc
    global_load_dword v116, v[114:115], off
    v_add_u32 v113, 4096, v112
    v_min_u32 v113, L_code_end-final_kernel-4, v113
    v_mov_b32 v115, s61
    v_add_co_u32 v114, vcc, s60, v113
    s_nop 1
    v_addc_co_u32 v115, vcc, 0, v115, vcc
    global_load_dword v116, v[114:115], off
    v_add_u32 v113, 8192, v112
    v_min_u32 v113, L_code_end-final_kernel-4, v113
    v_mov_b32 v115, s61
    v_add_co_u32 v114, vcc, s60, v113
    s_nop 1
    v_addc_co_u32 v115, vcc, 0, v115, vcc
    global_load_dword v116, v[114:115], off
L_nopf45:
    v_lshlrev_b32 v214, 2, v0
    v_and_b32 v201, 15, v200
    v_lshrrev_b32 v202, 4, v200
    s_and_b32 s13, s2, 3
    s_lshr_b32 s12, s2, 2
    s_cmp_ge_u32 s12, 28
    s_cselect_b32 s11, 1, 0
    s_mul_i32 s15, s11, 28
    s_sub_u32 s12, s12, s15
    s_mul_i32 s61, s12, 6
    s_mov_b32 s62, 6
    s_add_u32 s14, s61, s10
    s_cmp_lt_u32 s10, s62
    s_cselect_b32 s14, s14, 200
    s_mov_b32 s24, 90112
    v_mul_u32_u24 v203, s24, v202
    v_lshrrev_b32 v205, 2, v201
    s_mov_b32 s24, 720896
    v_mad_u32_u24 v203, v205, s24, v203
    v_and_b32 v205, 3, v201
    v_lshl_add_u32 v203, v205, 4, v203
    s_mul_i32 s24, s11, 11534336
    s_mul_i32 s25, s13, 2883584
    s_add_u32 s24, s24, s25
    s_lshl_b32 s25, s14, 6
    s_add_u32 s24, s24, s25
    s_add_u32 s24, s24, 117440512
    s_mov_b32 s30, 0x05040100
    s_mov_b32 s31, 0x07060302
    s_waitcnt lgkmcnt(0)
    s_mov_b32 s16, s8
    s_and_b32 s17, s9, 0xffff
    s_mov_b32 s18, 268435456
    s_mov_b32 s19, 0x00020000
    s_cmp_ge_u32 s10, 6
    s_cbranch_scc1 L_k45_gb
    s_cmp_ge_u32 s14, 168
    s_cbranch_scc1 L_k45_noy
    s_add_u32 s25, s24, 0
    buffer_load_dwordx4 v[0:3], v203, s[16:19], s25 offen
    s_add_u32 s25, s24, 11264
    buffer_load_dwordx4 v[4:7], v203, s[16:19], s25 offen
    s_add_u32 s25, s24, 22528
    buffer_load_dwordx4 v[8:11], v203, s[16:19], s25 offen
    s_add_u32 s25, s24, 33792
    buffer_load_dwordx4 v[12:15], v203, s[16:19], s25 offen
    s_add_u32 s25, s24, 45056
    buffer_load_dwordx4 v[16:19], v203, s[16:19], s25 offen
    s_add_u32 s25, s24, 56320
    buffer_load_dwordx4 v[20:23], v203, s[16:19], s25 offen
    s_add_u32 s25, s24, 67584
    buffer_load_dwordx4 v[24:27], v203, s[16:19], s25 offen
    s_add_u32 s25, s24, 78848
    buffer_load_dwordx4 v[28:31], v203, s[16:19], s25 offen
    s_add_u32 s25, s24, 360448
    buffer_load_dwordx4 v[32:35], v203, s[16:19], s25 offen
    s_add_u32 s25, s24, 371712
    buffer_load_dwordx4 v[36:39], v203, s[16:19], s25 offen
    s_add_u32 s25, s24, 382976
    buffer_load_dwordx4 v[40:43], v203, s[16:19], s25 offen
    s_add_u32 s25, s24, 394240
    buffer_load_dwordx4 v[44:47], v203, s[16:19], s25 offen
    s_add_u32 s25, s24, 405504
    buffer_load_dwordx4 v[48:51], v203, s[16:19], s25 offen
    s_add_u32 s25, s24, 416768
    buffer_load_dwordx4 v[52:55], v203, s[16:19], s25 offen
    s_add_u32 s25, s24, 428032
    buffer_load_dwordx4 v[56:59], v203, s[16:19], s25 offen
    s_add_u32 s25, s24, 439296
    buffer_load_dwordx4 v[60:63], v203, s[16:19], s25 offen
L_k45_noy:
    s_lshr_b32 s27, s10, 1
    s_and_b32 s33, s10, 1
    s_lshl_b32 s27, s27, 4
    v_add_u32 v204, s27, v201
    s_lshl_b32 s33, s33, 5
    s_add_u32 s33, s33, 1
    v_lshlrev_b32 v205, 3, v202
    v_add_u32 v205, s33, v205
    v_mul_u32_u24 v88, v205, v204
    v_add_u32 v89, 32, v88
    v_add_u32 v205, 2, v205
    v_mul_u32_u24 v90, v205, v204
    v_add_u32 v91, 32, v90
    v_add_u32 v205, 2, v205
    v_mul_u32_u24 v92, v205, v204
    v_add_u32 v93, 32, v92
    v_add_u32 v205, 2, v205
    v_mul_u32_u24 v94, v205, v204
    v_add_u32 v95, 32, v94
    v_and_b32 v88, 127, v88
    v_cvt_f32_u32 v88, v88
    v_mul_f32 v88, 0x3c000000, v88
    v_cos_f32 v88, v88
    v_and_b32 v89, 127, v89
    v_cvt_f32_u32 v89, v89
    v_mul_f32 v89, 0x3c000000, v89
    v_cos_f32 v89, v89
    v_and_b32 v90, 127, v90
    v_cvt_f32_u32 v90, v90
    v_mul_f32 v90, 0x3c000000, v90
    v_cos_f32 v90, v90
    v_and_b32 v91, 127, v91
    v_cvt_f32_u32 v91, v91
    v_mul_f32 v91, 0x3c000000, v91
    v_cos_f32 v91, v91
    v_and_b32 v92, 127, v92
    v_cvt_f32_u32 v92, v92
    v_mul_f32 v92, 0x3c000000, v92
    v_cos_f32 v92, v92
    v_and_b32 v93, 127, v93
    v_cvt_f32_u32 v93, v93
    v_mul_f32 v93, 0x3c000000, v93
    v_cos_f32 v93, v93
    v_and_b32 v94, 127, v94
    v_cvt_f32_u32 v94, v94
    v_mul_f32 v94, 0x3c000000, v94
    v_cos_f32 v94, v94
    v_and_b32 v95, 127, v95
    v_cvt_f32_u32 v95, v95
    v_mul_f32 v95, 0x3c000000, v95
    v_cos_f32 v95, v95
    v_mul_f32 v88, 0x3d000000, v88
    v_mul_f32 v89, 0x3d000000, v89
    v_mul_f32 v90, 0x3d000000, v90
    v_mul_f32 v91, 0x3d000000, v91
    v_mul_f32 v92, 0x3d000000, v92
    v_mul_f32 v93, 0x3d000000, v93
    v_mul_f32 v94, 0x3d000000, v94
    v_mul_f32 v95, 0x3d000000, v95
    v_cvt_pk_bf16_f32 v104, v88, v89
    v_cvt_pk_bf16_f32 v105, v90, v91
    v_cvt_pk_bf16_f32 v106, v92, v93
    v_cvt_pk_bf16_f32 v107, v94, v95
    s_lshl_b32 s26, s10, 10
    v_lshlrev_b32 v207, 4, v200
    v_add_u32 v207, s26, v207
    ds_write_b128 v207, v[104:107] offset:0
L_k45_gb:
    s_mov_b32 s20, s4
    s_and_b32 s21, s5, 0xffff
    s_mov_b32 s22, 1024
    s_mov_b32 s23, 0x00020000
    s_mov_b32 s36, s6
    s_and_b32 s37, s7, 0xffff
    s_mov_b32 s38, 1024
    s_mov_b32 s39, 0x00020000
    v_lshlrev_b32 v210, 4, v201
    s_lshl_b32 s25, s13, 8
    buffer_load_dwordx4 v[232:235], v210, s[20:23], s25 offen
    buffer_load_dwordx4 v[236:239], v210, s[36:39], s25 offen
    s_waitcnt lgkmcnt(0)
    s_barrier
    s_cmp_ge_u32 s10, 6
    s_cbranch_scc1 L_k45_red2
    v_lshlrev_b32 v207, 4, v200
    ds_read_b128 v[64:67], v207 offset:0
    ds_read_b128 v[68:71], v207 offset:1024
    ds_read_b128 v[72:75], v207 offset:2048
    ds_read_b128 v[76:79], v207 offset:3072
    ds_read_b128 v[80:83], v207 offset:4096
    ds_read_b128 v[84:87], v207 offset:5120
    s_cmp_ge_u32 s14, 167
    s_cbranch_scc1 L_k45_zero
    s_waitcnt lgkmcnt(0)
    s_cmp_lg_u32 s14, 166
    s_cbranch_scc1 L_k45_full
    v_cmp_gt_i32 vcc, 17, v201
    s_nop 1
    v_cndmask_b32 v64, 0, v64, vcc
    v_cndmask_b32 v65, 0, v65, vcc
    v_cndmask_b32 v66, 0, v66, vcc
    v_cndmask_b32 v67, 0, v67, vcc
    v_cndmask_b32 v68, 0, v68, vcc
    v_cndmask_b32 v69, 0, v69, vcc
    v_cndmask_b32 v70, 0, v70, vcc
    v_cndmask_b32 v71, 0, v71, vcc
    v_cmp_gt_i32 vcc, 1, v201
    s_nop 1
    v_cndmask_b32 v72, 0, v72, vcc
    v_cndmask_b32 v73, 0, v73, vcc
    v_cndmask_b32 v74, 0, v74, vcc
    v_cndmask_b32 v75, 0, v75, vcc
    v_cndmask_b32 v76, 0, v76, vcc
    v_cndmask_b32 v77, 0, v77, vcc
    v_cndmask_b32 v78, 0, v78, vcc
    v_cndmask_b32 v79, 0, v79, vcc
    v_cmp_gt_i32 vcc, 0, v201
    s_nop 1
    v_cndmask_b32 v80, 0, v80, vcc
    v_cndmask_b32 v81, 0, v81, vcc
    v_cndmask_b32 v82, 0, v82, vcc
    v_cndmask_b32 v83, 0, v83, vcc
    v_cndmask_b32 v84, 0, v84, vcc
    v_cndmask_b32 v85, 0, v85, vcc
    v_cndmask_b32 v86, 0, v86, vcc
    v_cndmask_b32 v87, 0, v87, vcc
L_k45_full:
    s_waitcnt vmcnt(2)
    v_perm_b32 v88, v4, v0, s30
    v_perm_b32 v89, v12, v8, s30
    v_perm_b32 v90, v20, v16, s30
    v_perm_b32 v91, v28, v24, s30
    v_perm_b32 v92, v4, v0, s31
    v_perm_b32 v93, v12, v8, s31
    v_perm_b32 v94, v20, v16, s31
    v_perm_b32 v95, v28, v24, s31
    v_perm_b32 v96, v36, v32, s30
    v_perm_b32 v97, v44, v40, s30
    v_perm_b32 v98, v52, v48, s30
    v_perm_b32 v99, v60, v56, s30
    v_perm_b32 v100, v36, v32, s31
    v_perm_b32 v101, v44, v40, s31
    v_perm_b32 v102, v52, v48, s31
    v_perm_b32 v103, v60, v56, s31
    v_mfma_f32_16x16x32_bf16 v[104:107], v[64:67], v[88:91], 0
    v_mfma_f32_16x16x32_bf16 v[108:111], v[64:67], v[92:95], 0
    v_mfma_f32_16x16x32_bf16 v[136:139], v[72:75], v[88:91], 0
    v_mfma_f32_16x16x32_bf16 v[140:143], v[72:75], v[92:95], 0
    v_mfma_f32_16x16x32_bf16 v[168:171], v[80:83], v[88:91], 0
    v_mfma_f32_16x16x32_bf16 v[172:175], v[80:83], v[92:95], 0
    v_mfma_f32_16x16x32_bf16 v[104:107], v[68:71], v[96:99], v[104:107]
    v_mfma_f32_16x16x32_bf16 v[108:111], v[68:71], v[100:103], v[108:111]
    v_mfma_f32_16x16x32_bf16 v[136:139], v[76:79], v[96:99], v[136:139]
    v_mfma_f32_16x16x32_bf16 v[140:143], v[76:79], v[100:103], v[140:143]
    v_mfma_f32_16x16x32_bf16 v[168:171], v[84:87], v[96:99], v[168:171]
    v_mfma_f32_16x16x32_bf16 v[172:175], v[84:87], v[100:103], v[172:175]
    v_perm_b32 v88, v5, v1, s30
    v_perm_b32 v89, v13, v9, s30
    v_perm_b32 v90, v21, v17, s30
    v_perm_b32 v91, v29, v25, s30
    v_perm_b32 v92, v5, v1, s31
    v_perm_b32 v93, v13, v9, s31
    v_perm_b32 v94, v21, v17, s31
    v_perm_b32 v95, v29, v25, s31
    v_perm_b32 v96, v37, v33, s30
    v_perm_b32 v97, v45, v41, s30
    v_perm_b32 v98, v53, v49, s30
    v_perm_b32 v99, v61, v57, s30
    v_perm_b32 v100, v37, v33, s31
    v_perm_b32 v101, v45, v41, s31
    v_perm_b32 v102, v53, v49, s31
    v_perm_b32 v103, v61, v57, s31
    v_mfma_f32_16x16x32_bf16 v[112:115], v[64:67], v[88:91], 0
    v_mfma_f32_16x16x32_bf16 v[116:119], v[64:67], v[92:95], 0
    v_mfma_f32_16x16x32_bf16 v[144:147], v[72:75], v[88:91], 0
    v_mfma_f32_16x16x32_bf16 v[148:151], v[72:75], v[92:95], 0
    v_mfma_f32_16x16x32_bf16 v[176:179], v[80:83], v[88:91], 0
    v_mfma_f32_16x16x32_bf16 v[180:183], v[80:83], v[92:95], 0
    v_mfma_f32_16x16x32_bf16 v[112:115], v[68:71], v[96:99], v[112:115]
    v_mfma_f32_16x16x32_bf16 v[116:119], v[68:71], v[100:103], v[116:119]
    v_mfma_f32_16x16x32_bf16 v[144:147], v[76:79], v[96:99], v[144:147]
    v_mfma_f32_16x16x32_bf16 v[148:151], v[76:79], v[100:103], v[148:151]
    v_mfma_f32_16x16x32_bf16 v[176:179], v[84:87], v[96:99], v[176:179]
    v_mfma_f32_16x16x32_bf16 v[180:183], v[84:87], v[100:103], v[180:183]
    v_perm_b32 v88, v6, v2, s30
    v_perm_b32 v89, v14, v10, s30
    v_perm_b32 v90, v22, v18, s30
    v_perm_b32 v91, v30, v26, s30
    v_perm_b32 v92, v6, v2, s31
    v_perm_b32 v93, v14, v10, s31
    v_perm_b32 v94, v22, v18, s31
    v_perm_b32 v95, v30, v26, s31
    v_perm_b32 v96, v38, v34, s30
    v_perm_b32 v97, v46, v42, s30
    v_perm_b32 v98, v54, v50, s30
    v_perm_b32 v99, v62, v58, s30
    v_perm_b32 v100, v38, v34, s31
    v_perm_b32 v101, v46, v42, s31
    v_perm_b32 v102, v54, v50, s31
    v_perm_b32 v103, v62, v58, s31
    v_mfma_f32_16x16x32_bf16 v[120:123], v[64:67], v[88:91], 0
    v_mfma_f32_16x16x32_bf16 v[124:127], v[64:67], v[92:95], 0
    v_mfma_f32_16x16x32_bf16 v[152:155], v[72:75], v[88:91], 0
    v_mfma_f32_16x16x32_bf16 v[156:159], v[72:75], v[92:95], 0
    v_mfma_f32_16x16x32_bf16 v[184:187], v[80:83], v[88:91], 0
    v_mfma_f32_16x16x32_bf16 v[188:191], v[80:83], v[92:95], 0
    v_mfma_f32_16x16x32_bf16 v[120:123], v[68:71], v[96:99], v[120:123]
    v_mfma_f32_16x16x32_bf16 v[124:127], v[68:71], v[100:103], v[124:127]
    v_mfma_f32_16x16x32_bf16 v[152:155], v[76:79], v[96:99], v[152:155]
    v_mfma_f32_16x16x32_bf16 v[156:159], v[76:79], v[100:103], v[156:159]
    v_mfma_f32_16x16x32_bf16 v[184:187], v[84:87], v[96:99], v[184:187]
    v_mfma_f32_16x16x32_bf16 v[188:191], v[84:87], v[100:103], v[188:191]
    v_perm_b32 v88, v7, v3, s30
    v_perm_b32 v89, v15, v11, s30
    v_perm_b32 v90, v23, v19, s30
    v_perm_b32 v91, v31, v27, s30
    v_perm_b32 v92, v7, v3, s31
    v_perm_b32 v93, v15, v11, s31
    v_perm_b32 v94, v23, v19, s31
    v_perm_b32 v95, v31, v27, s31
    v_perm_b32 v96, v39, v35, s30
    v_perm_b32 v97, v47, v43, s30
    v_perm_b32 v98, v55, v51, s30
    v_perm_b32 v99, v63, v59, s30
    v_perm_b32 v100, v39, v35, s31
    v_perm_b32 v101, v47, v43, s31
    v_perm_b32 v102, v55, v51, s31
    v_perm_b32 v103, v63, v59, s31
    v_mfma_f32_16x16x32_bf16 v[128:131], v[64:67], v[88:91], 0
    v_mfma_f32_16x16x32_bf16 v[132:135], v[64:67], v[92:95], 0
    v_mfma_f32_16x16x32_bf16 v[160:163], v[72:75], v[88:91], 0
    v_mfma_f32_16x16x32_bf16 v[164:167], v[72:75], v[92:95], 0
    v_mfma_f32_16x16x32_bf16 v[192:195], v[80:83], v[88:91], 0
    v_mfma_f32_16x16x32_bf16 v[196:199], v[80:83], v[92:95], 0
    v_mfma_f32_16x16x32_bf16 v[128:131], v[68:71], v[96:99], v[128:131]
    v_mfma_f32_16x16x32_bf16 v[132:135], v[68:71], v[100:103], v[132:135]
    v_mfma_f32_16x16x32_bf16 v[160:163], v[76:79], v[96:99], v[160:163]
    v_mfma_f32_16x16x32_bf16 v[164:167], v[76:79], v[100:103], v[164:167]
    v_mfma_f32_16x16x32_bf16 v[192:195], v[84:87], v[96:99], v[192:195]
    v_mfma_f32_16x16x32_bf16 v[196:199], v[84:87], v[100:103], v[196:199]
    s_nop 7
    v_mul_f32 v224, v104, v104
    v_mov_b32 v216, v104
    v_fmac_f32 v224, v105, v105
    v_add_f32 v216, v216, v105
    v_fmac_f32 v224, v106, v106
    v_add_f32 v216, v216, v106
    v_fmac_f32 v224, v107, v107
    v_add_f32 v216, v216, v107
    v_fmac_f32 v224, v136, v136
    v_add_f32 v216, v216, v136
    v_fmac_f32 v224, v137, v137
    v_add_f32 v216, v216, v137
    v_fmac_f32 v224, v138, v138
    v_add_f32 v216, v216, v138
    v_fmac_f32 v224, v139, v139
    v_add_f32 v216, v216, v139
    v_fmac_f32 v224, v168, v168
    v_add_f32 v216, v216, v168
    v_fmac_f32 v224, v169, v169
    v_add_f32 v216, v216, v169
    v_fmac_f32 v224, v170, v170
    v_add_f32 v216, v216, v170
    v_fmac_f32 v224, v171, v171
    v_add_f32 v216, v216, v171
    v_mul_f32 v225, v108, v108
    v_mov_b32 v217, v108
    v_fmac_f32 v225, v109, v109
    v_add_f32 v217, v217, v109
    v_fmac_f32 v225, v110, v110
    v_add_f32 v217, v217, v110
    v_fmac_f32 v225, v111, v111
    v_add_f32 v217, v217, v111
    v_fmac_f32 v225, v140, v140
    v_add_f32 v217, v217, v140
    v_fmac_f32 v225, v141, v141
    v_add_f32 v217, v217, v141
    v_fmac_f32 v225, v142, v142
    v_add_f32 v217, v217, v142
    v_fmac_f32 v225, v143, v143
    v_add_f32 v217, v217, v143
    v_fmac_f32 v225, v172, v172
    v_add_f32 v217, v217, v172
    v_fmac_f32 v225, v173, v173
    v_add_f32 v217, v217, v173
    v_fmac_f32 v225, v174, v174
    v_add_f32 v217, v217, v174
    v_fmac_f32 v225, v175, v175
    v_add_f32 v217, v217, v175
    v_mul_f32 v226, v112, v112
    v_mov_b32 v218, v112
    v_fmac_f32 v226, v113, v113
    v_add_f32 v218, v218, v113
    v_fmac_f32 v226, v114, v114
    v_add_f32 v218, v218, v114
    v_fmac_f32 v226, v115, v115
    v_add_f32 v218, v218, v115
    v_fmac_f32 v226, v144, v144
    v_add_f32 v218, v218, v144
    v_fmac_f32 v226, v145, v145
    v_add_f32 v218, v218, v145
    v_fmac_f32 v226, v146, v146
    v_add_f32 v218, v218, v146
    v_fmac_f32 v226, v147, v147
    v_add_f32 v218, v218, v147
    v_fmac_f32 v226, v176, v176
    v_add_f32 v218, v218, v176
    v_fmac_f32 v226, v177, v177
    v_add_f32 v218, v218, v177
    v_fmac_f32 v226, v178, v178
    v_add_f32 v218, v218, v178
    v_fmac_f32 v226, v179, v179
    v_add_f32 v218, v218, v179
    v_mul_f32 v227, v116, v116
    v_mov_b32 v219, v116
    v_fmac_f32 v227, v117, v117
    v_add_f32 v219, v219, v117
    v_fmac_f32 v227, v118, v118
    v_add_f32 v219, v219, v118
    v_fmac_f32 v227, v119, v119
    v_add_f32 v219, v219, v119
    v_fmac_f32 v227, v148, v148
    v_add_f32 v219, v219, v148
    v_fmac_f32 v227, v149, v149
    v_add_f32 v219, v219, v149
    v_fmac_f32 v227, v150, v150
    v_add_f32 v219, v219, v150
    v_fmac_f32 v227, v151, v151
    v_add_f32 v219, v219, v151
    v_fmac_f32 v227, v180, v180
    v_add_f32 v219, v219, v180
    v_fmac_f32 v227, v181, v181
    v_add_f32 v219, v219, v181
    v_fmac_f32 v227, v182, v182
    v_add_f32 v219, v219, v182
    v_fmac_f32 v227, v183, v183
    v_add_f32 v219, v219, v183
    v_mul_f32 v228, v120, v120
    v_mov_b32 v220, v120
    v_fmac_f32 v228, v121, v121
    v_add_f32 v220, v220, v121
    v_fmac_f32 v228, v122, v122
    v_add_f32 v220, v220, v122
    v_fmac_f32 v228, v123, v123
    v_add_f32 v220, v220, v123
    v_fmac_f32 v228, v152, v152
    v_add_f32 v220, v220, v152
    v_fmac_f32 v228, v153, v153
    v_add_f32 v220, v220, v153
    v_fmac_f32 v228, v154, v154
    v_add_f32 v220, v220, v154
    v_fmac_f32 v228, v155, v155
    v_add_f32 v220, v220, v155
    v_fmac_f32 v228, v184, v184
    v_add_f32 v220, v220, v184
    v_fmac_f32 v228, v185, v185
    v_add_f32 v220, v220, v185
    v_fmac_f32 v228, v186, v186
    v_add_f32 v220, v220, v186
    v_fmac_f32 v228, v187, v187
    v_add_f32 v220, v220, v187
    v_mul_f32 v229, v124, v124
    v_mov_b32 v221, v124
    v_fmac_f32 v229, v125, v125
    v_add_f32 v221, v221, v125
    v_fmac_f32 v229, v126, v126
    v_add_f32 v221, v221, v126
    v_fmac_f32 v229, v127, v127
    v_add_f32 v221, v221, v127
    v_fmac_f32 v229, v156, v156
    v_add_f32 v221, v221, v156
    v_fmac_f32 v229, v157, v157
    v_add_f32 v221, v221, v157
    v_fmac_f32 v229, v158, v158
    v_add_f32 v221, v221, v158
    v_fmac_f32 v229, v159, v159
    v_add_f32 v221, v221, v159
    v_fmac_f32 v229, v188, v188
    v_add_f32 v221, v221, v188
    v_fmac_f32 v229, v189, v189
    v_add_f32 v221, v221, v189
    v_fmac_f32 v229, v190, v190
    v_add_f32 v221, v221, v190
    v_fmac_f32 v229, v191, v191
    v_add_f32 v221, v221, v191
    v_mul_f32 v230, v128, v128
    v_mov_b32 v222, v128
    v_fmac_f32 v230, v129, v129
    v_add_f32 v222, v222, v129
    v_fmac_f32 v230, v130, v130
    v_add_f32 v222, v222, v130
    v_fmac_f32 v230, v131, v131
    v_add_f32 v222, v222, v131
    v_fmac_f32 v230, v160, v160
    v_add_f32 v222, v222, v160
    v_fmac_f32 v230, v161, v161
    v_add_f32 v222, v222, v161
    v_fmac_f32 v230, v162, v162
    v_add_f32 v222, v222, v162
    v_fmac_f32 v230, v163, v163
    v_add_f32 v222, v222, v163
    v_fmac_f32 v230, v192, v192
    v_add_f32 v222, v222, v192
    v_fmac_f32 v230, v193, v193
    v_add_f32 v222, v222, v193
    v_fmac_f32 v230, v194, v194
    v_add_f32 v222, v222, v194
    v_fmac_f32 v230, v195, v195
    v_add_f32 v222, v222, v195
    v_mul_f32 v231, v132, v132
    v_mov_b32 v223, v132
    v_fmac_f32 v231, v133, v133
    v_add_f32 v223, v223, v133
    v_fmac_f32 v231, v134, v134
    v_add_f32 v223, v223, v134
    v_fmac_f32 v231, v135, v135
    v_add_f32 v223, v223, v135
    v_fmac_f32 v231, v164, v164
    v_add_f32 v223, v223, v164
    v_fmac_f32 v231, v165, v165
    v_add_f32 v223, v223, v165
    v_fmac_f32 v231, v166, v166
    v_add_f32 v223, v223, v166
    v_fmac_f32 v231, v167, v167
    v_add_f32 v223, v223, v167
    v_fmac_f32 v231, v196, v196
    v_add_f32 v223, v223, v196
    v_fmac_f32 v231, v197, v197
    v_add_f32 v223, v223, v197
    v_fmac_f32 v231, v198, v198
    v_add_f32 v223, v223, v198
    v_fmac_f32 v231, v199, v199
    v_add_f32 v223, v223, v199
    s_branch L_k45_red
L_k45_zero:
    s_waitcnt vmcnt(0) lgkmcnt(0)
    v_mov_b32 v216, 0
    v_mov_b32 v224, 0
    v_mov_b32 v217, 0
    v_mov_b32 v225, 0
    v_mov_b32 v218, 0
    v_mov_b32 v226, 0
    v_mov_b32 v219, 0
    v_mov_b32 v227, 0
    v_mov_b32 v220, 0
    v_mov_b32 v228, 0
    v_mov_b32 v221, 0
    v_mov_b32 v229, 0
    v_mov_b32 v222, 0
    v_mov_b32 v230, 0
    v_mov_b32 v223, 0
    v_mov_b32 v231, 0
L_k45_red:
    s_lshl_b32 s25, s10, 12
    v_lshlrev_b32 v204, 10, v202
    v_lshl_add_u32 v204, v201, 5, v204
    v_add_u32 v204, s25, v204
    ds_write_b128 v204, v[216:219] offset:8192
    ds_write_b128 v204, v[220:223] offset:8208
    ds_write_b128 v204, v[224:227] offset:8704
    ds_write_b128 v204, v[228:231] offset:8720
L_k45_red2:
    s_waitcnt lgkmcnt(0)
    s_barrier
    s_mul_i32 s24, s11, 112
    s_mul_i32 s25, s13, 28
    s_add_u32 s24, s24, s25
    s_lshl_b32 s26, s24, 10
    s_add_u32 s26, s26, 146800640
    s_cmp_ge_u32 s10, 6
    s_cbranch_scc1 L_k45_sumdone
    s_cmp_lt_u32 s10, 4
    s_cbranch_scc1 L_k45_red4
    s_lshl_b32 s25, s10, 13
    v_lshlrev_b32 v205, 4, v200
    v_add_u32 v205, s25, v205
    ds_write_b32 v205, v107 offset:33792
    ds_write_b32 v205, v139 offset:33796
    ds_write_b32 v205, v171 offset:33800
    ds_write_b32 v205, v111 offset:34816
    ds_write_b32 v205, v143 offset:34820
    ds_write_b32 v205, v175 offset:34824
    ds_write_b32 v205, v115 offset:35840
    ds_write_b32 v205, v147 offset:35844
    ds_write_b32 v205, v179 offset:35848
    ds_write_b32 v205, v119 offset:36864
    ds_write_b32 v205, v151 offset:36868
    ds_write_b32 v205, v183 offset:36872
    ds_write_b32 v205, v123 offset:37888
    ds_write_b32 v205, v155 offset:37892
    ds_write_b32 v205, v187 offset:37896
    ds_write_b32 v205, v127 offset:38912
    ds_write_b32 v205, v159 offset:38916
    ds_write_b32 v205, v191 offset:38920
    ds_write_b32 v205, v131 offset:39936
    ds_write_b32 v205, v163 offset:39940
    ds_write_b32 v205, v195 offset:39944
    ds_write_b32 v205, v135 offset:40960
    ds_write_b32 v205, v167 offset:40964
    ds_write_b32 v205, v199 offset:40968
    s_branch L_k45_sumdone
L_k45_red4:
    ds_read_b32 v16, v214 offset:8192
    ds_read_b32 v17, v214 offset:9216
    ds_read_b32 v18, v214 offset:10240
    ds_read_b32 v19, v214 offset:11264
    ds_read_b32 v20, v214 offset:12288
    ds_read_b32 v21, v214 offset:13312
    ds_read_b32 v22, v214 offset:14336
    ds_read_b32 v23, v214 offset:15360
    ds_read_b32 v24, v214 offset:16384
    ds_read_b32 v25, v214 offset:17408
    ds_read_b32 v26, v214 offset:18432
    ds_read_b32 v27, v214 offset:19456
    ds_read_b32 v28, v214 offset:20480
    ds_read_b32 v29, v214 offset:21504
    ds_read_b32 v30, v214 offset:22528
    ds_read_b32 v31, v214 offset:23552
    ds_read_b32 v32, v214 offset:24576
    ds_read_b32 v33, v214 offset:25600
    ds_read_b32 v34, v214 offset:26624
    ds_read_b32 v35, v214 offset:27648
    ds_read_b32 v36, v214 offset:28672
    ds_read_b32 v37, v214 offset:29696
    ds_read_b32 v38, v214 offset:30720
    ds_read_b32 v39, v214 offset:31744
    s_waitcnt lgkmcnt(0)
    v_add_f32 v16, v16, v17
    v_add_f32 v18, v18, v19
    v_add_f32 v20, v20, v21
    v_add_f32 v22, v22, v23
    v_add_f32 v24, v24, v25
    v_add_f32 v26, v26, v27
    v_add_f32 v28, v28, v29
    v_add_f32 v30, v30, v31
    v_add_f32 v32, v32, v33
    v_add_f32 v34, v34, v35
    v_add_f32 v36, v36, v37
    v_add_f32 v38, v38, v39
    v_add_f32 v16, v16, v18
    v_add_f32 v20, v20, v22
    v_add_f32 v24, v24, v26
    v_add_f32 v28, v28, v30
    v_add_f32 v32, v32, v34
    v_add_f32 v36, v36, v38
    v_add_f32 v16, v16, v20
    v_add_f32 v24, v24, v28
    v_add_f32 v32, v32, v36
    v_add_f32 v16, v16, v24
    v_add_f32 v16, v16, v32
    s_lshl_b32 s24, s12, 10
    s_add_u32 s24, s24, s26
    buffer_store_dword v16, v214, s[16:19], s24 offen sc1
    s_lshl_b32 s25, s10, 13
    v_lshlrev_b32 v205, 4, v200
    v_add_u32 v205, s25, v205
    ds_write_b32 v205, v107 offset:33792
    ds_write_b32 v205, v139 offset:33796
    ds_write_b32 v205, v171 offset:33800
    ds_write_b32 v205, v111 offset:34816
    ds_write_b32 v205, v143 offset:34820
    ds_write_b32 v205, v175 offset:34824
    ds_write_b32 v205, v115 offset:35840
    ds_write_b32 v205, v147 offset:35844
    ds_write_b32 v205, v179 offset:35848
    ds_write_b32 v205, v119 offset:36864
    ds_write_b32 v205, v151 offset:36868
    ds_write_b32 v205, v183 offset:36872
    ds_write_b32 v205, v123 offset:37888
    ds_write_b32 v205, v155 offset:37892
    ds_write_b32 v205, v187 offset:37896
    ds_write_b32 v205, v127 offset:38912
    ds_write_b32 v205, v159 offset:38916
    ds_write_b32 v205, v191 offset:38920
    ds_write_b32 v205, v131 offset:39936
    ds_write_b32 v205, v163 offset:39940
    ds_write_b32 v205, v195 offset:39944
    ds_write_b32 v205, v135 offset:40960
    ds_write_b32 v205, v167 offset:40964
    ds_write_b32 v205, v199 offset:40968
    s_mov_b32 s33, 16384
L_k45_poll:
    s_mov_b32 s27, s26
    buffer_load_dword v0, v214, s[16:19], s27 offen offset:0 sc1
    buffer_load_dword v1, v214, s[16:19], s27 offen offset:1024 sc1
    buffer_load_dword v2, v214, s[16:19], s27 offen offset:2048 sc1
    buffer_load_dword v3, v214, s[16:19], s27 offen offset:3072 sc1
    s_add_u32 s27, s27, 4096
    buffer_load_dword v4, v214, s[16:19], s27 offen offset:0 sc1
    buffer_load_dword v5, v214, s[16:19], s27 offen offset:1024 sc1
    buffer_load_dword v6, v214, s[16:19], s27 offen offset:2048 sc1
    buffer_load_dword v7, v214, s[16:19], s27 offen offset:3072 sc1
    s_add_u32 s27, s27, 4096
    buffer_load_dword v8, v214, s[16:19], s27 offen offset:0 sc1
    buffer_load_dword v9, v214, s[16:19], s27 offen offset:1024 sc1
    buffer_load_dword v10, v214, s[16:19], s27 offen offset:2048 sc1
    buffer_load_dword v11, v214, s[16:19], s27 offen offset:3072 sc1
    s_add_u32 s27, s27, 4096
    buffer_load_dword v12, v214, s[16:19], s27 offen offset:0 sc1
    buffer_load_dword v13, v214, s[16:19], s27 offen offset:1024 sc1
    buffer_load_dword v14, v214, s[16:19], s27 offen offset:2048 sc1
    buffer_load_dword v15, v214, s[16:19], s27 offen offset:3072 sc1
    s_add_u32 s27, s27, 4096
    buffer_load_dword v16, v214, s[16:19], s27 offen offset:0 sc1
    buffer_load_dword v17, v214, s[16:19], s27 offen offset:1024 sc1
    buffer_load_dword v18, v214, s[16:19], s27 offen offset:2048 sc1
    buffer_load_dword v19, v214, s[16:19], s27 offen offset:3072 sc1
    s_add_u32 s27, s27, 4096
    buffer_load_dword v20, v214, s[16:19], s27 offen offset:0 sc1
    buffer_load_dword v21, v214, s[16:19], s27 offen offset:1024 sc1
    buffer_load_dword v22, v214, s[16:19], s27 offen offset:2048 sc1
    buffer_load_dword v23, v214, s[16:19], s27 offen offset:3072 sc1
    s_add_u32 s27, s27, 4096
    buffer_load_dword v24, v214, s[16:19], s27 offen offset:0 sc1
    buffer_load_dword v25, v214, s[16:19], s27 offen offset:1024 sc1
    buffer_load_dword v26, v214, s[16:19], s27 offen offset:2048 sc1
    buffer_load_dword v27, v214, s[16:19], s27 offen offset:3072 sc1
    s_waitcnt vmcnt(0)
    v_max3_u32 v32, v0, v1, v2
    v_max3_u32 v32, v32, v3, v4
    v_max3_u32 v32, v32, v5, v6
    v_max3_u32 v32, v32, v7, v8
    v_max3_u32 v32, v32, v9, v10
    v_max3_u32 v32, v32, v11, v12
    v_max3_u32 v32, v32, v13, v14
    v_max3_u32 v32, v32, v15, v16
    v_max3_u32 v32, v32, v17, v18
    v_max3_u32 v32, v32, v19, v20
    v_max3_u32 v32, v32, v21, v22
    v_max3_u32 v32, v32, v23, v24
    v_max3_u32 v32, v32, v25, v26
    v_max_u32 v32, v32, v27
    v_cmp_eq_u32 vcc, -1, v32
    s_nop 3
    s_cmp_eq_u64 vcc, 0
    s_cbranch_scc1 L_k45_got
    s_sub_u32 s33, s33, 1
    s_cmp_eq_u32 s33, 0
    s_cbranch_scc1 L_k45_got
    s_sleep 2
    s_branch L_k45_poll
L_k45_got:
    v_add_f32 v0, v0, v1
    v_add_f32 v2, v2, v3
    v_add_f32 v4, v4, v5
    v_add_f32 v6, v6, v7
    v_add_f32 v8, v8, v9
    v_add_f32 v10, v10, v11
    v_add_f32 v12, v12, v13
    v_add_f32 v14, v14, v15
    v_add_f32 v16, v16, v17
    v_add_f32 v18, v18, v19
    v_add_f32 v20, v20, v21
    v_add_f32 v22, v22, v23
    v_add_f32 v24, v24, v25
    v_add_f32 v26, v26, v27
    v_add_f32 v0, v0, v2
    v_add_f32 v4, v4, v6
    v_add_f32 v8, v8, v10
    v_add_f32 v12, v12, v14
    v_add_f32 v16, v16, v18
    v_add_f32 v20, v20, v22
    v_add_f32 v24, v24, v26
    v_add_f32 v0, v0, v4
    v_add_f32 v8, v8, v12
    v_add_f32 v16, v16, v20
    v_add_f32 v0, v0, v8
    v_add_f32 v16, v16, v24
    v_add_f32 v0, v0, v16
    ds_write_b32 v214, v0 offset:32768
L_k45_sumdone:
    s_waitcnt lgkmcnt(0)
    s_barrier
    s_cmp_lt_u32 s10, 6
    s_cbranch_scc1 L_k45_nohread
    s_waitcnt vmcnt(0)
    s_sub_u32 s25, s10, 6
    s_mul_i32 s25, s25, 3
    s_lshl_b32 s25, s25, 13
    v_lshlrev_b32 v205, 4, v200
    v_add_u32 v205, s25, v205
    ds_read_b96 v[104:106], v205 offset:33792
    ds_read_b96 v[108:110], v205 offset:34816
    ds_read_b96 v[112:114], v205 offset:35840
    ds_read_b96 v[116:118], v205 offset:36864
    ds_read_b96 v[120:122], v205 offset:37888
    ds_read_b96 v[124:126], v205 offset:38912
    ds_read_b96 v[128:130], v205 offset:39936
    ds_read_b96 v[132:134], v205 offset:40960
    s_waitcnt lgkmcnt(0)
    ds_read_b96 v[136:138], v205 offset:41984
    ds_read_b96 v[140:142], v205 offset:43008
    ds_read_b96 v[144:146], v205 offset:44032
    ds_read_b96 v[148:150], v205 offset:45056
    ds_read_b96 v[152:154], v205 offset:46080
    ds_read_b96 v[156:158], v205 offset:47104
    ds_read_b96 v[160:162], v205 offset:48128
    ds_read_b96 v[164:166], v205 offset:49152
    s_waitcnt lgkmcnt(0)
    ds_read_b96 v[168:170], v205 offset:50176
    ds_read_b96 v[172:174], v205 offset:51200
    ds_read_b96 v[176:178], v205 offset:52224
    ds_read_b96 v[180:182], v205 offset:53248
    ds_read_b96 v[184:186], v205 offset:54272
    ds_read_b96 v[188:190], v205 offset:55296
    ds_read_b96 v[192:194], v205 offset:56320
    ds_read_b96 v[196:198], v205 offset:57344
L_k45_nohread:
    v_lshlrev_b32 v210, 5, v201
    ds_read_b128 v[44:47], v210 offset:32768
    ds_read_b128 v[48:51], v210 offset:32784
    ds_read_b128 v[52:55], v210 offset:33280
    ds_read_b128 v[56:59], v210 offset:33296
    s_mov_b32 s24, 0x39035177
    s_mov_b32 s25, 0x3727c5ac
    s_waitcnt vmcnt(0) lgkmcnt(0)
    v_mul_f32 v44, s24, v44
    v_mul_f32 v52, s24, v52
    v_fma_f32 v52, -v44, v44, v52
    v_max_f32 v52, 0, v52
    v_add_f32 v52, s25, v52
    v_rsq_f32 v52, v52
    v_lshlrev_b32 v216, 16, v232
    v_lshlrev_b32 v224, 16, v236
    v_mul_f32 v216, v216, v52
    v_fma_f32 v224, -v44, v216, v224
    v_mul_f32 v45, s24, v45
    v_mul_f32 v53, s24, v53
    v_fma_f32 v53, -v45, v45, v53
    v_max_f32 v53, 0, v53
    v_add_f32 v53, s25, v53
    v_rsq_f32 v53, v53
    v_and_b32 v217, 0xffff0000, v232
    v_and_b32 v225, 0xffff0000, v236
    v_mul_f32 v217, v217, v53
    v_fma_f32 v225, -v45, v217, v225
    v_mul_f32 v46, s24, v46
    v_mul_f32 v54, s24, v54
    v_fma_f32 v54, -v46, v46, v54
    v_max_f32 v54, 0, v54
    v_add_f32 v54, s25, v54
    v_rsq_f32 v54, v54
    v_lshlrev_b32 v218, 16, v233
    v_lshlrev_b32 v226, 16, v237
    v_mul_f32 v218, v218, v54
    v_fma_f32 v226, -v46, v218, v226
    v_mul_f32 v47, s24, v47
    v_mul_f32 v55, s24, v55
    v_fma_f32 v55, -v47, v47, v55
    v_max_f32 v55, 0, v55
    v_add_f32 v55, s25, v55
    v_rsq_f32 v55, v55
    v_and_b32 v219, 0xffff0000, v233
    v_and_b32 v227, 0xffff0000, v237
    v_mul_f32 v219, v219, v55
    v_fma_f32 v227, -v47, v219, v227
    v_mul_f32 v48, s24, v48
    v_mul_f32 v56, s24, v56
    v_fma_f32 v56, -v48, v48, v56
    v_max_f32 v56, 0, v56
    v_add_f32 v56, s25, v56
    v_rsq_f32 v56, v56
    v_lshlrev_b32 v220, 16, v234
    v_lshlrev_b32 v228, 16, v238
    v_mul_f32 v220, v220, v56
    v_fma_f32 v228, -v48, v220, v228
    v_mul_f32 v49, s24, v49
    v_mul_f32 v57, s24, v57
    v_fma_f32 v57, -v49, v49, v57
    v_max_f32 v57, 0, v57
    v_add_f32 v57, s25, v57
    v_rsq_f32 v57, v57
    v_and_b32 v221, 0xffff0000, v234
    v_and_b32 v229, 0xffff0000, v238
    v_mul_f32 v221, v221, v57
    v_fma_f32 v229, -v49, v221, v229
    v_mul_f32 v50, s24, v50
    v_mul_f32 v58, s24, v58
    v_fma_f32 v58, -v50, v50, v58
    v_max_f32 v58, 0, v58
    v_add_f32 v58, s25, v58
    v_rsq_f32 v58, v58
    v_lshlrev_b32 v222, 16, v235
    v_lshlrev_b32 v230, 16, v239
    v_mul_f32 v222, v222, v58
    v_fma_f32 v230, -v50, v222, v230
    v_mul_f32 v51, s24, v51
    v_mul_f32 v59, s24, v59
    v_fma_f32 v59, -v51, v51, v59
    v_max_f32 v59, 0, v59
    v_add_f32 v59, s25, v59
    v_rsq_f32 v59, v59
    v_and_b32 v223, 0xffff0000, v235
    v_and_b32 v231, 0xffff0000, v239
    v_mul_f32 v223, v223, v59
    v_fma_f32 v231, -v51, v223, v231
    s_mul_i32 s24, s11, 8176640
    s_add_u32 s28, s28, s24
    s_addc_u32 s29, s29, 0
    s_mov_b32 s32, s28
    s_and_b32 s33, s29, 0xffff
    s_mov_b32 s34, 8176640
    s_mov_b32 s35, 0x00020000
    s_lshl_b32 s25, s13, 8
    v_lshlrev_b32 v210, 12, v202
    v_lshl_add_u32 v210, v201, 4, v210
    v_add_u32 v210, s25, v210
    s_mov_b32 s26, 0xbdd2d3e8
    v_mov_b32 v211, 0xc0135761
    s_cmp_ge_u32 s10, 6
    s_cbranch_scc1 L_k45_hoff
    s_cmp_ge_u32 s14, 167
    s_cbranch_scc1 L_k45_fin
    s_mul_i32 s24, s14, 49152
    s_add_u32 s52, s24, 0
    s_add_u32 s53, s24, 1024
    s_add_u32 s54, s24, 2048
    s_add_u32 s55, s24, 16384
    s_add_u32 s56, s24, 17408
    s_add_u32 s57, s24, 18432
    s_add_u32 s58, s24, 32768
    s_add_u32 s59, s24, 33792
    s_add_u32 s60, s24, 34816
    s_branch L_k45_gelu
L_k45_hoff:
    s_sub_u32 s25, s10, 6
    s_mul_i32 s25, s25, 3
    s_add_u32 s24, s61, s25
    s_mul_i32 s24, s24, 49152
    s_add_u32 s52, s24, 3072
    s_add_u32 s53, s24, 19456
    s_add_u32 s54, s24, 35840
    s_add_u32 s55, s24, 52224
    s_add_u32 s56, s24, 68608
    s_add_u32 s57, s24, 84992
    s_add_u32 s58, s24, 101376
    s_add_u32 s59, s24, 117760
    s_add_u32 s60, s24, 134144
    s_add_u32 s25, s25, 2
    s_cmp_lt_u32 s25, s62
    s_cselect_b32 s58, s58, 0x7ff00000
    s_cselect_b32 s59, s59, 0x7ff00000
    s_cselect_b32 s60, s60, 0x7ff00000
L_k45_gelu:
    v_fma_f32 v104, v104, v216, v224
    v_fma_f32 v108, v108, v217, v225
    v_fma_f32 v112, v112, v218, v226
    v_fma_f32 v116, v116, v219, v227
    v_fma_f32 v120, v120, v220, v228
    v_fma_f32 v124, v124, v221, v229
    v_fma_f32 v128, v128, v222, v230
    v_fma_f32 v132, v132, v223, v231
    v_mul_f32 v0, v104, v104
    v_mul_f32 v1, v108, v108
    v_mul_f32 v2, v112, v112
    v_mul_f32 v3, v116, v116
    v_mul_f32 v4, v120, v120
    v_mul_f32 v5, v124, v124
    v_mul_f32 v6, v128, v128
    v_mul_f32 v7, v132, v132
    v_fma_f32 v0, v0, s26, v211
    v_fma_f32 v1, v1, s26, v211
    v_fma_f32 v2, v2, s26, v211
    v_fma_f32 v3, v3, s26, v211
    v_fma_f32 v4, v4, s26, v211
    v_fma_f32 v5, v5, s26, v211
    v_fma_f32 v6, v6, s26, v211
    v_fma_f32 v7, v7, s26, v211
    v_mul_f32 v0, v0, v104
    v_mul_f32 v1, v1, v108
    v_mul_f32 v2, v2, v112
    v_mul_f32 v3, v3, v116
    v_mul_f32 v4, v4, v120
    v_mul_f32 v5, v5, v124
    v_mul_f32 v6, v6, v128
    v_mul_f32 v7, v7, v132
    v_exp_f32 v0, v0
    v_exp_f32 v1, v1
    v_exp_f32 v2, v2
    v_exp_f32 v3, v3
    v_exp_f32 v4, v4
    v_exp_f32 v5, v5
    v_exp_f32 v6, v6
    v_exp_f32 v7, v7
    v_add_f32 v0, 1.0, v0
    v_add_f32 v1, 1.0, v1
    v_add_f32 v2, 1.0, v2
    v_add_f32 v3, 1.0, v3
    v_add_f32 v4, 1.0, v4
    v_add_f32 v5, 1.0, v5
    v_add_f32 v6, 1.0, v6
    v_add_f32 v7, 1.0, v7
    v_rcp_f32 v0, v0
    v_rcp_f32 v1, v1
    v_rcp_f32 v2, v2
    v_rcp_f32 v3, v3
    v_rcp_f32 v4, v4
    v_rcp_f32 v5, v5
    v_rcp_f32 v6, v6
    v_rcp_f32 v7, v7
    v_mul_f32 v0, v0, v104
    v_mul_f32 v1, v1, v108
    v_mul_f32 v2, v2, v112
    v_mul_f32 v3, v3, v116
    v_mul_f32 v4, v4, v120
    v_mul_f32 v5, v5, v124
    v_mul_f32 v6, v6, v128
    v_mul_f32 v7, v7, v132
    v_cvt_pk_bf16_f32 v16, v0, v1
    v_cvt_pk_bf16_f32 v17, v2, v3
    v_cvt_pk_bf16_f32 v18, v4, v5
    v_cvt_pk_bf16_f32 v19, v6, v7
    buffer_store_dwordx4 v[16:19], v210, s[32:35], s52 offen sc1
    v_fma_f32 v105, v105, v216, v224
    v_fma_f32 v109, v109, v217, v225
    v_fma_f32 v113, v113, v218, v226
    v_fma_f32 v117, v117, v219, v227
    v_fma_f32 v121, v121, v220, v228
    v_fma_f32 v125, v125, v221, v229
    v_fma_f32 v129, v129, v222, v230
    v_fma_f32 v133, v133, v223, v231
    v_mul_f32 v0, v105, v105
    v_mul_f32 v1, v109, v109
    v_mul_f32 v2, v113, v113
    v_mul_f32 v3, v117, v117
    v_mul_f32 v4, v121, v121
    v_mul_f32 v5, v125, v125
    v_mul_f32 v6, v129, v129
    v_mul_f32 v7, v133, v133
    v_fma_f32 v0, v0, s26, v211
    v_fma_f32 v1, v1, s26, v211
    v_fma_f32 v2, v2, s26, v211
    v_fma_f32 v3, v3, s26, v211
    v_fma_f32 v4, v4, s26, v211
    v_fma_f32 v5, v5, s26, v211
    v_fma_f32 v6, v6, s26, v211
    v_fma_f32 v7, v7, s26, v211
    v_mul_f32 v0, v0, v105
    v_mul_f32 v1, v1, v109
    v_mul_f32 v2, v2, v113
    v_mul_f32 v3, v3, v117
    v_mul_f32 v4, v4, v121
    v_mul_f32 v5, v5, v125
    v_mul_f32 v6, v6, v129
    v_mul_f32 v7, v7, v133
    v_exp_f32 v0, v0
    v_exp_f32 v1, v1
    v_exp_f32 v2, v2
    v_exp_f32 v3, v3
    v_exp_f32 v4, v4
    v_exp_f32 v5, v5
    v_exp_f32 v6, v6
    v_exp_f32 v7, v7
    v_add_f32 v0, 1.0, v0
    v_add_f32 v1, 1.0, v1
    v_add_f32 v2, 1.0, v2
    v_add_f32 v3, 1.0, v3
    v_add_f32 v4, 1.0, v4
    v_add_f32 v5, 1.0, v5
    v_add_f32 v6, 1.0, v6
    v_add_f32 v7, 1.0, v7
    v_rcp_f32 v0, v0
    v_rcp_f32 v1, v1
    v_rcp_f32 v2, v2
    v_rcp_f32 v3, v3
    v_rcp_f32 v4, v4
    v_rcp_f32 v5, v5
    v_rcp_f32 v6, v6
    v_rcp_f32 v7, v7
    v_mul_f32 v0, v0, v105
    v_mul_f32 v1, v1, v109
    v_mul_f32 v2, v2, v113
    v_mul_f32 v3, v3, v117
    v_mul_f32 v4, v4, v121
    v_mul_f32 v5, v5, v125
    v_mul_f32 v6, v6, v129
    v_mul_f32 v7, v7, v133
    v_cvt_pk_bf16_f32 v20, v0, v1
    v_cvt_pk_bf16_f32 v21, v2, v3
    v_cvt_pk_bf16_f32 v22, v4, v5
    v_cvt_pk_bf16_f32 v23, v6, v7
    buffer_store_dwordx4 v[20:23], v210, s[32:35], s53 offen sc1
    v_fma_f32 v106, v106, v216, v224
    v_fma_f32 v110, v110, v217, v225
    v_fma_f32 v114, v114, v218, v226
    v_fma_f32 v118, v118, v219, v227
    v_fma_f32 v122, v122, v220, v228
    v_fma_f32 v126, v126, v221, v229
    v_fma_f32 v130, v130, v222, v230
    v_fma_f32 v134, v134, v223, v231
    v_mul_f32 v0, v106, v106
    v_mul_f32 v1, v110, v110
    v_mul_f32 v2, v114, v114
    v_mul_f32 v3, v118, v118
    v_mul_f32 v4, v122, v122
    v_mul_f32 v5, v126, v126
    v_mul_f32 v6, v130, v130
    v_mul_f32 v7, v134, v134
    v_fma_f32 v0, v0, s26, v211
    v_fma_f32 v1, v1, s26, v211
    v_fma_f32 v2, v2, s26, v211
    v_fma_f32 v3, v3, s26, v211
    v_fma_f32 v4, v4, s26, v211
    v_fma_f32 v5, v5, s26, v211
    v_fma_f32 v6, v6, s26, v211
    v_fma_f32 v7, v7, s26, v211
    v_mul_f32 v0, v0, v106
    v_mul_f32 v1, v1, v110
    v_mul_f32 v2, v2, v114
    v_mul_f32 v3, v3, v118
    v_mul_f32 v4, v4, v122
    v_mul_f32 v5, v5, v126
    v_mul_f32 v6, v6, v130
    v_mul_f32 v7, v7, v134
    v_exp_f32 v0, v0
    v_exp_f32 v1, v1
    v_exp_f32 v2, v2
    v_exp_f32 v3, v3
    v_exp_f32 v4, v4
    v_exp_f32 v5, v5
    v_exp_f32 v6, v6
    v_exp_f32 v7, v7
    v_add_f32 v0, 1.0, v0
    v_add_f32 v1, 1.0, v1
    v_add_f32 v2, 1.0, v2
    v_add_f32 v3, 1.0, v3
    v_add_f32 v4, 1.0, v4
    v_add_f32 v5, 1.0, v5
    v_add_f32 v6, 1.0, v6
    v_add_f32 v7, 1.0, v7
    v_rcp_f32 v0, v0
    v_rcp_f32 v1, v1
    v_rcp_f32 v2, v2
    v_rcp_f32 v3, v3
    v_rcp_f32 v4, v4
    v_rcp_f32 v5, v5
    v_rcp_f32 v6, v6
    v_rcp_f32 v7, v7
    v_mul_f32 v0, v0, v106
    v_mul_f32 v1, v1, v110
    v_mul_f32 v2, v2, v114
    v_mul_f32 v3, v3, v118
    v_mul_f32 v4, v4, v122
    v_mul_f32 v5, v5, v126
    v_mul_f32 v6, v6, v130
    v_mul_f32 v7, v7, v134
    v_cvt_pk_bf16_f32 v24, v0, v1
    v_cvt_pk_bf16_f32 v25, v2, v3
    v_cvt_pk_bf16_f32 v26, v4, v5
    v_cvt_pk_bf16_f32 v27, v6, v7
    buffer_store_dwordx4 v[24:27], v210, s[32:35], s54 offen sc1
    v_fma_f32 v136, v136, v216, v224
    v_fma_f32 v140, v140, v217, v225
    v_fma_f32 v144, v144, v218, v226
    v_fma_f32 v148, v148, v219, v227
    v_fma_f32 v152, v152, v220, v228
    v_fma_f32 v156, v156, v221, v229
    v_fma_f32 v160, v160, v222, v230
    v_fma_f32 v164, v164, v223, v231
    v_mul_f32 v0, v136, v136
    v_mul_f32 v1, v140, v140
    v_mul_f32 v2, v144, v144
    v_mul_f32 v3, v148, v148
    v_mul_f32 v4, v152, v152
    v_mul_f32 v5, v156, v156
    v_mul_f32 v6, v160, v160
    v_mul_f32 v7, v164, v164
    v_fma_f32 v0, v0, s26, v211
    v_fma_f32 v1, v1, s26, v211
    v_fma_f32 v2, v2, s26, v211
    v_fma_f32 v3, v3, s26, v211
    v_fma_f32 v4, v4, s26, v211
    v_fma_f32 v5, v5, s26, v211
    v_fma_f32 v6, v6, s26, v211
    v_fma_f32 v7, v7, s26, v211
    v_mul_f32 v0, v0, v136
    v_mul_f32 v1, v1, v140
    v_mul_f32 v2, v2, v144
    v_mul_f32 v3, v3, v148
    v_mul_f32 v4, v4, v152
    v_mul_f32 v5, v5, v156
    v_mul_f32 v6, v6, v160
    v_mul_f32 v7, v7, v164
    v_exp_f32 v0, v0
    v_exp_f32 v1, v1
    v_exp_f32 v2, v2
    v_exp_f32 v3, v3
    v_exp_f32 v4, v4
    v_exp_f32 v5, v5
    v_exp_f32 v6, v6
    v_exp_f32 v7, v7
    v_add_f32 v0, 1.0, v0
    v_add_f32 v1, 1.0, v1
    v_add_f32 v2, 1.0, v2
    v_add_f32 v3, 1.0, v3
    v_add_f32 v4, 1.0, v4
    v_add_f32 v5, 1.0, v5
    v_add_f32 v6, 1.0, v6
    v_add_f32 v7, 1.0, v7
    v_rcp_f32 v0, v0
    v_rcp_f32 v1, v1
    v_rcp_f32 v2, v2
    v_rcp_f32 v3, v3
    v_rcp_f32 v4, v4
    v_rcp_f32 v5, v5
    v_rcp_f32 v6, v6
    v_rcp_f32 v7, v7
    v_mul_f32 v0, v0, v136
    v_mul_f32 v1, v1, v140
    v_mul_f32 v2, v2, v144
    v_mul_f32 v3, v3, v148
    v_mul_f32 v4, v4, v152
    v_mul_f32 v5, v5, v156
    v_mul_f32 v6, v6, v160
    v_mul_f32 v7, v7, v164
    v_cvt_pk_bf16_f32 v28, v0, v1
    v_cvt_pk_bf16_f32 v29, v2, v3
    v_cvt_pk_bf16_f32 v30, v4, v5
    v_cvt_pk_bf16_f32 v31, v6, v7
    buffer_store_dwordx4 v[28:31], v210, s[32:35], s55 offen sc1
    v_fma_f32 v137, v137, v216, v224
    v_fma_f32 v141, v141, v217, v225
    v_fma_f32 v145, v145, v218, v226
    v_fma_f32 v149, v149, v219, v227
    v_fma_f32 v153, v153, v220, v228
    v_fma_f32 v157, v157, v221, v229
    v_fma_f32 v161, v161, v222, v230
    v_fma_f32 v165, v165, v223, v231
    v_mul_f32 v0, v137, v137
    v_mul_f32 v1, v141, v141
    v_mul_f32 v2, v145, v145
    v_mul_f32 v3, v149, v149
    v_mul_f32 v4, v153, v153
    v_mul_f32 v5, v157, v157
    v_mul_f32 v6, v161, v161
    v_mul_f32 v7, v165, v165
    v_fma_f32 v0, v0, s26, v211
    v_fma_f32 v1, v1, s26, v211
    v_fma_f32 v2, v2, s26, v211
    v_fma_f32 v3, v3, s26, v211
    v_fma_f32 v4, v4, s26, v211
    v_fma_f32 v5, v5, s26, v211
    v_fma_f32 v6, v6, s26, v211
    v_fma_f32 v7, v7, s26, v211
    v_mul_f32 v0, v0, v137
    v_mul_f32 v1, v1, v141
    v_mul_f32 v2, v2, v145
    v_mul_f32 v3, v3, v149
    v_mul_f32 v4, v4, v153
    v_mul_f32 v5, v5, v157
    v_mul_f32 v6, v6, v161
    v_mul_f32 v7, v7, v165
    v_exp_f32 v0, v0
    v_exp_f32 v1, v1
    v_exp_f32 v2, v2
    v_exp_f32 v3, v3
    v_exp_f32 v4, v4
    v_exp_f32 v5, v5
    v_exp_f32 v6, v6
    v_exp_f32 v7, v7
    v_add_f32 v0, 1.0, v0
    v_add_f32 v1, 1.0, v1
    v_add_f32 v2, 1.0, v2
    v_add_f32 v3, 1.0, v3
    v_add_f32 v4, 1.0, v4
    v_add_f32 v5, 1.0, v5
    v_add_f32 v6, 1.0, v6
    v_add_f32 v7, 1.0, v7
    v_rcp_f32 v0, v0
    v_rcp_f32 v1, v1
    v_rcp_f32 v2, v2
    v_rcp_f32 v3, v3
    v_rcp_f32 v4, v4
    v_rcp_f32 v5, v5
    v_rcp_f32 v6, v6
    v_rcp_f32 v7, v7
    v_mul_f32 v0, v0, v137
    v_mul_f32 v1, v1, v141
    v_mul_f32 v2, v2, v145
    v_mul_f32 v3, v3, v149
    v_mul_f32 v4, v4, v153
    v_mul_f32 v5, v5, v157
    v_mul_f32 v6, v6, v161
    v_mul_f32 v7, v7, v165
    v_cvt_pk_bf16_f32 v32, v0, v1
    v_cvt_pk_bf16_f32 v33, v2, v3
    v_cvt_pk_bf16_f32 v34, v4, v5
    v_cvt_pk_bf16_f32 v35, v6, v7
    buffer_store_dwordx4 v[32:35], v210, s[32:35], s56 offen sc1
    v_fma_f32 v138, v138, v216, v224
    v_fma_f32 v142, v142, v217, v225
    v_fma_f32 v146, v146, v218, v226
    v_fma_f32 v150, v150, v219, v227
    v_fma_f32 v154, v154, v220, v228
    v_fma_f32 v158, v158, v221, v229
    v_fma_f32 v162, v162, v222, v230
    v_fma_f32 v166, v166, v223, v231
    v_mul_f32 v0, v138, v138
    v_mul_f32 v1, v142, v142
    v_mul_f32 v2, v146, v146
    v_mul_f32 v3, v150, v150
    v_mul_f32 v4, v154, v154
    v_mul_f32 v5, v158, v158
    v_mul_f32 v6, v162, v162
    v_mul_f32 v7, v166, v166
    v_fma_f32 v0, v0, s26, v211
    v_fma_f32 v1, v1, s26, v211
    v_fma_f32 v2, v2, s26, v211
    v_fma_f32 v3, v3, s26, v211
    v_fma_f32 v4, v4, s26, v211
    v_fma_f32 v5, v5, s26, v211
    v_fma_f32 v6, v6, s26, v211
    v_fma_f32 v7, v7, s26, v211
    v_mul_f32 v0, v0, v138
    v_mul_f32 v1, v1, v142
    v_mul_f32 v2, v2, v146
    v_mul_f32 v3, v3, v150
    v_mul_f32 v4, v4, v154
    v_mul_f32 v5, v5, v158
    v_mul_f32 v6, v6, v162
    v_mul_f32 v7, v7, v166
    v_exp_f32 v0, v0
    v_exp_f32 v1, v1
    v_exp_f32 v2, v2
    v_exp_f32 v3, v3
    v_exp_f32 v4, v4
    v_exp_f32 v5, v5
    v_exp_f32 v6, v6
    v_exp_f32 v7, v7
    v_add_f32 v0, 1.0, v0
    v_add_f32 v1, 1.0, v1
    v_add_f32 v2, 1.0, v2
    v_add_f32 v3, 1.0, v3
    v_add_f32 v4, 1.0, v4
    v_add_f32 v5, 1.0, v5
    v_add_f32 v6, 1.0, v6
    v_add_f32 v7, 1.0, v7
    v_rcp_f32 v0, v0
    v_rcp_f32 v1, v1
    v_rcp_f32 v2, v2
    v_rcp_f32 v3, v3
    v_rcp_f32 v4, v4
    v_rcp_f32 v5, v5
    v_rcp_f32 v6, v6
    v_rcp_f32 v7, v7
    v_mul_f32 v0, v0, v138
    v_mul_f32 v1, v1, v142
    v_mul_f32 v2, v2, v146
    v_mul_f32 v3, v3, v150
    v_mul_f32 v4, v4, v154
    v_mul_f32 v5, v5, v158
    v_mul_f32 v6, v6, v162
    v_mul_f32 v7, v7, v166
    v_cvt_pk_bf16_f32 v36, v0, v1
    v_cvt_pk_bf16_f32 v37, v2, v3
    v_cvt_pk_bf16_f32 v38, v4, v5
    v_cvt_pk_bf16_f32 v39, v6, v7
    buffer_store_dwordx4 v[36:39], v210, s[32:35], s57 offen sc1
    v_fma_f32 v168, v168, v216, v224
    v_fma_f32 v172, v172, v217, v225
    v_fma_f32 v176, v176, v218, v226
    v_fma_f32 v180, v180, v219, v227
    v_fma_f32 v184, v184, v220, v228
    v_fma_f32 v188, v188, v221, v229
    v_fma_f32 v192, v192, v222, v230
    v_fma_f32 v196, v196, v223, v231
    v_mul_f32 v0, v168, v168
    v_mul_f32 v1, v172, v172
    v_mul_f32 v2, v176, v176
    v_mul_f32 v3, v180, v180
    v_mul_f32 v4, v184, v184
    v_mul_f32 v5, v188, v188
    v_mul_f32 v6, v192, v192
    v_mul_f32 v7, v196, v196
    v_fma_f32 v0, v0, s26, v211
    v_fma_f32 v1, v1, s26, v211
    v_fma_f32 v2, v2, s26, v211
    v_fma_f32 v3, v3, s26, v211
    v_fma_f32 v4, v4, s26, v211
    v_fma_f32 v5, v5, s26, v211
    v_fma_f32 v6, v6, s26, v211
    v_fma_f32 v7, v7, s26, v211
    v_mul_f32 v0, v0, v168
    v_mul_f32 v1, v1, v172
    v_mul_f32 v2, v2, v176
    v_mul_f32 v3, v3, v180
    v_mul_f32 v4, v4, v184
    v_mul_f32 v5, v5, v188
    v_mul_f32 v6, v6, v192
    v_mul_f32 v7, v7, v196
    v_exp_f32 v0, v0
    v_exp_f32 v1, v1
    v_exp_f32 v2, v2
    v_exp_f32 v3, v3
    v_exp_f32 v4, v4
    v_exp_f32 v5, v5
    v_exp_f32 v6, v6
    v_exp_f32 v7, v7
    v_add_f32 v0, 1.0, v0
    v_add_f32 v1, 1.0, v1
    v_add_f32 v2, 1.0, v2
    v_add_f32 v3, 1.0, v3
    v_add_f32 v4, 1.0, v4
    v_add_f32 v5, 1.0, v5
    v_add_f32 v6, 1.0, v6
    v_add_f32 v7, 1.0, v7
    v_rcp_f32 v0, v0
    v_rcp_f32 v1, v1
    v_rcp_f32 v2, v2
    v_rcp_f32 v3, v3
    v_rcp_f32 v4, v4
    v_rcp_f32 v5, v5
    v_rcp_f32 v6, v6
    v_rcp_f32 v7, v7
    v_mul_f32 v0, v0, v168
    v_mul_f32 v1, v1, v172
    v_mul_f32 v2, v2, v176
    v_mul_f32 v3, v3, v180
    v_mul_f32 v4, v4, v184
    v_mul_f32 v5, v5, v188
    v_mul_f32 v6, v6, v192
    v_mul_f32 v7, v7, v196
    v_cvt_pk_bf16_f32 v40, v0, v1
    v_cvt_pk_bf16_f32 v41, v2, v3
    v_cvt_pk_bf16_f32 v42, v4, v5
    v_cvt_pk_bf16_f32 v43, v6, v7
    buffer_store_dwordx4 v[40:43], v210, s[32:35], s58 offen sc1
    v_fma_f32 v169, v169, v216, v224
    v_fma_f32 v173, v173, v217, v225
    v_fma_f32 v177, v177, v218, v226
    v_fma_f32 v181, v181, v219, v227
    v_fma_f32 v185, v185, v220, v228
    v_fma_f32 v189, v189, v221, v229
    v_fma_f32 v193, v193, v222, v230
    v_fma_f32 v197, v197, v223, v231
    v_mul_f32 v0, v169, v169
    v_mul_f32 v1, v173, v173
    v_mul_f32 v2, v177, v177
    v_mul_f32 v3, v181, v181
    v_mul_f32 v4, v185, v185
    v_mul_f32 v5, v189, v189
    v_mul_f32 v6, v193, v193
    v_mul_f32 v7, v197, v197
    v_fma_f32 v0, v0, s26, v211
    v_fma_f32 v1, v1, s26, v211
    v_fma_f32 v2, v2, s26, v211
    v_fma_f32 v3, v3, s26, v211
    v_fma_f32 v4, v4, s26, v211
    v_fma_f32 v5, v5, s26, v211
    v_fma_f32 v6, v6, s26, v211
    v_fma_f32 v7, v7, s26, v211
    v_mul_f32 v0, v0, v169
    v_mul_f32 v1, v1, v173
    v_mul_f32 v2, v2, v177
    v_mul_f32 v3, v3, v181
    v_mul_f32 v4, v4, v185
    v_mul_f32 v5, v5, v189
    v_mul_f32 v6, v6, v193
    v_mul_f32 v7, v7, v197
    v_exp_f32 v0, v0
    v_exp_f32 v1, v1
    v_exp_f32 v2, v2
    v_exp_f32 v3, v3
    v_exp_f32 v4, v4
    v_exp_f32 v5, v5
    v_exp_f32 v6, v6
    v_exp_f32 v7, v7
    v_add_f32 v0, 1.0, v0
    v_add_f32 v1, 1.0, v1
    v_add_f32 v2, 1.0, v2
    v_add_f32 v3, 1.0, v3
    v_add_f32 v4, 1.0, v4
    v_add_f32 v5, 1.0, v5
    v_add_f32 v6, 1.0, v6
    v_add_f32 v7, 1.0, v7
    v_rcp_f32 v0, v0
    v_rcp_f32 v1, v1
    v_rcp_f32 v2, v2
    v_rcp_f32 v3, v3
    v_rcp_f32 v4, v4
    v_rcp_f32 v5, v5
    v_rcp_f32 v6, v6
    v_rcp_f32 v7, v7
    v_mul_f32 v0, v0, v169
    v_mul_f32 v1, v1, v173
    v_mul_f32 v2, v2, v177
    v_mul_f32 v3, v3, v181
    v_mul_f32 v4, v4, v185
    v_mul_f32 v5, v5, v189
    v_mul_f32 v6, v6, v193
    v_mul_f32 v7, v7, v197
    v_cvt_pk_bf16_f32 v44, v0, v1
    v_cvt_pk_bf16_f32 v45, v2, v3
    v_cvt_pk_bf16_f32 v46, v4, v5
    v_cvt_pk_bf16_f32 v47, v6, v7
    buffer_store_dwordx4 v[44:47], v210, s[32:35], s59 offen sc1
    v_fma_f32 v170, v170, v216, v224
    v_fma_f32 v174, v174, v217, v225
    v_fma_f32 v178, v178, v218, v226
    v_fma_f32 v182, v182, v219, v227
    v_fma_f32 v186, v186, v220, v228
    v_fma_f32 v190, v190, v221, v229
    v_fma_f32 v194, v194, v222, v230
    v_fma_f32 v198, v198, v223, v231
    v_mul_f32 v0, v170, v170
    v_mul_f32 v1, v174, v174
    v_mul_f32 v2, v178, v178
    v_mul_f32 v3, v182, v182
    v_mul_f32 v4, v186, v186
    v_mul_f32 v5, v190, v190
    v_mul_f32 v6, v194, v194
    v_mul_f32 v7, v198, v198
    v_fma_f32 v0, v0, s26, v211
    v_fma_f32 v1, v1, s26, v211
    v_fma_f32 v2, v2, s26, v211
    v_fma_f32 v3, v3, s26, v211
    v_fma_f32 v4, v4, s26, v211
    v_fma_f32 v5, v5, s26, v211
    v_fma_f32 v6, v6, s26, v211
    v_fma_f32 v7, v7, s26, v211
    v_mul_f32 v0, v0, v170
    v_mul_f32 v1, v1, v174
    v_mul_f32 v2, v2, v178
    v_mul_f32 v3, v3, v182
    v_mul_f32 v4, v4, v186
    v_mul_f32 v5, v5, v190
    v_mul_f32 v6, v6, v194
    v_mul_f32 v7, v7, v198
    v_exp_f32 v0, v0
    v_exp_f32 v1, v1
    v_exp_f32 v2, v2
    v_exp_f32 v3, v3
    v_exp_f32 v4, v4
    v_exp_f32 v5, v5
    v_exp_f32 v6, v6
    v_exp_f32 v7, v7
    v_add_f32 v0, 1.0, v0
    v_add_f32 v1, 1.0, v1
    v_add_f32 v2, 1.0, v2
    v_add_f32 v3, 1.0, v3
    v_add_f32 v4, 1.0, v4
    v_add_f32 v5, 1.0, v5
    v_add_f32 v6, 1.0, v6
    v_add_f32 v7, 1.0, v7
    v_rcp_f32 v0, v0
    v_rcp_f32 v1, v1
    v_rcp_f32 v2, v2
    v_rcp_f32 v3, v3
    v_rcp_f32 v4, v4
    v_rcp_f32 v5, v5
    v_rcp_f32 v6, v6
    v_rcp_f32 v7, v7
    v_mul_f32 v0, v0, v170
    v_mul_f32 v1, v1, v174
    v_mul_f32 v2, v2, v178
    v_mul_f32 v3, v3, v182
    v_mul_f32 v4, v4, v186
    v_mul_f32 v5, v5, v190
    v_mul_f32 v6, v6, v194
    v_mul_f32 v7, v7, v198
    v_cvt_pk_bf16_f32 v16, v0, v1
    v_cvt_pk_bf16_f32 v17, v2, v3
    v_cvt_pk_bf16_f32 v18, v4, v5
    v_cvt_pk_bf16_f32 v19, v6, v7
    buffer_store_dwordx4 v[16:19], v210, s[32:35], s60 offen sc1
L_k45_fin:
L_k45_end:
    s_endpgm
L_code_end:
    s_endpgm
.section .rodata,"a"
.p2align 6
.amdhsa_kernel conv_kernel
  .amdhsa_next_free_vgpr 256
  .amdhsa_next_free_sgpr 96
  .amdhsa_accum_offset 256
  .amdhsa_group_segment_fixed_size 0
  .amdhsa_kernarg_size 56
  .amdhsa_user_sgpr_count 2
  .amdhsa_user_sgpr_kernarg_segment_ptr 1
  .amdhsa_system_sgpr_workgroup_id_x 1
  .amdhsa_float_denorm_mode_32 3
.end_amdhsa_kernel

.p2align 6
.amdhsa_kernel final_kernel
  .amdhsa_next_free_vgpr 240
  .amdhsa_next_free_sgpr 96
  .amdhsa_accum_offset 240
  .amdhsa_group_segment_fixed_size 0
  .amdhsa_kernarg_size 56
  .amdhsa_user_sgpr_count 2
  .amdhsa_user_sgpr_kernarg_segment_ptr 1
  .amdhsa_system_sgpr_workgroup_id_x 1
  .amdhsa_float_denorm_mode_32 3
.end_amdhsa_kernel
```
